```python
import torch

def _softmax(x, axis=-1):
    return torch.softmax(x, dim=axis)

def _gelu(x):
    return torch.nn.functional.gelu(x, approximate='tanh')

def _silu(x):
    return torch.nn.functional.silu(x)

def _sigmoid(x):
    return torch.sigmoid(x)

def _layernorm(x, axis=-1, eps=1e-05):
    m = x.mean(dim=axis, keepdim=True)
    v = x.var(dim=axis, keepdim=True, unbiased=False)
    return (x - m) / torch.sqrt(v + eps)

def _scatter_add(tgt, idx, src, axis=0):
    return tgt.clone().index_add_(axis, idx, src)

def _segment_sum(src, seg, n):
    out = torch.zeros((n,) + src.shape[1:], dtype=src.dtype)
    return out.index_add_(0, seg, src)

def _pad(x, pw):
    flat = tuple((v for pair in reversed(pw) for v in pair))
    return torch.nn.functional.pad(x, flat)
kernel_name = 'adaLN_cond__sliding_block_cached__moe_arch_mod__decode'

def setup_inputs():

    _w = lambda a: (lambda t: t.to(torch.bfloat16) if t.is_floating_point() else t)(torch.as_tensor(a))

    def _A_setup():
        B, Sq, D = (8, 1, 576)
        Hq, Hkv, Sk, Dh = (32, 16, 8192, 128)
        assert Hq % Hkv == 0, (Hq, Hkv)
        return {'x': _w((lambda *s: torch.randn(*s, dtype=torch.bfloat16) * 0.1)(B, Sq, D)), 'k_cache': _w((lambda *s: torch.randn(*s, dtype=torch.bfloat16) * 0.8)(B, Hkv, Sk, Dh)), 'v_cache': _w((lambda *s: torch.randn(*s, dtype=torch.bfloat16) * 0.8)(B, Hkv, Sk, Dh)), 'wq': _w((lambda *s: torch.randn(*s, dtype=torch.bfloat16) * 0.8)(D, Hq * Dh) * D ** (-0.5)), 'wo': _w((lambda *s: torch.randn(*s, dtype=torch.bfloat16) * 0.8)(Hq * Dh, D) * (Hq * Dh) ** (-0.5))}
    _A_in = _A_setup()

    def _B_setup():
        B, S, D, F, C = (8, 1, 576, 4608, 1)
        return {'x': _w((lambda *s: torch.randn(*s, dtype=torch.bfloat16) * 0.1)(B, S, D)), 'w_r': _w((lambda *s: torch.randn(*s, dtype=torch.bfloat16) * 0.2)(D)), 'w_gate': _w((lambda *s: torch.randn(*s, dtype=torch.bfloat16) * 0.1)(D, F)), 'w_up': _w((lambda *s: torch.randn(*s, dtype=torch.bfloat16) * 0.1)(D, F)), 'w_down': _w((lambda *s: torch.randn(*s, dtype=torch.bfloat16) * 0.1)(F, D))}
    _B_in = _B_setup()
    return {'A_x': _A_in['x'], 'A_k_cache': _A_in['k_cache'], 'A_v_cache': _A_in['v_cache'], 'A_wq': _A_in['wq'], 'A_wo': _A_in['wo'], 'B_x': _B_in['x'], 'B_w_r': _B_in['w_r'], 'B_w_gate': _B_in['w_gate'], 'B_w_up': _B_in['w_up'], 'B_w_down': _B_in['w_down'], 'c': _w((lambda *s: torch.randn(*s, dtype=torch.bfloat16) * 0.4)(8, 576) * 8.0), 'w_mod': _w((lambda *s: torch.randn(*s, dtype=torch.bfloat16) * 0.4)(576, 6 * 576) * 576 ** (-0.5) * 8.0)}

def reference(A_x, A_k_cache, A_v_cache, A_wq, A_wo, B_x, B_w_r, B_w_gate, B_w_up, B_w_down, c, w_mod):

    def _A_ref(x, k_cache, v_cache, wq, wo):
        B, Sq, D = x.shape
        Hq, Dh = (32, 128)
        Hkv, Sk = (k_cache.shape[1], k_cache.shape[2])
        W = min(4096, max(256, Sk // 4))
        rep = Hq // Hkv
        q = (lambda x, *d: x.permute(*d))((x @ wq).reshape(B, Sq, Hq, Dh), 0, 2, 1, 3)
        k = (lambda x, n, axis: torch.repeat_interleave(x, n, dim=axis))(k_cache[:, :, Sk - W:, :], rep, axis=1)
        v = (lambda x, n, axis: torch.repeat_interleave(x, n, dim=axis))(v_cache[:, :, Sk - W:, :], rep, axis=1)
        scores = torch.einsum('bhqd,bhkd->bhqk', q, k) * Dh ** (-0.5)
        p = _softmax(scores, axis=-1)
        o = torch.einsum('bhqk,bhkd->bhqd', p, v)
        return (lambda x, *d: x.permute(*d))(o, 0, 2, 1, 3).reshape(B, Sq, Hq * Dh) @ wo

    def _B_ref(x, w_r, w_gate, w_up, w_down):
        B, S, D = x.shape
        C = 1
        r = x @ w_r
        idx = torch.argsort(-r, axis=-1)[:, :C]
        idx_e = (lambda x, n, axis: torch.repeat_interleave(x, n, dim=axis))(idx.reshape(B, C, 1), D, axis=2)
        x_sel = (lambda x, i, axis: torch.take_along_dim(x, i, dim=axis))(x, idx_e, axis=1)
        g = _silu(x_sel @ w_gate)
        u = x_sel @ w_up
        y = g * u @ w_down
        r_sel = _sigmoid((lambda x, i, axis: torch.take_along_dim(x, i, dim=axis))(r, idx, axis=1))
        y = y * r_sel.reshape(B, C, 1)
        b_off = (torch.arange(B) * S).reshape(B, 1)
        flat_idx = (idx + b_off).reshape(B * C)
        zero = (x * 0.0).reshape(B * S, D)
        upd = _scatter_add(zero, flat_idx, y.reshape(B * C, D), axis=0)
        return x + upd.reshape(B, S, D)
    x = A_x
    mod = (_silu(c) @ w_mod).reshape(c.shape[0], 6, 1, -1)
    sa, ca, ga, sb, cb, gb = (mod[:, 0].clone(), mod[:, 1].clone(), mod[:, 2].clone(), mod[:, 3].clone(), mod[:, 4].clone(), mod[:, 5].clone())
    h = _layernorm(x, axis=-1) * (1 + ca) + sa
    x = x + ga * _A_ref(h, A_k_cache, A_v_cache, A_wq, A_wo)
    h = _layernorm(x, axis=-1) * (1 + cb) + sb
    x = x + gb * _B_ref(h, B_w_r, B_w_gate, B_w_up, B_w_down)
    return x
```

```asm
; @launch grid=(256,1,1) block=(512,1,1) lds=159104
.amdgcn_target "amdgcn-amd-amdhsa--gfx950"
.text
.p2align 12
.globl adaLN_cond__sliding_block_cached__moe_arch_mod__decode_kernel
.p2align 8
.type adaLN_cond__sliding_block_cached__moe_arch_mod__decode_kernel,@function
adaLN_cond__sliding_block_cached__moe_arch_mod__decode_kernel:
    s_cmp_ge_u32 s2, 256
    s_cbranch_scc1 .Lend
    s_load_dwordx16 s[4:19], s[0:1], 0
    s_load_dwordx8 s[20:27], s[0:1], 64
    s_load_dwordx4 s[28:31], s[0:1], 96
    s_load_dwordx2 s[32:33], s[0:1], 112
    s_memrealtime s[70:71]
    v_lshrrev_b32 v1, 6, v0
    v_and_b32 v0, 63, v0
    v_readfirstlane_b32 s3, v1
    s_mov_b32 s35, 0x3ffff
    s_mov_b32 s98, 0xbfb8aa3b
    s_mov_b32 s94, 0x05040100
    s_mov_b32 s95, 0x07060302
    s_mov_b32 s96, 0xaaaaaaaa
    s_mov_b32 s97, 0xaaaaaaaa
    s_and_b32 s64, s2, 7
    s_lshr_b32 s65, s2, 3
    s_cmp_eq_u32 s65, 0
    s_cselect_b32 s57, 21, s65
    s_cmp_eq_u32 s65, 21
    s_cselect_b32 s57, 0, s57
    s_and_b32 s66, s57, 7
    s_lshr_b32 s67, s57, 4
    s_lshl1_add_u32 s67, s64, s67
    s_bfe_u32 s68, s57, 0x10003
    s_lshl4_add_u32 s69, s66, s67
    s_lshl_b32 s69, s69, 21
    s_cmp_eq_u32 s64, 7
    s_cselect_b32 s58, 0x404000, 0
    s_or_b32 s58, s58, 0x1808001
    s_cmp_lt_u32 s57, 16
    s_cselect_b32 s58, s58, 0
    s_lshr_b32 s58, s58, s57
    s_movk_i32 s60, 0x3210
    s_bitcmp1_b32 s58, 0
    s_cselect_b32 s60, 0x4320, s60
    s_bitcmp1_b32 s58, 16
    s_cselect_b32 s60, 0x7651, s60
    s_and_b32 s57, s3, 1
    s_and_b32 s59, s3, 6
    s_cmpk_eq_u32 s60, 0x3210
    s_cselect_b32 s57, s68, s57
    s_cselect_b32 s59, s3, s59
    s_lshl_b32 s57, s57, 16
    s_lshl_b32 s59, s59, 10
    s_add_u32 s69, s69, s57
    s_add_u32 s69, s69, s59
    s_add_u32 s69, s69, 0x180000
    v_bfe_u32 v1, v0, 2, 2
    v_lshlrev_b32 v1, 2, v1
    v_bfe_u32 v1, s60, v1, 4
    v_lshrrev_b32 v2, 4, v0
    v_lshl_add_u32 v1, v1, 2, v2
    v_and_b32 v2, 3, v0
    v_lshl_add_u32 v1, v1, 2, v2
    v_lshlrev_b32 v1, 4, v1
    v_lshlrev_b32 v2, 4, v0
    v_lshlrev_b32 v3, 3, v0
    v_and_b32 v4, 31, v0
    v_lshlrev_b32 v4, 2, v4
    v_add_u32 v4, 1024, v4
    v_lshlrev_b32 v5, 1, v4
    s_waitcnt lgkmcnt(0)
    s_load_dword s34, s[32:33], 0
    s_mov_b32 s40, s6
    s_and_b32 s41, s7, 0xffff
    s_mov_b32 s42, 0x10000000
    s_mov_b32 s43, 0x00020000
    s_mov_b32 s6, s60
    s_add_u32 s63, s69, 0
    buffer_load_dwordx4 v[32:35], v1, s[40:43], s63 offen nt
    s_add_u32 s63, s69, 8192
    buffer_load_dwordx4 v[36:39], v1, s[40:43], s63 offen nt
    s_add_u32 s63, s69, 16384
    buffer_load_dwordx4 v[64:67], v1, s[40:43], s63 offen nt
    s_add_u32 s63, s69, 24576
    buffer_load_dwordx4 v[68:71], v1, s[40:43], s63 offen nt
    s_mov_b32 s44, s8
    s_and_b32 s45, s9, 0xffff
    s_mov_b32 s46, 0x10000000
    s_mov_b32 s47, 0x00020000
    s_mov_b32 s36, s32
    s_and_b32 s37, s33, 0xffff
    s_mov_b32 s38, 0x40000000
    s_mov_b32 s39, 0x00020000
    s_lshl3_add_u32 s56, s3, s2
    s_cmp_lt_u32 s56, 8
    s_cbranch_scc0 .Let_no
    s_lshl2_add_u32 s56, s2, 0x4a1000
    v_lshlrev_b32 v6, 8, v0
    v_mov_b32 v7, s70
    s_mov_b64 exec, 3
    buffer_store_dword v7, v6, s[36:39], s56 offen sc1
    s_mov_b64 exec, -1
.Let_no:
    s_cmp_lt_u32 s3, 4
    s_cbranch_scc1 1
    s_setprio 1
    s_cmp_lt_u32 s65, 9
    s_cbranch_scc1 .Lm
    s_cmp_lt_u32 s65, 18
    s_cbranch_scc1 .Lbc
    s_sub_u32 s65, s65, 18
    s_cmp_ge_u32 s65, 8
    s_cbranch_scc1 .La_early
    s_cmp_eq_u32 s65, 3
    s_mov_b32 s14, 0xb55aab55
    s_cselect_b32 s14, 0x8421084, s14
    s_mov_b32 s15, 0x5aab55aa
    s_cselect_b32 s15, 0x42108421, s15
    s_add_u32 s30, s70, 0
    s_mov_b32 s31, s70
    v_bfe_u32 v16, v0, 1, 3
    v_mul_u32_u24 v16, 1312, v16
    v_lshrrev_b32 v12, 4, v0
    v_lshl_add_u32 v16, v12, 5, v16
    v_and_b32 v12, 1, v0
    v_lshl_add_u32 v16, v12, 4, v16
    v_add_u32 v16, 147456, v16
    s_mul_i32 s56, s3, 1312
    s_add_u32 s56, s56, 147456
    v_add_u32 v17, s56, v3
    v_add_u32 v18, s56, v4
    v_lshrrev_b32 v12, 4, v0
    v_bfe_u32 v13, v0, 1, 1
    v_lshl_add_u32 v12, v12, 1, v13
    v_bfe_u32 v13, v0, 2, 2
    v_lshl_add_u32 v20, v12, 3, v13
    v_lshlrev_b32 v20, 7, v20
    v_and_b32 v12, 3, v12
    v_lshrrev_b32 v13, 1, v13
    v_lshl_add_u32 v12, v12, 1, v13
    v_xor_b32 v12, s3, v12
    v_lshl_add_u32 v20, v12, 4, v20
    v_and_b32 v12, 1, v0
    v_lshl_add_u32 v20, v12, 3, v20
    v_bfe_u32 v23, v0, 1, 3
    v_mul_u32_u24 v23, 144, v23
    v_bfe_u32 v12, v0, 4, 1
    v_lshl_add_u32 v23, v12, 3, v23
    v_lshrrev_b32 v12, 5, v0
    v_lshl_add_u32 v23, v12, 2, v23
    v_and_b32 v12, 1, v0
    v_lshl_add_u32 v23, v12, 1, v23
    s_lshl_b32 s56, s3, 4
    s_add_u32 s56, s56, 157952
    v_add_u32 v23, s56, v23
    v_and_b32 v24, 15, v0
    v_lshlrev_b32 v24, 3, v24
    s_mul_i32 s56, s3, 144
    s_add_u32 s56, s56, 157952
    v_add_u32 v24, s56, v24
    v_add_u32 v21, 32768, v20
    s_lshl_b32 s100, s3, 10
    s_mul_i32 s58, s3, 1152
    s_mov_b32 s52, s4
    s_and_b32 s53, s5, 0xffff
    s_mov_b32 s54, 0x2400
    s_mov_b32 s55, 0x00020000
    buffer_load_dwordx2 v[246:247], v3, s[52:55], s58 offen
    buffer_load_dwordx2 v[248:249], v3, s[52:55], s58 offen offset:512
    buffer_load_dword v250, v4, s[52:55], s58 offen
    s_mov_b32 s48, s10
    s_and_b32 s49, s11, 0xffff
    s_mov_b32 s50, 0x480000
    s_mov_b32 s51, 0x00020000
    v_bfe_u32 v12, v0, 4, 1
    s_and_b32 s56, s3, 3
    s_lshl_b32 s56, s56, 1
    v_or_b32 v12, s56, v12
    v_and_b32 v19, 7, v0
    v_xor_b32 v12, v12, v19
    v_lshrrev_b32 v19, 3, v0
    v_mul_u32_u24 v19, 8192, v19
    v_lshl_add_u32 v19, v12, 4, v19
    s_lshl3_add_u32 s101, s64, s65
    s_lshl_b32 s57, s3, 16
    s_lshl_b32 s59, s101, 7
    s_add_u32 s57, s57, s59
    s_mov_b32 s99, s57
    s_add_u32 m0, s100, 0
    s_add_u32 s56, s99, 0
    buffer_load_dwordx4 v19, s[48:51], s56 offen nt lds
    s_add_u32 s63, s69, 32768
    buffer_load_dwordx4 v[96:99], v1, s[40:43], s63 offen nt
    s_waitcnt lgkmcnt(0)
    s_add_u32 s34, s34, 1
    s_getreg_b32 s1, hwreg(HW_REG_XCC_ID)
    s_lshl_b32 s1, s1, 24
    s_add_u32 s1, s1, s34
    s_lshr_b32 s0, s2, 3
    s_lshl3_add_u32 s63, s64, s3
    s_lshl_b32 s63, s63, 5
    s_add_u32 s0, s0, s63
    s_lshl2_add_u32 s0, s0, 0x480000
    v_mov_b32 v30, s1
    s_mov_b64 exec, 1
    buffer_store_dword v30, v2, s[36:39], s0 offen sc1
    s_mov_b64 exec, -1
    s_lshl_b32 s101, s101, 8
    s_lshl_b32 s58, s3, 14
    s_add_u32 s101, s101, s58
    s_add_u32 s101, s101, 0x70000
    s_and_b32 s58, s64, 1
    s_mul_i32 s58, s58, 18432
    s_mul_i32 s59, s3, 2304
    s_add_u32 s58, s58, s59
    s_add_u32 s58, s58, 0x1000
    s_add_u32 s59, s58, 73728
    s_waitcnt vmcnt(5)
    s_add_u32 m0, s100, 8192
    s_add_u32 s56, s99, 524288
    buffer_load_dwordx4 v19, s[48:51], s56 offen nt lds
    s_waitcnt vmcnt(5)
    s_add_u32 s63, s69, 40960
    buffer_load_dwordx4 v[100:103], v1, s[40:43], s63 offen nt
    s_waitcnt vmcnt(5)
    s_add_u32 m0, s100, 16384
    s_add_u32 s56, s99, 1048576
    buffer_load_dwordx4 v19, s[48:51], s56 offen nt lds
    s_waitcnt vmcnt(5)
    s_add_u32 s63, s69, 49152
    buffer_load_dwordx4 v[128:131], v1, s[40:43], s63 offen nt
    v_lshlrev_b32 v236, 16, v246
    v_and_b32 v237, 0xffff0000, v246
    v_lshlrev_b32 v238, 16, v247
    v_and_b32 v239, 0xffff0000, v247
    v_lshlrev_b32 v240, 16, v248
    v_and_b32 v241, 0xffff0000, v248
    v_lshlrev_b32 v242, 16, v249
    v_and_b32 v243, 0xffff0000, v249
    v_lshlrev_b32 v244, 16, v250
    v_and_b32 v245, 0xffff0000, v250
    s_mov_b32 s56, 0x3f803f80
    v_dot2_f32_bf16 v10, v246, s56, 0
    v_dot2_f32_bf16 v11, v246, v246, 0
    v_dot2_f32_bf16 v10, v247, s56, v10
    v_dot2_f32_bf16 v11, v247, v247, v11
    v_dot2_f32_bf16 v10, v248, s56, v10
    v_dot2_f32_bf16 v11, v248, v248, v11
    v_dot2_f32_bf16 v10, v249, s56, v10
    v_dot2_f32_bf16 v11, v249, v249, v11
    s_mov_b64 exec, 0xffffffff
    v_dot2_f32_bf16 v10, v250, s56, v10
    v_dot2_f32_bf16 v11, v250, v250, v11
    s_mov_b64 exec, -1
    s_nop 1
    v_permlane32_swap_b32 v10, v11
    v_add_f32 v10, v10, v11
    v_mov_b32 v12, v10
    s_nop 1
    v_permlane16_swap_b32 v12, v10
    v_add_f32 v10, v12, v10
    s_nop 1
    v_add_f32_dpp v10, v10, v10 row_ror:8 row_mask:0xf bank_mask:0xf
    s_nop 1
    v_add_f32_dpp v10, v10, v10 row_ror:4 row_mask:0xf bank_mask:0xf
    s_nop 1
    v_add_f32_dpp v10, v10, v10 quad_perm:[2,3,0,1] row_mask:0xf bank_mask:0xf
    s_nop 1
    v_add_f32_dpp v10, v10, v10 quad_perm:[1,0,3,2] row_mask:0xf bank_mask:0xf
    v_mul_f32 v10, 0x3ae38e39, v10
    s_nop 0
    v_readlane_b32 s56, v10, 0
    v_readlane_b32 s57, v10, 32
    s_nop 0
    v_mov_b32 v10, s56
    v_fma_f32 v11, -v10, v10, s57
    v_max_f32 v11, 0, v11
    v_cvt_pk_bf16_f32 v12, -v10, v11
    v_and_b32 v13, 0xffff0000, v12
    v_add_f32 v13, 0x3727c5ac, v13
    v_lshlrev_b32 v10, 16, v12
    v_cvt_pk_bf16_f32 v13, v13, v13
    v_lshlrev_b32 v13, 16, v13
    v_sqrt_f32 v13, v13
    v_mov_b32 v11, v10
    v_cvt_pk_bf16_f32 v13, v13, v13
    v_lshlrev_b32 v13, 16, v13
    v_rcp_f32 v12, v13
    v_rcp_f32 v13, v13
    v_pk_add_f32 v[236:237], v[236:237], v[10:11]
    v_pk_add_f32 v[238:239], v[238:239], v[10:11]
    v_pk_add_f32 v[240:241], v[240:241], v[10:11]
    v_pk_add_f32 v[242:243], v[242:243], v[10:11]
    v_pk_add_f32 v[244:245], v[244:245], v[10:11]
    v_cvt_pk_bf16_f32 v236, v236, v237
    v_and_b32 v237, 0xffff0000, v236
    v_lshlrev_b32 v236, 16, v236
    v_cvt_pk_bf16_f32 v238, v238, v239
    v_and_b32 v239, 0xffff0000, v238
    v_lshlrev_b32 v238, 16, v238
    v_cvt_pk_bf16_f32 v240, v240, v241
    v_and_b32 v241, 0xffff0000, v240
    v_lshlrev_b32 v240, 16, v240
    v_cvt_pk_bf16_f32 v242, v242, v243
    v_and_b32 v243, 0xffff0000, v242
    v_lshlrev_b32 v242, 16, v242
    v_cvt_pk_bf16_f32 v244, v244, v245
    v_and_b32 v245, 0xffff0000, v244
    v_lshlrev_b32 v244, 16, v244
    v_pk_mul_f32 v[236:237], v[236:237], v[12:13]
    v_pk_mul_f32 v[238:239], v[238:239], v[12:13]
    v_pk_mul_f32 v[240:241], v[240:241], v[12:13]
    v_pk_mul_f32 v[242:243], v[242:243], v[12:13]
    v_pk_mul_f32 v[244:245], v[244:245], v[12:13]
    v_cvt_pk_bf16_f32 v236, v236, v237
    v_and_b32 v237, 0xffff0000, v236
    v_lshlrev_b32 v236, 16, v236
    v_cvt_pk_bf16_f32 v238, v238, v239
    v_and_b32 v239, 0xffff0000, v238
    v_lshlrev_b32 v238, 16, v238
    v_cvt_pk_bf16_f32 v240, v240, v241
    v_and_b32 v241, 0xffff0000, v240
    v_lshlrev_b32 v240, 16, v240
    v_cvt_pk_bf16_f32 v242, v242, v243
    v_and_b32 v243, 0xffff0000, v242
    v_lshlrev_b32 v242, 16, v242
    v_cvt_pk_bf16_f32 v244, v244, v245
    v_and_b32 v245, 0xffff0000, v244
    v_lshlrev_b32 v244, 16, v244
    s_waitcnt vmcnt(5)
    s_add_u32 m0, s100, 24576
    s_add_u32 s56, s99, 1572864
    buffer_load_dwordx4 v19, s[48:51], s56 offen nt lds
    s_waitcnt vmcnt(4)
    s_add_u32 s63, s69, 57344
    buffer_load_dwordx4 v[132:135], v1, s[40:43], s63 offen nt
    s_waitcnt vmcnt(4)
    s_add_u32 m0, s100, 32768
    s_add_u32 s56, s99, 2097152
    buffer_load_dwordx4 v19, s[48:51], s56 offen nt lds
    s_waitcnt vmcnt(4)
    s_add_u32 s63, s69, 131072
    buffer_load_dwordx4 v[40:43], v1, s[40:43], s63 offen nt
    s_waitcnt vmcnt(4)
    s_add_u32 m0, s100, 40960
    s_add_u32 s56, s99, 2621440
    buffer_load_dwordx4 v19, s[48:51], s56 offen nt lds
    s_waitcnt vmcnt(4)
    s_add_u32 s63, s69, 139264
    buffer_load_dwordx4 v[44:47], v1, s[40:43], s63 offen nt
    s_waitcnt vmcnt(4)
    s_add_u32 m0, s100, 49152
    s_add_u32 s56, s99, 3145728
    buffer_load_dwordx4 v19, s[48:51], s56 offen nt lds
    s_waitcnt vmcnt(4)
    s_add_u32 s63, s69, 147456
    buffer_load_dwordx4 v[72:75], v1, s[40:43], s63 offen nt
    s_waitcnt vmcnt(4)
    s_add_u32 m0, s100, 57344
    s_add_u32 s56, s99, 3670016
    buffer_load_dwordx4 v19, s[48:51], s56 offen nt lds
    s_waitcnt vmcnt(4)
    s_add_u32 s63, s69, 155648
    buffer_load_dwordx4 v[76:79], v1, s[40:43], s63 offen nt
    s_waitcnt vmcnt(4)
    s_add_u32 m0, s100, 65536
    s_add_u32 s56, s99, 4194304
    buffer_load_dwordx4 v19, s[48:51], s56 offen nt lds
    s_waitcnt vmcnt(4)
    s_add_u32 s63, s69, 163840
    buffer_load_dwordx4 v[104:107], v1, s[40:43], s63 offen nt
    s_waitcnt vmcnt(4)
    s_add_u32 s63, s69, 172032
    buffer_load_dwordx4 v[108:111], v1, s[40:43], s63 offen nt
    buffer_load_dwordx4 v[196:199], v2, s[36:39], s58 offen offset:0 sc1
    buffer_load_dwordx4 v[200:203], v2, s[36:39], s58 offen offset:1024 sc1
    buffer_load_dwordx2 v[204:205], v5, s[36:39], s58 offen offset:0 sc1
    buffer_load_dwordx4 v[206:209], v2, s[36:39], s59 offen offset:0 sc1
    buffer_load_dwordx4 v[210:213], v2, s[36:39], s59 offen offset:1024 sc1
    buffer_load_dwordx2 v[214:215], v5, s[36:39], s59 offen offset:0 sc1
    s_add_u32 s63, s69, 180224
    buffer_load_dwordx4 v[136:139], v1, s[40:43], s63 offen nt
    s_add_u32 s63, s69, 188416
    buffer_load_dwordx4 v[140:143], v1, s[40:43], s63 offen nt
    s_add_u32 s63, s69, 262144
    buffer_load_dwordx4 v[48:51], v1, s[40:43], s63 offen nt
    s_add_u32 s63, s69, 270336
    buffer_load_dwordx4 v[52:55], v1, s[40:43], s63 offen nt
    s_waitcnt vmcnt(12)
    s_barrier
    ds_read_b64_tr_b16 v[160:161], v20 offset:0
    ds_read_b64_tr_b16 v[162:163], v20 offset:512
    ds_read_b64_tr_b16 v[164:165], v20 offset:8192
    ds_read_b64_tr_b16 v[166:167], v20 offset:8704
    ds_read_b64_tr_b16 v[168:169], v20 offset:16384
    ds_read_b64_tr_b16 v[170:171], v20 offset:16896
    ds_read_b64_tr_b16 v[172:173], v20 offset:24576
    ds_read_b64_tr_b16 v[174:175], v20 offset:25088
    ds_read_b64_tr_b16 v[176:177], v21 offset:0
    ds_read_b64_tr_b16 v[178:179], v21 offset:512
    ds_read_b64_tr_b16 v[180:181], v21 offset:8192
    ds_read_b64_tr_b16 v[182:183], v21 offset:8704
    ds_read_b64_tr_b16 v[184:185], v21 offset:16384
    ds_read_b64_tr_b16 v[186:187], v21 offset:16896
    ds_read_b64_tr_b16 v[188:189], v21 offset:24576
    ds_read_b64_tr_b16 v[190:191], v21 offset:25088
    ds_read_b64_tr_b16 v[192:193], v21 offset:32768
    ds_read_b64_tr_b16 v[194:195], v21 offset:33280
    s_waitcnt vmcnt(4)
    s_branch .gpc_2
.gp_1:
    buffer_load_dwordx4 v[196:199], v2, s[36:39], s58 offen offset:0 sc1
    buffer_load_dwordx4 v[200:203], v2, s[36:39], s58 offen offset:1024 sc1
    buffer_load_dwordx2 v[204:205], v5, s[36:39], s58 offen offset:0 sc1
    buffer_load_dwordx4 v[206:209], v2, s[36:39], s59 offen offset:0 sc1
    buffer_load_dwordx4 v[210:213], v2, s[36:39], s59 offen offset:1024 sc1
    buffer_load_dwordx2 v[214:215], v5, s[36:39], s59 offen offset:0 sc1
    s_waitcnt vmcnt(0)
.gpc_2:
    v_min_u32 v10, v197, v199
    v_max_u32 v11, v197, v199
    v_min3_u32 v10, v10, v201, v203
    v_max3_u32 v11, v11, v201, v203
    v_min3_u32 v10, v10, v205, v207
    v_max3_u32 v11, v11, v205, v207
    v_min3_u32 v10, v10, v209, v211
    v_max3_u32 v11, v11, v209, v211
    v_min3_u32 v10, v10, v213, v215
    v_max3_u32 v11, v11, v213, v215
    v_cmp_eq_u32 vcc, s34, v10
    v_cmp_eq_u32 s[56:57], s34, v11
    s_and_b64 vcc, vcc, s[56:57]
    s_cmp_eq_u64 vcc, -1
    s_nop 2
    s_cbranch_scc1 .gpd_3
    s_sub_u32 s35, s35, 1
    s_cbranch_scc1 .Lexit
    s_branch .gp_1
.gpd_3:
    v_and_b32 v207, 0xffff0000, v206
    v_lshlrev_b32 v206, 16, v206
    v_and_b32 v209, 0xffff0000, v208
    v_lshlrev_b32 v208, 16, v208
    v_and_b32 v211, 0xffff0000, v210
    v_lshlrev_b32 v210, 16, v210
    v_and_b32 v213, 0xffff0000, v212
    v_lshlrev_b32 v212, 16, v212
    v_and_b32 v215, 0xffff0000, v214
    v_lshlrev_b32 v214, 16, v214
    v_and_b32 v197, 0xffff0000, v196
    v_lshlrev_b32 v196, 16, v196
    v_and_b32 v199, 0xffff0000, v198
    v_lshlrev_b32 v198, 16, v198
    v_and_b32 v201, 0xffff0000, v200
    v_lshlrev_b32 v200, 16, v200
    v_and_b32 v203, 0xffff0000, v202
    v_lshlrev_b32 v202, 16, v202
    v_and_b32 v205, 0xffff0000, v204
    v_lshlrev_b32 v204, 16, v204
    v_pk_mul_f32 v[236:237], v[236:237], v[206:207]
    v_pk_mul_f32 v[238:239], v[238:239], v[208:209]
    v_pk_mul_f32 v[240:241], v[240:241], v[210:211]
    v_pk_mul_f32 v[242:243], v[242:243], v[212:213]
    v_pk_mul_f32 v[244:245], v[244:245], v[214:215]
    v_cvt_pk_bf16_f32 v236, v236, v237
    v_and_b32 v237, 0xffff0000, v236
    v_lshlrev_b32 v236, 16, v236
    v_cvt_pk_bf16_f32 v238, v238, v239
    v_and_b32 v239, 0xffff0000, v238
    v_lshlrev_b32 v238, 16, v238
    v_cvt_pk_bf16_f32 v240, v240, v241
    v_and_b32 v241, 0xffff0000, v240
    v_lshlrev_b32 v240, 16, v240
    v_cvt_pk_bf16_f32 v242, v242, v243
    v_and_b32 v243, 0xffff0000, v242
    v_lshlrev_b32 v242, 16, v242
    v_cvt_pk_bf16_f32 v244, v244, v245
    v_and_b32 v245, 0xffff0000, v244
    v_lshlrev_b32 v244, 16, v244
    v_pk_add_f32 v[236:237], v[236:237], v[196:197]
    v_pk_add_f32 v[238:239], v[238:239], v[198:199]
    v_pk_add_f32 v[240:241], v[240:241], v[200:201]
    v_pk_add_f32 v[242:243], v[242:243], v[202:203]
    v_pk_add_f32 v[244:245], v[244:245], v[204:205]
    v_cvt_pk_bf16_f32 v246, v236, v237
    v_cvt_pk_bf16_f32 v247, v238, v239
    v_cvt_pk_bf16_f32 v248, v240, v241
    v_cvt_pk_bf16_f32 v249, v242, v243
    v_cvt_pk_bf16_f32 v250, v244, v245
    ds_write_b64 v17, v[246:247] offset:0
    ds_write_b64 v17, v[248:249] offset:512
    ds_write_b32 v18, v250 offset:0
    s_waitcnt lgkmcnt(0)
    s_barrier
    ds_read_b128 v[196:199], v16 offset:0
    ds_read_b128 v[200:203], v16 offset:128
    ds_read_b128 v[204:207], v16 offset:256
    ds_read_b128 v[208:211], v16 offset:384
    ds_read_b128 v[212:215], v16 offset:512
    ds_read_b128 v[216:219], v16 offset:640
    ds_read_b128 v[220:223], v16 offset:768
    ds_read_b128 v[224:227], v16 offset:896
    ds_read_b128 v[228:231], v16 offset:1024
    s_waitcnt lgkmcnt(8)
    v_mfma_f32_16x16x32_bf16 v[232:235], v[160:163], v[196:199], 0
    s_waitcnt lgkmcnt(7)
    v_mfma_f32_16x16x32_bf16 v[232:235], v[164:167], v[200:203], v[232:235]
    s_waitcnt lgkmcnt(6)
    v_mfma_f32_16x16x32_bf16 v[232:235], v[168:171], v[204:207], v[232:235]
    s_waitcnt lgkmcnt(5)
    v_mfma_f32_16x16x32_bf16 v[232:235], v[172:175], v[208:211], v[232:235]
    s_waitcnt lgkmcnt(4)
    v_mfma_f32_16x16x32_bf16 v[232:235], v[176:179], v[212:215], v[232:235]
    s_waitcnt lgkmcnt(3)
    v_mfma_f32_16x16x32_bf16 v[232:235], v[180:183], v[216:219], v[232:235]
    s_waitcnt lgkmcnt(2)
    v_mfma_f32_16x16x32_bf16 v[232:235], v[184:187], v[220:223], v[232:235]
    s_waitcnt lgkmcnt(1)
    v_mfma_f32_16x16x32_bf16 v[232:235], v[188:191], v[224:227], v[232:235]
    s_waitcnt lgkmcnt(0)
    v_mfma_f32_16x16x32_bf16 v[232:235], v[192:195], v[228:231], v[232:235]
    s_nop 7
    v_permlane32_swap_b32 v232, v234
    v_permlane32_swap_b32 v233, v235
    v_cndmask_b32 v233, v233, v234, s[96:97]
    v_cndmask_b32 v232, v232, v235, s[96:97]
    s_nop 1
    v_add_f32_dpp v236, v233, v232 quad_perm:[1,0,3,2] row_mask:0xf bank_mask:0xf
    v_cvt_pk_bf16_f32 v236, v236, v236
    ds_write_b16 v23, v236
    v_mov_b32 v243, s34
    s_waitcnt lgkmcnt(0)
    s_barrier
    ds_read2_b32 v[244:245], v24 offset1:1
    v_mov_b32 v241, s34
    s_waitcnt lgkmcnt(0)
    v_mov_b32 v240, v244
    v_mov_b32 v242, v245
    s_mov_b64 exec, 0xffff
    buffer_store_dwordx4 v[240:243], v2, s[36:39], s101 offen sc1
    s_mov_b64 exec, -1
    s_waitcnt vmcnt(3)
    s_bitcmp1_b64 s[14:15], 18
    s_cbranch_scc0 1
    s_waitcnt vmcnt(2)
    s_add_u32 s63, s69, 278528
    buffer_load_dwordx4 v[80:83], v1, s[40:43], s63 offen nt
    v_and_b32 v157, 7, v0
    v_lshlrev_b32 v157, 2, v157
    s_mov_b32 s63, 0x4a1000
    buffer_load_dword v156, v157, s[36:39], s63 offen
    s_waitcnt vmcnt(4)
    s_bitcmp1_b64 s[14:15], 19
    s_cbranch_scc0 1
    s_waitcnt vmcnt(3)
    s_add_u32 s63, s69, 286720
    buffer_load_dwordx4 v[84:87], v1, s[40:43], s63 offen nt
    s_waitcnt vmcnt(4)
    s_bitcmp1_b64 s[14:15], 20
    s_cbranch_scc0 1
    s_waitcnt vmcnt(3)
    s_add_u32 s63, s69, 294912
    buffer_load_dwordx4 v[112:115], v1, s[40:43], s63 offen nt
    s_waitcnt vmcnt(4)
    s_bitcmp1_b64 s[14:15], 21
    s_cbranch_scc0 1
    s_waitcnt vmcnt(3)
    s_add_u32 s63, s69, 303104
    buffer_load_dwordx4 v[116:119], v1, s[40:43], s63 offen nt
    s_waitcnt vmcnt(4)
    s_bitcmp1_b64 s[14:15], 22
    s_cbranch_scc0 1
    s_waitcnt vmcnt(2)
    s_add_u32 s63, s69, 311296
    buffer_load_dwordx4 v[144:147], v1, s[40:43], s63 offen nt
    s_waitcnt vmcnt(4)
    s_sub_u32 s63, s70, 300
    v_subrev_u32 v156, s63, v156
    v_mov_b32 v157, 600
    v_cmp_lt_u32 s[8:9], v156, v157
    v_add_u32_dpp v156, v156, v156 quad_perm:[1,0,3,2] row_mask:0xf bank_mask:0xf
    s_nop 1
    v_add_u32_dpp v156, v156, v156 quad_perm:[2,3,0,1] row_mask:0xf bank_mask:0xf
    s_nop 1
    v_add_u32_dpp v156, v156, v156 row_ror:4 row_mask:0xf bank_mask:0xf
    s_nop 0
    v_readfirstlane_b32 s63, v156
    s_cmp_eq_u64 s[8:9], -1
    s_nop 3
    s_cbranch_scc0 .et_4
    s_lshr_b32 s63, s63, 3
    s_sub_u32 s63, s63, 300
    s_add_u32 s30, s30, s63
    s_add_u32 s31, s31, s63
.et_4:
    s_waitcnt vmcnt(3)
    s_bitcmp1_b64 s[14:15], 23
    s_cbranch_scc0 1
    s_waitcnt vmcnt(2)
    s_add_u32 s63, s69, 319488
    buffer_load_dwordx4 v[148:151], v1, s[40:43], s63 offen nt
    s_waitcnt vmcnt(3)
    s_bitcmp1_b64 s[14:15], 24
    s_cbranch_scc0 1
    s_waitcnt vmcnt(2)
    s_add_u32 s63, s69, 393216
    buffer_load_dwordx4 v[56:59], v1, s[40:43], s63 offen nt
    s_waitcnt vmcnt(3)
    s_bitcmp1_b64 s[14:15], 25
    s_cbranch_scc0 1
    s_waitcnt vmcnt(2)
    s_add_u32 s63, s69, 401408
    buffer_load_dwordx4 v[60:63], v1, s[40:43], s63 offen nt
    s_branch .Ln_att
.La_early:
    s_mov_b32 s14, 0x6ddb76dd
    s_mov_b32 s15, 0xdb76ddb7
    s_add_u32 s30, s70, -60
    s_mov_b32 s31, s70
    s_cmp_ge_u32 s65, 11
    s_cselect_b32 s99, 1, 0
    s_mul_i32 s57, s99, 3
    s_sub_u32 s100, s65, s57
    s_sub_u32 s100, s100, 8
    s_lshl1_add_u32 s99, s64, s99
    s_mov_b32 s48, s12
    s_and_b32 s49, s13, 0xffff
    s_mov_b32 s50, 0x480000
    s_mov_b32 s51, 0x00020000
    v_bfe_u32 v12, v0, 4, 1
    s_and_b32 s56, s3, 1
    s_lshl_b32 s56, s56, 2
    v_lshl_or_b32 v12, v12, 1, s56
    v_and_b32 v13, 7, v0
    v_xor_b32 v12, v12, v13
    v_lshrrev_b32 v13, 3, v0
    v_mul_u32_u24 v13, 1152, v13
    v_lshl_add_u32 v6, v12, 4, v13
    s_mul_i32 s101, s99, 294912
    s_mul_i32 s56, s100, 384
    s_add_u32 s101, s101, s56
    s_mul_i32 s56, s3, 9216
    s_add_u32 s101, s101, s56
    s_lshl_b32 s57, s3, 10
    s_waitcnt vmcnt(3)
    s_add_u32 m0, s57, 0
    s_add_u32 s56, s101, 0
    buffer_load_dwordx4 v6, s[48:51], s56 offen nt lds
    s_waitcnt vmcnt(3)
    s_add_u32 m0, s57, 32768
    s_add_u32 s56, s101, 128
    buffer_load_dwordx4 v6, s[48:51], s56 offen nt lds
    s_waitcnt vmcnt(3)
    s_bitcmp1_b64 s[14:15], 4
    s_cbranch_scc0 1
    s_waitcnt vmcnt(2)
    s_add_u32 s63, s69, 32768
    buffer_load_dwordx4 v[96:99], v1, s[40:43], s63 offen nt
    s_waitcnt vmcnt(3)
    s_bitcmp1_b64 s[14:15], 5
    s_cbranch_scc0 1
    s_waitcnt vmcnt(2)
    s_add_u32 s63, s69, 40960
    buffer_load_dwordx4 v[100:103], v1, s[40:43], s63 offen nt
    s_waitcnt vmcnt(3)
    s_add_u32 m0, s57, 65536
    s_add_u32 s56, s101, 256
    buffer_load_dwordx4 v6, s[48:51], s56 offen nt lds
    s_waitcnt vmcnt(3)
    s_bitcmp1_b64 s[14:15], 6
    s_cbranch_scc0 1
    s_waitcnt vmcnt(2)
    s_add_u32 s63, s69, 49152
    buffer_load_dwordx4 v[128:131], v1, s[40:43], s63 offen nt
    s_waitcnt vmcnt(3)
    s_bitcmp1_b64 s[14:15], 7
    s_cbranch_scc0 1
    s_waitcnt vmcnt(2)
    s_add_u32 s63, s69, 57344
    buffer_load_dwordx4 v[132:135], v1, s[40:43], s63 offen nt
    s_waitcnt vmcnt(3)
    s_add_u32 m0, s57, 8192
    s_add_u32 s56, s101, 73728
    buffer_load_dwordx4 v6, s[48:51], s56 offen nt lds
    s_waitcnt vmcnt(3)
    s_bitcmp1_b64 s[14:15], 8
    s_cbranch_scc0 1
    s_waitcnt vmcnt(2)
    s_add_u32 s63, s69, 131072
    buffer_load_dwordx4 v[40:43], v1, s[40:43], s63 offen nt
    s_waitcnt vmcnt(3)
    s_bitcmp1_b64 s[14:15], 9
    s_cbranch_scc0 1
    s_waitcnt vmcnt(2)
    s_add_u32 s63, s69, 139264
    buffer_load_dwordx4 v[44:47], v1, s[40:43], s63 offen nt
    s_waitcnt vmcnt(3)
    s_add_u32 m0, s57, 40960
    s_add_u32 s56, s101, 73856
    buffer_load_dwordx4 v6, s[48:51], s56 offen nt lds
    s_waitcnt vmcnt(3)
    s_bitcmp1_b64 s[14:15], 10
    s_cbranch_scc0 1
    s_waitcnt vmcnt(2)
    s_add_u32 s63, s69, 147456
    buffer_load_dwordx4 v[72:75], v1, s[40:43], s63 offen nt
    s_waitcnt vmcnt(3)
    s_bitcmp1_b64 s[14:15], 11
    s_cbranch_scc0 1
    s_waitcnt vmcnt(2)
    s_add_u32 s63, s69, 155648
    buffer_load_dwordx4 v[76:79], v1, s[40:43], s63 offen nt
    s_waitcnt vmcnt(3)
    s_add_u32 m0, s57, 73728
    s_add_u32 s56, s101, 73984
    buffer_load_dwordx4 v6, s[48:51], s56 offen nt lds
    s_waitcnt vmcnt(3)
    s_waitcnt lgkmcnt(0)
    s_add_u32 s34, s34, 1
    s_getreg_b32 s1, hwreg(HW_REG_XCC_ID)
    s_lshl_b32 s1, s1, 24
    s_add_u32 s1, s1, s34
    s_lshr_b32 s0, s2, 3
    s_lshl3_add_u32 s63, s64, s3
    s_lshl_b32 s63, s63, 5
    s_add_u32 s0, s0, s63
    s_lshl2_add_u32 s0, s0, 0x480000
    v_mov_b32 v30, s1
    s_mov_b64 exec, 1
    buffer_store_dword v30, v2, s[36:39], s0 offen sc1
    s_mov_b64 exec, -1
    s_bitcmp1_b64 s[14:15], 12
    s_cbranch_scc0 1
    s_waitcnt vmcnt(3)
    s_add_u32 s63, s69, 163840
    buffer_load_dwordx4 v[104:107], v1, s[40:43], s63 offen nt
    s_waitcnt vmcnt(4)
    s_bitcmp1_b64 s[14:15], 13
    s_cbranch_scc0 1
    s_waitcnt vmcnt(3)
    s_add_u32 s63, s69, 172032
    buffer_load_dwordx4 v[108:111], v1, s[40:43], s63 offen nt
    s_waitcnt vmcnt(4)
    s_add_u32 m0, s57, 16384
    s_add_u32 s56, s101, 147456
    buffer_load_dwordx4 v6, s[48:51], s56 offen nt lds
    s_waitcnt vmcnt(4)
    s_bitcmp1_b64 s[14:15], 14
    s_cbranch_scc0 1
    s_waitcnt vmcnt(2)
    s_add_u32 s63, s69, 180224
    buffer_load_dwordx4 v[136:139], v1, s[40:43], s63 offen nt
    s_waitcnt vmcnt(3)
    s_bitcmp1_b64 s[14:15], 15
    s_cbranch_scc0 1
    s_waitcnt vmcnt(2)
    s_add_u32 s63, s69, 188416
    buffer_load_dwordx4 v[140:143], v1, s[40:43], s63 offen nt
    s_waitcnt vmcnt(3)
    s_add_u32 m0, s57, 49152
    s_add_u32 s56, s101, 147584
    buffer_load_dwordx4 v6, s[48:51], s56 offen nt lds
    s_waitcnt vmcnt(3)
    s_bitcmp1_b64 s[14:15], 16
    s_cbranch_scc0 1
    s_waitcnt vmcnt(2)
    s_add_u32 s63, s69, 262144
    buffer_load_dwordx4 v[48:51], v1, s[40:43], s63 offen nt
    s_waitcnt vmcnt(3)
    s_bitcmp1_b64 s[14:15], 17
    s_cbranch_scc0 1
    s_waitcnt vmcnt(2)
    s_add_u32 s63, s69, 270336
    buffer_load_dwordx4 v[52:55], v1, s[40:43], s63 offen nt
    s_waitcnt vmcnt(3)
    s_add_u32 m0, s57, 81920
    s_add_u32 s56, s101, 147712
    buffer_load_dwordx4 v6, s[48:51], s56 offen nt lds
    s_waitcnt vmcnt(3)
    s_bitcmp1_b64 s[14:15], 18
    s_cbranch_scc0 1
    s_waitcnt vmcnt(2)
    s_add_u32 s63, s69, 278528
    buffer_load_dwordx4 v[80:83], v1, s[40:43], s63 offen nt
    v_and_b32 v157, 7, v0
    v_lshlrev_b32 v157, 2, v157
    s_mov_b32 s63, 0x4a1000
    buffer_load_dword v156, v157, s[36:39], s63 offen
    s_waitcnt vmcnt(4)
    s_bitcmp1_b64 s[14:15], 19
    s_cbranch_scc0 1
    s_waitcnt vmcnt(3)
    s_add_u32 s63, s69, 286720
    buffer_load_dwordx4 v[84:87], v1, s[40:43], s63 offen nt
    s_waitcnt vmcnt(4)
    s_add_u32 m0, s57, 24576
    s_add_u32 s56, s101, 221184
    buffer_load_dwordx4 v6, s[48:51], s56 offen nt lds
    s_waitcnt vmcnt(4)
    s_bitcmp1_b64 s[14:15], 20
    s_cbranch_scc0 1
    s_waitcnt vmcnt(3)
    s_add_u32 s63, s69, 294912
    buffer_load_dwordx4 v[112:115], v1, s[40:43], s63 offen nt
    s_waitcnt vmcnt(4)
    s_bitcmp1_b64 s[14:15], 21
    s_cbranch_scc0 1
    s_waitcnt vmcnt(2)
    s_add_u32 s63, s69, 303104
    buffer_load_dwordx4 v[116:119], v1, s[40:43], s63 offen nt
    s_waitcnt vmcnt(3)
    s_add_u32 m0, s57, 57344
    s_add_u32 s56, s101, 221312
    buffer_load_dwordx4 v6, s[48:51], s56 offen nt lds
    s_waitcnt vmcnt(3)
    s_bitcmp1_b64 s[14:15], 22
    s_cbranch_scc0 1
    s_waitcnt vmcnt(2)
    s_add_u32 s63, s69, 311296
    buffer_load_dwordx4 v[144:147], v1, s[40:43], s63 offen nt
    s_sub_u32 s63, s70, 300
    v_subrev_u32 v156, s63, v156
    v_mov_b32 v157, 600
    v_cmp_lt_u32 s[8:9], v156, v157
    v_add_u32_dpp v156, v156, v156 quad_perm:[1,0,3,2] row_mask:0xf bank_mask:0xf
    s_nop 1
    v_add_u32_dpp v156, v156, v156 quad_perm:[2,3,0,1] row_mask:0xf bank_mask:0xf
    s_nop 1
    v_add_u32_dpp v156, v156, v156 row_ror:4 row_mask:0xf bank_mask:0xf
    s_nop 0
    v_readfirstlane_b32 s63, v156
    s_cmp_eq_u64 s[8:9], -1
    s_nop 3
    s_cbranch_scc0 .et_5
    s_lshr_b32 s63, s63, 3
    s_sub_u32 s63, s63, 300
    s_add_u32 s30, s30, s63
    s_add_u32 s31, s31, s63
.et_5:
    s_waitcnt vmcnt(3)
    s_bitcmp1_b64 s[14:15], 23
    s_cbranch_scc0 1
    s_waitcnt vmcnt(2)
    s_add_u32 s63, s69, 319488
    buffer_load_dwordx4 v[148:151], v1, s[40:43], s63 offen nt
    s_waitcnt vmcnt(3)
    s_add_u32 m0, s57, 90112
    s_add_u32 s56, s101, 221440
    buffer_load_dwordx4 v6, s[48:51], s56 offen nt lds
    s_waitcnt vmcnt(3)
    s_bitcmp1_b64 s[14:15], 24
    s_cbranch_scc0 1
    s_waitcnt vmcnt(2)
    s_add_u32 s63, s69, 393216
    buffer_load_dwordx4 v[56:59], v1, s[40:43], s63 offen nt
    s_waitcnt vmcnt(3)
    s_bitcmp1_b64 s[14:15], 25
    s_cbranch_scc0 1
    s_waitcnt vmcnt(2)
    s_add_u32 s63, s69, 401408
    buffer_load_dwordx4 v[60:63], v1, s[40:43], s63 offen nt
.Ln_att:
    v_and_b32 v8, 1, v0
    v_lshlrev_b32 v8, 8, v8
    v_and_b32 v9, 0x3c, v0
    v_lshl_add_u32 v9, v9, 2, v8
    v_lshlrev_b32 v7, 1, v9
    v_and_b32 v9, 0x3c, v0
    v_lshrrev_b32 v8, 4, v8
    v_lshl_add_u32 v9, v9, 3, v8
    s_lshl_b32 s58, s66, 14
    s_lshl_b32 s59, s67, 10
    s_add_u32 s58, s58, s59
    s_add_u32 s58, s58, 0x70000
    s_lshl4_add_u32 s59, s66, s67
    s_lshl_b32 s59, s59, 11
    s_add_u32 s59, s59, 0x430000
    s_memrealtime s[8:9]
    s_waitcnt vmcnt(8)
    s_waitcnt lgkmcnt(0)
    s_sub_u32 s8, s8, s30
    s_cmpk_ge_u32 s8, 1238
    s_cbranch_scc1 .ap_6
    s_waitcnt vmcnt(5)
    s_cmpk_ge_u32 s8, 1138
    s_cbranch_scc1 .ap_6
    s_waitcnt vmcnt(3)
    s_bitcmp1_b64 s[14:15], 26
    s_cbranch_scc0 1
    s_waitcnt vmcnt(2)
    s_cmpk_ge_u32 s8, 1018
    s_cbranch_scc1 .ap_6
    s_waitcnt vmcnt(1)
.ap_6:
    s_add_u32 s63, s69, 409600
    buffer_load_dwordx4 v[88:91], v1, s[40:43], s63 offen nt
    s_memrealtime s[8:9]
    s_waitcnt vmcnt(8)
    s_waitcnt lgkmcnt(0)
    s_sub_u32 s8, s8, s30
    s_cmpk_ge_u32 s8, 1266
    s_cbranch_scc1 .ap_7
    s_waitcnt vmcnt(5)
    s_cmpk_ge_u32 s8, 1166
    s_cbranch_scc1 .ap_7
    s_waitcnt vmcnt(3)
    s_bitcmp1_b64 s[14:15], 27
    s_cbranch_scc0 1
    s_waitcnt vmcnt(2)
    s_cmpk_ge_u32 s8, 1046
    s_cbranch_scc1 .ap_7
    s_waitcnt vmcnt(1)
.ap_7:
    s_add_u32 s63, s69, 417792
    buffer_load_dwordx4 v[92:95], v1, s[40:43], s63 offen nt
    s_memrealtime s[8:9]
    s_waitcnt vmcnt(8)
    s_waitcnt lgkmcnt(0)
    s_sub_u32 s8, s8, s30
    s_cmpk_ge_u32 s8, 1294
    s_cbranch_scc1 .ap_8
    s_waitcnt vmcnt(5)
    s_cmpk_ge_u32 s8, 1194
    s_cbranch_scc1 .ap_8
    s_waitcnt vmcnt(3)
    s_bitcmp1_b64 s[14:15], 28
    s_cbranch_scc0 1
    s_waitcnt vmcnt(2)
    s_cmpk_ge_u32 s8, 1074
    s_cbranch_scc1 .ap_8
    s_waitcnt vmcnt(1)
.ap_8:
    s_add_u32 s63, s69, 425984
    buffer_load_dwordx4 v[120:123], v1, s[40:43], s63 offen nt
    s_memrealtime s[8:9]
    s_waitcnt vmcnt(8)
    s_waitcnt lgkmcnt(0)
    s_sub_u32 s8, s8, s30
    s_cmpk_ge_u32 s8, 1322
    s_cbranch_scc1 .ap_9
    s_waitcnt vmcnt(5)
    s_cmpk_ge_u32 s8, 1222
    s_cbranch_scc1 .ap_9
    s_waitcnt vmcnt(3)
    s_bitcmp1_b64 s[14:15], 29
    s_cbranch_scc0 1
    s_waitcnt vmcnt(2)
    s_cmpk_ge_u32 s8, 1102
    s_cbranch_scc1 .ap_9
    s_waitcnt vmcnt(1)
.ap_9:
    s_add_u32 s63, s69, 434176
    buffer_load_dwordx4 v[124:127], v1, s[40:43], s63 offen nt
    s_memrealtime s[8:9]
    s_waitcnt vmcnt(8)
    s_waitcnt lgkmcnt(0)
    s_sub_u32 s8, s8, s30
    s_cmpk_ge_u32 s8, 1350
    s_cbranch_scc1 .ap_10
    s_waitcnt vmcnt(5)
    s_cmpk_ge_u32 s8, 1250
    s_cbranch_scc1 .ap_10
    s_waitcnt vmcnt(3)
    s_bitcmp1_b64 s[14:15], 30
    s_cbranch_scc0 1
    s_waitcnt vmcnt(2)
    s_cmpk_ge_u32 s8, 1130
    s_cbranch_scc1 .ap_10
    s_waitcnt vmcnt(1)
.ap_10:
    s_add_u32 s63, s69, 442368
    buffer_load_dwordx4 v[152:155], v1, s[40:43], s63 offen nt
    s_memrealtime s[8:9]
    s_waitcnt vmcnt(8)
    s_waitcnt lgkmcnt(0)
    s_sub_u32 s8, s8, s30
    s_cmpk_ge_u32 s8, 1378
    s_cbranch_scc1 .ap_11
    s_waitcnt vmcnt(5)
    s_cmpk_ge_u32 s8, 1278
    s_cbranch_scc1 .ap_11
    s_waitcnt vmcnt(3)
    s_bitcmp1_b64 s[14:15], 31
    s_cbranch_scc0 1
    s_waitcnt vmcnt(2)
    s_cmpk_ge_u32 s8, 1158
    s_cbranch_scc1 .ap_11
    s_waitcnt vmcnt(1)
.ap_11:
    s_add_u32 s63, s69, 450560
    buffer_load_dwordx4 v[156:159], v1, s[40:43], s63 offen nt
    buffer_load_dwordx4 v[16:19], v7, s[36:39], s58 offen offset:0 sc1
    buffer_load_dwordx4 v[20:23], v7, s[36:39], s58 offen offset:16 sc1
    s_memrealtime s[8:9]
    s_waitcnt vmcnt(8)
    s_waitcnt lgkmcnt(0)
    s_sub_u32 s8, s8, s30
    s_cmpk_ge_u32 s8, 1406
    s_cbranch_scc1 .ap_12
    s_waitcnt vmcnt(5)
    s_cmpk_ge_u32 s8, 1306
    s_cbranch_scc1 .ap_12
    s_waitcnt vmcnt(3)
    s_bitcmp1_b64 s[14:15], 32
    s_cbranch_scc0 1
    s_waitcnt vmcnt(2)
    s_cmpk_ge_u32 s8, 1186
    s_cbranch_scc1 .ap_12
    s_waitcnt vmcnt(1)
.ap_12:
    v_bfe_u32 v1, v0, 4, 2
    v_and_b32 v10, 0xf0, v2
    v_lshlrev_b32 v1, 2, v1
    v_bfe_u32 v1, s6, v1, 4
    v_lshl_add_u32 v1, v1, 8, v10
    s_add_u32 s63, s69, 0
    buffer_load_dwordx4 v[160:163], v1, s[44:47], s63 offen nt
    s_memrealtime s[8:9]
    s_waitcnt vmcnt(8)
    s_waitcnt lgkmcnt(0)
    s_sub_u32 s8, s8, s30
    s_cmpk_ge_u32 s8, 1434
    s_cbranch_scc1 .ap_13
    s_waitcnt vmcnt(5)
    s_cmpk_ge_u32 s8, 1334
    s_cbranch_scc1 .ap_13
    s_waitcnt vmcnt(3)
    s_bitcmp1_b64 s[14:15], 33
    s_cbranch_scc0 1
    s_waitcnt vmcnt(2)
    s_cmpk_ge_u32 s8, 1214
    s_cbranch_scc1 .ap_13
    s_waitcnt vmcnt(1)
.ap_13:
    s_add_u32 s63, s69, 8192
    buffer_load_dwordx4 v[164:167], v1, s[44:47], s63 offen nt
    s_memrealtime s[8:9]
    s_waitcnt vmcnt(8)
    s_waitcnt lgkmcnt(0)
    s_sub_u32 s8, s8, s30
    s_cmpk_ge_u32 s8, 1462
    s_cbranch_scc1 .ap_14
    s_waitcnt vmcnt(5)
    s_cmpk_ge_u32 s8, 1362
    s_cbranch_scc1 .ap_14
    s_waitcnt vmcnt(3)
    s_bitcmp1_b64 s[14:15], 34
    s_cbranch_scc0 1
    s_waitcnt vmcnt(2)
    s_cmpk_ge_u32 s8, 1242
    s_cbranch_scc1 .ap_14
    s_waitcnt vmcnt(1)
.ap_14:
    s_add_u32 s63, s69, 16384
    buffer_load_dwordx4 v[168:171], v1, s[44:47], s63 offen nt
    s_waitcnt vmcnt(3)
    s_branch .gpc_16
.gp_15:
    buffer_load_dwordx4 v[16:19], v7, s[36:39], s58 offen offset:0 sc1
    buffer_load_dwordx4 v[20:23], v7, s[36:39], s58 offen offset:16 sc1
    s_waitcnt vmcnt(0)
.gpc_16:
    v_min_u32 v10, v17, v19
    v_max_u32 v11, v17, v19
    v_min3_u32 v10, v10, v21, v23
    v_max3_u32 v11, v11, v21, v23
    v_cmp_eq_u32 vcc, s34, v10
    v_cmp_eq_u32 s[56:57], s34, v11
    s_and_b64 vcc, vcc, s[56:57]
    s_cmp_eq_u64 vcc, -1
    s_nop 2
    s_cbranch_scc1 .gpd_17
    s_sub_u32 s35, s35, 1
    s_cbranch_scc1 .Lexit
    s_sleep 1
    s_branch .gp_15
.gpd_17:
    s_mov_b32 vcc_lo, 0xcccccccc
    s_mov_b32 vcc_hi, 0xcccccccc
    v_cndmask_b32_e64 v24, v16, 0, vcc
    v_cndmask_b32_e64 v25, v18, 0, vcc
    v_cndmask_b32_e64 v26, v20, 0, vcc
    v_cndmask_b32_e64 v27, v22, 0, vcc
    v_cndmask_b32_e32 v28, 0, v16, vcc
    v_cndmask_b32_e32 v29, 0, v18, vcc
    v_cndmask_b32_e32 v30, 0, v20, vcc
    v_cndmask_b32_e32 v31, 0, v22, vcc
    v_mfma_f32_16x16x32_bf16 v[16:19], v[32:35], v[24:27], 0
    v_mfma_f32_16x16x32_bf16 v[32:35], v[40:43], v[24:27], 0
    v_mfma_f32_16x16x32_bf16 v[16:19], v[36:39], v[28:31], v[16:19]
    v_mfma_f32_16x16x32_bf16 v[40:43], v[48:51], v[24:27], 0
    v_mfma_f32_16x16x32_bf16 v[32:35], v[44:47], v[28:31], v[32:35]
    v_mfma_f32_16x16x32_bf16 v[48:51], v[56:59], v[24:27], 0
    v_mfma_f32_16x16x32_bf16 v[40:43], v[52:55], v[28:31], v[40:43]
    v_mfma_f32_16x16x32_bf16 v[56:59], v[64:67], v[24:27], 0
    v_mfma_f32_16x16x32_bf16 v[48:51], v[60:63], v[28:31], v[48:51]
    s_nop 1
    v_add_f32_dpp v10, v17, v16 row_ror:12 row_mask:0xf bank_mask:0x1
    s_memrealtime s[8:9]
    s_waitcnt lgkmcnt(0)
    s_sub_u32 s8, s8, s30
    s_cmpk_ge_u32 s8, 1490
    s_nop 0
    s_cbranch_scc1 .ap_18
    s_waitcnt vmcnt(3)
    s_cmpk_ge_u32 s8, 1390
    s_cbranch_scc1 .ap_18
    s_waitcnt vmcnt(3)
    s_bitcmp1_b64 s[14:15], 35
    s_cbranch_scc0 1
    s_waitcnt vmcnt(2)
    s_cmpk_ge_u32 s8, 1270
    s_cbranch_scc1 .ap_18
    s_waitcnt vmcnt(1)
.ap_18:
    s_add_u32 s63, s69, 24576
    buffer_load_dwordx4 v[172:175], v1, s[44:47], s63 offen nt
    v_mfma_f32_16x16x32_bf16 v[64:67], v[72:75], v[24:27], 0
    v_mfma_f32_16x16x32_bf16 v[56:59], v[68:71], v[28:31], v[56:59]
    v_add_f32_dpp v11, v33, v32 row_ror:12 row_mask:0xf bank_mask:0x1
    v_add_f32_dpp v10, v18, v10 row_ror:8 row_mask:0xf bank_mask:0x1
    v_mfma_f32_16x16x32_bf16 v[72:75], v[80:83], v[24:27], 0
    v_mfma_f32_16x16x32_bf16 v[64:67], v[76:79], v[28:31], v[64:67]
    v_add_f32_dpp v12, v41, v40 row_ror:12 row_mask:0xf bank_mask:0x1
    v_add_f32_dpp v11, v34, v11 row_ror:8 row_mask:0xf bank_mask:0x1
    v_add_f32_dpp v10, v19, v10 row_ror:4 row_mask:0xf bank_mask:0x1
    v_mfma_f32_16x16x32_bf16 v[80:83], v[88:91], v[24:27], 0
    v_mfma_f32_16x16x32_bf16 v[72:75], v[84:87], v[28:31], v[72:75]
    v_add_f32_dpp v13, v49, v48 row_ror:12 row_mask:0xf bank_mask:0x1
    v_add_f32_dpp v12, v42, v12 row_ror:8 row_mask:0xf bank_mask:0x1
    v_add_f32_dpp v11, v35, v11 row_ror:4 row_mask:0xf bank_mask:0x1
    v_mfma_f32_16x16x32_bf16 v[88:91], v[96:99], v[24:27], 0
    v_mfma_f32_16x16x32_bf16 v[80:83], v[92:95], v[28:31], v[80:83]
    v_add_f32_dpp v10, v58, v57 row_ror:12 row_mask:0xf bank_mask:0x2
    v_add_f32_dpp v13, v50, v13 row_ror:8 row_mask:0xf bank_mask:0x1
    v_add_f32_dpp v12, v43, v12 row_ror:4 row_mask:0xf bank_mask:0x1
    s_memrealtime s[8:9]
    s_waitcnt lgkmcnt(0)
    s_sub_u32 s8, s8, s30
    s_cmpk_ge_u32 s8, 1521
    s_nop 0
    s_cbranch_scc1 .ap_19
    s_waitcnt vmcnt(4)
    s_cmpk_ge_u32 s8, 1421
    s_cbranch_scc1 .ap_19
    s_waitcnt vmcnt(3)
    s_bitcmp1_b64 s[14:15], 36
    s_cbranch_scc0 1
    s_waitcnt vmcnt(2)
    s_cmpk_ge_u32 s8, 1301
    s_cbranch_scc1 .ap_19
    s_waitcnt vmcnt(1)
.ap_19:
    s_add_u32 s63, s69, 32768
    buffer_load_dwordx4 v[176:179], v1, s[44:47], s63 offen nt
    v_mfma_f32_16x16x32_bf16 v[96:99], v[104:107], v[24:27], 0
    v_mfma_f32_16x16x32_bf16 v[88:91], v[100:103], v[28:31], v[88:91]
    v_add_f32_dpp v11, v66, v65 row_ror:12 row_mask:0xf bank_mask:0x2
    v_add_f32_dpp v10, v59, v10 row_ror:8 row_mask:0xf bank_mask:0x2
    v_add_f32_dpp v13, v51, v13 row_ror:4 row_mask:0xf bank_mask:0x1
    v_mfma_f32_16x16x32_bf16 v[104:107], v[112:115], v[24:27], 0
    v_mfma_f32_16x16x32_bf16 v[96:99], v[108:111], v[28:31], v[96:99]
    v_add_f32_dpp v12, v74, v73 row_ror:12 row_mask:0xf bank_mask:0x2
    v_add_f32_dpp v11, v67, v11 row_ror:8 row_mask:0xf bank_mask:0x2
    v_add_f32_dpp v10, v56, v10 row_ror:4 row_mask:0xf bank_mask:0x2
    v_mfma_f32_16x16x32_bf16 v[112:115], v[120:123], v[24:27], 0
    v_mfma_f32_16x16x32_bf16 v[104:107], v[116:119], v[28:31], v[104:107]
    v_add_f32_dpp v13, v82, v81 row_ror:12 row_mask:0xf bank_mask:0x2
    v_add_f32_dpp v12, v75, v12 row_ror:8 row_mask:0xf bank_mask:0x2
    v_add_f32_dpp v11, v64, v11 row_ror:4 row_mask:0xf bank_mask:0x2
    v_mfma_f32_16x16x32_bf16 v[120:123], v[128:131], v[24:27], 0
    v_mfma_f32_16x16x32_bf16 v[112:115], v[124:127], v[28:31], v[112:115]
    v_add_f32_dpp v10, v91, v90 row_ror:12 row_mask:0xf bank_mask:0x4
    v_add_f32_dpp v13, v83, v13 row_ror:8 row_mask:0xf bank_mask:0x2
    v_add_f32_dpp v12, v72, v12 row_ror:4 row_mask:0xf bank_mask:0x2
    s_memrealtime s[8:9]
    s_waitcnt lgkmcnt(0)
    s_sub_u32 s8, s8, s30
    s_cmpk_ge_u32 s8, 1552
    s_nop 0
    s_cbranch_scc1 .ap_20
    s_waitcnt vmcnt(5)
    s_cmpk_ge_u32 s8, 1452
    s_cbranch_scc1 .ap_20
    s_waitcnt vmcnt(3)
    s_bitcmp1_b64 s[14:15], 37
    s_cbranch_scc0 1
    s_waitcnt vmcnt(2)
    s_cmpk_ge_u32 s8, 1332
    s_cbranch_scc1 .ap_20
    s_waitcnt vmcnt(1)
.ap_20:
    s_add_u32 s63, s69, 40960
    buffer_load_dwordx4 v[180:183], v1, s[44:47], s63 offen nt
    v_mfma_f32_16x16x32_bf16 v[128:131], v[136:139], v[24:27], 0
    v_mfma_f32_16x16x32_bf16 v[120:123], v[132:135], v[28:31], v[120:123]
    v_add_f32_dpp v11, v99, v98 row_ror:12 row_mask:0xf bank_mask:0x4
    v_add_f32_dpp v10, v88, v10 row_ror:8 row_mask:0xf bank_mask:0x4
    v_add_f32_dpp v13, v80, v13 row_ror:4 row_mask:0xf bank_mask:0x2
    v_mfma_f32_16x16x32_bf16 v[136:139], v[144:147], v[24:27], 0
    v_mfma_f32_16x16x32_bf16 v[128:131], v[140:143], v[28:31], v[128:131]
    v_add_f32_dpp v12, v107, v106 row_ror:12 row_mask:0xf bank_mask:0x4
    v_add_f32_dpp v11, v96, v11 row_ror:8 row_mask:0xf bank_mask:0x4
    v_add_f32_dpp v10, v89, v10 row_ror:4 row_mask:0xf bank_mask:0x4
    v_mfma_f32_16x16x32_bf16 v[144:147], v[152:155], v[24:27], 0
    v_mfma_f32_16x16x32_bf16 v[136:139], v[148:151], v[28:31], v[136:139]
    v_add_f32_dpp v13, v115, v114 row_ror:12 row_mask:0xf bank_mask:0x4
    v_add_f32_dpp v12, v104, v12 row_ror:8 row_mask:0xf bank_mask:0x4
    v_add_f32_dpp v11, v97, v11 row_ror:4 row_mask:0xf bank_mask:0x4
    v_mfma_f32_16x16x32_bf16 v[144:147], v[156:159], v[28:31], v[144:147]
    v_add_f32_dpp v10, v120, v123 row_ror:12 row_mask:0xf bank_mask:0x8
    v_add_f32_dpp v13, v112, v13 row_ror:8 row_mask:0xf bank_mask:0x4
    v_add_f32_dpp v12, v105, v12 row_ror:4 row_mask:0xf bank_mask:0x4
    s_memrealtime s[8:9]
    s_waitcnt lgkmcnt(0)
    s_sub_u32 s8, s8, s30
    s_cmpk_ge_u32 s8, 1583
    s_nop 0
    s_cbranch_scc1 .ap_21
    s_waitcnt vmcnt(5)
    s_cmpk_ge_u32 s8, 1483
    s_cbranch_scc1 .ap_21
    s_waitcnt vmcnt(3)
    s_bitcmp1_b64 s[14:15], 38
    s_cbranch_scc0 1
    s_waitcnt vmcnt(2)
    s_cmpk_ge_u32 s8, 1363
    s_cbranch_scc1 .ap_21
    s_waitcnt vmcnt(1)
.ap_21:
    s_add_u32 s63, s69, 49152
    buffer_load_dwordx4 v[184:187], v1, s[44:47], s63 offen nt
    v_add_f32_dpp v11, v128, v131 row_ror:12 row_mask:0xf bank_mask:0x8
    v_add_f32_dpp v10, v121, v10 row_ror:8 row_mask:0xf bank_mask:0x8
    v_add_f32_dpp v13, v113, v13 row_ror:4 row_mask:0xf bank_mask:0x4
    v_add_f32_dpp v12, v136, v139 row_ror:12 row_mask:0xf bank_mask:0x8
    v_add_f32_dpp v11, v129, v11 row_ror:8 row_mask:0xf bank_mask:0x8
    v_add_f32_dpp v10, v122, v10 row_ror:4 row_mask:0xf bank_mask:0x8
    v_add_f32_dpp v13, v144, v147 row_ror:12 row_mask:0xf bank_mask:0x8
    v_add_f32_dpp v12, v137, v12 row_ror:8 row_mask:0xf bank_mask:0x8
    v_add_f32_dpp v11, v130, v11 row_ror:4 row_mask:0xf bank_mask:0x8
    v_add_f32_dpp v13, v145, v13 row_ror:8 row_mask:0xf bank_mask:0x8
    v_add_f32_dpp v12, v138, v12 row_ror:4 row_mask:0xf bank_mask:0x8
    s_memrealtime s[8:9]
    s_waitcnt lgkmcnt(0)
    s_sub_u32 s8, s8, s30
    s_cmpk_ge_u32 s8, 1614
    s_cbranch_scc1 .ap_22
    s_waitcnt vmcnt(5)
    s_cmpk_ge_u32 s8, 1514
    s_cbranch_scc1 .ap_22
    s_waitcnt vmcnt(3)
    s_bitcmp1_b64 s[14:15], 39
    s_cbranch_scc0 1
    s_waitcnt vmcnt(2)
    s_cmpk_ge_u32 s8, 1394
    s_cbranch_scc1 .ap_22
    s_waitcnt vmcnt(1)
.ap_22:
    s_add_u32 s63, s69, 57344
    buffer_load_dwordx4 v[188:191], v1, s[44:47], s63 offen nt
    v_add_f32_dpp v13, v146, v13 row_ror:4 row_mask:0xf bank_mask:0x8
    s_mov_b32 s60, 0x3db504f3
    s_mov_b32 s61, 0x3db504f3
    v_cvt_pk_bf16_f32 v10, v10, v11
    v_and_b32 v11, 0xffff0000, v10
    v_lshlrev_b32 v10, 16, v10
    v_cvt_pk_bf16_f32 v12, v12, v13
    v_and_b32 v13, 0xffff0000, v12
    v_lshlrev_b32 v12, 16, v12
    v_pk_mul_f32 v[10:11], v[10:11], s[60:61]
    v_pk_mul_f32 v[12:13], v[12:13], s[60:61]
    v_cvt_pk_bf16_f32 v10, v10, v11
    v_and_b32 v11, 0xffff0000, v10
    v_lshlrev_b32 v10, 16, v10
    v_cvt_pk_bf16_f32 v12, v12, v13
    v_and_b32 v13, 0xffff0000, v12
    v_lshlrev_b32 v12, 16, v12
    v_max_f32 v14, v10, v11
    v_max3_f32 v14, v14, v12, v13
    s_mov_b32 s60, 0x3fb8aa3b
    v_mov_b32 v22, s34
    v_mov_b32 v23, s34
    v_max_f32_dpp v14, v14, v14 quad_perm:[2,3,0,1] row_mask:0xf bank_mask:0xf
    s_nop 1
    v_max_f32_dpp v14, v14, v14 row_ror:4 row_mask:0xf bank_mask:0xf
    s_nop 1
    v_max_f32_dpp v14, v14, v14 row_ror:8 row_mask:0xf bank_mask:0xf
    v_mov_b32 v15, v14
    s_nop 1
    v_permlane16_swap_b32 v15, v14
    v_max_f32 v14, v15, v14
    v_mov_b32 v15, v14
    s_nop 1
    v_permlane32_swap_b32 v15, v14
    v_max_f32 v14, v15, v14
    v_mul_f32 v15, 0xbfb8aa3b, v14
    v_fma_f32 v10, v10, s60, v15
    v_fma_f32 v11, v11, s60, v15
    v_fma_f32 v12, v12, s60, v15
    v_fma_f32 v13, v13, s60, v15
    v_exp_f32 v10, v10
    v_exp_f32 v11, v11
    v_exp_f32 v12, v12
    v_exp_f32 v13, v13
    v_mov_b32 v20, v14
    v_pk_add_f32 v[16:17], v[10:11], v[12:13]
    v_add_f32 v21, v16, v17
    s_lshl3_add_u32 s60, s68, s3
    s_lshl_b32 s60, s60, 5
    s_add_u32 s60, s60, s59
    v_add_f32_dpp v21, v21, v21 quad_perm:[2,3,0,1] row_mask:0xf bank_mask:0xf
    s_nop 1
    v_add_f32_dpp v21, v21, v21 row_ror:4 row_mask:0xf bank_mask:0xf
    s_nop 1
    v_add_f32_dpp v21, v21, v21 row_ror:8 row_mask:0xf bank_mask:0xf
    v_mov_b32 v15, v21
    s_nop 1
    v_permlane16_swap_b32 v15, v21
    v_add_f32 v21, v15, v21
    v_mov_b32 v15, v21
    s_nop 1
    v_permlane32_swap_b32 v15, v21
    v_add_f32 v21, v15, v21
    s_mov_b64 exec, 0x3
    buffer_store_dwordx4 v[20:23], v2, s[36:39], s60 offen sc1
    s_mov_b64 exec, -1
    s_memrealtime s[8:9]
    s_waitcnt vmcnt(8)
    s_waitcnt lgkmcnt(0)
    s_sub_u32 s8, s8, s30
    s_cmpk_ge_u32 s8, 1645
    s_cbranch_scc1 .ap_23
    s_waitcnt vmcnt(5)
    s_cmpk_ge_u32 s8, 1545
    s_cbranch_scc1 .ap_23
    s_waitcnt vmcnt(3)
    s_bitcmp1_b64 s[14:15], 40
    s_cbranch_scc0 1
    s_waitcnt vmcnt(2)
    s_cmpk_ge_u32 s8, 1425
    s_cbranch_scc1 .ap_23
    s_waitcnt vmcnt(1)
.ap_23:
    s_add_u32 s63, s69, 131072
    buffer_load_dwordx4 v[192:195], v1, s[44:47], s63 offen nt
    s_memrealtime s[8:9]
    s_waitcnt vmcnt(8)
    s_waitcnt lgkmcnt(0)
    s_sub_u32 s8, s8, s30
    s_cmpk_ge_u32 s8, 1676
    s_cbranch_scc1 .ap_24
    s_waitcnt vmcnt(5)
    s_cmpk_ge_u32 s8, 1576
    s_cbranch_scc1 .ap_24
    s_waitcnt vmcnt(3)
    s_bitcmp1_b64 s[14:15], 41
    s_cbranch_scc0 1
    s_waitcnt vmcnt(2)
    s_cmpk_ge_u32 s8, 1456
    s_cbranch_scc1 .ap_24
    s_waitcnt vmcnt(1)
.ap_24:
    s_add_u32 s63, s69, 139264
    buffer_load_dwordx4 v[196:199], v1, s[44:47], s63 offen nt
    s_memrealtime s[8:9]
    s_waitcnt vmcnt(8)
    s_waitcnt lgkmcnt(0)
    s_sub_u32 s8, s8, s30
    s_cmpk_ge_u32 s8, 1707
    s_cbranch_scc1 .ap_25
    s_waitcnt vmcnt(5)
    s_cmpk_ge_u32 s8, 1607
    s_cbranch_scc1 .ap_25
    s_waitcnt vmcnt(3)
    s_bitcmp1_b64 s[14:15], 42
    s_cbranch_scc0 1
    s_waitcnt vmcnt(2)
    s_cmpk_ge_u32 s8, 1487
    s_cbranch_scc1 .ap_25
    s_waitcnt vmcnt(1)
.ap_25:
    s_add_u32 s63, s69, 147456
    buffer_load_dwordx4 v[200:203], v1, s[44:47], s63 offen nt
    s_memrealtime s[8:9]
    s_waitcnt vmcnt(8)
    s_waitcnt lgkmcnt(0)
    s_sub_u32 s8, s8, s30
    s_cmpk_ge_u32 s8, 1738
    s_cbranch_scc1 .ap_26
    s_waitcnt vmcnt(5)
    s_cmpk_ge_u32 s8, 1638
    s_cbranch_scc1 .ap_26
    s_waitcnt vmcnt(3)
    s_bitcmp1_b64 s[14:15], 43
    s_cbranch_scc0 1
    s_waitcnt vmcnt(2)
    s_cmpk_ge_u32 s8, 1518
    s_cbranch_scc1 .ap_26
    s_waitcnt vmcnt(1)
.ap_26:
    s_add_u32 s63, s69, 155648
    buffer_load_dwordx4 v[204:207], v1, s[44:47], s63 offen nt
    s_memrealtime s[8:9]
    s_waitcnt vmcnt(8)
    s_waitcnt lgkmcnt(0)
    s_sub_u32 s8, s8, s30
    s_cmpk_ge_u32 s8, 1769
    s_cbranch_scc1 .ap_27
    s_waitcnt vmcnt(5)
    s_cmpk_ge_u32 s8, 1669
    s_cbranch_scc1 .ap_27
    s_waitcnt vmcnt(3)
    s_bitcmp1_b64 s[14:15], 44
    s_cbranch_scc0 1
    s_waitcnt vmcnt(2)
    s_cmpk_ge_u32 s8, 1549
    s_cbranch_scc1 .ap_27
    s_waitcnt vmcnt(1)
.ap_27:
    s_add_u32 s63, s69, 163840
    buffer_load_dwordx4 v[208:211], v1, s[44:47], s63 offen nt
    s_memrealtime s[8:9]
    s_waitcnt vmcnt(8)
    s_waitcnt lgkmcnt(0)
    s_sub_u32 s8, s8, s30
    s_cmpk_ge_u32 s8, 1800
    s_cbranch_scc1 .ap_28
    s_waitcnt vmcnt(5)
    s_cmpk_ge_u32 s8, 1700
    s_cbranch_scc1 .ap_28
    s_waitcnt vmcnt(3)
    s_bitcmp1_b64 s[14:15], 45
    s_cbranch_scc0 1
    s_waitcnt vmcnt(2)
    s_cmpk_ge_u32 s8, 1580
    s_cbranch_scc1 .ap_28
    s_waitcnt vmcnt(1)
.ap_28:
    s_add_u32 s63, s69, 172032
    buffer_load_dwordx4 v[212:215], v1, s[44:47], s63 offen nt
    s_memrealtime s[8:9]
    s_waitcnt vmcnt(8)
    s_waitcnt lgkmcnt(0)
    s_sub_u32 s8, s8, s30
    s_cmpk_ge_u32 s8, 1833
    s_cbranch_scc1 .ap_29
    s_waitcnt vmcnt(5)
    s_cmpk_ge_u32 s8, 1733
    s_cbranch_scc1 .ap_29
    s_waitcnt vmcnt(3)
    s_bitcmp1_b64 s[14:15], 46
    s_cbranch_scc0 1
    s_waitcnt vmcnt(2)
    s_cmpk_ge_u32 s8, 1613
    s_cbranch_scc1 .ap_29
    s_waitcnt vmcnt(1)
.ap_29:
    s_add_u32 s63, s69, 180224
    buffer_load_dwordx4 v[216:219], v1, s[44:47], s63 offen nt
    s_memrealtime s[8:9]
    s_waitcnt vmcnt(8)
    s_waitcnt lgkmcnt(0)
    s_sub_u32 s8, s8, s30
    s_cmpk_ge_u32 s8, 1866
    s_cbranch_scc1 .ap_30
    s_waitcnt vmcnt(5)
    s_cmpk_ge_u32 s8, 1766
    s_cbranch_scc1 .ap_30
    s_waitcnt vmcnt(3)
    s_bitcmp1_b64 s[14:15], 47
    s_cbranch_scc0 1
    s_waitcnt vmcnt(2)
    s_cmpk_ge_u32 s8, 1646
    s_cbranch_scc1 .ap_30
    s_waitcnt vmcnt(1)
.ap_30:
    s_add_u32 s63, s69, 188416
    buffer_load_dwordx4 v[220:223], v1, s[44:47], s63 offen nt
    s_memrealtime s[8:9]
    s_waitcnt vmcnt(8)
    s_waitcnt lgkmcnt(0)
    s_sub_u32 s8, s8, s30
    s_cmpk_ge_u32 s8, 1899
    s_cbranch_scc1 .ap_31
    s_waitcnt vmcnt(5)
    s_cmpk_ge_u32 s8, 1799
    s_cbranch_scc1 .ap_31
    s_waitcnt vmcnt(3)
    s_bitcmp1_b64 s[14:15], 48
    s_cbranch_scc0 1
    s_waitcnt vmcnt(2)
    s_cmpk_ge_u32 s8, 1679
    s_cbranch_scc1 .ap_31
    s_waitcnt vmcnt(1)
.ap_31:
    s_add_u32 s63, s69, 262144
    buffer_load_dwordx4 v[224:227], v1, s[44:47], s63 offen nt
    s_memrealtime s[8:9]
    s_waitcnt vmcnt(8)
    s_waitcnt lgkmcnt(0)
    s_sub_u32 s8, s8, s30
    s_cmpk_ge_u32 s8, 1932
    s_cbranch_scc1 .ap_32
    s_waitcnt vmcnt(5)
    s_cmpk_ge_u32 s8, 1832
    s_cbranch_scc1 .ap_32
    s_waitcnt vmcnt(3)
    s_bitcmp1_b64 s[14:15], 49
    s_cbranch_scc0 1
    s_waitcnt vmcnt(2)
    s_cmpk_ge_u32 s8, 1712
    s_cbranch_scc1 .ap_32
    s_waitcnt vmcnt(1)
.ap_32:
    s_add_u32 s63, s69, 270336
    buffer_load_dwordx4 v[228:231], v1, s[44:47], s63 offen nt
    s_memrealtime s[8:9]
    s_waitcnt vmcnt(8)
    s_waitcnt lgkmcnt(0)
    s_sub_u32 s8, s8, s30
    s_cmpk_ge_u32 s8, 1965
    s_cbranch_scc1 .ap_33
    s_waitcnt vmcnt(5)
    s_cmpk_ge_u32 s8, 1865
    s_cbranch_scc1 .ap_33
    s_waitcnt vmcnt(3)
    s_bitcmp1_b64 s[14:15], 50
    s_cbranch_scc0 1
    s_waitcnt vmcnt(2)
    s_cmpk_ge_u32 s8, 1745
    s_cbranch_scc1 .ap_33
    s_waitcnt vmcnt(1)
.ap_33:
    s_add_u32 s63, s69, 278528
    buffer_load_dwordx4 v[232:235], v1, s[44:47], s63 offen nt
    s_memrealtime s[8:9]
    s_waitcnt vmcnt(8)
    s_waitcnt lgkmcnt(0)
    s_sub_u32 s8, s8, s30
    s_cmpk_ge_u32 s8, 1998
    s_cbranch_scc1 .ap_34
    s_waitcnt vmcnt(5)
    s_cmpk_ge_u32 s8, 1898
    s_cbranch_scc1 .ap_34
    s_waitcnt vmcnt(3)
    s_bitcmp1_b64 s[14:15], 51
    s_cbranch_scc0 1
    s_waitcnt vmcnt(2)
    s_cmpk_ge_u32 s8, 1778
    s_cbranch_scc1 .ap_34
    s_waitcnt vmcnt(1)
.ap_34:
    s_add_u32 s63, s69, 286720
    buffer_load_dwordx4 v[236:239], v1, s[44:47], s63 offen nt
    s_memrealtime s[8:9]
    s_waitcnt vmcnt(8)
    s_waitcnt lgkmcnt(0)
    s_sub_u32 s8, s8, s30
    s_cmpk_ge_u32 s8, 2031
    s_cbranch_scc1 .ap_35
    s_waitcnt vmcnt(5)
    s_cmpk_ge_u32 s8, 1931
    s_cbranch_scc1 .ap_35
    s_waitcnt vmcnt(3)
    s_bitcmp1_b64 s[14:15], 52
    s_cbranch_scc0 1
    s_waitcnt vmcnt(2)
    s_cmpk_ge_u32 s8, 1811
    s_cbranch_scc1 .ap_35
    s_waitcnt vmcnt(1)
.ap_35:
    s_add_u32 s63, s69, 294912
    buffer_load_dwordx4 v[240:243], v1, s[44:47], s63 offen nt
    s_memrealtime s[8:9]
    s_waitcnt vmcnt(8)
    s_waitcnt lgkmcnt(0)
    s_sub_u32 s8, s8, s30
    s_cmpk_ge_u32 s8, 2064
    s_cbranch_scc1 .ap_36
    s_waitcnt vmcnt(5)
    s_cmpk_ge_u32 s8, 1964
    s_cbranch_scc1 .ap_36
    s_waitcnt vmcnt(3)
    s_bitcmp1_b64 s[14:15], 53
    s_cbranch_scc0 1
    s_waitcnt vmcnt(2)
    s_cmpk_ge_u32 s8, 1844
    s_cbranch_scc1 .ap_36
    s_waitcnt vmcnt(1)
.ap_36:
    s_add_u32 s63, s69, 303104
    buffer_load_dwordx4 v[244:247], v1, s[44:47], s63 offen nt
    s_and_b32 s0, s0, 0xffffff80
    s_sub_u32 s0, s0, 1024
    buffer_load_dword v28, v4, s[36:39], s0 offen sc1
    buffer_load_dwordx4 v[24:27], v9, s[36:39], s59 offen offset:0 sc1
    s_memrealtime s[8:9]
    s_waitcnt vmcnt(9)
    s_waitcnt lgkmcnt(0)
    s_sub_u32 s8, s8, s30
    s_cmpk_ge_u32 s8, 2097
    s_cbranch_scc1 .ap_37
    s_waitcnt vmcnt(6)
    s_cmpk_ge_u32 s8, 1997
    s_cbranch_scc1 .ap_37
    s_waitcnt vmcnt(4)
    s_bitcmp1_b64 s[14:15], 54
    s_cbranch_scc0 1
    s_waitcnt vmcnt(3)
    s_cmpk_ge_u32 s8, 1877
    s_cbranch_scc1 .ap_37
    s_waitcnt vmcnt(2)
.ap_37:
    s_add_u32 s63, s69, 311296
    buffer_load_dwordx4 v[248:251], v1, s[44:47], s63 offen nt
    s_memrealtime s[8:9]
    s_waitcnt vmcnt(9)
    s_waitcnt lgkmcnt(0)
    s_sub_u32 s8, s8, s30
    s_cmpk_ge_u32 s8, 2130
    s_cbranch_scc1 .ap_38
    s_waitcnt vmcnt(6)
    s_cmpk_ge_u32 s8, 2030
    s_cbranch_scc1 .ap_38
    s_waitcnt vmcnt(4)
    s_bitcmp1_b64 s[14:15], 55
    s_cbranch_scc0 1
    s_waitcnt vmcnt(3)
    s_cmpk_ge_u32 s8, 1910
    s_cbranch_scc1 .ap_38
    s_waitcnt vmcnt(1)
.ap_38:
    s_add_u32 s63, s69, 319488
    buffer_load_dwordx4 v[252:255], v1, s[44:47], s63 offen nt
    s_memrealtime s[8:9]
    s_waitcnt vmcnt(9)
    s_waitcnt lgkmcnt(0)
    s_sub_u32 s8, s8, s30
    s_cmpk_ge_u32 s8, 2163
    s_cbranch_scc1 .ap_39
    s_waitcnt vmcnt(6)
    s_cmpk_ge_u32 s8, 2063
    s_cbranch_scc1 .ap_39
    s_waitcnt vmcnt(4)
    s_bitcmp1_b64 s[14:15], 56
    s_cbranch_scc0 1
    s_waitcnt vmcnt(2)
    s_cmpk_ge_u32 s8, 1943
    s_cbranch_scc1 .ap_39
    s_waitcnt vmcnt(1)
.ap_39:
    s_add_u32 s63, s69, 393216
    buffer_load_dwordx4 v[36:39], v1, s[44:47], s63 offen nt
    s_memrealtime s[8:9]
    s_waitcnt vmcnt(9)
    s_waitcnt lgkmcnt(0)
    s_sub_u32 s8, s8, s30
    s_cmpk_ge_u32 s8, 2196
    s_cbranch_scc1 .ap_40
    s_waitcnt vmcnt(6)
    s_cmpk_ge_u32 s8, 2096
    s_cbranch_scc1 .ap_40
    s_waitcnt vmcnt(3)
    s_bitcmp1_b64 s[14:15], 57
    s_cbranch_scc0 1
    s_waitcnt vmcnt(2)
    s_cmpk_ge_u32 s8, 1976
    s_cbranch_scc1 .ap_40
    s_waitcnt vmcnt(1)
.ap_40:
    s_add_u32 s63, s69, 401408
    buffer_load_dwordx4 v[44:47], v1, s[44:47], s63 offen nt
    s_memrealtime s[8:9]
    s_waitcnt vmcnt(9)
    s_waitcnt lgkmcnt(0)
    s_sub_u32 s8, s8, s30
    s_cmpk_ge_u32 s8, 2229
    s_cbranch_scc1 .ap_41
    s_waitcnt vmcnt(6)
    s_cmpk_ge_u32 s8, 2129
    s_cbranch_scc1 .ap_41
    s_waitcnt vmcnt(3)
    s_bitcmp1_b64 s[14:15], 58
    s_cbranch_scc0 1
    s_waitcnt vmcnt(2)
    s_cmpk_ge_u32 s8, 2009
    s_cbranch_scc1 .ap_41
    s_waitcnt vmcnt(1)
.ap_41:
    s_add_u32 s63, s69, 409600
    buffer_load_dwordx4 v[52:55], v1, s[44:47], s63 offen nt
    s_memrealtime s[8:9]
    s_waitcnt vmcnt(9)
    s_waitcnt lgkmcnt(0)
    s_sub_u32 s8, s8, s30
    s_cmpk_ge_u32 s8, 2262
    s_cbranch_scc1 .ap_42
    s_waitcnt vmcnt(5)
    s_cmpk_ge_u32 s8, 2162
    s_cbranch_scc1 .ap_42
    s_waitcnt vmcnt(3)
    s_bitcmp1_b64 s[14:15], 59
    s_cbranch_scc0 1
    s_waitcnt vmcnt(2)
    s_cmpk_ge_u32 s8, 2042
    s_cbranch_scc1 .ap_42
    s_waitcnt vmcnt(1)
.ap_42:
    s_add_u32 s63, s69, 417792
    buffer_load_dwordx4 v[60:63], v1, s[44:47], s63 offen nt
    s_memrealtime s[8:9]
    s_waitcnt vmcnt(9)
    s_waitcnt lgkmcnt(0)
    s_sub_u32 s8, s8, s30
    s_cmpk_ge_u32 s8, 2295
    s_cbranch_scc1 .ap_43
    s_waitcnt vmcnt(5)
    s_cmpk_ge_u32 s8, 2195
    s_cbranch_scc1 .ap_43
    s_waitcnt vmcnt(3)
    s_bitcmp1_b64 s[14:15], 60
    s_cbranch_scc0 1
    s_waitcnt vmcnt(2)
    s_cmpk_ge_u32 s8, 2075
    s_cbranch_scc1 .ap_43
    s_waitcnt vmcnt(1)
.ap_43:
    s_add_u32 s63, s69, 425984
    buffer_load_dwordx4 v[68:71], v1, s[44:47], s63 offen nt
    s_memrealtime s[8:9]
    s_waitcnt vmcnt(9)
    s_waitcnt lgkmcnt(0)
    s_sub_u32 s8, s8, s30
    s_cmpk_ge_u32 s8, 2328
    s_cbranch_scc1 .ap_44
    s_waitcnt vmcnt(5)
    s_cmpk_ge_u32 s8, 2228
    s_cbranch_scc1 .ap_44
    s_waitcnt vmcnt(3)
    s_bitcmp1_b64 s[14:15], 61
    s_cbranch_scc0 1
    s_waitcnt vmcnt(2)
    s_cmpk_ge_u32 s8, 2108
    s_cbranch_scc1 .ap_44
    s_waitcnt vmcnt(1)
.ap_44:
    s_add_u32 s63, s69, 434176
    buffer_load_dwordx4 v[76:79], v1, s[44:47], s63 offen nt
    s_memrealtime s[8:9]
    s_waitcnt vmcnt(8)
    s_waitcnt lgkmcnt(0)
    s_sub_u32 s8, s8, s30
    s_cmpk_ge_u32 s8, 2361
    s_cbranch_scc1 .ap_45
    s_waitcnt vmcnt(5)
    s_cmpk_ge_u32 s8, 2261
    s_cbranch_scc1 .ap_45
    s_waitcnt vmcnt(3)
    s_bitcmp1_b64 s[14:15], 62
    s_cbranch_scc0 1
    s_waitcnt vmcnt(2)
    s_cmpk_ge_u32 s8, 2141
    s_cbranch_scc1 .ap_45
    s_waitcnt vmcnt(1)
.ap_45:
    s_add_u32 s63, s69, 442368
    buffer_load_dwordx4 v[84:87], v1, s[44:47], s63 offen nt
    s_memrealtime s[8:9]
    s_waitcnt vmcnt(8)
    s_waitcnt lgkmcnt(0)
    s_sub_u32 s8, s8, s30
    s_cmpk_ge_u32 s8, 2394
    s_cbranch_scc1 .ap_46
    s_waitcnt vmcnt(5)
    s_cmpk_ge_u32 s8, 2294
    s_cbranch_scc1 .ap_46
    s_waitcnt vmcnt(3)
    s_bitcmp1_b64 s[14:15], 63
    s_cbranch_scc0 1
    s_waitcnt vmcnt(2)
    s_cmpk_ge_u32 s8, 2174
    s_cbranch_scc1 .ap_46
    s_waitcnt vmcnt(1)
.ap_46:
    s_add_u32 s63, s69, 450560
    buffer_load_dwordx4 v[92:95], v1, s[44:47], s63 offen nt
    s_setprio 0
    s_branch .gpc_48
.gp_47:
    buffer_load_dwordx4 v[24:27], v9, s[36:39], s59 offen offset:0 sc1
    s_waitcnt vmcnt(0)
.gpc_48:
    v_cmp_eq_u32 vcc, s34, v26
    s_cmp_eq_u64 vcc, -1
    s_nop 3
    s_cbranch_scc1 .gpd_49
    s_sub_u32 s35, s35, 1
    s_cbranch_scc1 .Lexit
    s_sleep 1
    s_branch .gp_47
.gpd_49:
    v_cmp_eq_u32 vcc, s1, v28
    s_cmp_eq_u64 vcc, -1
    s_cselect_b32 s0, 0x800000, 0
    v_mov_b32 v16, v24
    s_nop 1
    v_max_f32_dpp v16, v16, v16 row_ror:8 row_mask:0xf bank_mask:0xf
    s_nop 1
    v_max_f32_dpp v16, v16, v16 row_ror:4 row_mask:0xf bank_mask:0xf
    v_mov_b32 v17, v16
    s_nop 1
    v_permlane16_swap_b32 v17, v16
    v_max_f32 v16, v17, v16
    v_mov_b32 v17, v16
    s_nop 1
    v_permlane32_swap_b32 v17, v16
    v_max_f32 v16, v17, v16
    v_sub_f32 v17, v24, v16
    v_sub_f32 v18, v14, v16
    v_mul_f32 v17, 0x3fb8aa3b, v17
    v_mul_f32 v18, 0x3fb8aa3b, v18
    v_exp_f32 v17, v17
    v_exp_f32 v18, v18
    v_mul_f32 v17, v17, v25
    s_nop 1
    v_add_f32_dpp v17, v17, v17 row_ror:8 row_mask:0xf bank_mask:0xf
    s_nop 1
    v_add_f32_dpp v17, v17, v17 row_ror:4 row_mask:0xf bank_mask:0xf
    v_mov_b32 v19, v17
    s_nop 1
    v_permlane16_swap_b32 v19, v17
    v_add_f32 v17, v19, v17
    v_mov_b32 v19, v17
    s_nop 1
    v_permlane32_swap_b32 v19, v17
    v_add_f32 v17, v19, v17
    v_rcp_f32 v19, v17
    s_nop 0
    v_fma_f32 v15, -v17, v19, 1.0
    v_fma_f32 v19, v15, v19, v19
    v_mul_f32 v18, v18, v19
    v_mul_f32 v10, v10, v18
    v_mul_f32 v11, v11, v18
    v_mul_f32 v12, v12, v18
    v_mul_f32 v13, v13, v18
    v_mov_b32_dpp v112, v10 quad_perm:[2,3,0,1] row_mask:0xf bank_mask:0xf
    v_mov_b32_dpp v113, v11 quad_perm:[2,3,0,1] row_mask:0xf bank_mask:0xf
    v_mov_b32_dpp v114, v12 quad_perm:[2,3,0,1] row_mask:0xf bank_mask:0xf
    v_mov_b32_dpp v115, v13 quad_perm:[2,3,0,1] row_mask:0xf bank_mask:0xf
    v_cvt_pk_bf16_f32 v96, v10, v112
    v_cvt_pk_bf16_f32 v100, v11, v113
    v_cvt_pk_bf16_f32 v104, v12, v114
    v_cvt_pk_bf16_f32 v108, v13, v115
    v_mov_b32_dpp v97, v96 row_ror:12 row_mask:0xf bank_mask:0xf
    v_mov_b32_dpp v101, v100 row_ror:12 row_mask:0xf bank_mask:0xf
    v_mov_b32_dpp v105, v104 row_ror:12 row_mask:0xf bank_mask:0xf
    v_mov_b32_dpp v109, v108 row_ror:12 row_mask:0xf bank_mask:0xf
    v_mov_b32_dpp v98, v96 row_ror:8 row_mask:0xf bank_mask:0xf
    v_mov_b32_dpp v102, v100 row_ror:8 row_mask:0xf bank_mask:0xf
    v_mov_b32_dpp v106, v104 row_ror:8 row_mask:0xf bank_mask:0xf
    v_mov_b32_dpp v110, v108 row_ror:8 row_mask:0xf bank_mask:0xf
    v_mov_b32_dpp v99, v96 row_ror:4 row_mask:0xf bank_mask:0xf
    v_mov_b32_dpp v103, v100 row_ror:4 row_mask:0xf bank_mask:0xf
    v_mov_b32_dpp v107, v104 row_ror:4 row_mask:0xf bank_mask:0xf
    v_mov_b32_dpp v111, v108 row_ror:4 row_mask:0xf bank_mask:0xf
    s_lshl_b32 s60, s3, 10
    s_add_u32 s60, s60, 147456
    v_lshlrev_b32 v10, 5, v0
    v_add_u32 v10, s60, v10
    v_perm_b32 v112, v164, v160, s94
    v_perm_b32 v113, v172, v168, s94
    v_perm_b32 v114, v180, v176, s94
    v_perm_b32 v115, v188, v184, s94
    s_nop 1
    v_mfma_f32_16x16x32_bf16 v[128:131], v[96:99], v[112:115], 0
    v_perm_b32 v116, v164, v160, s95
    v_perm_b32 v117, v172, v168, s95
    v_perm_b32 v118, v180, v176, s95
    v_perm_b32 v119, v188, v184, s95
    s_nop 1
    v_mfma_f32_16x16x32_bf16 v[132:135], v[96:99], v[116:119], 0
    v_perm_b32 v120, v165, v161, s94
    v_perm_b32 v121, v173, v169, s94
    v_perm_b32 v122, v181, v177, s94
    v_perm_b32 v123, v189, v185, s94
    s_nop 1
    v_mfma_f32_16x16x32_bf16 v[136:139], v[96:99], v[120:123], 0
    v_perm_b32 v124, v165, v161, s95
    v_perm_b32 v125, v173, v169, s95
    v_perm_b32 v126, v181, v177, s95
    v_perm_b32 v127, v189, v185, s95
    s_nop 1
    v_mfma_f32_16x16x32_bf16 v[140:143], v[96:99], v[124:127], 0
    v_perm_b32 v112, v166, v162, s94
    v_perm_b32 v113, v174, v170, s94
    v_perm_b32 v114, v182, v178, s94
    v_perm_b32 v115, v190, v186, s94
    s_nop 1
    v_mfma_f32_16x16x32_bf16 v[144:147], v[96:99], v[112:115], 0
    v_perm_b32 v116, v166, v162, s95
    v_perm_b32 v117, v174, v170, s95
    v_perm_b32 v118, v182, v178, s95
    v_perm_b32 v119, v190, v186, s95
    s_nop 1
    v_mfma_f32_16x16x32_bf16 v[148:151], v[96:99], v[116:119], 0
    v_perm_b32 v120, v167, v163, s94
    v_perm_b32 v121, v175, v171, s94
    v_perm_b32 v122, v183, v179, s94
    v_perm_b32 v123, v191, v187, s94
    s_nop 1
    v_mfma_f32_16x16x32_bf16 v[152:155], v[96:99], v[120:123], 0
    v_perm_b32 v124, v167, v163, s95
    v_perm_b32 v125, v175, v171, s95
    v_perm_b32 v126, v183, v179, s95
    v_perm_b32 v127, v191, v187, s95
    s_nop 1
    v_mfma_f32_16x16x32_bf16 v[156:159], v[96:99], v[124:127], 0
    v_perm_b32 v112, v196, v192, s94
    v_perm_b32 v113, v204, v200, s94
    v_perm_b32 v114, v212, v208, s94
    v_perm_b32 v115, v220, v216, s94
    s_nop 1
    v_mfma_f32_16x16x32_bf16 v[128:131], v[100:103], v[112:115], v[128:131]
    v_perm_b32 v116, v196, v192, s95
    v_perm_b32 v117, v204, v200, s95
    v_perm_b32 v118, v212, v208, s95
    v_perm_b32 v119, v220, v216, s95
    s_nop 1
    v_mfma_f32_16x16x32_bf16 v[132:135], v[100:103], v[116:119], v[132:135]
    v_perm_b32 v120, v197, v193, s94
    v_perm_b32 v121, v205, v201, s94
    v_perm_b32 v122, v213, v209, s94
    v_perm_b32 v123, v221, v217, s94
    s_nop 1
    v_mfma_f32_16x16x32_bf16 v[136:139], v[100:103], v[120:123], v[136:139]
    v_perm_b32 v124, v197, v193, s95
    v_perm_b32 v125, v205, v201, s95
    v_perm_b32 v126, v213, v209, s95
    v_perm_b32 v127, v221, v217, s95
    s_nop 1
    v_mfma_f32_16x16x32_bf16 v[140:143], v[100:103], v[124:127], v[140:143]
    v_perm_b32 v112, v198, v194, s94
    v_perm_b32 v113, v206, v202, s94
    v_perm_b32 v114, v214, v210, s94
    v_perm_b32 v115, v222, v218, s94
    s_nop 1
    v_mfma_f32_16x16x32_bf16 v[144:147], v[100:103], v[112:115], v[144:147]
    v_perm_b32 v116, v198, v194, s95
    v_perm_b32 v117, v206, v202, s95
    v_perm_b32 v118, v214, v210, s95
    v_perm_b32 v119, v222, v218, s95
    s_nop 1
    v_mfma_f32_16x16x32_bf16 v[148:151], v[100:103], v[116:119], v[148:151]
    v_perm_b32 v120, v199, v195, s94
    v_perm_b32 v121, v207, v203, s94
    v_perm_b32 v122, v215, v211, s94
    v_perm_b32 v123, v223, v219, s94
    s_nop 1
    v_mfma_f32_16x16x32_bf16 v[152:155], v[100:103], v[120:123], v[152:155]
    v_perm_b32 v124, v199, v195, s95
    v_perm_b32 v125, v207, v203, s95
    v_perm_b32 v126, v215, v211, s95
    v_perm_b32 v127, v223, v219, s95
    s_nop 1
    v_mfma_f32_16x16x32_bf16 v[156:159], v[100:103], v[124:127], v[156:159]
    s_waitcnt vmcnt(8)
    v_perm_b32 v112, v228, v224, s94
    v_perm_b32 v113, v236, v232, s94
    v_perm_b32 v114, v244, v240, s94
    v_perm_b32 v115, v252, v248, s94
    s_nop 1
    v_mfma_f32_16x16x32_bf16 v[128:131], v[104:107], v[112:115], v[128:131]
    v_perm_b32 v116, v228, v224, s95
    v_perm_b32 v117, v236, v232, s95
    v_perm_b32 v118, v244, v240, s95
    v_perm_b32 v119, v252, v248, s95
    s_nop 1
    v_mfma_f32_16x16x32_bf16 v[132:135], v[104:107], v[116:119], v[132:135]
    v_perm_b32 v120, v229, v225, s94
    v_perm_b32 v121, v237, v233, s94
    v_perm_b32 v122, v245, v241, s94
    v_perm_b32 v123, v253, v249, s94
    s_nop 1
    v_mfma_f32_16x16x32_bf16 v[136:139], v[104:107], v[120:123], v[136:139]
    v_perm_b32 v124, v229, v225, s95
    v_perm_b32 v125, v237, v233, s95
    v_perm_b32 v126, v245, v241, s95
    v_perm_b32 v127, v253, v249, s95
    s_nop 1
    v_mfma_f32_16x16x32_bf16 v[140:143], v[104:107], v[124:127], v[140:143]
    v_perm_b32 v112, v230, v226, s94
    v_perm_b32 v113, v238, v234, s94
    v_perm_b32 v114, v246, v242, s94
    v_perm_b32 v115, v254, v250, s94
    s_nop 1
    v_mfma_f32_16x16x32_bf16 v[144:147], v[104:107], v[112:115], v[144:147]
    v_perm_b32 v116, v230, v226, s95
    v_perm_b32 v117, v238, v234, s95
    v_perm_b32 v118, v246, v242, s95
    v_perm_b32 v119, v254, v250, s95
    s_nop 1
    v_mfma_f32_16x16x32_bf16 v[148:151], v[104:107], v[116:119], v[148:151]
    v_perm_b32 v120, v231, v227, s94
    v_perm_b32 v121, v239, v235, s94
    v_perm_b32 v122, v247, v243, s94
    v_perm_b32 v123, v255, v251, s94
    s_nop 1
    v_mfma_f32_16x16x32_bf16 v[152:155], v[104:107], v[120:123], v[152:155]
    v_perm_b32 v124, v231, v227, s95
    v_perm_b32 v125, v239, v235, s95
    v_perm_b32 v126, v247, v243, s95
    v_perm_b32 v127, v255, v251, s95
    s_nop 1
    v_mfma_f32_16x16x32_bf16 v[156:159], v[104:107], v[124:127], v[156:159]
    s_waitcnt vmcnt(0)
    v_perm_b32 v112, v44, v36, s94
    v_perm_b32 v113, v60, v52, s94
    v_perm_b32 v114, v76, v68, s94
    v_perm_b32 v115, v92, v84, s94
    s_nop 1
    v_mfma_f32_16x16x32_bf16 v[128:131], v[108:111], v[112:115], v[128:131]
    v_perm_b32 v116, v44, v36, s95
    v_perm_b32 v117, v60, v52, s95
    v_perm_b32 v118, v76, v68, s95
    v_perm_b32 v119, v92, v84, s95
    s_nop 1
    v_mfma_f32_16x16x32_bf16 v[132:135], v[108:111], v[116:119], v[132:135]
    v_perm_b32 v120, v45, v37, s94
    v_perm_b32 v121, v61, v53, s94
    v_perm_b32 v122, v77, v69, s94
    v_perm_b32 v123, v93, v85, s94
    s_nop 1
    v_mfma_f32_16x16x32_bf16 v[136:139], v[108:111], v[120:123], v[136:139]
    v_perm_b32 v124, v45, v37, s95
    v_perm_b32 v125, v61, v53, s95
    v_perm_b32 v126, v77, v69, s95
    v_perm_b32 v127, v93, v85, s95
    s_nop 1
    v_mfma_f32_16x16x32_bf16 v[140:143], v[108:111], v[124:127], v[140:143]
    v_perm_b32 v112, v46, v38, s94
    v_perm_b32 v113, v62, v54, s94
    v_perm_b32 v114, v78, v70, s94
    v_perm_b32 v115, v94, v86, s94
    s_nop 1
    v_mfma_f32_16x16x32_bf16 v[144:147], v[108:111], v[112:115], v[144:147]
    v_perm_b32 v116, v46, v38, s95
    v_perm_b32 v117, v62, v54, s95
    v_perm_b32 v118, v78, v70, s95
    v_perm_b32 v119, v94, v86, s95
    s_nop 1
    v_mfma_f32_16x16x32_bf16 v[148:151], v[108:111], v[116:119], v[148:151]
    v_perm_b32 v120, v47, v39, s94
    v_perm_b32 v121, v63, v55, s94
    v_perm_b32 v122, v79, v71, s94
    v_perm_b32 v123, v95, v87, s94
    s_nop 1
    v_mfma_f32_16x16x32_bf16 v[152:155], v[108:111], v[120:123], v[152:155]
    v_perm_b32 v124, v47, v39, s95
    v_perm_b32 v125, v63, v55, s95
    v_perm_b32 v126, v79, v71, s95
    v_perm_b32 v127, v95, v87, s95
    s_nop 1
    v_mfma_f32_16x16x32_bf16 v[156:159], v[108:111], v[124:127], v[156:159]
    s_mov_b64 exec, 0xffff
    ds_write2_b32 v10, v128, v129 offset0:0 offset1:128
    ds_write2_b32 v10, v132, v133 offset0:1 offset1:129
    ds_write2_b32 v10, v136, v137 offset0:2 offset1:130
    ds_write2_b32 v10, v140, v141 offset0:3 offset1:131
    ds_write2_b32 v10, v144, v145 offset0:4 offset1:132
    ds_write2_b32 v10, v148, v149 offset0:5 offset1:133
    ds_write2_b32 v10, v152, v153 offset0:6 offset1:134
    ds_write2_b32 v10, v156, v157 offset0:7 offset1:135
    s_mov_b64 exec, -1
    s_waitcnt lgkmcnt(0)
    s_barrier
    s_cmp_lg_u32 s3, 7
    s_cbranch_scc1 .opub_50
    v_add_u32 v10, 147456, v2
    ds_read_b128 v[196:199], v10 offset:0
    ds_read_b128 v[200:203], v10 offset:1024
    ds_read_b128 v[204:207], v10 offset:2048
    ds_read_b128 v[208:211], v10 offset:3072
    ds_read_b128 v[212:215], v10 offset:4096
    ds_read_b128 v[216:219], v10 offset:5120
    ds_read_b128 v[220:223], v10 offset:6144
    ds_read_b128 v[224:227], v10 offset:7168
    v_lshrrev_b32 v11, 5, v0
    v_lshlrev_b32 v11, 13, v11
    v_and_b32 v12, 31, v0
    v_lshl_add_u32 v11, v12, 4, v11
    s_lshl4_add_u32 s56, s67, s66
    s_lshl1_add_u32 s56, s56, s68
    s_lshl_b32 s56, s56, 9
    s_add_u32 s56, s56, 0xa0000
    s_mov_b32 s60, 0x07060503
    s_mov_b32 s61, 0x07060502
    s_mov_b32 s62, 0x07060501
    v_mov_b32 v15, s34
    s_waitcnt lgkmcnt(6)
    v_pk_add_f32 v[196:197], v[196:197], v[200:201]
    v_pk_add_f32 v[198:199], v[198:199], v[202:203]
    s_waitcnt lgkmcnt(5)
    v_pk_add_f32 v[196:197], v[196:197], v[204:205]
    v_pk_add_f32 v[198:199], v[198:199], v[206:207]
    s_waitcnt lgkmcnt(4)
    v_pk_add_f32 v[196:197], v[196:197], v[208:209]
    v_pk_add_f32 v[198:199], v[198:199], v[210:211]
    s_waitcnt lgkmcnt(3)
    v_pk_add_f32 v[196:197], v[196:197], v[212:213]
    v_pk_add_f32 v[198:199], v[198:199], v[214:215]
    s_waitcnt lgkmcnt(2)
    v_pk_add_f32 v[196:197], v[196:197], v[216:217]
    v_pk_add_f32 v[198:199], v[198:199], v[218:219]
    s_waitcnt lgkmcnt(1)
    v_pk_add_f32 v[196:197], v[196:197], v[220:221]
    v_pk_add_f32 v[198:199], v[198:199], v[222:223]
    s_waitcnt lgkmcnt(0)
    v_pk_add_f32 v[196:197], v[196:197], v[224:225]
    v_pk_add_f32 v[198:199], v[198:199], v[226:227]
    v_perm_b32 v12, v196, v199, s60
    v_perm_b32 v13, v197, v199, s61
    v_perm_b32 v14, v198, v199, s62
    s_add_u32 s57, s56, 0x800000
    buffer_store_dwordx4 v[12:15], v11, s[36:39], s57 offen
    buffer_store_dwordx4 v[12:15], v11, s[36:39], s56 offen sc1
.opub_50:
    s_cmp_lt_u32 s65, 8
    s_nop 0
    s_cbranch_scc1 .Lexit
    v_and_b32 v6, 31, v0
    v_lshlrev_b32 v6, 3, v6
    v_lshrrev_b32 v7, 5, v0
    v_lshl_add_u32 v6, v7, 2, v6
    s_mul_i32 s56, s3, 528
    s_add_u32 s56, s56, 131072
    v_add_u32 v6, s56, v6
    s_lshl4_add_u32 s101, s99, s3
    s_lshl_b32 s101, s101, 10
    s_add_u32 s101, s101, 0xa0000
    v_add_u32 v5, 8192, v2
    s_cmp_ge_u32 s3, 6
    s_nop 0
    s_cbranch_scc1 .La_poll
    v_lshrrev_b32 v16, 4, v0
    v_bfe_u32 v17, v0, 2, 2
    v_lshl_add_u32 v7, v16, 3, v17
    v_lshlrev_b32 v7, 7, v7
    v_and_b32 v16, 1, v16
    v_lshrrev_b32 v17, 1, v17
    v_lshl_add_u32 v16, v16, 1, v17
    s_and_b32 s56, s3, 1
    s_lshl_b32 s56, s56, 1
    v_xor_b32 v16, s56, v16
    v_and_b32 v17, 3, v0
    v_lshl_add_u32 v7, v17, 3, v7
    s_lshr_b32 s56, s3, 1
    s_lshl_b32 s56, s56, 15
    v_add_u32 v7, s56, v7
    v_xor_b32 v17, 1, v16
    v_lshl_add_u32 v8, v17, 5, v7
    v_lshl_add_u32 v7, v16, 5, v7
    ds_read_b64_tr_b16 v[32:33], v7 offset:0
    ds_read_b64_tr_b16 v[34:35], v7 offset:512
    ds_read_b64_tr_b16 v[64:65], v8 offset:0
    ds_read_b64_tr_b16 v[66:67], v8 offset:512
    ds_read_b64_tr_b16 v[36:37], v7 offset:4096
    ds_read_b64_tr_b16 v[38:39], v7 offset:4608
    ds_read_b64_tr_b16 v[68:69], v8 offset:4096
    ds_read_b64_tr_b16 v[70:71], v8 offset:4608
    ds_read_b64_tr_b16 v[40:41], v7 offset:8192
    ds_read_b64_tr_b16 v[42:43], v7 offset:8704
    ds_read_b64_tr_b16 v[72:73], v8 offset:8192
    ds_read_b64_tr_b16 v[74:75], v8 offset:8704
    ds_read_b64_tr_b16 v[44:45], v7 offset:12288
    ds_read_b64_tr_b16 v[46:47], v7 offset:12800
    ds_read_b64_tr_b16 v[76:77], v8 offset:12288
    ds_read_b64_tr_b16 v[78:79], v8 offset:12800
    ds_read_b64_tr_b16 v[48:49], v7 offset:16384
    ds_read_b64_tr_b16 v[50:51], v7 offset:16896
    ds_read_b64_tr_b16 v[80:81], v8 offset:16384
    ds_read_b64_tr_b16 v[82:83], v8 offset:16896
    ds_read_b64_tr_b16 v[52:53], v7 offset:20480
    ds_read_b64_tr_b16 v[54:55], v7 offset:20992
    ds_read_b64_tr_b16 v[84:85], v8 offset:20480
    ds_read_b64_tr_b16 v[86:87], v8 offset:20992
    ds_read_b64_tr_b16 v[56:57], v7 offset:24576
    ds_read_b64_tr_b16 v[58:59], v7 offset:25088
    ds_read_b64_tr_b16 v[88:89], v8 offset:24576
    ds_read_b64_tr_b16 v[90:91], v8 offset:25088
    ds_read_b64_tr_b16 v[60:61], v7 offset:28672
    ds_read_b64_tr_b16 v[62:63], v7 offset:29184
    ds_read_b64_tr_b16 v[92:93], v8 offset:28672
    ds_read_b64_tr_b16 v[94:95], v8 offset:29184
    s_mov_b32 s56, 131072
    v_bfe_u32 v9, v0, 1, 3
    v_mul_u32_u24 v9, 528, v9
    v_and_b32 v16, 48, v0
    v_add3_u32 v9, v9, v16, s56
    v_bfe_u32 v10, v0, 1, 3
    v_mul_u32_u24 v10, 36864, v10
    v_and_b32 v16, 1, v0
    v_lshl_add_u32 v10, v16, 4, v10
    v_and_b32 v16, 48, v0
    v_lshl_add_u32 v10, v16, 1, v10
    s_mul_i32 s59, s100, 3
    s_lshr_b32 s56, s3, 1
    s_add_u32 s59, s59, s56
    s_lshl4_add_u32 s59, s59, s99
    s_and_b32 s56, s3, 1
    s_lshl1_add_u32 s59, s59, s56
    s_lshl_b32 s59, s59, 7
    s_add_u32 s59, s59, 0xe0000
    v_mov_b32 v139, s34
.La_poll:
    s_mov_b32 s94, 1
    s_nop 0
    s_branch .La_go
.La_again:
    s_mov_b32 s94, 0
.La_go:
    s_mov_b32 s60, 0x04000c0c
    s_mov_b32 s61, 0x0706000c
    s_cmp_lg_u32 s94, 0
    s_cbranch_scc1 .gpd_52
    s_mov_b32 s69, 0
.gp_51:
    s_add_u32 s69, s69, 1
    s_and_b32 s56, s69, 0x41
    s_cmp_lg_u32 s56, 0x41
    s_cselect_b32 s56, s0, 0
    s_add_u32 s58, s101, s56
    buffer_load_dwordx4 v[16:19], v2, s[36:39], s58 offen offset:0 sc1
    buffer_load_dwordx4 v[20:23], v5, s[36:39], s58 offen offset:0 sc1
    s_waitcnt vmcnt(0)
    v_cmp_eq_u32 vcc, s34, v19
    v_cmp_eq_u32 s[56:57], s34, v23
    s_and_b64 vcc, vcc, s[56:57]
    s_cmp_eq_u64 vcc, -1
    s_nop 2
    s_cbranch_scc1 .gpd_52
    s_sub_u32 s35, s35, 1
    s_cbranch_scc1 .Lexit
    s_branch .gp_51
.gpd_52:
    v_perm_b32 v19, v16, v17, s60
    v_perm_b32 v19, v19, v18, s61
    v_perm_b32 v23, v20, v21, s60
    v_perm_b32 v23, v23, v22, s61
    v_permlane32_swap_b32 v16, v18
    v_permlane32_swap_b32 v17, v19
    v_permlane32_swap_b32 v20, v22
    v_permlane32_swap_b32 v21, v23
    v_pk_add_f32 v[16:17], v[16:17], v[18:19]
    v_pk_add_f32 v[20:21], v[20:21], v[22:23]
    v_cvt_pk_bf16_f32 v16, v16, v17
    v_cvt_pk_bf16_f32 v20, v20, v21
    ds_write2_b32 v6, v16, v20 offset1:64
    s_mov_b32 s60, 0x07060503
    s_mov_b32 s61, 0x07060502
    s_mov_b32 s62, 0x07060501
    s_mov_b32 vcc_lo, 0xaaaaaaaa
    s_mov_b32 vcc_hi, 0xaaaaaaaa
    s_waitcnt lgkmcnt(0)
    s_barrier
    s_cmp_ge_u32 s3, 6
    s_cbranch_scc1 .La_67
    ds_read_b128 v[96:99], v9 offset:0
    ds_read_b128 v[100:103], v9 offset:64
    ds_read_b128 v[104:107], v9 offset:128
    ds_read_b128 v[108:111], v9 offset:192
    ds_read_b128 v[112:115], v9 offset:256
    ds_read_b128 v[116:119], v9 offset:320
    ds_read_b128 v[120:123], v9 offset:384
    ds_read_b128 v[124:127], v9 offset:448
    s_cmp_lg_u32 s94, 0
    s_waitcnt lgkmcnt(7)
    v_mfma_f32_16x16x32_bf16 v[128:131], v[32:35], v[96:99], 0
    v_mfma_f32_16x16x32_bf16 v[132:135], v[64:67], v[96:99], 0
    s_waitcnt lgkmcnt(6)
    v_mfma_f32_16x16x32_bf16 v[128:131], v[36:39], v[100:103], v[128:131]
    v_mfma_f32_16x16x32_bf16 v[132:135], v[68:71], v[100:103], v[132:135]
    s_waitcnt lgkmcnt(5)
    v_mfma_f32_16x16x32_bf16 v[128:131], v[40:43], v[104:107], v[128:131]
    v_mfma_f32_16x16x32_bf16 v[132:135], v[72:75], v[104:107], v[132:135]
    s_waitcnt lgkmcnt(4)
    v_mfma_f32_16x16x32_bf16 v[128:131], v[44:47], v[108:111], v[128:131]
    v_mfma_f32_16x16x32_bf16 v[132:135], v[76:79], v[108:111], v[132:135]
    s_waitcnt lgkmcnt(3)
    v_mfma_f32_16x16x32_bf16 v[128:131], v[48:51], v[112:115], v[128:131]
    v_mfma_f32_16x16x32_bf16 v[132:135], v[80:83], v[112:115], v[132:135]
    s_waitcnt lgkmcnt(2)
    v_mfma_f32_16x16x32_bf16 v[128:131], v[52:55], v[116:119], v[128:131]
    v_mfma_f32_16x16x32_bf16 v[132:135], v[84:87], v[116:119], v[132:135]
    s_waitcnt lgkmcnt(1)
    v_mfma_f32_16x16x32_bf16 v[128:131], v[56:59], v[120:123], v[128:131]
    v_mfma_f32_16x16x32_bf16 v[132:135], v[88:91], v[120:123], v[132:135]
    s_waitcnt lgkmcnt(0)
    v_mfma_f32_16x16x32_bf16 v[128:131], v[60:63], v[124:127], v[128:131]
    v_mfma_f32_16x16x32_bf16 v[132:135], v[92:95], v[124:127], v[132:135]
    s_nop 7
    v_cndmask_b32 v128, v128, v132, vcc
    v_cndmask_b32 v129, v129, v133, vcc
    v_cndmask_b32 v130, v130, v134, vcc
    v_cndmask_b32 v131, v131, v135, vcc
    v_perm_b32 v136, v128, v131, s60
    v_perm_b32 v137, v129, v131, s61
    v_perm_b32 v138, v130, v131, s62
    s_nop 1
    s_cbranch_scc1 .La_again
    buffer_store_dwordx4 v[136:139], v10, s[36:39], s59 offen sc1
    s_nop 1
    s_branch .Lexit
.La_67:
    s_cmp_lg_u32 s94, 0
    s_cbranch_scc1 .La_again
    s_branch .Lexit
.Lm:
    s_cmp_lt_u32 s2, 54
    s_mov_b32 s14, 0xfdff7fdf
    s_cselect_b32 s14, 0x6b5ad6b5, s14
    s_mov_b32 s15, 0xff7fdff7
    s_cselect_b32 s15, 0x5ad6b5ad, s15
    s_add_u32 s30, s70, 0
    s_mov_b32 s31, s70
    v_bfe_u32 v16, v0, 1, 3
    v_mul_u32_u24 v16, 1312, v16
    v_lshrrev_b32 v12, 4, v0
    v_lshl_add_u32 v16, v12, 5, v16
    v_and_b32 v12, 1, v0
    v_lshl_add_u32 v16, v12, 4, v16
    v_add_u32 v16, 147456, v16
    s_mul_i32 s56, s3, 1312
    s_add_u32 s56, s56, 147456
    v_add_u32 v17, s56, v3
    v_add_u32 v18, s56, v4
    v_lshrrev_b32 v12, 4, v0
    v_bfe_u32 v13, v0, 1, 1
    v_lshl_add_u32 v12, v12, 1, v13
    v_bfe_u32 v13, v0, 2, 2
    v_lshl_add_u32 v20, v12, 3, v13
    v_lshlrev_b32 v20, 7, v20
    v_and_b32 v12, 3, v12
    v_lshrrev_b32 v13, 1, v13
    v_lshl_add_u32 v12, v12, 1, v13
    v_xor_b32 v12, s3, v12
    v_lshl_add_u32 v20, v12, 4, v20
    v_and_b32 v12, 1, v0
    v_lshl_add_u32 v20, v12, 3, v20
    v_bfe_u32 v23, v0, 1, 3
    v_mul_u32_u24 v23, 144, v23
    v_bfe_u32 v12, v0, 4, 1
    v_lshl_add_u32 v23, v12, 3, v23
    v_lshrrev_b32 v12, 5, v0
    v_lshl_add_u32 v23, v12, 2, v23
    v_and_b32 v12, 1, v0
    v_lshl_add_u32 v23, v12, 1, v23
    s_lshl_b32 s56, s3, 4
    s_add_u32 s56, s56, 157952
    v_add_u32 v23, s56, v23
    v_and_b32 v24, 15, v0
    v_lshlrev_b32 v24, 3, v24
    s_mul_i32 s56, s3, 144
    s_add_u32 s56, s56, 157952
    v_add_u32 v24, s56, v24
    v_add_u32 v21, 32768, v20
    s_lshl_b32 s100, s3, 10
    s_mov_b32 s99, s2
    s_cmp_ge_u32 s99, 18
    s_cbranch_scc1 .Lm_rel
    s_mul_i32 s58, s3, 1152
    s_mov_b32 s52, s24
    s_and_b32 s53, s25, 0xffff
    s_mov_b32 s54, 0x2400
    s_mov_b32 s55, 0x00020000
    buffer_load_dwordx2 v[246:247], v3, s[52:55], s58 offen
    buffer_load_dwordx2 v[248:249], v3, s[52:55], s58 offen offset:512
    buffer_load_dword v250, v4, s[52:55], s58 offen
    s_mov_b32 s48, s26
    s_and_b32 s49, s27, 0xffff
    s_mov_b32 s50, 0x3cc000
    s_mov_b32 s51, 0x00020000
    v_bfe_u32 v12, v0, 4, 1
    s_and_b32 s56, s3, 3
    s_lshl_b32 s56, s56, 1
    v_or_b32 v12, s56, v12
    v_and_b32 v19, 7, v0
    v_xor_b32 v12, v12, v19
    v_lshrrev_b32 v19, 3, v0
    v_mul_u32_u24 v19, 6912, v19
    v_lshl_add_u32 v19, v12, 4, v19
    s_mul_i32 s57, s3, 55296
    s_lshl_b32 s59, s99, 7
    s_add_u32 s57, s57, s59
    s_add_u32 m0, s100, 0
    s_add_u32 s56, s57, 0
    buffer_load_dwordx4 v19, s[48:51], s56 offen nt lds
    s_add_u32 m0, s100, 8192
    s_add_u32 s56, s57, 442368
    buffer_load_dwordx4 v19, s[48:51], s56 offen nt lds
    s_add_u32 m0, s100, 16384
    s_add_u32 s56, s57, 884736
    buffer_load_dwordx4 v19, s[48:51], s56 offen nt lds
    s_add_u32 m0, s100, 24576
    s_add_u32 s56, s57, 1327104
    buffer_load_dwordx4 v19, s[48:51], s56 offen nt lds
    s_add_u32 m0, s100, 32768
    s_add_u32 s56, s57, 1769472
    buffer_load_dwordx4 v19, s[48:51], s56 offen nt lds
    s_add_u32 m0, s100, 40960
    s_add_u32 s56, s57, 2211840
    buffer_load_dwordx4 v19, s[48:51], s56 offen nt lds
    s_add_u32 m0, s100, 49152
    s_add_u32 s56, s57, 2654208
    buffer_load_dwordx4 v19, s[48:51], s56 offen nt lds
    s_add_u32 m0, s100, 57344
    s_add_u32 s56, s57, 3096576
    buffer_load_dwordx4 v19, s[48:51], s56 offen nt lds
    s_add_u32 m0, s100, 65536
    s_add_u32 s56, s57, 3538944
    buffer_load_dwordx4 v19, s[48:51], s56 offen nt lds
    s_waitcnt lgkmcnt(0)
    s_add_u32 s34, s34, 1
    s_getreg_b32 s1, hwreg(HW_REG_XCC_ID)
    s_lshl_b32 s1, s1, 24
    s_add_u32 s1, s1, s34
    s_lshr_b32 s0, s2, 3
    s_lshl3_add_u32 s63, s64, s3
    s_lshl_b32 s63, s63, 5
    s_add_u32 s0, s0, s63
    s_lshl2_add_u32 s0, s0, 0x480000
    v_mov_b32 v30, s1
    s_mov_b64 exec, 1
    buffer_store_dword v30, v2, s[36:39], s0 offen sc1
    s_mov_b64 exec, -1
    v_lshrrev_b32 v12, 4, v0
    v_mul_u32_u24 v12, 18432, v12
    v_and_b32 v13, 15, v0
    v_lshl_add_u32 v22, v13, 4, v12
    s_mul_i32 s57, s99, 57
    s_lshr_b32 s57, s57, 9
    s_mul_i32 s58, s57, 9
    s_sub_u32 s58, s99, s58
    s_mul_i32 s59, s57, 73728
    s_lshl_b32 s58, s58, 8
    s_add_u32 s59, s59, s58
    s_mul_i32 s58, s3, 2304
    s_add_u32 s59, s59, s58
    s_add_u32 s59, s59, 0x1000
    s_mov_b32 s58, 0
    s_cmp_eq_u32 s57, 1
    s_cselect_b32 s58, 1.0, s58
    s_cmp_eq_u32 s57, 4
    s_cselect_b32 s58, 1.0, s58
    s_waitcnt vmcnt(10)
    v_lshlrev_b32 v236, 16, v246
    v_and_b32 v237, 0xffff0000, v246
    v_max_f32 v236, 0xc2ae0000, v236
    v_min_f32 v242, 0x43000000, v236
    v_mul_f32 v238, 0xbfb8aa3b, v242
    v_fma_f32 v240, v242, s98, -v238
    v_fmac_f32 v240, 0xb2a57060, v242
    v_exp_f32 v238, v238
    v_mul_f32 v240, 0x3f317218, v240
    v_fmac_f32 v238, v238, v240
    v_add_f32 v238, 1.0, v238
    v_rcp_f32 v240, v238
    s_nop 0
    v_mul_f32 v242, v236, v240
    v_fma_f32 v238, -v242, v238, v236
    v_fma_f32 v236, v238, v240, v242
    v_max_f32 v237, 0xc2ae0000, v237
    v_min_f32 v243, 0x43000000, v237
    v_mul_f32 v239, 0xbfb8aa3b, v243
    v_fma_f32 v241, v243, s98, -v239
    v_fmac_f32 v241, 0xb2a57060, v243
    v_exp_f32 v239, v239
    v_mul_f32 v241, 0x3f317218, v241
    v_fmac_f32 v239, v239, v241
    v_add_f32 v239, 1.0, v239
    v_rcp_f32 v241, v239
    s_nop 0
    v_mul_f32 v243, v237, v241
    v_fma_f32 v239, -v243, v239, v237
    v_fma_f32 v237, v239, v241, v243
    v_cvt_pk_bf16_f32 v246, v236, v237
    v_lshlrev_b32 v236, 16, v247
    v_and_b32 v237, 0xffff0000, v247
    v_max_f32 v236, 0xc2ae0000, v236
    v_min_f32 v242, 0x43000000, v236
    v_mul_f32 v238, 0xbfb8aa3b, v242
    v_fma_f32 v240, v242, s98, -v238
    v_fmac_f32 v240, 0xb2a57060, v242
    v_exp_f32 v238, v238
    v_mul_f32 v240, 0x3f317218, v240
    v_fmac_f32 v238, v238, v240
    v_add_f32 v238, 1.0, v238
    v_rcp_f32 v240, v238
    s_nop 0
    v_mul_f32 v242, v236, v240
    v_fma_f32 v238, -v242, v238, v236
    v_fma_f32 v236, v238, v240, v242
    v_max_f32 v237, 0xc2ae0000, v237
    v_min_f32 v243, 0x43000000, v237
    v_mul_f32 v239, 0xbfb8aa3b, v243
    v_fma_f32 v241, v243, s98, -v239
    v_fmac_f32 v241, 0xb2a57060, v243
    v_exp_f32 v239, v239
    v_mul_f32 v241, 0x3f317218, v241
    v_fmac_f32 v239, v239, v241
    v_add_f32 v239, 1.0, v239
    v_rcp_f32 v241, v239
    s_nop 0
    v_mul_f32 v243, v237, v241
    v_fma_f32 v239, -v243, v239, v237
    v_fma_f32 v237, v239, v241, v243
    v_cvt_pk_bf16_f32 v247, v236, v237
    v_lshlrev_b32 v236, 16, v248
    v_and_b32 v237, 0xffff0000, v248
    v_max_f32 v236, 0xc2ae0000, v236
    v_min_f32 v242, 0x43000000, v236
    v_mul_f32 v238, 0xbfb8aa3b, v242
    v_fma_f32 v240, v242, s98, -v238
    v_fmac_f32 v240, 0xb2a57060, v242
    v_exp_f32 v238, v238
    v_mul_f32 v240, 0x3f317218, v240
    v_fmac_f32 v238, v238, v240
    v_add_f32 v238, 1.0, v238
    v_rcp_f32 v240, v238
    s_nop 0
    v_mul_f32 v242, v236, v240
    v_fma_f32 v238, -v242, v238, v236
    v_fma_f32 v236, v238, v240, v242
    v_max_f32 v237, 0xc2ae0000, v237
    v_min_f32 v243, 0x43000000, v237
    v_mul_f32 v239, 0xbfb8aa3b, v243
    v_fma_f32 v241, v243, s98, -v239
    v_fmac_f32 v241, 0xb2a57060, v243
    v_exp_f32 v239, v239
    v_mul_f32 v241, 0x3f317218, v241
    v_fmac_f32 v239, v239, v241
    v_add_f32 v239, 1.0, v239
    v_rcp_f32 v241, v239
    s_nop 0
    v_mul_f32 v243, v237, v241
    v_fma_f32 v239, -v243, v239, v237
    v_fma_f32 v237, v239, v241, v243
    v_cvt_pk_bf16_f32 v248, v236, v237
    v_lshlrev_b32 v236, 16, v249
    v_and_b32 v237, 0xffff0000, v249
    v_max_f32 v236, 0xc2ae0000, v236
    v_min_f32 v242, 0x43000000, v236
    v_mul_f32 v238, 0xbfb8aa3b, v242
    v_fma_f32 v240, v242, s98, -v238
    v_fmac_f32 v240, 0xb2a57060, v242
    v_exp_f32 v238, v238
    v_mul_f32 v240, 0x3f317218, v240
    v_fmac_f32 v238, v238, v240
    v_add_f32 v238, 1.0, v238
    v_rcp_f32 v240, v238
    s_nop 0
    v_mul_f32 v242, v236, v240
    v_fma_f32 v238, -v242, v238, v236
    v_fma_f32 v236, v238, v240, v242
    v_max_f32 v237, 0xc2ae0000, v237
    v_min_f32 v243, 0x43000000, v237
    v_mul_f32 v239, 0xbfb8aa3b, v243
    v_fma_f32 v241, v243, s98, -v239
    v_fmac_f32 v241, 0xb2a57060, v243
    v_exp_f32 v239, v239
    v_mul_f32 v241, 0x3f317218, v241
    v_fmac_f32 v239, v239, v241
    v_add_f32 v239, 1.0, v239
    v_rcp_f32 v241, v239
    s_nop 0
    v_mul_f32 v243, v237, v241
    v_fma_f32 v239, -v243, v239, v237
    v_fma_f32 v237, v239, v241, v243
    v_cvt_pk_bf16_f32 v249, v236, v237
    v_lshlrev_b32 v236, 16, v250
    v_and_b32 v237, 0xffff0000, v250
    v_max_f32 v236, 0xc2ae0000, v236
    v_min_f32 v242, 0x43000000, v236
    v_mul_f32 v238, 0xbfb8aa3b, v242
    v_fma_f32 v240, v242, s98, -v238
    v_fmac_f32 v240, 0xb2a57060, v242
    v_exp_f32 v238, v238
    v_mul_f32 v240, 0x3f317218, v240
    v_fmac_f32 v238, v238, v240
    v_add_f32 v238, 1.0, v238
    v_rcp_f32 v240, v238
    s_nop 0
    v_mul_f32 v242, v236, v240
    v_fma_f32 v238, -v242, v238, v236
    v_fma_f32 v236, v238, v240, v242
    v_max_f32 v237, 0xc2ae0000, v237
    v_min_f32 v243, 0x43000000, v237
    v_mul_f32 v239, 0xbfb8aa3b, v243
    v_fma_f32 v241, v243, s98, -v239
    v_fmac_f32 v241, 0xb2a57060, v243
    v_exp_f32 v239, v239
    v_mul_f32 v241, 0x3f317218, v241
    v_fmac_f32 v239, v239, v241
    v_add_f32 v239, 1.0, v239
    v_rcp_f32 v241, v239
    s_nop 0
    v_mul_f32 v243, v237, v241
    v_fma_f32 v239, -v243, v239, v237
    v_fma_f32 v237, v239, v241, v243
    v_cvt_pk_bf16_f32 v250, v236, v237
    ds_write_b64 v17, v[246:247] offset:0
    ds_write_b64 v17, v[248:249] offset:512
    ds_write_b32 v18, v250 offset:0
    s_waitcnt vmcnt(1)
    s_waitcnt lgkmcnt(0)
    s_barrier
    ds_read_b64_tr_b16 v[160:161], v20 offset:0
    ds_read_b64_tr_b16 v[162:163], v20 offset:512
    ds_read_b64_tr_b16 v[164:165], v20 offset:8192
    ds_read_b64_tr_b16 v[166:167], v20 offset:8704
    ds_read_b64_tr_b16 v[168:169], v20 offset:16384
    ds_read_b64_tr_b16 v[170:171], v20 offset:16896
    ds_read_b64_tr_b16 v[172:173], v20 offset:24576
    ds_read_b64_tr_b16 v[174:175], v20 offset:25088
    ds_read_b64_tr_b16 v[176:177], v21 offset:0
    ds_read_b64_tr_b16 v[178:179], v21 offset:512
    ds_read_b64_tr_b16 v[180:181], v21 offset:8192
    ds_read_b64_tr_b16 v[182:183], v21 offset:8704
    ds_read_b64_tr_b16 v[184:185], v21 offset:16384
    ds_read_b64_tr_b16 v[186:187], v21 offset:16896
    ds_read_b64_tr_b16 v[188:189], v21 offset:24576
    ds_read_b64_tr_b16 v[190:191], v21 offset:25088
    ds_read_b64_tr_b16 v[192:193], v21 offset:32768
    ds_read_b64_tr_b16 v[194:195], v21 offset:33280
    ds_read_b128 v[196:199], v16 offset:0
    ds_read_b128 v[200:203], v16 offset:128
    ds_read_b128 v[204:207], v16 offset:256
    ds_read_b128 v[208:211], v16 offset:384
    ds_read_b128 v[212:215], v16 offset:512
    ds_read_b128 v[216:219], v16 offset:640
    ds_read_b128 v[220:223], v16 offset:768
    ds_read_b128 v[224:227], v16 offset:896
    ds_read_b128 v[228:231], v16 offset:1024
    s_waitcnt lgkmcnt(8)
    v_mfma_f32_16x16x32_bf16 v[232:235], v[160:163], v[196:199], 0
    s_waitcnt lgkmcnt(7)
    v_mfma_f32_16x16x32_bf16 v[232:235], v[164:167], v[200:203], v[232:235]
    s_waitcnt lgkmcnt(6)
    v_mfma_f32_16x16x32_bf16 v[232:235], v[168:171], v[204:207], v[232:235]
    s_waitcnt lgkmcnt(5)
    v_mfma_f32_16x16x32_bf16 v[232:235], v[172:175], v[208:211], v[232:235]
    s_waitcnt lgkmcnt(4)
    v_mfma_f32_16x16x32_bf16 v[232:235], v[176:179], v[212:215], v[232:235]
    s_waitcnt lgkmcnt(3)
    v_mfma_f32_16x16x32_bf16 v[232:235], v[180:183], v[216:219], v[232:235]
    s_waitcnt lgkmcnt(2)
    v_mfma_f32_16x16x32_bf16 v[232:235], v[184:187], v[220:223], v[232:235]
    s_waitcnt lgkmcnt(1)
    v_mfma_f32_16x16x32_bf16 v[232:235], v[188:191], v[224:227], v[232:235]
    s_waitcnt lgkmcnt(0)
    v_mfma_f32_16x16x32_bf16 v[232:235], v[192:195], v[228:231], v[232:235]
    s_nop 7
    v_permlane32_swap_b32 v232, v234
    v_permlane32_swap_b32 v233, v235
    v_cndmask_b32 v233, v233, v234, s[96:97]
    v_cndmask_b32 v232, v232, v235, s[96:97]
    s_nop 1
    v_add_f32_dpp v236, v233, v232 quad_perm:[1,0,3,2] row_mask:0xf bank_mask:0xf
    v_cvt_pk_bf16_f32 v236, v236, v236
    v_lshlrev_b32 v236, 16, v236
    v_add_f32 v236, s58, v236
    v_cvt_pk_bf16_f32 v236, v236, v236
    ds_write_b16 v23, v236
    v_mov_b32 v243, s34
    s_waitcnt lgkmcnt(0)
    s_barrier
    ds_read2_b32 v[244:245], v24 offset1:1
    v_mov_b32 v241, s34
    s_waitcnt lgkmcnt(0)
    v_mov_b32 v240, v244
    v_mov_b32 v242, v245
    s_bfm_b64 exec, 32, 0
    buffer_store_dwordx4 v[240:243], v22, s[36:39], s59 offen sc1
    s_mov_b64 exec, -1
    s_add_u32 s63, s69, 32768
    buffer_load_dwordx4 v[96:99], v1, s[40:43], s63 offen nt
    s_add_u32 s63, s69, 40960
    buffer_load_dwordx4 v[100:103], v1, s[40:43], s63 offen nt
    s_add_u32 s63, s69, 49152
    buffer_load_dwordx4 v[128:131], v1, s[40:43], s63 offen nt
    s_add_u32 s63, s69, 57344
    buffer_load_dwordx4 v[132:135], v1, s[40:43], s63 offen nt
    s_waitcnt vmcnt(3)
    s_add_u32 s63, s69, 131072
    buffer_load_dwordx4 v[40:43], v1, s[40:43], s63 offen nt
    s_waitcnt vmcnt(3)
    s_add_u32 s63, s69, 139264
    buffer_load_dwordx4 v[44:47], v1, s[40:43], s63 offen nt
    s_waitcnt vmcnt(3)
    s_add_u32 s63, s69, 147456
    buffer_load_dwordx4 v[72:75], v1, s[40:43], s63 offen nt
    s_waitcnt vmcnt(3)
    s_add_u32 s63, s69, 155648
    buffer_load_dwordx4 v[76:79], v1, s[40:43], s63 offen nt
    s_waitcnt vmcnt(3)
    s_add_u32 s63, s69, 163840
    buffer_load_dwordx4 v[104:107], v1, s[40:43], s63 offen nt
    s_waitcnt vmcnt(3)
    s_add_u32 s63, s69, 172032
    buffer_load_dwordx4 v[108:111], v1, s[40:43], s63 offen nt
    s_waitcnt vmcnt(3)
    s_add_u32 s63, s69, 180224
    buffer_load_dwordx4 v[136:139], v1, s[40:43], s63 offen nt
    s_waitcnt vmcnt(3)
    s_add_u32 s63, s69, 188416
    buffer_load_dwordx4 v[140:143], v1, s[40:43], s63 offen nt
    s_waitcnt vmcnt(3)
    s_add_u32 s63, s69, 262144
    buffer_load_dwordx4 v[48:51], v1, s[40:43], s63 offen nt
    s_waitcnt vmcnt(3)
    s_add_u32 s63, s69, 270336
    buffer_load_dwordx4 v[52:55], v1, s[40:43], s63 offen nt
    s_branch .Le_done
.Lm_rel:
    s_waitcnt vmcnt(3)
    s_bitcmp1_b64 s[14:15], 4
    s_cbranch_scc0 1
    s_waitcnt vmcnt(2)
    s_add_u32 s63, s69, 32768
    buffer_load_dwordx4 v[96:99], v1, s[40:43], s63 offen nt
    s_waitcnt vmcnt(3)
    s_bitcmp1_b64 s[14:15], 5
    s_cbranch_scc0 1
    s_waitcnt vmcnt(2)
    s_add_u32 s63, s69, 40960
    buffer_load_dwordx4 v[100:103], v1, s[40:43], s63 offen nt
    s_waitcnt vmcnt(3)
    s_bitcmp1_b64 s[14:15], 6
    s_cbranch_scc0 1
    s_waitcnt vmcnt(2)
    s_add_u32 s63, s69, 49152
    buffer_load_dwordx4 v[128:131], v1, s[40:43], s63 offen nt
    s_waitcnt vmcnt(3)
    s_bitcmp1_b64 s[14:15], 7
    s_cbranch_scc0 1
    s_waitcnt vmcnt(2)
    s_add_u32 s63, s69, 57344
    buffer_load_dwordx4 v[132:135], v1, s[40:43], s63 offen nt
    s_waitcnt vmcnt(3)
    s_bitcmp1_b64 s[14:15], 8
    s_cbranch_scc0 1
    s_waitcnt vmcnt(2)
    s_add_u32 s63, s69, 131072
    buffer_load_dwordx4 v[40:43], v1, s[40:43], s63 offen nt
    s_waitcnt vmcnt(3)
    s_bitcmp1_b64 s[14:15], 9
    s_cbranch_scc0 1
    s_waitcnt vmcnt(2)
    s_add_u32 s63, s69, 139264
    buffer_load_dwordx4 v[44:47], v1, s[40:43], s63 offen nt
    s_waitcnt lgkmcnt(0)
    s_add_u32 s34, s34, 1
    s_getreg_b32 s1, hwreg(HW_REG_XCC_ID)
    s_lshl_b32 s1, s1, 24
    s_add_u32 s1, s1, s34
    s_lshr_b32 s0, s2, 3
    s_lshl3_add_u32 s63, s64, s3
    s_lshl_b32 s63, s63, 5
    s_add_u32 s0, s0, s63
    s_lshl2_add_u32 s0, s0, 0x480000
    v_mov_b32 v30, s1
    s_mov_b64 exec, 1
    buffer_store_dword v30, v2, s[36:39], s0 offen sc1
    s_mov_b64 exec, -1
    s_cmp_lt_u32 s99, 54
    s_cbranch_scc1 .Lmr_part
    s_waitcnt vmcnt(4)
    s_bitcmp1_b64 s[14:15], 10
    s_cbranch_scc0 1
    s_waitcnt vmcnt(3)
    s_add_u32 s63, s69, 147456
    buffer_load_dwordx4 v[72:75], v1, s[40:43], s63 offen nt
    s_waitcnt vmcnt(4)
    s_bitcmp1_b64 s[14:15], 11
    s_cbranch_scc0 1
    s_waitcnt vmcnt(3)
    s_add_u32 s63, s69, 155648
    buffer_load_dwordx4 v[76:79], v1, s[40:43], s63 offen nt
    s_waitcnt vmcnt(4)
    s_bitcmp1_b64 s[14:15], 12
    s_cbranch_scc0 1
    s_waitcnt vmcnt(3)
    s_add_u32 s63, s69, 163840
    buffer_load_dwordx4 v[104:107], v1, s[40:43], s63 offen nt
    s_waitcnt vmcnt(4)
    s_bitcmp1_b64 s[14:15], 13
    s_cbranch_scc0 1
    s_waitcnt vmcnt(2)
    s_add_u32 s63, s69, 172032
    buffer_load_dwordx4 v[108:111], v1, s[40:43], s63 offen nt
    s_waitcnt vmcnt(3)
    s_bitcmp1_b64 s[14:15], 14
    s_cbranch_scc0 1
    s_waitcnt vmcnt(2)
    s_add_u32 s63, s69, 180224
    buffer_load_dwordx4 v[136:139], v1, s[40:43], s63 offen nt
    s_waitcnt vmcnt(3)
    s_bitcmp1_b64 s[14:15], 15
    s_cbranch_scc0 1
    s_waitcnt vmcnt(2)
    s_add_u32 s63, s69, 188416
    buffer_load_dwordx4 v[140:143], v1, s[40:43], s63 offen nt
    s_waitcnt vmcnt(3)
    s_bitcmp1_b64 s[14:15], 16
    s_cbranch_scc0 1
    s_waitcnt vmcnt(2)
    s_add_u32 s63, s69, 262144
    buffer_load_dwordx4 v[48:51], v1, s[40:43], s63 offen nt
    s_waitcnt vmcnt(3)
    s_bitcmp1_b64 s[14:15], 17
    s_cbranch_scc0 1
    s_waitcnt vmcnt(2)
    s_add_u32 s63, s69, 270336
    buffer_load_dwordx4 v[52:55], v1, s[40:43], s63 offen nt
    s_branch .Le_done
.Lmr_part:
    s_mul_i32 s58, s3, 1152
    s_mov_b32 s52, s24
    s_and_b32 s53, s25, 0xffff
    s_mov_b32 s54, 0x2400
    s_mov_b32 s55, 0x00020000
    buffer_load_dwordx2 v[246:247], v3, s[52:55], s58 offen
    buffer_load_dwordx2 v[248:249], v3, s[52:55], s58 offen offset:512
    buffer_load_dword v250, v4, s[52:55], s58 offen
    s_mov_b32 s48, s26
    s_and_b32 s49, s27, 0xffff
    s_mov_b32 s50, 0x3cc000
    s_mov_b32 s51, 0x00020000
    v_bfe_u32 v12, v0, 4, 1
    s_and_b32 s56, s3, 3
    s_lshl_b32 s56, s56, 1
    v_or_b32 v12, s56, v12
    v_and_b32 v19, 7, v0
    v_xor_b32 v12, v12, v19
    v_lshrrev_b32 v19, 3, v0
    v_mul_u32_u24 v19, 6912, v19
    v_lshl_add_u32 v19, v12, 4, v19
    s_mul_i32 s57, s3, 55296
    s_lshl_b32 s59, s99, 7
    s_add_u32 s57, s57, s59
    s_add_u32 m0, s100, 0
    s_add_u32 s56, s57, 0
    buffer_load_dwordx4 v19, s[48:51], s56 offen nt lds
    s_add_u32 m0, s100, 8192
    s_add_u32 s56, s57, 442368
    buffer_load_dwordx4 v19, s[48:51], s56 offen nt lds
    s_add_u32 m0, s100, 16384
    s_add_u32 s56, s57, 884736
    buffer_load_dwordx4 v19, s[48:51], s56 offen nt lds
    s_add_u32 m0, s100, 24576
    s_add_u32 s56, s57, 1327104
    buffer_load_dwordx4 v19, s[48:51], s56 offen nt lds
    s_add_u32 m0, s100, 32768
    s_add_u32 s56, s57, 1769472
    buffer_load_dwordx4 v19, s[48:51], s56 offen nt lds
    s_add_u32 m0, s100, 40960
    s_add_u32 s56, s57, 2211840
    buffer_load_dwordx4 v19, s[48:51], s56 offen nt lds
    s_add_u32 m0, s100, 49152
    s_add_u32 s56, s57, 2654208
    buffer_load_dwordx4 v19, s[48:51], s56 offen nt lds
    s_add_u32 m0, s100, 57344
    s_add_u32 s56, s57, 3096576
    buffer_load_dwordx4 v19, s[48:51], s56 offen nt lds
    s_add_u32 m0, s100, 65536
    s_add_u32 s56, s57, 3538944
    buffer_load_dwordx4 v19, s[48:51], s56 offen nt lds
    v_lshrrev_b32 v12, 4, v0
    v_mul_u32_u24 v12, 18432, v12
    v_and_b32 v13, 15, v0
    v_lshl_add_u32 v22, v13, 4, v12
    s_mul_i32 s57, s99, 57
    s_lshr_b32 s57, s57, 9
    s_mul_i32 s58, s57, 9
    s_sub_u32 s58, s99, s58
    s_mul_i32 s59, s57, 73728
    s_lshl_b32 s58, s58, 8
    s_add_u32 s59, s59, s58
    s_mul_i32 s58, s3, 2304
    s_add_u32 s59, s59, s58
    s_add_u32 s59, s59, 0x1000
    s_mov_b32 s58, 0
    s_cmp_eq_u32 s57, 1
    s_cselect_b32 s58, 1.0, s58
    s_cmp_eq_u32 s57, 4
    s_cselect_b32 s58, 1.0, s58
    s_waitcnt vmcnt(9)
    v_lshlrev_b32 v236, 16, v246
    v_and_b32 v237, 0xffff0000, v246
    v_max_f32 v236, 0xc2ae0000, v236
    v_min_f32 v242, 0x43000000, v236
    v_mul_f32 v238, 0xbfb8aa3b, v242
    v_fma_f32 v240, v242, s98, -v238
    v_fmac_f32 v240, 0xb2a57060, v242
    v_exp_f32 v238, v238
    v_mul_f32 v240, 0x3f317218, v240
    v_fmac_f32 v238, v238, v240
    v_add_f32 v238, 1.0, v238
    v_rcp_f32 v240, v238
    s_nop 0
    v_mul_f32 v242, v236, v240
    v_fma_f32 v238, -v242, v238, v236
    v_fma_f32 v236, v238, v240, v242
    v_max_f32 v237, 0xc2ae0000, v237
    v_min_f32 v243, 0x43000000, v237
    v_mul_f32 v239, 0xbfb8aa3b, v243
    v_fma_f32 v241, v243, s98, -v239
    v_fmac_f32 v241, 0xb2a57060, v243
    v_exp_f32 v239, v239
    v_mul_f32 v241, 0x3f317218, v241
    v_fmac_f32 v239, v239, v241
    v_add_f32 v239, 1.0, v239
    v_rcp_f32 v241, v239
    s_nop 0
    v_mul_f32 v243, v237, v241
    v_fma_f32 v239, -v243, v239, v237
    v_fma_f32 v237, v239, v241, v243
    v_cvt_pk_bf16_f32 v246, v236, v237
    v_lshlrev_b32 v236, 16, v247
    v_and_b32 v237, 0xffff0000, v247
    v_max_f32 v236, 0xc2ae0000, v236
    v_min_f32 v242, 0x43000000, v236
    v_mul_f32 v238, 0xbfb8aa3b, v242
    v_fma_f32 v240, v242, s98, -v238
    v_fmac_f32 v240, 0xb2a57060, v242
    v_exp_f32 v238, v238
    v_mul_f32 v240, 0x3f317218, v240
    v_fmac_f32 v238, v238, v240
    v_add_f32 v238, 1.0, v238
    v_rcp_f32 v240, v238
    s_nop 0
    v_mul_f32 v242, v236, v240
    v_fma_f32 v238, -v242, v238, v236
    v_fma_f32 v236, v238, v240, v242
    v_max_f32 v237, 0xc2ae0000, v237
    v_min_f32 v243, 0x43000000, v237
    v_mul_f32 v239, 0xbfb8aa3b, v243
    v_fma_f32 v241, v243, s98, -v239
    v_fmac_f32 v241, 0xb2a57060, v243
    v_exp_f32 v239, v239
    v_mul_f32 v241, 0x3f317218, v241
    v_fmac_f32 v239, v239, v241
    v_add_f32 v239, 1.0, v239
    v_rcp_f32 v241, v239
    s_nop 0
    v_mul_f32 v243, v237, v241
    v_fma_f32 v239, -v243, v239, v237
    v_fma_f32 v237, v239, v241, v243
    v_cvt_pk_bf16_f32 v247, v236, v237
    v_lshlrev_b32 v236, 16, v248
    v_and_b32 v237, 0xffff0000, v248
    v_max_f32 v236, 0xc2ae0000, v236
    v_min_f32 v242, 0x43000000, v236
    v_mul_f32 v238, 0xbfb8aa3b, v242
    v_fma_f32 v240, v242, s98, -v238
    v_fmac_f32 v240, 0xb2a57060, v242
    v_exp_f32 v238, v238
    v_mul_f32 v240, 0x3f317218, v240
    v_fmac_f32 v238, v238, v240
    v_add_f32 v238, 1.0, v238
    v_rcp_f32 v240, v238
    s_nop 0
    v_mul_f32 v242, v236, v240
    v_fma_f32 v238, -v242, v238, v236
    v_fma_f32 v236, v238, v240, v242
    v_max_f32 v237, 0xc2ae0000, v237
    v_min_f32 v243, 0x43000000, v237
    v_mul_f32 v239, 0xbfb8aa3b, v243
    v_fma_f32 v241, v243, s98, -v239
    v_fmac_f32 v241, 0xb2a57060, v243
    v_exp_f32 v239, v239
    v_mul_f32 v241, 0x3f317218, v241
    v_fmac_f32 v239, v239, v241
    v_add_f32 v239, 1.0, v239
    v_rcp_f32 v241, v239
    s_nop 0
    v_mul_f32 v243, v237, v241
    v_fma_f32 v239, -v243, v239, v237
    v_fma_f32 v237, v239, v241, v243
    v_cvt_pk_bf16_f32 v248, v236, v237
    v_lshlrev_b32 v236, 16, v249
    v_and_b32 v237, 0xffff0000, v249
    v_max_f32 v236, 0xc2ae0000, v236
    v_min_f32 v242, 0x43000000, v236
    v_mul_f32 v238, 0xbfb8aa3b, v242
    v_fma_f32 v240, v242, s98, -v238
    v_fmac_f32 v240, 0xb2a57060, v242
    v_exp_f32 v238, v238
    v_mul_f32 v240, 0x3f317218, v240
    v_fmac_f32 v238, v238, v240
    v_add_f32 v238, 1.0, v238
    v_rcp_f32 v240, v238
    s_nop 0
    v_mul_f32 v242, v236, v240
    v_fma_f32 v238, -v242, v238, v236
    v_fma_f32 v236, v238, v240, v242
    v_max_f32 v237, 0xc2ae0000, v237
    v_min_f32 v243, 0x43000000, v237
    v_mul_f32 v239, 0xbfb8aa3b, v243
    v_fma_f32 v241, v243, s98, -v239
    v_fmac_f32 v241, 0xb2a57060, v243
    v_exp_f32 v239, v239
    v_mul_f32 v241, 0x3f317218, v241
    v_fmac_f32 v239, v239, v241
    v_add_f32 v239, 1.0, v239
    v_rcp_f32 v241, v239
    s_nop 0
    v_mul_f32 v243, v237, v241
    v_fma_f32 v239, -v243, v239, v237
    v_fma_f32 v237, v239, v241, v243
    v_cvt_pk_bf16_f32 v249, v236, v237
    v_lshlrev_b32 v236, 16, v250
    v_and_b32 v237, 0xffff0000, v250
    v_max_f32 v236, 0xc2ae0000, v236
    v_min_f32 v242, 0x43000000, v236
    v_mul_f32 v238, 0xbfb8aa3b, v242
    v_fma_f32 v240, v242, s98, -v238
    v_fmac_f32 v240, 0xb2a57060, v242
    v_exp_f32 v238, v238
    v_mul_f32 v240, 0x3f317218, v240
    v_fmac_f32 v238, v238, v240
    v_add_f32 v238, 1.0, v238
    v_rcp_f32 v240, v238
    s_nop 0
    v_mul_f32 v242, v236, v240
    v_fma_f32 v238, -v242, v238, v236
    v_fma_f32 v236, v238, v240, v242
    v_max_f32 v237, 0xc2ae0000, v237
    v_min_f32 v243, 0x43000000, v237
    v_mul_f32 v239, 0xbfb8aa3b, v243
    v_fma_f32 v241, v243, s98, -v239
    v_fmac_f32 v241, 0xb2a57060, v243
    v_exp_f32 v239, v239
    v_mul_f32 v241, 0x3f317218, v241
    v_fmac_f32 v239, v239, v241
    v_add_f32 v239, 1.0, v239
    v_rcp_f32 v241, v239
    s_nop 0
    v_mul_f32 v243, v237, v241
    v_fma_f32 v239, -v243, v239, v237
    v_fma_f32 v237, v239, v241, v243
    v_cvt_pk_bf16_f32 v250, v236, v237
    ds_write_b64 v17, v[246:247] offset:0
    ds_write_b64 v17, v[248:249] offset:512
    ds_write_b32 v18, v250 offset:0
    s_waitcnt vmcnt(3)
    s_add_u32 s63, s69, 147456
    buffer_load_dwordx4 v[72:75], v1, s[40:43], s63 offen nt
    s_waitcnt vmcnt(3)
    s_add_u32 s63, s69, 155648
    buffer_load_dwordx4 v[76:79], v1, s[40:43], s63 offen nt
    s_waitcnt vmcnt(3)
    s_add_u32 s63, s69, 163840
    buffer_load_dwordx4 v[104:107], v1, s[40:43], s63 offen nt
    s_waitcnt vmcnt(3)
    s_add_u32 s63, s69, 172032
    buffer_load_dwordx4 v[108:111], v1, s[40:43], s63 offen nt
    s_waitcnt vmcnt(3)
    s_add_u32 s63, s69, 180224
    buffer_load_dwordx4 v[136:139], v1, s[40:43], s63 offen nt
    s_waitcnt vmcnt(3)
    s_add_u32 s63, s69, 188416
    buffer_load_dwordx4 v[140:143], v1, s[40:43], s63 offen nt
    s_waitcnt vmcnt(3)
    s_add_u32 s63, s69, 262144
    buffer_load_dwordx4 v[48:51], v1, s[40:43], s63 offen nt
    s_waitcnt vmcnt(3)
    s_add_u32 s63, s69, 270336
    buffer_load_dwordx4 v[52:55], v1, s[40:43], s63 offen nt
    s_waitcnt lgkmcnt(0)
    s_barrier
    ds_read_b64_tr_b16 v[160:161], v20 offset:0
    ds_read_b64_tr_b16 v[162:163], v20 offset:512
    ds_read_b64_tr_b16 v[164:165], v20 offset:8192
    ds_read_b64_tr_b16 v[166:167], v20 offset:8704
    ds_read_b64_tr_b16 v[168:169], v20 offset:16384
    ds_read_b64_tr_b16 v[170:171], v20 offset:16896
    ds_read_b64_tr_b16 v[172:173], v20 offset:24576
    ds_read_b64_tr_b16 v[174:175], v20 offset:25088
    ds_read_b64_tr_b16 v[176:177], v21 offset:0
    ds_read_b64_tr_b16 v[178:179], v21 offset:512
    ds_read_b64_tr_b16 v[180:181], v21 offset:8192
    ds_read_b64_tr_b16 v[182:183], v21 offset:8704
    ds_read_b64_tr_b16 v[184:185], v21 offset:16384
    ds_read_b64_tr_b16 v[186:187], v21 offset:16896
    ds_read_b64_tr_b16 v[188:189], v21 offset:24576
    ds_read_b64_tr_b16 v[190:191], v21 offset:25088
    ds_read_b64_tr_b16 v[192:193], v21 offset:32768
    ds_read_b64_tr_b16 v[194:195], v21 offset:33280
    ds_read_b128 v[196:199], v16 offset:0
    ds_read_b128 v[200:203], v16 offset:128
    ds_read_b128 v[204:207], v16 offset:256
    ds_read_b128 v[208:211], v16 offset:384
    ds_read_b128 v[212:215], v16 offset:512
    ds_read_b128 v[216:219], v16 offset:640
    ds_read_b128 v[220:223], v16 offset:768
    ds_read_b128 v[224:227], v16 offset:896
    ds_read_b128 v[228:231], v16 offset:1024
    s_waitcnt lgkmcnt(8)
    v_mfma_f32_16x16x32_bf16 v[232:235], v[160:163], v[196:199], 0
    s_waitcnt lgkmcnt(7)
    v_mfma_f32_16x16x32_bf16 v[232:235], v[164:167], v[200:203], v[232:235]
    s_waitcnt lgkmcnt(6)
    v_mfma_f32_16x16x32_bf16 v[232:235], v[168:171], v[204:207], v[232:235]
    s_waitcnt lgkmcnt(5)
    v_mfma_f32_16x16x32_bf16 v[232:235], v[172:175], v[208:211], v[232:235]
    s_waitcnt lgkmcnt(4)
    v_mfma_f32_16x16x32_bf16 v[232:235], v[176:179], v[212:215], v[232:235]
    s_waitcnt lgkmcnt(3)
    v_mfma_f32_16x16x32_bf16 v[232:235], v[180:183], v[216:219], v[232:235]
    s_waitcnt lgkmcnt(2)
    v_mfma_f32_16x16x32_bf16 v[232:235], v[184:187], v[220:223], v[232:235]
    s_waitcnt lgkmcnt(1)
    v_mfma_f32_16x16x32_bf16 v[232:235], v[188:191], v[224:227], v[232:235]
    s_waitcnt lgkmcnt(0)
    v_mfma_f32_16x16x32_bf16 v[232:235], v[192:195], v[228:231], v[232:235]
    s_nop 7
    v_permlane32_swap_b32 v232, v234
    v_permlane32_swap_b32 v233, v235
    v_cndmask_b32 v233, v233, v234, s[96:97]
    v_cndmask_b32 v232, v232, v235, s[96:97]
    s_nop 1
    v_add_f32_dpp v236, v233, v232 quad_perm:[1,0,3,2] row_mask:0xf bank_mask:0xf
    v_cvt_pk_bf16_f32 v236, v236, v236
    v_lshlrev_b32 v236, 16, v236
    v_add_f32 v236, s58, v236
    v_cvt_pk_bf16_f32 v236, v236, v236
    ds_write_b16 v23, v236
    v_mov_b32 v243, s34
    s_waitcnt lgkmcnt(0)
    s_barrier
    ds_read2_b32 v[244:245], v24 offset1:1
    v_mov_b32 v241, s34
    s_waitcnt lgkmcnt(0)
    v_mov_b32 v240, v244
    v_mov_b32 v242, v245
    s_bfm_b64 exec, 16, 0
    buffer_store_dwordx4 v[240:243], v22, s[36:39], s59 offen sc1
    s_mov_b64 exec, -1
.Le_done:
    v_and_b32 v8, 1, v0
    v_lshlrev_b32 v8, 8, v8
    v_and_b32 v9, 0x3c, v0
    v_lshl_add_u32 v9, v9, 2, v8
    v_lshlrev_b32 v7, 1, v9
    v_and_b32 v9, 0x3c, v0
    v_lshrrev_b32 v8, 4, v8
    v_lshl_add_u32 v9, v9, 3, v8
    s_lshl_b32 s58, s66, 14
    s_lshl_b32 s59, s67, 10
    s_add_u32 s58, s58, s59
    s_add_u32 s58, s58, 0x70000
    s_lshl4_add_u32 s59, s66, s67
    s_lshl_b32 s59, s59, 11
    s_add_u32 s59, s59, 0x430000
    s_waitcnt vmcnt(3)
    s_bitcmp1_b64 s[14:15], 18
    s_cbranch_scc0 1
    s_waitcnt vmcnt(2)
    s_add_u32 s63, s69, 278528
    buffer_load_dwordx4 v[80:83], v1, s[40:43], s63 offen nt
    v_and_b32 v157, 7, v0
    v_lshlrev_b32 v157, 2, v157
    s_mov_b32 s63, 0x4a1000
    buffer_load_dword v156, v157, s[36:39], s63 offen
    s_memrealtime s[8:9]
    s_waitcnt lgkmcnt(0)
    s_sub_u32 s8, s8, s30
    s_cmpk_ge_u32 s8, 930
    s_cbranch_scc1 .ap_53
    s_waitcnt vmcnt(5)
    s_cmpk_ge_u32 s8, 830
    s_cbranch_scc1 .ap_53
    s_waitcnt vmcnt(4)
    s_bitcmp1_b64 s[14:15], 19
    s_cbranch_scc0 1
    s_waitcnt vmcnt(3)
    s_cmpk_ge_u32 s8, 710
    s_cbranch_scc1 .ap_53
    s_waitcnt vmcnt(2)
.ap_53:
    s_add_u32 s63, s69, 286720
    buffer_load_dwordx4 v[84:87], v1, s[40:43], s63 offen nt
    s_memrealtime s[8:9]
    s_waitcnt lgkmcnt(0)
    s_sub_u32 s8, s8, s30
    s_cmpk_ge_u32 s8, 976
    s_cbranch_scc1 .ap_54
    s_waitcnt vmcnt(6)
    s_cmpk_ge_u32 s8, 876
    s_cbranch_scc1 .ap_54
    s_waitcnt vmcnt(4)
    s_bitcmp1_b64 s[14:15], 20
    s_cbranch_scc0 1
    s_waitcnt vmcnt(3)
    s_cmpk_ge_u32 s8, 756
    s_cbranch_scc1 .ap_54
    s_waitcnt vmcnt(2)
.ap_54:
    s_add_u32 s63, s69, 294912
    buffer_load_dwordx4 v[112:115], v1, s[40:43], s63 offen nt
    s_memrealtime s[8:9]
    s_waitcnt lgkmcnt(0)
    s_sub_u32 s8, s8, s30
    s_cmpk_ge_u32 s8, 1023
    s_cbranch_scc1 .ap_55
    s_waitcnt vmcnt(6)
    s_cmpk_ge_u32 s8, 923
    s_cbranch_scc1 .ap_55
    s_waitcnt vmcnt(4)
    s_bitcmp1_b64 s[14:15], 21
    s_cbranch_scc0 1
    s_waitcnt vmcnt(3)
    s_cmpk_ge_u32 s8, 803
    s_cbranch_scc1 .ap_55
    s_waitcnt vmcnt(1)
.ap_55:
    s_add_u32 s63, s69, 303104
    buffer_load_dwordx4 v[116:119], v1, s[40:43], s63 offen nt
    s_memrealtime s[8:9]
    s_waitcnt lgkmcnt(0)
    s_sub_u32 s8, s8, s30
    s_cmpk_ge_u32 s8, 1070
    s_cbranch_scc1 .ap_56
    s_waitcnt vmcnt(6)
    s_cmpk_ge_u32 s8, 970
    s_cbranch_scc1 .ap_56
    s_waitcnt vmcnt(4)
    s_bitcmp1_b64 s[14:15], 22
    s_cbranch_scc0 1
    s_waitcnt vmcnt(2)
    s_cmpk_ge_u32 s8, 850
    s_cbranch_scc1 .ap_56
    s_waitcnt vmcnt(1)
.ap_56:
    s_add_u32 s63, s69, 311296
    buffer_load_dwordx4 v[144:147], v1, s[40:43], s63 offen nt
    s_waitcnt vmcnt(4)
    s_sub_u32 s63, s70, 300
    v_subrev_u32 v156, s63, v156
    v_mov_b32 v157, 600
    v_cmp_lt_u32 s[8:9], v156, v157
    v_add_u32_dpp v156, v156, v156 quad_perm:[1,0,3,2] row_mask:0xf bank_mask:0xf
    s_nop 1
    v_add_u32_dpp v156, v156, v156 quad_perm:[2,3,0,1] row_mask:0xf bank_mask:0xf
    s_nop 1
    v_add_u32_dpp v156, v156, v156 row_ror:4 row_mask:0xf bank_mask:0xf
    s_nop 0
    v_readfirstlane_b32 s63, v156
    s_cmp_eq_u64 s[8:9], -1
    s_nop 3
    s_cbranch_scc0 .et_57
    s_lshr_b32 s63, s63, 3
    s_sub_u32 s63, s63, 300
    s_add_u32 s30, s30, s63
    s_add_u32 s31, s31, s63
.et_57:
    s_memrealtime s[8:9]
    s_waitcnt lgkmcnt(0)
    s_sub_u32 s8, s8, s30
    s_cmpk_ge_u32 s8, 1116
    s_cbranch_scc1 .ap_58
    s_waitcnt vmcnt(4)
    s_cmpk_ge_u32 s8, 1016
    s_cbranch_scc1 .ap_58
    s_waitcnt vmcnt(3)
    s_bitcmp1_b64 s[14:15], 23
    s_cbranch_scc0 1
    s_waitcnt vmcnt(2)
    s_cmpk_ge_u32 s8, 896
    s_cbranch_scc1 .ap_58
    s_waitcnt vmcnt(1)
.ap_58:
    s_add_u32 s63, s69, 319488
    buffer_load_dwordx4 v[148:151], v1, s[40:43], s63 offen nt
    s_memrealtime s[8:9]
    s_waitcnt lgkmcnt(0)
    s_sub_u32 s8, s8, s30
    s_cmpk_ge_u32 s8, 1163
    s_cbranch_scc1 .ap_59
    s_waitcnt vmcnt(5)
    s_cmpk_ge_u32 s8, 1063
    s_cbranch_scc1 .ap_59
    s_waitcnt vmcnt(3)
    s_bitcmp1_b64 s[14:15], 24
    s_cbranch_scc0 1
    s_waitcnt vmcnt(2)
    s_cmpk_ge_u32 s8, 943
    s_cbranch_scc1 .ap_59
    s_waitcnt vmcnt(1)
.ap_59:
    s_add_u32 s63, s69, 393216
    buffer_load_dwordx4 v[56:59], v1, s[40:43], s63 offen nt
    s_memrealtime s[8:9]
    s_waitcnt lgkmcnt(0)
    s_sub_u32 s8, s8, s30
    s_cmpk_ge_u32 s8, 1210
    s_cbranch_scc1 .ap_60
    s_waitcnt vmcnt(5)
    s_cmpk_ge_u32 s8, 1110
    s_cbranch_scc1 .ap_60
    s_waitcnt vmcnt(3)
    s_bitcmp1_b64 s[14:15], 25
    s_cbranch_scc0 1
    s_waitcnt vmcnt(2)
    s_cmpk_ge_u32 s8, 990
    s_cbranch_scc1 .ap_60
    s_waitcnt vmcnt(1)
.ap_60:
    s_add_u32 s63, s69, 401408
    buffer_load_dwordx4 v[60:63], v1, s[40:43], s63 offen nt
    s_memrealtime s[8:9]
    s_waitcnt lgkmcnt(0)
    s_sub_u32 s8, s8, s30
    s_cmpk_ge_u32 s8, 1238
    s_cbranch_scc1 .ap_61
    s_waitcnt vmcnt(5)
    s_cmpk_ge_u32 s8, 1138
    s_cbranch_scc1 .ap_61
    s_waitcnt vmcnt(3)
    s_bitcmp1_b64 s[14:15], 26
    s_cbranch_scc0 1
    s_waitcnt vmcnt(2)
    s_cmpk_ge_u32 s8, 1018
    s_cbranch_scc1 .ap_61
    s_waitcnt vmcnt(1)
.ap_61:
    s_add_u32 s63, s69, 409600
    buffer_load_dwordx4 v[88:91], v1, s[40:43], s63 offen nt
    s_memrealtime s[8:9]
    s_waitcnt lgkmcnt(0)
    s_sub_u32 s8, s8, s30
    s_cmpk_ge_u32 s8, 1266
    s_cbranch_scc1 .ap_62
    s_waitcnt vmcnt(5)
    s_cmpk_ge_u32 s8, 1166
    s_cbranch_scc1 .ap_62
    s_waitcnt vmcnt(3)
    s_bitcmp1_b64 s[14:15], 27
    s_cbranch_scc0 1
    s_waitcnt vmcnt(2)
    s_cmpk_ge_u32 s8, 1046
    s_cbranch_scc1 .ap_62
    s_waitcnt vmcnt(1)
.ap_62:
    s_add_u32 s63, s69, 417792
    buffer_load_dwordx4 v[92:95], v1, s[40:43], s63 offen nt
    s_memrealtime s[8:9]
    s_waitcnt vmcnt(8)
    s_waitcnt lgkmcnt(0)
    s_sub_u32 s8, s8, s30
    s_cmpk_ge_u32 s8, 1294
    s_cbranch_scc1 .ap_63
    s_waitcnt vmcnt(5)
    s_cmpk_ge_u32 s8, 1194
    s_cbranch_scc1 .ap_63
    s_waitcnt vmcnt(3)
    s_bitcmp1_b64 s[14:15], 28
    s_cbranch_scc0 1
    s_waitcnt vmcnt(2)
    s_cmpk_ge_u32 s8, 1074
    s_cbranch_scc1 .ap_63
    s_waitcnt vmcnt(1)
.ap_63:
    s_add_u32 s63, s69, 425984
    buffer_load_dwordx4 v[120:123], v1, s[40:43], s63 offen nt
    s_memrealtime s[8:9]
    s_waitcnt vmcnt(8)
    s_waitcnt lgkmcnt(0)
    s_sub_u32 s8, s8, s30
    s_cmpk_ge_u32 s8, 1322
    s_cbranch_scc1 .ap_64
    s_waitcnt vmcnt(5)
    s_cmpk_ge_u32 s8, 1222
    s_cbranch_scc1 .ap_64
    s_waitcnt vmcnt(3)
    s_bitcmp1_b64 s[14:15], 29
    s_cbranch_scc0 1
    s_waitcnt vmcnt(2)
    s_cmpk_ge_u32 s8, 1102
    s_cbranch_scc1 .ap_64
    s_waitcnt vmcnt(1)
.ap_64:
    s_add_u32 s63, s69, 434176
    buffer_load_dwordx4 v[124:127], v1, s[40:43], s63 offen nt
    s_memrealtime s[8:9]
    s_waitcnt vmcnt(8)
    s_waitcnt lgkmcnt(0)
    s_sub_u32 s8, s8, s30
    s_cmpk_ge_u32 s8, 1350
    s_cbranch_scc1 .ap_65
    s_waitcnt vmcnt(5)
    s_cmpk_ge_u32 s8, 1250
    s_cbranch_scc1 .ap_65
    s_waitcnt vmcnt(3)
    s_bitcmp1_b64 s[14:15], 30
    s_cbranch_scc0 1
    s_waitcnt vmcnt(2)
    s_cmpk_ge_u32 s8, 1130
    s_cbranch_scc1 .ap_65
    s_waitcnt vmcnt(1)
.ap_65:
    s_add_u32 s63, s69, 442368
    buffer_load_dwordx4 v[152:155], v1, s[40:43], s63 offen nt
    s_memrealtime s[8:9]
    s_waitcnt vmcnt(8)
    s_waitcnt lgkmcnt(0)
    s_sub_u32 s8, s8, s30
    s_cmpk_ge_u32 s8, 1378
    s_cbranch_scc1 .ap_66
    s_waitcnt vmcnt(5)
    s_cmpk_ge_u32 s8, 1278
    s_cbranch_scc1 .ap_66
    s_waitcnt vmcnt(3)
    s_bitcmp1_b64 s[14:15], 31
    s_cbranch_scc0 1
    s_waitcnt vmcnt(2)
    s_cmpk_ge_u32 s8, 1158
    s_cbranch_scc1 .ap_66
    s_waitcnt vmcnt(1)
.ap_66:
    s_add_u32 s63, s69, 450560
    buffer_load_dwordx4 v[156:159], v1, s[40:43], s63 offen nt
    buffer_load_dwordx4 v[16:19], v7, s[36:39], s58 offen offset:0 sc1
    buffer_load_dwordx4 v[20:23], v7, s[36:39], s58 offen offset:16 sc1
    s_memrealtime s[8:9]
    s_waitcnt vmcnt(8)
    s_waitcnt lgkmcnt(0)
    s_sub_u32 s8, s8, s30
    s_cmpk_ge_u32 s8, 1406
    s_cbranch_scc1 .ap_67
    s_waitcnt vmcnt(5)
    s_cmpk_ge_u32 s8, 1306
    s_cbranch_scc1 .ap_67
    s_waitcnt vmcnt(3)
    s_bitcmp1_b64 s[14:15], 32
    s_cbranch_scc0 1
    s_waitcnt vmcnt(2)
    s_cmpk_ge_u32 s8, 1186
    s_cbranch_scc1 .ap_67
    s_waitcnt vmcnt(1)
.ap_67:
    v_bfe_u32 v1, v0, 4, 2
    v_and_b32 v10, 0xf0, v2
    v_lshlrev_b32 v1, 2, v1
    v_bfe_u32 v1, s6, v1, 4
    v_lshl_add_u32 v1, v1, 8, v10
    s_add_u32 s63, s69, 0
    buffer_load_dwordx4 v[160:163], v1, s[44:47], s63 offen nt
    s_memrealtime s[8:9]
    s_waitcnt vmcnt(8)
    s_waitcnt lgkmcnt(0)
    s_sub_u32 s8, s8, s30
    s_cmpk_ge_u32 s8, 1434
    s_cbranch_scc1 .ap_68
    s_waitcnt vmcnt(5)
    s_cmpk_ge_u32 s8, 1334
    s_cbranch_scc1 .ap_68
    s_waitcnt vmcnt(3)
    s_bitcmp1_b64 s[14:15], 33
    s_cbranch_scc0 1
    s_waitcnt vmcnt(2)
    s_cmpk_ge_u32 s8, 1214
    s_cbranch_scc1 .ap_68
    s_waitcnt vmcnt(1)
.ap_68:
    s_add_u32 s63, s69, 8192
    buffer_load_dwordx4 v[164:167], v1, s[44:47], s63 offen nt
    s_memrealtime s[8:9]
    s_waitcnt vmcnt(8)
    s_waitcnt lgkmcnt(0)
    s_sub_u32 s8, s8, s30
    s_cmpk_ge_u32 s8, 1462
    s_cbranch_scc1 .ap_69
    s_waitcnt vmcnt(5)
    s_cmpk_ge_u32 s8, 1362
    s_cbranch_scc1 .ap_69
    s_waitcnt vmcnt(3)
    s_bitcmp1_b64 s[14:15], 34
    s_cbranch_scc0 1
    s_waitcnt vmcnt(2)
    s_cmpk_ge_u32 s8, 1242
    s_cbranch_scc1 .ap_69
    s_waitcnt vmcnt(1)
.ap_69:
    s_add_u32 s63, s69, 16384
    buffer_load_dwordx4 v[168:171], v1, s[44:47], s63 offen nt
    s_waitcnt vmcnt(3)
    s_branch .gpc_71
.gp_70:
    buffer_load_dwordx4 v[16:19], v7, s[36:39], s58 offen offset:0 sc1
    buffer_load_dwordx4 v[20:23], v7, s[36:39], s58 offen offset:16 sc1
    s_waitcnt vmcnt(0)
.gpc_71:
    v_min_u32 v10, v17, v19
    v_max_u32 v11, v17, v19
    v_min3_u32 v10, v10, v21, v23
    v_max3_u32 v11, v11, v21, v23
    v_cmp_eq_u32 vcc, s34, v10
    v_cmp_eq_u32 s[56:57], s34, v11
    s_and_b64 vcc, vcc, s[56:57]
    s_cmp_eq_u64 vcc, -1
    s_nop 2
    s_cbranch_scc1 .gpd_72
    s_sub_u32 s35, s35, 1
    s_cbranch_scc1 .Lexit
    s_sleep 1
    s_branch .gp_70
.gpd_72:
    s_mov_b32 vcc_lo, 0xcccccccc
    s_mov_b32 vcc_hi, 0xcccccccc
    v_cndmask_b32_e64 v24, v16, 0, vcc
    v_cndmask_b32_e64 v25, v18, 0, vcc
    v_cndmask_b32_e64 v26, v20, 0, vcc
    v_cndmask_b32_e64 v27, v22, 0, vcc
    v_cndmask_b32_e32 v28, 0, v16, vcc
    v_cndmask_b32_e32 v29, 0, v18, vcc
    v_cndmask_b32_e32 v30, 0, v20, vcc
    v_cndmask_b32_e32 v31, 0, v22, vcc
    v_mfma_f32_16x16x32_bf16 v[16:19], v[32:35], v[24:27], 0
    v_mfma_f32_16x16x32_bf16 v[32:35], v[40:43], v[24:27], 0
    v_mfma_f32_16x16x32_bf16 v[16:19], v[36:39], v[28:31], v[16:19]
    v_mfma_f32_16x16x32_bf16 v[40:43], v[48:51], v[24:27], 0
    v_mfma_f32_16x16x32_bf16 v[32:35], v[44:47], v[28:31], v[32:35]
    v_mfma_f32_16x16x32_bf16 v[48:51], v[56:59], v[24:27], 0
    v_mfma_f32_16x16x32_bf16 v[40:43], v[52:55], v[28:31], v[40:43]
    v_mfma_f32_16x16x32_bf16 v[56:59], v[64:67], v[24:27], 0
    v_mfma_f32_16x16x32_bf16 v[48:51], v[60:63], v[28:31], v[48:51]
    s_nop 1
    v_add_f32_dpp v10, v17, v16 row_ror:12 row_mask:0xf bank_mask:0x1
    s_memrealtime s[8:9]
    s_waitcnt lgkmcnt(0)
    s_sub_u32 s8, s8, s30
    s_cmpk_ge_u32 s8, 1490
    s_nop 0
    s_cbranch_scc1 .ap_73
    s_waitcnt vmcnt(3)
    s_cmpk_ge_u32 s8, 1390
    s_cbranch_scc1 .ap_73
    s_waitcnt vmcnt(3)
    s_bitcmp1_b64 s[14:15], 35
    s_cbranch_scc0 1
    s_waitcnt vmcnt(2)
    s_cmpk_ge_u32 s8, 1270
    s_cbranch_scc1 .ap_73
    s_waitcnt vmcnt(1)
.ap_73:
    s_add_u32 s63, s69, 24576
    buffer_load_dwordx4 v[172:175], v1, s[44:47], s63 offen nt
    v_mfma_f32_16x16x32_bf16 v[64:67], v[72:75], v[24:27], 0
    v_mfma_f32_16x16x32_bf16 v[56:59], v[68:71], v[28:31], v[56:59]
    v_add_f32_dpp v11, v33, v32 row_ror:12 row_mask:0xf bank_mask:0x1
    v_add_f32_dpp v10, v18, v10 row_ror:8 row_mask:0xf bank_mask:0x1
    v_mfma_f32_16x16x32_bf16 v[72:75], v[80:83], v[24:27], 0
    v_mfma_f32_16x16x32_bf16 v[64:67], v[76:79], v[28:31], v[64:67]
    v_add_f32_dpp v12, v41, v40 row_ror:12 row_mask:0xf bank_mask:0x1
    v_add_f32_dpp v11, v34, v11 row_ror:8 row_mask:0xf bank_mask:0x1
    v_add_f32_dpp v10, v19, v10 row_ror:4 row_mask:0xf bank_mask:0x1
    v_mfma_f32_16x16x32_bf16 v[80:83], v[88:91], v[24:27], 0
    v_mfma_f32_16x16x32_bf16 v[72:75], v[84:87], v[28:31], v[72:75]
    v_add_f32_dpp v13, v49, v48 row_ror:12 row_mask:0xf bank_mask:0x1
    v_add_f32_dpp v12, v42, v12 row_ror:8 row_mask:0xf bank_mask:0x1
    v_add_f32_dpp v11, v35, v11 row_ror:4 row_mask:0xf bank_mask:0x1
    v_mfma_f32_16x16x32_bf16 v[88:91], v[96:99], v[24:27], 0
    v_mfma_f32_16x16x32_bf16 v[80:83], v[92:95], v[28:31], v[80:83]
    v_add_f32_dpp v10, v58, v57 row_ror:12 row_mask:0xf bank_mask:0x2
    v_add_f32_dpp v13, v50, v13 row_ror:8 row_mask:0xf bank_mask:0x1
    v_add_f32_dpp v12, v43, v12 row_ror:4 row_mask:0xf bank_mask:0x1
    s_memrealtime s[8:9]
    s_waitcnt lgkmcnt(0)
    s_sub_u32 s8, s8, s30
    s_cmpk_ge_u32 s8, 1521
    s_nop 0
    s_cbranch_scc1 .ap_74
    s_waitcnt vmcnt(4)
    s_cmpk_ge_u32 s8, 1421
    s_cbranch_scc1 .ap_74
    s_waitcnt vmcnt(3)
    s_bitcmp1_b64 s[14:15], 36
    s_cbranch_scc0 1
    s_waitcnt vmcnt(2)
    s_cmpk_ge_u32 s8, 1301
    s_cbranch_scc1 .ap_74
    s_waitcnt vmcnt(1)
.ap_74:
    s_add_u32 s63, s69, 32768
    buffer_load_dwordx4 v[176:179], v1, s[44:47], s63 offen nt
    v_mfma_f32_16x16x32_bf16 v[96:99], v[104:107], v[24:27], 0
    v_mfma_f32_16x16x32_bf16 v[88:91], v[100:103], v[28:31], v[88:91]
    v_add_f32_dpp v11, v66, v65 row_ror:12 row_mask:0xf bank_mask:0x2
    v_add_f32_dpp v10, v59, v10 row_ror:8 row_mask:0xf bank_mask:0x2
    v_add_f32_dpp v13, v51, v13 row_ror:4 row_mask:0xf bank_mask:0x1
    v_mfma_f32_16x16x32_bf16 v[104:107], v[112:115], v[24:27], 0
    v_mfma_f32_16x16x32_bf16 v[96:99], v[108:111], v[28:31], v[96:99]
    v_add_f32_dpp v12, v74, v73 row_ror:12 row_mask:0xf bank_mask:0x2
    v_add_f32_dpp v11, v67, v11 row_ror:8 row_mask:0xf bank_mask:0x2
    v_add_f32_dpp v10, v56, v10 row_ror:4 row_mask:0xf bank_mask:0x2
    v_mfma_f32_16x16x32_bf16 v[112:115], v[120:123], v[24:27], 0
    v_mfma_f32_16x16x32_bf16 v[104:107], v[116:119], v[28:31], v[104:107]
    v_add_f32_dpp v13, v82, v81 row_ror:12 row_mask:0xf bank_mask:0x2
    v_add_f32_dpp v12, v75, v12 row_ror:8 row_mask:0xf bank_mask:0x2
    v_add_f32_dpp v11, v64, v11 row_ror:4 row_mask:0xf bank_mask:0x2
    v_mfma_f32_16x16x32_bf16 v[120:123], v[128:131], v[24:27], 0
    v_mfma_f32_16x16x32_bf16 v[112:115], v[124:127], v[28:31], v[112:115]
    v_add_f32_dpp v10, v91, v90 row_ror:12 row_mask:0xf bank_mask:0x4
    v_add_f32_dpp v13, v83, v13 row_ror:8 row_mask:0xf bank_mask:0x2
    v_add_f32_dpp v12, v72, v12 row_ror:4 row_mask:0xf bank_mask:0x2
    s_memrealtime s[8:9]
    s_waitcnt lgkmcnt(0)
    s_sub_u32 s8, s8, s30
    s_cmpk_ge_u32 s8, 1552
    s_nop 0
    s_cbranch_scc1 .ap_75
    s_waitcnt vmcnt(5)
    s_cmpk_ge_u32 s8, 1452
    s_cbranch_scc1 .ap_75
    s_waitcnt vmcnt(3)
    s_bitcmp1_b64 s[14:15], 37
    s_cbranch_scc0 1
    s_waitcnt vmcnt(2)
    s_cmpk_ge_u32 s8, 1332
    s_cbranch_scc1 .ap_75
    s_waitcnt vmcnt(1)
.ap_75:
    s_add_u32 s63, s69, 40960
    buffer_load_dwordx4 v[180:183], v1, s[44:47], s63 offen nt
    v_mfma_f32_16x16x32_bf16 v[128:131], v[136:139], v[24:27], 0
    v_mfma_f32_16x16x32_bf16 v[120:123], v[132:135], v[28:31], v[120:123]
    v_add_f32_dpp v11, v99, v98 row_ror:12 row_mask:0xf bank_mask:0x4
    v_add_f32_dpp v10, v88, v10 row_ror:8 row_mask:0xf bank_mask:0x4
    v_add_f32_dpp v13, v80, v13 row_ror:4 row_mask:0xf bank_mask:0x2
    v_mfma_f32_16x16x32_bf16 v[136:139], v[144:147], v[24:27], 0
    v_mfma_f32_16x16x32_bf16 v[128:131], v[140:143], v[28:31], v[128:131]
    v_add_f32_dpp v12, v107, v106 row_ror:12 row_mask:0xf bank_mask:0x4
    v_add_f32_dpp v11, v96, v11 row_ror:8 row_mask:0xf bank_mask:0x4
    v_add_f32_dpp v10, v89, v10 row_ror:4 row_mask:0xf bank_mask:0x4
    v_mfma_f32_16x16x32_bf16 v[144:147], v[152:155], v[24:27], 0
    v_mfma_f32_16x16x32_bf16 v[136:139], v[148:151], v[28:31], v[136:139]
    v_add_f32_dpp v13, v115, v114 row_ror:12 row_mask:0xf bank_mask:0x4
    v_add_f32_dpp v12, v104, v12 row_ror:8 row_mask:0xf bank_mask:0x4
    v_add_f32_dpp v11, v97, v11 row_ror:4 row_mask:0xf bank_mask:0x4
    v_mfma_f32_16x16x32_bf16 v[144:147], v[156:159], v[28:31], v[144:147]
    v_add_f32_dpp v10, v120, v123 row_ror:12 row_mask:0xf bank_mask:0x8
    v_add_f32_dpp v13, v112, v13 row_ror:8 row_mask:0xf bank_mask:0x4
    v_add_f32_dpp v12, v105, v12 row_ror:4 row_mask:0xf bank_mask:0x4
    s_memrealtime s[8:9]
    s_waitcnt lgkmcnt(0)
    s_sub_u32 s8, s8, s30
    s_cmpk_ge_u32 s8, 1583
    s_nop 0
    s_cbranch_scc1 .ap_76
    s_waitcnt vmcnt(5)
    s_cmpk_ge_u32 s8, 1483
    s_cbranch_scc1 .ap_76
    s_waitcnt vmcnt(3)
    s_bitcmp1_b64 s[14:15], 38
    s_cbranch_scc0 1
    s_waitcnt vmcnt(2)
    s_cmpk_ge_u32 s8, 1363
    s_cbranch_scc1 .ap_76
    s_waitcnt vmcnt(1)
.ap_76:
    s_add_u32 s63, s69, 49152
    buffer_load_dwordx4 v[184:187], v1, s[44:47], s63 offen nt
    v_add_f32_dpp v11, v128, v131 row_ror:12 row_mask:0xf bank_mask:0x8
    v_add_f32_dpp v10, v121, v10 row_ror:8 row_mask:0xf bank_mask:0x8
    v_add_f32_dpp v13, v113, v13 row_ror:4 row_mask:0xf bank_mask:0x4
    v_add_f32_dpp v12, v136, v139 row_ror:12 row_mask:0xf bank_mask:0x8
    v_add_f32_dpp v11, v129, v11 row_ror:8 row_mask:0xf bank_mask:0x8
    v_add_f32_dpp v10, v122, v10 row_ror:4 row_mask:0xf bank_mask:0x8
    v_add_f32_dpp v13, v144, v147 row_ror:12 row_mask:0xf bank_mask:0x8
    v_add_f32_dpp v12, v137, v12 row_ror:8 row_mask:0xf bank_mask:0x8
    v_add_f32_dpp v11, v130, v11 row_ror:4 row_mask:0xf bank_mask:0x8
    v_add_f32_dpp v13, v145, v13 row_ror:8 row_mask:0xf bank_mask:0x8
    v_add_f32_dpp v12, v138, v12 row_ror:4 row_mask:0xf bank_mask:0x8
    s_memrealtime s[8:9]
    s_waitcnt lgkmcnt(0)
    s_sub_u32 s8, s8, s30
    s_cmpk_ge_u32 s8, 1614
    s_cbranch_scc1 .ap_77
    s_waitcnt vmcnt(5)
    s_cmpk_ge_u32 s8, 1514
    s_cbranch_scc1 .ap_77
    s_waitcnt vmcnt(3)
    s_bitcmp1_b64 s[14:15], 39
    s_cbranch_scc0 1
    s_waitcnt vmcnt(2)
    s_cmpk_ge_u32 s8, 1394
    s_cbranch_scc1 .ap_77
    s_waitcnt vmcnt(1)
.ap_77:
    s_add_u32 s63, s69, 57344
    buffer_load_dwordx4 v[188:191], v1, s[44:47], s63 offen nt
    v_add_f32_dpp v13, v146, v13 row_ror:4 row_mask:0xf bank_mask:0x8
    s_mov_b32 s60, 0x3db504f3
    s_mov_b32 s61, 0x3db504f3
    v_cvt_pk_bf16_f32 v10, v10, v11
    v_and_b32 v11, 0xffff0000, v10
    v_lshlrev_b32 v10, 16, v10
    v_cvt_pk_bf16_f32 v12, v12, v13
    v_and_b32 v13, 0xffff0000, v12
    v_lshlrev_b32 v12, 16, v12
    v_pk_mul_f32 v[10:11], v[10:11], s[60:61]
    v_pk_mul_f32 v[12:13], v[12:13], s[60:61]
    v_cvt_pk_bf16_f32 v10, v10, v11
    v_and_b32 v11, 0xffff0000, v10
    v_lshlrev_b32 v10, 16, v10
    v_cvt_pk_bf16_f32 v12, v12, v13
    v_and_b32 v13, 0xffff0000, v12
    v_lshlrev_b32 v12, 16, v12
    v_max_f32 v14, v10, v11
    v_max3_f32 v14, v14, v12, v13
    s_mov_b32 s60, 0x3fb8aa3b
    v_mov_b32 v22, s34
    v_mov_b32 v23, s34
    v_max_f32_dpp v14, v14, v14 quad_perm:[2,3,0,1] row_mask:0xf bank_mask:0xf
    s_nop 1
    v_max_f32_dpp v14, v14, v14 row_ror:4 row_mask:0xf bank_mask:0xf
    s_nop 1
    v_max_f32_dpp v14, v14, v14 row_ror:8 row_mask:0xf bank_mask:0xf
    v_mov_b32 v15, v14
    s_nop 1
    v_permlane16_swap_b32 v15, v14
    v_max_f32 v14, v15, v14
    v_mov_b32 v15, v14
    s_nop 1
    v_permlane32_swap_b32 v15, v14
    v_max_f32 v14, v15, v14
    v_mul_f32 v15, 0xbfb8aa3b, v14
    v_fma_f32 v10, v10, s60, v15
    v_fma_f32 v11, v11, s60, v15
    v_fma_f32 v12, v12, s60, v15
    v_fma_f32 v13, v13, s60, v15
    v_exp_f32 v10, v10
    v_exp_f32 v11, v11
    v_exp_f32 v12, v12
    v_exp_f32 v13, v13
    v_mov_b32 v20, v14
    v_pk_add_f32 v[16:17], v[10:11], v[12:13]
    v_add_f32 v21, v16, v17
    s_lshl3_add_u32 s60, s68, s3
    s_lshl_b32 s60, s60, 5
    s_add_u32 s60, s60, s59
    v_add_f32_dpp v21, v21, v21 quad_perm:[2,3,0,1] row_mask:0xf bank_mask:0xf
    s_nop 1
    v_add_f32_dpp v21, v21, v21 row_ror:4 row_mask:0xf bank_mask:0xf
    s_nop 1
    v_add_f32_dpp v21, v21, v21 row_ror:8 row_mask:0xf bank_mask:0xf
    v_mov_b32 v15, v21
    s_nop 1
    v_permlane16_swap_b32 v15, v21
    v_add_f32 v21, v15, v21
    v_mov_b32 v15, v21
    s_nop 1
    v_permlane32_swap_b32 v15, v21
    v_add_f32 v21, v15, v21
    s_mov_b64 exec, 0x3
    buffer_store_dwordx4 v[20:23], v2, s[36:39], s60 offen sc1
    s_mov_b64 exec, -1
    s_memrealtime s[8:9]
    s_waitcnt vmcnt(8)
    s_waitcnt lgkmcnt(0)
    s_sub_u32 s8, s8, s30
    s_cmpk_ge_u32 s8, 1645
    s_cbranch_scc1 .ap_78
    s_waitcnt vmcnt(5)
    s_cmpk_ge_u32 s8, 1545
    s_cbranch_scc1 .ap_78
    s_waitcnt vmcnt(3)
    s_bitcmp1_b64 s[14:15], 40
    s_cbranch_scc0 1
    s_waitcnt vmcnt(2)
    s_cmpk_ge_u32 s8, 1425
    s_cbranch_scc1 .ap_78
    s_waitcnt vmcnt(1)
.ap_78:
    s_add_u32 s63, s69, 131072
    buffer_load_dwordx4 v[192:195], v1, s[44:47], s63 offen nt
    s_memrealtime s[8:9]
    s_waitcnt vmcnt(8)
    s_waitcnt lgkmcnt(0)
    s_sub_u32 s8, s8, s30
    s_cmpk_ge_u32 s8, 1676
    s_cbranch_scc1 .ap_79
    s_waitcnt vmcnt(5)
    s_cmpk_ge_u32 s8, 1576
    s_cbranch_scc1 .ap_79
    s_waitcnt vmcnt(3)
    s_bitcmp1_b64 s[14:15], 41
    s_cbranch_scc0 1
    s_waitcnt vmcnt(2)
    s_cmpk_ge_u32 s8, 1456
    s_cbranch_scc1 .ap_79
    s_waitcnt vmcnt(1)
.ap_79:
    s_add_u32 s63, s69, 139264
    buffer_load_dwordx4 v[196:199], v1, s[44:47], s63 offen nt
    s_memrealtime s[8:9]
    s_waitcnt vmcnt(8)
    s_waitcnt lgkmcnt(0)
    s_sub_u32 s8, s8, s30
    s_cmpk_ge_u32 s8, 1707
    s_cbranch_scc1 .ap_80
    s_waitcnt vmcnt(5)
    s_cmpk_ge_u32 s8, 1607
    s_cbranch_scc1 .ap_80
    s_waitcnt vmcnt(3)
    s_bitcmp1_b64 s[14:15], 42
    s_cbranch_scc0 1
    s_waitcnt vmcnt(2)
    s_cmpk_ge_u32 s8, 1487
    s_cbranch_scc1 .ap_80
    s_waitcnt vmcnt(1)
.ap_80:
    s_add_u32 s63, s69, 147456
    buffer_load_dwordx4 v[200:203], v1, s[44:47], s63 offen nt
    s_memrealtime s[8:9]
    s_waitcnt vmcnt(8)
    s_waitcnt lgkmcnt(0)
    s_sub_u32 s8, s8, s30
    s_cmpk_ge_u32 s8, 1738
    s_cbranch_scc1 .ap_81
    s_waitcnt vmcnt(5)
    s_cmpk_ge_u32 s8, 1638
    s_cbranch_scc1 .ap_81
    s_waitcnt vmcnt(3)
    s_bitcmp1_b64 s[14:15], 43
    s_cbranch_scc0 1
    s_waitcnt vmcnt(2)
    s_cmpk_ge_u32 s8, 1518
    s_cbranch_scc1 .ap_81
    s_waitcnt vmcnt(1)
.ap_81:
    s_add_u32 s63, s69, 155648
    buffer_load_dwordx4 v[204:207], v1, s[44:47], s63 offen nt
    s_memrealtime s[8:9]
    s_waitcnt vmcnt(8)
    s_waitcnt lgkmcnt(0)
    s_sub_u32 s8, s8, s30
    s_cmpk_ge_u32 s8, 1769
    s_cbranch_scc1 .ap_82
    s_waitcnt vmcnt(5)
    s_cmpk_ge_u32 s8, 1669
    s_cbranch_scc1 .ap_82
    s_waitcnt vmcnt(3)
    s_bitcmp1_b64 s[14:15], 44
    s_cbranch_scc0 1
    s_waitcnt vmcnt(2)
    s_cmpk_ge_u32 s8, 1549
    s_cbranch_scc1 .ap_82
    s_waitcnt vmcnt(1)
.ap_82:
    s_add_u32 s63, s69, 163840
    buffer_load_dwordx4 v[208:211], v1, s[44:47], s63 offen nt
    v_and_b32 v16, 8, v0
    v_and_b32 v17, 1, v0
    v_lshl_add_u32 v16, v17, 2, v16
    v_bfe_u32 v17, v0, 1, 2
    v_add_u32 v16, v16, v17
    v_lshrrev_b32 v17, 4, v0
    v_lshl_add_u32 v16, v16, 2, v17
    v_lshlrev_b32 v7, 1, v16
    v_and_b32 v8, 62, v16
    v_lshlrev_b32 v8, 2, v8
    s_mul_i32 s100, s3, 1152
    s_lshl_b32 s56, s65, 7
    s_add_u32 s100, s100, s56
    s_mov_b32 s52, s4
    s_and_b32 s53, s5, 0xffff
    s_mov_b32 s54, 0x2400
    s_mov_b32 s55, 0x00020000
    buffer_load_ushort v40, v7, s[52:55], s100 offen
    s_mov_b32 s48, s16
    s_and_b32 s49, s17, 0xffff
    s_mov_b32 s50, 0x480
    s_mov_b32 s51, 0x00020000
    buffer_load_dwordx2 v[48:49], v3, s[48:51], 0 offen
    buffer_load_dwordx2 v[50:51], v3, s[48:51], 0 offen offset:512
    buffer_load_dword v34, v4, s[48:51], 0 offen
    s_mov_b32 s48, s28
    s_and_b32 s49, s29, 0xffff
    s_mov_b32 s50, 0x2400
    s_mov_b32 s51, 0x00020000
    buffer_load_ushort v39, v7, s[48:51], s100 offen nt
    s_memrealtime s[8:9]
    s_waitcnt vmcnt(13)
    s_waitcnt lgkmcnt(0)
    s_sub_u32 s8, s8, s30
    s_cmpk_ge_u32 s8, 1800
    s_cbranch_scc1 .ap_83
    s_waitcnt vmcnt(10)
    s_cmpk_ge_u32 s8, 1700
    s_cbranch_scc1 .ap_83
    s_waitcnt vmcnt(8)
    s_bitcmp1_b64 s[14:15], 45
    s_cbranch_scc0 1
    s_waitcnt vmcnt(7)
    s_cmpk_ge_u32 s8, 1580
    s_cbranch_scc1 .ap_83
    s_waitcnt vmcnt(6)
.ap_83:
    s_add_u32 s63, s69, 172032
    buffer_load_dwordx4 v[212:215], v1, s[44:47], s63 offen nt
    s_memrealtime s[8:9]
    s_waitcnt vmcnt(13)
    s_waitcnt lgkmcnt(0)
    s_sub_u32 s8, s8, s30
    s_cmpk_ge_u32 s8, 1833
    s_cbranch_scc1 .ap_84
    s_waitcnt vmcnt(10)
    s_cmpk_ge_u32 s8, 1733
    s_cbranch_scc1 .ap_84
    s_waitcnt vmcnt(8)
    s_bitcmp1_b64 s[14:15], 46
    s_cbranch_scc0 1
    s_waitcnt vmcnt(7)
    s_cmpk_ge_u32 s8, 1613
    s_cbranch_scc1 .ap_84
    s_waitcnt vmcnt(6)
.ap_84:
    s_add_u32 s63, s69, 180224
    buffer_load_dwordx4 v[216:219], v1, s[44:47], s63 offen nt
    s_memrealtime s[8:9]
    s_waitcnt vmcnt(13)
    s_waitcnt lgkmcnt(0)
    s_sub_u32 s8, s8, s30
    s_cmpk_ge_u32 s8, 1866
    s_cbranch_scc1 .ap_85
    s_waitcnt vmcnt(10)
    s_cmpk_ge_u32 s8, 1766
    s_cbranch_scc1 .ap_85
    s_waitcnt vmcnt(8)
    s_bitcmp1_b64 s[14:15], 47
    s_cbranch_scc0 1
    s_waitcnt vmcnt(7)
    s_cmpk_ge_u32 s8, 1646
    s_cbranch_scc1 .ap_85
    s_waitcnt vmcnt(1)
.ap_85:
    s_add_u32 s63, s69, 188416
    buffer_load_dwordx4 v[220:223], v1, s[44:47], s63 offen nt
    s_memrealtime s[8:9]
    s_waitcnt vmcnt(13)
    s_waitcnt lgkmcnt(0)
    s_sub_u32 s8, s8, s30
    s_cmpk_ge_u32 s8, 1899
    s_cbranch_scc1 .ap_86
    s_waitcnt vmcnt(10)
    s_cmpk_ge_u32 s8, 1799
    s_cbranch_scc1 .ap_86
    s_waitcnt vmcnt(8)
    s_bitcmp1_b64 s[14:15], 48
    s_cbranch_scc0 1
    s_waitcnt vmcnt(2)
    s_cmpk_ge_u32 s8, 1679
    s_cbranch_scc1 .ap_86
    s_waitcnt vmcnt(1)
.ap_86:
    s_add_u32 s63, s69, 262144
    buffer_load_dwordx4 v[224:227], v1, s[44:47], s63 offen nt
    s_memrealtime s[8:9]
    s_waitcnt vmcnt(13)
    s_waitcnt lgkmcnt(0)
    s_sub_u32 s8, s8, s30
    s_cmpk_ge_u32 s8, 1932
    s_cbranch_scc1 .ap_87
    s_waitcnt vmcnt(10)
    s_cmpk_ge_u32 s8, 1832
    s_cbranch_scc1 .ap_87
    s_waitcnt vmcnt(3)
    s_bitcmp1_b64 s[14:15], 49
    s_cbranch_scc0 1
    s_waitcnt vmcnt(2)
    s_cmpk_ge_u32 s8, 1712
    s_cbranch_scc1 .ap_87
    s_waitcnt vmcnt(1)
.ap_87:
    s_add_u32 s63, s69, 270336
    buffer_load_dwordx4 v[228:231], v1, s[44:47], s63 offen nt
    s_memrealtime s[8:9]
    s_waitcnt vmcnt(13)
    s_waitcnt lgkmcnt(0)
    s_sub_u32 s8, s8, s30
    s_cmpk_ge_u32 s8, 1965
    s_cbranch_scc1 .ap_88
    s_waitcnt vmcnt(10)
    s_cmpk_ge_u32 s8, 1865
    s_cbranch_scc1 .ap_88
    s_waitcnt vmcnt(3)
    s_bitcmp1_b64 s[14:15], 50
    s_cbranch_scc0 1
    s_waitcnt vmcnt(2)
    s_cmpk_ge_u32 s8, 1745
    s_cbranch_scc1 .ap_88
    s_waitcnt vmcnt(1)
.ap_88:
    s_add_u32 s63, s69, 278528
    buffer_load_dwordx4 v[232:235], v1, s[44:47], s63 offen nt
    s_memrealtime s[8:9]
    s_waitcnt vmcnt(13)
    s_waitcnt lgkmcnt(0)
    s_sub_u32 s8, s8, s30
    s_cmpk_ge_u32 s8, 1998
    s_cbranch_scc1 .ap_89
    s_waitcnt vmcnt(5)
    s_cmpk_ge_u32 s8, 1898
    s_cbranch_scc1 .ap_89
    s_waitcnt vmcnt(3)
    s_bitcmp1_b64 s[14:15], 51
    s_cbranch_scc0 1
    s_waitcnt vmcnt(2)
    s_cmpk_ge_u32 s8, 1778
    s_cbranch_scc1 .ap_89
    s_waitcnt vmcnt(1)
.ap_89:
    s_add_u32 s63, s69, 286720
    buffer_load_dwordx4 v[236:239], v1, s[44:47], s63 offen nt
    s_memrealtime s[8:9]
    s_waitcnt vmcnt(13)
    s_waitcnt lgkmcnt(0)
    s_sub_u32 s8, s8, s30
    s_cmpk_ge_u32 s8, 2031
    s_cbranch_scc1 .ap_90
    s_waitcnt vmcnt(5)
    s_cmpk_ge_u32 s8, 1931
    s_cbranch_scc1 .ap_90
    s_waitcnt vmcnt(3)
    s_bitcmp1_b64 s[14:15], 52
    s_cbranch_scc0 1
    s_waitcnt vmcnt(2)
    s_cmpk_ge_u32 s8, 1811
    s_cbranch_scc1 .ap_90
    s_waitcnt vmcnt(1)
.ap_90:
    s_add_u32 s63, s69, 294912
    buffer_load_dwordx4 v[240:243], v1, s[44:47], s63 offen nt
    s_memrealtime s[8:9]
    s_waitcnt vmcnt(13)
    s_waitcnt lgkmcnt(0)
    s_sub_u32 s8, s8, s30
    s_cmpk_ge_u32 s8, 2064
    s_cbranch_scc1 .ap_91
    s_waitcnt vmcnt(5)
    s_cmpk_ge_u32 s8, 1964
    s_cbranch_scc1 .ap_91
    s_waitcnt vmcnt(3)
    s_bitcmp1_b64 s[14:15], 53
    s_cbranch_scc0 1
    s_waitcnt vmcnt(2)
    s_cmpk_ge_u32 s8, 1844
    s_cbranch_scc1 .ap_91
    s_waitcnt vmcnt(1)
.ap_91:
    s_add_u32 s63, s69, 303104
    buffer_load_dwordx4 v[244:247], v1, s[44:47], s63 offen nt
    s_and_b32 s0, s0, 0xffffff80
    s_sub_u32 s0, s0, 1024
    buffer_load_dword v28, v4, s[36:39], s0 offen sc1
    buffer_load_dwordx4 v[24:27], v9, s[36:39], s59 offen offset:0 sc1
    s_memrealtime s[8:9]
    s_waitcnt vmcnt(9)
    s_waitcnt lgkmcnt(0)
    s_sub_u32 s8, s8, s30
    s_cmpk_ge_u32 s8, 2097
    s_cbranch_scc1 .ap_92
    s_waitcnt vmcnt(6)
    s_cmpk_ge_u32 s8, 1997
    s_cbranch_scc1 .ap_92
    s_waitcnt vmcnt(4)
    s_bitcmp1_b64 s[14:15], 54
    s_cbranch_scc0 1
    s_waitcnt vmcnt(3)
    s_cmpk_ge_u32 s8, 1877
    s_cbranch_scc1 .ap_92
    s_waitcnt vmcnt(2)
.ap_92:
    s_add_u32 s63, s69, 311296
    buffer_load_dwordx4 v[248:251], v1, s[44:47], s63 offen nt
    s_memrealtime s[8:9]
    s_waitcnt vmcnt(9)
    s_waitcnt lgkmcnt(0)
    s_sub_u32 s8, s8, s30
    s_cmpk_ge_u32 s8, 2130
    s_cbranch_scc1 .ap_93
    s_waitcnt vmcnt(6)
    s_cmpk_ge_u32 s8, 2030
    s_cbranch_scc1 .ap_93
    s_waitcnt vmcnt(4)
    s_bitcmp1_b64 s[14:15], 55
    s_cbranch_scc0 1
    s_waitcnt vmcnt(3)
    s_cmpk_ge_u32 s8, 1910
    s_cbranch_scc1 .ap_93
    s_waitcnt vmcnt(1)
.ap_93:
    s_add_u32 s63, s69, 319488
    buffer_load_dwordx4 v[252:255], v1, s[44:47], s63 offen nt
    s_memrealtime s[8:9]
    s_waitcnt vmcnt(9)
    s_waitcnt lgkmcnt(0)
    s_sub_u32 s8, s8, s30
    s_cmpk_ge_u32 s8, 2163
    s_cbranch_scc1 .ap_94
    s_waitcnt vmcnt(6)
    s_cmpk_ge_u32 s8, 2063
    s_cbranch_scc1 .ap_94
    s_waitcnt vmcnt(4)
    s_bitcmp1_b64 s[14:15], 56
    s_cbranch_scc0 1
    s_waitcnt vmcnt(2)
    s_cmpk_ge_u32 s8, 1943
    s_cbranch_scc1 .ap_94
    s_waitcnt vmcnt(1)
.ap_94:
    s_add_u32 s63, s69, 393216
    buffer_load_dwordx4 v[36:39], v1, s[44:47], s63 offen nt
    s_memrealtime s[8:9]
    s_waitcnt vmcnt(9)
    s_waitcnt lgkmcnt(0)
    s_sub_u32 s8, s8, s30
    s_cmpk_ge_u32 s8, 2196
    s_cbranch_scc1 .ap_95
    s_waitcnt vmcnt(6)
    s_cmpk_ge_u32 s8, 2096
    s_cbranch_scc1 .ap_95
    s_waitcnt vmcnt(3)
    s_bitcmp1_b64 s[14:15], 57
    s_cbranch_scc0 1
    s_waitcnt vmcnt(2)
    s_cmpk_ge_u32 s8, 1976
    s_cbranch_scc1 .ap_95
    s_waitcnt vmcnt(1)
.ap_95:
    s_add_u32 s63, s69, 401408
    buffer_load_dwordx4 v[44:47], v1, s[44:47], s63 offen nt
    s_memrealtime s[8:9]
    s_waitcnt vmcnt(9)
    s_waitcnt lgkmcnt(0)
    s_sub_u32 s8, s8, s30
    s_cmpk_ge_u32 s8, 2229
    s_cbranch_scc1 .ap_96
    s_waitcnt vmcnt(6)
    s_cmpk_ge_u32 s8, 2129
    s_cbranch_scc1 .ap_96
    s_waitcnt vmcnt(3)
    s_bitcmp1_b64 s[14:15], 58
    s_cbranch_scc0 1
    s_waitcnt vmcnt(2)
    s_cmpk_ge_u32 s8, 2009
    s_cbranch_scc1 .ap_96
    s_waitcnt vmcnt(1)
.ap_96:
    s_add_u32 s63, s69, 409600
    buffer_load_dwordx4 v[52:55], v1, s[44:47], s63 offen nt
    s_memrealtime s[8:9]
    s_waitcnt vmcnt(9)
    s_waitcnt lgkmcnt(0)
    s_sub_u32 s8, s8, s30
    s_cmpk_ge_u32 s8, 2262
    s_cbranch_scc1 .ap_97
    s_waitcnt vmcnt(5)
    s_cmpk_ge_u32 s8, 2162
    s_cbranch_scc1 .ap_97
    s_waitcnt vmcnt(3)
    s_bitcmp1_b64 s[14:15], 59
    s_cbranch_scc0 1
    s_waitcnt vmcnt(2)
    s_cmpk_ge_u32 s8, 2042
    s_cbranch_scc1 .ap_97
    s_waitcnt vmcnt(1)
.ap_97:
    s_add_u32 s63, s69, 417792
    buffer_load_dwordx4 v[60:63], v1, s[44:47], s63 offen nt
    s_memrealtime s[8:9]
    s_waitcnt vmcnt(9)
    s_waitcnt lgkmcnt(0)
    s_sub_u32 s8, s8, s30
    s_cmpk_ge_u32 s8, 2295
    s_cbranch_scc1 .ap_98
    s_waitcnt vmcnt(5)
    s_cmpk_ge_u32 s8, 2195
    s_cbranch_scc1 .ap_98
    s_waitcnt vmcnt(3)
    s_bitcmp1_b64 s[14:15], 60
    s_cbranch_scc0 1
    s_waitcnt vmcnt(2)
    s_cmpk_ge_u32 s8, 2075
    s_cbranch_scc1 .ap_98
    s_waitcnt vmcnt(1)
.ap_98:
    s_add_u32 s63, s69, 425984
    buffer_load_dwordx4 v[68:71], v1, s[44:47], s63 offen nt
    s_memrealtime s[8:9]
    s_waitcnt vmcnt(9)
    s_waitcnt lgkmcnt(0)
    s_sub_u32 s8, s8, s30
    s_cmpk_ge_u32 s8, 2328
    s_cbranch_scc1 .ap_99
    s_waitcnt vmcnt(5)
    s_cmpk_ge_u32 s8, 2228
    s_cbranch_scc1 .ap_99
    s_waitcnt vmcnt(3)
    s_bitcmp1_b64 s[14:15], 61
    s_cbranch_scc0 1
    s_waitcnt vmcnt(2)
    s_cmpk_ge_u32 s8, 2108
    s_cbranch_scc1 .ap_99
    s_waitcnt vmcnt(1)
.ap_99:
    s_add_u32 s63, s69, 434176
    buffer_load_dwordx4 v[76:79], v1, s[44:47], s63 offen nt
    s_memrealtime s[8:9]
    s_waitcnt vmcnt(8)
    s_waitcnt lgkmcnt(0)
    s_sub_u32 s8, s8, s30
    s_cmpk_ge_u32 s8, 2361
    s_cbranch_scc1 .ap_100
    s_waitcnt vmcnt(5)
    s_cmpk_ge_u32 s8, 2261
    s_cbranch_scc1 .ap_100
    s_waitcnt vmcnt(3)
    s_bitcmp1_b64 s[14:15], 62
    s_cbranch_scc0 1
    s_waitcnt vmcnt(2)
    s_cmpk_ge_u32 s8, 2141
    s_cbranch_scc1 .ap_100
    s_waitcnt vmcnt(1)
.ap_100:
    s_add_u32 s63, s69, 442368
    buffer_load_dwordx4 v[84:87], v1, s[44:47], s63 offen nt
    s_memrealtime s[8:9]
    s_waitcnt vmcnt(8)
    s_waitcnt lgkmcnt(0)
    s_sub_u32 s8, s8, s30
    s_cmpk_ge_u32 s8, 2394
    s_cbranch_scc1 .ap_101
    s_waitcnt vmcnt(5)
    s_cmpk_ge_u32 s8, 2294
    s_cbranch_scc1 .ap_101
    s_waitcnt vmcnt(3)
    s_bitcmp1_b64 s[14:15], 63
    s_cbranch_scc0 1
    s_waitcnt vmcnt(2)
    s_cmpk_ge_u32 s8, 2174
    s_cbranch_scc1 .ap_101
    s_waitcnt vmcnt(1)
.ap_101:
    s_add_u32 s63, s69, 450560
    buffer_load_dwordx4 v[92:95], v1, s[44:47], s63 offen nt
    s_setprio 0
    s_branch .gpc_103
.gp_102:
    buffer_load_dwordx4 v[24:27], v9, s[36:39], s59 offen offset:0 sc1
    s_waitcnt vmcnt(0)
.gpc_103:
    v_cmp_eq_u32 vcc, s34, v26
    s_cmp_eq_u64 vcc, -1
    s_nop 3
    s_cbranch_scc1 .gpd_104
    s_sub_u32 s35, s35, 1
    s_cbranch_scc1 .Lexit
    s_sleep 1
    s_branch .gp_102
.gpd_104:
    v_cmp_eq_u32 vcc, s1, v28
    s_cmp_eq_u64 vcc, -1
    s_cselect_b32 s0, 0x800000, 0
    v_mov_b32 v16, v24
    s_nop 1
    v_max_f32_dpp v16, v16, v16 row_ror:8 row_mask:0xf bank_mask:0xf
    s_nop 1
    v_max_f32_dpp v16, v16, v16 row_ror:4 row_mask:0xf bank_mask:0xf
    v_mov_b32 v17, v16
    s_nop 1
    v_permlane16_swap_b32 v17, v16
    v_max_f32 v16, v17, v16
    v_mov_b32 v17, v16
    s_nop 1
    v_permlane32_swap_b32 v17, v16
    v_max_f32 v16, v17, v16
    v_sub_f32 v17, v24, v16
    v_sub_f32 v18, v14, v16
    v_mul_f32 v17, 0x3fb8aa3b, v17
    v_mul_f32 v18, 0x3fb8aa3b, v18
    v_exp_f32 v17, v17
    v_exp_f32 v18, v18
    v_mul_f32 v17, v17, v25
    s_nop 1
    v_add_f32_dpp v17, v17, v17 row_ror:8 row_mask:0xf bank_mask:0xf
    s_nop 1
    v_add_f32_dpp v17, v17, v17 row_ror:4 row_mask:0xf bank_mask:0xf
    v_mov_b32 v19, v17
    s_nop 1
    v_permlane16_swap_b32 v19, v17
    v_add_f32 v17, v19, v17
    v_mov_b32 v19, v17
    s_nop 1
    v_permlane32_swap_b32 v19, v17
    v_add_f32 v17, v19, v17
    v_rcp_f32 v19, v17
    s_nop 0
    v_fma_f32 v15, -v17, v19, 1.0
    v_fma_f32 v19, v15, v19, v19
    v_mul_f32 v18, v18, v19
    v_mul_f32 v10, v10, v18
    v_mul_f32 v11, v11, v18
    v_mul_f32 v12, v12, v18
    v_mul_f32 v13, v13, v18
    v_mov_b32_dpp v112, v10 quad_perm:[2,3,0,1] row_mask:0xf bank_mask:0xf
    v_mov_b32_dpp v113, v11 quad_perm:[2,3,0,1] row_mask:0xf bank_mask:0xf
    v_mov_b32_dpp v114, v12 quad_perm:[2,3,0,1] row_mask:0xf bank_mask:0xf
    v_mov_b32_dpp v115, v13 quad_perm:[2,3,0,1] row_mask:0xf bank_mask:0xf
    v_cvt_pk_bf16_f32 v96, v10, v112
    v_cvt_pk_bf16_f32 v100, v11, v113
    v_cvt_pk_bf16_f32 v104, v12, v114
    v_cvt_pk_bf16_f32 v108, v13, v115
    v_mov_b32_dpp v97, v96 row_ror:12 row_mask:0xf bank_mask:0xf
    v_mov_b32_dpp v101, v100 row_ror:12 row_mask:0xf bank_mask:0xf
    v_mov_b32_dpp v105, v104 row_ror:12 row_mask:0xf bank_mask:0xf
    v_mov_b32_dpp v109, v108 row_ror:12 row_mask:0xf bank_mask:0xf
    v_mov_b32_dpp v98, v96 row_ror:8 row_mask:0xf bank_mask:0xf
    v_mov_b32_dpp v102, v100 row_ror:8 row_mask:0xf bank_mask:0xf
    v_mov_b32_dpp v106, v104 row_ror:8 row_mask:0xf bank_mask:0xf
    v_mov_b32_dpp v110, v108 row_ror:8 row_mask:0xf bank_mask:0xf
    v_mov_b32_dpp v99, v96 row_ror:4 row_mask:0xf bank_mask:0xf
    v_mov_b32_dpp v103, v100 row_ror:4 row_mask:0xf bank_mask:0xf
    v_mov_b32_dpp v107, v104 row_ror:4 row_mask:0xf bank_mask:0xf
    v_mov_b32_dpp v111, v108 row_ror:4 row_mask:0xf bank_mask:0xf
    s_lshl_b32 s60, s3, 10
    s_add_u32 s60, s60, 147456
    v_lshlrev_b32 v10, 5, v0
    v_add_u32 v10, s60, v10
    v_perm_b32 v112, v164, v160, s94
    v_perm_b32 v113, v172, v168, s94
    v_perm_b32 v114, v180, v176, s94
    v_perm_b32 v115, v188, v184, s94
    s_nop 1
    v_mfma_f32_16x16x32_bf16 v[128:131], v[96:99], v[112:115], 0
    v_perm_b32 v116, v164, v160, s95
    v_perm_b32 v117, v172, v168, s95
    v_perm_b32 v118, v180, v176, s95
    v_perm_b32 v119, v188, v184, s95
    s_nop 1
    v_mfma_f32_16x16x32_bf16 v[132:135], v[96:99], v[116:119], 0
    v_perm_b32 v120, v165, v161, s94
    v_perm_b32 v121, v173, v169, s94
    v_perm_b32 v122, v181, v177, s94
    v_perm_b32 v123, v189, v185, s94
    s_nop 1
    v_mfma_f32_16x16x32_bf16 v[136:139], v[96:99], v[120:123], 0
    v_perm_b32 v124, v165, v161, s95
    v_perm_b32 v125, v173, v169, s95
    v_perm_b32 v126, v181, v177, s95
    v_perm_b32 v127, v189, v185, s95
    s_nop 1
    v_mfma_f32_16x16x32_bf16 v[140:143], v[96:99], v[124:127], 0
    v_perm_b32 v112, v166, v162, s94
    v_perm_b32 v113, v174, v170, s94
    v_perm_b32 v114, v182, v178, s94
    v_perm_b32 v115, v190, v186, s94
    s_nop 1
    v_mfma_f32_16x16x32_bf16 v[144:147], v[96:99], v[112:115], 0
    v_perm_b32 v116, v166, v162, s95
    v_perm_b32 v117, v174, v170, s95
    v_perm_b32 v118, v182, v178, s95
    v_perm_b32 v119, v190, v186, s95
    s_nop 1
    v_mfma_f32_16x16x32_bf16 v[148:151], v[96:99], v[116:119], 0
    v_perm_b32 v120, v167, v163, s94
    v_perm_b32 v121, v175, v171, s94
    v_perm_b32 v122, v183, v179, s94
    v_perm_b32 v123, v191, v187, s94
    s_nop 1
    v_mfma_f32_16x16x32_bf16 v[152:155], v[96:99], v[120:123], 0
    v_perm_b32 v124, v167, v163, s95
    v_perm_b32 v125, v175, v171, s95
    v_perm_b32 v126, v183, v179, s95
    v_perm_b32 v127, v191, v187, s95
    s_nop 1
    v_mfma_f32_16x16x32_bf16 v[156:159], v[96:99], v[124:127], 0
    v_perm_b32 v112, v196, v192, s94
    v_perm_b32 v113, v204, v200, s94
    v_perm_b32 v114, v212, v208, s94
    v_perm_b32 v115, v220, v216, s94
    s_nop 1
    v_mfma_f32_16x16x32_bf16 v[128:131], v[100:103], v[112:115], v[128:131]
    v_perm_b32 v116, v196, v192, s95
    v_perm_b32 v117, v204, v200, s95
    v_perm_b32 v118, v212, v208, s95
    v_perm_b32 v119, v220, v216, s95
    s_nop 1
    v_mfma_f32_16x16x32_bf16 v[132:135], v[100:103], v[116:119], v[132:135]
    v_perm_b32 v120, v197, v193, s94
    v_perm_b32 v121, v205, v201, s94
    v_perm_b32 v122, v213, v209, s94
    v_perm_b32 v123, v221, v217, s94
    s_nop 1
    v_mfma_f32_16x16x32_bf16 v[136:139], v[100:103], v[120:123], v[136:139]
    v_perm_b32 v124, v197, v193, s95
    v_perm_b32 v125, v205, v201, s95
    v_perm_b32 v126, v213, v209, s95
    v_perm_b32 v127, v221, v217, s95
    s_nop 1
    v_mfma_f32_16x16x32_bf16 v[140:143], v[100:103], v[124:127], v[140:143]
    v_perm_b32 v112, v198, v194, s94
    v_perm_b32 v113, v206, v202, s94
    v_perm_b32 v114, v214, v210, s94
    v_perm_b32 v115, v222, v218, s94
    s_nop 1
    v_mfma_f32_16x16x32_bf16 v[144:147], v[100:103], v[112:115], v[144:147]
    v_perm_b32 v116, v198, v194, s95
    v_perm_b32 v117, v206, v202, s95
    v_perm_b32 v118, v214, v210, s95
    v_perm_b32 v119, v222, v218, s95
    s_nop 1
    v_mfma_f32_16x16x32_bf16 v[148:151], v[100:103], v[116:119], v[148:151]
    v_perm_b32 v120, v199, v195, s94
    v_perm_b32 v121, v207, v203, s94
    v_perm_b32 v122, v215, v211, s94
    v_perm_b32 v123, v223, v219, s94
    s_nop 1
    v_mfma_f32_16x16x32_bf16 v[152:155], v[100:103], v[120:123], v[152:155]
    v_perm_b32 v124, v199, v195, s95
    v_perm_b32 v125, v207, v203, s95
    v_perm_b32 v126, v215, v211, s95
    v_perm_b32 v127, v223, v219, s95
    s_nop 1
    v_mfma_f32_16x16x32_bf16 v[156:159], v[100:103], v[124:127], v[156:159]
    s_waitcnt vmcnt(8)
    v_perm_b32 v112, v228, v224, s94
    v_perm_b32 v113, v236, v232, s94
    v_perm_b32 v114, v244, v240, s94
    v_perm_b32 v115, v252, v248, s94
    s_nop 1
    v_mfma_f32_16x16x32_bf16 v[128:131], v[104:107], v[112:115], v[128:131]
    v_perm_b32 v116, v228, v224, s95
    v_perm_b32 v117, v236, v232, s95
    v_perm_b32 v118, v244, v240, s95
    v_perm_b32 v119, v252, v248, s95
    s_nop 1
    v_mfma_f32_16x16x32_bf16 v[132:135], v[104:107], v[116:119], v[132:135]
    v_perm_b32 v120, v229, v225, s94
    v_perm_b32 v121, v237, v233, s94
    v_perm_b32 v122, v245, v241, s94
    v_perm_b32 v123, v253, v249, s94
    s_nop 1
    v_mfma_f32_16x16x32_bf16 v[136:139], v[104:107], v[120:123], v[136:139]
    v_perm_b32 v124, v229, v225, s95
    v_perm_b32 v125, v237, v233, s95
    v_perm_b32 v126, v245, v241, s95
    v_perm_b32 v127, v253, v249, s95
    s_nop 1
    v_mfma_f32_16x16x32_bf16 v[140:143], v[104:107], v[124:127], v[140:143]
    v_perm_b32 v112, v230, v226, s94
    v_perm_b32 v113, v238, v234, s94
    v_perm_b32 v114, v246, v242, s94
    v_perm_b32 v115, v254, v250, s94
    s_nop 1
    v_mfma_f32_16x16x32_bf16 v[144:147], v[104:107], v[112:115], v[144:147]
    v_perm_b32 v116, v230, v226, s95
    v_perm_b32 v117, v238, v234, s95
    v_perm_b32 v118, v246, v242, s95
    v_perm_b32 v119, v254, v250, s95
    s_nop 1
    v_mfma_f32_16x16x32_bf16 v[148:151], v[104:107], v[116:119], v[148:151]
    v_perm_b32 v120, v231, v227, s94
    v_perm_b32 v121, v239, v235, s94
    v_perm_b32 v122, v247, v243, s94
    v_perm_b32 v123, v255, v251, s94
    s_nop 1
    v_mfma_f32_16x16x32_bf16 v[152:155], v[104:107], v[120:123], v[152:155]
    v_perm_b32 v124, v231, v227, s95
    v_perm_b32 v125, v239, v235, s95
    v_perm_b32 v126, v247, v243, s95
    v_perm_b32 v127, v255, v251, s95
    s_nop 1
    v_mfma_f32_16x16x32_bf16 v[156:159], v[104:107], v[124:127], v[156:159]
    s_waitcnt vmcnt(0)
    v_perm_b32 v112, v44, v36, s94
    v_perm_b32 v113, v60, v52, s94
    v_perm_b32 v114, v76, v68, s94
    v_perm_b32 v115, v92, v84, s94
    s_nop 1
    v_mfma_f32_16x16x32_bf16 v[128:131], v[108:111], v[112:115], v[128:131]
    v_perm_b32 v116, v44, v36, s95
    v_perm_b32 v117, v60, v52, s95
    v_perm_b32 v118, v76, v68, s95
    v_perm_b32 v119, v92, v84, s95
    s_nop 1
    v_mfma_f32_16x16x32_bf16 v[132:135], v[108:111], v[116:119], v[132:135]
    v_perm_b32 v120, v45, v37, s94
    v_perm_b32 v121, v61, v53, s94
    v_perm_b32 v122, v77, v69, s94
    v_perm_b32 v123, v93, v85, s94
    s_nop 1
    v_mfma_f32_16x16x32_bf16 v[136:139], v[108:111], v[120:123], v[136:139]
    v_perm_b32 v124, v45, v37, s95
    v_perm_b32 v125, v61, v53, s95
    v_perm_b32 v126, v77, v69, s95
    v_perm_b32 v127, v93, v85, s95
    s_nop 1
    v_mfma_f32_16x16x32_bf16 v[140:143], v[108:111], v[124:127], v[140:143]
    v_perm_b32 v112, v46, v38, s94
    v_perm_b32 v113, v62, v54, s94
    v_perm_b32 v114, v78, v70, s94
    v_perm_b32 v115, v94, v86, s94
    s_nop 1
    v_mfma_f32_16x16x32_bf16 v[144:147], v[108:111], v[112:115], v[144:147]
    v_perm_b32 v116, v46, v38, s95
    v_perm_b32 v117, v62, v54, s95
    v_perm_b32 v118, v78, v70, s95
    v_perm_b32 v119, v94, v86, s95
    s_nop 1
    v_mfma_f32_16x16x32_bf16 v[148:151], v[108:111], v[116:119], v[148:151]
    v_perm_b32 v120, v47, v39, s94
    v_perm_b32 v121, v63, v55, s94
    v_perm_b32 v122, v79, v71, s94
    v_perm_b32 v123, v95, v87, s94
    s_nop 1
    v_mfma_f32_16x16x32_bf16 v[152:155], v[108:111], v[120:123], v[152:155]
    v_perm_b32 v124, v47, v39, s95
    v_perm_b32 v125, v63, v55, s95
    v_perm_b32 v126, v79, v71, s95
    v_perm_b32 v127, v95, v87, s95
    s_nop 1
    v_mfma_f32_16x16x32_bf16 v[156:159], v[108:111], v[124:127], v[156:159]
    s_mov_b64 exec, 0xffff
    ds_write2_b32 v10, v128, v129 offset0:0 offset1:128
    ds_write2_b32 v10, v132, v133 offset0:1 offset1:129
    ds_write2_b32 v10, v136, v137 offset0:2 offset1:130
    ds_write2_b32 v10, v140, v141 offset0:3 offset1:131
    ds_write2_b32 v10, v144, v145 offset0:4 offset1:132
    ds_write2_b32 v10, v148, v149 offset0:5 offset1:133
    ds_write2_b32 v10, v152, v153 offset0:6 offset1:134
    ds_write2_b32 v10, v156, v157 offset0:7 offset1:135
    s_mov_b64 exec, -1
    s_waitcnt lgkmcnt(0)
    s_barrier
    s_cmp_lg_u32 s3, 7
    s_cbranch_scc1 .opub_105
    v_add_u32 v10, 147456, v2
    ds_read_b128 v[196:199], v10 offset:0
    ds_read_b128 v[200:203], v10 offset:1024
    ds_read_b128 v[204:207], v10 offset:2048
    ds_read_b128 v[208:211], v10 offset:3072
    ds_read_b128 v[212:215], v10 offset:4096
    ds_read_b128 v[216:219], v10 offset:5120
    ds_read_b128 v[220:223], v10 offset:6144
    ds_read_b128 v[224:227], v10 offset:7168
    v_lshrrev_b32 v11, 5, v0
    v_lshlrev_b32 v11, 13, v11
    v_and_b32 v12, 31, v0
    v_lshl_add_u32 v11, v12, 4, v11
    s_lshl4_add_u32 s56, s67, s66
    s_lshl1_add_u32 s56, s56, s68
    s_lshl_b32 s56, s56, 9
    s_add_u32 s56, s56, 0xa0000
    s_mov_b32 s60, 0x07060503
    s_mov_b32 s61, 0x07060502
    s_mov_b32 s62, 0x07060501
    v_mov_b32 v15, s34
    s_waitcnt lgkmcnt(6)
    v_pk_add_f32 v[196:197], v[196:197], v[200:201]
    v_pk_add_f32 v[198:199], v[198:199], v[202:203]
    s_waitcnt lgkmcnt(5)
    v_pk_add_f32 v[196:197], v[196:197], v[204:205]
    v_pk_add_f32 v[198:199], v[198:199], v[206:207]
    s_waitcnt lgkmcnt(4)
    v_pk_add_f32 v[196:197], v[196:197], v[208:209]
    v_pk_add_f32 v[198:199], v[198:199], v[210:211]
    s_waitcnt lgkmcnt(3)
    v_pk_add_f32 v[196:197], v[196:197], v[212:213]
    v_pk_add_f32 v[198:199], v[198:199], v[214:215]
    s_waitcnt lgkmcnt(2)
    v_pk_add_f32 v[196:197], v[196:197], v[216:217]
    v_pk_add_f32 v[198:199], v[198:199], v[218:219]
    s_waitcnt lgkmcnt(1)
    v_pk_add_f32 v[196:197], v[196:197], v[220:221]
    v_pk_add_f32 v[198:199], v[198:199], v[222:223]
    s_waitcnt lgkmcnt(0)
    v_pk_add_f32 v[196:197], v[196:197], v[224:225]
    v_pk_add_f32 v[198:199], v[198:199], v[226:227]
    v_perm_b32 v12, v196, v199, s60
    v_perm_b32 v13, v197, v199, s61
    v_perm_b32 v14, v198, v199, s62
    s_add_u32 s57, s56, 0x800000
    buffer_store_dwordx4 v[12:15], v11, s[36:39], s57 offen
    buffer_store_dwordx4 v[12:15], v11, s[36:39], s56 offen sc1
.opub_105:
    s_and_b32 s58, s64, 0
    s_mul_i32 s58, s58, 18432
    s_mul_i32 s59, s3, 2304
    s_add_u32 s58, s58, s59
    s_add_u32 s62, s58, 0x37000
    s_add_u32 s63, s58, 0x49000
    s_mul_i32 s101, s64, 18432
    s_add_u32 s101, s101, s59
    s_add_u32 s101, s101, 0x170000
    v_and_b32 v16, 8, v0
    v_and_b32 v17, 1, v0
    v_lshl_add_u32 v16, v17, 2, v16
    v_bfe_u32 v17, v0, 1, 2
    v_add_u32 v16, v16, v17
    v_lshlrev_b32 v9, 4, v16
    s_lshl_b32 s56, s65, 8
    s_add_u32 s58, s58, s56
    s_add_u32 s58, s58, 0x25000
    s_add_u32 s99, s101, s56
    s_lshr_b32 s56, s64, 1
    s_and_b32 s57, s3, 3
    s_cmp_lg_u32 s56, s57
    s_cbranch_scc1 .Lr_ga
    s_add_u32 s59, s58, 73728
    s_add_u32 s60, s58, 147456
    s_add_u32 s61, s58, 221184
.gp_106:
    buffer_load_dwordx4 v[56:59], v2, s[36:39], s62 offen offset:0 sc1
    buffer_load_dwordx4 v[60:63], v2, s[36:39], s62 offen offset:1024 sc1
    buffer_load_dwordx2 v[64:65], v5, s[36:39], s62 offen offset:0 sc1
    buffer_load_dwordx4 v[66:69], v2, s[36:39], s63 offen offset:0 sc1
    buffer_load_dwordx4 v[70:73], v2, s[36:39], s63 offen offset:1024 sc1
    buffer_load_dwordx2 v[74:75], v5, s[36:39], s63 offen offset:0 sc1
    buffer_load_dwordx2 v[76:77], v8, s[36:39], s59 offen offset:0 sc1
    buffer_load_dwordx2 v[78:79], v8, s[36:39], s60 offen offset:0 sc1
    buffer_load_dwordx2 v[80:81], v8, s[36:39], s61 offen offset:0 sc1
    buffer_load_dwordx2 v[42:43], v8, s[36:39], s58 offen offset:0 sc1
    s_waitcnt vmcnt(0)
.gpc_107:
    v_min_u32 v24, v57, v59
    v_max_u32 v25, v57, v59
    v_min3_u32 v24, v24, v61, v63
    v_max3_u32 v25, v25, v61, v63
    v_min3_u32 v24, v24, v65, v67
    v_max3_u32 v25, v25, v65, v67
    v_min3_u32 v24, v24, v69, v71
    v_max3_u32 v25, v25, v69, v71
    v_min3_u32 v24, v24, v73, v75
    v_max3_u32 v25, v25, v73, v75
    v_min3_u32 v24, v24, v77, v79
    v_max3_u32 v25, v25, v77, v79
    v_min3_u32 v24, v24, v81, v43
    v_max3_u32 v25, v25, v81, v43
    v_cmp_eq_u32 vcc, s34, v24
    v_cmp_eq_u32 s[56:57], s34, v25
    s_and_b64 vcc, vcc, s[56:57]
    s_cmp_eq_u64 vcc, -1
    s_nop 2
    s_cbranch_scc1 .gpd_108
    s_sub_u32 s35, s35, 1
    s_cbranch_scc1 .Lexit
    s_sleep 2
    s_branch .gp_106
.gpd_108:
    v_and_b32 v57, 0xffff0000, v56
    v_lshlrev_b32 v56, 16, v56
    v_and_b32 v67, 0xffff0000, v66
    v_lshlrev_b32 v66, 16, v66
    v_and_b32 v59, 0xffff0000, v58
    v_lshlrev_b32 v58, 16, v58
    v_and_b32 v69, 0xffff0000, v68
    v_lshlrev_b32 v68, 16, v68
    v_and_b32 v61, 0xffff0000, v60
    v_lshlrev_b32 v60, 16, v60
    v_and_b32 v71, 0xffff0000, v70
    v_lshlrev_b32 v70, 16, v70
    v_and_b32 v63, 0xffff0000, v62
    v_lshlrev_b32 v62, 16, v62
    v_and_b32 v73, 0xffff0000, v72
    v_lshlrev_b32 v72, 16, v72
    v_and_b32 v65, 0xffff0000, v64
    v_lshlrev_b32 v64, 16, v64
    v_and_b32 v75, 0xffff0000, v74
    v_lshlrev_b32 v74, 16, v74
    v_lshlrev_b32 v77, 16, v76
    v_and_b32 v76, 0xffff0000, v76
    s_mov_b32 vcc_lo, 0xffff0000
    s_mov_b32 vcc_hi, 0xffff0000
    v_cndmask_b32 v77, v77, v76, vcc
    v_lshlrev_b32 v79, 16, v78
    v_and_b32 v78, 0xffff0000, v78
    s_mov_b32 vcc_lo, 0xffff0000
    s_mov_b32 vcc_hi, 0xffff0000
    v_cndmask_b32 v79, v79, v78, vcc
    v_lshlrev_b32 v81, 16, v80
    v_and_b32 v80, 0xffff0000, v80
    s_mov_b32 vcc_lo, 0xffff0000
    s_mov_b32 vcc_hi, 0xffff0000
    v_cndmask_b32 v81, v81, v80, vcc
    s_nop 1
    s_branch .Lr_ga2
.Lr_ga:
.gp_109:
    buffer_load_dwordx2 v[42:43], v8, s[36:39], s58 offen offset:0 sc1
    s_waitcnt vmcnt(0)
.gpc_110:
    v_cmp_eq_u32 vcc, s34, v43
    s_cmp_eq_u64 vcc, -1
    s_nop 3
    s_cbranch_scc1 .gpd_111
    s_sub_u32 s35, s35, 1
    s_cbranch_scc1 .Lexit
    s_sleep 2
    s_branch .gp_109
.gpd_111:
.Lr_ga2:
    v_lshlrev_b32 v40, 16, v40
    v_lshlrev_b32 v41, 16, v42
    v_and_b32 v42, 0xffff0000, v42
    s_mov_b32 vcc_lo, 0xffff0000
    s_mov_b32 vcc_hi, 0xffff0000
    v_cndmask_b32 v41, v41, v42, vcc
    s_mul_i32 s59, s3, 9
    s_add_u32 s59, s59, s65
    s_lshl_b32 s59, s59, 12
    s_add_u32 s59, s59, 0xe0000
    s_mov_b32 s60, 0x04000c0c
    s_mov_b32 s61, 0x0706000c
    v_mov_b32 v45, s34
    v_mov_b32 v47, s34
.gp_112:
    buffer_load_dwordx4 v[16:19], v2, s[36:39], s59 offen offset:0 sc1
    buffer_load_dwordx4 v[20:23], v2, s[36:39], s59 offen offset:1024 sc1
    buffer_load_dwordx4 v[24:27], v2, s[36:39], s59 offen offset:2048 sc1
    buffer_load_dwordx4 v[28:31], v2, s[36:39], s59 offen offset:3072 sc1
    s_waitcnt vmcnt(0)
.gpc_113:
    v_min_u32 v32, v19, v23
    v_max_u32 v33, v19, v23
    v_min3_u32 v32, v32, v27, v31
    v_max3_u32 v33, v33, v27, v31
    v_cmp_eq_u32 vcc, s34, v32
    v_cmp_eq_u32 s[56:57], s34, v33
    s_and_b64 vcc, vcc, s[56:57]
    s_cmp_eq_u64 vcc, -1
    s_nop 2
    s_cbranch_scc1 .gpd_114
    s_sub_u32 s35, s35, 1
    s_cbranch_scc1 .Lexit
    s_branch .gp_112
.gpd_114:
    v_perm_b32 v19, v16, v17, s60
    v_perm_b32 v19, v19, v18, s61
    v_perm_b32 v23, v20, v21, s60
    v_perm_b32 v23, v23, v22, s61
    v_perm_b32 v27, v24, v25, s60
    v_perm_b32 v27, v27, v26, s61
    v_perm_b32 v31, v28, v29, s60
    v_perm_b32 v31, v31, v30, s61
    v_pk_add_f32 v[16:17], v[16:17], v[20:21]
    v_pk_add_f32 v[18:19], v[18:19], v[22:23]
    v_pk_add_f32 v[24:25], v[24:25], v[28:29]
    v_pk_add_f32 v[26:27], v[26:27], v[30:31]
    v_pk_add_f32 v[16:17], v[16:17], v[24:25]
    v_pk_add_f32 v[18:19], v[18:19], v[26:27]
    s_nop 1
    v_permlane32_swap_b32 v16, v18
    v_permlane32_swap_b32 v17, v19
    v_pk_add_f32 v[16:17], v[16:17], v[18:19]
    s_nop 1
    v_permlane16_swap_b32 v16, v17
    v_add_f32 v16, v16, v17
    v_cvt_pk_bf16_f32 v16, v16, v16
    v_lshlrev_b32 v16, 16, v16
    v_mul_f32 v16, v16, v41
    v_cvt_pk_bf16_f32 v16, v16, v16
    v_lshlrev_b32 v16, 16, v16
    v_add_f32 v17, v16, v40
    v_add_f32 v16, v16, v40
    v_mov_b32 v40, v16
    s_nop 0
    v_permlane16_swap_b32 v16, v17
    v_cvt_pk_bf16_f32 v44, v16, v17
    v_cvt_pk_bf16_f32 v46, v16, v17
    s_nop 1
    v_permlane32_swap_b32 v44, v46
    s_mov_b64 exec, 0xffff
    s_add_u32 s57, s99, 0x800000
    buffer_store_dwordx4 v[44:47], v9, s[36:39], s57 offen
    buffer_store_dwordx4 v[44:47], v9, s[36:39], s99 offen sc1
    s_mov_b64 exec, -1
    s_lshr_b32 s56, s64, 1
    s_and_b32 s57, s3, 3
    s_cmp_lg_u32 s56, s57
    s_cbranch_scc1 .Lexit
    v_cvt_pk_bf16_f32 v40, v40, v40
    v_lshlrev_b32 v40, 16, v40
    s_mov_b32 s69, 0
.gp_115:
    s_add_u32 s69, s69, 1
    s_and_b32 s56, s69, 0x41
    s_cmp_lg_u32 s56, 0x41
    s_cselect_b32 s56, s0, 0
    s_add_u32 s58, s101, s56
    buffer_load_dwordx4 v[84:87], v2, s[36:39], s58 offen offset:0 sc1
    buffer_load_dwordx4 v[88:91], v2, s[36:39], s58 offen offset:1024 sc1
    buffer_load_dwordx2 v[92:93], v5, s[36:39], s58 offen offset:0 sc1
    s_waitcnt vmcnt(0)
    v_min3_u32 v24, v85, v87, v89
    v_max3_u32 v25, v85, v87, v89
    v_min3_u32 v24, v24, v91, v93
    v_max3_u32 v25, v25, v91, v93
    v_cmp_eq_u32 vcc, s34, v24
    v_cmp_eq_u32 s[56:57], s34, v25
    s_and_b64 vcc, vcc, s[56:57]
    s_cmp_eq_u64 vcc, -1
    s_nop 2
    s_cbranch_scc1 .gpd_116
    s_sub_u32 s35, s35, 1
    s_cbranch_scc1 .Lexit
    s_sleep 1
    s_branch .gp_115
.gpd_116:
    s_mov_b32 s56, 0x3f803f80
    v_dot2_f32_bf16 v104, v84, s56, 0
    v_dot2_f32_bf16 v105, v84, v84, 0
    v_dot2_f32_bf16 v104, v86, s56, v104
    v_dot2_f32_bf16 v105, v86, v86, v105
    v_dot2_f32_bf16 v104, v88, s56, v104
    v_dot2_f32_bf16 v105, v88, v88, v105
    v_dot2_f32_bf16 v104, v90, s56, v104
    v_dot2_f32_bf16 v105, v90, v90, v105
    s_mov_b64 exec, 0xffffffff
    v_dot2_f32_bf16 v104, v92, s56, v104
    v_dot2_f32_bf16 v105, v92, v92, v105
    s_mov_b64 exec, -1
    s_nop 1
    v_permlane32_swap_b32 v104, v105
    v_add_f32 v104, v104, v105
    v_mov_b32 v106, v104
    s_nop 1
    v_permlane16_swap_b32 v106, v104
    v_add_f32 v104, v106, v104
    v_lshlrev_b32 v94, 16, v84
    v_and_b32 v95, 0xffff0000, v84
    v_add_f32_dpp v104, v104, v104 row_ror:8 row_mask:0xf bank_mask:0xf
    v_lshlrev_b32 v96, 16, v86
    v_and_b32 v97, 0xffff0000, v86
    v_add_f32_dpp v104, v104, v104 row_ror:4 row_mask:0xf bank_mask:0xf
    v_lshlrev_b32 v98, 16, v88
    v_and_b32 v99, 0xffff0000, v88
    v_add_f32_dpp v104, v104, v104 quad_perm:[2,3,0,1] row_mask:0xf bank_mask:0xf
    v_lshlrev_b32 v100, 16, v90
    v_and_b32 v101, 0xffff0000, v90
    v_add_f32_dpp v104, v104, v104 quad_perm:[1,0,3,2] row_mask:0xf bank_mask:0xf
    v_mul_f32 v104, 0x3ae38e39, v104
    v_lshlrev_b32 v102, 16, v92
    v_and_b32 v103, 0xffff0000, v92
    v_readlane_b32 s56, v104, 0
    v_readlane_b32 s57, v104, 32
    s_nop 0
    v_mov_b32 v104, s56
    v_fma_f32 v105, -v104, v104, s57
    v_max_f32 v105, 0, v105
    v_cvt_pk_bf16_f32 v106, -v104, v105
    v_and_b32 v107, 0xffff0000, v106
    v_add_f32 v107, 0x3727c5ac, v107
    v_lshlrev_b32 v104, 16, v106
    v_cvt_pk_bf16_f32 v107, v107, v107
    v_lshlrev_b32 v107, 16, v107
    v_sqrt_f32 v107, v107
    v_mov_b32 v105, v104
    v_cvt_pk_bf16_f32 v107, v107, v107
    v_lshlrev_b32 v107, 16, v107
    v_rcp_f32 v106, v107
    v_rcp_f32 v107, v107
    v_pk_add_f32 v[94:95], v[94:95], v[104:105]
    v_pk_add_f32 v[96:97], v[96:97], v[104:105]
    v_pk_add_f32 v[98:99], v[98:99], v[104:105]
    v_pk_add_f32 v[100:101], v[100:101], v[104:105]
    v_pk_add_f32 v[102:103], v[102:103], v[104:105]
    v_cvt_pk_bf16_f32 v94, v94, v95
    v_and_b32 v95, 0xffff0000, v94
    v_lshlrev_b32 v94, 16, v94
    v_cvt_pk_bf16_f32 v96, v96, v97
    v_and_b32 v97, 0xffff0000, v96
    v_lshlrev_b32 v96, 16, v96
    v_cvt_pk_bf16_f32 v98, v98, v99
    v_and_b32 v99, 0xffff0000, v98
    v_lshlrev_b32 v98, 16, v98
    v_cvt_pk_bf16_f32 v100, v100, v101
    v_and_b32 v101, 0xffff0000, v100
    v_lshlrev_b32 v100, 16, v100
    v_cvt_pk_bf16_f32 v102, v102, v103
    v_and_b32 v103, 0xffff0000, v102
    v_lshlrev_b32 v102, 16, v102
    v_pk_mul_f32 v[94:95], v[94:95], v[106:107]
    v_pk_mul_f32 v[96:97], v[96:97], v[106:107]
    v_pk_mul_f32 v[98:99], v[98:99], v[106:107]
    v_pk_mul_f32 v[100:101], v[100:101], v[106:107]
    v_pk_mul_f32 v[102:103], v[102:103], v[106:107]
    v_cvt_pk_bf16_f32 v94, v94, v95
    v_and_b32 v95, 0xffff0000, v94
    v_lshlrev_b32 v94, 16, v94
    v_cvt_pk_bf16_f32 v96, v96, v97
    v_and_b32 v97, 0xffff0000, v96
    v_lshlrev_b32 v96, 16, v96
    v_cvt_pk_bf16_f32 v98, v98, v99
    v_and_b32 v99, 0xffff0000, v98
    v_lshlrev_b32 v98, 16, v98
    v_cvt_pk_bf16_f32 v100, v100, v101
    v_and_b32 v101, 0xffff0000, v100
    v_lshlrev_b32 v100, 16, v100
    v_cvt_pk_bf16_f32 v102, v102, v103
    v_and_b32 v103, 0xffff0000, v102
    v_lshlrev_b32 v102, 16, v102
    v_pk_mul_f32 v[94:95], v[94:95], v[66:67]
    v_pk_mul_f32 v[96:97], v[96:97], v[68:69]
    v_pk_mul_f32 v[98:99], v[98:99], v[70:71]
    v_pk_mul_f32 v[100:101], v[100:101], v[72:73]
    v_pk_mul_f32 v[102:103], v[102:103], v[74:75]
    v_cvt_pk_bf16_f32 v94, v94, v95
    v_and_b32 v95, 0xffff0000, v94
    v_lshlrev_b32 v94, 16, v94
    v_cvt_pk_bf16_f32 v96, v96, v97
    v_and_b32 v97, 0xffff0000, v96
    v_lshlrev_b32 v96, 16, v96
    v_cvt_pk_bf16_f32 v98, v98, v99
    v_and_b32 v99, 0xffff0000, v98
    v_lshlrev_b32 v98, 16, v98
    v_cvt_pk_bf16_f32 v100, v100, v101
    v_and_b32 v101, 0xffff0000, v100
    v_lshlrev_b32 v100, 16, v100
    v_cvt_pk_bf16_f32 v102, v102, v103
    v_and_b32 v103, 0xffff0000, v102
    v_lshlrev_b32 v102, 16, v102
    v_pk_add_f32 v[94:95], v[94:95], v[56:57]
    v_pk_add_f32 v[96:97], v[96:97], v[58:59]
    v_pk_add_f32 v[98:99], v[98:99], v[60:61]
    v_pk_add_f32 v[100:101], v[100:101], v[62:63]
    v_pk_add_f32 v[102:103], v[102:103], v[64:65]
    v_cvt_pk_bf16_f32 v110, v94, v95
    v_cvt_pk_bf16_f32 v111, v96, v97
    v_cvt_pk_bf16_f32 v112, v98, v99
    v_cvt_pk_bf16_f32 v113, v100, v101
    v_cvt_pk_bf16_f32 v114, v102, v103
    v_dot2_f32_bf16 v14, v110, v48, 0
    v_dot2_f32_bf16 v14, v111, v49, v14
    v_dot2_f32_bf16 v14, v112, v50, v14
    v_dot2_f32_bf16 v14, v113, v51, v14
    s_mov_b64 exec, 0xffffffff
    v_dot2_f32_bf16 v14, v114, v34, v14
    s_mov_b64 exec, -1
    s_nop 1
    v_mov_b32 v15, v14
    s_nop 1
    v_permlane32_swap_b32 v15, v14
    v_add_f32 v14, v15, v14
    v_mov_b32 v15, v14
    s_nop 1
    v_permlane16_swap_b32 v15, v14
    v_add_f32 v14, v15, v14
    s_nop 1
    v_add_f32_dpp v14, v14, v14 row_ror:8 row_mask:0xf bank_mask:0xf
    s_nop 1
    v_add_f32_dpp v14, v14, v14 row_ror:4 row_mask:0xf bank_mask:0xf
    s_nop 1
    v_add_f32_dpp v14, v14, v14 quad_perm:[2,3,0,1] row_mask:0xf bank_mask:0xf
    s_nop 1
    v_add_f32_dpp v14, v14, v14 quad_perm:[1,0,3,2] row_mask:0xf bank_mask:0xf
    v_cvt_pk_bf16_f32 v14, v14, v14
    v_lshlrev_b32 v14, 16, v14
    v_max_f32 v14, 0xc2ae0000, v14
    v_min_f32 v14, 0x43000000, v14
    v_mul_f32 v15, 0xbfb8aa3b, v14
    v_fma_f32 v16, v14, s98, -v15
    v_fmac_f32 v16, 0xb2a57060, v14
    v_exp_f32 v15, v15
    v_mul_f32 v16, 0x3f317218, v16
    v_fmac_f32 v15, v15, v16
    v_add_f32 v15, 1.0, v15
    v_rcp_f32 v16, v15
    s_nop 0
    v_fma_f32 v15, -v15, v16, 1.0
    v_fma_f32 v14, v15, v16, v16
    v_cvt_pk_bf16_f32 v14, v14, v14
    v_lshlrev_b32 v14, 16, v14
    v_add_f32 v41, v40, v104
    v_cvt_pk_bf16_f32 v41, v41, v41
    v_lshlrev_b32 v41, 16, v41
    v_mul_f32 v41, v41, v106
    v_cvt_pk_bf16_f32 v41, v41, v41
    v_lshlrev_b32 v41, 16, v41
    v_mul_f32 v41, v41, v79
    v_cvt_pk_bf16_f32 v41, v41, v41
    v_lshlrev_b32 v41, 16, v41
    v_add_f32 v41, v41, v77
    v_cvt_pk_bf16_f32 v41, v41, v41
    v_lshlrev_b32 v41, 16, v41
    s_and_b32 s62, s64, 1
    s_lshl1_add_u32 s58, s65, s62
    s_lshl3_add_u32 s58, s58, s3
    s_mul_i32 s58, s58, 9216
    s_add_u32 s58, s58, 0x1a0000
    s_add_u32 s59, s58, 4096
    s_add_u32 s63, s58, 8192
    s_cmp_eq_u32 s62, 0
    s_mov_b32 s56, 0x00ff00ff
    s_cselect_b32 s62, s56, 0xff00ff00
    s_mov_b32 s60, 0x04000c0c
    s_mov_b32 s61, 0x0706000c
    s_mov_b32 s48, s28
    s_and_b32 s49, s29, 0xffff
    s_mov_b32 s50, 0x2400
    s_mov_b32 s51, 0x00020000
.gp_117:
    buffer_load_dwordx4 v[120:123], v2, s[36:39], s58 offen offset:0 sc1
    buffer_load_dwordx4 v[124:127], v2, s[36:39], s58 offen offset:1024 sc1
    buffer_load_dwordx4 v[128:131], v2, s[36:39], s58 offen offset:2048 sc1
    buffer_load_dwordx4 v[132:135], v2, s[36:39], s58 offen offset:3072 sc1
    buffer_load_dwordx4 v[136:139], v2, s[36:39], s59 offen offset:0 sc1
    buffer_load_dwordx4 v[140:143], v2, s[36:39], s59 offen offset:1024 sc1
    buffer_load_dwordx4 v[144:147], v2, s[36:39], s59 offen offset:2048 sc1
    buffer_load_dwordx4 v[148:151], v2, s[36:39], s59 offen offset:3072 sc1
    buffer_load_dwordx4 v[152:155], v2, s[36:39], s63 offen offset:0 sc1
    s_waitcnt vmcnt(0)
.gpc_118:
    v_min3_u32 v24, v123, v127, v131
    v_max3_u32 v25, v123, v127, v131
    v_min3_u32 v24, v24, v135, v139
    v_max3_u32 v25, v25, v135, v139
    v_min3_u32 v24, v24, v143, v147
    v_max3_u32 v25, v25, v143, v147
    v_min3_u32 v24, v24, v151, v155
    v_max3_u32 v25, v25, v151, v155
    v_cmp_eq_u32 vcc, s34, v24
    v_cmp_eq_u32 s[56:57], s34, v25
    s_and_b64 vcc, vcc, s[56:57]
    s_cmp_eq_u64 vcc, -1
    s_nop 2
    s_cbranch_scc1 .gpd_119
    s_sub_u32 s35, s35, 1
    s_cbranch_scc1 .Lexit
    s_branch .gp_117
.gpd_119:
    v_perm_b32 v123, v120, v121, s60
    v_perm_b32 v123, v123, v122, s61
    v_perm_b32 v127, v124, v125, s60
    v_perm_b32 v127, v127, v126, s61
    v_perm_b32 v131, v128, v129, s60
    v_perm_b32 v131, v131, v130, s61
    v_perm_b32 v135, v132, v133, s60
    v_perm_b32 v135, v135, v134, s61
    v_perm_b32 v139, v136, v137, s60
    v_perm_b32 v139, v139, v138, s61
    v_perm_b32 v143, v140, v141, s60
    v_perm_b32 v143, v143, v142, s61
    v_perm_b32 v147, v144, v145, s60
    v_perm_b32 v147, v147, v146, s61
    v_perm_b32 v151, v148, v149, s60
    v_perm_b32 v151, v151, v150, s61
    v_perm_b32 v155, v152, v153, s60
    v_perm_b32 v155, v155, v154, s61
    v_pk_add_f32 v[120:121], v[120:121], v[124:125]
    v_pk_add_f32 v[122:123], v[122:123], v[126:127]
    v_pk_add_f32 v[128:129], v[128:129], v[132:133]
    v_pk_add_f32 v[130:131], v[130:131], v[134:135]
    v_pk_add_f32 v[136:137], v[136:137], v[140:141]
    v_pk_add_f32 v[138:139], v[138:139], v[142:143]
    v_pk_add_f32 v[144:145], v[144:145], v[148:149]
    v_pk_add_f32 v[146:147], v[146:147], v[150:151]
    v_pk_add_f32 v[120:121], v[120:121], v[128:129]
    v_pk_add_f32 v[122:123], v[122:123], v[130:131]
    v_pk_add_f32 v[136:137], v[136:137], v[144:145]
    v_pk_add_f32 v[138:139], v[138:139], v[146:147]
    v_pk_add_f32 v[120:121], v[120:121], v[136:137]
    v_pk_add_f32 v[122:123], v[122:123], v[138:139]
    v_pk_add_f32 v[120:121], v[120:121], v[152:153]
    v_pk_add_f32 v[122:123], v[122:123], v[154:155]
    s_nop 1
    v_permlane32_swap_b32 v120, v122
    v_permlane32_swap_b32 v121, v123
    v_pk_add_f32 v[120:121], v[120:121], v[122:123]
    s_nop 1
    v_permlane16_swap_b32 v120, v121
    v_add_f32 v120, v120, v121
    s_nop 1
    v_add_f32_dpp v120, v120, v120 row_ror:8 row_mask:0xf bank_mask:0xf
    v_cvt_pk_bf16_f32 v120, v120, v120
    v_lshlrev_b32 v120, 16, v120
    v_mul_f32 v120, v120, v14
    v_cvt_pk_bf16_f32 v120, v120, v120
    v_lshlrev_b32 v120, 16, v120
    v_add_f32 v120, v120, v41
    v_cvt_pk_bf16_f32 v120, v120, v120
    v_lshlrev_b32 v120, 16, v120
    v_mul_f32 v120, v120, v81
    v_cvt_pk_bf16_f32 v120, v120, v120
    v_lshlrev_b32 v120, 16, v120
    v_add_f32 v120, v120, v40
    v_cvt_pk_bf16_f32 v120, v120, v120
    s_mov_b32 exec_lo, s62
    s_mov_b32 exec_hi, s62
    buffer_store_short v120, v7, s[48:51], s100 offen
    s_mov_b64 exec, -1
    s_or_b32 s56, s2, s3
    s_cmp_lg_u32 s56, 0
    s_cbranch_scc1 .Lexit
    v_mov_b32 v13, s34
    v_mov_b32 v12, 0
    s_mov_b64 exec, 1
    buffer_store_dword v13, v12, s[36:39], 0 offen
    s_mov_b64 exec, -1
    s_branch .Lexit
.Lbc:
    s_sub_u32 s56, s65, 9
    s_mov_b32 s57, 0x63054210
    s_cmp_eq_u32 s65, 14
    s_cselect_b32 s56, s64, s56
    s_cselect_b32 s57, 0x37654210, s57
    s_cselect_b32 s99, 8, s64
    s_lshl_b32 s56, s56, 2
    s_lshr_b32 s56, s57, s56
    s_and_b32 s56, s56, 7
    s_cmp_eq_u32 s65, 17
    s_cselect_b32 s56, 7, s56
    s_lshl3_add_u32 s99, s99, s56
    s_and_b32 s56, s99, 7
    s_cmp_eq_u32 s56, 3
    s_mov_b32 s14, 0xb5b5b5b5
    s_cselect_b32 s14, 0x0, s14
    s_mov_b32 s15, 0xd6d6b6b6
    s_cselect_b32 s15, 0x0, s15
    s_cselect_b32 s30, -50, 0
    s_add_u32 s30, s30, 0
    s_add_u32 s30, s30, s70
    s_mov_b32 s31, s70
    s_mov_b32 s48, s18
    s_and_b32 s49, s19, 0xffff
    s_mov_b32 s50, 0x510000
    s_mov_b32 s51, 0x00020000
    s_mov_b32 s52, s20
    s_and_b32 s53, s21, 0xffff
    s_mov_b32 s54, 0x510000
    s_mov_b32 s55, 0x00020000
    v_bfe_u32 v12, v0, 4, 1
    s_and_b32 s56, s3, 3
    s_lshl_b32 s56, s56, 1
    v_or_b32 v12, s56, v12
    v_and_b32 v6, 7, v0
    v_xor_b32 v12, v12, v6
    v_lshrrev_b32 v6, 3, v0
    v_mul_u32_u24 v6, 9216, v6
    v_lshl_add_u32 v6, v12, 4, v6
    s_mul_i32 s100, s3, 73728
    s_lshl_b32 s56, s99, 7
    s_add_u32 s100, s100, s56
    s_lshl_b32 s101, s3, 10
    s_waitcnt lgkmcnt(0)
    s_add_u32 s34, s34, 1
    s_getreg_b32 s1, hwreg(HW_REG_XCC_ID)
    s_lshl_b32 s1, s1, 24
    s_add_u32 s1, s1, s34
    s_lshr_b32 s0, s2, 3
    s_lshl3_add_u32 s63, s64, s3
    s_lshl_b32 s63, s63, 5
    s_add_u32 s0, s0, s63
    s_lshl2_add_u32 s0, s0, 0x480000
    v_mov_b32 v30, s1
    s_mov_b64 exec, 1
    buffer_store_dword v30, v2, s[36:39], s0 offen sc1
    s_mov_b64 exec, -1
    v_and_b32 v8, 1, v0
    v_lshlrev_b32 v8, 8, v8
    v_and_b32 v9, 0x3c, v0
    v_lshl_add_u32 v9, v9, 2, v8
    v_lshlrev_b32 v7, 1, v9
    v_and_b32 v9, 0x3c, v0
    v_lshrrev_b32 v8, 4, v8
    v_lshl_add_u32 v9, v9, 3, v8
    s_lshl_b32 s58, s66, 14
    s_lshl_b32 s59, s67, 10
    s_add_u32 s58, s58, s59
    s_add_u32 s58, s58, 0x70000
    s_lshl4_add_u32 s59, s66, s67
    s_lshl_b32 s59, s59, 11
    s_add_u32 s59, s59, 0x430000
    s_bitcmp1_b64 s[14:15], 4
    s_cbranch_scc0 1
    s_waitcnt vmcnt(3)
    s_add_u32 s63, s69, 32768
    buffer_load_dwordx4 v[96:99], v1, s[40:43], s63 offen nt
    s_waitcnt vmcnt(5)
    s_add_u32 m0, s101, 0
    s_add_u32 s56, s100, 0
    buffer_load_dwordx4 v6, s[48:51], s56 offen nt lds
    s_waitcnt vmcnt(5)
    s_bitcmp1_b64 s[14:15], 5
    s_cbranch_scc0 1
    s_waitcnt vmcnt(3)
    s_add_u32 s63, s69, 40960
    buffer_load_dwordx4 v[100:103], v1, s[40:43], s63 offen nt
    s_waitcnt vmcnt(5)
    s_bitcmp1_b64 s[14:15], 6
    s_cbranch_scc0 1
    s_waitcnt vmcnt(2)
    s_add_u32 s63, s69, 49152
    buffer_load_dwordx4 v[128:131], v1, s[40:43], s63 offen nt
    s_waitcnt vmcnt(5)
    s_add_u32 m0, s101, 8192
    s_add_u32 s56, s100, 589824
    buffer_load_dwordx4 v6, s[48:51], s56 offen nt lds
    s_waitcnt vmcnt(4)
    s_bitcmp1_b64 s[14:15], 7
    s_cbranch_scc0 1
    s_waitcnt vmcnt(2)
    s_add_u32 s63, s69, 57344
    buffer_load_dwordx4 v[132:135], v1, s[40:43], s63 offen nt
    s_waitcnt vmcnt(4)
    s_bitcmp1_b64 s[14:15], 8
    s_cbranch_scc0 1
    s_waitcnt vmcnt(2)
    s_add_u32 s63, s69, 131072
    buffer_load_dwordx4 v[40:43], v1, s[40:43], s63 offen nt
    s_memrealtime s[8:9]
    s_waitcnt lgkmcnt(0)
    s_sub_u32 s8, s8, s30
    s_cmpk_ge_u32 s8, 440
    s_cbranch_scc1 .ap_120
    s_waitcnt vmcnt(5)
    s_cmpk_ge_u32 s8, 340
    s_cbranch_scc1 .ap_120
    s_waitcnt vmcnt(4)
    s_bitcmp1_b64 s[14:15], 9
    s_cbranch_scc0 1
    s_waitcnt vmcnt(2)
    s_cmpk_ge_u32 s8, 220
    s_cbranch_scc1 .ap_120
    s_waitcnt vmcnt(1)
.ap_120:
    s_add_u32 s63, s69, 139264
    buffer_load_dwordx4 v[44:47], v1, s[40:43], s63 offen nt
    s_memrealtime s[8:9]
    s_waitcnt lgkmcnt(0)
    s_sub_u32 s8, s8, s30
    s_cmpk_ge_u32 s8, 475
    s_cbranch_scc1 .ap_121
    s_waitcnt vmcnt(5)
    s_cmpk_ge_u32 s8, 375
    s_cbranch_scc1 .ap_121
    s_waitcnt vmcnt(4)
    s_bitcmp1_b64 s[14:15], 10
    s_cbranch_scc0 1
    s_waitcnt vmcnt(2)
    s_cmpk_ge_u32 s8, 255
    s_cbranch_scc1 .ap_121
    s_waitcnt vmcnt(1)
.ap_121:
    s_add_u32 s63, s69, 147456
    buffer_load_dwordx4 v[72:75], v1, s[40:43], s63 offen nt
    s_memrealtime s[8:9]
    s_waitcnt lgkmcnt(0)
    s_sub_u32 s8, s8, s30
    s_cmpk_ge_u32 s8, 510
    s_cbranch_scc1 .ap_122
    s_waitcnt vmcnt(5)
    s_cmpk_ge_u32 s8, 410
    s_cbranch_scc1 .ap_122
    s_waitcnt vmcnt(4)
    s_cmpk_ge_u32 s8, 290
    s_cbranch_scc1 .ap_122
    s_waitcnt vmcnt(1)
.ap_122:
    s_add_u32 m0, s101, 16384
    s_add_u32 s56, s100, 1179648
    buffer_load_dwordx4 v6, s[48:51], s56 offen nt lds
    s_memrealtime s[8:9]
    s_waitcnt lgkmcnt(0)
    s_sub_u32 s8, s8, s30
    s_cmpk_ge_u32 s8, 510
    s_cbranch_scc1 .ap_123
    s_waitcnt vmcnt(5)
    s_cmpk_ge_u32 s8, 410
    s_cbranch_scc1 .ap_123
    s_waitcnt vmcnt(4)
    s_bitcmp1_b64 s[14:15], 11
    s_cbranch_scc0 1
    s_waitcnt vmcnt(2)
    s_cmpk_ge_u32 s8, 290
    s_cbranch_scc1 .ap_123
    s_waitcnt vmcnt(1)
.ap_123:
    s_add_u32 s63, s69, 155648
    buffer_load_dwordx4 v[76:79], v1, s[40:43], s63 offen nt
    s_memrealtime s[8:9]
    s_waitcnt vmcnt(8)
    s_waitcnt lgkmcnt(0)
    s_sub_u32 s8, s8, s30
    s_cmpk_ge_u32 s8, 545
    s_cbranch_scc1 .ap_124
    s_waitcnt vmcnt(5)
    s_cmpk_ge_u32 s8, 445
    s_cbranch_scc1 .ap_124
    s_waitcnt vmcnt(4)
    s_bitcmp1_b64 s[14:15], 12
    s_cbranch_scc0 1
    s_waitcnt vmcnt(2)
    s_cmpk_ge_u32 s8, 325
    s_cbranch_scc1 .ap_124
    s_waitcnt vmcnt(1)
.ap_124:
    s_add_u32 s63, s69, 163840
    buffer_load_dwordx4 v[104:107], v1, s[40:43], s63 offen nt
    v_and_b32 v157, 7, v0
    v_lshlrev_b32 v157, 2, v157
    s_mov_b32 s63, 0x4a1100
    buffer_load_dword v156, v157, s[36:39], s63 offen
    s_memrealtime s[8:9]
    s_waitcnt vmcnt(9)
    s_waitcnt lgkmcnt(0)
    s_sub_u32 s8, s8, s30
    s_cmpk_ge_u32 s8, 580
    s_cbranch_scc1 .ap_125
    s_waitcnt vmcnt(6)
    s_cmpk_ge_u32 s8, 480
    s_cbranch_scc1 .ap_125
    s_waitcnt vmcnt(5)
    s_bitcmp1_b64 s[14:15], 13
    s_cbranch_scc0 1
    s_waitcnt vmcnt(3)
    s_cmpk_ge_u32 s8, 360
    s_cbranch_scc1 .ap_125
    s_waitcnt vmcnt(2)
.ap_125:
    s_add_u32 s63, s69, 172032
    buffer_load_dwordx4 v[108:111], v1, s[40:43], s63 offen nt
    s_memrealtime s[8:9]
    s_waitcnt vmcnt(9)
    s_waitcnt lgkmcnt(0)
    s_sub_u32 s8, s8, s30
    s_cmpk_ge_u32 s8, 615
    s_cbranch_scc1 .ap_126
    s_waitcnt vmcnt(6)
    s_cmpk_ge_u32 s8, 515
    s_cbranch_scc1 .ap_126
    s_waitcnt vmcnt(5)
    s_bitcmp1_b64 s[14:15], 14
    s_cbranch_scc0 1
    s_waitcnt vmcnt(3)
    s_cmpk_ge_u32 s8, 395
    s_cbranch_scc1 .ap_126
    s_waitcnt vmcnt(2)
.ap_126:
    s_add_u32 s63, s69, 180224
    buffer_load_dwordx4 v[136:139], v1, s[40:43], s63 offen nt
    s_memrealtime s[8:9]
    s_waitcnt vmcnt(9)
    s_waitcnt lgkmcnt(0)
    s_sub_u32 s8, s8, s30
    s_cmpk_ge_u32 s8, 650
    s_cbranch_scc1 .ap_127
    s_waitcnt vmcnt(6)
    s_cmpk_ge_u32 s8, 550
    s_cbranch_scc1 .ap_127
    s_waitcnt vmcnt(5)
    s_cmpk_ge_u32 s8, 430
    s_cbranch_scc1 .ap_127
    s_waitcnt vmcnt(1)
.ap_127:
    s_add_u32 m0, s101, 24576
    s_add_u32 s56, s100, 1769472
    buffer_load_dwordx4 v6, s[48:51], s56 offen nt lds
    s_memrealtime s[8:9]
    s_waitcnt vmcnt(9)
    s_waitcnt lgkmcnt(0)
    s_sub_u32 s8, s8, s30
    s_cmpk_ge_u32 s8, 650
    s_cbranch_scc1 .ap_128
    s_waitcnt vmcnt(6)
    s_cmpk_ge_u32 s8, 550
    s_cbranch_scc1 .ap_128
    s_waitcnt vmcnt(5)
    s_bitcmp1_b64 s[14:15], 15
    s_cbranch_scc0 1
    s_waitcnt vmcnt(2)
    s_cmpk_ge_u32 s8, 430
    s_cbranch_scc1 .ap_128
    s_waitcnt vmcnt(1)
.ap_128:
    s_add_u32 s63, s69, 188416
    buffer_load_dwordx4 v[140:143], v1, s[40:43], s63 offen nt
    s_memrealtime s[8:9]
    s_waitcnt vmcnt(9)
    s_waitcnt lgkmcnt(0)
    s_sub_u32 s8, s8, s30
    s_cmpk_ge_u32 s8, 685
    s_cbranch_scc1 .ap_129
    s_waitcnt vmcnt(6)
    s_cmpk_ge_u32 s8, 585
    s_cbranch_scc1 .ap_129
    s_waitcnt vmcnt(5)
    s_bitcmp1_b64 s[14:15], 16
    s_cbranch_scc0 1
    s_waitcnt vmcnt(2)
    s_cmpk_ge_u32 s8, 465
    s_cbranch_scc1 .ap_129
    s_waitcnt vmcnt(1)
.ap_129:
    s_add_u32 s63, s69, 262144
    buffer_load_dwordx4 v[48:51], v1, s[40:43], s63 offen nt
    s_waitcnt vmcnt(5)
    s_sub_u32 s63, s70, 300
    v_subrev_u32 v156, s63, v156
    v_mov_b32 v157, 600
    v_cmp_lt_u32 s[8:9], v156, v157
    v_add_u32_dpp v156, v156, v156 quad_perm:[1,0,3,2] row_mask:0xf bank_mask:0xf
    s_nop 1
    v_add_u32_dpp v156, v156, v156 quad_perm:[2,3,0,1] row_mask:0xf bank_mask:0xf
    s_nop 1
    v_add_u32_dpp v156, v156, v156 row_ror:4 row_mask:0xf bank_mask:0xf
    s_nop 0
    v_readfirstlane_b32 s63, v156
    s_cmp_eq_u64 s[8:9], -1
    s_nop 3
    s_cbranch_scc0 .et_130
    s_lshr_b32 s63, s63, 3
    s_sub_u32 s63, s63, 300
    s_add_u32 s30, s30, s63
    s_add_u32 s31, s31, s63
.et_130:
    s_memrealtime s[8:9]
    s_waitcnt lgkmcnt(0)
    s_sub_u32 s8, s8, s30
    s_cmpk_ge_u32 s8, 720
    s_cbranch_scc1 .ap_131
    s_waitcnt vmcnt(5)
    s_cmpk_ge_u32 s8, 620
    s_cbranch_scc1 .ap_131
    s_waitcnt vmcnt(4)
    s_bitcmp1_b64 s[14:15], 17
    s_cbranch_scc0 1
    s_waitcnt vmcnt(2)
    s_cmpk_ge_u32 s8, 500
    s_cbranch_scc1 .ap_131
    s_waitcnt vmcnt(1)
.ap_131:
    s_add_u32 s63, s69, 270336
    buffer_load_dwordx4 v[52:55], v1, s[40:43], s63 offen nt
    s_memrealtime s[8:9]
    s_waitcnt lgkmcnt(0)
    s_sub_u32 s8, s8, s30
    s_cmpk_ge_u32 s8, 756
    s_cbranch_scc1 .ap_132
    s_waitcnt vmcnt(5)
    s_cmpk_ge_u32 s8, 656
    s_cbranch_scc1 .ap_132
    s_waitcnt vmcnt(4)
    s_bitcmp1_b64 s[14:15], 18
    s_cbranch_scc0 1
    s_waitcnt vmcnt(2)
    s_cmpk_ge_u32 s8, 536
    s_cbranch_scc1 .ap_132
    s_waitcnt vmcnt(1)
.ap_132:
    s_add_u32 s63, s69, 278528
    buffer_load_dwordx4 v[80:83], v1, s[40:43], s63 offen nt
    s_memrealtime s[8:9]
    s_waitcnt lgkmcnt(0)
    s_sub_u32 s8, s8, s30
    s_cmpk_ge_u32 s8, 792
    s_cbranch_scc1 .ap_133
    s_waitcnt vmcnt(5)
    s_cmpk_ge_u32 s8, 692
    s_cbranch_scc1 .ap_133
    s_waitcnt vmcnt(4)
    s_cmpk_ge_u32 s8, 572
    s_cbranch_scc1 .ap_133
    s_waitcnt vmcnt(1)
.ap_133:
    s_add_u32 m0, s101, 32768
    s_add_u32 s56, s100, 2359296
    buffer_load_dwordx4 v6, s[48:51], s56 offen nt lds
    s_memrealtime s[8:9]
    s_waitcnt lgkmcnt(0)
    s_sub_u32 s8, s8, s30
    s_cmpk_ge_u32 s8, 792
    s_cbranch_scc1 .ap_134
    s_waitcnt vmcnt(5)
    s_cmpk_ge_u32 s8, 692
    s_cbranch_scc1 .ap_134
    s_waitcnt vmcnt(4)
    s_bitcmp1_b64 s[14:15], 19
    s_cbranch_scc0 1
    s_waitcnt vmcnt(2)
    s_cmpk_ge_u32 s8, 572
    s_cbranch_scc1 .ap_134
    s_waitcnt vmcnt(1)
.ap_134:
    s_add_u32 s63, s69, 286720
    buffer_load_dwordx4 v[84:87], v1, s[40:43], s63 offen nt
    s_memrealtime s[8:9]
    s_waitcnt vmcnt(8)
    s_waitcnt lgkmcnt(0)
    s_sub_u32 s8, s8, s30
    s_cmpk_ge_u32 s8, 828
    s_cbranch_scc1 .ap_135
    s_waitcnt vmcnt(5)
    s_cmpk_ge_u32 s8, 728
    s_cbranch_scc1 .ap_135
    s_waitcnt vmcnt(4)
    s_bitcmp1_b64 s[14:15], 20
    s_cbranch_scc0 1
    s_waitcnt vmcnt(2)
    s_cmpk_ge_u32 s8, 608
    s_cbranch_scc1 .ap_135
    s_waitcnt vmcnt(1)
.ap_135:
    s_add_u32 s63, s69, 294912
    buffer_load_dwordx4 v[112:115], v1, s[40:43], s63 offen nt
    s_memrealtime s[8:9]
    s_waitcnt vmcnt(8)
    s_waitcnt lgkmcnt(0)
    s_sub_u32 s8, s8, s30
    s_cmpk_ge_u32 s8, 865
    s_cbranch_scc1 .ap_136
    s_waitcnt vmcnt(5)
    s_cmpk_ge_u32 s8, 765
    s_cbranch_scc1 .ap_136
    s_waitcnt vmcnt(4)
    s_bitcmp1_b64 s[14:15], 21
    s_cbranch_scc0 1
    s_waitcnt vmcnt(2)
    s_cmpk_ge_u32 s8, 645
    s_cbranch_scc1 .ap_136
    s_waitcnt vmcnt(1)
.ap_136:
    s_add_u32 s63, s69, 303104
    buffer_load_dwordx4 v[116:119], v1, s[40:43], s63 offen nt
    s_memrealtime s[8:9]
    s_waitcnt vmcnt(8)
    s_waitcnt lgkmcnt(0)
    s_sub_u32 s8, s8, s30
    s_cmpk_ge_u32 s8, 901
    s_cbranch_scc1 .ap_137
    s_waitcnt vmcnt(5)
    s_cmpk_ge_u32 s8, 801
    s_cbranch_scc1 .ap_137
    s_waitcnt vmcnt(4)
    s_bitcmp1_b64 s[14:15], 22
    s_cbranch_scc0 1
    s_waitcnt vmcnt(2)
    s_cmpk_ge_u32 s8, 681
    s_cbranch_scc1 .ap_137
    s_waitcnt vmcnt(1)
.ap_137:
    s_add_u32 s63, s69, 311296
    buffer_load_dwordx4 v[144:147], v1, s[40:43], s63 offen nt
    s_memrealtime s[8:9]
    s_waitcnt vmcnt(8)
    s_waitcnt lgkmcnt(0)
    s_sub_u32 s8, s8, s30
    s_cmpk_ge_u32 s8, 937
    s_cbranch_scc1 .ap_138
    s_waitcnt vmcnt(5)
    s_cmpk_ge_u32 s8, 837
    s_cbranch_scc1 .ap_138
    s_waitcnt vmcnt(4)
    s_cmpk_ge_u32 s8, 717
    s_cbranch_scc1 .ap_138
    s_waitcnt vmcnt(1)
.ap_138:
    s_add_u32 m0, s101, 40960
    s_add_u32 s56, s100, 2949120
    buffer_load_dwordx4 v6, s[48:51], s56 offen nt lds
    s_memrealtime s[8:9]
    s_waitcnt vmcnt(8)
    s_waitcnt lgkmcnt(0)
    s_sub_u32 s8, s8, s30
    s_cmpk_ge_u32 s8, 937
    s_cbranch_scc1 .ap_139
    s_waitcnt vmcnt(5)
    s_cmpk_ge_u32 s8, 837
    s_cbranch_scc1 .ap_139
    s_waitcnt vmcnt(4)
    s_bitcmp1_b64 s[14:15], 23
    s_cbranch_scc0 1
    s_waitcnt vmcnt(2)
    s_cmpk_ge_u32 s8, 717
    s_cbranch_scc1 .ap_139
    s_waitcnt vmcnt(1)
.ap_139:
    s_add_u32 s63, s69, 319488
    buffer_load_dwordx4 v[148:151], v1, s[40:43], s63 offen nt
    s_memrealtime s[8:9]
    s_waitcnt vmcnt(8)
    s_waitcnt lgkmcnt(0)
    s_sub_u32 s8, s8, s30
    s_cmpk_ge_u32 s8, 973
    s_cbranch_scc1 .ap_140
    s_waitcnt vmcnt(5)
    s_cmpk_ge_u32 s8, 873
    s_cbranch_scc1 .ap_140
    s_waitcnt vmcnt(4)
    s_bitcmp1_b64 s[14:15], 24
    s_cbranch_scc0 1
    s_waitcnt vmcnt(2)
    s_cmpk_ge_u32 s8, 753
    s_cbranch_scc1 .ap_140
    s_waitcnt vmcnt(1)
.ap_140:
    s_add_u32 s63, s69, 393216
    buffer_load_dwordx4 v[56:59], v1, s[40:43], s63 offen nt
    s_memrealtime s[8:9]
    s_waitcnt vmcnt(8)
    s_waitcnt lgkmcnt(0)
    s_sub_u32 s8, s8, s30
    s_cmpk_ge_u32 s8, 1010
    s_cbranch_scc1 .ap_141
    s_waitcnt vmcnt(5)
    s_cmpk_ge_u32 s8, 910
    s_cbranch_scc1 .ap_141
    s_waitcnt vmcnt(4)
    s_bitcmp1_b64 s[14:15], 25
    s_cbranch_scc0 1
    s_waitcnt vmcnt(2)
    s_cmpk_ge_u32 s8, 790
    s_cbranch_scc1 .ap_141
    s_waitcnt vmcnt(1)
.ap_141:
    s_add_u32 s63, s69, 401408
    buffer_load_dwordx4 v[60:63], v1, s[40:43], s63 offen nt
    s_memrealtime s[8:9]
    s_waitcnt vmcnt(8)
    s_waitcnt lgkmcnt(0)
    s_sub_u32 s8, s8, s30
    s_cmpk_ge_u32 s8, 1050
    s_cbranch_scc1 .ap_142
    s_waitcnt vmcnt(5)
    s_cmpk_ge_u32 s8, 950
    s_cbranch_scc1 .ap_142
    s_waitcnt vmcnt(4)
    s_bitcmp1_b64 s[14:15], 26
    s_cbranch_scc0 1
    s_waitcnt vmcnt(2)
    s_cmpk_ge_u32 s8, 830
    s_cbranch_scc1 .ap_142
    s_waitcnt vmcnt(1)
.ap_142:
    s_add_u32 s63, s69, 409600
    buffer_load_dwordx4 v[88:91], v1, s[40:43], s63 offen nt
    s_memrealtime s[8:9]
    s_waitcnt vmcnt(8)
    s_waitcnt lgkmcnt(0)
    s_sub_u32 s8, s8, s30
    s_cmpk_ge_u32 s8, 1090
    s_cbranch_scc1 .ap_143
    s_waitcnt vmcnt(5)
    s_cmpk_ge_u32 s8, 990
    s_cbranch_scc1 .ap_143
    s_waitcnt vmcnt(4)
    s_cmpk_ge_u32 s8, 870
    s_cbranch_scc1 .ap_143
    s_waitcnt vmcnt(1)
.ap_143:
    s_add_u32 m0, s101, 49152
    s_add_u32 s56, s100, 3538944
    buffer_load_dwordx4 v6, s[48:51], s56 offen nt lds
    s_memrealtime s[8:9]
    s_waitcnt vmcnt(8)
    s_waitcnt lgkmcnt(0)
    s_sub_u32 s8, s8, s30
    s_cmpk_ge_u32 s8, 1090
    s_cbranch_scc1 .ap_144
    s_waitcnt vmcnt(5)
    s_cmpk_ge_u32 s8, 990
    s_cbranch_scc1 .ap_144
    s_waitcnt vmcnt(4)
    s_bitcmp1_b64 s[14:15], 27
    s_cbranch_scc0 1
    s_waitcnt vmcnt(2)
    s_cmpk_ge_u32 s8, 870
    s_cbranch_scc1 .ap_144
    s_waitcnt vmcnt(1)
.ap_144:
    s_add_u32 s63, s69, 417792
    buffer_load_dwordx4 v[92:95], v1, s[40:43], s63 offen nt
    s_memrealtime s[8:9]
    s_waitcnt vmcnt(8)
    s_waitcnt lgkmcnt(0)
    s_sub_u32 s8, s8, s30
    s_cmpk_ge_u32 s8, 1130
    s_cbranch_scc1 .ap_145
    s_waitcnt vmcnt(5)
    s_cmpk_ge_u32 s8, 1030
    s_cbranch_scc1 .ap_145
    s_waitcnt vmcnt(4)
    s_bitcmp1_b64 s[14:15], 28
    s_cbranch_scc0 1
    s_waitcnt vmcnt(2)
    s_cmpk_ge_u32 s8, 910
    s_cbranch_scc1 .ap_145
    s_waitcnt vmcnt(1)
.ap_145:
    s_add_u32 s63, s69, 425984
    buffer_load_dwordx4 v[120:123], v1, s[40:43], s63 offen nt
    s_memrealtime s[8:9]
    s_waitcnt vmcnt(8)
    s_waitcnt lgkmcnt(0)
    s_sub_u32 s8, s8, s30
    s_cmpk_ge_u32 s8, 1170
    s_cbranch_scc1 .ap_146
    s_waitcnt vmcnt(5)
    s_cmpk_ge_u32 s8, 1070
    s_cbranch_scc1 .ap_146
    s_waitcnt vmcnt(4)
    s_bitcmp1_b64 s[14:15], 29
    s_cbranch_scc0 1
    s_waitcnt vmcnt(2)
    s_cmpk_ge_u32 s8, 950
    s_cbranch_scc1 .ap_146
    s_waitcnt vmcnt(1)
.ap_146:
    s_add_u32 s63, s69, 434176
    buffer_load_dwordx4 v[124:127], v1, s[40:43], s63 offen nt
    s_memrealtime s[8:9]
    s_waitcnt vmcnt(8)
    s_waitcnt lgkmcnt(0)
    s_sub_u32 s8, s8, s30
    s_cmpk_ge_u32 s8, 1210
    s_cbranch_scc1 .ap_147
    s_waitcnt vmcnt(5)
    s_cmpk_ge_u32 s8, 1110
    s_cbranch_scc1 .ap_147
    s_waitcnt vmcnt(4)
    s_bitcmp1_b64 s[14:15], 30
    s_cbranch_scc0 1
    s_waitcnt vmcnt(2)
    s_cmpk_ge_u32 s8, 990
    s_cbranch_scc1 .ap_147
    s_waitcnt vmcnt(1)
.ap_147:
    s_add_u32 s63, s69, 442368
    buffer_load_dwordx4 v[152:155], v1, s[40:43], s63 offen nt
    s_memrealtime s[8:9]
    s_waitcnt vmcnt(8)
    s_waitcnt lgkmcnt(0)
    s_sub_u32 s8, s8, s30
    s_cmpk_ge_u32 s8, 1250
    s_cbranch_scc1 .ap_148
    s_waitcnt vmcnt(5)
    s_cmpk_ge_u32 s8, 1150
    s_cbranch_scc1 .ap_148
    s_waitcnt vmcnt(4)
    s_cmpk_ge_u32 s8, 1030
    s_cbranch_scc1 .ap_148
    s_waitcnt vmcnt(1)
.ap_148:
    s_add_u32 m0, s101, 57344
    s_add_u32 s56, s100, 4128768
    buffer_load_dwordx4 v6, s[48:51], s56 offen nt lds
    s_memrealtime s[8:9]
    s_waitcnt vmcnt(8)
    s_waitcnt lgkmcnt(0)
    s_sub_u32 s8, s8, s30
    s_cmpk_ge_u32 s8, 1250
    s_cbranch_scc1 .ap_149
    s_waitcnt vmcnt(5)
    s_cmpk_ge_u32 s8, 1150
    s_cbranch_scc1 .ap_149
    s_waitcnt vmcnt(4)
    s_bitcmp1_b64 s[14:15], 31
    s_cbranch_scc0 1
    s_waitcnt vmcnt(2)
    s_cmpk_ge_u32 s8, 1030
    s_cbranch_scc1 .ap_149
    s_waitcnt vmcnt(1)
.ap_149:
    s_add_u32 s63, s69, 450560
    buffer_load_dwordx4 v[156:159], v1, s[40:43], s63 offen nt
    s_memrealtime s[8:9]
    s_waitcnt vmcnt(8)
    s_waitcnt lgkmcnt(0)
    s_sub_u32 s8, s8, s30
    s_cmpk_ge_u32 s8, 1290
    s_cbranch_scc1 .ap_150
    s_waitcnt vmcnt(5)
    s_cmpk_ge_u32 s8, 1190
    s_cbranch_scc1 .ap_150
    s_waitcnt vmcnt(4)
    s_bitcmp1_b64 s[14:15], 32
    s_cbranch_scc0 1
    s_waitcnt vmcnt(2)
    s_cmpk_ge_u32 s8, 1070
    s_cbranch_scc1 .ap_150
    s_waitcnt vmcnt(1)
.ap_150:
    v_bfe_u32 v1, v0, 4, 2
    v_and_b32 v10, 0xf0, v2
    v_lshlrev_b32 v1, 2, v1
    v_bfe_u32 v1, s6, v1, 4
    v_lshl_add_u32 v1, v1, 8, v10
    s_add_u32 s63, s69, 0
    buffer_load_dwordx4 v[160:163], v1, s[44:47], s63 offen nt
    s_memrealtime s[8:9]
    s_waitcnt vmcnt(8)
    s_waitcnt lgkmcnt(0)
    s_sub_u32 s8, s8, s30
    s_cmpk_ge_u32 s8, 1327
    s_cbranch_scc1 .ap_151
    s_waitcnt vmcnt(5)
    s_cmpk_ge_u32 s8, 1227
    s_cbranch_scc1 .ap_151
    s_waitcnt vmcnt(4)
    s_bitcmp1_b64 s[14:15], 33
    s_cbranch_scc0 1
    s_waitcnt vmcnt(2)
    s_cmpk_ge_u32 s8, 1107
    s_cbranch_scc1 .ap_151
    s_waitcnt vmcnt(1)
.ap_151:
    s_add_u32 s63, s69, 8192
    buffer_load_dwordx4 v[164:167], v1, s[44:47], s63 offen nt
    s_memrealtime s[8:9]
    s_waitcnt vmcnt(8)
    s_waitcnt lgkmcnt(0)
    s_sub_u32 s8, s8, s30
    s_cmpk_ge_u32 s8, 1365
    s_cbranch_scc1 .ap_152
    s_waitcnt vmcnt(5)
    s_cmpk_ge_u32 s8, 1265
    s_cbranch_scc1 .ap_152
    s_waitcnt vmcnt(4)
    s_bitcmp1_b64 s[14:15], 34
    s_cbranch_scc0 1
    s_waitcnt vmcnt(2)
    s_cmpk_ge_u32 s8, 1145
    s_cbranch_scc1 .ap_152
    s_waitcnt vmcnt(1)
.ap_152:
    s_add_u32 s63, s69, 16384
    buffer_load_dwordx4 v[168:171], v1, s[44:47], s63 offen nt
    s_memrealtime s[8:9]
    s_waitcnt vmcnt(8)
    s_waitcnt lgkmcnt(0)
    s_sub_u32 s8, s8, s30
    s_cmpk_ge_u32 s8, 1403
    s_cbranch_scc1 .ap_153
    s_waitcnt vmcnt(5)
    s_cmpk_ge_u32 s8, 1303
    s_cbranch_scc1 .ap_153
    s_waitcnt vmcnt(4)
    s_cmpk_ge_u32 s8, 1183
    s_cbranch_scc1 .ap_153
    s_waitcnt vmcnt(1)
.ap_153:
    s_add_u32 m0, s101, 65536
    s_add_u32 s56, s100, 4718592
    buffer_load_dwordx4 v6, s[48:51], s56 offen nt lds
    s_memrealtime s[8:9]
    s_waitcnt vmcnt(8)
    s_waitcnt lgkmcnt(0)
    s_sub_u32 s8, s8, s30
    s_cmpk_ge_u32 s8, 1403
    s_cbranch_scc1 .ap_154
    s_waitcnt vmcnt(5)
    s_cmpk_ge_u32 s8, 1303
    s_cbranch_scc1 .ap_154
    s_waitcnt vmcnt(4)
    s_bitcmp1_b64 s[14:15], 35
    s_cbranch_scc0 1
    s_waitcnt vmcnt(2)
    s_cmpk_ge_u32 s8, 1183
    s_cbranch_scc1 .ap_154
    s_waitcnt vmcnt(1)
.ap_154:
    s_add_u32 s63, s69, 24576
    buffer_load_dwordx4 v[172:175], v1, s[44:47], s63 offen nt
    s_memrealtime s[8:9]
    s_waitcnt vmcnt(8)
    s_waitcnt lgkmcnt(0)
    s_sub_u32 s8, s8, s30
    s_cmpk_ge_u32 s8, 1441
    s_cbranch_scc1 .ap_155
    s_waitcnt vmcnt(5)
    s_cmpk_ge_u32 s8, 1341
    s_cbranch_scc1 .ap_155
    s_waitcnt vmcnt(4)
    s_bitcmp1_b64 s[14:15], 36
    s_cbranch_scc0 1
    s_waitcnt vmcnt(2)
    s_cmpk_ge_u32 s8, 1221
    s_cbranch_scc1 .ap_155
    s_waitcnt vmcnt(1)
.ap_155:
    s_add_u32 s63, s69, 32768
    buffer_load_dwordx4 v[176:179], v1, s[44:47], s63 offen nt
    buffer_load_dwordx4 v[16:19], v7, s[36:39], s58 offen offset:0 sc1
    buffer_load_dwordx4 v[20:23], v7, s[36:39], s58 offen offset:16 sc1
    s_memrealtime s[8:9]
    s_waitcnt vmcnt(8)
    s_waitcnt lgkmcnt(0)
    s_sub_u32 s8, s8, s30
    s_cmpk_ge_u32 s8, 1478
    s_cbranch_scc1 .ap_156
    s_waitcnt vmcnt(5)
    s_cmpk_ge_u32 s8, 1378
    s_cbranch_scc1 .ap_156
    s_waitcnt vmcnt(4)
    s_bitcmp1_b64 s[14:15], 37
    s_cbranch_scc0 1
    s_waitcnt vmcnt(2)
    s_cmpk_ge_u32 s8, 1258
    s_cbranch_scc1 .ap_156
    s_waitcnt vmcnt(1)
.ap_156:
    s_add_u32 s63, s69, 40960
    buffer_load_dwordx4 v[180:183], v1, s[44:47], s63 offen nt
    s_memrealtime s[8:9]
    s_waitcnt vmcnt(8)
    s_waitcnt lgkmcnt(0)
    s_sub_u32 s8, s8, s30
    s_cmpk_ge_u32 s8, 1516
    s_cbranch_scc1 .ap_157
    s_waitcnt vmcnt(5)
    s_cmpk_ge_u32 s8, 1416
    s_cbranch_scc1 .ap_157
    s_waitcnt vmcnt(4)
    s_bitcmp1_b64 s[14:15], 38
    s_cbranch_scc0 1
    s_waitcnt vmcnt(2)
    s_cmpk_ge_u32 s8, 1296
    s_cbranch_scc1 .ap_157
    s_waitcnt vmcnt(1)
.ap_157:
    s_add_u32 s63, s69, 49152
    buffer_load_dwordx4 v[184:187], v1, s[44:47], s63 offen nt
    s_memrealtime s[8:9]
    s_waitcnt vmcnt(8)
    s_waitcnt lgkmcnt(0)
    s_sub_u32 s8, s8, s30
    s_cmpk_ge_u32 s8, 1554
    s_cbranch_scc1 .ap_158
    s_waitcnt vmcnt(5)
    s_cmpk_ge_u32 s8, 1454
    s_cbranch_scc1 .ap_158
    s_waitcnt vmcnt(4)
    s_cmpk_ge_u32 s8, 1334
    s_cbranch_scc1 .ap_158
    s_waitcnt vmcnt(1)
.ap_158:
    s_add_u32 m0, s101, 73728
    s_add_u32 s56, s100, 0
    buffer_load_dwordx4 v6, s[52:55], s56 offen nt lds
    s_memrealtime s[8:9]
    s_waitcnt vmcnt(8)
    s_waitcnt lgkmcnt(0)
    s_sub_u32 s8, s8, s30
    s_cmpk_ge_u32 s8, 1554
    s_cbranch_scc1 .ap_159
    s_waitcnt vmcnt(5)
    s_cmpk_ge_u32 s8, 1454
    s_cbranch_scc1 .ap_159
    s_waitcnt vmcnt(4)
    s_bitcmp1_b64 s[14:15], 39
    s_cbranch_scc0 1
    s_waitcnt vmcnt(2)
    s_cmpk_ge_u32 s8, 1334
    s_cbranch_scc1 .ap_159
    s_waitcnt vmcnt(1)
.ap_159:
    s_add_u32 s63, s69, 57344
    buffer_load_dwordx4 v[188:191], v1, s[44:47], s63 offen nt
    s_memrealtime s[8:9]
    s_waitcnt vmcnt(8)
    s_waitcnt lgkmcnt(0)
    s_sub_u32 s8, s8, s30
    s_cmpk_ge_u32 s8, 1592
    s_cbranch_scc1 .ap_160
    s_waitcnt vmcnt(5)
    s_cmpk_ge_u32 s8, 1492
    s_cbranch_scc1 .ap_160
    s_waitcnt vmcnt(4)
    s_bitcmp1_b64 s[14:15], 40
    s_cbranch_scc0 1
    s_waitcnt vmcnt(2)
    s_cmpk_ge_u32 s8, 1372
    s_cbranch_scc1 .ap_160
    s_waitcnt vmcnt(1)
.ap_160:
    s_add_u32 s63, s69, 131072
    buffer_load_dwordx4 v[192:195], v1, s[44:47], s63 offen nt
    s_waitcnt vmcnt(5)
    s_branch .gpc_162
.gp_161:
    buffer_load_dwordx4 v[16:19], v7, s[36:39], s58 offen offset:0 sc1
    buffer_load_dwordx4 v[20:23], v7, s[36:39], s58 offen offset:16 sc1
    s_waitcnt vmcnt(0)
.gpc_162:
    v_min_u32 v10, v17, v19
    v_max_u32 v11, v17, v19
    v_min3_u32 v10, v10, v21, v23
    v_max3_u32 v11, v11, v21, v23
    v_cmp_eq_u32 vcc, s34, v10
    v_cmp_eq_u32 s[56:57], s34, v11
    s_and_b64 vcc, vcc, s[56:57]
    s_cmp_eq_u64 vcc, -1
    s_nop 2
    s_cbranch_scc1 .gpd_163
    s_sub_u32 s35, s35, 1
    s_cbranch_scc1 .Lexit
    s_sleep 1
    s_branch .gp_161
.gpd_163:
    s_mov_b32 vcc_lo, 0xcccccccc
    s_mov_b32 vcc_hi, 0xcccccccc
    v_cndmask_b32_e64 v24, v16, 0, vcc
    v_cndmask_b32_e64 v25, v18, 0, vcc
    v_cndmask_b32_e64 v26, v20, 0, vcc
    v_cndmask_b32_e64 v27, v22, 0, vcc
    v_cndmask_b32_e32 v28, 0, v16, vcc
    v_cndmask_b32_e32 v29, 0, v18, vcc
    v_cndmask_b32_e32 v30, 0, v20, vcc
    v_cndmask_b32_e32 v31, 0, v22, vcc
    v_mfma_f32_16x16x32_bf16 v[16:19], v[32:35], v[24:27], 0
    v_mfma_f32_16x16x32_bf16 v[32:35], v[40:43], v[24:27], 0
    v_mfma_f32_16x16x32_bf16 v[16:19], v[36:39], v[28:31], v[16:19]
    v_mfma_f32_16x16x32_bf16 v[40:43], v[48:51], v[24:27], 0
    v_mfma_f32_16x16x32_bf16 v[32:35], v[44:47], v[28:31], v[32:35]
    v_mfma_f32_16x16x32_bf16 v[48:51], v[56:59], v[24:27], 0
    v_mfma_f32_16x16x32_bf16 v[40:43], v[52:55], v[28:31], v[40:43]
    v_mfma_f32_16x16x32_bf16 v[56:59], v[64:67], v[24:27], 0
    v_mfma_f32_16x16x32_bf16 v[48:51], v[60:63], v[28:31], v[48:51]
    s_nop 1
    v_add_f32_dpp v10, v17, v16 row_ror:12 row_mask:0xf bank_mask:0x1
    s_memrealtime s[8:9]
    s_waitcnt lgkmcnt(0)
    s_sub_u32 s8, s8, s30
    s_cmpk_ge_u32 s8, 1630
    s_nop 0
    s_cbranch_scc1 .ap_164
    s_waitcnt vmcnt(5)
    s_cmpk_ge_u32 s8, 1530
    s_cbranch_scc1 .ap_164
    s_waitcnt vmcnt(4)
    s_bitcmp1_b64 s[14:15], 41
    s_cbranch_scc0 1
    s_waitcnt vmcnt(2)
    s_cmpk_ge_u32 s8, 1410
    s_cbranch_scc1 .ap_164
    s_waitcnt vmcnt(1)
.ap_164:
    s_add_u32 s63, s69, 139264
    buffer_load_dwordx4 v[196:199], v1, s[44:47], s63 offen nt
    v_mfma_f32_16x16x32_bf16 v[64:67], v[72:75], v[24:27], 0
    v_mfma_f32_16x16x32_bf16 v[56:59], v[68:71], v[28:31], v[56:59]
    v_add_f32_dpp v11, v33, v32 row_ror:12 row_mask:0xf bank_mask:0x1
    v_add_f32_dpp v10, v18, v10 row_ror:8 row_mask:0xf bank_mask:0x1
    v_mfma_f32_16x16x32_bf16 v[72:75], v[80:83], v[24:27], 0
    v_mfma_f32_16x16x32_bf16 v[64:67], v[76:79], v[28:31], v[64:67]
    v_add_f32_dpp v12, v41, v40 row_ror:12 row_mask:0xf bank_mask:0x1
    v_add_f32_dpp v11, v34, v11 row_ror:8 row_mask:0xf bank_mask:0x1
    v_add_f32_dpp v10, v19, v10 row_ror:4 row_mask:0xf bank_mask:0x1
    v_mfma_f32_16x16x32_bf16 v[80:83], v[88:91], v[24:27], 0
    v_mfma_f32_16x16x32_bf16 v[72:75], v[84:87], v[28:31], v[72:75]
    v_add_f32_dpp v13, v49, v48 row_ror:12 row_mask:0xf bank_mask:0x1
    v_add_f32_dpp v12, v42, v12 row_ror:8 row_mask:0xf bank_mask:0x1
    v_add_f32_dpp v11, v35, v11 row_ror:4 row_mask:0xf bank_mask:0x1
    v_mfma_f32_16x16x32_bf16 v[88:91], v[96:99], v[24:27], 0
    v_mfma_f32_16x16x32_bf16 v[80:83], v[92:95], v[28:31], v[80:83]
    v_add_f32_dpp v10, v58, v57 row_ror:12 row_mask:0xf bank_mask:0x2
    v_add_f32_dpp v13, v50, v13 row_ror:8 row_mask:0xf bank_mask:0x1
    v_add_f32_dpp v12, v43, v12 row_ror:4 row_mask:0xf bank_mask:0x1
    s_memrealtime s[8:9]
    s_waitcnt lgkmcnt(0)
    s_sub_u32 s8, s8, s30
    s_cmpk_ge_u32 s8, 1652
    s_nop 0
    s_cbranch_scc1 .ap_165
    s_waitcnt vmcnt(5)
    s_cmpk_ge_u32 s8, 1552
    s_cbranch_scc1 .ap_165
    s_waitcnt vmcnt(4)
    s_bitcmp1_b64 s[14:15], 42
    s_cbranch_scc0 1
    s_waitcnt vmcnt(2)
    s_cmpk_ge_u32 s8, 1432
    s_cbranch_scc1 .ap_165
    s_waitcnt vmcnt(1)
.ap_165:
    s_add_u32 s63, s69, 147456
    buffer_load_dwordx4 v[200:203], v1, s[44:47], s63 offen nt
    s_memrealtime s[8:9]
    s_waitcnt lgkmcnt(0)
    s_sub_u32 s8, s8, s30
    s_cmpk_ge_u32 s8, 1675
    s_cbranch_scc1 .ap_166
    s_waitcnt vmcnt(5)
    s_cmpk_ge_u32 s8, 1575
    s_cbranch_scc1 .ap_166
    s_waitcnt vmcnt(4)
    s_cmpk_ge_u32 s8, 1455
    s_cbranch_scc1 .ap_166
    s_waitcnt vmcnt(1)
.ap_166:
    s_add_u32 m0, s101, 81920
    s_add_u32 s56, s100, 589824
    buffer_load_dwordx4 v6, s[52:55], s56 offen nt lds
    v_mfma_f32_16x16x32_bf16 v[96:99], v[104:107], v[24:27], 0
    v_mfma_f32_16x16x32_bf16 v[88:91], v[100:103], v[28:31], v[88:91]
    v_add_f32_dpp v11, v66, v65 row_ror:12 row_mask:0xf bank_mask:0x2
    v_add_f32_dpp v10, v59, v10 row_ror:8 row_mask:0xf bank_mask:0x2
    v_add_f32_dpp v13, v51, v13 row_ror:4 row_mask:0xf bank_mask:0x1
    v_mfma_f32_16x16x32_bf16 v[104:107], v[112:115], v[24:27], 0
    v_mfma_f32_16x16x32_bf16 v[96:99], v[108:111], v[28:31], v[96:99]
    v_add_f32_dpp v12, v74, v73 row_ror:12 row_mask:0xf bank_mask:0x2
    v_add_f32_dpp v11, v67, v11 row_ror:8 row_mask:0xf bank_mask:0x2
    v_add_f32_dpp v10, v56, v10 row_ror:4 row_mask:0xf bank_mask:0x2
    v_mfma_f32_16x16x32_bf16 v[112:115], v[120:123], v[24:27], 0
    v_mfma_f32_16x16x32_bf16 v[104:107], v[116:119], v[28:31], v[104:107]
    v_add_f32_dpp v13, v82, v81 row_ror:12 row_mask:0xf bank_mask:0x2
    v_add_f32_dpp v12, v75, v12 row_ror:8 row_mask:0xf bank_mask:0x2
    v_add_f32_dpp v11, v64, v11 row_ror:4 row_mask:0xf bank_mask:0x2
    v_mfma_f32_16x16x32_bf16 v[120:123], v[128:131], v[24:27], 0
    v_mfma_f32_16x16x32_bf16 v[112:115], v[124:127], v[28:31], v[112:115]
    v_add_f32_dpp v10, v91, v90 row_ror:12 row_mask:0xf bank_mask:0x4
    v_add_f32_dpp v13, v83, v13 row_ror:8 row_mask:0xf bank_mask:0x2
    v_add_f32_dpp v12, v72, v12 row_ror:4 row_mask:0xf bank_mask:0x2
    s_memrealtime s[8:9]
    s_waitcnt lgkmcnt(0)
    s_sub_u32 s8, s8, s30
    s_cmpk_ge_u32 s8, 1675
    s_nop 0
    s_cbranch_scc1 .ap_167
    s_waitcnt vmcnt(5)
    s_cmpk_ge_u32 s8, 1575
    s_cbranch_scc1 .ap_167
    s_waitcnt vmcnt(4)
    s_bitcmp1_b64 s[14:15], 43
    s_cbranch_scc0 1
    s_waitcnt vmcnt(2)
    s_cmpk_ge_u32 s8, 1455
    s_cbranch_scc1 .ap_167
    s_waitcnt vmcnt(1)
.ap_167:
    s_add_u32 s63, s69, 155648
    buffer_load_dwordx4 v[204:207], v1, s[44:47], s63 offen nt
    v_mfma_f32_16x16x32_bf16 v[128:131], v[136:139], v[24:27], 0
    v_mfma_f32_16x16x32_bf16 v[120:123], v[132:135], v[28:31], v[120:123]
    v_add_f32_dpp v11, v99, v98 row_ror:12 row_mask:0xf bank_mask:0x4
    v_add_f32_dpp v10, v88, v10 row_ror:8 row_mask:0xf bank_mask:0x4
    v_add_f32_dpp v13, v80, v13 row_ror:4 row_mask:0xf bank_mask:0x2
    v_mfma_f32_16x16x32_bf16 v[136:139], v[144:147], v[24:27], 0
    v_mfma_f32_16x16x32_bf16 v[128:131], v[140:143], v[28:31], v[128:131]
    v_add_f32_dpp v12, v107, v106 row_ror:12 row_mask:0xf bank_mask:0x4
    v_add_f32_dpp v11, v96, v11 row_ror:8 row_mask:0xf bank_mask:0x4
    v_add_f32_dpp v10, v89, v10 row_ror:4 row_mask:0xf bank_mask:0x4
    v_mfma_f32_16x16x32_bf16 v[144:147], v[152:155], v[24:27], 0
    v_mfma_f32_16x16x32_bf16 v[136:139], v[148:151], v[28:31], v[136:139]
    v_add_f32_dpp v13, v115, v114 row_ror:12 row_mask:0xf bank_mask:0x4
    v_add_f32_dpp v12, v104, v12 row_ror:8 row_mask:0xf bank_mask:0x4
    v_add_f32_dpp v11, v97, v11 row_ror:4 row_mask:0xf bank_mask:0x4
    v_mfma_f32_16x16x32_bf16 v[144:147], v[156:159], v[28:31], v[144:147]
    v_add_f32_dpp v10, v120, v123 row_ror:12 row_mask:0xf bank_mask:0x8
    v_add_f32_dpp v13, v112, v13 row_ror:8 row_mask:0xf bank_mask:0x4
    v_add_f32_dpp v12, v105, v12 row_ror:4 row_mask:0xf bank_mask:0x4
    s_memrealtime s[8:9]
    s_waitcnt vmcnt(8)
    s_waitcnt lgkmcnt(0)
    s_sub_u32 s8, s8, s30
    s_cmpk_ge_u32 s8, 1697
    s_cbranch_scc1 .ap_168
    s_waitcnt vmcnt(5)
    s_cmpk_ge_u32 s8, 1597
    s_cbranch_scc1 .ap_168
    s_waitcnt vmcnt(4)
    s_bitcmp1_b64 s[14:15], 44
    s_cbranch_scc0 1
    s_waitcnt vmcnt(2)
    s_cmpk_ge_u32 s8, 1477
    s_cbranch_scc1 .ap_168
    s_waitcnt vmcnt(1)
.ap_168:
    s_add_u32 s63, s69, 163840
    buffer_load_dwordx4 v[208:211], v1, s[44:47], s63 offen nt
    v_add_f32_dpp v11, v128, v131 row_ror:12 row_mask:0xf bank_mask:0x8
    v_add_f32_dpp v10, v121, v10 row_ror:8 row_mask:0xf bank_mask:0x8
    v_add_f32_dpp v13, v113, v13 row_ror:4 row_mask:0xf bank_mask:0x4
    v_add_f32_dpp v12, v136, v139 row_ror:12 row_mask:0xf bank_mask:0x8
    v_add_f32_dpp v11, v129, v11 row_ror:8 row_mask:0xf bank_mask:0x8
    v_add_f32_dpp v10, v122, v10 row_ror:4 row_mask:0xf bank_mask:0x8
    v_add_f32_dpp v13, v144, v147 row_ror:12 row_mask:0xf bank_mask:0x8
    v_add_f32_dpp v12, v137, v12 row_ror:8 row_mask:0xf bank_mask:0x8
    v_add_f32_dpp v11, v130, v11 row_ror:4 row_mask:0xf bank_mask:0x8
    v_add_f32_dpp v13, v145, v13 row_ror:8 row_mask:0xf bank_mask:0x8
    v_add_f32_dpp v12, v138, v12 row_ror:4 row_mask:0xf bank_mask:0x8
    s_memrealtime s[8:9]
    s_waitcnt vmcnt(8)
    s_waitcnt lgkmcnt(0)
    s_sub_u32 s8, s8, s30
    s_cmpk_ge_u32 s8, 1720
    s_cbranch_scc1 .ap_169
    s_waitcnt vmcnt(5)
    s_cmpk_ge_u32 s8, 1620
    s_cbranch_scc1 .ap_169
    s_waitcnt vmcnt(4)
    s_bitcmp1_b64 s[14:15], 45
    s_cbranch_scc0 1
    s_waitcnt vmcnt(2)
    s_cmpk_ge_u32 s8, 1500
    s_cbranch_scc1 .ap_169
    s_waitcnt vmcnt(1)
.ap_169:
    s_add_u32 s63, s69, 172032
    buffer_load_dwordx4 v[212:215], v1, s[44:47], s63 offen nt
    v_add_f32_dpp v13, v146, v13 row_ror:4 row_mask:0xf bank_mask:0x8
    s_mov_b32 s60, 0x3db504f3
    s_mov_b32 s61, 0x3db504f3
    v_cvt_pk_bf16_f32 v10, v10, v11
    v_and_b32 v11, 0xffff0000, v10
    v_lshlrev_b32 v10, 16, v10
    v_cvt_pk_bf16_f32 v12, v12, v13
    v_and_b32 v13, 0xffff0000, v12
    v_lshlrev_b32 v12, 16, v12
    v_pk_mul_f32 v[10:11], v[10:11], s[60:61]
    v_pk_mul_f32 v[12:13], v[12:13], s[60:61]
    v_cvt_pk_bf16_f32 v10, v10, v11
    v_and_b32 v11, 0xffff0000, v10
    v_lshlrev_b32 v10, 16, v10
    v_cvt_pk_bf16_f32 v12, v12, v13
    v_and_b32 v13, 0xffff0000, v12
    v_lshlrev_b32 v12, 16, v12
    v_max_f32 v14, v10, v11
    v_max3_f32 v14, v14, v12, v13
    s_mov_b32 s60, 0x3fb8aa3b
    v_mov_b32 v22, s34
    v_mov_b32 v23, s34
    v_max_f32_dpp v14, v14, v14 quad_perm:[2,3,0,1] row_mask:0xf bank_mask:0xf
    s_nop 1
    v_max_f32_dpp v14, v14, v14 row_ror:4 row_mask:0xf bank_mask:0xf
    s_nop 1
    v_max_f32_dpp v14, v14, v14 row_ror:8 row_mask:0xf bank_mask:0xf
    v_mov_b32 v15, v14
    s_nop 1
    v_permlane16_swap_b32 v15, v14
    v_max_f32 v14, v15, v14
    v_mov_b32 v15, v14
    s_nop 1
    v_permlane32_swap_b32 v15, v14
    v_max_f32 v14, v15, v14
    v_mul_f32 v15, 0xbfb8aa3b, v14
    v_fma_f32 v10, v10, s60, v15
    v_fma_f32 v11, v11, s60, v15
    v_fma_f32 v12, v12, s60, v15
    v_fma_f32 v13, v13, s60, v15
    v_exp_f32 v10, v10
    v_exp_f32 v11, v11
    v_exp_f32 v12, v12
    v_exp_f32 v13, v13
    v_mov_b32 v20, v14
    v_pk_add_f32 v[16:17], v[10:11], v[12:13]
    v_add_f32 v21, v16, v17
    s_lshl3_add_u32 s60, s68, s3
    s_lshl_b32 s60, s60, 5
    s_add_u32 s60, s60, s59
    v_add_f32_dpp v21, v21, v21 quad_perm:[2,3,0,1] row_mask:0xf bank_mask:0xf
    s_nop 1
    v_add_f32_dpp v21, v21, v21 row_ror:4 row_mask:0xf bank_mask:0xf
    s_nop 1
    v_add_f32_dpp v21, v21, v21 row_ror:8 row_mask:0xf bank_mask:0xf
    v_mov_b32 v15, v21
    s_nop 1
    v_permlane16_swap_b32 v15, v21
    v_add_f32 v21, v15, v21
    v_mov_b32 v15, v21
    s_nop 1
    v_permlane32_swap_b32 v15, v21
    v_add_f32 v21, v15, v21
    s_mov_b64 exec, 0x3
    buffer_store_dwordx4 v[20:23], v2, s[36:39], s60 offen sc1
    s_mov_b64 exec, -1
    s_memrealtime s[8:9]
    s_waitcnt vmcnt(8)
    s_waitcnt lgkmcnt(0)
    s_sub_u32 s8, s8, s30
    s_cmpk_ge_u32 s8, 1753
    s_cbranch_scc1 .ap_170
    s_waitcnt vmcnt(5)
    s_cmpk_ge_u32 s8, 1653
    s_cbranch_scc1 .ap_170
    s_waitcnt vmcnt(4)
    s_bitcmp1_b64 s[14:15], 46
    s_cbranch_scc0 1
    s_waitcnt vmcnt(2)
    s_cmpk_ge_u32 s8, 1533
    s_cbranch_scc1 .ap_170
    s_waitcnt vmcnt(1)
.ap_170:
    s_add_u32 s63, s69, 180224
    buffer_load_dwordx4 v[216:219], v1, s[44:47], s63 offen nt
    s_memrealtime s[8:9]
    s_waitcnt vmcnt(8)
    s_waitcnt lgkmcnt(0)
    s_sub_u32 s8, s8, s30
    s_cmpk_ge_u32 s8, 1786
    s_cbranch_scc1 .ap_171
    s_waitcnt vmcnt(5)
    s_cmpk_ge_u32 s8, 1686
    s_cbranch_scc1 .ap_171
    s_waitcnt vmcnt(4)
    s_bitcmp1_b64 s[14:15], 47
    s_cbranch_scc0 1
    s_waitcnt vmcnt(2)
    s_cmpk_ge_u32 s8, 1566
    s_cbranch_scc1 .ap_171
    s_waitcnt vmcnt(1)
.ap_171:
    s_add_u32 s63, s69, 188416
    buffer_load_dwordx4 v[220:223], v1, s[44:47], s63 offen nt
    s_and_b32 s56, s64, 0
    s_mul_i32 s56, s56, 18432
    s_mul_i32 s57, s3, 2304
    s_add_u32 s56, s56, s57
    s_add_u32 s56, s56, 0x37000
    buffer_load_dwordx4 v[32:35], v2, s[36:39], s56 offen offset:0 sc1
    buffer_load_dwordx4 v[40:43], v2, s[36:39], s56 offen offset:1024 sc1
    buffer_load_dwordx2 v[48:49], v5, s[36:39], s56 offen offset:0 sc1
    s_memrealtime s[8:9]
    s_waitcnt vmcnt(11)
    s_waitcnt lgkmcnt(0)
    s_sub_u32 s8, s8, s30
    s_cmpk_ge_u32 s8, 1819
    s_cbranch_scc1 .ap_172
    s_waitcnt vmcnt(8)
    s_cmpk_ge_u32 s8, 1719
    s_cbranch_scc1 .ap_172
    s_waitcnt vmcnt(7)
    s_bitcmp1_b64 s[14:15], 48
    s_cbranch_scc0 1
    s_waitcnt vmcnt(5)
    s_cmpk_ge_u32 s8, 1599
    s_cbranch_scc1 .ap_172
    s_waitcnt vmcnt(4)
.ap_172:
    s_add_u32 s63, s69, 262144
    buffer_load_dwordx4 v[224:227], v1, s[44:47], s63 offen nt
    s_memrealtime s[8:9]
    s_waitcnt vmcnt(11)
    s_waitcnt lgkmcnt(0)
    s_sub_u32 s8, s8, s30
    s_cmpk_ge_u32 s8, 1852
    s_cbranch_scc1 .ap_173
    s_waitcnt vmcnt(8)
    s_cmpk_ge_u32 s8, 1752
    s_cbranch_scc1 .ap_173
    s_waitcnt vmcnt(7)
    s_bitcmp1_b64 s[14:15], 49
    s_cbranch_scc0 1
    s_waitcnt vmcnt(5)
    s_cmpk_ge_u32 s8, 1632
    s_cbranch_scc1 .ap_173
    s_waitcnt vmcnt(4)
.ap_173:
    s_add_u32 s63, s69, 270336
    buffer_load_dwordx4 v[228:231], v1, s[44:47], s63 offen nt
    s_and_b32 s56, s64, 0
    s_mul_i32 s56, s56, 18432
    s_mul_i32 s57, s3, 2304
    s_add_u32 s56, s56, s57
    s_add_u32 s56, s56, 0x49000
    buffer_load_dwordx4 v[56:59], v2, s[36:39], s56 offen offset:0 sc1
    buffer_load_dwordx4 v[64:67], v2, s[36:39], s56 offen offset:1024 sc1
    buffer_load_dwordx2 v[72:73], v5, s[36:39], s56 offen offset:0 sc1
    s_memrealtime s[8:9]
    s_waitcnt vmcnt(14)
    s_waitcnt lgkmcnt(0)
    s_sub_u32 s8, s8, s30
    s_cmpk_ge_u32 s8, 1885
    s_cbranch_scc1 .ap_174
    s_waitcnt vmcnt(11)
    s_cmpk_ge_u32 s8, 1785
    s_cbranch_scc1 .ap_174
    s_waitcnt vmcnt(10)
    s_bitcmp1_b64 s[14:15], 50
    s_cbranch_scc0 1
    s_waitcnt vmcnt(8)
    s_cmpk_ge_u32 s8, 1665
    s_cbranch_scc1 .ap_174
    s_waitcnt vmcnt(4)
.ap_174:
    s_add_u32 s63, s69, 278528
    buffer_load_dwordx4 v[232:235], v1, s[44:47], s63 offen nt
    s_memrealtime s[8:9]
    s_waitcnt vmcnt(14)
    s_waitcnt lgkmcnt(0)
    s_sub_u32 s8, s8, s30
    s_cmpk_ge_u32 s8, 1918
    s_cbranch_scc1 .ap_175
    s_waitcnt vmcnt(11)
    s_cmpk_ge_u32 s8, 1818
    s_cbranch_scc1 .ap_175
    s_waitcnt vmcnt(10)
    s_bitcmp1_b64 s[14:15], 51
    s_cbranch_scc0 1
    s_waitcnt vmcnt(5)
    s_cmpk_ge_u32 s8, 1698
    s_cbranch_scc1 .ap_175
    s_waitcnt vmcnt(4)
.ap_175:
    s_add_u32 s63, s69, 286720
    buffer_load_dwordx4 v[236:239], v1, s[44:47], s63 offen nt
    s_memrealtime s[8:9]
    s_waitcnt vmcnt(14)
    s_waitcnt lgkmcnt(0)
    s_sub_u32 s8, s8, s30
    s_cmpk_ge_u32 s8, 1951
    s_cbranch_scc1 .ap_176
    s_waitcnt vmcnt(11)
    s_cmpk_ge_u32 s8, 1851
    s_cbranch_scc1 .ap_176
    s_waitcnt vmcnt(10)
    s_bitcmp1_b64 s[14:15], 52
    s_cbranch_scc0 1
    s_waitcnt vmcnt(5)
    s_cmpk_ge_u32 s8, 1731
    s_cbranch_scc1 .ap_176
    s_waitcnt vmcnt(1)
.ap_176:
    s_add_u32 s63, s69, 294912
    buffer_load_dwordx4 v[240:243], v1, s[44:47], s63 offen nt
    s_memrealtime s[8:9]
    s_waitcnt vmcnt(14)
    s_waitcnt lgkmcnt(0)
    s_sub_u32 s8, s8, s30
    s_cmpk_ge_u32 s8, 1984
    s_cbranch_scc1 .ap_177
    s_waitcnt vmcnt(11)
    s_cmpk_ge_u32 s8, 1884
    s_cbranch_scc1 .ap_177
    s_waitcnt vmcnt(7)
    s_bitcmp1_b64 s[14:15], 53
    s_cbranch_scc0 1
    s_waitcnt vmcnt(2)
    s_cmpk_ge_u32 s8, 1764
    s_cbranch_scc1 .ap_177
    s_waitcnt vmcnt(1)
.ap_177:
    s_add_u32 s63, s69, 303104
    buffer_load_dwordx4 v[244:247], v1, s[44:47], s63 offen nt
    s_and_b32 s0, s0, 0xffffff80
    s_sub_u32 s0, s0, 1024
    buffer_load_dword v28, v4, s[36:39], s0 offen sc1
    buffer_load_dwordx4 v[24:27], v9, s[36:39], s59 offen offset:0 sc1
    s_memrealtime s[8:9]
    s_waitcnt vmcnt(15)
    s_waitcnt lgkmcnt(0)
    s_sub_u32 s8, s8, s30
    s_cmpk_ge_u32 s8, 2017
    s_cbranch_scc1 .ap_178
    s_waitcnt vmcnt(9)
    s_cmpk_ge_u32 s8, 1917
    s_cbranch_scc1 .ap_178
    s_waitcnt vmcnt(5)
    s_bitcmp1_b64 s[14:15], 54
    s_cbranch_scc0 1
    s_waitcnt vmcnt(3)
    s_cmpk_ge_u32 s8, 1797
    s_cbranch_scc1 .ap_178
    s_waitcnt vmcnt(2)
.ap_178:
    s_add_u32 s63, s69, 311296
    buffer_load_dwordx4 v[248:251], v1, s[44:47], s63 offen nt
    s_memrealtime s[8:9]
    s_waitcnt vmcnt(15)
    s_waitcnt lgkmcnt(0)
    s_sub_u32 s8, s8, s30
    s_cmpk_ge_u32 s8, 2050
    s_cbranch_scc1 .ap_179
    s_waitcnt vmcnt(6)
    s_cmpk_ge_u32 s8, 1950
    s_cbranch_scc1 .ap_179
    s_waitcnt vmcnt(5)
    s_bitcmp1_b64 s[14:15], 55
    s_cbranch_scc0 1
    s_waitcnt vmcnt(3)
    s_cmpk_ge_u32 s8, 1830
    s_cbranch_scc1 .ap_179
    s_waitcnt vmcnt(1)
.ap_179:
    s_add_u32 s63, s69, 319488
    buffer_load_dwordx4 v[252:255], v1, s[44:47], s63 offen nt
    s_memrealtime s[8:9]
    s_waitcnt vmcnt(12)
    s_waitcnt lgkmcnt(0)
    s_sub_u32 s8, s8, s30
    s_cmpk_ge_u32 s8, 2083
    s_cbranch_scc1 .ap_180
    s_waitcnt vmcnt(6)
    s_cmpk_ge_u32 s8, 1983
    s_cbranch_scc1 .ap_180
    s_waitcnt vmcnt(5)
    s_bitcmp1_b64 s[14:15], 56
    s_cbranch_scc0 1
    s_waitcnt vmcnt(2)
    s_cmpk_ge_u32 s8, 1863
    s_cbranch_scc1 .ap_180
    s_waitcnt vmcnt(1)
.ap_180:
    s_add_u32 s63, s69, 393216
    buffer_load_dwordx4 v[36:39], v1, s[44:47], s63 offen nt
    s_memrealtime s[8:9]
    s_waitcnt vmcnt(12)
    s_waitcnt lgkmcnt(0)
    s_sub_u32 s8, s8, s30
    s_cmpk_ge_u32 s8, 2116
    s_cbranch_scc1 .ap_181
    s_waitcnt vmcnt(6)
    s_cmpk_ge_u32 s8, 2016
    s_cbranch_scc1 .ap_181
    s_waitcnt vmcnt(5)
    s_bitcmp1_b64 s[14:15], 57
    s_cbranch_scc0 1
    s_waitcnt vmcnt(2)
    s_cmpk_ge_u32 s8, 1896
    s_cbranch_scc1 .ap_181
    s_waitcnt vmcnt(1)
.ap_181:
    s_add_u32 s63, s69, 401408
    buffer_load_dwordx4 v[44:47], v1, s[44:47], s63 offen nt
    s_memrealtime s[8:9]
    s_waitcnt vmcnt(9)
    s_waitcnt lgkmcnt(0)
    s_sub_u32 s8, s8, s30
    s_cmpk_ge_u32 s8, 2149
    s_cbranch_scc1 .ap_182
    s_waitcnt vmcnt(6)
    s_cmpk_ge_u32 s8, 2049
    s_cbranch_scc1 .ap_182
    s_waitcnt vmcnt(4)
    s_bitcmp1_b64 s[14:15], 58
    s_cbranch_scc0 1
    s_waitcnt vmcnt(2)
    s_cmpk_ge_u32 s8, 1929
    s_cbranch_scc1 .ap_182
    s_waitcnt vmcnt(1)
.ap_182:
    s_add_u32 s63, s69, 409600
    buffer_load_dwordx4 v[52:55], v1, s[44:47], s63 offen nt
    s_memrealtime s[8:9]
    s_waitcnt vmcnt(9)
    s_waitcnt lgkmcnt(0)
    s_sub_u32 s8, s8, s30
    s_cmpk_ge_u32 s8, 2182
    s_cbranch_scc1 .ap_183
    s_waitcnt vmcnt(5)
    s_cmpk_ge_u32 s8, 2082
    s_cbranch_scc1 .ap_183
    s_waitcnt vmcnt(4)
    s_bitcmp1_b64 s[14:15], 59
    s_cbranch_scc0 1
    s_waitcnt vmcnt(2)
    s_cmpk_ge_u32 s8, 1962
    s_cbranch_scc1 .ap_183
    s_waitcnt vmcnt(1)
.ap_183:
    s_add_u32 s63, s69, 417792
    buffer_load_dwordx4 v[60:63], v1, s[44:47], s63 offen nt
    s_memrealtime s[8:9]
    s_waitcnt vmcnt(9)
    s_waitcnt lgkmcnt(0)
    s_sub_u32 s8, s8, s30
    s_cmpk_ge_u32 s8, 2215
    s_cbranch_scc1 .ap_184
    s_waitcnt vmcnt(5)
    s_cmpk_ge_u32 s8, 2115
    s_cbranch_scc1 .ap_184
    s_waitcnt vmcnt(4)
    s_bitcmp1_b64 s[14:15], 60
    s_cbranch_scc0 1
    s_waitcnt vmcnt(2)
    s_cmpk_ge_u32 s8, 1995
    s_cbranch_scc1 .ap_184
    s_waitcnt vmcnt(1)
.ap_184:
    s_add_u32 s63, s69, 425984
    buffer_load_dwordx4 v[68:71], v1, s[44:47], s63 offen nt
    s_memrealtime s[8:9]
    s_waitcnt vmcnt(9)
    s_waitcnt lgkmcnt(0)
    s_sub_u32 s8, s8, s30
    s_cmpk_ge_u32 s8, 2248
    s_cbranch_scc1 .ap_185
    s_waitcnt vmcnt(5)
    s_cmpk_ge_u32 s8, 2148
    s_cbranch_scc1 .ap_185
    s_waitcnt vmcnt(4)
    s_bitcmp1_b64 s[14:15], 61
    s_cbranch_scc0 1
    s_waitcnt vmcnt(2)
    s_cmpk_ge_u32 s8, 2028
    s_cbranch_scc1 .ap_185
    s_waitcnt vmcnt(1)
.ap_185:
    s_add_u32 s63, s69, 434176
    buffer_load_dwordx4 v[76:79], v1, s[44:47], s63 offen nt
    s_memrealtime s[8:9]
    s_waitcnt vmcnt(8)
    s_waitcnt lgkmcnt(0)
    s_sub_u32 s8, s8, s30
    s_cmpk_ge_u32 s8, 2281
    s_cbranch_scc1 .ap_186
    s_waitcnt vmcnt(5)
    s_cmpk_ge_u32 s8, 2181
    s_cbranch_scc1 .ap_186
    s_waitcnt vmcnt(4)
    s_bitcmp1_b64 s[14:15], 62
    s_cbranch_scc0 1
    s_waitcnt vmcnt(2)
    s_cmpk_ge_u32 s8, 2061
    s_cbranch_scc1 .ap_186
    s_waitcnt vmcnt(1)
.ap_186:
    s_add_u32 s63, s69, 442368
    buffer_load_dwordx4 v[84:87], v1, s[44:47], s63 offen nt
    s_memrealtime s[8:9]
    s_waitcnt vmcnt(8)
    s_waitcnt lgkmcnt(0)
    s_sub_u32 s8, s8, s30
    s_cmpk_ge_u32 s8, 2314
    s_cbranch_scc1 .ap_187
    s_waitcnt vmcnt(5)
    s_cmpk_ge_u32 s8, 2214
    s_cbranch_scc1 .ap_187
    s_waitcnt vmcnt(4)
    s_bitcmp1_b64 s[14:15], 63
    s_cbranch_scc0 1
    s_waitcnt vmcnt(2)
    s_cmpk_ge_u32 s8, 2094
    s_cbranch_scc1 .ap_187
    s_waitcnt vmcnt(1)
.ap_187:
    s_add_u32 s63, s69, 450560
    buffer_load_dwordx4 v[92:95], v1, s[44:47], s63 offen nt
    s_setprio 0
    s_branch .gpc_189
.gp_188:
    buffer_load_dwordx4 v[24:27], v9, s[36:39], s59 offen offset:0 sc1
    s_waitcnt vmcnt(0)
.gpc_189:
    v_cmp_eq_u32 vcc, s34, v26
    s_cmp_eq_u64 vcc, -1
    s_nop 3
    s_cbranch_scc1 .gpd_190
    s_sub_u32 s35, s35, 1
    s_cbranch_scc1 .Lexit
    s_sleep 1
    s_branch .gp_188
.gpd_190:
    v_cmp_eq_u32 vcc, s1, v28
    s_cmp_eq_u64 vcc, -1
    s_cselect_b32 s0, 0x800000, 0
    v_mov_b32 v16, v24
    s_nop 1
    v_max_f32_dpp v16, v16, v16 row_ror:8 row_mask:0xf bank_mask:0xf
    s_nop 1
    v_max_f32_dpp v16, v16, v16 row_ror:4 row_mask:0xf bank_mask:0xf
    v_mov_b32 v17, v16
    s_nop 1
    v_permlane16_swap_b32 v17, v16
    v_max_f32 v16, v17, v16
    v_mov_b32 v17, v16
    s_nop 1
    v_permlane32_swap_b32 v17, v16
    v_max_f32 v16, v17, v16
    v_sub_f32 v17, v24, v16
    v_sub_f32 v18, v14, v16
    v_mul_f32 v17, 0x3fb8aa3b, v17
    v_mul_f32 v18, 0x3fb8aa3b, v18
    v_exp_f32 v17, v17
    v_exp_f32 v18, v18
    v_mul_f32 v17, v17, v25
    s_nop 1
    v_add_f32_dpp v17, v17, v17 row_ror:8 row_mask:0xf bank_mask:0xf
    s_nop 1
    v_add_f32_dpp v17, v17, v17 row_ror:4 row_mask:0xf bank_mask:0xf
    v_mov_b32 v19, v17
    s_nop 1
    v_permlane16_swap_b32 v19, v17
    v_add_f32 v17, v19, v17
    v_mov_b32 v19, v17
    s_nop 1
    v_permlane32_swap_b32 v19, v17
    v_add_f32 v17, v19, v17
    v_rcp_f32 v19, v17
    s_nop 0
    v_fma_f32 v15, -v17, v19, 1.0
    v_fma_f32 v19, v15, v19, v19
    v_mul_f32 v18, v18, v19
    v_mul_f32 v10, v10, v18
    v_mul_f32 v11, v11, v18
    v_mul_f32 v12, v12, v18
    v_mul_f32 v13, v13, v18
    v_mov_b32_dpp v112, v10 quad_perm:[2,3,0,1] row_mask:0xf bank_mask:0xf
    v_mov_b32_dpp v113, v11 quad_perm:[2,3,0,1] row_mask:0xf bank_mask:0xf
    v_mov_b32_dpp v114, v12 quad_perm:[2,3,0,1] row_mask:0xf bank_mask:0xf
    v_mov_b32_dpp v115, v13 quad_perm:[2,3,0,1] row_mask:0xf bank_mask:0xf
    v_cvt_pk_bf16_f32 v96, v10, v112
    v_cvt_pk_bf16_f32 v100, v11, v113
    v_cvt_pk_bf16_f32 v104, v12, v114
    v_cvt_pk_bf16_f32 v108, v13, v115
    v_mov_b32_dpp v97, v96 row_ror:12 row_mask:0xf bank_mask:0xf
    v_mov_b32_dpp v101, v100 row_ror:12 row_mask:0xf bank_mask:0xf
    v_mov_b32_dpp v105, v104 row_ror:12 row_mask:0xf bank_mask:0xf
    v_mov_b32_dpp v109, v108 row_ror:12 row_mask:0xf bank_mask:0xf
    v_mov_b32_dpp v98, v96 row_ror:8 row_mask:0xf bank_mask:0xf
    v_mov_b32_dpp v102, v100 row_ror:8 row_mask:0xf bank_mask:0xf
    v_mov_b32_dpp v106, v104 row_ror:8 row_mask:0xf bank_mask:0xf
    v_mov_b32_dpp v110, v108 row_ror:8 row_mask:0xf bank_mask:0xf
    v_mov_b32_dpp v99, v96 row_ror:4 row_mask:0xf bank_mask:0xf
    v_mov_b32_dpp v103, v100 row_ror:4 row_mask:0xf bank_mask:0xf
    v_mov_b32_dpp v107, v104 row_ror:4 row_mask:0xf bank_mask:0xf
    v_mov_b32_dpp v111, v108 row_ror:4 row_mask:0xf bank_mask:0xf
    s_lshl_b32 s60, s3, 10
    s_add_u32 s60, s60, 147456
    v_lshlrev_b32 v10, 5, v0
    v_add_u32 v10, s60, v10
    v_perm_b32 v112, v164, v160, s94
    v_perm_b32 v113, v172, v168, s94
    v_perm_b32 v114, v180, v176, s94
    v_perm_b32 v115, v188, v184, s94
    s_nop 1
    v_mfma_f32_16x16x32_bf16 v[128:131], v[96:99], v[112:115], 0
    v_perm_b32 v116, v164, v160, s95
    v_perm_b32 v117, v172, v168, s95
    v_perm_b32 v118, v180, v176, s95
    v_perm_b32 v119, v188, v184, s95
    s_nop 1
    v_mfma_f32_16x16x32_bf16 v[132:135], v[96:99], v[116:119], 0
    v_perm_b32 v120, v165, v161, s94
    v_perm_b32 v121, v173, v169, s94
    v_perm_b32 v122, v181, v177, s94
    v_perm_b32 v123, v189, v185, s94
    s_nop 1
    v_mfma_f32_16x16x32_bf16 v[136:139], v[96:99], v[120:123], 0
    v_perm_b32 v124, v165, v161, s95
    v_perm_b32 v125, v173, v169, s95
    v_perm_b32 v126, v181, v177, s95
    v_perm_b32 v127, v189, v185, s95
    s_nop 1
    v_mfma_f32_16x16x32_bf16 v[140:143], v[96:99], v[124:127], 0
    v_perm_b32 v112, v166, v162, s94
    v_perm_b32 v113, v174, v170, s94
    v_perm_b32 v114, v182, v178, s94
    v_perm_b32 v115, v190, v186, s94
    s_nop 1
    v_mfma_f32_16x16x32_bf16 v[144:147], v[96:99], v[112:115], 0
    v_perm_b32 v116, v166, v162, s95
    v_perm_b32 v117, v174, v170, s95
    v_perm_b32 v118, v182, v178, s95
    v_perm_b32 v119, v190, v186, s95
    s_nop 1
    v_mfma_f32_16x16x32_bf16 v[148:151], v[96:99], v[116:119], 0
    v_perm_b32 v120, v167, v163, s94
    v_perm_b32 v121, v175, v171, s94
    v_perm_b32 v122, v183, v179, s94
    v_perm_b32 v123, v191, v187, s94
    s_nop 1
    v_mfma_f32_16x16x32_bf16 v[152:155], v[96:99], v[120:123], 0
    v_perm_b32 v124, v167, v163, s95
    v_perm_b32 v125, v175, v171, s95
    v_perm_b32 v126, v183, v179, s95
    v_perm_b32 v127, v191, v187, s95
    s_nop 1
    v_mfma_f32_16x16x32_bf16 v[156:159], v[96:99], v[124:127], 0
    v_perm_b32 v112, v196, v192, s94
    v_perm_b32 v113, v204, v200, s94
    v_perm_b32 v114, v212, v208, s94
    v_perm_b32 v115, v220, v216, s94
    s_nop 1
    v_mfma_f32_16x16x32_bf16 v[128:131], v[100:103], v[112:115], v[128:131]
    v_perm_b32 v116, v196, v192, s95
    v_perm_b32 v117, v204, v200, s95
    v_perm_b32 v118, v212, v208, s95
    v_perm_b32 v119, v220, v216, s95
    s_nop 1
    v_mfma_f32_16x16x32_bf16 v[132:135], v[100:103], v[116:119], v[132:135]
    v_perm_b32 v120, v197, v193, s94
    v_perm_b32 v121, v205, v201, s94
    v_perm_b32 v122, v213, v209, s94
    v_perm_b32 v123, v221, v217, s94
    s_nop 1
    v_mfma_f32_16x16x32_bf16 v[136:139], v[100:103], v[120:123], v[136:139]
    v_perm_b32 v124, v197, v193, s95
    v_perm_b32 v125, v205, v201, s95
    v_perm_b32 v126, v213, v209, s95
    v_perm_b32 v127, v221, v217, s95
    s_nop 1
    v_mfma_f32_16x16x32_bf16 v[140:143], v[100:103], v[124:127], v[140:143]
    v_perm_b32 v112, v198, v194, s94
    v_perm_b32 v113, v206, v202, s94
    v_perm_b32 v114, v214, v210, s94
    v_perm_b32 v115, v222, v218, s94
    s_nop 1
    v_mfma_f32_16x16x32_bf16 v[144:147], v[100:103], v[112:115], v[144:147]
    v_perm_b32 v116, v198, v194, s95
    v_perm_b32 v117, v206, v202, s95
    v_perm_b32 v118, v214, v210, s95
    v_perm_b32 v119, v222, v218, s95
    s_nop 1
    v_mfma_f32_16x16x32_bf16 v[148:151], v[100:103], v[116:119], v[148:151]
    v_perm_b32 v120, v199, v195, s94
    v_perm_b32 v121, v207, v203, s94
    v_perm_b32 v122, v215, v211, s94
    v_perm_b32 v123, v223, v219, s94
    s_nop 1
    v_mfma_f32_16x16x32_bf16 v[152:155], v[100:103], v[120:123], v[152:155]
    v_perm_b32 v124, v199, v195, s95
    v_perm_b32 v125, v207, v203, s95
    v_perm_b32 v126, v215, v211, s95
    v_perm_b32 v127, v223, v219, s95
    s_nop 1
    v_mfma_f32_16x16x32_bf16 v[156:159], v[100:103], v[124:127], v[156:159]
    s_waitcnt vmcnt(8)
    v_perm_b32 v112, v228, v224, s94
    v_perm_b32 v113, v236, v232, s94
    v_perm_b32 v114, v244, v240, s94
    v_perm_b32 v115, v252, v248, s94
    s_nop 1
    v_mfma_f32_16x16x32_bf16 v[128:131], v[104:107], v[112:115], v[128:131]
    v_perm_b32 v116, v228, v224, s95
    v_perm_b32 v117, v236, v232, s95
    v_perm_b32 v118, v244, v240, s95
    v_perm_b32 v119, v252, v248, s95
    s_nop 1
    v_mfma_f32_16x16x32_bf16 v[132:135], v[104:107], v[116:119], v[132:135]
    v_perm_b32 v120, v229, v225, s94
    v_perm_b32 v121, v237, v233, s94
    v_perm_b32 v122, v245, v241, s94
    v_perm_b32 v123, v253, v249, s94
    s_nop 1
    v_mfma_f32_16x16x32_bf16 v[136:139], v[104:107], v[120:123], v[136:139]
    v_perm_b32 v124, v229, v225, s95
    v_perm_b32 v125, v237, v233, s95
    v_perm_b32 v126, v245, v241, s95
    v_perm_b32 v127, v253, v249, s95
    s_nop 1
    v_mfma_f32_16x16x32_bf16 v[140:143], v[104:107], v[124:127], v[140:143]
    v_perm_b32 v112, v230, v226, s94
    v_perm_b32 v113, v238, v234, s94
    v_perm_b32 v114, v246, v242, s94
    v_perm_b32 v115, v254, v250, s94
    s_nop 1
    v_mfma_f32_16x16x32_bf16 v[144:147], v[104:107], v[112:115], v[144:147]
    v_perm_b32 v116, v230, v226, s95
    v_perm_b32 v117, v238, v234, s95
    v_perm_b32 v118, v246, v242, s95
    v_perm_b32 v119, v254, v250, s95
    s_nop 1
    v_mfma_f32_16x16x32_bf16 v[148:151], v[104:107], v[116:119], v[148:151]
    v_perm_b32 v120, v231, v227, s94
    v_perm_b32 v121, v239, v235, s94
    v_perm_b32 v122, v247, v243, s94
    v_perm_b32 v123, v255, v251, s94
    s_nop 1
    v_mfma_f32_16x16x32_bf16 v[152:155], v[104:107], v[120:123], v[152:155]
    v_perm_b32 v124, v231, v227, s95
    v_perm_b32 v125, v239, v235, s95
    v_perm_b32 v126, v247, v243, s95
    v_perm_b32 v127, v255, v251, s95
    s_nop 1
    v_mfma_f32_16x16x32_bf16 v[156:159], v[104:107], v[124:127], v[156:159]
    s_waitcnt vmcnt(0)
    s_add_u32 m0, s101, 90112
    s_add_u32 s56, s100, 1179648
    buffer_load_dwordx4 v6, s[52:55], s56 offen nt lds
    s_add_u32 m0, s101, 98304
    s_add_u32 s56, s100, 1769472
    buffer_load_dwordx4 v6, s[52:55], s56 offen nt lds
    s_add_u32 m0, s101, 106496
    s_add_u32 s56, s100, 2359296
    buffer_load_dwordx4 v6, s[52:55], s56 offen nt lds
    s_add_u32 m0, s101, 114688
    s_add_u32 s56, s100, 2949120
    buffer_load_dwordx4 v6, s[52:55], s56 offen nt lds
    s_add_u32 m0, s101, 122880
    s_add_u32 s56, s100, 3538944
    buffer_load_dwordx4 v6, s[52:55], s56 offen nt lds
    s_add_u32 m0, s101, 131072
    s_add_u32 s56, s100, 4128768
    buffer_load_dwordx4 v6, s[52:55], s56 offen nt lds
    s_add_u32 m0, s101, 139264
    s_add_u32 s56, s100, 4718592
    buffer_load_dwordx4 v6, s[52:55], s56 offen nt lds
    v_perm_b32 v112, v44, v36, s94
    v_perm_b32 v113, v60, v52, s94
    v_perm_b32 v114, v76, v68, s94
    v_perm_b32 v115, v92, v84, s94
    s_nop 1
    v_mfma_f32_16x16x32_bf16 v[128:131], v[108:111], v[112:115], v[128:131]
    v_perm_b32 v116, v44, v36, s95
    v_perm_b32 v117, v60, v52, s95
    v_perm_b32 v118, v76, v68, s95
    v_perm_b32 v119, v92, v84, s95
    s_nop 1
    v_mfma_f32_16x16x32_bf16 v[132:135], v[108:111], v[116:119], v[132:135]
    v_perm_b32 v120, v45, v37, s94
    v_perm_b32 v121, v61, v53, s94
    v_perm_b32 v122, v77, v69, s94
    v_perm_b32 v123, v93, v85, s94
    s_nop 1
    v_mfma_f32_16x16x32_bf16 v[136:139], v[108:111], v[120:123], v[136:139]
    v_perm_b32 v124, v45, v37, s95
    v_perm_b32 v125, v61, v53, s95
    v_perm_b32 v126, v77, v69, s95
    v_perm_b32 v127, v93, v85, s95
    s_nop 1
    v_mfma_f32_16x16x32_bf16 v[140:143], v[108:111], v[124:127], v[140:143]
    v_perm_b32 v112, v46, v38, s94
    v_perm_b32 v113, v62, v54, s94
    v_perm_b32 v114, v78, v70, s94
    v_perm_b32 v115, v94, v86, s94
    s_nop 1
    v_mfma_f32_16x16x32_bf16 v[144:147], v[108:111], v[112:115], v[144:147]
    v_perm_b32 v116, v46, v38, s95
    v_perm_b32 v117, v62, v54, s95
    v_perm_b32 v118, v78, v70, s95
    v_perm_b32 v119, v94, v86, s95
    s_nop 1
    v_mfma_f32_16x16x32_bf16 v[148:151], v[108:111], v[116:119], v[148:151]
    v_perm_b32 v120, v47, v39, s94
    v_perm_b32 v121, v63, v55, s94
    v_perm_b32 v122, v79, v71, s94
    v_perm_b32 v123, v95, v87, s94
    s_nop 1
    v_mfma_f32_16x16x32_bf16 v[152:155], v[108:111], v[120:123], v[152:155]
    v_perm_b32 v124, v47, v39, s95
    v_perm_b32 v125, v63, v55, s95
    v_perm_b32 v126, v79, v71, s95
    v_perm_b32 v127, v95, v87, s95
    s_nop 1
    v_mfma_f32_16x16x32_bf16 v[156:159], v[108:111], v[124:127], v[156:159]
    s_mov_b64 exec, 0xffff
    ds_write2_b32 v10, v128, v129 offset0:0 offset1:128
    ds_write2_b32 v10, v132, v133 offset0:1 offset1:129
    ds_write2_b32 v10, v136, v137 offset0:2 offset1:130
    ds_write2_b32 v10, v140, v141 offset0:3 offset1:131
    ds_write2_b32 v10, v144, v145 offset0:4 offset1:132
    ds_write2_b32 v10, v148, v149 offset0:5 offset1:133
    ds_write2_b32 v10, v152, v153 offset0:6 offset1:134
    ds_write2_b32 v10, v156, v157 offset0:7 offset1:135
    s_mov_b64 exec, -1
    s_waitcnt lgkmcnt(0)
    s_barrier
    s_cmp_lg_u32 s3, 7
    s_cbranch_scc1 .opub_191
    v_add_u32 v10, 147456, v2
    ds_read_b128 v[196:199], v10 offset:0
    ds_read_b128 v[200:203], v10 offset:1024
    ds_read_b128 v[204:207], v10 offset:2048
    ds_read_b128 v[208:211], v10 offset:3072
    ds_read_b128 v[212:215], v10 offset:4096
    ds_read_b128 v[216:219], v10 offset:5120
    ds_read_b128 v[220:223], v10 offset:6144
    ds_read_b128 v[224:227], v10 offset:7168
    v_lshrrev_b32 v11, 5, v0
    v_lshlrev_b32 v11, 13, v11
    v_and_b32 v12, 31, v0
    v_lshl_add_u32 v11, v12, 4, v11
    s_lshl4_add_u32 s56, s67, s66
    s_lshl1_add_u32 s56, s56, s68
    s_lshl_b32 s56, s56, 9
    s_add_u32 s56, s56, 0xa0000
    s_mov_b32 s60, 0x07060503
    s_mov_b32 s61, 0x07060502
    s_mov_b32 s62, 0x07060501
    v_mov_b32 v15, s34
    s_waitcnt lgkmcnt(6)
    v_pk_add_f32 v[196:197], v[196:197], v[200:201]
    v_pk_add_f32 v[198:199], v[198:199], v[202:203]
    s_waitcnt lgkmcnt(5)
    v_pk_add_f32 v[196:197], v[196:197], v[204:205]
    v_pk_add_f32 v[198:199], v[198:199], v[206:207]
    s_waitcnt lgkmcnt(4)
    v_pk_add_f32 v[196:197], v[196:197], v[208:209]
    v_pk_add_f32 v[198:199], v[198:199], v[210:211]
    s_waitcnt lgkmcnt(3)
    v_pk_add_f32 v[196:197], v[196:197], v[212:213]
    v_pk_add_f32 v[198:199], v[198:199], v[214:215]
    s_waitcnt lgkmcnt(2)
    v_pk_add_f32 v[196:197], v[196:197], v[216:217]
    v_pk_add_f32 v[198:199], v[198:199], v[218:219]
    s_waitcnt lgkmcnt(1)
    v_pk_add_f32 v[196:197], v[196:197], v[220:221]
    v_pk_add_f32 v[198:199], v[198:199], v[222:223]
    s_waitcnt lgkmcnt(0)
    v_pk_add_f32 v[196:197], v[196:197], v[224:225]
    v_pk_add_f32 v[198:199], v[198:199], v[226:227]
    v_perm_b32 v12, v196, v199, s60
    v_perm_b32 v13, v197, v199, s61
    v_perm_b32 v14, v198, v199, s62
    s_add_u32 s57, s56, 0x800000
    buffer_store_dwordx4 v[12:15], v11, s[36:39], s57 offen
    buffer_store_dwordx4 v[12:15], v11, s[36:39], s56 offen sc1
.opub_191:
    s_mov_b32 s61, s101
    v_lshrrev_b32 v25, 4, v0
    v_bfe_u32 v26, v0, 1, 1
    v_lshl_add_u32 v25, v25, 1, v26
    v_bfe_u32 v26, v0, 2, 2
    v_lshl_add_u32 v19, v25, 3, v26
    v_lshlrev_b32 v19, 7, v19
    v_and_b32 v25, 3, v25
    v_lshrrev_b32 v26, 1, v26
    v_lshl_add_u32 v25, v25, 1, v26
    v_xor_b32 v25, s3, v25
    v_lshl_add_u32 v19, v25, 4, v19
    v_and_b32 v25, 1, v0
    v_lshl_add_u32 v19, v25, 3, v19
    v_add_u32 v20, 32768, v19
    ds_read_b64_tr_b16 v[160:161], v19 offset:0
    ds_read_b64_tr_b16 v[162:163], v19 offset:512
    ds_read_b64_tr_b16 v[164:165], v19 offset:8192
    ds_read_b64_tr_b16 v[166:167], v19 offset:8704
    ds_read_b64_tr_b16 v[168:169], v19 offset:16384
    ds_read_b64_tr_b16 v[170:171], v19 offset:16896
    ds_read_b64_tr_b16 v[172:173], v19 offset:24576
    ds_read_b64_tr_b16 v[174:175], v19 offset:25088
    ds_read_b64_tr_b16 v[176:177], v20 offset:0
    ds_read_b64_tr_b16 v[178:179], v20 offset:512
    ds_read_b64_tr_b16 v[180:181], v20 offset:8192
    ds_read_b64_tr_b16 v[182:183], v20 offset:8704
    ds_read_b64_tr_b16 v[184:185], v20 offset:16384
    ds_read_b64_tr_b16 v[186:187], v20 offset:16896
    ds_read_b64_tr_b16 v[188:189], v20 offset:24576
    ds_read_b64_tr_b16 v[190:191], v20 offset:25088
    ds_read_b64_tr_b16 v[192:193], v20 offset:32768
    ds_read_b64_tr_b16 v[194:195], v20 offset:33280
    v_add_u32 v19, 73728, v19
    v_add_u32 v20, 73728, v20
    s_mov_b32 s48, s22
    s_and_b32 s49, s23, 0xffff
    s_mov_b32 s50, 0x510000
    s_mov_b32 s51, 0x00020000
    s_mul_i32 s69, s99, 73728
    s_mul_i32 s56, s3, 9216
    s_add_u32 s69, s69, s56
    v_bfe_u32 v25, v0, 4, 1
    s_and_b32 s56, s3, 1
    s_lshl_b32 s56, s56, 2
    v_lshl_or_b32 v25, v25, 1, s56
    v_and_b32 v26, 7, v0
    v_xor_b32 v25, v25, v26
    v_lshrrev_b32 v26, 3, v0
    v_mul_u32_u24 v26, 1152, v26
    v_lshl_add_u32 v24, v25, 4, v26
    s_and_b32 s58, s64, 0
    s_mul_i32 s58, s58, 18432
    s_mul_i32 s59, s3, 2304
    s_add_u32 s58, s58, s59
    s_add_u32 s62, s58, 0x37000
    s_add_u32 s63, s58, 0x49000
    s_mul_i32 s101, s64, 18432
    s_add_u32 s101, s101, s59
    s_add_u32 s101, s101, 0x170000
    s_waitcnt lgkmcnt(0)
    s_barrier
    s_add_u32 m0, s61, 0
    s_nop 0
    buffer_load_dwordx4 v24, s[48:51], s69 offen offset:0 nt lds
    s_add_u32 m0, s61, 8064
    s_nop 0
    buffer_load_dwordx4 v24, s[48:51], s69 offen offset:128 nt lds
    s_add_u32 m0, s61, 16128
    s_nop 0
    buffer_load_dwordx4 v24, s[48:51], s69 offen offset:256 nt lds
    s_add_u32 m0, s61, 24192
    s_nop 0
    buffer_load_dwordx4 v24, s[48:51], s69 offen offset:384 nt lds
    s_add_u32 m0, s61, 32256
    s_nop 0
    buffer_load_dwordx4 v24, s[48:51], s69 offen offset:512 nt lds
    s_add_u32 m0, s61, 40320
    s_nop 0
    buffer_load_dwordx4 v24, s[48:51], s69 offen offset:640 nt lds
    s_add_u32 m0, s61, 48384
    s_nop 0
    buffer_load_dwordx4 v24, s[48:51], s69 offen offset:768 nt lds
    s_add_u32 m0, s61, 56448
    s_nop 0
    buffer_load_dwordx4 v24, s[48:51], s69 offen offset:896 nt lds
    s_add_u32 m0, s61, 64512
    s_nop 0
    buffer_load_dwordx4 v24, s[48:51], s69 offen offset:1024 nt lds
    v_bfe_u32 v16, v0, 1, 3
    v_mul_u32_u24 v16, 1312, v16
    v_lshrrev_b32 v25, 4, v0
    v_lshl_add_u32 v16, v25, 5, v16
    v_and_b32 v25, 1, v0
    v_lshl_add_u32 v16, v25, 4, v16
    v_add_u32 v16, 147456, v16
    s_mul_i32 s56, s3, 1312
    s_add_u32 s56, s56, 147456
    v_add_u32 v17, s56, v3
    v_add_u32 v18, s56, v4
    v_bfe_u32 v21, v0, 1, 3
    v_mul_u32_u24 v21, 144, v21
    v_bfe_u32 v25, v0, 4, 1
    v_lshl_add_u32 v21, v25, 3, v21
    v_lshrrev_b32 v25, 5, v0
    v_lshl_add_u32 v21, v25, 2, v21
    v_and_b32 v25, 1, v0
    v_lshl_add_u32 v21, v25, 1, v21
    s_lshl_b32 s56, s3, 4
    s_add_u32 s56, s56, 157952
    v_add_u32 v21, s56, v21
    v_and_b32 v22, 15, v0
    v_lshlrev_b32 v22, 3, v22
    s_mul_i32 s56, s3, 144
    s_add_u32 s56, s56, 157952
    v_add_u32 v22, s56, v22
    s_mov_b32 s56, 157952
    v_bfe_u32 v22, v0, 1, 3
    v_mul_u32_u24 v22, 144, v22
    v_and_b32 v25, 48, v0
    v_add3_u32 v22, v22, v25, s56
    v_bfe_u32 v23, v0, 1, 3
    v_mul_u32_u24 v23, 9216, v23
    v_and_b32 v25, 1, v0
    v_lshl_add_u32 v23, v25, 4, v23
    v_and_b32 v25, 48, v0
    v_lshl_add_u32 v23, v25, 1, v23
    v_lshrrev_b32 v25, 4, v0
    v_bfe_u32 v26, v0, 2, 2
    v_lshl_add_u32 v28, v25, 3, v26
    v_lshlrev_b32 v28, 7, v28
    v_and_b32 v25, 1, v25
    v_lshrrev_b32 v26, 1, v26
    v_lshl_add_u32 v25, v25, 1, v26
    s_and_b32 s56, s3, 1
    s_lshl_b32 s56, s56, 1
    v_xor_b32 v25, s56, v25
    v_and_b32 v26, 3, v0
    v_lshl_add_u32 v28, v26, 3, v28
    s_lshr_b32 s56, s3, 1
    s_lshl_b32 s56, s56, 13
    v_add_u32 v28, s56, v28
    v_xor_b32 v26, 1, v25
    v_lshl_add_u32 v29, v26, 5, v28
    v_lshl_add_u32 v28, v25, 5, v28
    v_add_u32 v30, 0x10000, v28
    v_add_u32 v31, 0x10000, v29
    s_mul_i32 s59, s3, 73728
    s_lshl_b32 s56, s99, 7
    s_add_u32 s59, s59, s56
    s_add_u32 s59, s59, 0x1a0000
    s_add_u32 s99, s59, 589824
    s_add_u32 s100, s59, 1179648
    s_branch .gpc_193
.gp_192:
    buffer_load_dwordx4 v[32:35], v2, s[36:39], s62 offen offset:0 sc1
    buffer_load_dwordx4 v[40:43], v2, s[36:39], s62 offen offset:1024 sc1
    buffer_load_dwordx2 v[48:49], v5, s[36:39], s62 offen offset:0 sc1
    buffer_load_dwordx4 v[56:59], v2, s[36:39], s63 offen offset:0 sc1
    buffer_load_dwordx4 v[64:67], v2, s[36:39], s63 offen offset:1024 sc1
    buffer_load_dwordx2 v[72:73], v5, s[36:39], s63 offen offset:0 sc1
    s_waitcnt vmcnt(0)
.gpc_193:
    v_min_u32 v25, v33, v35
    v_max_u32 v26, v33, v35
    v_min3_u32 v25, v25, v41, v43
    v_max3_u32 v26, v26, v41, v43
    v_min3_u32 v25, v25, v49, v57
    v_max3_u32 v26, v26, v49, v57
    v_min3_u32 v25, v25, v59, v65
    v_max3_u32 v26, v26, v59, v65
    v_min3_u32 v25, v25, v67, v73
    v_max3_u32 v26, v26, v67, v73
    v_cmp_eq_u32 vcc, s34, v25
    v_cmp_eq_u32 s[56:57], s34, v26
    s_and_b64 vcc, vcc, s[56:57]
    s_cmp_eq_u64 vcc, -1
    s_nop 2
    s_cbranch_scc1 .gpd_194
    s_sub_u32 s35, s35, 1
    s_cbranch_scc1 .Lexit
    s_sleep 2
    s_branch .gp_192
.gpd_194:
    v_lshlrev_b32 v206, 16, v32
    v_and_b32 v207, 0xffff0000, v32
    v_lshlrev_b32 v216, 16, v56
    v_and_b32 v217, 0xffff0000, v56
    v_lshlrev_b32 v208, 16, v34
    v_and_b32 v209, 0xffff0000, v34
    v_lshlrev_b32 v218, 16, v58
    v_and_b32 v219, 0xffff0000, v58
    v_lshlrev_b32 v210, 16, v40
    v_and_b32 v211, 0xffff0000, v40
    v_lshlrev_b32 v220, 16, v64
    v_and_b32 v221, 0xffff0000, v64
    v_lshlrev_b32 v212, 16, v42
    v_and_b32 v213, 0xffff0000, v42
    v_lshlrev_b32 v222, 16, v66
    v_and_b32 v223, 0xffff0000, v66
    v_lshlrev_b32 v214, 16, v48
    v_and_b32 v215, 0xffff0000, v48
    v_lshlrev_b32 v224, 16, v72
    v_and_b32 v225, 0xffff0000, v72
    s_mov_b32 s94, 1
    s_nop 0
    s_branch .Lbc_go2
.Lbc_again:
    s_mov_b32 s94, 0
    s_waitcnt vmcnt(9)
    s_barrier
    ds_read_b64_tr_b16 v[68:69], v19 offset:0
    ds_read_b64_tr_b16 v[70:71], v19 offset:512
    ds_read_b64_tr_b16 v[72:73], v19 offset:8192
    ds_read_b64_tr_b16 v[74:75], v19 offset:8704
    ds_read_b64_tr_b16 v[76:77], v19 offset:16384
    ds_read_b64_tr_b16 v[78:79], v19 offset:16896
    ds_read_b64_tr_b16 v[80:81], v19 offset:24576
    ds_read_b64_tr_b16 v[82:83], v19 offset:25088
    ds_read_b64_tr_b16 v[84:85], v20 offset:0
    ds_read_b64_tr_b16 v[86:87], v20 offset:512
    ds_read_b64_tr_b16 v[88:89], v20 offset:8192
    ds_read_b64_tr_b16 v[90:91], v20 offset:8704
    ds_read_b64_tr_b16 v[92:93], v20 offset:16384
    ds_read_b64_tr_b16 v[94:95], v20 offset:16896
    ds_read_b64_tr_b16 v[96:97], v20 offset:24576
    ds_read_b64_tr_b16 v[98:99], v20 offset:25088
    ds_read_b64_tr_b16 v[100:101], v20 offset:32768
    ds_read_b64_tr_b16 v[102:103], v20 offset:33280
    s_waitcnt vmcnt(0)
    s_barrier
    ds_read_b64_tr_b16 v[104:105], v28 offset:0
    ds_read_b64_tr_b16 v[106:107], v28 offset:512
    ds_read_b64_tr_b16 v[108:109], v29 offset:0
    ds_read_b64_tr_b16 v[110:111], v29 offset:512
    ds_read_b64_tr_b16 v[112:113], v28 offset:4096
    ds_read_b64_tr_b16 v[114:115], v28 offset:4608
    ds_read_b64_tr_b16 v[116:117], v29 offset:4096
    ds_read_b64_tr_b16 v[118:119], v29 offset:4608
    ds_read_b64_tr_b16 v[120:121], v28 offset:32768
    ds_read_b64_tr_b16 v[122:123], v28 offset:33280
    ds_read_b64_tr_b16 v[124:125], v29 offset:32768
    ds_read_b64_tr_b16 v[126:127], v29 offset:33280
    ds_read_b64_tr_b16 v[128:129], v28 offset:36864
    ds_read_b64_tr_b16 v[130:131], v28 offset:37376
    ds_read_b64_tr_b16 v[132:133], v29 offset:36864
    ds_read_b64_tr_b16 v[134:135], v29 offset:37376
    s_cmp_ge_u32 s3, 2
    s_cbranch_scc1 .Lbc_nodn3
    ds_read_b64_tr_b16 v[136:137], v30 offset:0
    ds_read_b64_tr_b16 v[138:139], v30 offset:512
    ds_read_b64_tr_b16 v[140:141], v31 offset:0
    ds_read_b64_tr_b16 v[142:143], v31 offset:512
    ds_read_b64_tr_b16 v[144:145], v30 offset:4096
    ds_read_b64_tr_b16 v[146:147], v30 offset:4608
    ds_read_b64_tr_b16 v[148:149], v31 offset:4096
    ds_read_b64_tr_b16 v[150:151], v31 offset:4608
.Lbc_nodn3:
    s_mov_b32 s69, 0
.gp_195:
    s_add_u32 s69, s69, 1
    s_and_b32 s56, s69, 0x41
    s_cmp_lg_u32 s56, 0x41
    s_cselect_b32 s56, s0, 0
    s_add_u32 s58, s101, s56
    buffer_load_dwordx4 v[196:199], v2, s[36:39], s58 offen offset:0 sc1
    buffer_load_dwordx4 v[200:203], v2, s[36:39], s58 offen offset:1024 sc1
    buffer_load_dwordx2 v[204:205], v5, s[36:39], s58 offen offset:0 sc1
    s_waitcnt vmcnt(0)
    v_min3_u32 v25, v197, v199, v201
    v_max3_u32 v26, v197, v199, v201
    v_min3_u32 v25, v25, v203, v205
    v_max3_u32 v26, v26, v203, v205
    v_cmp_eq_u32 vcc, s34, v25
    v_cmp_eq_u32 s[56:57], s34, v26
    s_and_b64 vcc, vcc, s[56:57]
    s_cmp_eq_u64 vcc, -1
    s_nop 2
    s_cbranch_scc1 .gpd_196
    s_sub_u32 s35, s35, 1
    s_cbranch_scc1 .Lexit
    s_branch .gp_195
.gpd_196:
.Lbc_go:
    s_mov_b32 s56, 0x3f803f80
    v_dot2_f32_bf16 v236, v196, s56, 0
    v_dot2_f32_bf16 v237, v196, v196, 0
    v_dot2_f32_bf16 v236, v198, s56, v236
    v_dot2_f32_bf16 v237, v198, v198, v237
    v_dot2_f32_bf16 v236, v200, s56, v236
    v_dot2_f32_bf16 v237, v200, v200, v237
    v_dot2_f32_bf16 v236, v202, s56, v236
    v_dot2_f32_bf16 v237, v202, v202, v237
    s_mov_b64 exec, 0xffffffff
    v_dot2_f32_bf16 v236, v204, s56, v236
    v_dot2_f32_bf16 v237, v204, v204, v237
    s_mov_b64 exec, -1
    s_nop 1
    v_permlane32_swap_b32 v236, v237
    v_add_f32 v236, v236, v237
    v_mov_b32 v238, v236
    s_nop 1
    v_permlane16_swap_b32 v238, v236
    v_add_f32 v236, v238, v236
    v_lshlrev_b32 v226, 16, v196
    v_and_b32 v227, 0xffff0000, v196
    v_add_f32_dpp v236, v236, v236 row_ror:8 row_mask:0xf bank_mask:0xf
    v_lshlrev_b32 v228, 16, v198
    v_and_b32 v229, 0xffff0000, v198
    v_add_f32_dpp v236, v236, v236 row_ror:4 row_mask:0xf bank_mask:0xf
    v_lshlrev_b32 v230, 16, v200
    v_and_b32 v231, 0xffff0000, v200
    v_add_f32_dpp v236, v236, v236 quad_perm:[2,3,0,1] row_mask:0xf bank_mask:0xf
    v_lshlrev_b32 v232, 16, v202
    v_and_b32 v233, 0xffff0000, v202
    v_add_f32_dpp v236, v236, v236 quad_perm:[1,0,3,2] row_mask:0xf bank_mask:0xf
    v_mul_f32 v236, 0x3ae38e39, v236
    v_lshlrev_b32 v234, 16, v204
    v_and_b32 v235, 0xffff0000, v204
    v_readlane_b32 s56, v236, 0
    v_readlane_b32 s57, v236, 32
    s_nop 0
    v_mov_b32 v236, s56
    v_fma_f32 v237, -v236, v236, s57
    v_max_f32 v237, 0, v237
    v_cvt_pk_bf16_f32 v238, -v236, v237
    v_and_b32 v239, 0xffff0000, v238
    v_add_f32 v239, 0x3727c5ac, v239
    v_lshlrev_b32 v236, 16, v238
    v_cvt_pk_bf16_f32 v239, v239, v239
    v_lshlrev_b32 v239, 16, v239
    v_sqrt_f32 v239, v239
    v_mov_b32 v237, v236
    v_cvt_pk_bf16_f32 v239, v239, v239
    v_lshlrev_b32 v239, 16, v239
    v_rcp_f32 v238, v239
    v_rcp_f32 v239, v239
    v_pk_add_f32 v[226:227], v[226:227], v[236:237]
    v_pk_add_f32 v[228:229], v[228:229], v[236:237]
    v_pk_add_f32 v[230:231], v[230:231], v[236:237]
    v_pk_add_f32 v[232:233], v[232:233], v[236:237]
    v_pk_add_f32 v[234:235], v[234:235], v[236:237]
    v_cvt_pk_bf16_f32 v226, v226, v227
    v_and_b32 v227, 0xffff0000, v226
    v_lshlrev_b32 v226, 16, v226
    v_cvt_pk_bf16_f32 v228, v228, v229
    v_and_b32 v229, 0xffff0000, v228
    v_lshlrev_b32 v228, 16, v228
    v_cvt_pk_bf16_f32 v230, v230, v231
    v_and_b32 v231, 0xffff0000, v230
    v_lshlrev_b32 v230, 16, v230
    v_cvt_pk_bf16_f32 v232, v232, v233
    v_and_b32 v233, 0xffff0000, v232
    v_lshlrev_b32 v232, 16, v232
    v_cvt_pk_bf16_f32 v234, v234, v235
    v_and_b32 v235, 0xffff0000, v234
    v_lshlrev_b32 v234, 16, v234
    v_pk_mul_f32 v[226:227], v[226:227], v[238:239]
    v_pk_mul_f32 v[228:229], v[228:229], v[238:239]
    v_pk_mul_f32 v[230:231], v[230:231], v[238:239]
    v_pk_mul_f32 v[232:233], v[232:233], v[238:239]
    v_pk_mul_f32 v[234:235], v[234:235], v[238:239]
    v_cvt_pk_bf16_f32 v226, v226, v227
    v_and_b32 v227, 0xffff0000, v226
    v_lshlrev_b32 v226, 16, v226
    v_cvt_pk_bf16_f32 v228, v228, v229
    v_and_b32 v229, 0xffff0000, v228
    v_lshlrev_b32 v228, 16, v228
    v_cvt_pk_bf16_f32 v230, v230, v231
    v_and_b32 v231, 0xffff0000, v230
    v_lshlrev_b32 v230, 16, v230
    v_cvt_pk_bf16_f32 v232, v232, v233
    v_and_b32 v233, 0xffff0000, v232
    v_lshlrev_b32 v232, 16, v232
    v_cvt_pk_bf16_f32 v234, v234, v235
    v_and_b32 v235, 0xffff0000, v234
    v_lshlrev_b32 v234, 16, v234
    v_pk_mul_f32 v[226:227], v[226:227], v[216:217]
    v_pk_mul_f32 v[228:229], v[228:229], v[218:219]
    v_pk_mul_f32 v[230:231], v[230:231], v[220:221]
    v_pk_mul_f32 v[232:233], v[232:233], v[222:223]
    v_pk_mul_f32 v[234:235], v[234:235], v[224:225]
    v_cvt_pk_bf16_f32 v226, v226, v227
    v_and_b32 v227, 0xffff0000, v226
    v_lshlrev_b32 v226, 16, v226
    v_cvt_pk_bf16_f32 v228, v228, v229
    v_and_b32 v229, 0xffff0000, v228
    v_lshlrev_b32 v228, 16, v228
    v_cvt_pk_bf16_f32 v230, v230, v231
    v_and_b32 v231, 0xffff0000, v230
    v_lshlrev_b32 v230, 16, v230
    v_cvt_pk_bf16_f32 v232, v232, v233
    v_and_b32 v233, 0xffff0000, v232
    v_lshlrev_b32 v232, 16, v232
    v_cvt_pk_bf16_f32 v234, v234, v235
    v_and_b32 v235, 0xffff0000, v234
    v_lshlrev_b32 v234, 16, v234
    v_pk_add_f32 v[226:227], v[226:227], v[206:207]
    v_pk_add_f32 v[228:229], v[228:229], v[208:209]
    v_pk_add_f32 v[230:231], v[230:231], v[210:211]
    v_pk_add_f32 v[232:233], v[232:233], v[212:213]
    v_pk_add_f32 v[234:235], v[234:235], v[214:215]
    v_cvt_pk_bf16_f32 v242, v226, v227
    v_cvt_pk_bf16_f32 v243, v228, v229
    v_cvt_pk_bf16_f32 v244, v230, v231
    v_cvt_pk_bf16_f32 v245, v232, v233
    v_cvt_pk_bf16_f32 v246, v234, v235
    ds_write_b64 v17, v[242:243] offset:0
    ds_write_b64 v17, v[244:245] offset:512
    ds_write_b32 v18, v246 offset:0
    s_waitcnt lgkmcnt(0)
    s_barrier
    ds_read_b128 v[32:35], v16 offset:0
    ds_read_b128 v[36:39], v16 offset:128
    ds_read_b128 v[40:43], v16 offset:256
    ds_read_b128 v[44:47], v16 offset:384
    ds_read_b128 v[48:51], v16 offset:512
    ds_read_b128 v[52:55], v16 offset:640
    ds_read_b128 v[56:59], v16 offset:768
    ds_read_b128 v[60:63], v16 offset:896
    ds_read_b128 v[64:67], v16 offset:1024
    s_waitcnt lgkmcnt(8)
    v_mfma_f32_16x16x32_bf16 v[152:155], v[160:163], v[32:35], 0
    v_mfma_f32_16x16x32_bf16 v[156:159], v[68:71], v[32:35], 0
    s_waitcnt lgkmcnt(7)
    v_mfma_f32_16x16x32_bf16 v[152:155], v[164:167], v[36:39], v[152:155]
    v_mfma_f32_16x16x32_bf16 v[156:159], v[72:75], v[36:39], v[156:159]
    s_waitcnt lgkmcnt(6)
    v_mfma_f32_16x16x32_bf16 v[152:155], v[168:171], v[40:43], v[152:155]
    v_mfma_f32_16x16x32_bf16 v[156:159], v[76:79], v[40:43], v[156:159]
    s_waitcnt lgkmcnt(5)
    v_mfma_f32_16x16x32_bf16 v[152:155], v[172:175], v[44:47], v[152:155]
    v_mfma_f32_16x16x32_bf16 v[156:159], v[80:83], v[44:47], v[156:159]
    s_waitcnt lgkmcnt(4)
    v_mfma_f32_16x16x32_bf16 v[152:155], v[176:179], v[48:51], v[152:155]
    v_mfma_f32_16x16x32_bf16 v[156:159], v[84:87], v[48:51], v[156:159]
    s_waitcnt lgkmcnt(3)
    v_mfma_f32_16x16x32_bf16 v[152:155], v[180:183], v[52:55], v[152:155]
    v_mfma_f32_16x16x32_bf16 v[156:159], v[88:91], v[52:55], v[156:159]
    s_waitcnt lgkmcnt(2)
    v_mfma_f32_16x16x32_bf16 v[152:155], v[184:187], v[56:59], v[152:155]
    v_mfma_f32_16x16x32_bf16 v[156:159], v[92:95], v[56:59], v[156:159]
    s_waitcnt lgkmcnt(1)
    v_mfma_f32_16x16x32_bf16 v[152:155], v[188:191], v[60:63], v[152:155]
    v_mfma_f32_16x16x32_bf16 v[156:159], v[96:99], v[60:63], v[156:159]
    s_waitcnt lgkmcnt(0)
    v_mfma_f32_16x16x32_bf16 v[152:155], v[192:195], v[64:67], v[152:155]
    v_mfma_f32_16x16x32_bf16 v[156:159], v[100:103], v[64:67], v[156:159]
.Lbc_go2:
    s_nop 6
    v_permlane32_swap_b32 v152, v154
    v_permlane32_swap_b32 v153, v155
    v_cndmask_b32 v153, v153, v154, s[96:97]
    v_cndmask_b32 v152, v152, v155, s[96:97]
    s_nop 1
    v_add_f32_dpp v12, v153, v152 quad_perm:[1,0,3,2] row_mask:0xf bank_mask:0xf
    v_permlane32_swap_b32 v156, v158
    v_permlane32_swap_b32 v157, v159
    v_cndmask_b32 v157, v157, v158, s[96:97]
    v_cndmask_b32 v156, v156, v159, s[96:97]
    s_nop 1
    v_add_f32_dpp v14, v157, v156 quad_perm:[1,0,3,2] row_mask:0xf bank_mask:0xf
    v_cvt_pk_bf16_f32 v12, v12, v12
    v_lshlrev_b32 v12, 16, v12
    v_cvt_pk_bf16_f32 v14, v14, v14
    v_lshlrev_b32 v14, 16, v14
    v_max_f32 v12, 0xc2ae0000, v12
    v_min_f32 v27, 0x43000000, v12
    v_mul_f32 v25, 0xbfb8aa3b, v27
    v_fma_f32 v26, v27, s98, -v25
    v_fmac_f32 v26, 0xb2a57060, v27
    v_exp_f32 v25, v25
    v_mul_f32 v26, 0x3f317218, v26
    v_fmac_f32 v25, v25, v26
    v_add_f32 v25, 1.0, v25
    v_rcp_f32 v26, v25
    s_nop 0
    v_mul_f32 v27, v12, v26
    v_fma_f32 v25, -v27, v25, v12
    v_fma_f32 v12, v25, v26, v27
    v_cvt_pk_bf16_f32 v12, v12, v12
    v_lshlrev_b32 v12, 16, v12
    v_mul_f32 v12, v12, v14
    v_cvt_pk_bf16_f32 v12, v12, v12
    ds_write_b16 v21, v12
    s_mov_b32 s60, 0x07060503
    s_mov_b32 s61, 0x07060502
    s_mov_b32 s62, 0x07060501
    s_mov_b32 vcc_lo, 0xaaaaaaaa
    s_mov_b32 vcc_hi, 0xaaaaaaaa
    v_mov_b32 v59, s34
    v_mov_b32 v63, s34
    v_mov_b32 v67, s34
    s_waitcnt lgkmcnt(0)
    s_barrier
    ds_read_b128 v[8:11], v22
    ds_read_b128 v[12:15], v22 offset:64
    s_waitcnt lgkmcnt(1)
    v_mfma_f32_16x16x32_bf16 v[32:35], v[104:107], v[8:11], 0
    v_mfma_f32_16x16x32_bf16 v[36:39], v[108:111], v[8:11], 0
    v_mfma_f32_16x16x32_bf16 v[40:43], v[120:123], v[8:11], 0
    v_mfma_f32_16x16x32_bf16 v[44:47], v[124:127], v[8:11], 0
    v_mfma_f32_16x16x32_bf16 v[48:51], v[136:139], v[8:11], 0
    v_mfma_f32_16x16x32_bf16 v[52:55], v[140:143], v[8:11], 0
    s_waitcnt lgkmcnt(0)
    v_mfma_f32_16x16x32_bf16 v[32:35], v[112:115], v[12:15], v[32:35]
    v_mfma_f32_16x16x32_bf16 v[36:39], v[116:119], v[12:15], v[36:39]
    v_mfma_f32_16x16x32_bf16 v[40:43], v[128:131], v[12:15], v[40:43]
    v_mfma_f32_16x16x32_bf16 v[44:47], v[132:135], v[12:15], v[44:47]
    v_mfma_f32_16x16x32_bf16 v[48:51], v[144:147], v[12:15], v[48:51]
    v_mfma_f32_16x16x32_bf16 v[52:55], v[148:151], v[12:15], v[52:55]
    s_cmp_lg_u32 s94, 0
    s_nop 2
    v_cndmask_b32 v32, v32, v36, vcc
    v_cndmask_b32 v33, v33, v37, vcc
    v_cndmask_b32 v34, v34, v38, vcc
    v_cndmask_b32 v35, v35, v39, vcc
    v_perm_b32 v56, v32, v35, s60
    v_perm_b32 v57, v33, v35, s61
    v_perm_b32 v58, v34, v35, s62
    s_nop 1
    s_cbranch_scc1 .Lbc_ns0
    buffer_store_dwordx4 v[56:59], v23, s[36:39], s59 offen sc1
.Lbc_ns0:
    v_cndmask_b32 v40, v40, v44, vcc
    v_cndmask_b32 v41, v41, v45, vcc
    v_cndmask_b32 v42, v42, v46, vcc
    v_cndmask_b32 v43, v43, v47, vcc
    v_perm_b32 v60, v40, v43, s60
    v_perm_b32 v61, v41, v43, s61
    v_perm_b32 v62, v42, v43, s62
    s_nop 1
    s_cbranch_scc1 .Lbc_ns1
    buffer_store_dwordx4 v[60:63], v23, s[36:39], s99 offen sc1
.Lbc_ns1:
    v_cndmask_b32 v48, v48, v52, vcc
    v_cndmask_b32 v49, v49, v53, vcc
    v_cndmask_b32 v50, v50, v54, vcc
    v_cndmask_b32 v51, v51, v55, vcc
    v_perm_b32 v64, v48, v51, s60
    v_perm_b32 v65, v49, v51, s61
    v_perm_b32 v66, v50, v51, s62
    s_nop 1
    s_cbranch_scc1 .Lbc_again
    s_cmp_ge_u32 s3, 2
    s_cbranch_scc1 .Lbc_nost3
    buffer_store_dwordx4 v[64:67], v23, s[36:39], s100 offen sc1
.Lbc_nost3:
.Lexit:
.Lend:
s_endpgm
.section .rodata,"a"
.p2align 6
.amdhsa_kernel adaLN_cond__sliding_block_cached__moe_arch_mod__decode_kernel
  .amdhsa_next_free_vgpr 256
  .amdhsa_next_free_sgpr 102
  .amdhsa_accum_offset 256
  .amdhsa_group_segment_fixed_size 0
  .amdhsa_kernarg_size 120
  .amdhsa_user_sgpr_count 2
  .amdhsa_user_sgpr_kernarg_segment_ptr 1
  .amdhsa_system_sgpr_workgroup_id_x 1
.end_amdhsa_kernel
```

```asm
; @launch grid=(256,1,1) block=(512,1,1) lds=159360
.amdgcn_target "amdgcn-amd-amdhsa--gfx950"
.text
.p2align 12
.globl adaLN_cond__sliding_block_cached__moe_arch_mod__decode_kernel
.p2align 8
.type adaLN_cond__sliding_block_cached__moe_arch_mod__decode_kernel,@function
adaLN_cond__sliding_block_cached__moe_arch_mod__decode_kernel:
    s_cmp_ge_u32 s2, 256
    s_cbranch_scc1 .Lend
    s_load_dwordx16 s[4:19], s[0:1], 0
    s_load_dwordx8 s[20:27], s[0:1], 64
    s_load_dwordx4 s[28:31], s[0:1], 96
    s_load_dwordx2 s[32:33], s[0:1], 112
    s_memrealtime s[70:71]
    v_lshrrev_b32 v1, 6, v0
    v_and_b32 v0, 63, v0
    v_readfirstlane_b32 s3, v1
    s_cmp_lt_u32 s3, 4
    s_nop 3
    s_cbranch_scc1 .Ltw_done
    s_cmp_lt_u32 s2, 72
    s_cbranch_scc1 .Ltw_m
    s_cmp_lt_u32 s2, 144
    s_cbranch_scc1 .Ltw_b
    s_cmp_lt_u32 s2, 208
    s_cbranch_scc1 .Ltw_q
    s_cmp_eq_u32 s3, 4
    s_cbranch_scc1 .Lst_a0_0
    s_cmp_eq_u32 s3, 5
    s_cbranch_scc1 .Lst_a0_1
.Lrt_a0_0:
.Lrt_a0_1:
    s_branch .Ltw_done
.Ltw_m:
    s_cmp_eq_u32 s3, 4
    s_cbranch_scc1 .Lst_m0_0
    s_cmp_eq_u32 s3, 5
    s_cbranch_scc1 .Lst_m0_1
.Lrt_m0_1:
    s_cmp_eq_u32 s3, 6
    s_cbranch_scc1 .Lst_m0_2
.Lrt_m0_2:
    s_cmp_eq_u32 s3, 7
    s_cbranch_scc1 .Lst_m0_3
    s_cmp_eq_u32 s3, 5
    s_cbranch_scc1 .Lst_m0_4
    s_cmp_eq_u32 s3, 6
    s_cbranch_scc1 .Lst_m0_5
.Lrt_m0_0:
.Lrt_m0_3:
.Lrt_m0_4:
.Lrt_m0_5:
    s_branch .Ltw_done
.Ltw_b:
    s_cmp_eq_u32 s3, 4
    s_cbranch_scc1 .Lst_b0_0
    s_cmp_eq_u32 s3, 5
    s_cbranch_scc1 .Lst_b0_1
    s_cmp_eq_u32 s3, 6
    s_cbranch_scc1 .Lst_b0_2
    s_cmp_eq_u32 s3, 7
    s_cbranch_scc1 .Lst_b0_3
.Lrt_b0_0:
.Lrt_b0_1:
.Lrt_b0_2:
.Lrt_b0_3:
    s_branch .Ltw_done
.Ltw_q:
    s_cmp_eq_u32 s3, 4
    s_cbranch_scc1 .Lst_q0_0
    s_cmp_eq_u32 s3, 5
    s_cbranch_scc1 .Lst_q0_1
    s_cmp_eq_u32 s3, 6
    s_cbranch_scc1 .Lst_q0_2
    s_cmp_eq_u32 s3, 7
    s_cbranch_scc1 .Lst_q0_3
.Lrt_q0_0:
.Lrt_q0_1:
.Lrt_q0_2:
.Lrt_q0_3:
.Ltw_done:
    s_mov_b32 s35, 0x3ffff
    s_mov_b32 s98, 0xbfb8aa3b
    s_mov_b32 s94, 0x05040100
    s_mov_b32 s95, 0x07060302
    s_mov_b32 s96, 0xaaaaaaaa
    s_mov_b32 s97, 0xaaaaaaaa
    s_and_b32 s64, s2, 7
    s_lshr_b32 s65, s2, 3
    s_mov_b32 s58, 0x2554433
    s_mov_b32 s59, 0x2877661
    s_cmp_ge_u32 s65, 16
    s_cselect_b32 s58, 0xbb1aa998, s58
    s_cselect_b32 s59, 0xffeeddcc, s59
    s_lshl_b32 s57, s65, 2
    s_lshr_b64 s[58:59], s[58:59], s57
    s_lshl1_add_u32 s59, s64, 1
    s_mul_i32 s58, s58, s59
    s_add_u32 s58, s58, s64
    s_add_u32 s58, s58, s59
    s_and_b32 s66, s58, 7
    s_bfe_u32 s67, s58, 0x10003
    s_lshl1_add_u32 s67, s64, s67
    s_lshr_b32 s68, 0xaab5d42a, s65
    s_and_b32 s68, s68, 1
    s_movk_i32 s60, 0x7651
    s_cselect_b32 s60, 0x4320, s60
    s_lshl4_add_u32 s69, s66, s67
    s_lshl_b32 s69, s69, 21
    s_cmp_eq_u32 s64, 7
    s_cselect_b32 s58, 0x4040, 0
    s_or_b32 s58, s58, 0x208180
    s_bitcmp1_b32 s58, s65
    s_cselect_b32 s60, s60, 0x3210
    s_and_b32 s57, s3, 1
    s_and_b32 s59, s3, 6
    s_cmpk_eq_u32 s60, 0x3210
    s_cselect_b32 s57, s68, s57
    s_cselect_b32 s59, s3, s59
    s_lshl_b32 s57, s57, 16
    s_lshl_b32 s59, s59, 10
    s_add_u32 s69, s69, s57
    s_add_u32 s69, s69, s59
    s_add_u32 s69, s69, 0x180000
    v_bfe_u32 v1, v0, 2, 2
    v_lshlrev_b32 v1, 2, v1
    v_bfe_u32 v1, s60, v1, 4
    v_lshrrev_b32 v2, 4, v0
    v_lshl_add_u32 v1, v1, 2, v2
    v_and_b32 v2, 3, v0
    v_lshl_add_u32 v1, v1, 2, v2
    v_lshlrev_b32 v1, 4, v1
    v_lshlrev_b32 v2, 4, v0
    v_lshlrev_b32 v3, 3, v0
    v_and_b32 v4, 31, v0
    v_lshlrev_b32 v4, 2, v4
    v_add_u32 v4, 1024, v4
    v_lshlrev_b32 v5, 1, v4
    s_waitcnt lgkmcnt(0)
    s_load_dword s34, s[32:33], 0
    s_mov_b32 s40, s6
    s_and_b32 s41, s7, 0xffff
    s_mov_b32 s42, 0x10000000
    s_mov_b32 s43, 0x00020000
    s_mov_b32 s6, s60
    s_add_u32 s63, s69, 0
    buffer_load_dwordx4 v[32:35], v1, s[40:43], s63 offen nt
    s_add_u32 s63, s69, 8192
    buffer_load_dwordx4 v[36:39], v1, s[40:43], s63 offen nt
    s_add_u32 s63, s69, 16384
    buffer_load_dwordx4 v[64:67], v1, s[40:43], s63 offen nt
    s_add_u32 s63, s69, 24576
    buffer_load_dwordx4 v[68:71], v1, s[40:43], s63 offen nt
.Lnokpre:
    s_mov_b32 s44, s8
    s_and_b32 s45, s9, 0xffff
    s_mov_b32 s46, 0x10000000
    s_mov_b32 s47, 0x00020000
    s_cmp_eq_u32 s3, 0
    s_cselect_b64 exec, 1, 0
    buffer_load_dword v255, v2, s[44:47], s69 offen nt
    s_mov_b64 exec, -1
    s_mov_b32 s36, s32
    s_and_b32 s37, s33, 0xffff
    s_mov_b32 s38, 0x40000000
    s_mov_b32 s39, 0x00020000
    s_lshl3_add_u32 s56, s3, s2
    s_cmp_lt_u32 s56, 8
    s_cbranch_scc0 .Let_no
    s_lshl2_add_u32 s56, s2, 0x4a1000
    v_lshlrev_b32 v6, 8, v0
    v_mov_b32 v7, s70
    s_mov_b64 exec, 3
    buffer_store_dword v7, v6, s[36:39], s56 offen sc1
    s_mov_b64 exec, -1
.Let_no:
    v_mov_b32 v6, 159232
    v_mov_b32 v7, 0
    ds_write_b32 v6, v7
    s_waitcnt lgkmcnt(0)
    s_barrier
    s_cmp_lt_u32 s3, 4
    s_cbranch_scc1 1
    s_setprio 1
    s_cmp_lt_u32 s65, 9
    s_cbranch_scc1 .Lm
    s_cmp_lt_u32 s65, 18
    s_cbranch_scc1 .Lbc
    s_sub_u32 s65, s65, 18
    s_cmp_ge_u32 s65, 8
    s_cbranch_scc1 .La_early
    s_cmp_eq_u32 s65, 3
    s_mov_b32 s14, 0xb55aab55
    s_cselect_b32 s14, 0x8421084, s14
    s_mov_b32 s15, 0x5aab55aa
    s_cselect_b32 s15, 0x42108421, s15
    s_add_u32 s30, s70, 0
    s_mov_b32 s31, s70
    v_bfe_u32 v16, v0, 1, 3
    v_mul_u32_u24 v16, 1312, v16
    v_lshrrev_b32 v12, 4, v0
    v_lshl_add_u32 v16, v12, 5, v16
    v_and_b32 v12, 1, v0
    v_lshl_add_u32 v16, v12, 4, v16
    v_add_u32 v16, 147456, v16
    s_mul_i32 s56, s3, 1312
    s_add_u32 s56, s56, 147456
    v_add_u32 v17, s56, v3
    v_add_u32 v18, s56, v4
    v_lshrrev_b32 v12, 4, v0
    v_bfe_u32 v13, v0, 1, 1
    v_lshl_add_u32 v12, v12, 1, v13
    v_bfe_u32 v13, v0, 2, 2
    v_lshl_add_u32 v20, v12, 3, v13
    v_lshlrev_b32 v20, 7, v20
    v_and_b32 v12, 3, v12
    v_lshrrev_b32 v13, 1, v13
    v_lshl_add_u32 v12, v12, 1, v13
    v_xor_b32 v12, s3, v12
    v_lshl_add_u32 v20, v12, 4, v20
    v_and_b32 v12, 1, v0
    v_lshl_add_u32 v20, v12, 3, v20
    v_bfe_u32 v23, v0, 1, 3
    v_mul_u32_u24 v23, 144, v23
    v_bfe_u32 v12, v0, 4, 1
    v_lshl_add_u32 v23, v12, 3, v23
    s_branch .Lsk_q0_0
.Lst_q0_0:
    s_branch .Lrt_q0_0
.Lsk_q0_0:
    v_lshrrev_b32 v12, 5, v0
    v_lshl_add_u32 v23, v12, 2, v23
    v_and_b32 v12, 1, v0
    v_lshl_add_u32 v23, v12, 1, v23
    s_lshl_b32 s56, s3, 4
    s_add_u32 s56, s56, 157952
    v_add_u32 v23, s56, v23
    v_and_b32 v24, 15, v0
    v_lshlrev_b32 v24, 3, v24
    s_mul_i32 s56, s3, 144
    s_add_u32 s56, s56, 157952
    v_add_u32 v24, s56, v24
    v_add_u32 v21, 32768, v20
    s_lshl_b32 s100, s3, 10
    s_mul_i32 s58, s3, 1152
    s_mov_b32 s52, s4
    s_and_b32 s53, s5, 0xffff
    s_mov_b32 s54, 0x2400
    s_mov_b32 s55, 0x00020000
    buffer_load_dwordx2 v[246:247], v3, s[52:55], s58 offen
    buffer_load_dwordx2 v[248:249], v3, s[52:55], s58 offen offset:512
    buffer_load_dword v250, v4, s[52:55], s58 offen
    s_mov_b32 s48, s10
    s_and_b32 s49, s11, 0xffff
    s_mov_b32 s50, 0x480000
    s_mov_b32 s51, 0x00020000
    v_bfe_u32 v12, v0, 4, 1
    s_and_b32 s56, s3, 3
    s_lshl_b32 s56, s56, 1
    v_or_b32 v12, s56, v12
    v_and_b32 v19, 7, v0
    v_xor_b32 v12, v12, v19
    v_lshrrev_b32 v19, 3, v0
    v_mul_u32_u24 v19, 8192, v19
    v_lshl_add_u32 v19, v12, 4, v19
    s_lshl3_add_u32 s101, s64, s65
    s_lshl_b32 s57, s3, 16
    s_lshl_b32 s59, s101, 7
    s_add_u32 s57, s57, s59
    s_mov_b32 s99, s57
    s_add_u32 m0, s100, 0
    s_add_u32 s56, s99, 0
    buffer_load_dwordx4 v19, s[48:51], s56 offen nt lds
    s_add_u32 s63, s69, 32768
    buffer_load_dwordx4 v[96:99], v1, s[40:43], s63 offen nt
    s_waitcnt lgkmcnt(0)
    s_add_u32 s34, s34, 1
    s_getreg_b32 s1, hwreg(HW_REG_XCC_ID)
    s_lshl_b32 s1, s1, 24
    s_add_u32 s1, s1, s34
    s_lshr_b32 s0, s2, 3
    s_lshl_b32 s63, s64, 8
    s_add_u32 s0, s0, s63
    s_lshl2_add_u32 s0, s0, 0x480000
    v_mov_b32 v30, s1
    s_cmp_eq_u32 s3, 0
    s_cselect_b64 exec, 1, 0
    buffer_store_dword v30, v2, s[36:39], s0 offen sc1
    s_mov_b64 exec, -1
    s_and_b32 s58, s101, 1
    s_lshl_b32 s101, s101, 8
    s_lshl_b32 s58, s58, 7
    s_sub_u32 s101, s101, s58
    s_lshl_b32 s58, s3, 14
    s_add_u32 s101, s101, s58
    s_add_u32 s101, s101, 0x70000
    s_and_b32 s58, s64, 1
    s_mul_i32 s58, s58, 18432
    s_mul_i32 s59, s3, 2304
    s_add_u32 s58, s58, s59
    s_add_u32 s58, s58, 0x1000
    s_add_u32 s59, s58, 73728
    s_waitcnt vmcnt(5)
    s_add_u32 m0, s100, 8192
    s_add_u32 s56, s99, 524288
    buffer_load_dwordx4 v19, s[48:51], s56 offen nt lds
    s_waitcnt vmcnt(5)
    s_add_u32 s63, s69, 40960
    buffer_load_dwordx4 v[100:103], v1, s[40:43], s63 offen nt
    s_waitcnt vmcnt(5)
    s_add_u32 m0, s100, 16384
    s_add_u32 s56, s99, 1048576
    buffer_load_dwordx4 v19, s[48:51], s56 offen nt lds
    s_waitcnt vmcnt(5)
    s_add_u32 s63, s69, 49152
    buffer_load_dwordx4 v[128:131], v1, s[40:43], s63 offen nt
    v_lshlrev_b32 v236, 16, v246
    v_and_b32 v237, 0xffff0000, v246
    v_lshlrev_b32 v238, 16, v247
    v_and_b32 v239, 0xffff0000, v247
    v_lshlrev_b32 v240, 16, v248
    v_and_b32 v241, 0xffff0000, v248
    v_lshlrev_b32 v242, 16, v249
    v_and_b32 v243, 0xffff0000, v249
    v_lshlrev_b32 v244, 16, v250
    v_and_b32 v245, 0xffff0000, v250
    s_mov_b32 s56, 0x3f803f80
    v_dot2_f32_bf16 v10, v246, s56, 0
    v_dot2_f32_bf16 v11, v246, v246, 0
    v_dot2_f32_bf16 v10, v247, s56, v10
    v_dot2_f32_bf16 v11, v247, v247, v11
    v_dot2_f32_bf16 v10, v248, s56, v10
    v_dot2_f32_bf16 v11, v248, v248, v11
    v_dot2_f32_bf16 v10, v249, s56, v10
    v_dot2_f32_bf16 v11, v249, v249, v11
    s_mov_b64 exec, 0xffffffff
    v_dot2_f32_bf16 v10, v250, s56, v10
    v_dot2_f32_bf16 v11, v250, v250, v11
    s_mov_b64 exec, -1
    s_nop 1
    v_permlane32_swap_b32 v10, v11
    v_add_f32 v10, v10, v11
    v_mov_b32 v12, v10
    s_nop 1
    v_permlane16_swap_b32 v12, v10
    v_add_f32 v10, v12, v10
    s_nop 1
    v_add_f32_dpp v10, v10, v10 row_ror:8 row_mask:0xf bank_mask:0xf
    s_nop 1
    v_add_f32_dpp v10, v10, v10 row_ror:4 row_mask:0xf bank_mask:0xf
    s_nop 1
    v_add_f32_dpp v10, v10, v10 quad_perm:[2,3,0,1] row_mask:0xf bank_mask:0xf
    s_nop 1
    v_add_f32_dpp v10, v10, v10 quad_perm:[1,0,3,2] row_mask:0xf bank_mask:0xf
    v_mul_f32 v10, 0x3ae38e39, v10
    s_nop 0
    v_readlane_b32 s56, v10, 0
    v_readlane_b32 s57, v10, 32
    s_nop 0
    v_mov_b32 v10, s56
    v_fma_f32 v11, -v10, v10, s57
    v_max_f32 v11, 0, v11
    v_cvt_pk_bf16_f32 v12, -v10, v11
    v_and_b32 v13, 0xffff0000, v12
    v_add_f32 v13, 0x3727c5ac, v13
    v_lshlrev_b32 v10, 16, v12
    v_cvt_pk_bf16_f32 v13, v13, v13
    v_lshlrev_b32 v13, 16, v13
    v_sqrt_f32 v13, v13
    v_mov_b32 v11, v10
    v_cvt_pk_bf16_f32 v13, v13, v13
    v_lshlrev_b32 v13, 16, v13
    v_rcp_f32 v12, v13
    v_rcp_f32 v13, v13
    v_pk_add_f32 v[236:237], v[236:237], v[10:11]
    v_pk_add_f32 v[238:239], v[238:239], v[10:11]
    v_pk_add_f32 v[240:241], v[240:241], v[10:11]
    v_pk_add_f32 v[242:243], v[242:243], v[10:11]
    v_pk_add_f32 v[244:245], v[244:245], v[10:11]
    v_cvt_pk_bf16_f32 v236, v236, v237
    v_and_b32 v237, 0xffff0000, v236
    v_lshlrev_b32 v236, 16, v236
    v_cvt_pk_bf16_f32 v238, v238, v239
    v_and_b32 v239, 0xffff0000, v238
    v_lshlrev_b32 v238, 16, v238
    v_cvt_pk_bf16_f32 v240, v240, v241
    v_and_b32 v241, 0xffff0000, v240
    v_lshlrev_b32 v240, 16, v240
    v_cvt_pk_bf16_f32 v242, v242, v243
    v_and_b32 v243, 0xffff0000, v242
    v_lshlrev_b32 v242, 16, v242
    v_cvt_pk_bf16_f32 v244, v244, v245
    v_and_b32 v245, 0xffff0000, v244
    v_lshlrev_b32 v244, 16, v244
    v_pk_mul_f32 v[236:237], v[236:237], v[12:13]
    v_pk_mul_f32 v[238:239], v[238:239], v[12:13]
    v_pk_mul_f32 v[240:241], v[240:241], v[12:13]
    v_pk_mul_f32 v[242:243], v[242:243], v[12:13]
    v_pk_mul_f32 v[244:245], v[244:245], v[12:13]
    v_cvt_pk_bf16_f32 v236, v236, v237
    v_and_b32 v237, 0xffff0000, v236
    v_lshlrev_b32 v236, 16, v236
    v_cvt_pk_bf16_f32 v238, v238, v239
    v_and_b32 v239, 0xffff0000, v238
    v_lshlrev_b32 v238, 16, v238
    v_cvt_pk_bf16_f32 v240, v240, v241
    s_branch .Lsk_q0_1
.Lst_q0_1:
    s_branch .Lrt_q0_1
.Lsk_q0_1:
    v_and_b32 v241, 0xffff0000, v240
    v_lshlrev_b32 v240, 16, v240
    v_cvt_pk_bf16_f32 v242, v242, v243
    v_and_b32 v243, 0xffff0000, v242
    v_lshlrev_b32 v242, 16, v242
    v_cvt_pk_bf16_f32 v244, v244, v245
    v_and_b32 v245, 0xffff0000, v244
    v_lshlrev_b32 v244, 16, v244
    s_waitcnt vmcnt(5)
    s_add_u32 m0, s100, 24576
    s_add_u32 s56, s99, 1572864
    buffer_load_dwordx4 v19, s[48:51], s56 offen nt lds
    s_waitcnt vmcnt(4)
    s_add_u32 s63, s69, 57344
    buffer_load_dwordx4 v[132:135], v1, s[40:43], s63 offen nt
    s_waitcnt vmcnt(4)
    s_add_u32 m0, s100, 32768
    s_add_u32 s56, s99, 2097152
    buffer_load_dwordx4 v19, s[48:51], s56 offen nt lds
    s_waitcnt vmcnt(4)
    s_add_u32 s63, s69, 131072
    buffer_load_dwordx4 v[40:43], v1, s[40:43], s63 offen nt
    s_waitcnt vmcnt(4)
    s_add_u32 m0, s100, 40960
    s_add_u32 s56, s99, 2621440
    buffer_load_dwordx4 v19, s[48:51], s56 offen nt lds
    s_waitcnt vmcnt(4)
    s_add_u32 s63, s69, 139264
    buffer_load_dwordx4 v[44:47], v1, s[40:43], s63 offen nt
    s_waitcnt vmcnt(4)
    s_add_u32 m0, s100, 49152
    s_add_u32 s56, s99, 3145728
    buffer_load_dwordx4 v19, s[48:51], s56 offen nt lds
    s_waitcnt vmcnt(4)
    s_add_u32 s63, s69, 147456
    buffer_load_dwordx4 v[72:75], v1, s[40:43], s63 offen nt
    s_waitcnt vmcnt(4)
    s_add_u32 m0, s100, 57344
    s_add_u32 s56, s99, 3670016
    buffer_load_dwordx4 v19, s[48:51], s56 offen nt lds
    s_waitcnt vmcnt(4)
    s_add_u32 s63, s69, 155648
    buffer_load_dwordx4 v[76:79], v1, s[40:43], s63 offen nt
    s_waitcnt vmcnt(4)
    s_add_u32 m0, s100, 65536
    s_add_u32 s56, s99, 4194304
    buffer_load_dwordx4 v19, s[48:51], s56 offen nt lds
    s_waitcnt vmcnt(4)
    s_add_u32 s63, s69, 163840
    buffer_load_dwordx4 v[104:107], v1, s[40:43], s63 offen nt
    s_waitcnt vmcnt(4)
    s_add_u32 s63, s69, 172032
    buffer_load_dwordx4 v[108:111], v1, s[40:43], s63 offen nt
    s_waitcnt vmcnt(4)
    s_add_u32 s63, s69, 180224
    buffer_load_dwordx4 v[136:139], v1, s[40:43], s63 offen nt
    s_waitcnt vmcnt(4)
    s_add_u32 s63, s69, 188416
    buffer_load_dwordx4 v[140:143], v1, s[40:43], s63 offen nt
    s_waitcnt vmcnt(4)
    s_add_u32 s63, s69, 262144
    buffer_load_dwordx4 v[48:51], v1, s[40:43], s63 offen nt
    s_waitcnt vmcnt(4)
    s_add_u32 s63, s69, 270336
    buffer_load_dwordx4 v[52:55], v1, s[40:43], s63 offen nt
    buffer_load_dwordx4 v[196:199], v2, s[36:39], s58 offen offset:0 sc1
    buffer_load_dwordx4 v[200:203], v2, s[36:39], s58 offen offset:1024 sc1
    buffer_load_dwordx2 v[204:205], v5, s[36:39], s58 offen offset:0 sc1
    buffer_load_dwordx4 v[206:209], v2, s[36:39], s59 offen offset:0 sc1
    buffer_load_dwordx4 v[210:213], v2, s[36:39], s59 offen offset:1024 sc1
    buffer_load_dwordx2 v[214:215], v5, s[36:39], s59 offen offset:0 sc1
    s_add_u32 s63, s69, 278528
    buffer_load_dwordx4 v[80:83], v1, s[40:43], s63 offen nt
    s_add_u32 s63, s69, 286720
    buffer_load_dwordx4 v[84:87], v1, s[40:43], s63 offen nt
    s_add_u32 s63, s69, 294912
    buffer_load_dwordx4 v[112:115], v1, s[40:43], s63 offen nt
    s_barrier
    ds_read_b64_tr_b16 v[160:161], v20 offset:0
    ds_read_b64_tr_b16 v[162:163], v20 offset:512
    ds_read_b64_tr_b16 v[164:165], v20 offset:8192
    ds_read_b64_tr_b16 v[166:167], v20 offset:8704
    ds_read_b64_tr_b16 v[168:169], v20 offset:16384
    ds_read_b64_tr_b16 v[170:171], v20 offset:16896
    ds_read_b64_tr_b16 v[172:173], v20 offset:24576
    ds_read_b64_tr_b16 v[174:175], v20 offset:25088
    ds_read_b64_tr_b16 v[176:177], v21 offset:0
    ds_read_b64_tr_b16 v[178:179], v21 offset:512
    ds_read_b64_tr_b16 v[180:181], v21 offset:8192
    ds_read_b64_tr_b16 v[182:183], v21 offset:8704
    ds_read_b64_tr_b16 v[184:185], v21 offset:16384
    ds_read_b64_tr_b16 v[186:187], v21 offset:16896
    ds_read_b64_tr_b16 v[188:189], v21 offset:24576
    ds_read_b64_tr_b16 v[190:191], v21 offset:25088
    ds_read_b64_tr_b16 v[192:193], v21 offset:32768
    ds_read_b64_tr_b16 v[194:195], v21 offset:33280
    s_add_u32 s63, s69, 303104
    buffer_load_dwordx4 v[116:119], v1, s[40:43], s63 offen nt
    s_waitcnt vmcnt(4)
    s_branch .gpc_2
.gp_1:
    buffer_load_dwordx4 v[196:199], v2, s[36:39], s58 offen offset:0 sc1
    buffer_load_dwordx4 v[200:203], v2, s[36:39], s58 offen offset:1024 sc1
    buffer_load_dwordx2 v[204:205], v5, s[36:39], s58 offen offset:0 sc1
    buffer_load_dwordx4 v[206:209], v2, s[36:39], s59 offen offset:0 sc1
    buffer_load_dwordx4 v[210:213], v2, s[36:39], s59 offen offset:1024 sc1
    buffer_load_dwordx2 v[214:215], v5, s[36:39], s59 offen offset:0 sc1
    s_waitcnt vmcnt(0)
.gpc_2:
    v_min_u32 v10, v197, v199
    v_max_u32 v11, v197, v199
    v_min3_u32 v10, v10, v201, v203
    v_max3_u32 v11, v11, v201, v203
    v_min3_u32 v10, v10, v205, v207
    v_max3_u32 v11, v11, v205, v207
    v_min3_u32 v10, v10, v209, v211
    v_max3_u32 v11, v11, v209, v211
    v_min3_u32 v10, v10, v213, v215
    v_max3_u32 v11, v11, v213, v215
    v_cmp_eq_u32 vcc, s34, v10
    v_cmp_eq_u32 s[56:57], s34, v11
    s_and_b64 vcc, vcc, s[56:57]
    s_cmp_eq_u64 vcc, -1
    s_nop 2
    s_cbranch_scc1 .gpd_3
    s_sub_u32 s35, s35, 1
    s_cbranch_scc1 .Lexit
    s_branch .gp_1
.gpd_3:
    s_add_u32 s63, s69, 311296
    buffer_load_dwordx4 v[144:147], v1, s[40:43], s63 offen nt
    v_and_b32 v207, 0xffff0000, v206
    v_lshlrev_b32 v206, 16, v206
    v_and_b32 v209, 0xffff0000, v208
    v_lshlrev_b32 v208, 16, v208
    v_and_b32 v211, 0xffff0000, v210
    v_lshlrev_b32 v210, 16, v210
    v_and_b32 v213, 0xffff0000, v212
    v_lshlrev_b32 v212, 16, v212
    v_and_b32 v215, 0xffff0000, v214
    v_lshlrev_b32 v214, 16, v214
    v_and_b32 v197, 0xffff0000, v196
    v_lshlrev_b32 v196, 16, v196
    v_and_b32 v199, 0xffff0000, v198
    v_lshlrev_b32 v198, 16, v198
    v_and_b32 v201, 0xffff0000, v200
    v_lshlrev_b32 v200, 16, v200
    v_and_b32 v203, 0xffff0000, v202
    v_lshlrev_b32 v202, 16, v202
    v_and_b32 v205, 0xffff0000, v204
    v_lshlrev_b32 v204, 16, v204
    v_pk_mul_f32 v[236:237], v[236:237], v[206:207]
    v_pk_mul_f32 v[238:239], v[238:239], v[208:209]
    v_pk_mul_f32 v[240:241], v[240:241], v[210:211]
    v_pk_mul_f32 v[242:243], v[242:243], v[212:213]
    v_pk_mul_f32 v[244:245], v[244:245], v[214:215]
    v_cvt_pk_bf16_f32 v236, v236, v237
    v_and_b32 v237, 0xffff0000, v236
    v_lshlrev_b32 v236, 16, v236
    v_cvt_pk_bf16_f32 v238, v238, v239
    v_and_b32 v239, 0xffff0000, v238
    s_branch .Lsk_q0_2
.Lst_q0_2:
    s_branch .Lrt_q0_2
.Lsk_q0_2:
    v_lshlrev_b32 v238, 16, v238
    v_cvt_pk_bf16_f32 v240, v240, v241
    v_and_b32 v241, 0xffff0000, v240
    v_lshlrev_b32 v240, 16, v240
    v_cvt_pk_bf16_f32 v242, v242, v243
    v_and_b32 v243, 0xffff0000, v242
    v_lshlrev_b32 v242, 16, v242
    v_cvt_pk_bf16_f32 v244, v244, v245
    s_branch .Lsk_q0_3
.Lst_q0_3:
    s_branch .Lrt_q0_3
.Lsk_q0_3:
    v_and_b32 v245, 0xffff0000, v244
    v_lshlrev_b32 v244, 16, v244
    v_pk_add_f32 v[236:237], v[236:237], v[196:197]
    v_pk_add_f32 v[238:239], v[238:239], v[198:199]
    v_pk_add_f32 v[240:241], v[240:241], v[200:201]
    v_pk_add_f32 v[242:243], v[242:243], v[202:203]
    v_pk_add_f32 v[244:245], v[244:245], v[204:205]
    v_cvt_pk_bf16_f32 v246, v236, v237
    v_cvt_pk_bf16_f32 v247, v238, v239
    v_cvt_pk_bf16_f32 v248, v240, v241
    v_cvt_pk_bf16_f32 v249, v242, v243
    v_cvt_pk_bf16_f32 v250, v244, v245
    ds_write_b64 v17, v[246:247] offset:0
    ds_write_b64 v17, v[248:249] offset:512
    ds_write_b32 v18, v250 offset:0
    s_add_u32 s63, s69, 319488
    buffer_load_dwordx4 v[148:151], v1, s[40:43], s63 offen nt
    s_waitcnt lgkmcnt(0)
    s_barrier
    s_add_u32 s63, s69, 393216
    buffer_load_dwordx4 v[56:59], v1, s[40:43], s63 offen nt
    ds_read_b128 v[196:199], v16 offset:0
    ds_read_b128 v[200:203], v16 offset:128
    ds_read_b128 v[204:207], v16 offset:256
    ds_read_b128 v[208:211], v16 offset:384
    ds_read_b128 v[212:215], v16 offset:512
    ds_read_b128 v[216:219], v16 offset:640
    ds_read_b128 v[220:223], v16 offset:768
    ds_read_b128 v[224:227], v16 offset:896
    ds_read_b128 v[228:231], v16 offset:1024
    s_waitcnt lgkmcnt(8)
    v_mfma_f32_16x16x32_bf16 v[232:235], v[160:163], v[196:199], 0
    s_waitcnt lgkmcnt(7)
    v_mfma_f32_16x16x32_bf16 v[232:235], v[164:167], v[200:203], v[232:235]
    s_waitcnt lgkmcnt(6)
    v_mfma_f32_16x16x32_bf16 v[232:235], v[168:171], v[204:207], v[232:235]
    s_waitcnt lgkmcnt(5)
    v_mfma_f32_16x16x32_bf16 v[232:235], v[172:175], v[208:211], v[232:235]
    s_waitcnt lgkmcnt(4)
    v_mfma_f32_16x16x32_bf16 v[232:235], v[176:179], v[212:215], v[232:235]
    s_waitcnt lgkmcnt(3)
    v_mfma_f32_16x16x32_bf16 v[232:235], v[180:183], v[216:219], v[232:235]
    s_waitcnt lgkmcnt(2)
    v_mfma_f32_16x16x32_bf16 v[232:235], v[184:187], v[220:223], v[232:235]
    s_waitcnt lgkmcnt(1)
    v_mfma_f32_16x16x32_bf16 v[232:235], v[188:191], v[224:227], v[232:235]
    s_waitcnt lgkmcnt(0)
    v_mfma_f32_16x16x32_bf16 v[232:235], v[192:195], v[228:231], v[232:235]
    s_nop 7
    v_permlane32_swap_b32 v232, v234
    v_permlane32_swap_b32 v233, v235
    v_cndmask_b32 v233, v233, v234, s[96:97]
    v_cndmask_b32 v232, v232, v235, s[96:97]
    s_nop 1
    v_add_f32_dpp v236, v233, v232 quad_perm:[1,0,3,2] row_mask:0xf bank_mask:0xf
    v_and_b32 v12, 1, v0
    v_lshlrev_b32 v12, 8, v12
    v_bfe_u32 v13, v0, 1, 3
    v_lshl_add_u32 v12, v13, 4, v12
    v_cvt_pk_bf16_f32 v236, v236, v236
    ds_write_b16 v23, v236
    v_mov_b32 v243, s34
    s_waitcnt lgkmcnt(0)
    s_barrier
    ds_read2_b32 v[244:245], v24 offset1:1
    v_mov_b32 v241, s34
    s_waitcnt lgkmcnt(0)
    v_mov_b32 v240, v244
    v_mov_b32 v242, v245
    s_mov_b64 exec, 0xffff
    buffer_store_dwordx4 v[240:243], v12, s[36:39], s101 offen sc1
    s_mov_b64 exec, -1
    s_waitcnt vmcnt(3)
    s_bitcmp1_b64 s[14:15], 25
    s_cbranch_scc0 1
    s_waitcnt vmcnt(2)
    s_add_u32 s63, s69, 401408
    buffer_load_dwordx4 v[60:63], v1, s[40:43], s63 offen nt
    s_branch .Ln_att
.La_early:
    s_branch .Lsk_a0_0
.Lst_a0_0:
    s_branch .Lrt_a0_0
.Lsk_a0_0:
    s_mov_b32 s14, 0x6ddb76dd
    s_mov_b32 s15, 0xdb76ddb7
    s_add_u32 s30, s70, -60
    s_mov_b32 s31, s70
    s_cmp_ge_u32 s65, 11
    s_cselect_b32 s99, 1, 0
    s_mul_i32 s57, s99, 3
    s_sub_u32 s100, s65, s57
    s_sub_u32 s100, s100, 8
    s_lshl1_add_u32 s99, s64, s99
    s_mov_b32 s48, s12
    s_and_b32 s49, s13, 0xffff
    s_mov_b32 s50, 0x480000
    s_mov_b32 s51, 0x00020000
    v_bfe_u32 v12, v0, 4, 1
    s_and_b32 s56, s3, 1
    s_lshl_b32 s56, s56, 2
    v_lshl_or_b32 v12, v12, 1, s56
    v_and_b32 v13, 7, v0
    v_xor_b32 v12, v12, v13
    v_lshrrev_b32 v13, 3, v0
    v_mul_u32_u24 v13, 1152, v13
    v_lshl_add_u32 v6, v12, 4, v13
    s_mul_i32 s101, s99, 294912
    s_mul_i32 s56, s100, 384
    s_add_u32 s101, s101, s56
    s_mul_i32 s56, s3, 9216
    s_add_u32 s101, s101, s56
    s_lshl_b32 s57, s3, 10
    s_waitcnt vmcnt(4)
    s_add_u32 m0, s57, 0
    s_add_u32 s56, s101, 0
    buffer_load_dwordx4 v6, s[48:51], s56 offen nt lds
    s_waitcnt vmcnt(4)
    s_add_u32 m0, s57, 32768
    s_add_u32 s56, s101, 128
    buffer_load_dwordx4 v6, s[48:51], s56 offen nt lds
    s_waitcnt vmcnt(4)
    s_bitcmp1_b64 s[14:15], 4
    s_cbranch_scc0 1
    s_waitcnt vmcnt(3)
    s_add_u32 s63, s69, 32768
    buffer_load_dwordx4 v[96:99], v1, s[40:43], s63 offen nt
    s_waitcnt vmcnt(4)
    s_bitcmp1_b64 s[14:15], 5
    s_cbranch_scc0 1
    s_waitcnt vmcnt(2)
    s_add_u32 s63, s69, 40960
    buffer_load_dwordx4 v[100:103], v1, s[40:43], s63 offen nt
    s_waitcnt vmcnt(3)
    s_add_u32 m0, s57, 65536
    s_add_u32 s56, s101, 256
    buffer_load_dwordx4 v6, s[48:51], s56 offen nt lds
    s_waitcnt vmcnt(3)
    s_bitcmp1_b64 s[14:15], 6
    s_cbranch_scc0 1
    s_waitcnt vmcnt(2)
    s_add_u32 s63, s69, 49152
    buffer_load_dwordx4 v[128:131], v1, s[40:43], s63 offen nt
    s_waitcnt vmcnt(3)
    s_bitcmp1_b64 s[14:15], 7
    s_cbranch_scc0 1
    s_waitcnt vmcnt(2)
    s_add_u32 s63, s69, 57344
    buffer_load_dwordx4 v[132:135], v1, s[40:43], s63 offen nt
    s_waitcnt vmcnt(3)
    s_add_u32 m0, s57, 8192
    s_add_u32 s56, s101, 73728
    buffer_load_dwordx4 v6, s[48:51], s56 offen nt lds
    s_waitcnt vmcnt(3)
    s_bitcmp1_b64 s[14:15], 8
    s_cbranch_scc0 1
    s_waitcnt vmcnt(2)
    s_add_u32 s63, s69, 131072
    buffer_load_dwordx4 v[40:43], v1, s[40:43], s63 offen nt
    s_waitcnt vmcnt(3)
    s_bitcmp1_b64 s[14:15], 9
    s_cbranch_scc0 1
    s_waitcnt vmcnt(2)
    s_add_u32 s63, s69, 139264
    buffer_load_dwordx4 v[44:47], v1, s[40:43], s63 offen nt
    s_waitcnt vmcnt(3)
    s_add_u32 m0, s57, 40960
    s_add_u32 s56, s101, 73856
    buffer_load_dwordx4 v6, s[48:51], s56 offen nt lds
    s_waitcnt vmcnt(3)
    s_bitcmp1_b64 s[14:15], 10
    s_cbranch_scc0 1
    s_waitcnt vmcnt(2)
    s_add_u32 s63, s69, 147456
    buffer_load_dwordx4 v[72:75], v1, s[40:43], s63 offen nt
    s_waitcnt vmcnt(3)
    s_bitcmp1_b64 s[14:15], 11
    s_cbranch_scc0 1
    s_waitcnt vmcnt(2)
    s_add_u32 s63, s69, 155648
    buffer_load_dwordx4 v[76:79], v1, s[40:43], s63 offen nt
    s_waitcnt vmcnt(3)
    s_add_u32 m0, s57, 73728
    s_add_u32 s56, s101, 73984
    buffer_load_dwordx4 v6, s[48:51], s56 offen nt lds
    s_waitcnt vmcnt(3)
    s_waitcnt lgkmcnt(0)
    s_add_u32 s34, s34, 1
    s_getreg_b32 s1, hwreg(HW_REG_XCC_ID)
    s_lshl_b32 s1, s1, 24
    s_add_u32 s1, s1, s34
    s_lshr_b32 s0, s2, 3
    s_lshl_b32 s63, s64, 8
    s_add_u32 s0, s0, s63
    s_lshl2_add_u32 s0, s0, 0x480000
    v_mov_b32 v30, s1
    s_cmp_eq_u32 s3, 0
    s_cselect_b64 exec, 1, 0
    buffer_store_dword v30, v2, s[36:39], s0 offen sc1
    s_mov_b64 exec, -1
    s_bitcmp1_b64 s[14:15], 12
    s_cbranch_scc0 1
    s_waitcnt vmcnt(3)
    s_add_u32 s63, s69, 163840
    buffer_load_dwordx4 v[104:107], v1, s[40:43], s63 offen nt
    s_waitcnt vmcnt(4)
    s_bitcmp1_b64 s[14:15], 13
    s_cbranch_scc0 1
    s_waitcnt vmcnt(3)
    s_add_u32 s63, s69, 172032
    buffer_load_dwordx4 v[108:111], v1, s[40:43], s63 offen nt
    s_waitcnt vmcnt(4)
    s_add_u32 m0, s57, 16384
    s_add_u32 s56, s101, 147456
    buffer_load_dwordx4 v6, s[48:51], s56 offen nt lds
    s_waitcnt vmcnt(4)
    s_bitcmp1_b64 s[14:15], 14
    s_cbranch_scc0 1
    s_waitcnt vmcnt(2)
    s_add_u32 s63, s69, 180224
    buffer_load_dwordx4 v[136:139], v1, s[40:43], s63 offen nt
    s_waitcnt vmcnt(3)
    s_bitcmp1_b64 s[14:15], 15
    s_cbranch_scc0 1
    s_waitcnt vmcnt(2)
    s_add_u32 s63, s69, 188416
    buffer_load_dwordx4 v[140:143], v1, s[40:43], s63 offen nt
    s_waitcnt vmcnt(3)
    s_add_u32 m0, s57, 49152
    s_add_u32 s56, s101, 147584
    buffer_load_dwordx4 v6, s[48:51], s56 offen nt lds
    s_waitcnt vmcnt(3)
    s_bitcmp1_b64 s[14:15], 16
    s_cbranch_scc0 1
    s_waitcnt vmcnt(2)
    s_add_u32 s63, s69, 262144
    buffer_load_dwordx4 v[48:51], v1, s[40:43], s63 offen nt
    s_waitcnt vmcnt(3)
    s_bitcmp1_b64 s[14:15], 17
    s_cbranch_scc0 1
    s_waitcnt vmcnt(2)
    s_add_u32 s63, s69, 270336
    buffer_load_dwordx4 v[52:55], v1, s[40:43], s63 offen nt
    s_waitcnt vmcnt(3)
    s_add_u32 m0, s57, 81920
    s_add_u32 s56, s101, 147712
    buffer_load_dwordx4 v6, s[48:51], s56 offen nt lds
    s_waitcnt vmcnt(3)
    s_bitcmp1_b64 s[14:15], 18
    s_cbranch_scc0 1
    s_waitcnt vmcnt(2)
    s_add_u32 s63, s69, 278528
    buffer_load_dwordx4 v[80:83], v1, s[40:43], s63 offen nt
    s_waitcnt vmcnt(3)
    s_bitcmp1_b64 s[14:15], 19
    s_cbranch_scc0 1
    s_waitcnt vmcnt(2)
    s_add_u32 s63, s69, 286720
    buffer_load_dwordx4 v[84:87], v1, s[40:43], s63 offen nt
    s_waitcnt vmcnt(3)
    s_add_u32 m0, s57, 24576
    s_add_u32 s56, s101, 221184
    buffer_load_dwordx4 v6, s[48:51], s56 offen nt lds
    s_waitcnt vmcnt(3)
    s_bitcmp1_b64 s[14:15], 20
    s_cbranch_scc0 1
    s_waitcnt vmcnt(2)
    s_add_u32 s63, s69, 294912
    buffer_load_dwordx4 v[112:115], v1, s[40:43], s63 offen nt
    s_waitcnt vmcnt(3)
    s_bitcmp1_b64 s[14:15], 21
    s_cbranch_scc0 1
    s_waitcnt vmcnt(2)
    s_add_u32 s63, s69, 303104
    buffer_load_dwordx4 v[116:119], v1, s[40:43], s63 offen nt
    s_branch .Lsk_a0_1
.Lst_a0_1:
    s_branch .Lrt_a0_1
.Lsk_a0_1:
    s_waitcnt vmcnt(3)
    s_add_u32 m0, s57, 57344
    s_add_u32 s56, s101, 221312
    buffer_load_dwordx4 v6, s[48:51], s56 offen nt lds
    s_waitcnt vmcnt(3)
    s_bitcmp1_b64 s[14:15], 22
    s_cbranch_scc0 1
    s_waitcnt vmcnt(2)
    s_add_u32 s63, s69, 311296
    buffer_load_dwordx4 v[144:147], v1, s[40:43], s63 offen nt
    s_waitcnt vmcnt(3)
    s_bitcmp1_b64 s[14:15], 23
    s_cbranch_scc0 1
    s_waitcnt vmcnt(2)
    s_add_u32 s63, s69, 319488
    buffer_load_dwordx4 v[148:151], v1, s[40:43], s63 offen nt
    s_waitcnt vmcnt(3)
    s_add_u32 m0, s57, 90112
    s_add_u32 s56, s101, 221440
    buffer_load_dwordx4 v6, s[48:51], s56 offen nt lds
    s_waitcnt vmcnt(3)
    s_bitcmp1_b64 s[14:15], 24
    s_cbranch_scc0 1
    s_waitcnt vmcnt(2)
    s_add_u32 s63, s69, 393216
    buffer_load_dwordx4 v[56:59], v1, s[40:43], s63 offen nt
    s_waitcnt vmcnt(3)
    s_bitcmp1_b64 s[14:15], 25
    s_cbranch_scc0 1
    s_waitcnt vmcnt(2)
    s_add_u32 s63, s69, 401408
    buffer_load_dwordx4 v[60:63], v1, s[40:43], s63 offen nt
.Ln_att:
    v_and_b32 v8, 1, v0
    v_lshlrev_b32 v8, 8, v8
    v_and_b32 v9, 0x3c, v0
    v_lshl_add_u32 v9, v9, 2, v8
    v_add_u32 v7, v9, v8
    v_and_b32 v9, 0x3c, v0
    v_lshrrev_b32 v8, 4, v8
    v_and_b32 v9, 4, v0
    v_lshl_add_u32 v9, v9, 3, v8
    s_lshl_b32 s58, s66, 14
    s_lshl_b32 s59, s67, 10
    s_add_u32 s58, s58, s59
    s_add_u32 s58, s58, 0x70000
    s_lshl4_add_u32 s59, s66, s67
    s_lshl_b32 s59, s59, 7
    s_add_u32 s59, s59, 0x430000
    s_memrealtime s[8:9]
    s_waitcnt vmcnt(8)
    s_waitcnt lgkmcnt(0)
    s_sub_u32 s8, s8, s30
    s_cmpk_ge_u32 s8, 1211
    s_cbranch_scc1 .ap_4
    s_waitcnt vmcnt(5)
    s_cmpk_ge_u32 s8, 1111
    s_cbranch_scc1 .ap_4
    s_waitcnt vmcnt(3)
    s_bitcmp1_b64 s[14:15], 26
    s_cbranch_scc0 1
    s_waitcnt vmcnt(2)
    s_cmpk_ge_u32 s8, 991
    s_cbranch_scc1 .ap_4
    s_waitcnt vmcnt(1)
.ap_4:
    s_add_u32 s63, s69, 409600
    buffer_load_dwordx4 v[88:91], v1, s[40:43], s63 offen nt
    v_and_b32 v157, 7, v0
    v_lshlrev_b32 v157, 2, v157
    s_mov_b32 s63, 0x4a1000
    buffer_load_dword v156, v157, s[36:39], s63 offen
    s_cmp_eq_u32 s3, 0
    s_cbranch_scc1 .Lst_n1_0
.Lrt_n1_0:
    s_cmp_eq_u32 s3, 1
    s_cbranch_scc1 .Lst_n1_1
    s_cmp_eq_u32 s3, 2
    s_cbranch_scc1 .Lst_n1_2
    s_cmp_eq_u32 s3, 3
    s_cbranch_scc1 .Lst_n1_3
    s_cmp_eq_u32 s3, 4
    s_cbranch_scc1 .Lst_n1_4
    s_cmp_eq_u32 s3, 5
    s_cbranch_scc1 .Lst_n1_5
    s_cmp_eq_u32 s3, 6
    s_cbranch_scc1 .Lst_n1_6
    s_cmp_eq_u32 s3, 7
    s_cbranch_scc1 .Lst_n1_7
    s_cmp_eq_u32 s3, 0
    s_cbranch_scc1 .Lrt_n1_8
.Lrt_n1_1:
.Lrt_n1_2:
.Lrt_n1_3:
.Lrt_n1_4:
.Lrt_n1_5:
.Lrt_n1_6:
.Lrt_n1_7:
.Lrt_n1_8:
    s_memrealtime s[8:9]
    s_waitcnt vmcnt(9)
    s_waitcnt lgkmcnt(0)
    s_sub_u32 s8, s8, s30
    s_cmpk_ge_u32 s8, 1238
    s_cbranch_scc1 .ap_5
    s_waitcnt vmcnt(6)
    s_cmpk_ge_u32 s8, 1138
    s_cbranch_scc1 .ap_5
    s_waitcnt vmcnt(4)
    s_bitcmp1_b64 s[14:15], 27
    s_cbranch_scc0 1
    s_waitcnt vmcnt(3)
    s_cmpk_ge_u32 s8, 1018
    s_cbranch_scc1 .ap_5
    s_waitcnt vmcnt(2)
.ap_5:
    s_add_u32 s63, s69, 417792
    buffer_load_dwordx4 v[92:95], v1, s[40:43], s63 offen nt
    s_memrealtime s[8:9]
    s_waitcnt vmcnt(9)
    s_waitcnt lgkmcnt(0)
    s_sub_u32 s8, s8, s30
    s_cmpk_ge_u32 s8, 1265
    s_cbranch_scc1 .ap_6
    s_waitcnt vmcnt(6)
    s_cmpk_ge_u32 s8, 1165
    s_cbranch_scc1 .ap_6
    s_waitcnt vmcnt(4)
    s_bitcmp1_b64 s[14:15], 28
    s_cbranch_scc0 1
    s_waitcnt vmcnt(3)
    s_cmpk_ge_u32 s8, 1045
    s_cbranch_scc1 .ap_6
    s_waitcnt vmcnt(2)
.ap_6:
    s_add_u32 s63, s69, 425984
    buffer_load_dwordx4 v[120:123], v1, s[40:43], s63 offen nt
    s_memrealtime s[8:9]
    s_waitcnt vmcnt(9)
    s_waitcnt lgkmcnt(0)
    s_sub_u32 s8, s8, s30
    s_cmpk_ge_u32 s8, 1292
    s_cbranch_scc1 .ap_7
    s_waitcnt vmcnt(6)
    s_cmpk_ge_u32 s8, 1192
    s_cbranch_scc1 .ap_7
    s_waitcnt vmcnt(4)
    s_bitcmp1_b64 s[14:15], 29
    s_cbranch_scc0 1
    s_waitcnt vmcnt(3)
    s_cmpk_ge_u32 s8, 1072
    s_cbranch_scc1 .ap_7
    s_waitcnt vmcnt(1)
.ap_7:
    s_add_u32 s63, s69, 434176
    buffer_load_dwordx4 v[124:127], v1, s[40:43], s63 offen nt
    s_memrealtime s[8:9]
    s_waitcnt vmcnt(9)
    s_waitcnt lgkmcnt(0)
    s_sub_u32 s8, s8, s30
    s_cmpk_ge_u32 s8, 1320
    s_cbranch_scc1 .ap_8
    s_waitcnt vmcnt(6)
    s_cmpk_ge_u32 s8, 1220
    s_cbranch_scc1 .ap_8
    s_waitcnt vmcnt(4)
    s_bitcmp1_b64 s[14:15], 30
    s_cbranch_scc0 1
    s_waitcnt vmcnt(2)
    s_cmpk_ge_u32 s8, 1100
    s_cbranch_scc1 .ap_8
    s_waitcnt vmcnt(1)
.ap_8:
    s_add_u32 s63, s69, 442368
    buffer_load_dwordx4 v[152:155], v1, s[40:43], s63 offen nt
    s_waitcnt vmcnt(4)
    s_sub_u32 s63, s70, 300
    v_subrev_u32 v156, s63, v156
    v_mov_b32 v157, 600
    v_cmp_lt_u32 s[8:9], v156, v157
    v_add_u32_dpp v156, v156, v156 quad_perm:[1,0,3,2] row_mask:0xf bank_mask:0xf
    s_nop 1
    v_add_u32_dpp v156, v156, v156 quad_perm:[2,3,0,1] row_mask:0xf bank_mask:0xf
    s_nop 1
    v_add_u32_dpp v156, v156, v156 row_ror:4 row_mask:0xf bank_mask:0xf
    s_nop 0
    v_readfirstlane_b32 s63, v156
    s_cmp_eq_u64 s[8:9], -1
    s_nop 3
    s_cbranch_scc0 .et_9
    s_lshr_b32 s63, s63, 3
    s_sub_u32 s63, s63, 300
    s_add_u32 s30, s30, s63
    s_add_u32 s31, s31, s63
.et_9:
    s_memrealtime s[8:9]
    s_waitcnt lgkmcnt(0)
    s_sub_u32 s8, s8, s30
    s_cmpk_ge_u32 s8, 1347
    s_cbranch_scc1 .ap_10
    s_waitcnt vmcnt(4)
    s_cmpk_ge_u32 s8, 1247
    s_cbranch_scc1 .ap_10
    s_waitcnt vmcnt(3)
    s_bitcmp1_b64 s[14:15], 31
    s_cbranch_scc0 1
    s_waitcnt vmcnt(2)
    s_cmpk_ge_u32 s8, 1127
    s_cbranch_scc1 .ap_10
    s_waitcnt vmcnt(1)
.ap_10:
    s_add_u32 s63, s69, 450560
    buffer_load_dwordx4 v[156:159], v1, s[40:43], s63 offen nt
    buffer_load_dwordx4 v[16:19], v7, s[36:39], s58 offen offset:0 sc1
    buffer_load_dwordx4 v[20:23], v7, s[36:39], s58 offen offset:256 sc1
    s_memrealtime s[8:9]
    s_waitcnt lgkmcnt(0)
    s_sub_u32 s8, s8, s30
    s_cmpk_ge_u32 s8, 1374
    s_cbranch_scc1 .ap_11
    s_waitcnt vmcnt(5)
    s_cmpk_ge_u32 s8, 1274
    s_cbranch_scc1 .ap_11
    s_waitcnt vmcnt(3)
    s_bitcmp1_b64 s[14:15], 32
    s_cbranch_scc0 1
    s_waitcnt vmcnt(2)
    s_cmpk_ge_u32 s8, 1154
    s_cbranch_scc1 .ap_11
    s_waitcnt vmcnt(1)
.ap_11:
    v_bfe_u32 v1, v0, 4, 2
    v_and_b32 v10, 0xf0, v2
    v_lshlrev_b32 v1, 2, v1
    v_bfe_u32 v1, s6, v1, 4
    v_lshl_add_u32 v1, v1, 8, v10
    s_add_u32 s63, s69, 0
    buffer_load_dwordx4 v[160:163], v1, s[44:47], s63 offen nt
    s_memrealtime s[8:9]
    s_waitcnt lgkmcnt(0)
    s_sub_u32 s8, s8, s30
    s_cmpk_ge_u32 s8, 1401
    s_cbranch_scc1 .ap_12
    s_waitcnt vmcnt(5)
    s_cmpk_ge_u32 s8, 1301
    s_cbranch_scc1 .ap_12
    s_waitcnt vmcnt(3)
    s_bitcmp1_b64 s[14:15], 33
    s_cbranch_scc0 1
    s_waitcnt vmcnt(2)
    s_cmpk_ge_u32 s8, 1181
    s_cbranch_scc1 .ap_12
    s_waitcnt vmcnt(1)
.ap_12:
    s_add_u32 s63, s69, 8192
    buffer_load_dwordx4 v[164:167], v1, s[44:47], s63 offen nt
    s_memrealtime s[8:9]
    s_waitcnt vmcnt(8)
    s_waitcnt lgkmcnt(0)
    s_sub_u32 s8, s8, s30
    s_cmpk_ge_u32 s8, 1428
    s_cbranch_scc1 .ap_13
    s_waitcnt vmcnt(5)
    s_cmpk_ge_u32 s8, 1328
    s_cbranch_scc1 .ap_13
    s_waitcnt vmcnt(3)
    s_bitcmp1_b64 s[14:15], 34
    s_cbranch_scc0 1
    s_waitcnt vmcnt(2)
    s_cmpk_ge_u32 s8, 1208
    s_cbranch_scc1 .ap_13
    s_waitcnt vmcnt(1)
.ap_13:
    s_add_u32 s63, s69, 16384
    buffer_load_dwordx4 v[168:171], v1, s[44:47], s63 offen nt
    s_waitcnt vmcnt(3)
    s_branch .gpc_15
.gp_14:
    buffer_load_dwordx4 v[16:19], v7, s[36:39], s58 offen offset:0 sc1
    s_branch .Lsk_n1_0
.Lst_n1_0:
    s_branch .Lrt_n1_0
.Lsk_n1_0:
    buffer_load_dwordx4 v[20:23], v7, s[36:39], s58 offen offset:256 sc1
    s_waitcnt vmcnt(0)
.gpc_15:
    v_min_u32 v10, v17, v19
    v_max_u32 v11, v17, v19
    v_min3_u32 v10, v10, v21, v23
    v_max3_u32 v11, v11, v21, v23
    v_cmp_eq_u32 vcc, s34, v10
    v_cmp_eq_u32 s[56:57], s34, v11
    s_and_b64 vcc, vcc, s[56:57]
    s_cmp_eq_u64 vcc, -1
    s_nop 2
    s_cbranch_scc1 .gpd_16
    s_sub_u32 s35, s35, 1
    s_cbranch_scc1 .Lexit
    s_sleep 1
    s_branch .gp_14
.gpd_16:
    s_mov_b32 vcc_lo, 0xcccccccc
    s_mov_b32 vcc_hi, 0xcccccccc
    v_cndmask_b32_e64 v24, v16, 0, vcc
    v_cndmask_b32_e64 v25, v18, 0, vcc
    v_cndmask_b32_e64 v26, v20, 0, vcc
    v_cndmask_b32_e64 v27, v22, 0, vcc
    v_cndmask_b32_e32 v28, 0, v16, vcc
    v_cndmask_b32_e32 v29, 0, v18, vcc
    v_cndmask_b32_e32 v30, 0, v20, vcc
    v_cndmask_b32_e32 v31, 0, v22, vcc
    v_mfma_f32_16x16x32_bf16 v[16:19], v[32:35], v[24:27], 0
    v_mfma_f32_16x16x32_bf16 v[32:35], v[40:43], v[24:27], 0
    v_mfma_f32_16x16x32_bf16 v[16:19], v[36:39], v[28:31], v[16:19]
    v_mfma_f32_16x16x32_bf16 v[40:43], v[48:51], v[24:27], 0
    v_mfma_f32_16x16x32_bf16 v[32:35], v[44:47], v[28:31], v[32:35]
    v_mfma_f32_16x16x32_bf16 v[48:51], v[56:59], v[24:27], 0
    v_mfma_f32_16x16x32_bf16 v[40:43], v[52:55], v[28:31], v[40:43]
    v_mfma_f32_16x16x32_bf16 v[56:59], v[64:67], v[24:27], 0
    v_mfma_f32_16x16x32_bf16 v[48:51], v[60:63], v[28:31], v[48:51]
    s_nop 1
    v_add_f32_dpp v10, v17, v16 row_ror:12 row_mask:0xf bank_mask:0x1
    s_memrealtime s[8:9]
    s_waitcnt lgkmcnt(0)
    s_sub_u32 s8, s8, s30
    s_cmpk_ge_u32 s8, 1456
    s_nop 0
    s_cbranch_scc1 .ap_17
    s_waitcnt vmcnt(3)
    s_cmpk_ge_u32 s8, 1356
    s_cbranch_scc1 .ap_17
    s_waitcnt vmcnt(3)
    s_bitcmp1_b64 s[14:15], 35
    s_cbranch_scc0 1
    s_waitcnt vmcnt(2)
    s_cmpk_ge_u32 s8, 1236
    s_cbranch_scc1 .ap_17
    s_waitcnt vmcnt(1)
.ap_17:
    s_add_u32 s63, s69, 24576
    buffer_load_dwordx4 v[172:175], v1, s[44:47], s63 offen nt
    v_mfma_f32_16x16x32_bf16 v[64:67], v[72:75], v[24:27], 0
    v_mfma_f32_16x16x32_bf16 v[56:59], v[68:71], v[28:31], v[56:59]
    v_add_f32_dpp v11, v33, v32 row_ror:12 row_mask:0xf bank_mask:0x1
    v_add_f32_dpp v10, v18, v10 row_ror:8 row_mask:0xf bank_mask:0x1
    v_mfma_f32_16x16x32_bf16 v[72:75], v[80:83], v[24:27], 0
    v_mfma_f32_16x16x32_bf16 v[64:67], v[76:79], v[28:31], v[64:67]
    v_add_f32_dpp v12, v41, v40 row_ror:12 row_mask:0xf bank_mask:0x1
    v_add_f32_dpp v11, v34, v11 row_ror:8 row_mask:0xf bank_mask:0x1
    v_add_f32_dpp v10, v19, v10 row_ror:4 row_mask:0xf bank_mask:0x1
    v_mfma_f32_16x16x32_bf16 v[80:83], v[88:91], v[24:27], 0
    v_mfma_f32_16x16x32_bf16 v[72:75], v[84:87], v[28:31], v[72:75]
    v_add_f32_dpp v13, v49, v48 row_ror:12 row_mask:0xf bank_mask:0x1
    v_add_f32_dpp v12, v42, v12 row_ror:8 row_mask:0xf bank_mask:0x1
    v_add_f32_dpp v11, v35, v11 row_ror:4 row_mask:0xf bank_mask:0x1
    v_mfma_f32_16x16x32_bf16 v[88:91], v[96:99], v[24:27], 0
    v_mfma_f32_16x16x32_bf16 v[80:83], v[92:95], v[28:31], v[80:83]
    v_add_f32_dpp v10, v58, v57 row_ror:12 row_mask:0xf bank_mask:0x2
    v_add_f32_dpp v13, v50, v13 row_ror:8 row_mask:0xf bank_mask:0x1
    v_add_f32_dpp v12, v43, v12 row_ror:4 row_mask:0xf bank_mask:0x1
    s_memrealtime s[8:9]
    s_waitcnt lgkmcnt(0)
    s_sub_u32 s8, s8, s30
    s_cmpk_ge_u32 s8, 1486
    s_nop 0
    s_cbranch_scc1 .ap_18
    s_waitcnt vmcnt(4)
    s_cmpk_ge_u32 s8, 1386
    s_cbranch_scc1 .ap_18
    s_waitcnt vmcnt(3)
    s_bitcmp1_b64 s[14:15], 36
    s_cbranch_scc0 1
    s_waitcnt vmcnt(2)
    s_cmpk_ge_u32 s8, 1266
    s_cbranch_scc1 .ap_18
    s_waitcnt vmcnt(1)
.ap_18:
    s_add_u32 s63, s69, 32768
    buffer_load_dwordx4 v[176:179], v1, s[44:47], s63 offen nt
    v_mfma_f32_16x16x32_bf16 v[96:99], v[104:107], v[24:27], 0
    v_mfma_f32_16x16x32_bf16 v[88:91], v[100:103], v[28:31], v[88:91]
    v_add_f32_dpp v11, v66, v65 row_ror:12 row_mask:0xf bank_mask:0x2
    v_add_f32_dpp v10, v59, v10 row_ror:8 row_mask:0xf bank_mask:0x2
    v_add_f32_dpp v13, v51, v13 row_ror:4 row_mask:0xf bank_mask:0x1
    v_mfma_f32_16x16x32_bf16 v[104:107], v[112:115], v[24:27], 0
    v_mfma_f32_16x16x32_bf16 v[96:99], v[108:111], v[28:31], v[96:99]
    v_add_f32_dpp v12, v74, v73 row_ror:12 row_mask:0xf bank_mask:0x2
    v_add_f32_dpp v11, v67, v11 row_ror:8 row_mask:0xf bank_mask:0x2
    v_add_f32_dpp v10, v56, v10 row_ror:4 row_mask:0xf bank_mask:0x2
    v_mfma_f32_16x16x32_bf16 v[112:115], v[120:123], v[24:27], 0
    v_mfma_f32_16x16x32_bf16 v[104:107], v[116:119], v[28:31], v[104:107]
    v_add_f32_dpp v13, v82, v81 row_ror:12 row_mask:0xf bank_mask:0x2
    v_add_f32_dpp v12, v75, v12 row_ror:8 row_mask:0xf bank_mask:0x2
    v_add_f32_dpp v11, v64, v11 row_ror:4 row_mask:0xf bank_mask:0x2
    v_mfma_f32_16x16x32_bf16 v[120:123], v[128:131], v[24:27], 0
    v_mfma_f32_16x16x32_bf16 v[112:115], v[124:127], v[28:31], v[112:115]
    v_add_f32_dpp v10, v91, v90 row_ror:12 row_mask:0xf bank_mask:0x4
    v_add_f32_dpp v13, v83, v13 row_ror:8 row_mask:0xf bank_mask:0x2
    v_add_f32_dpp v12, v72, v12 row_ror:4 row_mask:0xf bank_mask:0x2
    s_memrealtime s[8:9]
    s_waitcnt lgkmcnt(0)
    s_sub_u32 s8, s8, s30
    s_cmpk_ge_u32 s8, 1516
    s_nop 0
    s_cbranch_scc1 .ap_19
    s_waitcnt vmcnt(5)
    s_cmpk_ge_u32 s8, 1416
    s_cbranch_scc1 .ap_19
    s_waitcnt vmcnt(3)
    s_bitcmp1_b64 s[14:15], 37
    s_cbranch_scc0 1
    s_waitcnt vmcnt(2)
    s_cmpk_ge_u32 s8, 1296
    s_cbranch_scc1 .ap_19
    s_waitcnt vmcnt(1)
.ap_19:
    s_add_u32 s63, s69, 40960
    buffer_load_dwordx4 v[180:183], v1, s[44:47], s63 offen nt
    v_mfma_f32_16x16x32_bf16 v[128:131], v[136:139], v[24:27], 0
    v_mfma_f32_16x16x32_bf16 v[120:123], v[132:135], v[28:31], v[120:123]
    v_add_f32_dpp v11, v99, v98 row_ror:12 row_mask:0xf bank_mask:0x4
    v_add_f32_dpp v10, v88, v10 row_ror:8 row_mask:0xf bank_mask:0x4
    v_add_f32_dpp v13, v80, v13 row_ror:4 row_mask:0xf bank_mask:0x2
    v_mfma_f32_16x16x32_bf16 v[136:139], v[144:147], v[24:27], 0
    v_mfma_f32_16x16x32_bf16 v[128:131], v[140:143], v[28:31], v[128:131]
    v_add_f32_dpp v12, v107, v106 row_ror:12 row_mask:0xf bank_mask:0x4
    v_add_f32_dpp v11, v96, v11 row_ror:8 row_mask:0xf bank_mask:0x4
    v_add_f32_dpp v10, v89, v10 row_ror:4 row_mask:0xf bank_mask:0x4
    v_mfma_f32_16x16x32_bf16 v[144:147], v[152:155], v[24:27], 0
    v_mfma_f32_16x16x32_bf16 v[136:139], v[148:151], v[28:31], v[136:139]
    v_add_f32_dpp v13, v115, v114 row_ror:12 row_mask:0xf bank_mask:0x4
    v_add_f32_dpp v12, v104, v12 row_ror:8 row_mask:0xf bank_mask:0x4
    v_add_f32_dpp v11, v97, v11 row_ror:4 row_mask:0xf bank_mask:0x4
    v_mfma_f32_16x16x32_bf16 v[144:147], v[156:159], v[28:31], v[144:147]
    v_add_f32_dpp v10, v120, v123 row_ror:12 row_mask:0xf bank_mask:0x8
    v_add_f32_dpp v13, v112, v13 row_ror:8 row_mask:0xf bank_mask:0x4
    v_add_f32_dpp v12, v105, v12 row_ror:4 row_mask:0xf bank_mask:0x4
    s_memrealtime s[8:9]
    s_waitcnt lgkmcnt(0)
    s_sub_u32 s8, s8, s30
    s_cmpk_ge_u32 s8, 1546
    s_nop 0
    s_cbranch_scc1 .ap_20
    s_waitcnt vmcnt(5)
    s_cmpk_ge_u32 s8, 1446
    s_cbranch_scc1 .ap_20
    s_waitcnt vmcnt(3)
    s_bitcmp1_b64 s[14:15], 38
    s_cbranch_scc0 1
    s_waitcnt vmcnt(2)
    s_cmpk_ge_u32 s8, 1326
    s_cbranch_scc1 .ap_20
    s_waitcnt vmcnt(1)
.ap_20:
    s_add_u32 s63, s69, 49152
    buffer_load_dwordx4 v[184:187], v1, s[44:47], s63 offen nt
    v_add_f32_dpp v11, v128, v131 row_ror:12 row_mask:0xf bank_mask:0x8
    v_add_f32_dpp v10, v121, v10 row_ror:8 row_mask:0xf bank_mask:0x8
    v_add_f32_dpp v13, v113, v13 row_ror:4 row_mask:0xf bank_mask:0x4
    v_add_f32_dpp v12, v136, v139 row_ror:12 row_mask:0xf bank_mask:0x8
    v_add_f32_dpp v11, v129, v11 row_ror:8 row_mask:0xf bank_mask:0x8
    v_add_f32_dpp v10, v122, v10 row_ror:4 row_mask:0xf bank_mask:0x8
    s_branch .Lsk_n1_1
.Lst_n1_1:
    s_branch .Lrt_n1_1
.Lsk_n1_1:
    v_add_f32_dpp v13, v144, v147 row_ror:12 row_mask:0xf bank_mask:0x8
    v_add_f32_dpp v12, v137, v12 row_ror:8 row_mask:0xf bank_mask:0x8
    v_add_f32_dpp v11, v130, v11 row_ror:4 row_mask:0xf bank_mask:0x8
    v_add_f32_dpp v13, v145, v13 row_ror:8 row_mask:0xf bank_mask:0x8
    v_add_f32_dpp v12, v138, v12 row_ror:4 row_mask:0xf bank_mask:0x8
    s_memrealtime s[8:9]
    s_waitcnt lgkmcnt(0)
    s_sub_u32 s8, s8, s30
    s_cmpk_ge_u32 s8, 1576
    s_cbranch_scc1 .ap_21
    s_waitcnt vmcnt(5)
    s_cmpk_ge_u32 s8, 1476
    s_cbranch_scc1 .ap_21
    s_waitcnt vmcnt(3)
    s_bitcmp1_b64 s[14:15], 39
    s_cbranch_scc0 1
    s_waitcnt vmcnt(2)
    s_cmpk_ge_u32 s8, 1356
    s_cbranch_scc1 .ap_21
    s_waitcnt vmcnt(1)
.ap_21:
    s_add_u32 s63, s69, 57344
    buffer_load_dwordx4 v[188:191], v1, s[44:47], s63 offen nt
    s_branch .Lsk_n1_2
.Lst_n1_2:
    s_branch .Lrt_n1_2
.Lsk_n1_2:
    v_add_f32_dpp v13, v146, v13 row_ror:4 row_mask:0xf bank_mask:0x8
    s_mov_b32 s60, 0x3db504f3
    s_mov_b32 s61, 0x3db504f3
    v_cvt_pk_bf16_f32 v10, v10, v11
    v_and_b32 v11, 0xffff0000, v10
    v_lshlrev_b32 v10, 16, v10
    v_cvt_pk_bf16_f32 v12, v12, v13
    v_and_b32 v13, 0xffff0000, v12
    v_lshlrev_b32 v12, 16, v12
    v_pk_mul_f32 v[10:11], v[10:11], s[60:61]
    v_pk_mul_f32 v[12:13], v[12:13], s[60:61]
    v_cvt_pk_bf16_f32 v10, v10, v11
    v_and_b32 v11, 0xffff0000, v10
    v_lshlrev_b32 v10, 16, v10
    v_cvt_pk_bf16_f32 v12, v12, v13
    v_and_b32 v13, 0xffff0000, v12
    v_lshlrev_b32 v12, 16, v12
    v_max_f32 v14, v10, v11
    v_max3_f32 v14, v14, v12, v13
    s_mov_b32 s60, 0x3fb8aa3b
    v_mov_b32 v22, s34
    v_mov_b32 v23, s34
    v_max_f32_dpp v14, v14, v14 quad_perm:[2,3,0,1] row_mask:0xf bank_mask:0xf
    s_nop 1
    v_max_f32_dpp v14, v14, v14 row_ror:4 row_mask:0xf bank_mask:0xf
    s_nop 1
    v_max_f32_dpp v14, v14, v14 row_ror:8 row_mask:0xf bank_mask:0xf
    v_mov_b32 v15, v14
    s_nop 1
    v_permlane16_swap_b32 v15, v14
    v_max_f32 v14, v15, v14
    v_mov_b32 v15, v14
    s_nop 1
    v_permlane32_swap_b32 v15, v14
    v_max_f32 v14, v15, v14
    v_mul_f32 v15, 0xbfb8aa3b, v14
    v_fma_f32 v10, v10, s60, v15
    v_fma_f32 v11, v11, s60, v15
    v_fma_f32 v12, v12, s60, v15
    v_fma_f32 v13, v13, s60, v15
    v_exp_f32 v10, v10
    v_exp_f32 v11, v11
    v_exp_f32 v12, v12
    v_exp_f32 v13, v13
    v_mov_b32 v20, v14
    v_pk_add_f32 v[16:17], v[10:11], v[12:13]
    v_add_f32 v21, v16, v17
    s_lshl_b32 s60, s68, 5
    s_lshl_b32 s61, s3, 4
    s_add_u32 s61, s61, 159104
    v_add_u32 v16, s61, v3
    v_mov_b32 v17, 159232
    v_mov_b32 v18, 1
    s_add_u32 s60, s60, s59
    v_add_f32_dpp v21, v21, v21 quad_perm:[2,3,0,1] row_mask:0xf bank_mask:0xf
    s_nop 1
    v_add_f32_dpp v21, v21, v21 row_ror:4 row_mask:0xf bank_mask:0xf
    s_nop 1
    v_add_f32_dpp v21, v21, v21 row_ror:8 row_mask:0xf bank_mask:0xf
    v_mov_b32 v15, v21
    s_nop 1
    v_permlane16_swap_b32 v15, v21
    v_add_f32 v21, v15, v21
    v_mov_b32 v15, v21
    s_nop 1
    v_permlane32_swap_b32 v15, v21
    v_add_f32 v21, v15, v21
    s_mov_b64 exec, 3
    ds_write_b64 v16, v[20:21]
    s_mov_b64 exec, 1
    ds_add_rtn_u32 v18, v17, v18
    s_mov_b64 exec, -1
    v_and_b32 v16, 0x78, v3
    v_or_b32 v16, 159104, v16
    s_waitcnt lgkmcnt(0)
    v_readfirstlane_b32 s61, v18
    s_cmp_eq_u32 s61, 7
    s_nop 3
    s_cbranch_scc0 .mlc_22
    ds_read_b64 v[18:19], v16
    s_waitcnt lgkmcnt(0)
    v_mov_b32 v20, v18
    s_nop 1
    v_max_f32_dpp v20, v20, v20 quad_perm:[2,3,0,1] row_mask:0xf bank_mask:0xf
    s_nop 1
    v_max_f32_dpp v20, v20, v20 row_ror:4 row_mask:0xf bank_mask:0xf
    s_nop 1
    v_max_f32_dpp v20, v20, v20 row_ror:8 row_mask:0xf bank_mask:0xf
    v_sub_f32 v18, v18, v20
    v_mul_f32 v18, 0x3fb8aa3b, v18
    v_exp_f32 v18, v18
    s_nop 0
    v_mul_f32 v21, v18, v19
    s_nop 1
    v_add_f32_dpp v21, v21, v21 quad_perm:[2,3,0,1] row_mask:0xf bank_mask:0xf
    s_nop 1
    v_add_f32_dpp v21, v21, v21 row_ror:4 row_mask:0xf bank_mask:0xf
    s_nop 1
    v_add_f32_dpp v21, v21, v21 row_ror:8 row_mask:0xf bank_mask:0xf
    s_mov_b64 exec, 3
    buffer_store_dwordx4 v[20:23], v2, s[36:39], s60 offen sc1
    s_mov_b64 exec, -1
.mlc_22:
    s_memrealtime s[8:9]
    s_waitcnt lgkmcnt(0)
    s_sub_u32 s8, s8, s30
    s_cmpk_ge_u32 s8, 1606
    s_cbranch_scc1 .ap_23
    s_waitcnt vmcnt(5)
    s_cmpk_ge_u32 s8, 1506
    s_cbranch_scc1 .ap_23
    s_waitcnt vmcnt(3)
    s_bitcmp1_b64 s[14:15], 40
    s_cbranch_scc0 1
    s_waitcnt vmcnt(2)
    s_cmpk_ge_u32 s8, 1386
    s_cbranch_scc1 .ap_23
    s_waitcnt vmcnt(1)
.ap_23:
    s_add_u32 s63, s69, 131072
    buffer_load_dwordx4 v[192:195], v1, s[44:47], s63 offen nt
    s_memrealtime s[8:9]
    s_waitcnt vmcnt(8)
    s_waitcnt lgkmcnt(0)
    s_sub_u32 s8, s8, s30
    s_cmpk_ge_u32 s8, 1636
    s_cbranch_scc1 .ap_24
    s_waitcnt vmcnt(5)
    s_cmpk_ge_u32 s8, 1536
    s_cbranch_scc1 .ap_24
    s_waitcnt vmcnt(3)
    s_bitcmp1_b64 s[14:15], 41
    s_cbranch_scc0 1
    s_waitcnt vmcnt(2)
    s_cmpk_ge_u32 s8, 1416
    s_cbranch_scc1 .ap_24
    s_waitcnt vmcnt(1)
.ap_24:
    s_add_u32 s63, s69, 139264
    buffer_load_dwordx4 v[196:199], v1, s[44:47], s63 offen nt
    s_memrealtime s[8:9]
    s_waitcnt vmcnt(8)
    s_waitcnt lgkmcnt(0)
    s_sub_u32 s8, s8, s30
    s_cmpk_ge_u32 s8, 1666
    s_cbranch_scc1 .ap_25
    s_waitcnt vmcnt(5)
    s_cmpk_ge_u32 s8, 1566
    s_cbranch_scc1 .ap_25
    s_waitcnt vmcnt(3)
    s_bitcmp1_b64 s[14:15], 42
    s_cbranch_scc0 1
    s_waitcnt vmcnt(2)
    s_cmpk_ge_u32 s8, 1446
    s_cbranch_scc1 .ap_25
    s_waitcnt vmcnt(1)
.ap_25:
    s_add_u32 s63, s69, 147456
    buffer_load_dwordx4 v[200:203], v1, s[44:47], s63 offen nt
    s_memrealtime s[8:9]
    s_waitcnt vmcnt(8)
    s_waitcnt lgkmcnt(0)
    s_sub_u32 s8, s8, s30
    s_cmpk_ge_u32 s8, 1696
    s_cbranch_scc1 .ap_26
    s_waitcnt vmcnt(5)
    s_cmpk_ge_u32 s8, 1596
    s_cbranch_scc1 .ap_26
    s_waitcnt vmcnt(3)
    s_bitcmp1_b64 s[14:15], 43
    s_cbranch_scc0 1
    s_waitcnt vmcnt(2)
    s_cmpk_ge_u32 s8, 1476
    s_cbranch_scc1 .ap_26
    s_waitcnt vmcnt(1)
.ap_26:
    s_add_u32 s63, s69, 155648
    buffer_load_dwordx4 v[204:207], v1, s[44:47], s63 offen nt
    s_memrealtime s[8:9]
    s_waitcnt vmcnt(8)
    s_waitcnt lgkmcnt(0)
    s_sub_u32 s8, s8, s30
    s_cmpk_ge_u32 s8, 1726
    s_cbranch_scc1 .ap_27
    s_waitcnt vmcnt(5)
    s_cmpk_ge_u32 s8, 1626
    s_cbranch_scc1 .ap_27
    s_waitcnt vmcnt(3)
    s_bitcmp1_b64 s[14:15], 44
    s_cbranch_scc0 1
    s_waitcnt vmcnt(2)
    s_cmpk_ge_u32 s8, 1506
    s_cbranch_scc1 .ap_27
    s_waitcnt vmcnt(1)
.ap_27:
    s_add_u32 s63, s69, 163840
    buffer_load_dwordx4 v[208:211], v1, s[44:47], s63 offen nt
    s_memrealtime s[8:9]
    s_waitcnt vmcnt(8)
    s_waitcnt lgkmcnt(0)
    s_sub_u32 s8, s8, s30
    s_cmpk_ge_u32 s8, 1756
    s_cbranch_scc1 .ap_28
    s_waitcnt vmcnt(5)
    s_cmpk_ge_u32 s8, 1656
    s_cbranch_scc1 .ap_28
    s_waitcnt vmcnt(3)
    s_bitcmp1_b64 s[14:15], 45
    s_cbranch_scc0 1
    s_waitcnt vmcnt(2)
    s_cmpk_ge_u32 s8, 1536
    s_cbranch_scc1 .ap_28
    s_waitcnt vmcnt(1)
.ap_28:
    s_add_u32 s63, s69, 172032
    buffer_load_dwordx4 v[212:215], v1, s[44:47], s63 offen nt
    s_memrealtime s[8:9]
    s_branch .Lsk_n1_3
.Lst_n1_3:
    s_branch .Lrt_n1_3
.Lsk_n1_3:
    s_waitcnt vmcnt(8)
    s_waitcnt lgkmcnt(0)
    s_sub_u32 s8, s8, s30
    s_cmpk_ge_u32 s8, 1788
    s_cbranch_scc1 .ap_29
    s_waitcnt vmcnt(5)
    s_cmpk_ge_u32 s8, 1688
    s_cbranch_scc1 .ap_29
    s_waitcnt vmcnt(3)
    s_bitcmp1_b64 s[14:15], 46
    s_cbranch_scc0 1
    s_waitcnt vmcnt(2)
    s_cmpk_ge_u32 s8, 1568
    s_cbranch_scc1 .ap_29
    s_waitcnt vmcnt(1)
.ap_29:
    s_add_u32 s63, s69, 180224
    buffer_load_dwordx4 v[216:219], v1, s[44:47], s63 offen nt
    s_memrealtime s[8:9]
    s_waitcnt vmcnt(8)
    s_waitcnt lgkmcnt(0)
    s_sub_u32 s8, s8, s30
    s_cmpk_ge_u32 s8, 1820
    s_cbranch_scc1 .ap_30
    s_waitcnt vmcnt(5)
    s_cmpk_ge_u32 s8, 1720
    s_cbranch_scc1 .ap_30
    s_waitcnt vmcnt(3)
    s_bitcmp1_b64 s[14:15], 47
    s_cbranch_scc0 1
    s_waitcnt vmcnt(2)
    s_cmpk_ge_u32 s8, 1600
    s_cbranch_scc1 .ap_30
    s_waitcnt vmcnt(1)
.ap_30:
    s_add_u32 s63, s69, 188416
    buffer_load_dwordx4 v[220:223], v1, s[44:47], s63 offen nt
    s_memrealtime s[8:9]
    s_waitcnt vmcnt(8)
    s_waitcnt lgkmcnt(0)
    s_sub_u32 s8, s8, s30
    s_cmpk_ge_u32 s8, 1852
    s_cbranch_scc1 .ap_31
    s_waitcnt vmcnt(5)
    s_cmpk_ge_u32 s8, 1752
    s_cbranch_scc1 .ap_31
    s_waitcnt vmcnt(3)
    s_bitcmp1_b64 s[14:15], 48
    s_cbranch_scc0 1
    s_waitcnt vmcnt(2)
    s_cmpk_ge_u32 s8, 1632
    s_cbranch_scc1 .ap_31
    s_waitcnt vmcnt(1)
.ap_31:
    s_add_u32 s63, s69, 262144
    buffer_load_dwordx4 v[224:227], v1, s[44:47], s63 offen nt
    s_memrealtime s[8:9]
    s_waitcnt vmcnt(8)
    s_waitcnt lgkmcnt(0)
    s_sub_u32 s8, s8, s30
    s_cmpk_ge_u32 s8, 1884
    s_cbranch_scc1 .ap_32
    s_waitcnt vmcnt(5)
    s_cmpk_ge_u32 s8, 1784
    s_cbranch_scc1 .ap_32
    s_waitcnt vmcnt(3)
    s_bitcmp1_b64 s[14:15], 49
    s_cbranch_scc0 1
    s_waitcnt vmcnt(2)
    s_cmpk_ge_u32 s8, 1664
    s_cbranch_scc1 .ap_32
    s_waitcnt vmcnt(1)
.ap_32:
    s_add_u32 s63, s69, 270336
    buffer_load_dwordx4 v[228:231], v1, s[44:47], s63 offen nt
    s_memrealtime s[8:9]
    s_waitcnt vmcnt(8)
    s_waitcnt lgkmcnt(0)
    s_sub_u32 s8, s8, s30
    s_cmpk_ge_u32 s8, 1916
    s_cbranch_scc1 .ap_33
    s_waitcnt vmcnt(5)
    s_cmpk_ge_u32 s8, 1816
    s_cbranch_scc1 .ap_33
    s_waitcnt vmcnt(3)
    s_bitcmp1_b64 s[14:15], 50
    s_cbranch_scc0 1
    s_waitcnt vmcnt(2)
    s_cmpk_ge_u32 s8, 1696
    s_cbranch_scc1 .ap_33
    s_waitcnt vmcnt(1)
.ap_33:
    s_add_u32 s63, s69, 278528
    buffer_load_dwordx4 v[232:235], v1, s[44:47], s63 offen nt
    s_memrealtime s[8:9]
    s_waitcnt vmcnt(8)
    s_waitcnt lgkmcnt(0)
    s_sub_u32 s8, s8, s30
    s_cmpk_ge_u32 s8, 1948
    s_cbranch_scc1 .ap_34
    s_waitcnt vmcnt(5)
    s_cmpk_ge_u32 s8, 1848
    s_cbranch_scc1 .ap_34
    s_waitcnt vmcnt(3)
    s_bitcmp1_b64 s[14:15], 51
    s_cbranch_scc0 1
    s_waitcnt vmcnt(2)
    s_cmpk_ge_u32 s8, 1728
    s_cbranch_scc1 .ap_34
    s_waitcnt vmcnt(1)
.ap_34:
    s_add_u32 s63, s69, 286720
    buffer_load_dwordx4 v[236:239], v1, s[44:47], s63 offen nt
    s_memrealtime s[8:9]
    s_waitcnt vmcnt(8)
    s_waitcnt lgkmcnt(0)
    s_sub_u32 s8, s8, s30
    s_cmpk_ge_u32 s8, 1980
    s_cbranch_scc1 .ap_35
    s_waitcnt vmcnt(5)
    s_cmpk_ge_u32 s8, 1880
    s_cbranch_scc1 .ap_35
    s_waitcnt vmcnt(3)
    s_bitcmp1_b64 s[14:15], 52
    s_cbranch_scc0 1
    s_waitcnt vmcnt(2)
    s_cmpk_ge_u32 s8, 1760
    s_cbranch_scc1 .ap_35
    s_waitcnt vmcnt(1)
.ap_35:
    s_add_u32 s63, s69, 294912
    buffer_load_dwordx4 v[240:243], v1, s[44:47], s63 offen nt
    s_memrealtime s[8:9]
    s_waitcnt vmcnt(8)
    s_waitcnt lgkmcnt(0)
    s_sub_u32 s8, s8, s30
    s_cmpk_ge_u32 s8, 2012
    s_cbranch_scc1 .ap_36
    s_waitcnt vmcnt(5)
    s_cmpk_ge_u32 s8, 1912
    s_cbranch_scc1 .ap_36
    s_waitcnt vmcnt(3)
    s_bitcmp1_b64 s[14:15], 53
    s_cbranch_scc0 1
    s_waitcnt vmcnt(2)
    s_cmpk_ge_u32 s8, 1792
    s_cbranch_scc1 .ap_36
    s_waitcnt vmcnt(1)
.ap_36:
    s_add_u32 s63, s69, 303104
    buffer_load_dwordx4 v[244:247], v1, s[44:47], s63 offen nt
    s_and_b32 s0, s0, 0xffffff80
    s_sub_u32 s0, s0, 1024
    buffer_load_dword v28, v4, s[36:39], s0 offen sc1
    buffer_load_dwordx4 v[24:27], v9, s[36:39], s59 offen offset:0 sc1
    s_memrealtime s[8:9]
    s_waitcnt vmcnt(9)
    s_waitcnt lgkmcnt(0)
    s_sub_u32 s8, s8, s30
    s_cmpk_ge_u32 s8, 2044
    s_cbranch_scc1 .ap_37
    s_waitcnt vmcnt(6)
    s_cmpk_ge_u32 s8, 1944
    s_cbranch_scc1 .ap_37
    s_waitcnt vmcnt(4)
    s_bitcmp1_b64 s[14:15], 54
    s_cbranch_scc0 1
    s_waitcnt vmcnt(3)
    s_cmpk_ge_u32 s8, 1824
    s_cbranch_scc1 .ap_37
    s_waitcnt vmcnt(2)
.ap_37:
    s_add_u32 s63, s69, 311296
    buffer_load_dwordx4 v[248:251], v1, s[44:47], s63 offen nt
    s_memrealtime s[8:9]
    s_waitcnt vmcnt(9)
    s_waitcnt lgkmcnt(0)
    s_sub_u32 s8, s8, s30
    s_cmpk_ge_u32 s8, 2076
    s_cbranch_scc1 .ap_38
    s_waitcnt vmcnt(6)
    s_cmpk_ge_u32 s8, 1976
    s_cbranch_scc1 .ap_38
    s_waitcnt vmcnt(4)
    s_bitcmp1_b64 s[14:15], 55
    s_cbranch_scc0 1
    s_waitcnt vmcnt(3)
    s_cmpk_ge_u32 s8, 1856
    s_cbranch_scc1 .ap_38
    s_waitcnt vmcnt(1)
.ap_38:
    s_add_u32 s63, s69, 319488
    buffer_load_dwordx4 v[252:255], v1, s[44:47], s63 offen nt
    s_memrealtime s[8:9]
    s_waitcnt vmcnt(9)
    s_waitcnt lgkmcnt(0)
    s_sub_u32 s8, s8, s30
    s_cmpk_ge_u32 s8, 2108
    s_cbranch_scc1 .ap_39
    s_waitcnt vmcnt(6)
    s_cmpk_ge_u32 s8, 2008
    s_cbranch_scc1 .ap_39
    s_waitcnt vmcnt(4)
    s_bitcmp1_b64 s[14:15], 56
    s_cbranch_scc0 1
    s_waitcnt vmcnt(2)
    s_cmpk_ge_u32 s8, 1888
    s_cbranch_scc1 .ap_39
    s_waitcnt vmcnt(1)
.ap_39:
    s_add_u32 s63, s69, 393216
    buffer_load_dwordx4 v[36:39], v1, s[44:47], s63 offen nt
    s_memrealtime s[8:9]
    s_waitcnt vmcnt(9)
    s_waitcnt lgkmcnt(0)
    s_sub_u32 s8, s8, s30
    s_cmpk_ge_u32 s8, 2140
    s_cbranch_scc1 .ap_40
    s_waitcnt vmcnt(6)
    s_cmpk_ge_u32 s8, 2040
    s_cbranch_scc1 .ap_40
    s_waitcnt vmcnt(3)
    s_bitcmp1_b64 s[14:15], 57
    s_cbranch_scc0 1
    s_waitcnt vmcnt(2)
    s_cmpk_ge_u32 s8, 1920
    s_cbranch_scc1 .ap_40
    s_waitcnt vmcnt(1)
.ap_40:
    s_add_u32 s63, s69, 401408
    buffer_load_dwordx4 v[44:47], v1, s[44:47], s63 offen nt
    s_memrealtime s[8:9]
    s_waitcnt vmcnt(9)
    s_waitcnt lgkmcnt(0)
    s_sub_u32 s8, s8, s30
    s_cmpk_ge_u32 s8, 2172
    s_cbranch_scc1 .ap_41
    s_waitcnt vmcnt(6)
    s_cmpk_ge_u32 s8, 2072
    s_cbranch_scc1 .ap_41
    s_waitcnt vmcnt(3)
    s_branch .Lsk_n1_4
.Lst_n1_4:
    s_branch .Lrt_n1_4
.Lsk_n1_4:
    s_bitcmp1_b64 s[14:15], 58
    s_cbranch_scc0 1
    s_waitcnt vmcnt(2)
    s_cmpk_ge_u32 s8, 1952
    s_cbranch_scc1 .ap_41
    s_waitcnt vmcnt(1)
.ap_41:
    s_add_u32 s63, s69, 409600
    buffer_load_dwordx4 v[52:55], v1, s[44:47], s63 offen nt
    s_memrealtime s[8:9]
    s_waitcnt vmcnt(9)
    s_waitcnt lgkmcnt(0)
    s_sub_u32 s8, s8, s30
    s_cmpk_ge_u32 s8, 2204
    s_cbranch_scc1 .ap_42
    s_waitcnt vmcnt(5)
    s_cmpk_ge_u32 s8, 2104
    s_cbranch_scc1 .ap_42
    s_waitcnt vmcnt(3)
    s_bitcmp1_b64 s[14:15], 59
    s_cbranch_scc0 1
    s_waitcnt vmcnt(2)
    s_cmpk_ge_u32 s8, 1984
    s_cbranch_scc1 .ap_42
    s_waitcnt vmcnt(1)
.ap_42:
    s_add_u32 s63, s69, 417792
    buffer_load_dwordx4 v[60:63], v1, s[44:47], s63 offen nt
    s_memrealtime s[8:9]
    s_waitcnt vmcnt(9)
    s_waitcnt lgkmcnt(0)
    s_sub_u32 s8, s8, s30
    s_cmpk_ge_u32 s8, 2236
    s_cbranch_scc1 .ap_43
    s_waitcnt vmcnt(5)
    s_cmpk_ge_u32 s8, 2136
    s_cbranch_scc1 .ap_43
    s_waitcnt vmcnt(3)
    s_bitcmp1_b64 s[14:15], 60
    s_cbranch_scc0 1
    s_waitcnt vmcnt(2)
    s_cmpk_ge_u32 s8, 2016
    s_cbranch_scc1 .ap_43
    s_waitcnt vmcnt(1)
.ap_43:
    s_add_u32 s63, s69, 425984
    buffer_load_dwordx4 v[68:71], v1, s[44:47], s63 offen nt
    s_memrealtime s[8:9]
    s_waitcnt vmcnt(9)
    s_waitcnt lgkmcnt(0)
    s_sub_u32 s8, s8, s30
    s_cmpk_ge_u32 s8, 2268
    s_cbranch_scc1 .ap_44
    s_waitcnt vmcnt(5)
    s_cmpk_ge_u32 s8, 2168
    s_cbranch_scc1 .ap_44
    s_waitcnt vmcnt(3)
    s_bitcmp1_b64 s[14:15], 61
    s_cbranch_scc0 1
    s_waitcnt vmcnt(2)
    s_cmpk_ge_u32 s8, 2048
    s_cbranch_scc1 .ap_44
    s_waitcnt vmcnt(1)
.ap_44:
    s_add_u32 s63, s69, 434176
    buffer_load_dwordx4 v[76:79], v1, s[44:47], s63 offen nt
    s_memrealtime s[8:9]
    s_waitcnt vmcnt(8)
    s_waitcnt lgkmcnt(0)
    s_sub_u32 s8, s8, s30
    s_cmpk_ge_u32 s8, 2300
    s_cbranch_scc1 .ap_45
    s_waitcnt vmcnt(5)
    s_cmpk_ge_u32 s8, 2200
    s_cbranch_scc1 .ap_45
    s_waitcnt vmcnt(3)
    s_bitcmp1_b64 s[14:15], 62
    s_cbranch_scc0 1
    s_waitcnt vmcnt(2)
    s_cmpk_ge_u32 s8, 2080
    s_cbranch_scc1 .ap_45
    s_waitcnt vmcnt(1)
.ap_45:
    s_add_u32 s63, s69, 442368
    buffer_load_dwordx4 v[84:87], v1, s[44:47], s63 offen nt
    s_memrealtime s[8:9]
    s_waitcnt vmcnt(8)
    s_waitcnt lgkmcnt(0)
    s_sub_u32 s8, s8, s30
    s_cmpk_ge_u32 s8, 2332
    s_cbranch_scc1 .ap_46
    s_waitcnt vmcnt(5)
    s_cmpk_ge_u32 s8, 2232
    s_cbranch_scc1 .ap_46
    s_waitcnt vmcnt(3)
    s_bitcmp1_b64 s[14:15], 63
    s_cbranch_scc0 1
    s_waitcnt vmcnt(2)
    s_cmpk_ge_u32 s8, 2112
    s_cbranch_scc1 .ap_46
    s_waitcnt vmcnt(1)
.ap_46:
    s_add_u32 s63, s69, 450560
    buffer_load_dwordx4 v[92:95], v1, s[44:47], s63 offen nt
    s_setprio 0
    s_branch .gpc_48
.gp_47:
    buffer_load_dwordx4 v[24:27], v9, s[36:39], s59 offen offset:0 sc1
    s_waitcnt vmcnt(0)
.gpc_48:
    v_cmp_eq_u32 vcc, s34, v26
    s_cmp_eq_u64 vcc, -1
    s_nop 3
    s_cbranch_scc1 .gpd_49
    s_sub_u32 s35, s35, 1
    s_cbranch_scc1 .Lexit
    s_sleep 1
    s_branch .gp_47
.gpd_49:
    v_cmp_eq_u32 vcc, s1, v28
    s_cmp_eq_u64 vcc, -1
    s_cselect_b32 s0, 0x800000, 0
    v_mov_b32 v16, v24
    s_nop 1
    v_max_f32_dpp v16, v16, v16 row_ror:4 row_mask:0xf bank_mask:0xf
    v_sub_f32 v17, v24, v16
    v_sub_f32 v18, v14, v16
    v_mul_f32 v17, 0x3fb8aa3b, v17
    v_mul_f32 v18, 0x3fb8aa3b, v18
    v_exp_f32 v17, v17
    v_exp_f32 v18, v18
    v_mul_f32 v17, v17, v25
    s_nop 1
    v_add_f32_dpp v17, v17, v17 row_ror:4 row_mask:0xf bank_mask:0xf
    v_rcp_f32 v19, v17
    s_nop 0
    v_fma_f32 v15, -v17, v19, 1.0
    v_fma_f32 v19, v15, v19, v19
    v_mul_f32 v18, v18, v19
    v_mul_f32 v10, v10, v18
    v_mul_f32 v11, v11, v18
    v_mul_f32 v12, v12, v18
    v_mul_f32 v13, v13, v18
    v_mov_b32_dpp v112, v10 quad_perm:[2,3,0,1] row_mask:0xf bank_mask:0xf
    v_mov_b32_dpp v113, v11 quad_perm:[2,3,0,1] row_mask:0xf bank_mask:0xf
    v_mov_b32_dpp v114, v12 quad_perm:[2,3,0,1] row_mask:0xf bank_mask:0xf
    v_mov_b32_dpp v115, v13 quad_perm:[2,3,0,1] row_mask:0xf bank_mask:0xf
    v_cvt_pk_bf16_f32 v96, v10, v112
    v_cvt_pk_bf16_f32 v100, v11, v113
    v_cvt_pk_bf16_f32 v104, v12, v114
    v_cvt_pk_bf16_f32 v108, v13, v115
    v_mov_b32_dpp v97, v96 row_ror:12 row_mask:0xf bank_mask:0xf
    v_mov_b32_dpp v101, v100 row_ror:12 row_mask:0xf bank_mask:0xf
    v_mov_b32_dpp v105, v104 row_ror:12 row_mask:0xf bank_mask:0xf
    v_mov_b32_dpp v109, v108 row_ror:12 row_mask:0xf bank_mask:0xf
    v_mov_b32_dpp v98, v96 row_ror:8 row_mask:0xf bank_mask:0xf
    v_mov_b32_dpp v102, v100 row_ror:8 row_mask:0xf bank_mask:0xf
    v_mov_b32_dpp v106, v104 row_ror:8 row_mask:0xf bank_mask:0xf
    v_mov_b32_dpp v110, v108 row_ror:8 row_mask:0xf bank_mask:0xf
    v_mov_b32_dpp v99, v96 row_ror:4 row_mask:0xf bank_mask:0xf
    v_mov_b32_dpp v103, v100 row_ror:4 row_mask:0xf bank_mask:0xf
    v_mov_b32_dpp v107, v104 row_ror:4 row_mask:0xf bank_mask:0xf
    v_mov_b32_dpp v111, v108 row_ror:4 row_mask:0xf bank_mask:0xf
    s_lshl_b32 s60, s3, 10
    s_add_u32 s60, s60, 147456
    v_lshlrev_b32 v10, 5, v0
    v_add_u32 v10, s60, v10
    v_perm_b32 v112, v164, v160, s94
    v_perm_b32 v113, v172, v168, s94
    v_perm_b32 v114, v180, v176, s94
    v_perm_b32 v115, v188, v184, s94
    s_nop 1
    v_mfma_f32_16x16x32_bf16 v[128:131], v[96:99], v[112:115], 0
    v_perm_b32 v116, v164, v160, s95
    v_perm_b32 v117, v172, v168, s95
    v_perm_b32 v118, v180, v176, s95
    v_perm_b32 v119, v188, v184, s95
    s_nop 1
    v_mfma_f32_16x16x32_bf16 v[132:135], v[96:99], v[116:119], 0
    v_perm_b32 v120, v165, v161, s94
    v_perm_b32 v121, v173, v169, s94
    v_perm_b32 v122, v181, v177, s94
    v_perm_b32 v123, v189, v185, s94
    s_nop 1
    v_mfma_f32_16x16x32_bf16 v[136:139], v[96:99], v[120:123], 0
    v_perm_b32 v124, v165, v161, s95
    v_perm_b32 v125, v173, v169, s95
    v_perm_b32 v126, v181, v177, s95
    v_perm_b32 v127, v189, v185, s95
    s_nop 1
    v_mfma_f32_16x16x32_bf16 v[140:143], v[96:99], v[124:127], 0
    v_perm_b32 v112, v166, v162, s94
    v_perm_b32 v113, v174, v170, s94
    v_perm_b32 v114, v182, v178, s94
    v_perm_b32 v115, v190, v186, s94
    s_nop 1
    v_mfma_f32_16x16x32_bf16 v[144:147], v[96:99], v[112:115], 0
    v_perm_b32 v116, v166, v162, s95
    v_perm_b32 v117, v174, v170, s95
    v_perm_b32 v118, v182, v178, s95
    v_perm_b32 v119, v190, v186, s95
    s_nop 1
    v_mfma_f32_16x16x32_bf16 v[148:151], v[96:99], v[116:119], 0
    s_branch .Lsk_n1_5
.Lst_n1_5:
    s_branch .Lrt_n1_5
.Lsk_n1_5:
    v_perm_b32 v120, v167, v163, s94
    v_perm_b32 v121, v175, v171, s94
    v_perm_b32 v122, v183, v179, s94
    v_perm_b32 v123, v191, v187, s94
    s_nop 1
    v_mfma_f32_16x16x32_bf16 v[152:155], v[96:99], v[120:123], 0
    v_perm_b32 v124, v167, v163, s95
    v_perm_b32 v125, v175, v171, s95
    v_perm_b32 v126, v183, v179, s95
    v_perm_b32 v127, v191, v187, s95
    s_nop 1
    v_mfma_f32_16x16x32_bf16 v[156:159], v[96:99], v[124:127], 0
    v_perm_b32 v112, v196, v192, s94
    v_perm_b32 v113, v204, v200, s94
    v_perm_b32 v114, v212, v208, s94
    v_perm_b32 v115, v220, v216, s94
    s_nop 1
    v_mfma_f32_16x16x32_bf16 v[128:131], v[100:103], v[112:115], v[128:131]
    v_perm_b32 v116, v196, v192, s95
    v_perm_b32 v117, v204, v200, s95
    v_perm_b32 v118, v212, v208, s95
    v_perm_b32 v119, v220, v216, s95
    s_nop 1
    v_mfma_f32_16x16x32_bf16 v[132:135], v[100:103], v[116:119], v[132:135]
    v_perm_b32 v120, v197, v193, s94
    v_perm_b32 v121, v205, v201, s94
    v_perm_b32 v122, v213, v209, s94
    v_perm_b32 v123, v221, v217, s94
    s_nop 1
    v_mfma_f32_16x16x32_bf16 v[136:139], v[100:103], v[120:123], v[136:139]
    v_perm_b32 v124, v197, v193, s95
    v_perm_b32 v125, v205, v201, s95
    v_perm_b32 v126, v213, v209, s95
    v_perm_b32 v127, v221, v217, s95
    s_nop 1
    v_mfma_f32_16x16x32_bf16 v[140:143], v[100:103], v[124:127], v[140:143]
    v_perm_b32 v112, v198, v194, s94
    v_perm_b32 v113, v206, v202, s94
    v_perm_b32 v114, v214, v210, s94
    v_perm_b32 v115, v222, v218, s94
    s_nop 1
    v_mfma_f32_16x16x32_bf16 v[144:147], v[100:103], v[112:115], v[144:147]
    v_perm_b32 v116, v198, v194, s95
    v_perm_b32 v117, v206, v202, s95
    v_perm_b32 v118, v214, v210, s95
    v_perm_b32 v119, v222, v218, s95
    s_nop 1
    v_mfma_f32_16x16x32_bf16 v[148:151], v[100:103], v[116:119], v[148:151]
    v_perm_b32 v120, v199, v195, s94
    v_perm_b32 v121, v207, v203, s94
    v_perm_b32 v122, v215, v211, s94
    v_perm_b32 v123, v223, v219, s94
    s_nop 1
    v_mfma_f32_16x16x32_bf16 v[152:155], v[100:103], v[120:123], v[152:155]
    v_perm_b32 v124, v199, v195, s95
    v_perm_b32 v125, v207, v203, s95
    v_perm_b32 v126, v215, v211, s95
    v_perm_b32 v127, v223, v219, s95
    s_nop 1
    v_mfma_f32_16x16x32_bf16 v[156:159], v[100:103], v[124:127], v[156:159]
    s_waitcnt vmcnt(8)
    v_perm_b32 v112, v228, v224, s94
    v_perm_b32 v113, v236, v232, s94
    v_perm_b32 v114, v244, v240, s94
    v_perm_b32 v115, v252, v248, s94
    s_nop 1
    v_mfma_f32_16x16x32_bf16 v[128:131], v[104:107], v[112:115], v[128:131]
    v_perm_b32 v116, v228, v224, s95
    v_perm_b32 v117, v236, v232, s95
    v_perm_b32 v118, v244, v240, s95
    v_perm_b32 v119, v252, v248, s95
    s_nop 1
    v_mfma_f32_16x16x32_bf16 v[132:135], v[104:107], v[116:119], v[132:135]
    v_perm_b32 v120, v229, v225, s94
    v_perm_b32 v121, v237, v233, s94
    v_perm_b32 v122, v245, v241, s94
    v_perm_b32 v123, v253, v249, s94
    s_nop 1
    v_mfma_f32_16x16x32_bf16 v[136:139], v[104:107], v[120:123], v[136:139]
    v_perm_b32 v124, v229, v225, s95
    v_perm_b32 v125, v237, v233, s95
    v_perm_b32 v126, v245, v241, s95
    v_perm_b32 v127, v253, v249, s95
    s_nop 1
    v_mfma_f32_16x16x32_bf16 v[140:143], v[104:107], v[124:127], v[140:143]
    v_perm_b32 v112, v230, v226, s94
    v_perm_b32 v113, v238, v234, s94
    v_perm_b32 v114, v246, v242, s94
    v_perm_b32 v115, v254, v250, s94
    s_nop 1
    v_mfma_f32_16x16x32_bf16 v[144:147], v[104:107], v[112:115], v[144:147]
    v_perm_b32 v116, v230, v226, s95
    v_perm_b32 v117, v238, v234, s95
    v_perm_b32 v118, v246, v242, s95
    v_perm_b32 v119, v254, v250, s95
    s_nop 1
    v_mfma_f32_16x16x32_bf16 v[148:151], v[104:107], v[116:119], v[148:151]
    v_perm_b32 v120, v231, v227, s94
    v_perm_b32 v121, v239, v235, s94
    v_perm_b32 v122, v247, v243, s94
    v_perm_b32 v123, v255, v251, s94
    s_nop 1
    v_mfma_f32_16x16x32_bf16 v[152:155], v[104:107], v[120:123], v[152:155]
    v_perm_b32 v124, v231, v227, s95
    v_perm_b32 v125, v239, v235, s95
    v_perm_b32 v126, v247, v243, s95
    v_perm_b32 v127, v255, v251, s95
    s_nop 1
    v_mfma_f32_16x16x32_bf16 v[156:159], v[104:107], v[124:127], v[156:159]
    s_waitcnt vmcnt(0)
    v_perm_b32 v112, v44, v36, s94
    v_perm_b32 v113, v60, v52, s94
    v_perm_b32 v114, v76, v68, s94
    s_branch .Lsk_n1_6
.Lst_n1_6:
    s_branch .Lrt_n1_6
.Lsk_n1_6:
    v_perm_b32 v115, v92, v84, s94
    s_nop 1
    v_mfma_f32_16x16x32_bf16 v[128:131], v[108:111], v[112:115], v[128:131]
    v_perm_b32 v116, v44, v36, s95
    v_perm_b32 v117, v60, v52, s95
    v_perm_b32 v118, v76, v68, s95
    v_perm_b32 v119, v92, v84, s95
    s_nop 1
    v_mfma_f32_16x16x32_bf16 v[132:135], v[108:111], v[116:119], v[132:135]
    v_perm_b32 v120, v45, v37, s94
    v_perm_b32 v121, v61, v53, s94
    v_perm_b32 v122, v77, v69, s94
    v_perm_b32 v123, v93, v85, s94
    s_nop 1
    v_mfma_f32_16x16x32_bf16 v[136:139], v[108:111], v[120:123], v[136:139]
    v_perm_b32 v124, v45, v37, s95
    v_perm_b32 v125, v61, v53, s95
    v_perm_b32 v126, v77, v69, s95
    v_perm_b32 v127, v93, v85, s95
    s_nop 1
    v_mfma_f32_16x16x32_bf16 v[140:143], v[108:111], v[124:127], v[140:143]
    v_perm_b32 v112, v46, v38, s94
    v_perm_b32 v113, v62, v54, s94
    v_perm_b32 v114, v78, v70, s94
    v_perm_b32 v115, v94, v86, s94
    s_nop 1
    v_mfma_f32_16x16x32_bf16 v[144:147], v[108:111], v[112:115], v[144:147]
    v_perm_b32 v116, v46, v38, s95
    v_perm_b32 v117, v62, v54, s95
    v_perm_b32 v118, v78, v70, s95
    v_perm_b32 v119, v94, v86, s95
    s_nop 1
    v_mfma_f32_16x16x32_bf16 v[148:151], v[108:111], v[116:119], v[148:151]
    v_perm_b32 v120, v47, v39, s94
    v_perm_b32 v121, v63, v55, s94
    v_perm_b32 v122, v79, v71, s94
    v_perm_b32 v123, v95, v87, s94
    s_nop 1
    v_mfma_f32_16x16x32_bf16 v[152:155], v[108:111], v[120:123], v[152:155]
    v_perm_b32 v124, v47, v39, s95
    v_perm_b32 v125, v63, v55, s95
    v_perm_b32 v126, v79, v71, s95
    v_perm_b32 v127, v95, v87, s95
    s_nop 1
    v_mfma_f32_16x16x32_bf16 v[156:159], v[108:111], v[124:127], v[156:159]
    s_mov_b64 exec, 0xffff
    ds_write2_b32 v10, v128, v129 offset0:0 offset1:128
    ds_write2_b32 v10, v132, v133 offset0:1 offset1:129
    ds_write2_b32 v10, v136, v137 offset0:2 offset1:130
    ds_write2_b32 v10, v140, v141 offset0:3 offset1:131
    ds_write2_b32 v10, v144, v145 offset0:4 offset1:132
    ds_write2_b32 v10, v148, v149 offset0:5 offset1:133
    ds_write2_b32 v10, v152, v153 offset0:6 offset1:134
    ds_write2_b32 v10, v156, v157 offset0:7 offset1:135
    s_mov_b64 exec, -1
    s_waitcnt lgkmcnt(0)
    s_barrier
    s_cmp_lg_u32 s3, 7
    s_cbranch_scc1 .opub_50
    v_add_u32 v10, 147456, v2
    ds_read_b128 v[196:199], v10 offset:0
    ds_read_b128 v[200:203], v10 offset:1024
    ds_read_b128 v[204:207], v10 offset:2048
    ds_read_b128 v[208:211], v10 offset:3072
    ds_read_b128 v[212:215], v10 offset:4096
    ds_read_b128 v[216:219], v10 offset:5120
    ds_read_b128 v[220:223], v10 offset:6144
    ds_read_b128 v[224:227], v10 offset:7168
    v_lshrrev_b32 v11, 5, v0
    v_lshlrev_b32 v11, 13, v11
    v_and_b32 v12, 31, v0
    v_lshl_add_u32 v11, v12, 4, v11
    s_lshl4_add_u32 s56, s67, s66
    s_lshl1_add_u32 s56, s56, s68
    s_lshl_b32 s56, s56, 9
    s_add_u32 s56, s56, 0xa0000
    s_mov_b32 s60, 0x07060503
    s_mov_b32 s61, 0x07060502
    s_mov_b32 s62, 0x07060501
    v_mov_b32 v15, s34
    s_waitcnt lgkmcnt(6)
    v_pk_add_f32 v[196:197], v[196:197], v[200:201]
    v_pk_add_f32 v[198:199], v[198:199], v[202:203]
    s_waitcnt lgkmcnt(5)
    v_pk_add_f32 v[196:197], v[196:197], v[204:205]
    v_pk_add_f32 v[198:199], v[198:199], v[206:207]
    s_waitcnt lgkmcnt(4)
    v_pk_add_f32 v[196:197], v[196:197], v[208:209]
    v_pk_add_f32 v[198:199], v[198:199], v[210:211]
    s_waitcnt lgkmcnt(3)
    v_pk_add_f32 v[196:197], v[196:197], v[212:213]
    v_pk_add_f32 v[198:199], v[198:199], v[214:215]
    s_waitcnt lgkmcnt(2)
    v_pk_add_f32 v[196:197], v[196:197], v[216:217]
    v_pk_add_f32 v[198:199], v[198:199], v[218:219]
    s_waitcnt lgkmcnt(1)
    v_pk_add_f32 v[196:197], v[196:197], v[220:221]
    v_pk_add_f32 v[198:199], v[198:199], v[222:223]
    s_waitcnt lgkmcnt(0)
    v_pk_add_f32 v[196:197], v[196:197], v[224:225]
    v_pk_add_f32 v[198:199], v[198:199], v[226:227]
    v_perm_b32 v12, v196, v199, s60
    v_perm_b32 v13, v197, v199, s61
    v_perm_b32 v14, v198, v199, s62
    s_add_u32 s57, s56, 0x800000
    buffer_store_dwordx4 v[12:15], v11, s[36:39], s57 offen
    buffer_store_dwordx4 v[12:15], v11, s[36:39], s56 offen sc1
.opub_50:
    s_cmp_lt_u32 s65, 8
    s_nop 0
    s_cbranch_scc1 .Lexit
    v_and_b32 v6, 31, v0
    v_lshlrev_b32 v6, 3, v6
    v_lshrrev_b32 v7, 5, v0
    v_lshl_add_u32 v6, v7, 2, v6
    s_mul_i32 s56, s3, 528
    s_add_u32 s56, s56, 131072
    v_add_u32 v6, s56, v6
    s_lshl4_add_u32 s101, s99, s3
    s_lshl_b32 s101, s101, 10
    s_add_u32 s101, s101, 0xa0000
    v_add_u32 v5, 8192, v2
    s_cmp_ge_u32 s3, 6
    s_nop 0
    s_cbranch_scc1 .La_poll
    v_lshrrev_b32 v16, 4, v0
    v_bfe_u32 v17, v0, 2, 2
    v_lshl_add_u32 v7, v16, 3, v17
    v_lshlrev_b32 v7, 7, v7
    v_and_b32 v16, 1, v16
    v_lshrrev_b32 v17, 1, v17
    v_lshl_add_u32 v16, v16, 1, v17
    s_and_b32 s56, s3, 1
    s_lshl_b32 s56, s56, 1
    v_xor_b32 v16, s56, v16
    v_and_b32 v17, 3, v0
    v_lshl_add_u32 v7, v17, 3, v7
    s_lshr_b32 s56, s3, 1
    s_lshl_b32 s56, s56, 15
    v_add_u32 v7, s56, v7
    v_xor_b32 v17, 1, v16
    v_lshl_add_u32 v8, v17, 5, v7
    v_lshl_add_u32 v7, v16, 5, v7
    ds_read_b64_tr_b16 v[32:33], v7 offset:0
    ds_read_b64_tr_b16 v[34:35], v7 offset:512
    ds_read_b64_tr_b16 v[64:65], v8 offset:0
    ds_read_b64_tr_b16 v[66:67], v8 offset:512
    ds_read_b64_tr_b16 v[36:37], v7 offset:4096
    ds_read_b64_tr_b16 v[38:39], v7 offset:4608
    ds_read_b64_tr_b16 v[68:69], v8 offset:4096
    ds_read_b64_tr_b16 v[70:71], v8 offset:4608
    ds_read_b64_tr_b16 v[40:41], v7 offset:8192
    ds_read_b64_tr_b16 v[42:43], v7 offset:8704
    ds_read_b64_tr_b16 v[72:73], v8 offset:8192
    ds_read_b64_tr_b16 v[74:75], v8 offset:8704
    ds_read_b64_tr_b16 v[44:45], v7 offset:12288
    ds_read_b64_tr_b16 v[46:47], v7 offset:12800
    ds_read_b64_tr_b16 v[76:77], v8 offset:12288
    ds_read_b64_tr_b16 v[78:79], v8 offset:12800
    ds_read_b64_tr_b16 v[48:49], v7 offset:16384
    ds_read_b64_tr_b16 v[50:51], v7 offset:16896
    ds_read_b64_tr_b16 v[80:81], v8 offset:16384
    s_branch .Lsk_n1_7
.Lst_n1_7:
    s_branch .Lrt_n1_7
.Lsk_n1_7:
    ds_read_b64_tr_b16 v[82:83], v8 offset:16896
    ds_read_b64_tr_b16 v[52:53], v7 offset:20480
    ds_read_b64_tr_b16 v[54:55], v7 offset:20992
    ds_read_b64_tr_b16 v[84:85], v8 offset:20480
    ds_read_b64_tr_b16 v[86:87], v8 offset:20992
    ds_read_b64_tr_b16 v[56:57], v7 offset:24576
    ds_read_b64_tr_b16 v[58:59], v7 offset:25088
    ds_read_b64_tr_b16 v[88:89], v8 offset:24576
    ds_read_b64_tr_b16 v[90:91], v8 offset:25088
    ds_read_b64_tr_b16 v[60:61], v7 offset:28672
    ds_read_b64_tr_b16 v[62:63], v7 offset:29184
    ds_read_b64_tr_b16 v[92:93], v8 offset:28672
    ds_read_b64_tr_b16 v[94:95], v8 offset:29184
    s_mov_b32 s56, 131072
    v_bfe_u32 v9, v0, 1, 3
    v_mul_u32_u24 v9, 528, v9
    v_and_b32 v16, 48, v0
    v_add3_u32 v9, v9, v16, s56
    v_bfe_u32 v10, v0, 1, 3
    v_mul_u32_u24 v10, 36864, v10
    v_and_b32 v16, 1, v0
    v_lshl_add_u32 v10, v16, 4, v10
    v_and_b32 v16, 48, v0
    v_lshl_add_u32 v10, v16, 1, v10
    s_mul_i32 s59, s100, 3
    s_lshr_b32 s56, s3, 1
    s_add_u32 s59, s59, s56
    s_lshl4_add_u32 s59, s59, s99
    s_and_b32 s56, s3, 1
    s_lshl1_add_u32 s59, s59, s56
    s_lshl_b32 s59, s59, 7
    s_add_u32 s59, s59, 0xe0000
    v_mov_b32 v139, s34
.La_poll:
    s_mov_b32 s60, 0x04000c0c
    s_mov_b32 s61, 0x0706000c
    s_mov_b32 s69, 0
.gp_51:
    s_add_u32 s69, s69, 1
    s_and_b32 s56, s69, 0x41
    s_cmp_lg_u32 s56, 0x41
    s_cselect_b32 s56, s0, 0
    s_add_u32 s58, s101, s56
    buffer_load_dwordx4 v[16:19], v2, s[36:39], s58 offen offset:0 sc1
    buffer_load_dwordx4 v[20:23], v5, s[36:39], s58 offen offset:0 sc1
    s_waitcnt vmcnt(0)
    v_cmp_eq_u32 vcc, s34, v19
    v_cmp_eq_u32 s[56:57], s34, v23
    s_and_b64 vcc, vcc, s[56:57]
    s_cmp_eq_u64 vcc, -1
    s_nop 2
    s_cbranch_scc1 .gpd_52
    s_sub_u32 s35, s35, 1
    s_cbranch_scc1 .Lexit
    s_branch .gp_51
.gpd_52:
    v_perm_b32 v19, v16, v17, s60
    v_perm_b32 v19, v19, v18, s61
    v_perm_b32 v23, v20, v21, s60
    v_perm_b32 v23, v23, v22, s61
    v_permlane32_swap_b32 v16, v18
    v_permlane32_swap_b32 v17, v19
    v_permlane32_swap_b32 v20, v22
    v_permlane32_swap_b32 v21, v23
    v_pk_add_f32 v[16:17], v[16:17], v[18:19]
    v_pk_add_f32 v[20:21], v[20:21], v[22:23]
    v_cvt_pk_bf16_f32 v16, v16, v17
    v_cvt_pk_bf16_f32 v20, v20, v21
    ds_write2_b32 v6, v16, v20 offset1:64
    s_mov_b32 s60, 0x07060503
    s_mov_b32 s61, 0x07060502
    s_mov_b32 s62, 0x07060501
    s_mov_b32 vcc_lo, 0xaaaaaaaa
    s_mov_b32 vcc_hi, 0xaaaaaaaa
    s_waitcnt lgkmcnt(0)
    s_barrier
    s_cmp_ge_u32 s3, 6
    s_cbranch_scc1 .Lexit
    ds_read_b128 v[96:99], v9 offset:0
    ds_read_b128 v[100:103], v9 offset:64
    ds_read_b128 v[104:107], v9 offset:128
    ds_read_b128 v[108:111], v9 offset:192
    ds_read_b128 v[112:115], v9 offset:256
    ds_read_b128 v[116:119], v9 offset:320
    ds_read_b128 v[120:123], v9 offset:384
    ds_read_b128 v[124:127], v9 offset:448
    s_waitcnt lgkmcnt(7)
    v_mfma_f32_16x16x32_bf16 v[128:131], v[32:35], v[96:99], 0
    v_mfma_f32_16x16x32_bf16 v[132:135], v[64:67], v[96:99], 0
    s_waitcnt lgkmcnt(6)
    v_mfma_f32_16x16x32_bf16 v[128:131], v[36:39], v[100:103], v[128:131]
    v_mfma_f32_16x16x32_bf16 v[132:135], v[68:71], v[100:103], v[132:135]
    s_waitcnt lgkmcnt(5)
    v_mfma_f32_16x16x32_bf16 v[128:131], v[40:43], v[104:107], v[128:131]
    v_mfma_f32_16x16x32_bf16 v[132:135], v[72:75], v[104:107], v[132:135]
    s_waitcnt lgkmcnt(4)
    v_mfma_f32_16x16x32_bf16 v[128:131], v[44:47], v[108:111], v[128:131]
    v_mfma_f32_16x16x32_bf16 v[132:135], v[76:79], v[108:111], v[132:135]
    s_waitcnt lgkmcnt(3)
    v_mfma_f32_16x16x32_bf16 v[128:131], v[48:51], v[112:115], v[128:131]
    v_mfma_f32_16x16x32_bf16 v[132:135], v[80:83], v[112:115], v[132:135]
    s_waitcnt lgkmcnt(2)
    v_mfma_f32_16x16x32_bf16 v[128:131], v[52:55], v[116:119], v[128:131]
    v_mfma_f32_16x16x32_bf16 v[132:135], v[84:87], v[116:119], v[132:135]
    s_waitcnt lgkmcnt(1)
    v_mfma_f32_16x16x32_bf16 v[128:131], v[56:59], v[120:123], v[128:131]
    v_mfma_f32_16x16x32_bf16 v[132:135], v[88:91], v[120:123], v[132:135]
    s_waitcnt lgkmcnt(0)
    v_mfma_f32_16x16x32_bf16 v[128:131], v[60:63], v[124:127], v[128:131]
    v_mfma_f32_16x16x32_bf16 v[132:135], v[92:95], v[124:127], v[132:135]
    s_nop 7
    v_cndmask_b32 v128, v128, v132, vcc
    v_cndmask_b32 v129, v129, v133, vcc
    v_cndmask_b32 v130, v130, v134, vcc
    v_cndmask_b32 v131, v131, v135, vcc
    v_perm_b32 v136, v128, v131, s60
    v_perm_b32 v137, v129, v131, s61
    v_perm_b32 v138, v130, v131, s62
    buffer_store_dwordx4 v[136:139], v10, s[36:39], s59 offen sc1
    s_nop 1
    s_branch .Lexit
.Lm:
    s_branch .Lsk_m0_0
.Lst_m0_0:
    s_branch .Lrt_m0_0
.Lsk_m0_0:
    s_cmp_lt_u32 s2, 54
    s_mov_b32 s14, 0xfdff7fdf
    s_cselect_b32 s14, 0x6b5ad6b5, s14
    s_mov_b32 s15, 0xff7fdff7
    s_cselect_b32 s15, 0x5ad6b5ad, s15
    s_add_u32 s30, s70, 0
    s_mov_b32 s31, s70
    v_bfe_u32 v16, v0, 1, 3
    v_mul_u32_u24 v16, 1312, v16
    v_lshrrev_b32 v12, 4, v0
    v_lshl_add_u32 v16, v12, 5, v16
    v_and_b32 v12, 1, v0
    v_lshl_add_u32 v16, v12, 4, v16
    v_add_u32 v16, 147456, v16
    s_mul_i32 s56, s3, 1312
    s_add_u32 s56, s56, 147456
    v_add_u32 v17, s56, v3
    v_add_u32 v18, s56, v4
    v_lshrrev_b32 v12, 4, v0
    v_bfe_u32 v13, v0, 1, 1
    v_lshl_add_u32 v12, v12, 1, v13
    v_bfe_u32 v13, v0, 2, 2
    v_lshl_add_u32 v20, v12, 3, v13
    v_lshlrev_b32 v20, 7, v20
    v_and_b32 v12, 3, v12
    v_lshrrev_b32 v13, 1, v13
    v_lshl_add_u32 v12, v12, 1, v13
    v_xor_b32 v12, s3, v12
    v_lshl_add_u32 v20, v12, 4, v20
    v_and_b32 v12, 1, v0
    v_lshl_add_u32 v20, v12, 3, v20
    v_bfe_u32 v23, v0, 1, 3
    v_mul_u32_u24 v23, 144, v23
    v_bfe_u32 v12, v0, 4, 1
    v_lshl_add_u32 v23, v12, 3, v23
    v_lshrrev_b32 v12, 5, v0
    v_lshl_add_u32 v23, v12, 2, v23
    v_and_b32 v12, 1, v0
    v_lshl_add_u32 v23, v12, 1, v23
    s_lshl_b32 s56, s3, 4
    s_add_u32 s56, s56, 157952
    v_add_u32 v23, s56, v23
    v_and_b32 v24, 15, v0
    v_lshlrev_b32 v24, 3, v24
    s_mul_i32 s56, s3, 144
    s_add_u32 s56, s56, 157952
    v_add_u32 v24, s56, v24
    v_add_u32 v21, 32768, v20
    s_lshl_b32 s100, s3, 10
    s_mov_b32 s99, s2
    s_cmp_ge_u32 s99, 18
    s_cbranch_scc1 .Lm_rel
    s_mul_i32 s58, s3, 1152
    s_mov_b32 s52, s24
    s_and_b32 s53, s25, 0xffff
    s_mov_b32 s54, 0x2400
    s_mov_b32 s55, 0x00020000
    buffer_load_dwordx2 v[246:247], v3, s[52:55], s58 offen
    buffer_load_dwordx2 v[248:249], v3, s[52:55], s58 offen offset:512
    buffer_load_dword v250, v4, s[52:55], s58 offen
    s_mov_b32 s48, s26
    s_and_b32 s49, s27, 0xffff
    s_mov_b32 s50, 0x3cc000
    s_mov_b32 s51, 0x00020000
    v_bfe_u32 v12, v0, 4, 1
    s_and_b32 s56, s3, 3
    s_lshl_b32 s56, s56, 1
    v_or_b32 v12, s56, v12
    v_and_b32 v19, 7, v0
    v_xor_b32 v12, v12, v19
    v_lshrrev_b32 v19, 3, v0
    v_mul_u32_u24 v19, 6912, v19
    v_lshl_add_u32 v19, v12, 4, v19
    s_mul_i32 s57, s3, 55296
    s_lshl_b32 s59, s99, 7
    s_add_u32 s57, s57, s59
    s_add_u32 m0, s100, 0
    s_add_u32 s56, s57, 0
    buffer_load_dwordx4 v19, s[48:51], s56 offen nt lds
    s_add_u32 m0, s100, 8192
    s_add_u32 s56, s57, 442368
    buffer_load_dwordx4 v19, s[48:51], s56 offen nt lds
    s_add_u32 m0, s100, 16384
    s_add_u32 s56, s57, 884736
    buffer_load_dwordx4 v19, s[48:51], s56 offen nt lds
    s_add_u32 m0, s100, 24576
    s_add_u32 s56, s57, 1327104
    buffer_load_dwordx4 v19, s[48:51], s56 offen nt lds
    s_add_u32 m0, s100, 32768
    s_add_u32 s56, s57, 1769472
    buffer_load_dwordx4 v19, s[48:51], s56 offen nt lds
    s_add_u32 m0, s100, 40960
    s_add_u32 s56, s57, 2211840
    buffer_load_dwordx4 v19, s[48:51], s56 offen nt lds
    s_add_u32 m0, s100, 49152
    s_add_u32 s56, s57, 2654208
    buffer_load_dwordx4 v19, s[48:51], s56 offen nt lds
    s_add_u32 m0, s100, 57344
    s_add_u32 s56, s57, 3096576
    buffer_load_dwordx4 v19, s[48:51], s56 offen nt lds
    s_add_u32 m0, s100, 65536
    s_add_u32 s56, s57, 3538944
    buffer_load_dwordx4 v19, s[48:51], s56 offen nt lds
    s_waitcnt lgkmcnt(0)
    s_add_u32 s34, s34, 1
    s_getreg_b32 s1, hwreg(HW_REG_XCC_ID)
    s_lshl_b32 s1, s1, 24
    s_add_u32 s1, s1, s34
    s_lshr_b32 s0, s2, 3
    s_lshl_b32 s63, s64, 8
    s_add_u32 s0, s0, s63
    s_lshl2_add_u32 s0, s0, 0x480000
    v_mov_b32 v30, s1
    s_cmp_eq_u32 s3, 0
    s_cselect_b64 exec, 1, 0
    buffer_store_dword v30, v2, s[36:39], s0 offen sc1
    s_mov_b64 exec, -1
    v_lshrrev_b32 v12, 4, v0
    v_mul_u32_u24 v12, 18432, v12
    v_and_b32 v13, 15, v0
    v_lshl_add_u32 v22, v13, 4, v12
    s_mul_i32 s57, s99, 57
    s_lshr_b32 s57, s57, 9
    s_mul_i32 s58, s57, 9
    s_sub_u32 s58, s99, s58
    s_mul_i32 s59, s57, 73728
    s_lshl_b32 s58, s58, 8
    s_add_u32 s59, s59, s58
    s_mul_i32 s58, s3, 2304
    s_add_u32 s59, s59, s58
    s_add_u32 s59, s59, 0x1000
    s_mov_b32 s58, 0
    s_cmp_eq_u32 s57, 1
    s_cselect_b32 s58, 1.0, s58
    s_cmp_eq_u32 s57, 4
    s_cselect_b32 s58, 1.0, s58
    s_waitcnt vmcnt(10)
    v_lshlrev_b32 v236, 16, v246
    v_and_b32 v237, 0xffff0000, v246
    v_max_f32 v236, 0xc2ae0000, v236
    v_min_f32 v242, 0x43000000, v236
    v_mul_f32 v238, 0xbfb8aa3b, v242
    v_fma_f32 v240, v242, s98, -v238
    v_fmac_f32 v240, 0xb2a57060, v242
    v_exp_f32 v238, v238
    v_mul_f32 v240, 0x3f317218, v240
    v_fmac_f32 v238, v238, v240
    v_add_f32 v238, 1.0, v238
    v_rcp_f32 v240, v238
    s_nop 0
    v_mul_f32 v242, v236, v240
    v_fma_f32 v238, -v242, v238, v236
    v_fma_f32 v236, v238, v240, v242
    v_max_f32 v237, 0xc2ae0000, v237
    v_min_f32 v243, 0x43000000, v237
    v_mul_f32 v239, 0xbfb8aa3b, v243
    v_fma_f32 v241, v243, s98, -v239
    v_fmac_f32 v241, 0xb2a57060, v243
    v_exp_f32 v239, v239
    v_mul_f32 v241, 0x3f317218, v241
    v_fmac_f32 v239, v239, v241
    v_add_f32 v239, 1.0, v239
    v_rcp_f32 v241, v239
    s_nop 0
    v_mul_f32 v243, v237, v241
    v_fma_f32 v239, -v243, v239, v237
    v_fma_f32 v237, v239, v241, v243
    v_cvt_pk_bf16_f32 v246, v236, v237
    v_lshlrev_b32 v236, 16, v247
    v_and_b32 v237, 0xffff0000, v247
    v_max_f32 v236, 0xc2ae0000, v236
    v_min_f32 v242, 0x43000000, v236
    v_mul_f32 v238, 0xbfb8aa3b, v242
    v_fma_f32 v240, v242, s98, -v238
    s_branch .Lsk_m0_1
.Lst_m0_1:
    s_branch .Lrt_m0_1
.Lsk_m0_1:
    v_fmac_f32 v240, 0xb2a57060, v242
    v_exp_f32 v238, v238
    v_mul_f32 v240, 0x3f317218, v240
    v_fmac_f32 v238, v238, v240
    v_add_f32 v238, 1.0, v238
    v_rcp_f32 v240, v238
    s_nop 0
    v_mul_f32 v242, v236, v240
    v_fma_f32 v238, -v242, v238, v236
    v_fma_f32 v236, v238, v240, v242
    v_max_f32 v237, 0xc2ae0000, v237
    v_min_f32 v243, 0x43000000, v237
    v_mul_f32 v239, 0xbfb8aa3b, v243
    v_fma_f32 v241, v243, s98, -v239
    v_fmac_f32 v241, 0xb2a57060, v243
    v_exp_f32 v239, v239
    v_mul_f32 v241, 0x3f317218, v241
    v_fmac_f32 v239, v239, v241
    v_add_f32 v239, 1.0, v239
    v_rcp_f32 v241, v239
    s_nop 0
    v_mul_f32 v243, v237, v241
    v_fma_f32 v239, -v243, v239, v237
    v_fma_f32 v237, v239, v241, v243
    v_cvt_pk_bf16_f32 v247, v236, v237
    v_lshlrev_b32 v236, 16, v248
    v_and_b32 v237, 0xffff0000, v248
    v_max_f32 v236, 0xc2ae0000, v236
    v_min_f32 v242, 0x43000000, v236
    v_mul_f32 v238, 0xbfb8aa3b, v242
    v_fma_f32 v240, v242, s98, -v238
    v_fmac_f32 v240, 0xb2a57060, v242
    v_exp_f32 v238, v238
    v_mul_f32 v240, 0x3f317218, v240
    v_fmac_f32 v238, v238, v240
    v_add_f32 v238, 1.0, v238
    v_rcp_f32 v240, v238
    s_nop 0
    v_mul_f32 v242, v236, v240
    v_fma_f32 v238, -v242, v238, v236
    v_fma_f32 v236, v238, v240, v242
    v_max_f32 v237, 0xc2ae0000, v237
    v_min_f32 v243, 0x43000000, v237
    v_mul_f32 v239, 0xbfb8aa3b, v243
    v_fma_f32 v241, v243, s98, -v239
    v_fmac_f32 v241, 0xb2a57060, v243
    v_exp_f32 v239, v239
    v_mul_f32 v241, 0x3f317218, v241
    v_fmac_f32 v239, v239, v241
    v_add_f32 v239, 1.0, v239
    v_rcp_f32 v241, v239
    s_nop 0
    v_mul_f32 v243, v237, v241
    v_fma_f32 v239, -v243, v239, v237
    v_fma_f32 v237, v239, v241, v243
    v_cvt_pk_bf16_f32 v248, v236, v237
    v_lshlrev_b32 v236, 16, v249
    v_and_b32 v237, 0xffff0000, v249
    v_max_f32 v236, 0xc2ae0000, v236
    v_min_f32 v242, 0x43000000, v236
    v_mul_f32 v238, 0xbfb8aa3b, v242
    v_fma_f32 v240, v242, s98, -v238
    v_fmac_f32 v240, 0xb2a57060, v242
    v_exp_f32 v238, v238
    v_mul_f32 v240, 0x3f317218, v240
    v_fmac_f32 v238, v238, v240
    v_add_f32 v238, 1.0, v238
    v_rcp_f32 v240, v238
    s_nop 0
    v_mul_f32 v242, v236, v240
    v_fma_f32 v238, -v242, v238, v236
    v_fma_f32 v236, v238, v240, v242
    v_max_f32 v237, 0xc2ae0000, v237
    v_min_f32 v243, 0x43000000, v237
    v_mul_f32 v239, 0xbfb8aa3b, v243
    v_fma_f32 v241, v243, s98, -v239
    v_fmac_f32 v241, 0xb2a57060, v243
    v_exp_f32 v239, v239
    v_mul_f32 v241, 0x3f317218, v241
    v_fmac_f32 v239, v239, v241
    v_add_f32 v239, 1.0, v239
    v_rcp_f32 v241, v239
    s_nop 0
    v_mul_f32 v243, v237, v241
    v_fma_f32 v239, -v243, v239, v237
    v_fma_f32 v237, v239, v241, v243
    v_cvt_pk_bf16_f32 v249, v236, v237
    v_lshlrev_b32 v236, 16, v250
    v_and_b32 v237, 0xffff0000, v250
    v_max_f32 v236, 0xc2ae0000, v236
    v_min_f32 v242, 0x43000000, v236
    v_mul_f32 v238, 0xbfb8aa3b, v242
    v_fma_f32 v240, v242, s98, -v238
    v_fmac_f32 v240, 0xb2a57060, v242
    v_exp_f32 v238, v238
    v_mul_f32 v240, 0x3f317218, v240
    v_fmac_f32 v238, v238, v240
    v_add_f32 v238, 1.0, v238
    v_rcp_f32 v240, v238
    s_nop 0
    v_mul_f32 v242, v236, v240
    v_fma_f32 v238, -v242, v238, v236
    v_fma_f32 v236, v238, v240, v242
    v_max_f32 v237, 0xc2ae0000, v237
    v_min_f32 v243, 0x43000000, v237
    v_mul_f32 v239, 0xbfb8aa3b, v243
    v_fma_f32 v241, v243, s98, -v239
    v_fmac_f32 v241, 0xb2a57060, v243
    v_exp_f32 v239, v239
    v_mul_f32 v241, 0x3f317218, v241
    v_fmac_f32 v239, v239, v241
    v_add_f32 v239, 1.0, v239
    v_rcp_f32 v241, v239
    s_nop 0
    v_mul_f32 v243, v237, v241
    v_fma_f32 v239, -v243, v239, v237
    v_fma_f32 v237, v239, v241, v243
    v_cvt_pk_bf16_f32 v250, v236, v237
    ds_write_b64 v17, v[246:247] offset:0
    ds_write_b64 v17, v[248:249] offset:512
    ds_write_b32 v18, v250 offset:0
    s_waitcnt vmcnt(1)
    s_waitcnt lgkmcnt(0)
    s_barrier
    ds_read_b64_tr_b16 v[160:161], v20 offset:0
    ds_read_b64_tr_b16 v[162:163], v20 offset:512
    ds_read_b64_tr_b16 v[164:165], v20 offset:8192
    ds_read_b64_tr_b16 v[166:167], v20 offset:8704
    ds_read_b64_tr_b16 v[168:169], v20 offset:16384
    ds_read_b64_tr_b16 v[170:171], v20 offset:16896
    ds_read_b64_tr_b16 v[172:173], v20 offset:24576
    ds_read_b64_tr_b16 v[174:175], v20 offset:25088
    ds_read_b64_tr_b16 v[176:177], v21 offset:0
    ds_read_b64_tr_b16 v[178:179], v21 offset:512
    ds_read_b64_tr_b16 v[180:181], v21 offset:8192
    ds_read_b64_tr_b16 v[182:183], v21 offset:8704
    ds_read_b64_tr_b16 v[184:185], v21 offset:16384
    ds_read_b64_tr_b16 v[186:187], v21 offset:16896
    ds_read_b64_tr_b16 v[188:189], v21 offset:24576
    ds_read_b64_tr_b16 v[190:191], v21 offset:25088
    ds_read_b64_tr_b16 v[192:193], v21 offset:32768
    ds_read_b64_tr_b16 v[194:195], v21 offset:33280
    ds_read_b128 v[196:199], v16 offset:0
    ds_read_b128 v[200:203], v16 offset:128
    ds_read_b128 v[204:207], v16 offset:256
    ds_read_b128 v[208:211], v16 offset:384
    ds_read_b128 v[212:215], v16 offset:512
    ds_read_b128 v[216:219], v16 offset:640
    ds_read_b128 v[220:223], v16 offset:768
    ds_read_b128 v[224:227], v16 offset:896
    ds_read_b128 v[228:231], v16 offset:1024
    s_waitcnt lgkmcnt(8)
    v_mfma_f32_16x16x32_bf16 v[232:235], v[160:163], v[196:199], 0
    s_waitcnt lgkmcnt(7)
    v_mfma_f32_16x16x32_bf16 v[232:235], v[164:167], v[200:203], v[232:235]
    s_waitcnt lgkmcnt(6)
    v_mfma_f32_16x16x32_bf16 v[232:235], v[168:171], v[204:207], v[232:235]
    s_waitcnt lgkmcnt(5)
    v_mfma_f32_16x16x32_bf16 v[232:235], v[172:175], v[208:211], v[232:235]
    s_waitcnt lgkmcnt(4)
    v_mfma_f32_16x16x32_bf16 v[232:235], v[176:179], v[212:215], v[232:235]
    s_waitcnt lgkmcnt(3)
    v_mfma_f32_16x16x32_bf16 v[232:235], v[180:183], v[216:219], v[232:235]
    s_waitcnt lgkmcnt(2)
    v_mfma_f32_16x16x32_bf16 v[232:235], v[184:187], v[220:223], v[232:235]
    s_branch .Lsk_m0_2
.Lst_m0_2:
    s_branch .Lrt_m0_2
.Lsk_m0_2:
    s_waitcnt lgkmcnt(1)
    v_mfma_f32_16x16x32_bf16 v[232:235], v[188:191], v[224:227], v[232:235]
    s_waitcnt lgkmcnt(0)
    v_mfma_f32_16x16x32_bf16 v[232:235], v[192:195], v[228:231], v[232:235]
    s_nop 7
    v_permlane32_swap_b32 v232, v234
    v_permlane32_swap_b32 v233, v235
    v_cndmask_b32 v233, v233, v234, s[96:97]
    v_cndmask_b32 v232, v232, v235, s[96:97]
    s_nop 1
    s_branch .Lsk_m0_3
.Lst_m0_3:
    s_branch .Lrt_m0_3
.Lsk_m0_3:
    v_add_f32_dpp v236, v233, v232 quad_perm:[1,0,3,2] row_mask:0xf bank_mask:0xf
    v_cvt_pk_bf16_f32 v236, v236, v236
    v_lshlrev_b32 v236, 16, v236
    v_add_f32 v236, s58, v236
    v_cvt_pk_bf16_f32 v236, v236, v236
    ds_write_b16 v23, v236
    v_mov_b32 v243, s34
    s_waitcnt lgkmcnt(0)
    s_barrier
    ds_read2_b32 v[244:245], v24 offset1:1
    v_mov_b32 v241, s34
    s_waitcnt lgkmcnt(0)
    v_mov_b32 v240, v244
    v_mov_b32 v242, v245
    s_bfm_b64 exec, 32, 0
    buffer_store_dwordx4 v[240:243], v22, s[36:39], s59 offen sc1
    s_mov_b64 exec, -1
    s_add_u32 s63, s69, 32768
    buffer_load_dwordx4 v[96:99], v1, s[40:43], s63 offen nt
    s_add_u32 s63, s69, 40960
    buffer_load_dwordx4 v[100:103], v1, s[40:43], s63 offen nt
    s_add_u32 s63, s69, 49152
    buffer_load_dwordx4 v[128:131], v1, s[40:43], s63 offen nt
    s_add_u32 s63, s69, 57344
    buffer_load_dwordx4 v[132:135], v1, s[40:43], s63 offen nt
    s_waitcnt vmcnt(3)
    s_add_u32 s63, s69, 131072
    buffer_load_dwordx4 v[40:43], v1, s[40:43], s63 offen nt
    s_waitcnt vmcnt(3)
    s_add_u32 s63, s69, 139264
    buffer_load_dwordx4 v[44:47], v1, s[40:43], s63 offen nt
    s_waitcnt vmcnt(3)
    s_add_u32 s63, s69, 147456
    buffer_load_dwordx4 v[72:75], v1, s[40:43], s63 offen nt
    s_waitcnt vmcnt(3)
    s_add_u32 s63, s69, 155648
    buffer_load_dwordx4 v[76:79], v1, s[40:43], s63 offen nt
    s_waitcnt vmcnt(3)
    s_add_u32 s63, s69, 163840
    buffer_load_dwordx4 v[104:107], v1, s[40:43], s63 offen nt
    s_waitcnt vmcnt(3)
    s_add_u32 s63, s69, 172032
    buffer_load_dwordx4 v[108:111], v1, s[40:43], s63 offen nt
    s_waitcnt vmcnt(3)
    s_add_u32 s63, s69, 180224
    buffer_load_dwordx4 v[136:139], v1, s[40:43], s63 offen nt
    s_waitcnt vmcnt(3)
    s_add_u32 s63, s69, 188416
    buffer_load_dwordx4 v[140:143], v1, s[40:43], s63 offen nt
    s_waitcnt vmcnt(3)
    s_add_u32 s63, s69, 262144
    buffer_load_dwordx4 v[48:51], v1, s[40:43], s63 offen nt
    s_waitcnt vmcnt(3)
    s_add_u32 s63, s69, 270336
    buffer_load_dwordx4 v[52:55], v1, s[40:43], s63 offen nt
    s_branch .Le_done
.Lm_rel:
    s_waitcnt vmcnt(4)
    s_bitcmp1_b64 s[14:15], 4
    s_cbranch_scc0 1
    s_waitcnt vmcnt(3)
    s_add_u32 s63, s69, 32768
    buffer_load_dwordx4 v[96:99], v1, s[40:43], s63 offen nt
    s_waitcnt vmcnt(4)
    s_bitcmp1_b64 s[14:15], 5
    s_cbranch_scc0 1
    s_waitcnt vmcnt(3)
    s_add_u32 s63, s69, 40960
    buffer_load_dwordx4 v[100:103], v1, s[40:43], s63 offen nt
    s_waitcnt vmcnt(4)
    s_bitcmp1_b64 s[14:15], 6
    s_cbranch_scc0 1
    s_waitcnt vmcnt(3)
    s_add_u32 s63, s69, 49152
    buffer_load_dwordx4 v[128:131], v1, s[40:43], s63 offen nt
    s_waitcnt vmcnt(4)
    s_bitcmp1_b64 s[14:15], 7
    s_cbranch_scc0 1
    s_waitcnt vmcnt(2)
    s_add_u32 s63, s69, 57344
    buffer_load_dwordx4 v[132:135], v1, s[40:43], s63 offen nt
    s_waitcnt vmcnt(3)
    s_bitcmp1_b64 s[14:15], 8
    s_cbranch_scc0 1
    s_waitcnt vmcnt(2)
    s_add_u32 s63, s69, 131072
    buffer_load_dwordx4 v[40:43], v1, s[40:43], s63 offen nt
    s_waitcnt vmcnt(3)
    s_bitcmp1_b64 s[14:15], 9
    s_cbranch_scc0 1
    s_waitcnt vmcnt(2)
    s_add_u32 s63, s69, 139264
    buffer_load_dwordx4 v[44:47], v1, s[40:43], s63 offen nt
    s_waitcnt lgkmcnt(0)
    s_add_u32 s34, s34, 1
    s_getreg_b32 s1, hwreg(HW_REG_XCC_ID)
    s_lshl_b32 s1, s1, 24
    s_add_u32 s1, s1, s34
    s_lshr_b32 s0, s2, 3
    s_lshl_b32 s63, s64, 8
    s_add_u32 s0, s0, s63
    s_lshl2_add_u32 s0, s0, 0x480000
    v_mov_b32 v30, s1
    s_cmp_eq_u32 s3, 0
    s_cselect_b64 exec, 1, 0
    buffer_store_dword v30, v2, s[36:39], s0 offen sc1
    s_mov_b64 exec, -1
    s_cmp_lt_u32 s99, 54
    s_cbranch_scc1 .Lmr_part
    s_waitcnt vmcnt(4)
    s_bitcmp1_b64 s[14:15], 10
    s_cbranch_scc0 1
    s_waitcnt vmcnt(3)
    s_add_u32 s63, s69, 147456
    buffer_load_dwordx4 v[72:75], v1, s[40:43], s63 offen nt
    s_waitcnt vmcnt(4)
    s_bitcmp1_b64 s[14:15], 11
    s_cbranch_scc0 1
    s_waitcnt vmcnt(3)
    s_add_u32 s63, s69, 155648
    buffer_load_dwordx4 v[76:79], v1, s[40:43], s63 offen nt
    s_waitcnt vmcnt(4)
    s_bitcmp1_b64 s[14:15], 12
    s_cbranch_scc0 1
    s_waitcnt vmcnt(3)
    s_add_u32 s63, s69, 163840
    buffer_load_dwordx4 v[104:107], v1, s[40:43], s63 offen nt
    s_waitcnt vmcnt(4)
    s_bitcmp1_b64 s[14:15], 13
    s_cbranch_scc0 1
    s_waitcnt vmcnt(2)
    s_add_u32 s63, s69, 172032
    buffer_load_dwordx4 v[108:111], v1, s[40:43], s63 offen nt
    s_waitcnt vmcnt(3)
    s_bitcmp1_b64 s[14:15], 14
    s_cbranch_scc0 1
    s_waitcnt vmcnt(2)
    s_add_u32 s63, s69, 180224
    buffer_load_dwordx4 v[136:139], v1, s[40:43], s63 offen nt
    s_waitcnt vmcnt(3)
    s_bitcmp1_b64 s[14:15], 15
    s_cbranch_scc0 1
    s_waitcnt vmcnt(2)
    s_add_u32 s63, s69, 188416
    buffer_load_dwordx4 v[140:143], v1, s[40:43], s63 offen nt
    s_waitcnt vmcnt(3)
    s_bitcmp1_b64 s[14:15], 16
    s_cbranch_scc0 1
    s_waitcnt vmcnt(2)
    s_add_u32 s63, s69, 262144
    buffer_load_dwordx4 v[48:51], v1, s[40:43], s63 offen nt
    s_waitcnt vmcnt(3)
    s_bitcmp1_b64 s[14:15], 17
    s_cbranch_scc0 1
    s_waitcnt vmcnt(2)
    s_add_u32 s63, s69, 270336
    buffer_load_dwordx4 v[52:55], v1, s[40:43], s63 offen nt
    s_branch .Le_done
.Lmr_part:
    s_mul_i32 s58, s3, 1152
    s_mov_b32 s52, s24
    s_and_b32 s53, s25, 0xffff
    s_mov_b32 s54, 0x2400
    s_mov_b32 s55, 0x00020000
    buffer_load_dwordx2 v[246:247], v3, s[52:55], s58 offen
    buffer_load_dwordx2 v[248:249], v3, s[52:55], s58 offen offset:512
    buffer_load_dword v250, v4, s[52:55], s58 offen
    s_mov_b32 s48, s26
    s_and_b32 s49, s27, 0xffff
    s_mov_b32 s50, 0x3cc000
    s_mov_b32 s51, 0x00020000
    v_bfe_u32 v12, v0, 4, 1
    s_and_b32 s56, s3, 3
    s_lshl_b32 s56, s56, 1
    v_or_b32 v12, s56, v12
    v_and_b32 v19, 7, v0
    v_xor_b32 v12, v12, v19
    v_lshrrev_b32 v19, 3, v0
    v_mul_u32_u24 v19, 6912, v19
    v_lshl_add_u32 v19, v12, 4, v19
    s_mul_i32 s57, s3, 55296
    s_lshl_b32 s59, s99, 7
    s_add_u32 s57, s57, s59
    s_add_u32 m0, s100, 0
    s_add_u32 s56, s57, 0
    buffer_load_dwordx4 v19, s[48:51], s56 offen nt lds
    s_add_u32 m0, s100, 8192
    s_add_u32 s56, s57, 442368
    buffer_load_dwordx4 v19, s[48:51], s56 offen nt lds
    s_add_u32 m0, s100, 16384
    s_branch .Lsk_m0_4
.Lst_m0_4:
    s_branch .Lrt_m0_4
.Lsk_m0_4:
    s_add_u32 s56, s57, 884736
    buffer_load_dwordx4 v19, s[48:51], s56 offen nt lds
    s_add_u32 m0, s100, 24576
    s_add_u32 s56, s57, 1327104
    buffer_load_dwordx4 v19, s[48:51], s56 offen nt lds
    s_add_u32 m0, s100, 32768
    s_add_u32 s56, s57, 1769472
    buffer_load_dwordx4 v19, s[48:51], s56 offen nt lds
    s_add_u32 m0, s100, 40960
    s_add_u32 s56, s57, 2211840
    buffer_load_dwordx4 v19, s[48:51], s56 offen nt lds
    s_add_u32 m0, s100, 49152
    s_add_u32 s56, s57, 2654208
    buffer_load_dwordx4 v19, s[48:51], s56 offen nt lds
    s_add_u32 m0, s100, 57344
    s_add_u32 s56, s57, 3096576
    buffer_load_dwordx4 v19, s[48:51], s56 offen nt lds
    s_add_u32 m0, s100, 65536
    s_add_u32 s56, s57, 3538944
    buffer_load_dwordx4 v19, s[48:51], s56 offen nt lds
    v_lshrrev_b32 v12, 4, v0
    v_mul_u32_u24 v12, 18432, v12
    v_and_b32 v13, 15, v0
    v_lshl_add_u32 v22, v13, 4, v12
    s_mul_i32 s57, s99, 57
    s_lshr_b32 s57, s57, 9
    s_mul_i32 s58, s57, 9
    s_sub_u32 s58, s99, s58
    s_mul_i32 s59, s57, 73728
    s_lshl_b32 s58, s58, 8
    s_add_u32 s59, s59, s58
    s_mul_i32 s58, s3, 2304
    s_add_u32 s59, s59, s58
    s_add_u32 s59, s59, 0x1000
    s_mov_b32 s58, 0
    s_cmp_eq_u32 s57, 1
    s_cselect_b32 s58, 1.0, s58
    s_cmp_eq_u32 s57, 4
    s_cselect_b32 s58, 1.0, s58
    s_waitcnt vmcnt(9)
    v_lshlrev_b32 v236, 16, v246
    v_and_b32 v237, 0xffff0000, v246
    v_max_f32 v236, 0xc2ae0000, v236
    v_min_f32 v242, 0x43000000, v236
    v_mul_f32 v238, 0xbfb8aa3b, v242
    v_fma_f32 v240, v242, s98, -v238
    v_fmac_f32 v240, 0xb2a57060, v242
    v_exp_f32 v238, v238
    v_mul_f32 v240, 0x3f317218, v240
    v_fmac_f32 v238, v238, v240
    v_add_f32 v238, 1.0, v238
    v_rcp_f32 v240, v238
    s_nop 0
    v_mul_f32 v242, v236, v240
    v_fma_f32 v238, -v242, v238, v236
    v_fma_f32 v236, v238, v240, v242
    v_max_f32 v237, 0xc2ae0000, v237
    v_min_f32 v243, 0x43000000, v237
    v_mul_f32 v239, 0xbfb8aa3b, v243
    v_fma_f32 v241, v243, s98, -v239
    v_fmac_f32 v241, 0xb2a57060, v243
    v_exp_f32 v239, v239
    v_mul_f32 v241, 0x3f317218, v241
    v_fmac_f32 v239, v239, v241
    v_add_f32 v239, 1.0, v239
    v_rcp_f32 v241, v239
    s_nop 0
    v_mul_f32 v243, v237, v241
    v_fma_f32 v239, -v243, v239, v237
    v_fma_f32 v237, v239, v241, v243
    v_cvt_pk_bf16_f32 v246, v236, v237
    v_lshlrev_b32 v236, 16, v247
    v_and_b32 v237, 0xffff0000, v247
    v_max_f32 v236, 0xc2ae0000, v236
    v_min_f32 v242, 0x43000000, v236
    v_mul_f32 v238, 0xbfb8aa3b, v242
    v_fma_f32 v240, v242, s98, -v238
    v_fmac_f32 v240, 0xb2a57060, v242
    v_exp_f32 v238, v238
    v_mul_f32 v240, 0x3f317218, v240
    v_fmac_f32 v238, v238, v240
    v_add_f32 v238, 1.0, v238
    v_rcp_f32 v240, v238
    s_nop 0
    v_mul_f32 v242, v236, v240
    v_fma_f32 v238, -v242, v238, v236
    v_fma_f32 v236, v238, v240, v242
    v_max_f32 v237, 0xc2ae0000, v237
    v_min_f32 v243, 0x43000000, v237
    v_mul_f32 v239, 0xbfb8aa3b, v243
    v_fma_f32 v241, v243, s98, -v239
    v_fmac_f32 v241, 0xb2a57060, v243
    v_exp_f32 v239, v239
    v_mul_f32 v241, 0x3f317218, v241
    v_fmac_f32 v239, v239, v241
    v_add_f32 v239, 1.0, v239
    v_rcp_f32 v241, v239
    s_nop 0
    v_mul_f32 v243, v237, v241
    v_fma_f32 v239, -v243, v239, v237
    v_fma_f32 v237, v239, v241, v243
    v_cvt_pk_bf16_f32 v247, v236, v237
    v_lshlrev_b32 v236, 16, v248
    v_and_b32 v237, 0xffff0000, v248
    v_max_f32 v236, 0xc2ae0000, v236
    v_min_f32 v242, 0x43000000, v236
    v_mul_f32 v238, 0xbfb8aa3b, v242
    v_fma_f32 v240, v242, s98, -v238
    v_fmac_f32 v240, 0xb2a57060, v242
    v_exp_f32 v238, v238
    v_mul_f32 v240, 0x3f317218, v240
    v_fmac_f32 v238, v238, v240
    v_add_f32 v238, 1.0, v238
    v_rcp_f32 v240, v238
    s_nop 0
    v_mul_f32 v242, v236, v240
    v_fma_f32 v238, -v242, v238, v236
    v_fma_f32 v236, v238, v240, v242
    v_max_f32 v237, 0xc2ae0000, v237
    v_min_f32 v243, 0x43000000, v237
    v_mul_f32 v239, 0xbfb8aa3b, v243
    v_fma_f32 v241, v243, s98, -v239
    v_fmac_f32 v241, 0xb2a57060, v243
    v_exp_f32 v239, v239
    v_mul_f32 v241, 0x3f317218, v241
    v_fmac_f32 v239, v239, v241
    v_add_f32 v239, 1.0, v239
    v_rcp_f32 v241, v239
    s_nop 0
    v_mul_f32 v243, v237, v241
    v_fma_f32 v239, -v243, v239, v237
    v_fma_f32 v237, v239, v241, v243
    v_cvt_pk_bf16_f32 v248, v236, v237
    v_lshlrev_b32 v236, 16, v249
    v_and_b32 v237, 0xffff0000, v249
    v_max_f32 v236, 0xc2ae0000, v236
    v_min_f32 v242, 0x43000000, v236
    v_mul_f32 v238, 0xbfb8aa3b, v242
    v_fma_f32 v240, v242, s98, -v238
    v_fmac_f32 v240, 0xb2a57060, v242
    v_exp_f32 v238, v238
    v_mul_f32 v240, 0x3f317218, v240
    v_fmac_f32 v238, v238, v240
    v_add_f32 v238, 1.0, v238
    v_rcp_f32 v240, v238
    s_nop 0
    v_mul_f32 v242, v236, v240
    v_fma_f32 v238, -v242, v238, v236
    v_fma_f32 v236, v238, v240, v242
    v_max_f32 v237, 0xc2ae0000, v237
    v_min_f32 v243, 0x43000000, v237
    v_mul_f32 v239, 0xbfb8aa3b, v243
    v_fma_f32 v241, v243, s98, -v239
    v_fmac_f32 v241, 0xb2a57060, v243
    v_exp_f32 v239, v239
    v_mul_f32 v241, 0x3f317218, v241
    v_fmac_f32 v239, v239, v241
    v_add_f32 v239, 1.0, v239
    v_rcp_f32 v241, v239
    s_nop 0
    v_mul_f32 v243, v237, v241
    v_fma_f32 v239, -v243, v239, v237
    v_fma_f32 v237, v239, v241, v243
    v_cvt_pk_bf16_f32 v249, v236, v237
    v_lshlrev_b32 v236, 16, v250
    v_and_b32 v237, 0xffff0000, v250
    v_max_f32 v236, 0xc2ae0000, v236
    v_min_f32 v242, 0x43000000, v236
    v_mul_f32 v238, 0xbfb8aa3b, v242
    s_branch .Lsk_m0_5
.Lst_m0_5:
    s_branch .Lrt_m0_5
.Lsk_m0_5:
    v_fma_f32 v240, v242, s98, -v238
    v_fmac_f32 v240, 0xb2a57060, v242
    v_exp_f32 v238, v238
    v_mul_f32 v240, 0x3f317218, v240
    v_fmac_f32 v238, v238, v240
    v_add_f32 v238, 1.0, v238
    v_rcp_f32 v240, v238
    s_nop 0
    v_mul_f32 v242, v236, v240
    v_fma_f32 v238, -v242, v238, v236
    v_fma_f32 v236, v238, v240, v242
    v_max_f32 v237, 0xc2ae0000, v237
    v_min_f32 v243, 0x43000000, v237
    v_mul_f32 v239, 0xbfb8aa3b, v243
    v_fma_f32 v241, v243, s98, -v239
    v_fmac_f32 v241, 0xb2a57060, v243
    v_exp_f32 v239, v239
    v_mul_f32 v241, 0x3f317218, v241
    v_fmac_f32 v239, v239, v241
    v_add_f32 v239, 1.0, v239
    v_rcp_f32 v241, v239
    s_nop 0
    v_mul_f32 v243, v237, v241
    v_fma_f32 v239, -v243, v239, v237
    v_fma_f32 v237, v239, v241, v243
    v_cvt_pk_bf16_f32 v250, v236, v237
    ds_write_b64 v17, v[246:247] offset:0
    ds_write_b64 v17, v[248:249] offset:512
    ds_write_b32 v18, v250 offset:0
    s_waitcnt vmcnt(3)
    s_add_u32 s63, s69, 147456
    buffer_load_dwordx4 v[72:75], v1, s[40:43], s63 offen nt
    s_waitcnt vmcnt(3)
    s_add_u32 s63, s69, 155648
    buffer_load_dwordx4 v[76:79], v1, s[40:43], s63 offen nt
    s_waitcnt vmcnt(3)
    s_add_u32 s63, s69, 163840
    buffer_load_dwordx4 v[104:107], v1, s[40:43], s63 offen nt
    s_waitcnt vmcnt(3)
    s_add_u32 s63, s69, 172032
    buffer_load_dwordx4 v[108:111], v1, s[40:43], s63 offen nt
    s_waitcnt vmcnt(3)
    s_add_u32 s63, s69, 180224
    buffer_load_dwordx4 v[136:139], v1, s[40:43], s63 offen nt
    s_waitcnt vmcnt(3)
    s_add_u32 s63, s69, 188416
    buffer_load_dwordx4 v[140:143], v1, s[40:43], s63 offen nt
    s_waitcnt vmcnt(3)
    s_add_u32 s63, s69, 262144
    buffer_load_dwordx4 v[48:51], v1, s[40:43], s63 offen nt
    s_waitcnt vmcnt(3)
    s_add_u32 s63, s69, 270336
    buffer_load_dwordx4 v[52:55], v1, s[40:43], s63 offen nt
    s_waitcnt lgkmcnt(0)
    s_barrier
    ds_read_b64_tr_b16 v[160:161], v20 offset:0
    ds_read_b64_tr_b16 v[162:163], v20 offset:512
    ds_read_b64_tr_b16 v[164:165], v20 offset:8192
    ds_read_b64_tr_b16 v[166:167], v20 offset:8704
    ds_read_b64_tr_b16 v[168:169], v20 offset:16384
    ds_read_b64_tr_b16 v[170:171], v20 offset:16896
    ds_read_b64_tr_b16 v[172:173], v20 offset:24576
    ds_read_b64_tr_b16 v[174:175], v20 offset:25088
    ds_read_b64_tr_b16 v[176:177], v21 offset:0
    ds_read_b64_tr_b16 v[178:179], v21 offset:512
    ds_read_b64_tr_b16 v[180:181], v21 offset:8192
    ds_read_b64_tr_b16 v[182:183], v21 offset:8704
    ds_read_b64_tr_b16 v[184:185], v21 offset:16384
    ds_read_b64_tr_b16 v[186:187], v21 offset:16896
    ds_read_b64_tr_b16 v[188:189], v21 offset:24576
    ds_read_b64_tr_b16 v[190:191], v21 offset:25088
    ds_read_b64_tr_b16 v[192:193], v21 offset:32768
    ds_read_b64_tr_b16 v[194:195], v21 offset:33280
    ds_read_b128 v[196:199], v16 offset:0
    ds_read_b128 v[200:203], v16 offset:128
    ds_read_b128 v[204:207], v16 offset:256
    ds_read_b128 v[208:211], v16 offset:384
    ds_read_b128 v[212:215], v16 offset:512
    ds_read_b128 v[216:219], v16 offset:640
    ds_read_b128 v[220:223], v16 offset:768
    ds_read_b128 v[224:227], v16 offset:896
    ds_read_b128 v[228:231], v16 offset:1024
    s_waitcnt lgkmcnt(8)
    v_mfma_f32_16x16x32_bf16 v[232:235], v[160:163], v[196:199], 0
    s_waitcnt lgkmcnt(7)
    v_mfma_f32_16x16x32_bf16 v[232:235], v[164:167], v[200:203], v[232:235]
    s_waitcnt lgkmcnt(6)
    v_mfma_f32_16x16x32_bf16 v[232:235], v[168:171], v[204:207], v[232:235]
    s_waitcnt lgkmcnt(5)
    v_mfma_f32_16x16x32_bf16 v[232:235], v[172:175], v[208:211], v[232:235]
    s_waitcnt lgkmcnt(4)
    v_mfma_f32_16x16x32_bf16 v[232:235], v[176:179], v[212:215], v[232:235]
    s_waitcnt lgkmcnt(3)
    v_mfma_f32_16x16x32_bf16 v[232:235], v[180:183], v[216:219], v[232:235]
    s_waitcnt lgkmcnt(2)
    v_mfma_f32_16x16x32_bf16 v[232:235], v[184:187], v[220:223], v[232:235]
    s_waitcnt lgkmcnt(1)
    v_mfma_f32_16x16x32_bf16 v[232:235], v[188:191], v[224:227], v[232:235]
    s_waitcnt lgkmcnt(0)
    v_mfma_f32_16x16x32_bf16 v[232:235], v[192:195], v[228:231], v[232:235]
    s_nop 7
    v_permlane32_swap_b32 v232, v234
    v_permlane32_swap_b32 v233, v235
    v_cndmask_b32 v233, v233, v234, s[96:97]
    v_cndmask_b32 v232, v232, v235, s[96:97]
    s_nop 1
    v_add_f32_dpp v236, v233, v232 quad_perm:[1,0,3,2] row_mask:0xf bank_mask:0xf
    v_cvt_pk_bf16_f32 v236, v236, v236
    v_lshlrev_b32 v236, 16, v236
    v_add_f32 v236, s58, v236
    v_cvt_pk_bf16_f32 v236, v236, v236
    ds_write_b16 v23, v236
    v_mov_b32 v243, s34
    s_waitcnt lgkmcnt(0)
    s_barrier
    ds_read2_b32 v[244:245], v24 offset1:1
    v_mov_b32 v241, s34
    s_waitcnt lgkmcnt(0)
    v_mov_b32 v240, v244
    v_mov_b32 v242, v245
    s_bfm_b64 exec, 16, 0
    buffer_store_dwordx4 v[240:243], v22, s[36:39], s59 offen sc1
    s_mov_b64 exec, -1
.Le_done:
    v_and_b32 v8, 1, v0
    v_lshlrev_b32 v8, 8, v8
    v_and_b32 v9, 0x3c, v0
    v_lshl_add_u32 v9, v9, 2, v8
    v_add_u32 v7, v9, v8
    v_and_b32 v9, 0x3c, v0
    v_lshrrev_b32 v8, 4, v8
    v_and_b32 v9, 4, v0
    v_lshl_add_u32 v9, v9, 3, v8
    s_lshl_b32 s58, s66, 14
    s_lshl_b32 s59, s67, 10
    s_add_u32 s58, s58, s59
    s_add_u32 s58, s58, 0x70000
    s_lshl4_add_u32 s59, s66, s67
    s_lshl_b32 s59, s59, 7
    s_add_u32 s59, s59, 0x430000
    s_waitcnt vmcnt(3)
    s_bitcmp1_b64 s[14:15], 18
    s_cbranch_scc0 1
    s_waitcnt vmcnt(2)
    s_add_u32 s63, s69, 278528
    buffer_load_dwordx4 v[80:83], v1, s[40:43], s63 offen nt
    v_and_b32 v157, 7, v0
    v_lshlrev_b32 v157, 2, v157
    s_mov_b32 s63, 0x4a1000
    buffer_load_dword v156, v157, s[36:39], s63 offen
    s_cmp_eq_u32 s3, 0
    s_cbranch_scc1 .Lst_m1_0
    s_cmp_eq_u32 s3, 1
    s_cbranch_scc1 .Lst_m1_1
    s_cmp_eq_u32 s3, 2
    s_cbranch_scc1 .Lst_m1_2
    s_cmp_eq_u32 s3, 3
    s_cbranch_scc1 .Lst_m1_3
    s_cmp_eq_u32 s3, 4
    s_cbranch_scc1 .Lst_m1_4
    s_cmp_eq_u32 s3, 5
    s_cbranch_scc1 .Lst_m1_5
    s_cmp_eq_u32 s3, 6
    s_cbranch_scc1 .Lst_m1_6
    s_cmp_eq_u32 s3, 7
    s_cbranch_scc1 .Lst_m1_7
.Lrt_m1_0:
.Lrt_m1_1:
.Lrt_m1_2:
.Lrt_m1_3:
.Lrt_m1_4:
.Lrt_m1_5:
.Lrt_m1_6:
.Lrt_m1_7:
    s_memrealtime s[8:9]
    s_waitcnt lgkmcnt(0)
    s_sub_u32 s8, s8, s30
    s_cmpk_ge_u32 s8, 912
    s_cbranch_scc1 .ap_53
    s_waitcnt vmcnt(5)
    s_cmpk_ge_u32 s8, 812
    s_cbranch_scc1 .ap_53
    s_waitcnt vmcnt(4)
    s_bitcmp1_b64 s[14:15], 19
    s_cbranch_scc0 1
    s_waitcnt vmcnt(3)
    s_cmpk_ge_u32 s8, 692
    s_cbranch_scc1 .ap_53
    s_waitcnt vmcnt(2)
.ap_53:
    s_add_u32 s63, s69, 286720
    buffer_load_dwordx4 v[84:87], v1, s[40:43], s63 offen nt
    s_memrealtime s[8:9]
    s_waitcnt lgkmcnt(0)
    s_sub_u32 s8, s8, s30
    s_cmpk_ge_u32 s8, 957
    s_cbranch_scc1 .ap_54
    s_waitcnt vmcnt(6)
    s_cmpk_ge_u32 s8, 857
    s_cbranch_scc1 .ap_54
    s_waitcnt vmcnt(4)
    s_bitcmp1_b64 s[14:15], 20
    s_cbranch_scc0 1
    s_waitcnt vmcnt(3)
    s_cmpk_ge_u32 s8, 737
    s_cbranch_scc1 .ap_54
    s_waitcnt vmcnt(2)
.ap_54:
    s_add_u32 s63, s69, 294912
    buffer_load_dwordx4 v[112:115], v1, s[40:43], s63 offen nt
    s_memrealtime s[8:9]
    s_waitcnt lgkmcnt(0)
    s_sub_u32 s8, s8, s30
    s_cmpk_ge_u32 s8, 1002
    s_cbranch_scc1 .ap_55
    s_waitcnt vmcnt(6)
    s_cmpk_ge_u32 s8, 902
    s_cbranch_scc1 .ap_55
    s_waitcnt vmcnt(4)
    s_bitcmp1_b64 s[14:15], 21
    s_cbranch_scc0 1
    s_waitcnt vmcnt(3)
    s_cmpk_ge_u32 s8, 782
    s_cbranch_scc1 .ap_55
    s_waitcnt vmcnt(1)
.ap_55:
    s_add_u32 s63, s69, 303104
    buffer_load_dwordx4 v[116:119], v1, s[40:43], s63 offen nt
    s_memrealtime s[8:9]
    s_waitcnt lgkmcnt(0)
    s_sub_u32 s8, s8, s30
    s_cmpk_ge_u32 s8, 1048
    s_cbranch_scc1 .ap_56
    s_waitcnt vmcnt(6)
    s_cmpk_ge_u32 s8, 948
    s_cbranch_scc1 .ap_56
    s_waitcnt vmcnt(4)
    s_bitcmp1_b64 s[14:15], 22
    s_cbranch_scc0 1
    s_waitcnt vmcnt(2)
    s_cmpk_ge_u32 s8, 828
    s_cbranch_scc1 .ap_56
    s_waitcnt vmcnt(1)
.ap_56:
    s_add_u32 s63, s69, 311296
    buffer_load_dwordx4 v[144:147], v1, s[40:43], s63 offen nt
    s_waitcnt vmcnt(4)
    s_sub_u32 s63, s70, 300
    v_subrev_u32 v156, s63, v156
    v_mov_b32 v157, 600
    v_cmp_lt_u32 s[8:9], v156, v157
    v_add_u32_dpp v156, v156, v156 quad_perm:[1,0,3,2] row_mask:0xf bank_mask:0xf
    s_nop 1
    v_add_u32_dpp v156, v156, v156 quad_perm:[2,3,0,1] row_mask:0xf bank_mask:0xf
    s_nop 1
    v_add_u32_dpp v156, v156, v156 row_ror:4 row_mask:0xf bank_mask:0xf
    s_nop 0
    v_readfirstlane_b32 s63, v156
    s_cmp_eq_u64 s[8:9], -1
    s_nop 3
    s_cbranch_scc0 .et_57
    s_lshr_b32 s63, s63, 3
    s_sub_u32 s63, s63, 300
    s_add_u32 s30, s30, s63
    s_add_u32 s31, s31, s63
.et_57:
    s_memrealtime s[8:9]
    s_waitcnt lgkmcnt(0)
    s_sub_u32 s8, s8, s30
    s_cmpk_ge_u32 s8, 1093
    s_cbranch_scc1 .ap_58
    s_waitcnt vmcnt(4)
    s_cmpk_ge_u32 s8, 993
    s_cbranch_scc1 .ap_58
    s_waitcnt vmcnt(3)
    s_bitcmp1_b64 s[14:15], 23
    s_cbranch_scc0 1
    s_waitcnt vmcnt(2)
    s_cmpk_ge_u32 s8, 873
    s_cbranch_scc1 .ap_58
    s_waitcnt vmcnt(1)
.ap_58:
    s_add_u32 s63, s69, 319488
    buffer_load_dwordx4 v[148:151], v1, s[40:43], s63 offen nt
    s_memrealtime s[8:9]
    s_waitcnt lgkmcnt(0)
    s_sub_u32 s8, s8, s30
    s_cmpk_ge_u32 s8, 1138
    s_cbranch_scc1 .ap_59
    s_waitcnt vmcnt(5)
    s_cmpk_ge_u32 s8, 1038
    s_cbranch_scc1 .ap_59
    s_waitcnt vmcnt(3)
    s_bitcmp1_b64 s[14:15], 24
    s_cbranch_scc0 1
    s_waitcnt vmcnt(2)
    s_cmpk_ge_u32 s8, 918
    s_cbranch_scc1 .ap_59
    s_waitcnt vmcnt(1)
.ap_59:
    s_add_u32 s63, s69, 393216
    buffer_load_dwordx4 v[56:59], v1, s[40:43], s63 offen nt
    s_memrealtime s[8:9]
    s_waitcnt lgkmcnt(0)
    s_sub_u32 s8, s8, s30
    s_cmpk_ge_u32 s8, 1184
    s_cbranch_scc1 .ap_60
    s_waitcnt vmcnt(5)
    s_cmpk_ge_u32 s8, 1084
    s_cbranch_scc1 .ap_60
    s_waitcnt vmcnt(3)
    s_bitcmp1_b64 s[14:15], 25
    s_cbranch_scc0 1
    s_waitcnt vmcnt(2)
    s_cmpk_ge_u32 s8, 964
    s_cbranch_scc1 .ap_60
    s_waitcnt vmcnt(1)
.ap_60:
    s_add_u32 s63, s69, 401408
    buffer_load_dwordx4 v[60:63], v1, s[40:43], s63 offen nt
    s_memrealtime s[8:9]
    s_waitcnt lgkmcnt(0)
    s_sub_u32 s8, s8, s30
    s_cmpk_ge_u32 s8, 1211
    s_cbranch_scc1 .ap_61
    s_waitcnt vmcnt(5)
    s_cmpk_ge_u32 s8, 1111
    s_cbranch_scc1 .ap_61
    s_waitcnt vmcnt(3)
    s_bitcmp1_b64 s[14:15], 26
    s_cbranch_scc0 1
    s_waitcnt vmcnt(2)
    s_cmpk_ge_u32 s8, 991
    s_cbranch_scc1 .ap_61
    s_waitcnt vmcnt(1)
.ap_61:
    s_add_u32 s63, s69, 409600
    buffer_load_dwordx4 v[88:91], v1, s[40:43], s63 offen nt
    s_memrealtime s[8:9]
    s_waitcnt lgkmcnt(0)
    s_sub_u32 s8, s8, s30
    s_cmpk_ge_u32 s8, 1238
    s_cbranch_scc1 .ap_62
    s_waitcnt vmcnt(5)
    s_cmpk_ge_u32 s8, 1138
    s_cbranch_scc1 .ap_62
    s_waitcnt vmcnt(3)
    s_bitcmp1_b64 s[14:15], 27
    s_cbranch_scc0 1
    s_waitcnt vmcnt(2)
    s_cmpk_ge_u32 s8, 1018
    s_cbranch_scc1 .ap_62
    s_waitcnt vmcnt(1)
.ap_62:
    s_add_u32 s63, s69, 417792
    buffer_load_dwordx4 v[92:95], v1, s[40:43], s63 offen nt
    s_memrealtime s[8:9]
    s_waitcnt vmcnt(8)
    s_waitcnt lgkmcnt(0)
    s_sub_u32 s8, s8, s30
    s_branch .Lsk_m1_0
.Lst_m1_0:
    s_branch .Lrt_m1_0
.Lsk_m1_0:
    s_cmpk_ge_u32 s8, 1265
    s_cbranch_scc1 .ap_63
    s_waitcnt vmcnt(5)
    s_cmpk_ge_u32 s8, 1165
    s_cbranch_scc1 .ap_63
    s_waitcnt vmcnt(3)
    s_bitcmp1_b64 s[14:15], 28
    s_cbranch_scc0 1
    s_waitcnt vmcnt(2)
    s_cmpk_ge_u32 s8, 1045
    s_cbranch_scc1 .ap_63
    s_waitcnt vmcnt(1)
.ap_63:
    s_add_u32 s63, s69, 425984
    s_branch .Lsk_m1_1
.Lst_m1_1:
    s_branch .Lrt_m1_1
.Lsk_m1_1:
    buffer_load_dwordx4 v[120:123], v1, s[40:43], s63 offen nt
    s_memrealtime s[8:9]
    s_waitcnt vmcnt(8)
    s_waitcnt lgkmcnt(0)
    s_sub_u32 s8, s8, s30
    s_cmpk_ge_u32 s8, 1292
    s_cbranch_scc1 .ap_64
    s_waitcnt vmcnt(5)
    s_cmpk_ge_u32 s8, 1192
    s_cbranch_scc1 .ap_64
    s_waitcnt vmcnt(3)
    s_bitcmp1_b64 s[14:15], 29
    s_cbranch_scc0 1
    s_waitcnt vmcnt(2)
    s_cmpk_ge_u32 s8, 1072
    s_cbranch_scc1 .ap_64
    s_waitcnt vmcnt(1)
.ap_64:
    s_add_u32 s63, s69, 434176
    buffer_load_dwordx4 v[124:127], v1, s[40:43], s63 offen nt
    s_memrealtime s[8:9]
    s_waitcnt vmcnt(8)
    s_waitcnt lgkmcnt(0)
    s_sub_u32 s8, s8, s30
    s_cmpk_ge_u32 s8, 1320
    s_cbranch_scc1 .ap_65
    s_waitcnt vmcnt(5)
    s_cmpk_ge_u32 s8, 1220
    s_cbranch_scc1 .ap_65
    s_waitcnt vmcnt(3)
    s_bitcmp1_b64 s[14:15], 30
    s_cbranch_scc0 1
    s_waitcnt vmcnt(2)
    s_cmpk_ge_u32 s8, 1100
    s_cbranch_scc1 .ap_65
    s_waitcnt vmcnt(1)
.ap_65:
    s_add_u32 s63, s69, 442368
    buffer_load_dwordx4 v[152:155], v1, s[40:43], s63 offen nt
    s_memrealtime s[8:9]
    s_waitcnt vmcnt(8)
    s_waitcnt lgkmcnt(0)
    s_sub_u32 s8, s8, s30
    s_cmpk_ge_u32 s8, 1347
    s_cbranch_scc1 .ap_66
    s_waitcnt vmcnt(5)
    s_cmpk_ge_u32 s8, 1247
    s_cbranch_scc1 .ap_66
    s_waitcnt vmcnt(3)
    s_bitcmp1_b64 s[14:15], 31
    s_cbranch_scc0 1
    s_waitcnt vmcnt(2)
    s_cmpk_ge_u32 s8, 1127
    s_cbranch_scc1 .ap_66
    s_waitcnt vmcnt(1)
.ap_66:
    s_add_u32 s63, s69, 450560
    buffer_load_dwordx4 v[156:159], v1, s[40:43], s63 offen nt
    buffer_load_dwordx4 v[16:19], v7, s[36:39], s58 offen offset:0 sc1
    buffer_load_dwordx4 v[20:23], v7, s[36:39], s58 offen offset:256 sc1
    s_memrealtime s[8:9]
    s_waitcnt vmcnt(8)
    s_waitcnt lgkmcnt(0)
    s_sub_u32 s8, s8, s30
    s_cmpk_ge_u32 s8, 1374
    s_cbranch_scc1 .ap_67
    s_waitcnt vmcnt(5)
    s_cmpk_ge_u32 s8, 1274
    s_cbranch_scc1 .ap_67
    s_waitcnt vmcnt(3)
    s_bitcmp1_b64 s[14:15], 32
    s_cbranch_scc0 1
    s_waitcnt vmcnt(2)
    s_cmpk_ge_u32 s8, 1154
    s_cbranch_scc1 .ap_67
    s_waitcnt vmcnt(1)
.ap_67:
    v_bfe_u32 v1, v0, 4, 2
    v_and_b32 v10, 0xf0, v2
    v_lshlrev_b32 v1, 2, v1
    v_bfe_u32 v1, s6, v1, 4
    v_lshl_add_u32 v1, v1, 8, v10
    s_add_u32 s63, s69, 0
    buffer_load_dwordx4 v[160:163], v1, s[44:47], s63 offen nt
    s_memrealtime s[8:9]
    s_waitcnt vmcnt(8)
    s_waitcnt lgkmcnt(0)
    s_sub_u32 s8, s8, s30
    s_cmpk_ge_u32 s8, 1401
    s_cbranch_scc1 .ap_68
    s_waitcnt vmcnt(5)
    s_cmpk_ge_u32 s8, 1301
    s_cbranch_scc1 .ap_68
    s_waitcnt vmcnt(3)
    s_bitcmp1_b64 s[14:15], 33
    s_cbranch_scc0 1
    s_waitcnt vmcnt(2)
    s_cmpk_ge_u32 s8, 1181
    s_cbranch_scc1 .ap_68
    s_waitcnt vmcnt(1)
.ap_68:
    s_add_u32 s63, s69, 8192
    buffer_load_dwordx4 v[164:167], v1, s[44:47], s63 offen nt
    s_memrealtime s[8:9]
    s_waitcnt vmcnt(8)
    s_waitcnt lgkmcnt(0)
    s_sub_u32 s8, s8, s30
    s_cmpk_ge_u32 s8, 1428
    s_cbranch_scc1 .ap_69
    s_waitcnt vmcnt(5)
    s_cmpk_ge_u32 s8, 1328
    s_cbranch_scc1 .ap_69
    s_waitcnt vmcnt(3)
    s_bitcmp1_b64 s[14:15], 34
    s_cbranch_scc0 1
    s_waitcnt vmcnt(2)
    s_cmpk_ge_u32 s8, 1208
    s_cbranch_scc1 .ap_69
    s_waitcnt vmcnt(1)
.ap_69:
    s_add_u32 s63, s69, 16384
    buffer_load_dwordx4 v[168:171], v1, s[44:47], s63 offen nt
    s_waitcnt vmcnt(3)
    s_branch .gpc_71
.gp_70:
    buffer_load_dwordx4 v[16:19], v7, s[36:39], s58 offen offset:0 sc1
    buffer_load_dwordx4 v[20:23], v7, s[36:39], s58 offen offset:256 sc1
    s_waitcnt vmcnt(0)
.gpc_71:
    v_min_u32 v10, v17, v19
    v_max_u32 v11, v17, v19
    v_min3_u32 v10, v10, v21, v23
    v_max3_u32 v11, v11, v21, v23
    v_cmp_eq_u32 vcc, s34, v10
    v_cmp_eq_u32 s[56:57], s34, v11
    s_and_b64 vcc, vcc, s[56:57]
    s_cmp_eq_u64 vcc, -1
    s_nop 2
    s_cbranch_scc1 .gpd_72
    s_sub_u32 s35, s35, 1
    s_cbranch_scc1 .Lexit
    s_sleep 1
    s_branch .gp_70
.gpd_72:
    s_mov_b32 vcc_lo, 0xcccccccc
    s_mov_b32 vcc_hi, 0xcccccccc
    v_cndmask_b32_e64 v24, v16, 0, vcc
    v_cndmask_b32_e64 v25, v18, 0, vcc
    v_cndmask_b32_e64 v26, v20, 0, vcc
    v_cndmask_b32_e64 v27, v22, 0, vcc
    v_cndmask_b32_e32 v28, 0, v16, vcc
    v_cndmask_b32_e32 v29, 0, v18, vcc
    v_cndmask_b32_e32 v30, 0, v20, vcc
    v_cndmask_b32_e32 v31, 0, v22, vcc
    v_mfma_f32_16x16x32_bf16 v[16:19], v[32:35], v[24:27], 0
    v_mfma_f32_16x16x32_bf16 v[32:35], v[40:43], v[24:27], 0
    v_mfma_f32_16x16x32_bf16 v[16:19], v[36:39], v[28:31], v[16:19]
    v_mfma_f32_16x16x32_bf16 v[40:43], v[48:51], v[24:27], 0
    v_mfma_f32_16x16x32_bf16 v[32:35], v[44:47], v[28:31], v[32:35]
    v_mfma_f32_16x16x32_bf16 v[48:51], v[56:59], v[24:27], 0
    v_mfma_f32_16x16x32_bf16 v[40:43], v[52:55], v[28:31], v[40:43]
    v_mfma_f32_16x16x32_bf16 v[56:59], v[64:67], v[24:27], 0
    v_mfma_f32_16x16x32_bf16 v[48:51], v[60:63], v[28:31], v[48:51]
    s_nop 1
    v_add_f32_dpp v10, v17, v16 row_ror:12 row_mask:0xf bank_mask:0x1
    s_memrealtime s[8:9]
    s_waitcnt lgkmcnt(0)
    s_sub_u32 s8, s8, s30
    s_cmpk_ge_u32 s8, 1456
    s_nop 0
    s_cbranch_scc1 .ap_73
    s_waitcnt vmcnt(3)
    s_cmpk_ge_u32 s8, 1356
    s_cbranch_scc1 .ap_73
    s_waitcnt vmcnt(3)
    s_bitcmp1_b64 s[14:15], 35
    s_cbranch_scc0 1
    s_waitcnt vmcnt(2)
    s_cmpk_ge_u32 s8, 1236
    s_cbranch_scc1 .ap_73
    s_waitcnt vmcnt(1)
.ap_73:
    s_add_u32 s63, s69, 24576
    buffer_load_dwordx4 v[172:175], v1, s[44:47], s63 offen nt
    v_mfma_f32_16x16x32_bf16 v[64:67], v[72:75], v[24:27], 0
    v_mfma_f32_16x16x32_bf16 v[56:59], v[68:71], v[28:31], v[56:59]
    v_add_f32_dpp v11, v33, v32 row_ror:12 row_mask:0xf bank_mask:0x1
    v_add_f32_dpp v10, v18, v10 row_ror:8 row_mask:0xf bank_mask:0x1
    v_mfma_f32_16x16x32_bf16 v[72:75], v[80:83], v[24:27], 0
    v_mfma_f32_16x16x32_bf16 v[64:67], v[76:79], v[28:31], v[64:67]
    v_add_f32_dpp v12, v41, v40 row_ror:12 row_mask:0xf bank_mask:0x1
    v_add_f32_dpp v11, v34, v11 row_ror:8 row_mask:0xf bank_mask:0x1
    v_add_f32_dpp v10, v19, v10 row_ror:4 row_mask:0xf bank_mask:0x1
    v_mfma_f32_16x16x32_bf16 v[80:83], v[88:91], v[24:27], 0
    v_mfma_f32_16x16x32_bf16 v[72:75], v[84:87], v[28:31], v[72:75]
    v_add_f32_dpp v13, v49, v48 row_ror:12 row_mask:0xf bank_mask:0x1
    v_add_f32_dpp v12, v42, v12 row_ror:8 row_mask:0xf bank_mask:0x1
    v_add_f32_dpp v11, v35, v11 row_ror:4 row_mask:0xf bank_mask:0x1
    v_mfma_f32_16x16x32_bf16 v[88:91], v[96:99], v[24:27], 0
    v_mfma_f32_16x16x32_bf16 v[80:83], v[92:95], v[28:31], v[80:83]
    v_add_f32_dpp v10, v58, v57 row_ror:12 row_mask:0xf bank_mask:0x2
    v_add_f32_dpp v13, v50, v13 row_ror:8 row_mask:0xf bank_mask:0x1
    v_add_f32_dpp v12, v43, v12 row_ror:4 row_mask:0xf bank_mask:0x1
    s_memrealtime s[8:9]
    s_waitcnt lgkmcnt(0)
    s_sub_u32 s8, s8, s30
    s_cmpk_ge_u32 s8, 1486
    s_nop 0
    s_cbranch_scc1 .ap_74
    s_waitcnt vmcnt(4)
    s_cmpk_ge_u32 s8, 1386
    s_cbranch_scc1 .ap_74
    s_branch .Lsk_m1_2
.Lst_m1_2:
    s_branch .Lrt_m1_2
.Lsk_m1_2:
    s_waitcnt vmcnt(3)
    s_bitcmp1_b64 s[14:15], 36
    s_cbranch_scc0 1
    s_waitcnt vmcnt(2)
    s_cmpk_ge_u32 s8, 1266
    s_cbranch_scc1 .ap_74
    s_waitcnt vmcnt(1)
.ap_74:
    s_add_u32 s63, s69, 32768
    buffer_load_dwordx4 v[176:179], v1, s[44:47], s63 offen nt
    v_mfma_f32_16x16x32_bf16 v[96:99], v[104:107], v[24:27], 0
    v_mfma_f32_16x16x32_bf16 v[88:91], v[100:103], v[28:31], v[88:91]
    v_add_f32_dpp v11, v66, v65 row_ror:12 row_mask:0xf bank_mask:0x2
    v_add_f32_dpp v10, v59, v10 row_ror:8 row_mask:0xf bank_mask:0x2
    v_add_f32_dpp v13, v51, v13 row_ror:4 row_mask:0xf bank_mask:0x1
    v_mfma_f32_16x16x32_bf16 v[104:107], v[112:115], v[24:27], 0
    v_mfma_f32_16x16x32_bf16 v[96:99], v[108:111], v[28:31], v[96:99]
    v_add_f32_dpp v12, v74, v73 row_ror:12 row_mask:0xf bank_mask:0x2
    v_add_f32_dpp v11, v67, v11 row_ror:8 row_mask:0xf bank_mask:0x2
    v_add_f32_dpp v10, v56, v10 row_ror:4 row_mask:0xf bank_mask:0x2
    v_mfma_f32_16x16x32_bf16 v[112:115], v[120:123], v[24:27], 0
    v_mfma_f32_16x16x32_bf16 v[104:107], v[116:119], v[28:31], v[104:107]
    v_add_f32_dpp v13, v82, v81 row_ror:12 row_mask:0xf bank_mask:0x2
    v_add_f32_dpp v12, v75, v12 row_ror:8 row_mask:0xf bank_mask:0x2
    v_add_f32_dpp v11, v64, v11 row_ror:4 row_mask:0xf bank_mask:0x2
    v_mfma_f32_16x16x32_bf16 v[120:123], v[128:131], v[24:27], 0
    v_mfma_f32_16x16x32_bf16 v[112:115], v[124:127], v[28:31], v[112:115]
    v_add_f32_dpp v10, v91, v90 row_ror:12 row_mask:0xf bank_mask:0x4
    v_add_f32_dpp v13, v83, v13 row_ror:8 row_mask:0xf bank_mask:0x2
    v_add_f32_dpp v12, v72, v12 row_ror:4 row_mask:0xf bank_mask:0x2
    s_memrealtime s[8:9]
    s_waitcnt lgkmcnt(0)
    s_sub_u32 s8, s8, s30
    s_cmpk_ge_u32 s8, 1516
    s_nop 0
    s_cbranch_scc1 .ap_75
    s_waitcnt vmcnt(5)
    s_cmpk_ge_u32 s8, 1416
    s_cbranch_scc1 .ap_75
    s_waitcnt vmcnt(3)
    s_bitcmp1_b64 s[14:15], 37
    s_cbranch_scc0 1
    s_waitcnt vmcnt(2)
    s_cmpk_ge_u32 s8, 1296
    s_cbranch_scc1 .ap_75
    s_waitcnt vmcnt(1)
.ap_75:
    s_add_u32 s63, s69, 40960
    buffer_load_dwordx4 v[180:183], v1, s[44:47], s63 offen nt
    v_mfma_f32_16x16x32_bf16 v[128:131], v[136:139], v[24:27], 0
    v_mfma_f32_16x16x32_bf16 v[120:123], v[132:135], v[28:31], v[120:123]
    v_add_f32_dpp v11, v99, v98 row_ror:12 row_mask:0xf bank_mask:0x4
    v_add_f32_dpp v10, v88, v10 row_ror:8 row_mask:0xf bank_mask:0x4
    v_add_f32_dpp v13, v80, v13 row_ror:4 row_mask:0xf bank_mask:0x2
    v_mfma_f32_16x16x32_bf16 v[136:139], v[144:147], v[24:27], 0
    v_mfma_f32_16x16x32_bf16 v[128:131], v[140:143], v[28:31], v[128:131]
    v_add_f32_dpp v12, v107, v106 row_ror:12 row_mask:0xf bank_mask:0x4
    v_add_f32_dpp v11, v96, v11 row_ror:8 row_mask:0xf bank_mask:0x4
    v_add_f32_dpp v10, v89, v10 row_ror:4 row_mask:0xf bank_mask:0x4
    v_mfma_f32_16x16x32_bf16 v[144:147], v[152:155], v[24:27], 0
    v_mfma_f32_16x16x32_bf16 v[136:139], v[148:151], v[28:31], v[136:139]
    v_add_f32_dpp v13, v115, v114 row_ror:12 row_mask:0xf bank_mask:0x4
    v_add_f32_dpp v12, v104, v12 row_ror:8 row_mask:0xf bank_mask:0x4
    v_add_f32_dpp v11, v97, v11 row_ror:4 row_mask:0xf bank_mask:0x4
    v_mfma_f32_16x16x32_bf16 v[144:147], v[156:159], v[28:31], v[144:147]
    v_add_f32_dpp v10, v120, v123 row_ror:12 row_mask:0xf bank_mask:0x8
    v_add_f32_dpp v13, v112, v13 row_ror:8 row_mask:0xf bank_mask:0x4
    v_add_f32_dpp v12, v105, v12 row_ror:4 row_mask:0xf bank_mask:0x4
    s_memrealtime s[8:9]
    s_waitcnt lgkmcnt(0)
    s_sub_u32 s8, s8, s30
    s_cmpk_ge_u32 s8, 1546
    s_nop 0
    s_cbranch_scc1 .ap_76
    s_waitcnt vmcnt(5)
    s_cmpk_ge_u32 s8, 1446
    s_cbranch_scc1 .ap_76
    s_waitcnt vmcnt(3)
    s_bitcmp1_b64 s[14:15], 38
    s_cbranch_scc0 1
    s_waitcnt vmcnt(2)
    s_cmpk_ge_u32 s8, 1326
    s_cbranch_scc1 .ap_76
    s_waitcnt vmcnt(1)
.ap_76:
    s_add_u32 s63, s69, 49152
    buffer_load_dwordx4 v[184:187], v1, s[44:47], s63 offen nt
    v_add_f32_dpp v11, v128, v131 row_ror:12 row_mask:0xf bank_mask:0x8
    v_add_f32_dpp v10, v121, v10 row_ror:8 row_mask:0xf bank_mask:0x8
    v_add_f32_dpp v13, v113, v13 row_ror:4 row_mask:0xf bank_mask:0x4
    v_add_f32_dpp v12, v136, v139 row_ror:12 row_mask:0xf bank_mask:0x8
    v_add_f32_dpp v11, v129, v11 row_ror:8 row_mask:0xf bank_mask:0x8
    v_add_f32_dpp v10, v122, v10 row_ror:4 row_mask:0xf bank_mask:0x8
    v_add_f32_dpp v13, v144, v147 row_ror:12 row_mask:0xf bank_mask:0x8
    v_add_f32_dpp v12, v137, v12 row_ror:8 row_mask:0xf bank_mask:0x8
    v_add_f32_dpp v11, v130, v11 row_ror:4 row_mask:0xf bank_mask:0x8
    v_add_f32_dpp v13, v145, v13 row_ror:8 row_mask:0xf bank_mask:0x8
    v_add_f32_dpp v12, v138, v12 row_ror:4 row_mask:0xf bank_mask:0x8
    s_memrealtime s[8:9]
    s_waitcnt lgkmcnt(0)
    s_sub_u32 s8, s8, s30
    s_cmpk_ge_u32 s8, 1576
    s_cbranch_scc1 .ap_77
    s_waitcnt vmcnt(5)
    s_cmpk_ge_u32 s8, 1476
    s_cbranch_scc1 .ap_77
    s_waitcnt vmcnt(3)
    s_bitcmp1_b64 s[14:15], 39
    s_cbranch_scc0 1
    s_waitcnt vmcnt(2)
    s_cmpk_ge_u32 s8, 1356
    s_cbranch_scc1 .ap_77
    s_waitcnt vmcnt(1)
.ap_77:
    s_add_u32 s63, s69, 57344
    buffer_load_dwordx4 v[188:191], v1, s[44:47], s63 offen nt
    v_add_f32_dpp v13, v146, v13 row_ror:4 row_mask:0xf bank_mask:0x8
    s_mov_b32 s60, 0x3db504f3
    s_mov_b32 s61, 0x3db504f3
    v_cvt_pk_bf16_f32 v10, v10, v11
    v_and_b32 v11, 0xffff0000, v10
    v_lshlrev_b32 v10, 16, v10
    v_cvt_pk_bf16_f32 v12, v12, v13
    v_and_b32 v13, 0xffff0000, v12
    v_lshlrev_b32 v12, 16, v12
    v_pk_mul_f32 v[10:11], v[10:11], s[60:61]
    v_pk_mul_f32 v[12:13], v[12:13], s[60:61]
    v_cvt_pk_bf16_f32 v10, v10, v11
    v_and_b32 v11, 0xffff0000, v10
    v_lshlrev_b32 v10, 16, v10
    v_cvt_pk_bf16_f32 v12, v12, v13
    v_and_b32 v13, 0xffff0000, v12
    v_lshlrev_b32 v12, 16, v12
    v_max_f32 v14, v10, v11
    v_max3_f32 v14, v14, v12, v13
    s_mov_b32 s60, 0x3fb8aa3b
    v_mov_b32 v22, s34
    v_mov_b32 v23, s34
    v_max_f32_dpp v14, v14, v14 quad_perm:[2,3,0,1] row_mask:0xf bank_mask:0xf
    s_nop 1
    v_max_f32_dpp v14, v14, v14 row_ror:4 row_mask:0xf bank_mask:0xf
    s_nop 1
    v_max_f32_dpp v14, v14, v14 row_ror:8 row_mask:0xf bank_mask:0xf
    v_mov_b32 v15, v14
    s_nop 1
    v_permlane16_swap_b32 v15, v14
    v_max_f32 v14, v15, v14
    v_mov_b32 v15, v14
    s_nop 1
    v_permlane32_swap_b32 v15, v14
    v_max_f32 v14, v15, v14
    v_mul_f32 v15, 0xbfb8aa3b, v14
    v_fma_f32 v10, v10, s60, v15
    v_fma_f32 v11, v11, s60, v15
    v_fma_f32 v12, v12, s60, v15
    v_fma_f32 v13, v13, s60, v15
    v_exp_f32 v10, v10
    v_exp_f32 v11, v11
    v_exp_f32 v12, v12
    v_exp_f32 v13, v13
    v_mov_b32 v20, v14
    v_pk_add_f32 v[16:17], v[10:11], v[12:13]
    v_add_f32 v21, v16, v17
    s_lshl_b32 s60, s68, 5
    s_lshl_b32 s61, s3, 4
    s_add_u32 s61, s61, 159104
    v_add_u32 v16, s61, v3
    v_mov_b32 v17, 159232
    v_mov_b32 v18, 1
    s_add_u32 s60, s60, s59
    v_add_f32_dpp v21, v21, v21 quad_perm:[2,3,0,1] row_mask:0xf bank_mask:0xf
    s_nop 1
    v_add_f32_dpp v21, v21, v21 row_ror:4 row_mask:0xf bank_mask:0xf
    s_nop 1
    v_add_f32_dpp v21, v21, v21 row_ror:8 row_mask:0xf bank_mask:0xf
    v_mov_b32 v15, v21
    s_nop 1
    v_permlane16_swap_b32 v15, v21
    v_add_f32 v21, v15, v21
    v_mov_b32 v15, v21
    s_nop 1
    v_permlane32_swap_b32 v15, v21
    v_add_f32 v21, v15, v21
    s_mov_b64 exec, 3
    s_branch .Lsk_m1_3
.Lst_m1_3:
    s_branch .Lrt_m1_3
.Lsk_m1_3:
    ds_write_b64 v16, v[20:21]
    s_mov_b64 exec, 1
    ds_add_rtn_u32 v18, v17, v18
    s_mov_b64 exec, -1
    v_and_b32 v16, 0x78, v3
    v_or_b32 v16, 159104, v16
    s_waitcnt lgkmcnt(0)
    v_readfirstlane_b32 s61, v18
    s_cmp_eq_u32 s61, 7
    s_nop 3
    s_cbranch_scc0 .mlc_78
    ds_read_b64 v[18:19], v16
    s_waitcnt lgkmcnt(0)
    v_mov_b32 v20, v18
    s_nop 1
    v_max_f32_dpp v20, v20, v20 quad_perm:[2,3,0,1] row_mask:0xf bank_mask:0xf
    s_nop 1
    v_max_f32_dpp v20, v20, v20 row_ror:4 row_mask:0xf bank_mask:0xf
    s_nop 1
    v_max_f32_dpp v20, v20, v20 row_ror:8 row_mask:0xf bank_mask:0xf
    v_sub_f32 v18, v18, v20
    v_mul_f32 v18, 0x3fb8aa3b, v18
    v_exp_f32 v18, v18
    s_nop 0
    v_mul_f32 v21, v18, v19
    s_nop 1
    v_add_f32_dpp v21, v21, v21 quad_perm:[2,3,0,1] row_mask:0xf bank_mask:0xf
    s_nop 1
    v_add_f32_dpp v21, v21, v21 row_ror:4 row_mask:0xf bank_mask:0xf
    s_nop 1
    v_add_f32_dpp v21, v21, v21 row_ror:8 row_mask:0xf bank_mask:0xf
    s_mov_b64 exec, 3
    buffer_store_dwordx4 v[20:23], v2, s[36:39], s60 offen sc1
    s_mov_b64 exec, -1
.mlc_78:
    s_memrealtime s[8:9]
    s_waitcnt lgkmcnt(0)
    s_sub_u32 s8, s8, s30
    s_cmpk_ge_u32 s8, 1606
    s_cbranch_scc1 .ap_79
    s_waitcnt vmcnt(5)
    s_cmpk_ge_u32 s8, 1506
    s_cbranch_scc1 .ap_79
    s_waitcnt vmcnt(3)
    s_bitcmp1_b64 s[14:15], 40
    s_cbranch_scc0 1
    s_waitcnt vmcnt(2)
    s_cmpk_ge_u32 s8, 1386
    s_cbranch_scc1 .ap_79
    s_waitcnt vmcnt(1)
.ap_79:
    s_add_u32 s63, s69, 131072
    buffer_load_dwordx4 v[192:195], v1, s[44:47], s63 offen nt
    s_memrealtime s[8:9]
    s_waitcnt vmcnt(8)
    s_waitcnt lgkmcnt(0)
    s_sub_u32 s8, s8, s30
    s_cmpk_ge_u32 s8, 1636
    s_cbranch_scc1 .ap_80
    s_waitcnt vmcnt(5)
    s_cmpk_ge_u32 s8, 1536
    s_cbranch_scc1 .ap_80
    s_waitcnt vmcnt(3)
    s_bitcmp1_b64 s[14:15], 41
    s_cbranch_scc0 1
    s_waitcnt vmcnt(2)
    s_cmpk_ge_u32 s8, 1416
    s_cbranch_scc1 .ap_80
    s_waitcnt vmcnt(1)
.ap_80:
    s_add_u32 s63, s69, 139264
    buffer_load_dwordx4 v[196:199], v1, s[44:47], s63 offen nt
    s_memrealtime s[8:9]
    s_waitcnt vmcnt(8)
    s_waitcnt lgkmcnt(0)
    s_sub_u32 s8, s8, s30
    s_cmpk_ge_u32 s8, 1666
    s_cbranch_scc1 .ap_81
    s_waitcnt vmcnt(5)
    s_cmpk_ge_u32 s8, 1566
    s_cbranch_scc1 .ap_81
    s_waitcnt vmcnt(3)
    s_bitcmp1_b64 s[14:15], 42
    s_cbranch_scc0 1
    s_waitcnt vmcnt(2)
    s_cmpk_ge_u32 s8, 1446
    s_cbranch_scc1 .ap_81
    s_waitcnt vmcnt(1)
.ap_81:
    s_add_u32 s63, s69, 147456
    buffer_load_dwordx4 v[200:203], v1, s[44:47], s63 offen nt
    s_memrealtime s[8:9]
    s_waitcnt vmcnt(8)
    s_waitcnt lgkmcnt(0)
    s_sub_u32 s8, s8, s30
    s_cmpk_ge_u32 s8, 1696
    s_cbranch_scc1 .ap_82
    s_waitcnt vmcnt(5)
    s_cmpk_ge_u32 s8, 1596
    s_cbranch_scc1 .ap_82
    s_waitcnt vmcnt(3)
    s_bitcmp1_b64 s[14:15], 43
    s_cbranch_scc0 1
    s_waitcnt vmcnt(2)
    s_cmpk_ge_u32 s8, 1476
    s_cbranch_scc1 .ap_82
    s_waitcnt vmcnt(1)
.ap_82:
    s_add_u32 s63, s69, 155648
    buffer_load_dwordx4 v[204:207], v1, s[44:47], s63 offen nt
    s_memrealtime s[8:9]
    s_waitcnt vmcnt(8)
    s_waitcnt lgkmcnt(0)
    s_sub_u32 s8, s8, s30
    s_cmpk_ge_u32 s8, 1726
    s_cbranch_scc1 .ap_83
    s_waitcnt vmcnt(5)
    s_cmpk_ge_u32 s8, 1626
    s_cbranch_scc1 .ap_83
    s_waitcnt vmcnt(3)
    s_bitcmp1_b64 s[14:15], 44
    s_cbranch_scc0 1
    s_waitcnt vmcnt(2)
    s_cmpk_ge_u32 s8, 1506
    s_cbranch_scc1 .ap_83
    s_waitcnt vmcnt(1)
.ap_83:
    s_add_u32 s63, s69, 163840
    buffer_load_dwordx4 v[208:211], v1, s[44:47], s63 offen nt
    s_cmp_eq_u32 s3, 0
    s_cbranch_scc1 .Lst_m2_0
    s_cmp_eq_u32 s3, 1
    s_cbranch_scc1 .Lst_m2_1
    s_cmp_eq_u32 s3, 2
    s_cbranch_scc1 .Lst_m2_2
    s_cmp_eq_u32 s3, 3
    s_cbranch_scc1 .Lrt_m2_3
.Lrt_m2_0:
.Lrt_m2_1:
.Lrt_m2_2:
.Lrt_m2_3:
    v_and_b32 v16, 8, v0
    v_and_b32 v17, 1, v0
    v_lshl_add_u32 v16, v17, 2, v16
    v_bfe_u32 v17, v0, 1, 2
    v_add_u32 v16, v16, v17
    v_lshrrev_b32 v17, 4, v0
    v_lshl_add_u32 v16, v16, 2, v17
    v_lshlrev_b32 v7, 1, v16
    v_and_b32 v8, 62, v16
    v_lshlrev_b32 v8, 2, v8
    s_mul_i32 s100, s3, 1152
    s_lshl_b32 s56, s65, 7
    s_add_u32 s100, s100, s56
    s_mov_b32 s52, s4
    s_and_b32 s53, s5, 0xffff
    s_mov_b32 s54, 0x2400
    s_mov_b32 s55, 0x00020000
    buffer_load_ushort v40, v7, s[52:55], s100 offen
    s_mov_b32 s48, s16
    s_and_b32 s49, s17, 0xffff
    s_mov_b32 s50, 0x480
    s_mov_b32 s51, 0x00020000
    buffer_load_dwordx2 v[48:49], v3, s[48:51], 0 offen
    buffer_load_dwordx2 v[50:51], v3, s[48:51], 0 offen offset:512
    buffer_load_dword v34, v4, s[48:51], 0 offen
    s_mov_b32 s48, s28
    s_and_b32 s49, s29, 0xffff
    s_mov_b32 s50, 0x2400
    s_mov_b32 s51, 0x00020000
    buffer_load_ushort v39, v7, s[48:51], s100 offen nt
    s_memrealtime s[8:9]
    s_waitcnt vmcnt(13)
    s_waitcnt lgkmcnt(0)
    s_sub_u32 s8, s8, s30
    s_cmpk_ge_u32 s8, 1756
    s_cbranch_scc1 .ap_84
    s_waitcnt vmcnt(10)
    s_cmpk_ge_u32 s8, 1656
    s_cbranch_scc1 .ap_84
    s_waitcnt vmcnt(8)
    s_bitcmp1_b64 s[14:15], 45
    s_cbranch_scc0 1
    s_waitcnt vmcnt(7)
    s_cmpk_ge_u32 s8, 1536
    s_cbranch_scc1 .ap_84
    s_waitcnt vmcnt(6)
.ap_84:
    s_add_u32 s63, s69, 172032
    buffer_load_dwordx4 v[212:215], v1, s[44:47], s63 offen nt
    s_memrealtime s[8:9]
    s_waitcnt vmcnt(13)
    s_waitcnt lgkmcnt(0)
    s_sub_u32 s8, s8, s30
    s_cmpk_ge_u32 s8, 1788
    s_cbranch_scc1 .ap_85
    s_waitcnt vmcnt(10)
    s_cmpk_ge_u32 s8, 1688
    s_cbranch_scc1 .ap_85
    s_waitcnt vmcnt(8)
    s_bitcmp1_b64 s[14:15], 46
    s_cbranch_scc0 1
    s_waitcnt vmcnt(7)
    s_cmpk_ge_u32 s8, 1568
    s_cbranch_scc1 .ap_85
    s_waitcnt vmcnt(6)
.ap_85:
    s_add_u32 s63, s69, 180224
    buffer_load_dwordx4 v[216:219], v1, s[44:47], s63 offen nt
    s_memrealtime s[8:9]
    s_waitcnt vmcnt(13)
    s_waitcnt lgkmcnt(0)
    s_sub_u32 s8, s8, s30
    s_cmpk_ge_u32 s8, 1820
    s_cbranch_scc1 .ap_86
    s_waitcnt vmcnt(10)
    s_cmpk_ge_u32 s8, 1720
    s_cbranch_scc1 .ap_86
    s_waitcnt vmcnt(8)
    s_bitcmp1_b64 s[14:15], 47
    s_cbranch_scc0 1
    s_waitcnt vmcnt(7)
    s_cmpk_ge_u32 s8, 1600
    s_cbranch_scc1 .ap_86
    s_waitcnt vmcnt(1)
.ap_86:
    s_add_u32 s63, s69, 188416
    buffer_load_dwordx4 v[220:223], v1, s[44:47], s63 offen nt
    s_branch .Lsk_m1_4
.Lst_m1_4:
    s_branch .Lrt_m1_4
.Lsk_m1_4:
    s_memrealtime s[8:9]
    s_waitcnt vmcnt(13)
    s_waitcnt lgkmcnt(0)
    s_sub_u32 s8, s8, s30
    s_cmpk_ge_u32 s8, 1852
    s_cbranch_scc1 .ap_87
    s_waitcnt vmcnt(10)
    s_cmpk_ge_u32 s8, 1752
    s_cbranch_scc1 .ap_87
    s_waitcnt vmcnt(8)
    s_bitcmp1_b64 s[14:15], 48
    s_cbranch_scc0 1
    s_waitcnt vmcnt(2)
    s_cmpk_ge_u32 s8, 1632
    s_cbranch_scc1 .ap_87
    s_waitcnt vmcnt(1)
.ap_87:
    s_add_u32 s63, s69, 262144
    buffer_load_dwordx4 v[224:227], v1, s[44:47], s63 offen nt
    s_memrealtime s[8:9]
    s_waitcnt vmcnt(13)
    s_waitcnt lgkmcnt(0)
    s_sub_u32 s8, s8, s30
    s_cmpk_ge_u32 s8, 1884
    s_cbranch_scc1 .ap_88
    s_waitcnt vmcnt(10)
    s_cmpk_ge_u32 s8, 1784
    s_cbranch_scc1 .ap_88
    s_waitcnt vmcnt(3)
    s_bitcmp1_b64 s[14:15], 49
    s_cbranch_scc0 1
    s_waitcnt vmcnt(2)
    s_cmpk_ge_u32 s8, 1664
    s_cbranch_scc1 .ap_88
    s_waitcnt vmcnt(1)
.ap_88:
    s_add_u32 s63, s69, 270336
    buffer_load_dwordx4 v[228:231], v1, s[44:47], s63 offen nt
    s_memrealtime s[8:9]
    s_waitcnt vmcnt(13)
    s_waitcnt lgkmcnt(0)
    s_sub_u32 s8, s8, s30
    s_cmpk_ge_u32 s8, 1916
    s_cbranch_scc1 .ap_89
    s_waitcnt vmcnt(10)
    s_cmpk_ge_u32 s8, 1816
    s_cbranch_scc1 .ap_89
    s_waitcnt vmcnt(3)
    s_bitcmp1_b64 s[14:15], 50
    s_cbranch_scc0 1
    s_waitcnt vmcnt(2)
    s_cmpk_ge_u32 s8, 1696
    s_cbranch_scc1 .ap_89
    s_waitcnt vmcnt(1)
.ap_89:
    s_add_u32 s63, s69, 278528
    buffer_load_dwordx4 v[232:235], v1, s[44:47], s63 offen nt
    s_memrealtime s[8:9]
    s_waitcnt vmcnt(13)
    s_waitcnt lgkmcnt(0)
    s_sub_u32 s8, s8, s30
    s_cmpk_ge_u32 s8, 1948
    s_cbranch_scc1 .ap_90
    s_waitcnt vmcnt(5)
    s_cmpk_ge_u32 s8, 1848
    s_cbranch_scc1 .ap_90
    s_waitcnt vmcnt(3)
    s_bitcmp1_b64 s[14:15], 51
    s_cbranch_scc0 1
    s_waitcnt vmcnt(2)
    s_cmpk_ge_u32 s8, 1728
    s_cbranch_scc1 .ap_90
    s_waitcnt vmcnt(1)
.ap_90:
    s_add_u32 s63, s69, 286720
    buffer_load_dwordx4 v[236:239], v1, s[44:47], s63 offen nt
    s_memrealtime s[8:9]
    s_waitcnt vmcnt(13)
    s_waitcnt lgkmcnt(0)
    s_sub_u32 s8, s8, s30
    s_cmpk_ge_u32 s8, 1980
    s_cbranch_scc1 .ap_91
    s_waitcnt vmcnt(5)
    s_cmpk_ge_u32 s8, 1880
    s_cbranch_scc1 .ap_91
    s_waitcnt vmcnt(3)
    s_bitcmp1_b64 s[14:15], 52
    s_cbranch_scc0 1
    s_waitcnt vmcnt(2)
    s_cmpk_ge_u32 s8, 1760
    s_cbranch_scc1 .ap_91
    s_waitcnt vmcnt(1)
.ap_91:
    s_add_u32 s63, s69, 294912
    buffer_load_dwordx4 v[240:243], v1, s[44:47], s63 offen nt
    s_memrealtime s[8:9]
    s_waitcnt vmcnt(13)
    s_waitcnt lgkmcnt(0)
    s_sub_u32 s8, s8, s30
    s_cmpk_ge_u32 s8, 2012
    s_cbranch_scc1 .ap_92
    s_waitcnt vmcnt(5)
    s_cmpk_ge_u32 s8, 1912
    s_cbranch_scc1 .ap_92
    s_waitcnt vmcnt(3)
    s_bitcmp1_b64 s[14:15], 53
    s_cbranch_scc0 1
    s_waitcnt vmcnt(2)
    s_cmpk_ge_u32 s8, 1792
    s_cbranch_scc1 .ap_92
    s_waitcnt vmcnt(1)
.ap_92:
    s_add_u32 s63, s69, 303104
    buffer_load_dwordx4 v[244:247], v1, s[44:47], s63 offen nt
    s_and_b32 s0, s0, 0xffffff80
    s_sub_u32 s0, s0, 1024
    buffer_load_dword v28, v4, s[36:39], s0 offen sc1
    buffer_load_dwordx4 v[24:27], v9, s[36:39], s59 offen offset:0 sc1
    s_memrealtime s[8:9]
    s_waitcnt vmcnt(9)
    s_waitcnt lgkmcnt(0)
    s_sub_u32 s8, s8, s30
    s_cmpk_ge_u32 s8, 2044
    s_cbranch_scc1 .ap_93
    s_waitcnt vmcnt(6)
    s_cmpk_ge_u32 s8, 1944
    s_cbranch_scc1 .ap_93
    s_waitcnt vmcnt(4)
    s_bitcmp1_b64 s[14:15], 54
    s_cbranch_scc0 1
    s_waitcnt vmcnt(3)
    s_cmpk_ge_u32 s8, 1824
    s_cbranch_scc1 .ap_93
    s_waitcnt vmcnt(2)
.ap_93:
    s_add_u32 s63, s69, 311296
    buffer_load_dwordx4 v[248:251], v1, s[44:47], s63 offen nt
    s_memrealtime s[8:9]
    s_waitcnt vmcnt(9)
    s_waitcnt lgkmcnt(0)
    s_sub_u32 s8, s8, s30
    s_cmpk_ge_u32 s8, 2076
    s_cbranch_scc1 .ap_94
    s_waitcnt vmcnt(6)
    s_cmpk_ge_u32 s8, 1976
    s_cbranch_scc1 .ap_94
    s_waitcnt vmcnt(4)
    s_bitcmp1_b64 s[14:15], 55
    s_cbranch_scc0 1
    s_waitcnt vmcnt(3)
    s_cmpk_ge_u32 s8, 1856
    s_cbranch_scc1 .ap_94
    s_waitcnt vmcnt(1)
.ap_94:
    s_add_u32 s63, s69, 319488
    buffer_load_dwordx4 v[252:255], v1, s[44:47], s63 offen nt
    s_memrealtime s[8:9]
    s_waitcnt vmcnt(9)
    s_waitcnt lgkmcnt(0)
    s_sub_u32 s8, s8, s30
    s_cmpk_ge_u32 s8, 2108
    s_cbranch_scc1 .ap_95
    s_waitcnt vmcnt(6)
    s_cmpk_ge_u32 s8, 2008
    s_cbranch_scc1 .ap_95
    s_waitcnt vmcnt(4)
    s_bitcmp1_b64 s[14:15], 56
    s_cbranch_scc0 1
    s_waitcnt vmcnt(2)
    s_cmpk_ge_u32 s8, 1888
    s_cbranch_scc1 .ap_95
    s_waitcnt vmcnt(1)
.ap_95:
    s_add_u32 s63, s69, 393216
    buffer_load_dwordx4 v[36:39], v1, s[44:47], s63 offen nt
    s_memrealtime s[8:9]
    s_waitcnt vmcnt(9)
    s_waitcnt lgkmcnt(0)
    s_sub_u32 s8, s8, s30
    s_cmpk_ge_u32 s8, 2140
    s_cbranch_scc1 .ap_96
    s_waitcnt vmcnt(6)
    s_cmpk_ge_u32 s8, 2040
    s_branch .Lsk_m1_5
.Lst_m1_5:
    s_branch .Lrt_m1_5
.Lsk_m1_5:
    s_cbranch_scc1 .ap_96
    s_waitcnt vmcnt(3)
    s_bitcmp1_b64 s[14:15], 57
    s_cbranch_scc0 1
    s_waitcnt vmcnt(2)
    s_cmpk_ge_u32 s8, 1920
    s_cbranch_scc1 .ap_96
    s_waitcnt vmcnt(1)
.ap_96:
    s_add_u32 s63, s69, 401408
    buffer_load_dwordx4 v[44:47], v1, s[44:47], s63 offen nt
    s_memrealtime s[8:9]
    s_waitcnt vmcnt(9)
    s_waitcnt lgkmcnt(0)
    s_sub_u32 s8, s8, s30
    s_cmpk_ge_u32 s8, 2172
    s_cbranch_scc1 .ap_97
    s_waitcnt vmcnt(6)
    s_cmpk_ge_u32 s8, 2072
    s_cbranch_scc1 .ap_97
    s_waitcnt vmcnt(3)
    s_bitcmp1_b64 s[14:15], 58
    s_cbranch_scc0 1
    s_waitcnt vmcnt(2)
    s_cmpk_ge_u32 s8, 1952
    s_cbranch_scc1 .ap_97
    s_waitcnt vmcnt(1)
.ap_97:
    s_add_u32 s63, s69, 409600
    buffer_load_dwordx4 v[52:55], v1, s[44:47], s63 offen nt
    s_memrealtime s[8:9]
    s_waitcnt vmcnt(9)
    s_waitcnt lgkmcnt(0)
    s_sub_u32 s8, s8, s30
    s_cmpk_ge_u32 s8, 2204
    s_cbranch_scc1 .ap_98
    s_waitcnt vmcnt(5)
    s_cmpk_ge_u32 s8, 2104
    s_cbranch_scc1 .ap_98
    s_waitcnt vmcnt(3)
    s_bitcmp1_b64 s[14:15], 59
    s_cbranch_scc0 1
    s_waitcnt vmcnt(2)
    s_cmpk_ge_u32 s8, 1984
    s_cbranch_scc1 .ap_98
    s_waitcnt vmcnt(1)
.ap_98:
    s_add_u32 s63, s69, 417792
    buffer_load_dwordx4 v[60:63], v1, s[44:47], s63 offen nt
    s_memrealtime s[8:9]
    s_waitcnt vmcnt(9)
    s_waitcnt lgkmcnt(0)
    s_sub_u32 s8, s8, s30
    s_cmpk_ge_u32 s8, 2236
    s_cbranch_scc1 .ap_99
    s_waitcnt vmcnt(5)
    s_cmpk_ge_u32 s8, 2136
    s_cbranch_scc1 .ap_99
    s_waitcnt vmcnt(3)
    s_bitcmp1_b64 s[14:15], 60
    s_cbranch_scc0 1
    s_waitcnt vmcnt(2)
    s_cmpk_ge_u32 s8, 2016
    s_cbranch_scc1 .ap_99
    s_waitcnt vmcnt(1)
.ap_99:
    s_add_u32 s63, s69, 425984
    buffer_load_dwordx4 v[68:71], v1, s[44:47], s63 offen nt
    s_memrealtime s[8:9]
    s_waitcnt vmcnt(9)
    s_waitcnt lgkmcnt(0)
    s_sub_u32 s8, s8, s30
    s_cmpk_ge_u32 s8, 2268
    s_cbranch_scc1 .ap_100
    s_waitcnt vmcnt(5)
    s_cmpk_ge_u32 s8, 2168
    s_cbranch_scc1 .ap_100
    s_waitcnt vmcnt(3)
    s_bitcmp1_b64 s[14:15], 61
    s_cbranch_scc0 1
    s_waitcnt vmcnt(2)
    s_cmpk_ge_u32 s8, 2048
    s_cbranch_scc1 .ap_100
    s_waitcnt vmcnt(1)
.ap_100:
    s_add_u32 s63, s69, 434176
    buffer_load_dwordx4 v[76:79], v1, s[44:47], s63 offen nt
    s_memrealtime s[8:9]
    s_waitcnt vmcnt(8)
    s_waitcnt lgkmcnt(0)
    s_sub_u32 s8, s8, s30
    s_cmpk_ge_u32 s8, 2300
    s_cbranch_scc1 .ap_101
    s_waitcnt vmcnt(5)
    s_cmpk_ge_u32 s8, 2200
    s_cbranch_scc1 .ap_101
    s_waitcnt vmcnt(3)
    s_bitcmp1_b64 s[14:15], 62
    s_cbranch_scc0 1
    s_waitcnt vmcnt(2)
    s_cmpk_ge_u32 s8, 2080
    s_cbranch_scc1 .ap_101
    s_waitcnt vmcnt(1)
.ap_101:
    s_add_u32 s63, s69, 442368
    buffer_load_dwordx4 v[84:87], v1, s[44:47], s63 offen nt
    s_memrealtime s[8:9]
    s_waitcnt vmcnt(8)
    s_waitcnt lgkmcnt(0)
    s_sub_u32 s8, s8, s30
    s_cmpk_ge_u32 s8, 2332
    s_cbranch_scc1 .ap_102
    s_waitcnt vmcnt(5)
    s_cmpk_ge_u32 s8, 2232
    s_cbranch_scc1 .ap_102
    s_waitcnt vmcnt(3)
    s_bitcmp1_b64 s[14:15], 63
    s_cbranch_scc0 1
    s_waitcnt vmcnt(2)
    s_cmpk_ge_u32 s8, 2112
    s_cbranch_scc1 .ap_102
    s_waitcnt vmcnt(1)
.ap_102:
    s_add_u32 s63, s69, 450560
    buffer_load_dwordx4 v[92:95], v1, s[44:47], s63 offen nt
    s_setprio 0
    s_branch .gpc_104
.gp_103:
    buffer_load_dwordx4 v[24:27], v9, s[36:39], s59 offen offset:0 sc1
    s_waitcnt vmcnt(0)
.gpc_104:
    v_cmp_eq_u32 vcc, s34, v26
    s_cmp_eq_u64 vcc, -1
    s_nop 3
    s_cbranch_scc1 .gpd_105
    s_sub_u32 s35, s35, 1
    s_cbranch_scc1 .Lexit
    s_sleep 1
    s_branch .gp_103
.gpd_105:
    v_cmp_eq_u32 vcc, s1, v28
    s_cmp_eq_u64 vcc, -1
    s_cselect_b32 s0, 0x800000, 0
    v_mov_b32 v16, v24
    s_nop 1
    v_max_f32_dpp v16, v16, v16 row_ror:4 row_mask:0xf bank_mask:0xf
    v_sub_f32 v17, v24, v16
    v_sub_f32 v18, v14, v16
    v_mul_f32 v17, 0x3fb8aa3b, v17
    v_mul_f32 v18, 0x3fb8aa3b, v18
    v_exp_f32 v17, v17
    v_exp_f32 v18, v18
    v_mul_f32 v17, v17, v25
    s_nop 1
    v_add_f32_dpp v17, v17, v17 row_ror:4 row_mask:0xf bank_mask:0xf
    v_rcp_f32 v19, v17
    s_nop 0
    v_fma_f32 v15, -v17, v19, 1.0
    v_fma_f32 v19, v15, v19, v19
    v_mul_f32 v18, v18, v19
    v_mul_f32 v10, v10, v18
    v_mul_f32 v11, v11, v18
    v_mul_f32 v12, v12, v18
    v_mul_f32 v13, v13, v18
    v_mov_b32_dpp v112, v10 quad_perm:[2,3,0,1] row_mask:0xf bank_mask:0xf
    v_mov_b32_dpp v113, v11 quad_perm:[2,3,0,1] row_mask:0xf bank_mask:0xf
    v_mov_b32_dpp v114, v12 quad_perm:[2,3,0,1] row_mask:0xf bank_mask:0xf
    v_mov_b32_dpp v115, v13 quad_perm:[2,3,0,1] row_mask:0xf bank_mask:0xf
    v_cvt_pk_bf16_f32 v96, v10, v112
    v_cvt_pk_bf16_f32 v100, v11, v113
    v_cvt_pk_bf16_f32 v104, v12, v114
    v_cvt_pk_bf16_f32 v108, v13, v115
    v_mov_b32_dpp v97, v96 row_ror:12 row_mask:0xf bank_mask:0xf
    v_mov_b32_dpp v101, v100 row_ror:12 row_mask:0xf bank_mask:0xf
    v_mov_b32_dpp v105, v104 row_ror:12 row_mask:0xf bank_mask:0xf
    v_mov_b32_dpp v109, v108 row_ror:12 row_mask:0xf bank_mask:0xf
    v_mov_b32_dpp v98, v96 row_ror:8 row_mask:0xf bank_mask:0xf
    v_mov_b32_dpp v102, v100 row_ror:8 row_mask:0xf bank_mask:0xf
    v_mov_b32_dpp v106, v104 row_ror:8 row_mask:0xf bank_mask:0xf
    v_mov_b32_dpp v110, v108 row_ror:8 row_mask:0xf bank_mask:0xf
    v_mov_b32_dpp v99, v96 row_ror:4 row_mask:0xf bank_mask:0xf
    v_mov_b32_dpp v103, v100 row_ror:4 row_mask:0xf bank_mask:0xf
    v_mov_b32_dpp v107, v104 row_ror:4 row_mask:0xf bank_mask:0xf
    v_mov_b32_dpp v111, v108 row_ror:4 row_mask:0xf bank_mask:0xf
    s_lshl_b32 s60, s3, 10
    s_add_u32 s60, s60, 147456
    v_lshlrev_b32 v10, 5, v0
    v_add_u32 v10, s60, v10
    v_perm_b32 v112, v164, v160, s94
    v_perm_b32 v113, v172, v168, s94
    v_perm_b32 v114, v180, v176, s94
    v_perm_b32 v115, v188, v184, s94
    s_nop 1
    v_mfma_f32_16x16x32_bf16 v[128:131], v[96:99], v[112:115], 0
    v_perm_b32 v116, v164, v160, s95
    v_perm_b32 v117, v172, v168, s95
    v_perm_b32 v118, v180, v176, s95
    v_perm_b32 v119, v188, v184, s95
    s_nop 1
    v_mfma_f32_16x16x32_bf16 v[132:135], v[96:99], v[116:119], 0
    v_perm_b32 v120, v165, v161, s94
    v_perm_b32 v121, v173, v169, s94
    v_perm_b32 v122, v181, v177, s94
    v_perm_b32 v123, v189, v185, s94
    s_nop 1
    v_mfma_f32_16x16x32_bf16 v[136:139], v[96:99], v[120:123], 0
    v_perm_b32 v124, v165, v161, s95
    v_perm_b32 v125, v173, v169, s95
    v_perm_b32 v126, v181, v177, s95
    v_perm_b32 v127, v189, v185, s95
    s_nop 1
    v_mfma_f32_16x16x32_bf16 v[140:143], v[96:99], v[124:127], 0
    s_branch .Lsk_m1_6
.Lst_m1_6:
    s_branch .Lrt_m1_6
.Lsk_m1_6:
    v_perm_b32 v112, v166, v162, s94
    v_perm_b32 v113, v174, v170, s94
    v_perm_b32 v114, v182, v178, s94
    v_perm_b32 v115, v190, v186, s94
    s_nop 1
    v_mfma_f32_16x16x32_bf16 v[144:147], v[96:99], v[112:115], 0
    v_perm_b32 v116, v166, v162, s95
    v_perm_b32 v117, v174, v170, s95
    v_perm_b32 v118, v182, v178, s95
    v_perm_b32 v119, v190, v186, s95
    s_nop 1
    v_mfma_f32_16x16x32_bf16 v[148:151], v[96:99], v[116:119], 0
    v_perm_b32 v120, v167, v163, s94
    v_perm_b32 v121, v175, v171, s94
    v_perm_b32 v122, v183, v179, s94
    v_perm_b32 v123, v191, v187, s94
    s_nop 1
    v_mfma_f32_16x16x32_bf16 v[152:155], v[96:99], v[120:123], 0
    v_perm_b32 v124, v167, v163, s95
    v_perm_b32 v125, v175, v171, s95
    v_perm_b32 v126, v183, v179, s95
    v_perm_b32 v127, v191, v187, s95
    s_nop 1
    v_mfma_f32_16x16x32_bf16 v[156:159], v[96:99], v[124:127], 0
    v_perm_b32 v112, v196, v192, s94
    v_perm_b32 v113, v204, v200, s94
    v_perm_b32 v114, v212, v208, s94
    v_perm_b32 v115, v220, v216, s94
    s_nop 1
    v_mfma_f32_16x16x32_bf16 v[128:131], v[100:103], v[112:115], v[128:131]
    v_perm_b32 v116, v196, v192, s95
    v_perm_b32 v117, v204, v200, s95
    v_perm_b32 v118, v212, v208, s95
    v_perm_b32 v119, v220, v216, s95
    s_nop 1
    v_mfma_f32_16x16x32_bf16 v[132:135], v[100:103], v[116:119], v[132:135]
    v_perm_b32 v120, v197, v193, s94
    v_perm_b32 v121, v205, v201, s94
    v_perm_b32 v122, v213, v209, s94
    v_perm_b32 v123, v221, v217, s94
    s_nop 1
    v_mfma_f32_16x16x32_bf16 v[136:139], v[100:103], v[120:123], v[136:139]
    v_perm_b32 v124, v197, v193, s95
    v_perm_b32 v125, v205, v201, s95
    v_perm_b32 v126, v213, v209, s95
    v_perm_b32 v127, v221, v217, s95
    s_nop 1
    v_mfma_f32_16x16x32_bf16 v[140:143], v[100:103], v[124:127], v[140:143]
    v_perm_b32 v112, v198, v194, s94
    v_perm_b32 v113, v206, v202, s94
    v_perm_b32 v114, v214, v210, s94
    v_perm_b32 v115, v222, v218, s94
    s_nop 1
    v_mfma_f32_16x16x32_bf16 v[144:147], v[100:103], v[112:115], v[144:147]
    v_perm_b32 v116, v198, v194, s95
    v_perm_b32 v117, v206, v202, s95
    v_perm_b32 v118, v214, v210, s95
    v_perm_b32 v119, v222, v218, s95
    s_nop 1
    v_mfma_f32_16x16x32_bf16 v[148:151], v[100:103], v[116:119], v[148:151]
    v_perm_b32 v120, v199, v195, s94
    v_perm_b32 v121, v207, v203, s94
    v_perm_b32 v122, v215, v211, s94
    v_perm_b32 v123, v223, v219, s94
    s_nop 1
    v_mfma_f32_16x16x32_bf16 v[152:155], v[100:103], v[120:123], v[152:155]
    v_perm_b32 v124, v199, v195, s95
    v_perm_b32 v125, v207, v203, s95
    v_perm_b32 v126, v215, v211, s95
    v_perm_b32 v127, v223, v219, s95
    s_nop 1
    v_mfma_f32_16x16x32_bf16 v[156:159], v[100:103], v[124:127], v[156:159]
    s_waitcnt vmcnt(8)
    v_perm_b32 v112, v228, v224, s94
    v_perm_b32 v113, v236, v232, s94
    v_perm_b32 v114, v244, v240, s94
    v_perm_b32 v115, v252, v248, s94
    s_nop 1
    v_mfma_f32_16x16x32_bf16 v[128:131], v[104:107], v[112:115], v[128:131]
    v_perm_b32 v116, v228, v224, s95
    v_perm_b32 v117, v236, v232, s95
    v_perm_b32 v118, v244, v240, s95
    v_perm_b32 v119, v252, v248, s95
    s_nop 1
    v_mfma_f32_16x16x32_bf16 v[132:135], v[104:107], v[116:119], v[132:135]
    v_perm_b32 v120, v229, v225, s94
    v_perm_b32 v121, v237, v233, s94
    v_perm_b32 v122, v245, v241, s94
    v_perm_b32 v123, v253, v249, s94
    s_nop 1
    v_mfma_f32_16x16x32_bf16 v[136:139], v[104:107], v[120:123], v[136:139]
    v_perm_b32 v124, v229, v225, s95
    v_perm_b32 v125, v237, v233, s95
    v_perm_b32 v126, v245, v241, s95
    v_perm_b32 v127, v253, v249, s95
    s_nop 1
    v_mfma_f32_16x16x32_bf16 v[140:143], v[104:107], v[124:127], v[140:143]
    v_perm_b32 v112, v230, v226, s94
    v_perm_b32 v113, v238, v234, s94
    v_perm_b32 v114, v246, v242, s94
    v_perm_b32 v115, v254, v250, s94
    s_nop 1
    v_mfma_f32_16x16x32_bf16 v[144:147], v[104:107], v[112:115], v[144:147]
    v_perm_b32 v116, v230, v226, s95
    v_perm_b32 v117, v238, v234, s95
    v_perm_b32 v118, v246, v242, s95
    v_perm_b32 v119, v254, v250, s95
    s_nop 1
    v_mfma_f32_16x16x32_bf16 v[148:151], v[104:107], v[116:119], v[148:151]
    v_perm_b32 v120, v231, v227, s94
    v_perm_b32 v121, v239, v235, s94
    v_perm_b32 v122, v247, v243, s94
    v_perm_b32 v123, v255, v251, s94
    s_nop 1
    v_mfma_f32_16x16x32_bf16 v[152:155], v[104:107], v[120:123], v[152:155]
    v_perm_b32 v124, v231, v227, s95
    v_perm_b32 v125, v239, v235, s95
    v_perm_b32 v126, v247, v243, s95
    v_perm_b32 v127, v255, v251, s95
    s_nop 1
    v_mfma_f32_16x16x32_bf16 v[156:159], v[104:107], v[124:127], v[156:159]
    s_waitcnt vmcnt(0)
    v_perm_b32 v112, v44, v36, s94
    v_perm_b32 v113, v60, v52, s94
    v_perm_b32 v114, v76, v68, s94
    v_perm_b32 v115, v92, v84, s94
    s_nop 1
    v_mfma_f32_16x16x32_bf16 v[128:131], v[108:111], v[112:115], v[128:131]
    v_perm_b32 v116, v44, v36, s95
    v_perm_b32 v117, v60, v52, s95
    v_perm_b32 v118, v76, v68, s95
    v_perm_b32 v119, v92, v84, s95
    s_nop 1
    v_mfma_f32_16x16x32_bf16 v[132:135], v[108:111], v[116:119], v[132:135]
    v_perm_b32 v120, v45, v37, s94
    v_perm_b32 v121, v61, v53, s94
    v_perm_b32 v122, v77, v69, s94
    v_perm_b32 v123, v93, v85, s94
    s_nop 1
    v_mfma_f32_16x16x32_bf16 v[136:139], v[108:111], v[120:123], v[136:139]
    v_perm_b32 v124, v45, v37, s95
    v_perm_b32 v125, v61, v53, s95
    v_perm_b32 v126, v77, v69, s95
    v_perm_b32 v127, v93, v85, s95
    s_nop 1
    v_mfma_f32_16x16x32_bf16 v[140:143], v[108:111], v[124:127], v[140:143]
    v_perm_b32 v112, v46, v38, s94
    v_perm_b32 v113, v62, v54, s94
    s_branch .Lsk_m1_7
.Lst_m1_7:
    s_branch .Lrt_m1_7
.Lsk_m1_7:
    v_perm_b32 v114, v78, v70, s94
    v_perm_b32 v115, v94, v86, s94
    s_nop 1
    v_mfma_f32_16x16x32_bf16 v[144:147], v[108:111], v[112:115], v[144:147]
    v_perm_b32 v116, v46, v38, s95
    v_perm_b32 v117, v62, v54, s95
    v_perm_b32 v118, v78, v70, s95
    v_perm_b32 v119, v94, v86, s95
    s_nop 1
    v_mfma_f32_16x16x32_bf16 v[148:151], v[108:111], v[116:119], v[148:151]
    v_perm_b32 v120, v47, v39, s94
    v_perm_b32 v121, v63, v55, s94
    v_perm_b32 v122, v79, v71, s94
    v_perm_b32 v123, v95, v87, s94
    s_nop 1
    v_mfma_f32_16x16x32_bf16 v[152:155], v[108:111], v[120:123], v[152:155]
    v_perm_b32 v124, v47, v39, s95
    v_perm_b32 v125, v63, v55, s95
    v_perm_b32 v126, v79, v71, s95
    v_perm_b32 v127, v95, v87, s95
    s_nop 1
    v_mfma_f32_16x16x32_bf16 v[156:159], v[108:111], v[124:127], v[156:159]
    s_mov_b64 exec, 0xffff
    ds_write2_b32 v10, v128, v129 offset0:0 offset1:128
    ds_write2_b32 v10, v132, v133 offset0:1 offset1:129
    ds_write2_b32 v10, v136, v137 offset0:2 offset1:130
    ds_write2_b32 v10, v140, v141 offset0:3 offset1:131
    ds_write2_b32 v10, v144, v145 offset0:4 offset1:132
    ds_write2_b32 v10, v148, v149 offset0:5 offset1:133
    ds_write2_b32 v10, v152, v153 offset0:6 offset1:134
    ds_write2_b32 v10, v156, v157 offset0:7 offset1:135
    s_mov_b64 exec, -1
    s_waitcnt lgkmcnt(0)
    s_barrier
    s_cmp_lg_u32 s3, 7
    s_cbranch_scc1 .opub_106
    v_add_u32 v10, 147456, v2
    ds_read_b128 v[196:199], v10 offset:0
    ds_read_b128 v[200:203], v10 offset:1024
    ds_read_b128 v[204:207], v10 offset:2048
    ds_read_b128 v[208:211], v10 offset:3072
    ds_read_b128 v[212:215], v10 offset:4096
    ds_read_b128 v[216:219], v10 offset:5120
    ds_read_b128 v[220:223], v10 offset:6144
    ds_read_b128 v[224:227], v10 offset:7168
    v_lshrrev_b32 v11, 5, v0
    v_lshlrev_b32 v11, 13, v11
    v_and_b32 v12, 31, v0
    v_lshl_add_u32 v11, v12, 4, v11
    s_lshl4_add_u32 s56, s67, s66
    s_lshl1_add_u32 s56, s56, s68
    s_lshl_b32 s56, s56, 9
    s_add_u32 s56, s56, 0xa0000
    s_mov_b32 s60, 0x07060503
    s_mov_b32 s61, 0x07060502
    s_mov_b32 s62, 0x07060501
    v_mov_b32 v15, s34
    s_waitcnt lgkmcnt(6)
    v_pk_add_f32 v[196:197], v[196:197], v[200:201]
    v_pk_add_f32 v[198:199], v[198:199], v[202:203]
    s_waitcnt lgkmcnt(5)
    v_pk_add_f32 v[196:197], v[196:197], v[204:205]
    v_pk_add_f32 v[198:199], v[198:199], v[206:207]
    s_waitcnt lgkmcnt(4)
    v_pk_add_f32 v[196:197], v[196:197], v[208:209]
    v_pk_add_f32 v[198:199], v[198:199], v[210:211]
    s_waitcnt lgkmcnt(3)
    v_pk_add_f32 v[196:197], v[196:197], v[212:213]
    v_pk_add_f32 v[198:199], v[198:199], v[214:215]
    s_waitcnt lgkmcnt(2)
    v_pk_add_f32 v[196:197], v[196:197], v[216:217]
    v_pk_add_f32 v[198:199], v[198:199], v[218:219]
    s_waitcnt lgkmcnt(1)
    v_pk_add_f32 v[196:197], v[196:197], v[220:221]
    v_pk_add_f32 v[198:199], v[198:199], v[222:223]
    s_waitcnt lgkmcnt(0)
    v_pk_add_f32 v[196:197], v[196:197], v[224:225]
    v_pk_add_f32 v[198:199], v[198:199], v[226:227]
    v_perm_b32 v12, v196, v199, s60
    v_perm_b32 v13, v197, v199, s61
    v_perm_b32 v14, v198, v199, s62
    s_add_u32 s57, s56, 0x800000
    buffer_store_dwordx4 v[12:15], v11, s[36:39], s57 offen
    buffer_store_dwordx4 v[12:15], v11, s[36:39], s56 offen sc1
.opub_106:
    s_and_b32 s58, s64, 0
    s_mul_i32 s58, s58, 18432
    s_mul_i32 s59, s3, 2304
    s_add_u32 s58, s58, s59
    s_add_u32 s62, s58, 0x37000
    s_add_u32 s63, s58, 0x49000
    s_mul_i32 s101, s64, 18432
    s_add_u32 s101, s101, s59
    s_add_u32 s101, s101, 0x170000
    v_and_b32 v16, 8, v0
    v_and_b32 v17, 1, v0
    v_lshl_add_u32 v16, v17, 2, v16
    v_bfe_u32 v17, v0, 1, 2
    v_add_u32 v16, v16, v17
    v_lshlrev_b32 v9, 4, v16
    s_lshl_b32 s56, s65, 8
    s_add_u32 s58, s58, s56
    s_add_u32 s58, s58, 0x25000
    s_add_u32 s99, s101, s56
    s_lshr_b32 s56, s64, 1
    s_and_b32 s57, s3, 3
    s_cmp_lg_u32 s56, s57
    s_cbranch_scc1 .Lr_ga
    s_add_u32 s59, s58, 73728
    s_add_u32 s60, s58, 147456
    s_add_u32 s61, s58, 221184
.gp_107:
    buffer_load_dwordx4 v[56:59], v2, s[36:39], s62 offen offset:0 sc1
    buffer_load_dwordx4 v[60:63], v2, s[36:39], s62 offen offset:1024 sc1
    buffer_load_dwordx2 v[64:65], v5, s[36:39], s62 offen offset:0 sc1
    buffer_load_dwordx4 v[66:69], v2, s[36:39], s63 offen offset:0 sc1
    buffer_load_dwordx4 v[70:73], v2, s[36:39], s63 offen offset:1024 sc1
    buffer_load_dwordx2 v[74:75], v5, s[36:39], s63 offen offset:0 sc1
    buffer_load_dwordx2 v[76:77], v8, s[36:39], s59 offen offset:0 sc1
    buffer_load_dwordx2 v[78:79], v8, s[36:39], s60 offen offset:0 sc1
    buffer_load_dwordx2 v[80:81], v8, s[36:39], s61 offen offset:0 sc1
    buffer_load_dwordx2 v[42:43], v8, s[36:39], s58 offen offset:0 sc1
    s_waitcnt vmcnt(0)
.gpc_108:
    v_min_u32 v24, v57, v59
    v_max_u32 v25, v57, v59
    v_min3_u32 v24, v24, v61, v63
    v_max3_u32 v25, v25, v61, v63
    v_min3_u32 v24, v24, v65, v67
    v_max3_u32 v25, v25, v65, v67
    v_min3_u32 v24, v24, v69, v71
    v_max3_u32 v25, v25, v69, v71
    v_min3_u32 v24, v24, v73, v75
    v_max3_u32 v25, v25, v73, v75
    v_min3_u32 v24, v24, v77, v79
    v_max3_u32 v25, v25, v77, v79
    v_min3_u32 v24, v24, v81, v43
    v_max3_u32 v25, v25, v81, v43
    v_cmp_eq_u32 vcc, s34, v24
    v_cmp_eq_u32 s[56:57], s34, v25
    s_and_b64 vcc, vcc, s[56:57]
    s_cmp_eq_u64 vcc, -1
    s_nop 2
    s_cbranch_scc1 .gpd_109
    s_sub_u32 s35, s35, 1
    s_cbranch_scc1 .Lexit
    s_sleep 2
    s_branch .gp_107
.gpd_109:
    v_and_b32 v57, 0xffff0000, v56
    v_lshlrev_b32 v56, 16, v56
    v_and_b32 v67, 0xffff0000, v66
    v_lshlrev_b32 v66, 16, v66
    v_and_b32 v59, 0xffff0000, v58
    v_lshlrev_b32 v58, 16, v58
    v_and_b32 v69, 0xffff0000, v68
    v_lshlrev_b32 v68, 16, v68
    v_and_b32 v61, 0xffff0000, v60
    v_lshlrev_b32 v60, 16, v60
    v_and_b32 v71, 0xffff0000, v70
    v_lshlrev_b32 v70, 16, v70
    v_and_b32 v63, 0xffff0000, v62
    v_lshlrev_b32 v62, 16, v62
    v_and_b32 v73, 0xffff0000, v72
    v_lshlrev_b32 v72, 16, v72
    v_and_b32 v65, 0xffff0000, v64
    v_lshlrev_b32 v64, 16, v64
    v_and_b32 v75, 0xffff0000, v74
    s_branch .Lsk_m2_0
.Lst_m2_0:
    s_branch .Lrt_m2_0
.Lsk_m2_0:
    v_lshlrev_b32 v74, 16, v74
    v_lshlrev_b32 v77, 16, v76
    v_and_b32 v76, 0xffff0000, v76
    s_mov_b32 vcc_lo, 0xffff0000
    s_mov_b32 vcc_hi, 0xffff0000
    v_cndmask_b32 v77, v77, v76, vcc
    v_lshlrev_b32 v79, 16, v78
    v_and_b32 v78, 0xffff0000, v78
    s_mov_b32 vcc_lo, 0xffff0000
    s_mov_b32 vcc_hi, 0xffff0000
    v_cndmask_b32 v79, v79, v78, vcc
    v_lshlrev_b32 v81, 16, v80
    v_and_b32 v80, 0xffff0000, v80
    s_mov_b32 vcc_lo, 0xffff0000
    s_mov_b32 vcc_hi, 0xffff0000
    v_cndmask_b32 v81, v81, v80, vcc
    s_nop 1
    s_branch .Lr_ga2
.Lr_ga:
.gp_110:
    buffer_load_dwordx2 v[42:43], v8, s[36:39], s58 offen offset:0 sc1
    s_waitcnt vmcnt(0)
.gpc_111:
    v_cmp_eq_u32 vcc, s34, v43
    s_cmp_eq_u64 vcc, -1
    s_nop 3
    s_cbranch_scc1 .gpd_112
    s_sub_u32 s35, s35, 1
    s_cbranch_scc1 .Lexit
    s_sleep 2
    s_branch .gp_110
.gpd_112:
.Lr_ga2:
    v_lshlrev_b32 v40, 16, v40
    v_lshlrev_b32 v41, 16, v42
    v_and_b32 v42, 0xffff0000, v42
    s_mov_b32 vcc_lo, 0xffff0000
    s_mov_b32 vcc_hi, 0xffff0000
    v_cndmask_b32 v41, v41, v42, vcc
    s_mul_i32 s59, s3, 9
    s_add_u32 s59, s59, s65
    s_lshl_b32 s59, s59, 12
    s_add_u32 s59, s59, 0xe0000
    s_mov_b32 s60, 0x04000c0c
    s_mov_b32 s61, 0x0706000c
    v_mov_b32 v45, s34
    v_mov_b32 v47, s34
.gp_113:
    buffer_load_dwordx4 v[16:19], v2, s[36:39], s59 offen offset:0 sc1
    buffer_load_dwordx4 v[20:23], v2, s[36:39], s59 offen offset:1024 sc1
    buffer_load_dwordx4 v[24:27], v2, s[36:39], s59 offen offset:2048 sc1
    buffer_load_dwordx4 v[28:31], v2, s[36:39], s59 offen offset:3072 sc1
    s_waitcnt vmcnt(0)
.gpc_114:
    v_min_u32 v32, v19, v23
    v_max_u32 v33, v19, v23
    v_min3_u32 v32, v32, v27, v31
    v_max3_u32 v33, v33, v27, v31
    v_cmp_eq_u32 vcc, s34, v32
    v_cmp_eq_u32 s[56:57], s34, v33
    s_and_b64 vcc, vcc, s[56:57]
    s_cmp_eq_u64 vcc, -1
    s_nop 2
    s_cbranch_scc1 .gpd_115
    s_sub_u32 s35, s35, 1
    s_cbranch_scc1 .Lexit
    s_branch .gp_113
.gpd_115:
    v_perm_b32 v19, v16, v17, s60
    v_perm_b32 v19, v19, v18, s61
    v_perm_b32 v23, v20, v21, s60
    v_perm_b32 v23, v23, v22, s61
    v_perm_b32 v27, v24, v25, s60
    v_perm_b32 v27, v27, v26, s61
    v_perm_b32 v31, v28, v29, s60
    v_perm_b32 v31, v31, v30, s61
    v_pk_add_f32 v[16:17], v[16:17], v[20:21]
    v_pk_add_f32 v[18:19], v[18:19], v[22:23]
    v_pk_add_f32 v[24:25], v[24:25], v[28:29]
    v_pk_add_f32 v[26:27], v[26:27], v[30:31]
    v_pk_add_f32 v[16:17], v[16:17], v[24:25]
    v_pk_add_f32 v[18:19], v[18:19], v[26:27]
    s_nop 1
    v_permlane32_swap_b32 v16, v18
    v_permlane32_swap_b32 v17, v19
    v_pk_add_f32 v[16:17], v[16:17], v[18:19]
    s_nop 1
    v_permlane16_swap_b32 v16, v17
    v_add_f32 v16, v16, v17
    v_cvt_pk_bf16_f32 v16, v16, v16
    v_lshlrev_b32 v16, 16, v16
    v_mul_f32 v16, v16, v41
    v_cvt_pk_bf16_f32 v16, v16, v16
    v_lshlrev_b32 v16, 16, v16
    v_add_f32 v17, v16, v40
    v_add_f32 v16, v16, v40
    v_mov_b32 v40, v16
    s_nop 0
    v_permlane16_swap_b32 v16, v17
    v_cvt_pk_bf16_f32 v44, v16, v17
    v_cvt_pk_bf16_f32 v46, v16, v17
    s_nop 1
    v_permlane32_swap_b32 v44, v46
    s_mov_b64 exec, 0xffff
    s_add_u32 s57, s99, 0x800000
    buffer_store_dwordx4 v[44:47], v9, s[36:39], s57 offen
    buffer_store_dwordx4 v[44:47], v9, s[36:39], s99 offen sc1
    s_mov_b64 exec, -1
    s_lshr_b32 s56, s64, 1
    s_and_b32 s57, s3, 3
    s_cmp_lg_u32 s56, s57
    s_cbranch_scc1 .Lexit
    v_cvt_pk_bf16_f32 v40, v40, v40
    v_lshlrev_b32 v40, 16, v40
    s_mov_b32 s69, 0
.gp_116:
    s_add_u32 s69, s69, 1
    s_and_b32 s56, s69, 0x41
    s_cmp_lg_u32 s56, 0x41
    s_cselect_b32 s56, s0, 0
    s_add_u32 s58, s101, s56
    buffer_load_dwordx4 v[84:87], v2, s[36:39], s58 offen offset:0 sc1
    buffer_load_dwordx4 v[88:91], v2, s[36:39], s58 offen offset:1024 sc1
    buffer_load_dwordx2 v[92:93], v5, s[36:39], s58 offen offset:0 sc1
    s_waitcnt vmcnt(0)
    v_min3_u32 v24, v85, v87, v89
    v_max3_u32 v25, v85, v87, v89
    v_min3_u32 v24, v24, v91, v93
    v_max3_u32 v25, v25, v91, v93
    v_cmp_eq_u32 vcc, s34, v24
    v_cmp_eq_u32 s[56:57], s34, v25
    s_and_b64 vcc, vcc, s[56:57]
    s_cmp_eq_u64 vcc, -1
    s_nop 2
    s_cbranch_scc1 .gpd_117
    s_sub_u32 s35, s35, 1
    s_cbranch_scc1 .Lexit
    s_sleep 1
    s_branch .gp_116
.gpd_117:
    s_mov_b32 s56, 0x3f803f80
    v_dot2_f32_bf16 v104, v84, s56, 0
    v_dot2_f32_bf16 v105, v84, v84, 0
    v_dot2_f32_bf16 v104, v86, s56, v104
    v_dot2_f32_bf16 v105, v86, v86, v105
    v_dot2_f32_bf16 v104, v88, s56, v104
    v_dot2_f32_bf16 v105, v88, v88, v105
    v_dot2_f32_bf16 v104, v90, s56, v104
    v_dot2_f32_bf16 v105, v90, v90, v105
    s_branch .Lsk_m2_1
.Lst_m2_1:
    s_branch .Lrt_m2_1
.Lsk_m2_1:
    s_mov_b64 exec, 0xffffffff
    v_dot2_f32_bf16 v104, v92, s56, v104
    v_dot2_f32_bf16 v105, v92, v92, v105
    s_mov_b64 exec, -1
    s_nop 1
    v_permlane32_swap_b32 v104, v105
    v_add_f32 v104, v104, v105
    v_mov_b32 v106, v104
    s_nop 1
    v_permlane16_swap_b32 v106, v104
    v_add_f32 v104, v106, v104
    v_lshlrev_b32 v94, 16, v84
    v_and_b32 v95, 0xffff0000, v84
    v_add_f32_dpp v104, v104, v104 row_ror:8 row_mask:0xf bank_mask:0xf
    v_lshlrev_b32 v96, 16, v86
    v_and_b32 v97, 0xffff0000, v86
    v_add_f32_dpp v104, v104, v104 row_ror:4 row_mask:0xf bank_mask:0xf
    v_lshlrev_b32 v98, 16, v88
    v_and_b32 v99, 0xffff0000, v88
    v_add_f32_dpp v104, v104, v104 quad_perm:[2,3,0,1] row_mask:0xf bank_mask:0xf
    v_lshlrev_b32 v100, 16, v90
    v_and_b32 v101, 0xffff0000, v90
    v_add_f32_dpp v104, v104, v104 quad_perm:[1,0,3,2] row_mask:0xf bank_mask:0xf
    v_mul_f32 v104, 0x3ae38e39, v104
    v_lshlrev_b32 v102, 16, v92
    v_and_b32 v103, 0xffff0000, v92
    v_readlane_b32 s56, v104, 0
    v_readlane_b32 s57, v104, 32
    s_nop 0
    v_mov_b32 v104, s56
    v_fma_f32 v105, -v104, v104, s57
    v_max_f32 v105, 0, v105
    v_cvt_pk_bf16_f32 v106, -v104, v105
    v_and_b32 v107, 0xffff0000, v106
    v_add_f32 v107, 0x3727c5ac, v107
    v_lshlrev_b32 v104, 16, v106
    v_cvt_pk_bf16_f32 v107, v107, v107
    v_lshlrev_b32 v107, 16, v107
    v_sqrt_f32 v107, v107
    v_mov_b32 v105, v104
    v_cvt_pk_bf16_f32 v107, v107, v107
    v_lshlrev_b32 v107, 16, v107
    v_rcp_f32 v106, v107
    v_rcp_f32 v107, v107
    v_pk_add_f32 v[94:95], v[94:95], v[104:105]
    v_pk_add_f32 v[96:97], v[96:97], v[104:105]
    v_pk_add_f32 v[98:99], v[98:99], v[104:105]
    v_pk_add_f32 v[100:101], v[100:101], v[104:105]
    v_pk_add_f32 v[102:103], v[102:103], v[104:105]
    v_cvt_pk_bf16_f32 v94, v94, v95
    v_and_b32 v95, 0xffff0000, v94
    v_lshlrev_b32 v94, 16, v94
    v_cvt_pk_bf16_f32 v96, v96, v97
    v_and_b32 v97, 0xffff0000, v96
    v_lshlrev_b32 v96, 16, v96
    v_cvt_pk_bf16_f32 v98, v98, v99
    v_and_b32 v99, 0xffff0000, v98
    v_lshlrev_b32 v98, 16, v98
    v_cvt_pk_bf16_f32 v100, v100, v101
    v_and_b32 v101, 0xffff0000, v100
    v_lshlrev_b32 v100, 16, v100
    v_cvt_pk_bf16_f32 v102, v102, v103
    v_and_b32 v103, 0xffff0000, v102
    v_lshlrev_b32 v102, 16, v102
    v_pk_mul_f32 v[94:95], v[94:95], v[106:107]
    v_pk_mul_f32 v[96:97], v[96:97], v[106:107]
    v_pk_mul_f32 v[98:99], v[98:99], v[106:107]
    v_pk_mul_f32 v[100:101], v[100:101], v[106:107]
    v_pk_mul_f32 v[102:103], v[102:103], v[106:107]
    v_cvt_pk_bf16_f32 v94, v94, v95
    v_and_b32 v95, 0xffff0000, v94
    v_lshlrev_b32 v94, 16, v94
    v_cvt_pk_bf16_f32 v96, v96, v97
    v_and_b32 v97, 0xffff0000, v96
    v_lshlrev_b32 v96, 16, v96
    v_cvt_pk_bf16_f32 v98, v98, v99
    v_and_b32 v99, 0xffff0000, v98
    v_lshlrev_b32 v98, 16, v98
    v_cvt_pk_bf16_f32 v100, v100, v101
    v_and_b32 v101, 0xffff0000, v100
    v_lshlrev_b32 v100, 16, v100
    v_cvt_pk_bf16_f32 v102, v102, v103
    v_and_b32 v103, 0xffff0000, v102
    v_lshlrev_b32 v102, 16, v102
    v_pk_mul_f32 v[94:95], v[94:95], v[66:67]
    v_pk_mul_f32 v[96:97], v[96:97], v[68:69]
    v_pk_mul_f32 v[98:99], v[98:99], v[70:71]
    v_pk_mul_f32 v[100:101], v[100:101], v[72:73]
    v_pk_mul_f32 v[102:103], v[102:103], v[74:75]
    v_cvt_pk_bf16_f32 v94, v94, v95
    v_and_b32 v95, 0xffff0000, v94
    v_lshlrev_b32 v94, 16, v94
    v_cvt_pk_bf16_f32 v96, v96, v97
    v_and_b32 v97, 0xffff0000, v96
    v_lshlrev_b32 v96, 16, v96
    v_cvt_pk_bf16_f32 v98, v98, v99
    v_and_b32 v99, 0xffff0000, v98
    v_lshlrev_b32 v98, 16, v98
    v_cvt_pk_bf16_f32 v100, v100, v101
    v_and_b32 v101, 0xffff0000, v100
    v_lshlrev_b32 v100, 16, v100
    v_cvt_pk_bf16_f32 v102, v102, v103
    v_and_b32 v103, 0xffff0000, v102
    v_lshlrev_b32 v102, 16, v102
    v_pk_add_f32 v[94:95], v[94:95], v[56:57]
    v_pk_add_f32 v[96:97], v[96:97], v[58:59]
    v_pk_add_f32 v[98:99], v[98:99], v[60:61]
    v_pk_add_f32 v[100:101], v[100:101], v[62:63]
    v_pk_add_f32 v[102:103], v[102:103], v[64:65]
    v_cvt_pk_bf16_f32 v110, v94, v95
    v_cvt_pk_bf16_f32 v111, v96, v97
    v_cvt_pk_bf16_f32 v112, v98, v99
    v_cvt_pk_bf16_f32 v113, v100, v101
    v_cvt_pk_bf16_f32 v114, v102, v103
    v_dot2_f32_bf16 v14, v110, v48, 0
    v_dot2_f32_bf16 v14, v111, v49, v14
    v_dot2_f32_bf16 v14, v112, v50, v14
    v_dot2_f32_bf16 v14, v113, v51, v14
    s_mov_b64 exec, 0xffffffff
    v_dot2_f32_bf16 v14, v114, v34, v14
    s_mov_b64 exec, -1
    s_nop 1
    v_mov_b32 v15, v14
    s_nop 1
    v_permlane32_swap_b32 v15, v14
    v_add_f32 v14, v15, v14
    v_mov_b32 v15, v14
    s_nop 1
    v_permlane16_swap_b32 v15, v14
    v_add_f32 v14, v15, v14
    s_nop 1
    v_add_f32_dpp v14, v14, v14 row_ror:8 row_mask:0xf bank_mask:0xf
    s_nop 1
    v_add_f32_dpp v14, v14, v14 row_ror:4 row_mask:0xf bank_mask:0xf
    s_nop 1
    v_add_f32_dpp v14, v14, v14 quad_perm:[2,3,0,1] row_mask:0xf bank_mask:0xf
    s_nop 1
    v_add_f32_dpp v14, v14, v14 quad_perm:[1,0,3,2] row_mask:0xf bank_mask:0xf
    v_cvt_pk_bf16_f32 v14, v14, v14
    v_lshlrev_b32 v14, 16, v14
    v_max_f32 v14, 0xc2ae0000, v14
    v_min_f32 v14, 0x43000000, v14
    v_mul_f32 v15, 0xbfb8aa3b, v14
    v_fma_f32 v16, v14, s98, -v15
    v_fmac_f32 v16, 0xb2a57060, v14
    v_exp_f32 v15, v15
    v_mul_f32 v16, 0x3f317218, v16
    v_fmac_f32 v15, v15, v16
    v_add_f32 v15, 1.0, v15
    v_rcp_f32 v16, v15
    s_nop 0
    v_fma_f32 v15, -v15, v16, 1.0
    v_fma_f32 v14, v15, v16, v16
    v_cvt_pk_bf16_f32 v14, v14, v14
    v_lshlrev_b32 v14, 16, v14
    v_add_f32 v41, v40, v104
    v_cvt_pk_bf16_f32 v41, v41, v41
    v_lshlrev_b32 v41, 16, v41
    v_mul_f32 v41, v41, v106
    v_cvt_pk_bf16_f32 v41, v41, v41
    v_lshlrev_b32 v41, 16, v41
    v_mul_f32 v41, v41, v79
    v_cvt_pk_bf16_f32 v41, v41, v41
    v_lshlrev_b32 v41, 16, v41
    v_add_f32 v41, v41, v77
    v_cvt_pk_bf16_f32 v41, v41, v41
    v_lshlrev_b32 v41, 16, v41
    s_and_b32 s62, s64, 1
    s_lshl1_add_u32 s58, s65, s62
    s_lshl3_add_u32 s58, s58, s3
    s_branch .Lsk_m2_2
.Lst_m2_2:
    s_branch .Lrt_m2_2
.Lsk_m2_2:
    s_mul_i32 s58, s58, 9216
    s_add_u32 s58, s58, 0x1a0000
    s_add_u32 s59, s58, 4096
    s_add_u32 s63, s58, 8192
    s_cmp_eq_u32 s62, 0
    s_mov_b32 s56, 0x00ff00ff
    s_cselect_b32 s62, s56, 0xff00ff00
    s_mov_b32 s60, 0x04000c0c
    s_mov_b32 s61, 0x0706000c
    s_mov_b32 s48, s28
    s_and_b32 s49, s29, 0xffff
    s_mov_b32 s50, 0x2400
    s_mov_b32 s51, 0x00020000
.gp_118:
    buffer_load_dwordx4 v[120:123], v2, s[36:39], s58 offen offset:0 sc1
    buffer_load_dwordx4 v[124:127], v2, s[36:39], s58 offen offset:1024 sc1
    buffer_load_dwordx4 v[128:131], v2, s[36:39], s58 offen offset:2048 sc1
    buffer_load_dwordx4 v[132:135], v2, s[36:39], s58 offen offset:3072 sc1
    buffer_load_dwordx4 v[136:139], v2, s[36:39], s59 offen offset:0 sc1
    buffer_load_dwordx4 v[140:143], v2, s[36:39], s59 offen offset:1024 sc1
    buffer_load_dwordx4 v[144:147], v2, s[36:39], s59 offen offset:2048 sc1
    buffer_load_dwordx4 v[148:151], v2, s[36:39], s59 offen offset:3072 sc1
    buffer_load_dwordx4 v[152:155], v2, s[36:39], s63 offen offset:0 sc1
    s_waitcnt vmcnt(0)
.gpc_119:
    v_min3_u32 v24, v123, v127, v131
    v_max3_u32 v25, v123, v127, v131
    v_min3_u32 v24, v24, v135, v139
    v_max3_u32 v25, v25, v135, v139
    v_min3_u32 v24, v24, v143, v147
    v_max3_u32 v25, v25, v143, v147
    v_min3_u32 v24, v24, v151, v155
    v_max3_u32 v25, v25, v151, v155
    v_cmp_eq_u32 vcc, s34, v24
    v_cmp_eq_u32 s[56:57], s34, v25
    s_and_b64 vcc, vcc, s[56:57]
    s_cmp_eq_u64 vcc, -1
    s_nop 2
    s_cbranch_scc1 .gpd_120
    s_sub_u32 s35, s35, 1
    s_cbranch_scc1 .Lexit
    s_branch .gp_118
.gpd_120:
    v_perm_b32 v123, v120, v121, s60
    v_perm_b32 v123, v123, v122, s61
    v_perm_b32 v127, v124, v125, s60
    v_perm_b32 v127, v127, v126, s61
    v_perm_b32 v131, v128, v129, s60
    v_perm_b32 v131, v131, v130, s61
    v_perm_b32 v135, v132, v133, s60
    v_perm_b32 v135, v135, v134, s61
    v_perm_b32 v139, v136, v137, s60
    v_perm_b32 v139, v139, v138, s61
    v_perm_b32 v143, v140, v141, s60
    v_perm_b32 v143, v143, v142, s61
    v_perm_b32 v147, v144, v145, s60
    v_perm_b32 v147, v147, v146, s61
    v_perm_b32 v151, v148, v149, s60
    v_perm_b32 v151, v151, v150, s61
    v_perm_b32 v155, v152, v153, s60
    v_perm_b32 v155, v155, v154, s61
    v_pk_add_f32 v[120:121], v[120:121], v[124:125]
    v_pk_add_f32 v[122:123], v[122:123], v[126:127]
    v_pk_add_f32 v[128:129], v[128:129], v[132:133]
    v_pk_add_f32 v[130:131], v[130:131], v[134:135]
    v_pk_add_f32 v[136:137], v[136:137], v[140:141]
    v_pk_add_f32 v[138:139], v[138:139], v[142:143]
    v_pk_add_f32 v[144:145], v[144:145], v[148:149]
    v_pk_add_f32 v[146:147], v[146:147], v[150:151]
    v_pk_add_f32 v[120:121], v[120:121], v[128:129]
    v_pk_add_f32 v[122:123], v[122:123], v[130:131]
    v_pk_add_f32 v[136:137], v[136:137], v[144:145]
    v_pk_add_f32 v[138:139], v[138:139], v[146:147]
    v_pk_add_f32 v[120:121], v[120:121], v[136:137]
    v_pk_add_f32 v[122:123], v[122:123], v[138:139]
    v_pk_add_f32 v[120:121], v[120:121], v[152:153]
    v_pk_add_f32 v[122:123], v[122:123], v[154:155]
    s_nop 1
    v_permlane32_swap_b32 v120, v122
    v_permlane32_swap_b32 v121, v123
    v_pk_add_f32 v[120:121], v[120:121], v[122:123]
    s_nop 1
    v_permlane16_swap_b32 v120, v121
    v_add_f32 v120, v120, v121
    s_nop 1
    v_add_f32_dpp v120, v120, v120 row_ror:8 row_mask:0xf bank_mask:0xf
    v_cvt_pk_bf16_f32 v120, v120, v120
    v_lshlrev_b32 v120, 16, v120
    v_mul_f32 v120, v120, v14
    v_cvt_pk_bf16_f32 v120, v120, v120
    v_lshlrev_b32 v120, 16, v120
    v_add_f32 v120, v120, v41
    v_cvt_pk_bf16_f32 v120, v120, v120
    v_lshlrev_b32 v120, 16, v120
    v_mul_f32 v120, v120, v81
    v_cvt_pk_bf16_f32 v120, v120, v120
    v_lshlrev_b32 v120, 16, v120
    v_add_f32 v120, v120, v40
    v_cvt_pk_bf16_f32 v120, v120, v120
    s_mov_b32 exec_lo, s62
    s_mov_b32 exec_hi, s62
    buffer_store_short v120, v7, s[48:51], s100 offen
    s_mov_b64 exec, -1
    s_or_b32 s56, s2, s3
    s_cmp_lg_u32 s56, 0
    s_cbranch_scc1 .Lexit
    v_mov_b32 v13, s34
    v_mov_b32 v12, 0
    s_mov_b64 exec, 1
    buffer_store_dword v13, v12, s[36:39], 0 offen
    s_mov_b64 exec, -1
    s_branch .Lexit
.Lbc:
    s_branch .Lsk_b0_0
.Lst_b0_0:
    s_branch .Lrt_b0_0
.Lsk_b0_0:
    s_sub_u32 s56, s65, 9
    s_mov_b32 s57, 0x63054210
    s_cmp_eq_u32 s65, 14
    s_cselect_b32 s56, s64, s56
    s_cselect_b32 s57, 0x37654210, s57
    s_cselect_b32 s99, 8, s64
    s_lshl_b32 s56, s56, 2
    s_lshr_b32 s56, s57, s56
    s_and_b32 s56, s56, 7
    s_cmp_eq_u32 s65, 17
    s_cselect_b32 s56, 7, s56
    s_lshl3_add_u32 s99, s99, s56
    s_and_b32 s56, s99, 7
    s_cmp_eq_u32 s56, 3
    s_mov_b32 s14, 0xb5b5b5b5
    s_cselect_b32 s14, 0x0, s14
    s_mov_b32 s15, 0xd6d6b6b6
    s_cselect_b32 s15, 0x0, s15
    s_cselect_b32 s30, -50, 0
    s_add_u32 s30, s30, 0
    s_add_u32 s30, s30, s70
    s_mov_b32 s31, s70
    s_mov_b32 s48, s18
    s_and_b32 s49, s19, 0xffff
    s_mov_b32 s50, 0x510000
    s_mov_b32 s51, 0x00020000
    s_mov_b32 s52, s20
    s_and_b32 s53, s21, 0xffff
    s_mov_b32 s54, 0x510000
    s_mov_b32 s55, 0x00020000
    v_bfe_u32 v12, v0, 4, 1
    s_and_b32 s56, s3, 3
    s_lshl_b32 s56, s56, 1
    v_or_b32 v12, s56, v12
    v_and_b32 v6, 7, v0
    v_xor_b32 v12, v12, v6
    v_lshrrev_b32 v6, 3, v0
    v_mul_u32_u24 v6, 9216, v6
    v_lshl_add_u32 v6, v12, 4, v6
    s_mul_i32 s100, s3, 73728
    s_lshl_b32 s56, s99, 7
    s_add_u32 s100, s100, s56
    s_lshl_b32 s101, s3, 10
    s_waitcnt lgkmcnt(0)
    s_add_u32 s34, s34, 1
    s_getreg_b32 s1, hwreg(HW_REG_XCC_ID)
    s_lshl_b32 s1, s1, 24
    s_add_u32 s1, s1, s34
    s_lshr_b32 s0, s2, 3
    s_lshl_b32 s63, s64, 8
    s_add_u32 s0, s0, s63
    s_lshl2_add_u32 s0, s0, 0x480000
    v_mov_b32 v30, s1
    s_cmp_eq_u32 s3, 0
    s_cselect_b64 exec, 1, 0
    buffer_store_dword v30, v2, s[36:39], s0 offen sc1
    s_mov_b64 exec, -1
    v_and_b32 v8, 1, v0
    v_lshlrev_b32 v8, 8, v8
    v_and_b32 v9, 0x3c, v0
    v_lshl_add_u32 v9, v9, 2, v8
    v_add_u32 v7, v9, v8
    v_and_b32 v9, 0x3c, v0
    v_lshrrev_b32 v8, 4, v8
    v_and_b32 v9, 4, v0
    v_lshl_add_u32 v9, v9, 3, v8
    s_lshl_b32 s58, s66, 14
    s_lshl_b32 s59, s67, 10
    s_add_u32 s58, s58, s59
    s_add_u32 s58, s58, 0x70000
    s_lshl4_add_u32 s59, s66, s67
    s_lshl_b32 s59, s59, 7
    s_add_u32 s59, s59, 0x430000
    s_bitcmp1_b64 s[14:15], 4
    s_cbranch_scc0 1
    s_waitcnt vmcnt(4)
    s_add_u32 s63, s69, 32768
    buffer_load_dwordx4 v[96:99], v1, s[40:43], s63 offen nt
    s_waitcnt vmcnt(6)
    s_add_u32 m0, s101, 0
    s_add_u32 s56, s100, 0
    buffer_load_dwordx4 v6, s[48:51], s56 offen nt lds
    s_waitcnt vmcnt(6)
    s_bitcmp1_b64 s[14:15], 5
    s_cbranch_scc0 1
    s_waitcnt vmcnt(4)
    s_add_u32 s63, s69, 40960
    buffer_load_dwordx4 v[100:103], v1, s[40:43], s63 offen nt
    s_waitcnt vmcnt(6)
    s_bitcmp1_b64 s[14:15], 6
    s_cbranch_scc0 1
    s_waitcnt vmcnt(2)
    s_add_u32 s63, s69, 49152
    buffer_load_dwordx4 v[128:131], v1, s[40:43], s63 offen nt
    s_cmp_eq_u32 s3, 0
    s_cbranch_scc1 .Lst_b1_0
    s_cmp_eq_u32 s3, 1
    s_cbranch_scc1 .Lst_b1_1
    s_cmp_eq_u32 s3, 2
    s_cbranch_scc1 .Lst_b1_2
    s_cmp_eq_u32 s3, 3
    s_cbranch_scc1 .Lst_b1_3
    s_cmp_eq_u32 s3, 4
    s_cbranch_scc1 .Lst_b1_4
    s_cmp_eq_u32 s3, 5
    s_cbranch_scc1 .Lst_b1_5
    s_cmp_eq_u32 s3, 6
    s_cbranch_scc1 .Lst_b1_6
    s_cmp_eq_u32 s3, 7
    s_cbranch_scc1 .Lst_b1_7
.Lrt_b1_0:
.Lrt_b1_1:
.Lrt_b1_2:
.Lrt_b1_3:
.Lrt_b1_4:
.Lrt_b1_5:
.Lrt_b1_6:
.Lrt_b1_7:
    s_waitcnt vmcnt(6)
    s_add_u32 m0, s101, 8192
    s_add_u32 s56, s100, 589824
    buffer_load_dwordx4 v6, s[48:51], s56 offen nt lds
    s_waitcnt vmcnt(4)
    s_bitcmp1_b64 s[14:15], 7
    s_cbranch_scc0 1
    s_waitcnt vmcnt(2)
    s_add_u32 s63, s69, 57344
    buffer_load_dwordx4 v[132:135], v1, s[40:43], s63 offen nt
    s_waitcnt vmcnt(4)
    s_bitcmp1_b64 s[14:15], 8
    s_cbranch_scc0 1
    s_waitcnt vmcnt(2)
    s_add_u32 s63, s69, 131072
    buffer_load_dwordx4 v[40:43], v1, s[40:43], s63 offen nt
    s_memrealtime s[8:9]
    s_waitcnt lgkmcnt(0)
    s_sub_u32 s8, s8, s30
    s_cmpk_ge_u32 s8, 437
    s_cbranch_scc1 .ap_121
    s_waitcnt vmcnt(5)
    s_cmpk_ge_u32 s8, 337
    s_cbranch_scc1 .ap_121
    s_waitcnt vmcnt(4)
    s_bitcmp1_b64 s[14:15], 9
    s_cbranch_scc0 1
    s_waitcnt vmcnt(2)
    s_cmpk_ge_u32 s8, 217
    s_cbranch_scc1 .ap_121
    s_waitcnt vmcnt(1)
.ap_121:
    s_add_u32 s63, s69, 139264
    buffer_load_dwordx4 v[44:47], v1, s[40:43], s63 offen nt
    s_memrealtime s[8:9]
    s_waitcnt lgkmcnt(0)
    s_sub_u32 s8, s8, s30
    s_cmpk_ge_u32 s8, 471
    s_cbranch_scc1 .ap_122
    s_waitcnt vmcnt(5)
    s_cmpk_ge_u32 s8, 371
    s_cbranch_scc1 .ap_122
    s_waitcnt vmcnt(4)
    s_bitcmp1_b64 s[14:15], 10
    s_cbranch_scc0 1
    s_waitcnt vmcnt(2)
    s_cmpk_ge_u32 s8, 251
    s_cbranch_scc1 .ap_122
    s_waitcnt vmcnt(1)
.ap_122:
    s_add_u32 s63, s69, 147456
    buffer_load_dwordx4 v[72:75], v1, s[40:43], s63 offen nt
    s_memrealtime s[8:9]
    s_waitcnt lgkmcnt(0)
    s_sub_u32 s8, s8, s30
    s_cmpk_ge_u32 s8, 505
    s_cbranch_scc1 .ap_123
    s_waitcnt vmcnt(5)
    s_cmpk_ge_u32 s8, 405
    s_cbranch_scc1 .ap_123
    s_waitcnt vmcnt(4)
    s_cmpk_ge_u32 s8, 285
    s_cbranch_scc1 .ap_123
    s_waitcnt vmcnt(1)
.ap_123:
    s_add_u32 m0, s101, 16384
    s_add_u32 s56, s100, 1179648
    buffer_load_dwordx4 v6, s[48:51], s56 offen nt lds
    s_memrealtime s[8:9]
    s_waitcnt lgkmcnt(0)
    s_sub_u32 s8, s8, s30
    s_cmpk_ge_u32 s8, 505
    s_cbranch_scc1 .ap_124
    s_waitcnt vmcnt(5)
    s_cmpk_ge_u32 s8, 405
    s_cbranch_scc1 .ap_124
    s_waitcnt vmcnt(4)
    s_bitcmp1_b64 s[14:15], 11
    s_cbranch_scc0 1
    s_waitcnt vmcnt(2)
    s_cmpk_ge_u32 s8, 285
    s_cbranch_scc1 .ap_124
    s_waitcnt vmcnt(1)
.ap_124:
    s_add_u32 s63, s69, 155648
    buffer_load_dwordx4 v[76:79], v1, s[40:43], s63 offen nt
    s_memrealtime s[8:9]
    s_waitcnt vmcnt(8)
    s_waitcnt lgkmcnt(0)
    s_sub_u32 s8, s8, s30
    s_cmpk_ge_u32 s8, 539
    s_cbranch_scc1 .ap_125
    s_waitcnt vmcnt(5)
    s_cmpk_ge_u32 s8, 439
    s_cbranch_scc1 .ap_125
    s_waitcnt vmcnt(4)
    s_bitcmp1_b64 s[14:15], 12
    s_cbranch_scc0 1
    s_waitcnt vmcnt(2)
    s_cmpk_ge_u32 s8, 319
    s_cbranch_scc1 .ap_125
    s_waitcnt vmcnt(1)
.ap_125:
    s_add_u32 s63, s69, 163840
    buffer_load_dwordx4 v[104:107], v1, s[40:43], s63 offen nt
    v_and_b32 v157, 7, v0
    v_lshlrev_b32 v157, 2, v157
    s_branch .Lsk_b0_1
.Lst_b0_1:
    s_branch .Lrt_b0_1
.Lsk_b0_1:
    s_mov_b32 s63, 0x4a1100
    buffer_load_dword v156, v157, s[36:39], s63 offen
    s_memrealtime s[8:9]
    s_waitcnt vmcnt(9)
    s_waitcnt lgkmcnt(0)
    s_sub_u32 s8, s8, s30
    s_cmpk_ge_u32 s8, 573
    s_cbranch_scc1 .ap_126
    s_waitcnt vmcnt(6)
    s_cmpk_ge_u32 s8, 473
    s_cbranch_scc1 .ap_126
    s_waitcnt vmcnt(5)
    s_bitcmp1_b64 s[14:15], 13
    s_cbranch_scc0 1
    s_waitcnt vmcnt(3)
    s_cmpk_ge_u32 s8, 353
    s_cbranch_scc1 .ap_126
    s_waitcnt vmcnt(2)
.ap_126:
    s_add_u32 s63, s69, 172032
    buffer_load_dwordx4 v[108:111], v1, s[40:43], s63 offen nt
    s_memrealtime s[8:9]
    s_waitcnt vmcnt(9)
    s_waitcnt lgkmcnt(0)
    s_sub_u32 s8, s8, s30
    s_cmpk_ge_u32 s8, 607
    s_cbranch_scc1 .ap_127
    s_waitcnt vmcnt(6)
    s_cmpk_ge_u32 s8, 507
    s_cbranch_scc1 .ap_127
    s_waitcnt vmcnt(5)
    s_bitcmp1_b64 s[14:15], 14
    s_cbranch_scc0 1
    s_waitcnt vmcnt(3)
    s_cmpk_ge_u32 s8, 387
    s_cbranch_scc1 .ap_127
    s_waitcnt vmcnt(2)
.ap_127:
    s_add_u32 s63, s69, 180224
    buffer_load_dwordx4 v[136:139], v1, s[40:43], s63 offen nt
    s_memrealtime s[8:9]
    s_waitcnt vmcnt(9)
    s_waitcnt lgkmcnt(0)
    s_sub_u32 s8, s8, s30
    s_cmpk_ge_u32 s8, 641
    s_cbranch_scc1 .ap_128
    s_waitcnt vmcnt(6)
    s_cmpk_ge_u32 s8, 541
    s_cbranch_scc1 .ap_128
    s_waitcnt vmcnt(5)
    s_cmpk_ge_u32 s8, 421
    s_cbranch_scc1 .ap_128
    s_waitcnt vmcnt(1)
.ap_128:
    s_add_u32 m0, s101, 24576
    s_add_u32 s56, s100, 1769472
    buffer_load_dwordx4 v6, s[48:51], s56 offen nt lds
    s_memrealtime s[8:9]
    s_waitcnt vmcnt(9)
    s_waitcnt lgkmcnt(0)
    s_sub_u32 s8, s8, s30
    s_cmpk_ge_u32 s8, 641
    s_cbranch_scc1 .ap_129
    s_waitcnt vmcnt(6)
    s_cmpk_ge_u32 s8, 541
    s_cbranch_scc1 .ap_129
    s_waitcnt vmcnt(5)
    s_bitcmp1_b64 s[14:15], 15
    s_cbranch_scc0 1
    s_waitcnt vmcnt(2)
    s_cmpk_ge_u32 s8, 421
    s_cbranch_scc1 .ap_129
    s_waitcnt vmcnt(1)
.ap_129:
    s_add_u32 s63, s69, 188416
    buffer_load_dwordx4 v[140:143], v1, s[40:43], s63 offen nt
    s_memrealtime s[8:9]
    s_waitcnt vmcnt(9)
    s_waitcnt lgkmcnt(0)
    s_sub_u32 s8, s8, s30
    s_cmpk_ge_u32 s8, 675
    s_cbranch_scc1 .ap_130
    s_waitcnt vmcnt(6)
    s_cmpk_ge_u32 s8, 575
    s_cbranch_scc1 .ap_130
    s_waitcnt vmcnt(5)
    s_bitcmp1_b64 s[14:15], 16
    s_cbranch_scc0 1
    s_waitcnt vmcnt(2)
    s_cmpk_ge_u32 s8, 455
    s_cbranch_scc1 .ap_130
    s_waitcnt vmcnt(1)
.ap_130:
    s_add_u32 s63, s69, 262144
    buffer_load_dwordx4 v[48:51], v1, s[40:43], s63 offen nt
    s_waitcnt vmcnt(5)
    s_sub_u32 s63, s70, 300
    v_subrev_u32 v156, s63, v156
    v_mov_b32 v157, 600
    v_cmp_lt_u32 s[8:9], v156, v157
    v_add_u32_dpp v156, v156, v156 quad_perm:[1,0,3,2] row_mask:0xf bank_mask:0xf
    s_nop 1
    v_add_u32_dpp v156, v156, v156 quad_perm:[2,3,0,1] row_mask:0xf bank_mask:0xf
    s_nop 1
    v_add_u32_dpp v156, v156, v156 row_ror:4 row_mask:0xf bank_mask:0xf
    s_nop 0
    v_readfirstlane_b32 s63, v156
    s_cmp_eq_u64 s[8:9], -1
    s_nop 3
    s_cbranch_scc0 .et_131
    s_lshr_b32 s63, s63, 3
    s_sub_u32 s63, s63, 300
    s_add_u32 s30, s30, s63
    s_add_u32 s31, s31, s63
.et_131:
    s_memrealtime s[8:9]
    s_waitcnt lgkmcnt(0)
    s_sub_u32 s8, s8, s30
    s_cmpk_ge_u32 s8, 709
    s_cbranch_scc1 .ap_132
    s_waitcnt vmcnt(5)
    s_cmpk_ge_u32 s8, 609
    s_cbranch_scc1 .ap_132
    s_waitcnt vmcnt(4)
    s_bitcmp1_b64 s[14:15], 17
    s_cbranch_scc0 1
    s_waitcnt vmcnt(2)
    s_cmpk_ge_u32 s8, 489
    s_cbranch_scc1 .ap_132
    s_waitcnt vmcnt(1)
.ap_132:
    s_add_u32 s63, s69, 270336
    buffer_load_dwordx4 v[52:55], v1, s[40:43], s63 offen nt
    s_memrealtime s[8:9]
    s_waitcnt lgkmcnt(0)
    s_sub_u32 s8, s8, s30
    s_cmpk_ge_u32 s8, 744
    s_cbranch_scc1 .ap_133
    s_waitcnt vmcnt(5)
    s_cmpk_ge_u32 s8, 644
    s_cbranch_scc1 .ap_133
    s_waitcnt vmcnt(4)
    s_bitcmp1_b64 s[14:15], 18
    s_cbranch_scc0 1
    s_waitcnt vmcnt(2)
    s_cmpk_ge_u32 s8, 524
    s_cbranch_scc1 .ap_133
    s_waitcnt vmcnt(1)
.ap_133:
    s_add_u32 s63, s69, 278528
    buffer_load_dwordx4 v[80:83], v1, s[40:43], s63 offen nt
    s_memrealtime s[8:9]
    s_waitcnt lgkmcnt(0)
    s_sub_u32 s8, s8, s30
    s_cmpk_ge_u32 s8, 779
    s_cbranch_scc1 .ap_134
    s_waitcnt vmcnt(5)
    s_cmpk_ge_u32 s8, 679
    s_cbranch_scc1 .ap_134
    s_waitcnt vmcnt(4)
    s_cmpk_ge_u32 s8, 559
    s_cbranch_scc1 .ap_134
    s_waitcnt vmcnt(1)
.ap_134:
    s_add_u32 m0, s101, 32768
    s_add_u32 s56, s100, 2359296
    buffer_load_dwordx4 v6, s[48:51], s56 offen nt lds
    s_memrealtime s[8:9]
    s_waitcnt lgkmcnt(0)
    s_sub_u32 s8, s8, s30
    s_cmpk_ge_u32 s8, 779
    s_cbranch_scc1 .ap_135
    s_waitcnt vmcnt(5)
    s_cmpk_ge_u32 s8, 679
    s_cbranch_scc1 .ap_135
    s_waitcnt vmcnt(4)
    s_bitcmp1_b64 s[14:15], 19
    s_cbranch_scc0 1
    s_waitcnt vmcnt(2)
    s_cmpk_ge_u32 s8, 559
    s_cbranch_scc1 .ap_135
    s_waitcnt vmcnt(1)
.ap_135:
    s_add_u32 s63, s69, 286720
    buffer_load_dwordx4 v[84:87], v1, s[40:43], s63 offen nt
    s_memrealtime s[8:9]
    s_waitcnt vmcnt(8)
    s_waitcnt lgkmcnt(0)
    s_sub_u32 s8, s8, s30
    s_cmpk_ge_u32 s8, 814
    s_cbranch_scc1 .ap_136
    s_waitcnt vmcnt(5)
    s_cmpk_ge_u32 s8, 714
    s_cbranch_scc1 .ap_136
    s_waitcnt vmcnt(4)
    s_bitcmp1_b64 s[14:15], 20
    s_cbranch_scc0 1
    s_waitcnt vmcnt(2)
    s_cmpk_ge_u32 s8, 594
    s_cbranch_scc1 .ap_136
    s_waitcnt vmcnt(1)
.ap_136:
    s_add_u32 s63, s69, 294912
    buffer_load_dwordx4 v[112:115], v1, s[40:43], s63 offen nt
    s_memrealtime s[8:9]
    s_waitcnt vmcnt(8)
    s_waitcnt lgkmcnt(0)
    s_sub_u32 s8, s8, s30
    s_cmpk_ge_u32 s8, 849
    s_cbranch_scc1 .ap_137
    s_waitcnt vmcnt(5)
    s_cmpk_ge_u32 s8, 749
    s_cbranch_scc1 .ap_137
    s_waitcnt vmcnt(4)
    s_bitcmp1_b64 s[14:15], 21
    s_cbranch_scc0 1
    s_waitcnt vmcnt(2)
    s_cmpk_ge_u32 s8, 629
    s_cbranch_scc1 .ap_137
    s_waitcnt vmcnt(1)
.ap_137:
    s_add_u32 s63, s69, 303104
    buffer_load_dwordx4 v[116:119], v1, s[40:43], s63 offen nt
    s_memrealtime s[8:9]
    s_waitcnt vmcnt(8)
    s_waitcnt lgkmcnt(0)
    s_sub_u32 s8, s8, s30
    s_cmpk_ge_u32 s8, 884
    s_cbranch_scc1 .ap_138
    s_waitcnt vmcnt(5)
    s_cmpk_ge_u32 s8, 784
    s_cbranch_scc1 .ap_138
    s_waitcnt vmcnt(4)
    s_bitcmp1_b64 s[14:15], 22
    s_cbranch_scc0 1
    s_waitcnt vmcnt(2)
    s_cmpk_ge_u32 s8, 664
    s_branch .Lsk_b0_2
.Lst_b0_2:
    s_branch .Lrt_b0_2
.Lsk_b0_2:
    s_cbranch_scc1 .ap_138
    s_waitcnt vmcnt(1)
.ap_138:
    s_add_u32 s63, s69, 311296
    buffer_load_dwordx4 v[144:147], v1, s[40:43], s63 offen nt
    s_memrealtime s[8:9]
    s_waitcnt vmcnt(8)
    s_waitcnt lgkmcnt(0)
    s_sub_u32 s8, s8, s30
    s_cmpk_ge_u32 s8, 919
    s_cbranch_scc1 .ap_139
    s_waitcnt vmcnt(5)
    s_cmpk_ge_u32 s8, 819
    s_cbranch_scc1 .ap_139
    s_waitcnt vmcnt(4)
    s_cmpk_ge_u32 s8, 699
    s_cbranch_scc1 .ap_139
    s_waitcnt vmcnt(1)
.ap_139:
    s_add_u32 m0, s101, 40960
    s_add_u32 s56, s100, 2949120
    buffer_load_dwordx4 v6, s[48:51], s56 offen nt lds
    s_memrealtime s[8:9]
    s_waitcnt vmcnt(8)
    s_waitcnt lgkmcnt(0)
    s_branch .Lsk_b0_3
.Lst_b0_3:
    s_branch .Lrt_b0_3
.Lsk_b0_3:
    s_sub_u32 s8, s8, s30
    s_cmpk_ge_u32 s8, 919
    s_cbranch_scc1 .ap_140
    s_waitcnt vmcnt(5)
    s_cmpk_ge_u32 s8, 819
    s_cbranch_scc1 .ap_140
    s_waitcnt vmcnt(4)
    s_bitcmp1_b64 s[14:15], 23
    s_cbranch_scc0 1
    s_waitcnt vmcnt(2)
    s_cmpk_ge_u32 s8, 699
    s_cbranch_scc1 .ap_140
    s_waitcnt vmcnt(1)
.ap_140:
    s_add_u32 s63, s69, 319488
    buffer_load_dwordx4 v[148:151], v1, s[40:43], s63 offen nt
    s_memrealtime s[8:9]
    s_waitcnt vmcnt(8)
    s_waitcnt lgkmcnt(0)
    s_sub_u32 s8, s8, s30
    s_cmpk_ge_u32 s8, 954
    s_cbranch_scc1 .ap_141
    s_waitcnt vmcnt(5)
    s_cmpk_ge_u32 s8, 854
    s_cbranch_scc1 .ap_141
    s_waitcnt vmcnt(4)
    s_bitcmp1_b64 s[14:15], 24
    s_cbranch_scc0 1
    s_waitcnt vmcnt(2)
    s_cmpk_ge_u32 s8, 734
    s_cbranch_scc1 .ap_141
    s_waitcnt vmcnt(1)
.ap_141:
    s_add_u32 s63, s69, 393216
    buffer_load_dwordx4 v[56:59], v1, s[40:43], s63 offen nt
    s_memrealtime s[8:9]
    s_waitcnt vmcnt(8)
    s_waitcnt lgkmcnt(0)
    s_sub_u32 s8, s8, s30
    s_cmpk_ge_u32 s8, 990
    s_cbranch_scc1 .ap_142
    s_waitcnt vmcnt(5)
    s_cmpk_ge_u32 s8, 890
    s_cbranch_scc1 .ap_142
    s_waitcnt vmcnt(4)
    s_bitcmp1_b64 s[14:15], 25
    s_cbranch_scc0 1
    s_waitcnt vmcnt(2)
    s_cmpk_ge_u32 s8, 770
    s_cbranch_scc1 .ap_142
    s_waitcnt vmcnt(1)
.ap_142:
    s_add_u32 s63, s69, 401408
    buffer_load_dwordx4 v[60:63], v1, s[40:43], s63 offen nt
    s_memrealtime s[8:9]
    s_waitcnt vmcnt(8)
    s_waitcnt lgkmcnt(0)
    s_sub_u32 s8, s8, s30
    s_cmpk_ge_u32 s8, 1028
    s_cbranch_scc1 .ap_143
    s_waitcnt vmcnt(5)
    s_cmpk_ge_u32 s8, 928
    s_cbranch_scc1 .ap_143
    s_waitcnt vmcnt(4)
    s_bitcmp1_b64 s[14:15], 26
    s_cbranch_scc0 1
    s_waitcnt vmcnt(2)
    s_cmpk_ge_u32 s8, 808
    s_cbranch_scc1 .ap_143
    s_waitcnt vmcnt(1)
.ap_143:
    s_add_u32 s63, s69, 409600
    buffer_load_dwordx4 v[88:91], v1, s[40:43], s63 offen nt
    s_memrealtime s[8:9]
    s_waitcnt vmcnt(8)
    s_waitcnt lgkmcnt(0)
    s_sub_u32 s8, s8, s30
    s_cmpk_ge_u32 s8, 1067
    s_cbranch_scc1 .ap_144
    s_waitcnt vmcnt(5)
    s_cmpk_ge_u32 s8, 967
    s_cbranch_scc1 .ap_144
    s_waitcnt vmcnt(4)
    s_cmpk_ge_u32 s8, 847
    s_cbranch_scc1 .ap_144
    s_waitcnt vmcnt(1)
.ap_144:
    s_add_u32 m0, s101, 49152
    s_add_u32 s56, s100, 3538944
    buffer_load_dwordx4 v6, s[48:51], s56 offen nt lds
    s_memrealtime s[8:9]
    s_waitcnt vmcnt(8)
    s_waitcnt lgkmcnt(0)
    s_sub_u32 s8, s8, s30
    s_cmpk_ge_u32 s8, 1067
    s_cbranch_scc1 .ap_145
    s_waitcnt vmcnt(5)
    s_cmpk_ge_u32 s8, 967
    s_cbranch_scc1 .ap_145
    s_waitcnt vmcnt(4)
    s_bitcmp1_b64 s[14:15], 27
    s_cbranch_scc0 1
    s_waitcnt vmcnt(2)
    s_cmpk_ge_u32 s8, 847
    s_cbranch_scc1 .ap_145
    s_waitcnt vmcnt(1)
.ap_145:
    s_add_u32 s63, s69, 417792
    buffer_load_dwordx4 v[92:95], v1, s[40:43], s63 offen nt
    s_memrealtime s[8:9]
    s_waitcnt vmcnt(8)
    s_waitcnt lgkmcnt(0)
    s_sub_u32 s8, s8, s30
    s_cmpk_ge_u32 s8, 1106
    s_cbranch_scc1 .ap_146
    s_waitcnt vmcnt(5)
    s_cmpk_ge_u32 s8, 1006
    s_cbranch_scc1 .ap_146
    s_waitcnt vmcnt(4)
    s_bitcmp1_b64 s[14:15], 28
    s_cbranch_scc0 1
    s_waitcnt vmcnt(2)
    s_cmpk_ge_u32 s8, 886
    s_cbranch_scc1 .ap_146
    s_waitcnt vmcnt(1)
.ap_146:
    s_add_u32 s63, s69, 425984
    buffer_load_dwordx4 v[120:123], v1, s[40:43], s63 offen nt
    s_memrealtime s[8:9]
    s_waitcnt vmcnt(8)
    s_waitcnt lgkmcnt(0)
    s_sub_u32 s8, s8, s30
    s_cmpk_ge_u32 s8, 1145
    s_cbranch_scc1 .ap_147
    s_waitcnt vmcnt(5)
    s_cmpk_ge_u32 s8, 1045
    s_cbranch_scc1 .ap_147
    s_waitcnt vmcnt(4)
    s_bitcmp1_b64 s[14:15], 29
    s_cbranch_scc0 1
    s_waitcnt vmcnt(2)
    s_cmpk_ge_u32 s8, 925
    s_cbranch_scc1 .ap_147
    s_waitcnt vmcnt(1)
.ap_147:
    s_add_u32 s63, s69, 434176
    buffer_load_dwordx4 v[124:127], v1, s[40:43], s63 offen nt
    s_memrealtime s[8:9]
    s_waitcnt vmcnt(8)
    s_waitcnt lgkmcnt(0)
    s_sub_u32 s8, s8, s30
    s_cmpk_ge_u32 s8, 1184
    s_cbranch_scc1 .ap_148
    s_waitcnt vmcnt(5)
    s_cmpk_ge_u32 s8, 1084
    s_cbranch_scc1 .ap_148
    s_waitcnt vmcnt(4)
    s_bitcmp1_b64 s[14:15], 30
    s_cbranch_scc0 1
    s_waitcnt vmcnt(2)
    s_cmpk_ge_u32 s8, 964
    s_cbranch_scc1 .ap_148
    s_waitcnt vmcnt(1)
.ap_148:
    s_add_u32 s63, s69, 442368
    buffer_load_dwordx4 v[152:155], v1, s[40:43], s63 offen nt
    s_memrealtime s[8:9]
    s_waitcnt vmcnt(8)
    s_waitcnt lgkmcnt(0)
    s_sub_u32 s8, s8, s30
    s_cmpk_ge_u32 s8, 1223
    s_cbranch_scc1 .ap_149
    s_waitcnt vmcnt(5)
    s_cmpk_ge_u32 s8, 1123
    s_cbranch_scc1 .ap_149
    s_waitcnt vmcnt(4)
    s_cmpk_ge_u32 s8, 1003
    s_cbranch_scc1 .ap_149
    s_waitcnt vmcnt(1)
.ap_149:
    s_add_u32 m0, s101, 57344
    s_add_u32 s56, s100, 4128768
    buffer_load_dwordx4 v6, s[48:51], s56 offen nt lds
    s_memrealtime s[8:9]
    s_waitcnt vmcnt(8)
    s_waitcnt lgkmcnt(0)
    s_sub_u32 s8, s8, s30
    s_cmpk_ge_u32 s8, 1223
    s_cbranch_scc1 .ap_150
    s_waitcnt vmcnt(5)
    s_cmpk_ge_u32 s8, 1123
    s_cbranch_scc1 .ap_150
    s_waitcnt vmcnt(4)
    s_bitcmp1_b64 s[14:15], 31
    s_cbranch_scc0 1
    s_waitcnt vmcnt(2)
    s_cmpk_ge_u32 s8, 1003
    s_cbranch_scc1 .ap_150
    s_waitcnt vmcnt(1)
.ap_150:
    s_add_u32 s63, s69, 450560
    buffer_load_dwordx4 v[156:159], v1, s[40:43], s63 offen nt
    s_memrealtime s[8:9]
    s_waitcnt vmcnt(8)
    s_waitcnt lgkmcnt(0)
    s_sub_u32 s8, s8, s30
    s_cmpk_ge_u32 s8, 1262
    s_cbranch_scc1 .ap_151
    s_waitcnt vmcnt(5)
    s_cmpk_ge_u32 s8, 1162
    s_cbranch_scc1 .ap_151
    s_waitcnt vmcnt(4)
    s_bitcmp1_b64 s[14:15], 32
    s_cbranch_scc0 1
    s_waitcnt vmcnt(2)
    s_cmpk_ge_u32 s8, 1042
    s_cbranch_scc1 .ap_151
    s_waitcnt vmcnt(1)
.ap_151:
    v_bfe_u32 v1, v0, 4, 2
    v_and_b32 v10, 0xf0, v2
    v_lshlrev_b32 v1, 2, v1
    v_bfe_u32 v1, s6, v1, 4
    v_lshl_add_u32 v1, v1, 8, v10
    s_add_u32 s63, s69, 0
    buffer_load_dwordx4 v[160:163], v1, s[44:47], s63 offen nt
    s_memrealtime s[8:9]
    s_waitcnt vmcnt(8)
    s_waitcnt lgkmcnt(0)
    s_sub_u32 s8, s8, s30
    s_cmpk_ge_u32 s8, 1298
    s_cbranch_scc1 .ap_152
    s_waitcnt vmcnt(5)
    s_cmpk_ge_u32 s8, 1198
    s_cbranch_scc1 .ap_152
    s_waitcnt vmcnt(4)
    s_bitcmp1_b64 s[14:15], 33
    s_cbranch_scc0 1
    s_waitcnt vmcnt(2)
    s_cmpk_ge_u32 s8, 1078
    s_cbranch_scc1 .ap_152
    s_branch .Lsk_b1_0
.Lst_b1_0:
    s_branch .Lrt_b1_0
.Lsk_b1_0:
    s_waitcnt vmcnt(1)
.ap_152:
    s_add_u32 s63, s69, 8192
    buffer_load_dwordx4 v[164:167], v1, s[44:47], s63 offen nt
    s_memrealtime s[8:9]
    s_waitcnt vmcnt(8)
    s_waitcnt lgkmcnt(0)
    s_sub_u32 s8, s8, s30
    s_cmpk_ge_u32 s8, 1335
    s_cbranch_scc1 .ap_153
    s_waitcnt vmcnt(5)
    s_cmpk_ge_u32 s8, 1235
    s_cbranch_scc1 .ap_153
    s_waitcnt vmcnt(4)
    s_bitcmp1_b64 s[14:15], 34
    s_cbranch_scc0 1
    s_waitcnt vmcnt(2)
    s_cmpk_ge_u32 s8, 1115
    s_cbranch_scc1 .ap_153
    s_waitcnt vmcnt(1)
.ap_153:
    s_add_u32 s63, s69, 16384
    buffer_load_dwordx4 v[168:171], v1, s[44:47], s63 offen nt
    s_memrealtime s[8:9]
    s_waitcnt vmcnt(8)
    s_waitcnt lgkmcnt(0)
    s_sub_u32 s8, s8, s30
    s_cmpk_ge_u32 s8, 1371
    s_cbranch_scc1 .ap_154
    s_waitcnt vmcnt(5)
    s_cmpk_ge_u32 s8, 1271
    s_cbranch_scc1 .ap_154
    s_waitcnt vmcnt(4)
    s_cmpk_ge_u32 s8, 1151
    s_cbranch_scc1 .ap_154
    s_waitcnt vmcnt(1)
.ap_154:
    s_add_u32 m0, s101, 65536
    s_add_u32 s56, s100, 4718592
    buffer_load_dwordx4 v6, s[48:51], s56 offen nt lds
    s_memrealtime s[8:9]
    s_waitcnt vmcnt(8)
    s_waitcnt lgkmcnt(0)
    s_sub_u32 s8, s8, s30
    s_cmpk_ge_u32 s8, 1371
    s_cbranch_scc1 .ap_155
    s_waitcnt vmcnt(5)
    s_cmpk_ge_u32 s8, 1271
    s_cbranch_scc1 .ap_155
    s_waitcnt vmcnt(4)
    s_bitcmp1_b64 s[14:15], 35
    s_cbranch_scc0 1
    s_waitcnt vmcnt(2)
    s_cmpk_ge_u32 s8, 1151
    s_cbranch_scc1 .ap_155
    s_waitcnt vmcnt(1)
.ap_155:
    s_add_u32 s63, s69, 24576
    buffer_load_dwordx4 v[172:175], v1, s[44:47], s63 offen nt
    s_memrealtime s[8:9]
    s_waitcnt vmcnt(8)
    s_waitcnt lgkmcnt(0)
    s_sub_u32 s8, s8, s30
    s_cmpk_ge_u32 s8, 1408
    s_cbranch_scc1 .ap_156
    s_waitcnt vmcnt(5)
    s_cmpk_ge_u32 s8, 1308
    s_cbranch_scc1 .ap_156
    s_waitcnt vmcnt(4)
    s_bitcmp1_b64 s[14:15], 36
    s_cbranch_scc0 1
    s_waitcnt vmcnt(2)
    s_cmpk_ge_u32 s8, 1188
    s_cbranch_scc1 .ap_156
    s_waitcnt vmcnt(1)
.ap_156:
    s_add_u32 s63, s69, 32768
    buffer_load_dwordx4 v[176:179], v1, s[44:47], s63 offen nt
    buffer_load_dwordx4 v[16:19], v7, s[36:39], s58 offen offset:0 sc1
    buffer_load_dwordx4 v[20:23], v7, s[36:39], s58 offen offset:256 sc1
    s_memrealtime s[8:9]
    s_waitcnt vmcnt(8)
    s_waitcnt lgkmcnt(0)
    s_sub_u32 s8, s8, s30
    s_cmpk_ge_u32 s8, 1444
    s_cbranch_scc1 .ap_157
    s_waitcnt vmcnt(5)
    s_cmpk_ge_u32 s8, 1344
    s_cbranch_scc1 .ap_157
    s_waitcnt vmcnt(4)
    s_bitcmp1_b64 s[14:15], 37
    s_cbranch_scc0 1
    s_waitcnt vmcnt(2)
    s_cmpk_ge_u32 s8, 1224
    s_cbranch_scc1 .ap_157
    s_waitcnt vmcnt(1)
.ap_157:
    s_add_u32 s63, s69, 40960
    buffer_load_dwordx4 v[180:183], v1, s[44:47], s63 offen nt
    s_memrealtime s[8:9]
    s_waitcnt vmcnt(8)
    s_waitcnt lgkmcnt(0)
    s_sub_u32 s8, s8, s30
    s_cmpk_ge_u32 s8, 1481
    s_cbranch_scc1 .ap_158
    s_waitcnt vmcnt(5)
    s_cmpk_ge_u32 s8, 1381
    s_cbranch_scc1 .ap_158
    s_waitcnt vmcnt(4)
    s_bitcmp1_b64 s[14:15], 38
    s_cbranch_scc0 1
    s_waitcnt vmcnt(2)
    s_cmpk_ge_u32 s8, 1261
    s_cbranch_scc1 .ap_158
    s_waitcnt vmcnt(1)
.ap_158:
    s_add_u32 s63, s69, 49152
    buffer_load_dwordx4 v[184:187], v1, s[44:47], s63 offen nt
    s_memrealtime s[8:9]
    s_waitcnt vmcnt(8)
    s_waitcnt lgkmcnt(0)
    s_sub_u32 s8, s8, s30
    s_cmpk_ge_u32 s8, 1517
    s_cbranch_scc1 .ap_159
    s_waitcnt vmcnt(5)
    s_cmpk_ge_u32 s8, 1417
    s_cbranch_scc1 .ap_159
    s_waitcnt vmcnt(4)
    s_cmpk_ge_u32 s8, 1297
    s_cbranch_scc1 .ap_159
    s_waitcnt vmcnt(1)
.ap_159:
    s_add_u32 m0, s101, 73728
    s_add_u32 s56, s100, 0
    buffer_load_dwordx4 v6, s[52:55], s56 offen nt lds
    s_memrealtime s[8:9]
    s_waitcnt vmcnt(8)
    s_waitcnt lgkmcnt(0)
    s_sub_u32 s8, s8, s30
    s_cmpk_ge_u32 s8, 1517
    s_cbranch_scc1 .ap_160
    s_waitcnt vmcnt(5)
    s_cmpk_ge_u32 s8, 1417
    s_cbranch_scc1 .ap_160
    s_waitcnt vmcnt(4)
    s_bitcmp1_b64 s[14:15], 39
    s_cbranch_scc0 1
    s_waitcnt vmcnt(2)
    s_cmpk_ge_u32 s8, 1297
    s_cbranch_scc1 .ap_160
    s_waitcnt vmcnt(1)
.ap_160:
    s_add_u32 s63, s69, 57344
    buffer_load_dwordx4 v[188:191], v1, s[44:47], s63 offen nt
    s_memrealtime s[8:9]
    s_waitcnt vmcnt(8)
    s_waitcnt lgkmcnt(0)
    s_sub_u32 s8, s8, s30
    s_cmpk_ge_u32 s8, 1554
    s_cbranch_scc1 .ap_161
    s_waitcnt vmcnt(5)
    s_cmpk_ge_u32 s8, 1454
    s_cbranch_scc1 .ap_161
    s_waitcnt vmcnt(4)
    s_bitcmp1_b64 s[14:15], 40
    s_cbranch_scc0 1
    s_waitcnt vmcnt(2)
    s_cmpk_ge_u32 s8, 1334
    s_cbranch_scc1 .ap_161
    s_waitcnt vmcnt(1)
.ap_161:
    s_add_u32 s63, s69, 131072
    buffer_load_dwordx4 v[192:195], v1, s[44:47], s63 offen nt
    s_waitcnt vmcnt(5)
    s_branch .gpc_163
.gp_162:
    buffer_load_dwordx4 v[16:19], v7, s[36:39], s58 offen offset:0 sc1
    buffer_load_dwordx4 v[20:23], v7, s[36:39], s58 offen offset:256 sc1
    s_waitcnt vmcnt(0)
.gpc_163:
    v_min_u32 v10, v17, v19
    v_max_u32 v11, v17, v19
    v_min3_u32 v10, v10, v21, v23
    v_max3_u32 v11, v11, v21, v23
    v_cmp_eq_u32 vcc, s34, v10
    v_cmp_eq_u32 s[56:57], s34, v11
    s_and_b64 vcc, vcc, s[56:57]
    s_cmp_eq_u64 vcc, -1
    s_nop 2
    s_cbranch_scc1 .gpd_164
    s_sub_u32 s35, s35, 1
    s_cbranch_scc1 .Lexit
    s_sleep 1
    s_branch .gp_162
.gpd_164:
    s_mov_b32 vcc_lo, 0xcccccccc
    s_mov_b32 vcc_hi, 0xcccccccc
    v_cndmask_b32_e64 v24, v16, 0, vcc
    v_cndmask_b32_e64 v25, v18, 0, vcc
    v_cndmask_b32_e64 v26, v20, 0, vcc
    v_cndmask_b32_e64 v27, v22, 0, vcc
    v_cndmask_b32_e32 v28, 0, v16, vcc
    v_cndmask_b32_e32 v29, 0, v18, vcc
    v_cndmask_b32_e32 v30, 0, v20, vcc
    v_cndmask_b32_e32 v31, 0, v22, vcc
    v_mfma_f32_16x16x32_bf16 v[16:19], v[32:35], v[24:27], 0
    v_mfma_f32_16x16x32_bf16 v[32:35], v[40:43], v[24:27], 0
    v_mfma_f32_16x16x32_bf16 v[16:19], v[36:39], v[28:31], v[16:19]
    v_mfma_f32_16x16x32_bf16 v[40:43], v[48:51], v[24:27], 0
    v_mfma_f32_16x16x32_bf16 v[32:35], v[44:47], v[28:31], v[32:35]
    v_mfma_f32_16x16x32_bf16 v[48:51], v[56:59], v[24:27], 0
    v_mfma_f32_16x16x32_bf16 v[40:43], v[52:55], v[28:31], v[40:43]
    v_mfma_f32_16x16x32_bf16 v[56:59], v[64:67], v[24:27], 0
    v_mfma_f32_16x16x32_bf16 v[48:51], v[60:63], v[28:31], v[48:51]
    s_nop 1
    v_add_f32_dpp v10, v17, v16 row_ror:12 row_mask:0xf bank_mask:0x1
    s_memrealtime s[8:9]
    s_waitcnt lgkmcnt(0)
    s_sub_u32 s8, s8, s30
    s_cmpk_ge_u32 s8, 1591
    s_nop 0
    s_cbranch_scc1 .ap_165
    s_waitcnt vmcnt(5)
    s_cmpk_ge_u32 s8, 1491
    s_cbranch_scc1 .ap_165
    s_waitcnt vmcnt(4)
    s_bitcmp1_b64 s[14:15], 41
    s_cbranch_scc0 1
    s_waitcnt vmcnt(2)
    s_branch .Lsk_b1_1
.Lst_b1_1:
    s_branch .Lrt_b1_1
.Lsk_b1_1:
    s_cmpk_ge_u32 s8, 1371
    s_cbranch_scc1 .ap_165
    s_waitcnt vmcnt(1)
.ap_165:
    s_add_u32 s63, s69, 139264
    buffer_load_dwordx4 v[196:199], v1, s[44:47], s63 offen nt
    v_mfma_f32_16x16x32_bf16 v[64:67], v[72:75], v[24:27], 0
    v_mfma_f32_16x16x32_bf16 v[56:59], v[68:71], v[28:31], v[56:59]
    v_add_f32_dpp v11, v33, v32 row_ror:12 row_mask:0xf bank_mask:0x1
    v_add_f32_dpp v10, v18, v10 row_ror:8 row_mask:0xf bank_mask:0x1
    v_mfma_f32_16x16x32_bf16 v[72:75], v[80:83], v[24:27], 0
    v_mfma_f32_16x16x32_bf16 v[64:67], v[76:79], v[28:31], v[64:67]
    v_add_f32_dpp v12, v41, v40 row_ror:12 row_mask:0xf bank_mask:0x1
    v_add_f32_dpp v11, v34, v11 row_ror:8 row_mask:0xf bank_mask:0x1
    v_add_f32_dpp v10, v19, v10 row_ror:4 row_mask:0xf bank_mask:0x1
    v_mfma_f32_16x16x32_bf16 v[80:83], v[88:91], v[24:27], 0
    v_mfma_f32_16x16x32_bf16 v[72:75], v[84:87], v[28:31], v[72:75]
    v_add_f32_dpp v13, v49, v48 row_ror:12 row_mask:0xf bank_mask:0x1
    v_add_f32_dpp v12, v42, v12 row_ror:8 row_mask:0xf bank_mask:0x1
    v_add_f32_dpp v11, v35, v11 row_ror:4 row_mask:0xf bank_mask:0x1
    v_mfma_f32_16x16x32_bf16 v[88:91], v[96:99], v[24:27], 0
    v_mfma_f32_16x16x32_bf16 v[80:83], v[92:95], v[28:31], v[80:83]
    v_add_f32_dpp v10, v58, v57 row_ror:12 row_mask:0xf bank_mask:0x2
    v_add_f32_dpp v13, v50, v13 row_ror:8 row_mask:0xf bank_mask:0x1
    v_add_f32_dpp v12, v43, v12 row_ror:4 row_mask:0xf bank_mask:0x1
    s_memrealtime s[8:9]
    s_waitcnt lgkmcnt(0)
    s_sub_u32 s8, s8, s30
    s_cmpk_ge_u32 s8, 1612
    s_nop 0
    s_cbranch_scc1 .ap_166
    s_waitcnt vmcnt(5)
    s_cmpk_ge_u32 s8, 1512
    s_cbranch_scc1 .ap_166
    s_waitcnt vmcnt(4)
    s_bitcmp1_b64 s[14:15], 42
    s_cbranch_scc0 1
    s_waitcnt vmcnt(2)
    s_cmpk_ge_u32 s8, 1392
    s_cbranch_scc1 .ap_166
    s_waitcnt vmcnt(1)
.ap_166:
    s_add_u32 s63, s69, 147456
    buffer_load_dwordx4 v[200:203], v1, s[44:47], s63 offen nt
    s_memrealtime s[8:9]
    s_waitcnt lgkmcnt(0)
    s_sub_u32 s8, s8, s30
    s_cmpk_ge_u32 s8, 1633
    s_cbranch_scc1 .ap_167
    s_waitcnt vmcnt(5)
    s_cmpk_ge_u32 s8, 1533
    s_cbranch_scc1 .ap_167
    s_waitcnt vmcnt(4)
    s_cmpk_ge_u32 s8, 1413
    s_cbranch_scc1 .ap_167
    s_waitcnt vmcnt(1)
.ap_167:
    s_add_u32 m0, s101, 81920
    s_add_u32 s56, s100, 589824
    buffer_load_dwordx4 v6, s[52:55], s56 offen nt lds
    v_mfma_f32_16x16x32_bf16 v[96:99], v[104:107], v[24:27], 0
    v_mfma_f32_16x16x32_bf16 v[88:91], v[100:103], v[28:31], v[88:91]
    v_add_f32_dpp v11, v66, v65 row_ror:12 row_mask:0xf bank_mask:0x2
    v_add_f32_dpp v10, v59, v10 row_ror:8 row_mask:0xf bank_mask:0x2
    v_add_f32_dpp v13, v51, v13 row_ror:4 row_mask:0xf bank_mask:0x1
    v_mfma_f32_16x16x32_bf16 v[104:107], v[112:115], v[24:27], 0
    v_mfma_f32_16x16x32_bf16 v[96:99], v[108:111], v[28:31], v[96:99]
    v_add_f32_dpp v12, v74, v73 row_ror:12 row_mask:0xf bank_mask:0x2
    v_add_f32_dpp v11, v67, v11 row_ror:8 row_mask:0xf bank_mask:0x2
    v_add_f32_dpp v10, v56, v10 row_ror:4 row_mask:0xf bank_mask:0x2
    v_mfma_f32_16x16x32_bf16 v[112:115], v[120:123], v[24:27], 0
    v_mfma_f32_16x16x32_bf16 v[104:107], v[116:119], v[28:31], v[104:107]
    v_add_f32_dpp v13, v82, v81 row_ror:12 row_mask:0xf bank_mask:0x2
    v_add_f32_dpp v12, v75, v12 row_ror:8 row_mask:0xf bank_mask:0x2
    v_add_f32_dpp v11, v64, v11 row_ror:4 row_mask:0xf bank_mask:0x2
    v_mfma_f32_16x16x32_bf16 v[120:123], v[128:131], v[24:27], 0
    v_mfma_f32_16x16x32_bf16 v[112:115], v[124:127], v[28:31], v[112:115]
    v_add_f32_dpp v10, v91, v90 row_ror:12 row_mask:0xf bank_mask:0x4
    v_add_f32_dpp v13, v83, v13 row_ror:8 row_mask:0xf bank_mask:0x2
    v_add_f32_dpp v12, v72, v12 row_ror:4 row_mask:0xf bank_mask:0x2
    s_memrealtime s[8:9]
    s_waitcnt lgkmcnt(0)
    s_sub_u32 s8, s8, s30
    s_cmpk_ge_u32 s8, 1633
    s_nop 0
    s_cbranch_scc1 .ap_168
    s_waitcnt vmcnt(5)
    s_cmpk_ge_u32 s8, 1533
    s_cbranch_scc1 .ap_168
    s_waitcnt vmcnt(4)
    s_bitcmp1_b64 s[14:15], 43
    s_cbranch_scc0 1
    s_waitcnt vmcnt(2)
    s_cmpk_ge_u32 s8, 1413
    s_cbranch_scc1 .ap_168
    s_waitcnt vmcnt(1)
.ap_168:
    s_add_u32 s63, s69, 155648
    buffer_load_dwordx4 v[204:207], v1, s[44:47], s63 offen nt
    v_mfma_f32_16x16x32_bf16 v[128:131], v[136:139], v[24:27], 0
    v_mfma_f32_16x16x32_bf16 v[120:123], v[132:135], v[28:31], v[120:123]
    v_add_f32_dpp v11, v99, v98 row_ror:12 row_mask:0xf bank_mask:0x4
    v_add_f32_dpp v10, v88, v10 row_ror:8 row_mask:0xf bank_mask:0x4
    v_add_f32_dpp v13, v80, v13 row_ror:4 row_mask:0xf bank_mask:0x2
    v_mfma_f32_16x16x32_bf16 v[136:139], v[144:147], v[24:27], 0
    v_mfma_f32_16x16x32_bf16 v[128:131], v[140:143], v[28:31], v[128:131]
    v_add_f32_dpp v12, v107, v106 row_ror:12 row_mask:0xf bank_mask:0x4
    v_add_f32_dpp v11, v96, v11 row_ror:8 row_mask:0xf bank_mask:0x4
    v_add_f32_dpp v10, v89, v10 row_ror:4 row_mask:0xf bank_mask:0x4
    v_mfma_f32_16x16x32_bf16 v[144:147], v[152:155], v[24:27], 0
    v_mfma_f32_16x16x32_bf16 v[136:139], v[148:151], v[28:31], v[136:139]
    v_add_f32_dpp v13, v115, v114 row_ror:12 row_mask:0xf bank_mask:0x4
    v_add_f32_dpp v12, v104, v12 row_ror:8 row_mask:0xf bank_mask:0x4
    v_add_f32_dpp v11, v97, v11 row_ror:4 row_mask:0xf bank_mask:0x4
    v_mfma_f32_16x16x32_bf16 v[144:147], v[156:159], v[28:31], v[144:147]
    v_add_f32_dpp v10, v120, v123 row_ror:12 row_mask:0xf bank_mask:0x8
    v_add_f32_dpp v13, v112, v13 row_ror:8 row_mask:0xf bank_mask:0x4
    v_add_f32_dpp v12, v105, v12 row_ror:4 row_mask:0xf bank_mask:0x4
    s_memrealtime s[8:9]
    s_waitcnt vmcnt(8)
    s_waitcnt lgkmcnt(0)
    s_sub_u32 s8, s8, s30
    s_cmpk_ge_u32 s8, 1654
    s_cbranch_scc1 .ap_169
    s_waitcnt vmcnt(5)
    s_cmpk_ge_u32 s8, 1554
    s_cbranch_scc1 .ap_169
    s_waitcnt vmcnt(4)
    s_bitcmp1_b64 s[14:15], 44
    s_cbranch_scc0 1
    s_waitcnt vmcnt(2)
    s_cmpk_ge_u32 s8, 1434
    s_cbranch_scc1 .ap_169
    s_waitcnt vmcnt(1)
.ap_169:
    s_add_u32 s63, s69, 163840
    buffer_load_dwordx4 v[208:211], v1, s[44:47], s63 offen nt
    s_cmp_eq_u32 s3, 0
    s_cbranch_scc1 .Lst_b2_0
    s_cmp_eq_u32 s3, 1
    s_cbranch_scc1 .Lst_b2_1
    s_cmp_eq_u32 s3, 2
    s_cbranch_scc1 .Lrt_b2_2
    s_cmp_eq_u32 s3, 3
    s_cbranch_scc1 .Lrt_b2_3
.Lrt_b2_0:
.Lrt_b2_1:
.Lrt_b2_2:
.Lrt_b2_3:
    v_add_f32_dpp v11, v128, v131 row_ror:12 row_mask:0xf bank_mask:0x8
    v_add_f32_dpp v10, v121, v10 row_ror:8 row_mask:0xf bank_mask:0x8
    v_add_f32_dpp v13, v113, v13 row_ror:4 row_mask:0xf bank_mask:0x4
    v_add_f32_dpp v12, v136, v139 row_ror:12 row_mask:0xf bank_mask:0x8
    v_add_f32_dpp v11, v129, v11 row_ror:8 row_mask:0xf bank_mask:0x8
    v_add_f32_dpp v10, v122, v10 row_ror:4 row_mask:0xf bank_mask:0x8
    v_add_f32_dpp v13, v144, v147 row_ror:12 row_mask:0xf bank_mask:0x8
    v_add_f32_dpp v12, v137, v12 row_ror:8 row_mask:0xf bank_mask:0x8
    v_add_f32_dpp v11, v130, v11 row_ror:4 row_mask:0xf bank_mask:0x8
    v_add_f32_dpp v13, v145, v13 row_ror:8 row_mask:0xf bank_mask:0x8
    v_add_f32_dpp v12, v138, v12 row_ror:4 row_mask:0xf bank_mask:0x8
    s_memrealtime s[8:9]
    s_waitcnt vmcnt(8)
    s_waitcnt lgkmcnt(0)
    s_sub_u32 s8, s8, s30
    s_cmpk_ge_u32 s8, 1676
    s_cbranch_scc1 .ap_170
    s_waitcnt vmcnt(5)
    s_cmpk_ge_u32 s8, 1576
    s_cbranch_scc1 .ap_170
    s_waitcnt vmcnt(4)
    s_bitcmp1_b64 s[14:15], 45
    s_cbranch_scc0 1
    s_waitcnt vmcnt(2)
    s_cmpk_ge_u32 s8, 1456
    s_cbranch_scc1 .ap_170
    s_waitcnt vmcnt(1)
.ap_170:
    s_add_u32 s63, s69, 172032
    buffer_load_dwordx4 v[212:215], v1, s[44:47], s63 offen nt
    v_add_f32_dpp v13, v146, v13 row_ror:4 row_mask:0xf bank_mask:0x8
    s_mov_b32 s60, 0x3db504f3
    s_mov_b32 s61, 0x3db504f3
    v_cvt_pk_bf16_f32 v10, v10, v11
    v_and_b32 v11, 0xffff0000, v10
    v_lshlrev_b32 v10, 16, v10
    v_cvt_pk_bf16_f32 v12, v12, v13
    v_and_b32 v13, 0xffff0000, v12
    s_branch .Lsk_b1_2
.Lst_b1_2:
    s_branch .Lrt_b1_2
.Lsk_b1_2:
    v_lshlrev_b32 v12, 16, v12
    v_pk_mul_f32 v[10:11], v[10:11], s[60:61]
    v_pk_mul_f32 v[12:13], v[12:13], s[60:61]
    v_cvt_pk_bf16_f32 v10, v10, v11
    v_and_b32 v11, 0xffff0000, v10
    v_lshlrev_b32 v10, 16, v10
    v_cvt_pk_bf16_f32 v12, v12, v13
    v_and_b32 v13, 0xffff0000, v12
    v_lshlrev_b32 v12, 16, v12
    v_max_f32 v14, v10, v11
    v_max3_f32 v14, v14, v12, v13
    s_mov_b32 s60, 0x3fb8aa3b
    v_mov_b32 v22, s34
    v_mov_b32 v23, s34
    v_max_f32_dpp v14, v14, v14 quad_perm:[2,3,0,1] row_mask:0xf bank_mask:0xf
    s_nop 1
    v_max_f32_dpp v14, v14, v14 row_ror:4 row_mask:0xf bank_mask:0xf
    s_nop 1
    v_max_f32_dpp v14, v14, v14 row_ror:8 row_mask:0xf bank_mask:0xf
    v_mov_b32 v15, v14
    s_nop 1
    v_permlane16_swap_b32 v15, v14
    v_max_f32 v14, v15, v14
    v_mov_b32 v15, v14
    s_nop 1
    v_permlane32_swap_b32 v15, v14
    v_max_f32 v14, v15, v14
    v_mul_f32 v15, 0xbfb8aa3b, v14
    v_fma_f32 v10, v10, s60, v15
    v_fma_f32 v11, v11, s60, v15
    v_fma_f32 v12, v12, s60, v15
    v_fma_f32 v13, v13, s60, v15
    v_exp_f32 v10, v10
    v_exp_f32 v11, v11
    v_exp_f32 v12, v12
    v_exp_f32 v13, v13
    v_mov_b32 v20, v14
    v_pk_add_f32 v[16:17], v[10:11], v[12:13]
    v_add_f32 v21, v16, v17
    s_lshl_b32 s60, s68, 5
    s_lshl_b32 s61, s3, 4
    s_add_u32 s61, s61, 159104
    v_add_u32 v16, s61, v3
    v_mov_b32 v17, 159232
    v_mov_b32 v18, 1
    s_add_u32 s60, s60, s59
    v_add_f32_dpp v21, v21, v21 quad_perm:[2,3,0,1] row_mask:0xf bank_mask:0xf
    s_nop 1
    v_add_f32_dpp v21, v21, v21 row_ror:4 row_mask:0xf bank_mask:0xf
    s_nop 1
    v_add_f32_dpp v21, v21, v21 row_ror:8 row_mask:0xf bank_mask:0xf
    v_mov_b32 v15, v21
    s_nop 1
    v_permlane16_swap_b32 v15, v21
    v_add_f32 v21, v15, v21
    v_mov_b32 v15, v21
    s_nop 1
    v_permlane32_swap_b32 v15, v21
    v_add_f32 v21, v15, v21
    s_mov_b64 exec, 3
    ds_write_b64 v16, v[20:21]
    s_mov_b64 exec, 1
    ds_add_rtn_u32 v18, v17, v18
    s_mov_b64 exec, -1
    v_and_b32 v16, 0x78, v3
    v_or_b32 v16, 159104, v16
    s_waitcnt lgkmcnt(0)
    v_readfirstlane_b32 s61, v18
    s_cmp_eq_u32 s61, 7
    s_nop 3
    s_cbranch_scc0 .mlc_171
    ds_read_b64 v[18:19], v16
    s_waitcnt lgkmcnt(0)
    v_mov_b32 v20, v18
    s_nop 1
    v_max_f32_dpp v20, v20, v20 quad_perm:[2,3,0,1] row_mask:0xf bank_mask:0xf
    s_nop 1
    v_max_f32_dpp v20, v20, v20 row_ror:4 row_mask:0xf bank_mask:0xf
    s_nop 1
    v_max_f32_dpp v20, v20, v20 row_ror:8 row_mask:0xf bank_mask:0xf
    v_sub_f32 v18, v18, v20
    v_mul_f32 v18, 0x3fb8aa3b, v18
    v_exp_f32 v18, v18
    s_nop 0
    v_mul_f32 v21, v18, v19
    s_nop 1
    v_add_f32_dpp v21, v21, v21 quad_perm:[2,3,0,1] row_mask:0xf bank_mask:0xf
    s_nop 1
    v_add_f32_dpp v21, v21, v21 row_ror:4 row_mask:0xf bank_mask:0xf
    s_nop 1
    v_add_f32_dpp v21, v21, v21 row_ror:8 row_mask:0xf bank_mask:0xf
    s_mov_b64 exec, 3
    buffer_store_dwordx4 v[20:23], v2, s[36:39], s60 offen sc1
    s_mov_b64 exec, -1
.mlc_171:
    s_memrealtime s[8:9]
    s_waitcnt vmcnt(8)
    s_waitcnt lgkmcnt(0)
    s_sub_u32 s8, s8, s30
    s_cmpk_ge_u32 s8, 1708
    s_cbranch_scc1 .ap_172
    s_waitcnt vmcnt(5)
    s_cmpk_ge_u32 s8, 1608
    s_cbranch_scc1 .ap_172
    s_waitcnt vmcnt(4)
    s_bitcmp1_b64 s[14:15], 46
    s_cbranch_scc0 1
    s_waitcnt vmcnt(2)
    s_cmpk_ge_u32 s8, 1488
    s_cbranch_scc1 .ap_172
    s_waitcnt vmcnt(1)
.ap_172:
    s_add_u32 s63, s69, 180224
    buffer_load_dwordx4 v[216:219], v1, s[44:47], s63 offen nt
    s_memrealtime s[8:9]
    s_waitcnt vmcnt(8)
    s_waitcnt lgkmcnt(0)
    s_sub_u32 s8, s8, s30
    s_cmpk_ge_u32 s8, 1740
    s_cbranch_scc1 .ap_173
    s_waitcnt vmcnt(5)
    s_cmpk_ge_u32 s8, 1640
    s_cbranch_scc1 .ap_173
    s_waitcnt vmcnt(4)
    s_bitcmp1_b64 s[14:15], 47
    s_cbranch_scc0 1
    s_waitcnt vmcnt(2)
    s_cmpk_ge_u32 s8, 1520
    s_cbranch_scc1 .ap_173
    s_waitcnt vmcnt(1)
.ap_173:
    s_add_u32 s63, s69, 188416
    buffer_load_dwordx4 v[220:223], v1, s[44:47], s63 offen nt
    s_and_b32 s56, s64, 0
    s_mul_i32 s56, s56, 18432
    s_mul_i32 s57, s3, 2304
    s_add_u32 s56, s56, s57
    s_add_u32 s56, s56, 0x37000
    buffer_load_dwordx4 v[32:35], v2, s[36:39], s56 offen offset:0 sc1
    buffer_load_dwordx4 v[40:43], v2, s[36:39], s56 offen offset:1024 sc1
    buffer_load_dwordx2 v[48:49], v5, s[36:39], s56 offen offset:0 sc1
    s_memrealtime s[8:9]
    s_waitcnt vmcnt(11)
    s_waitcnt lgkmcnt(0)
    s_sub_u32 s8, s8, s30
    s_cmpk_ge_u32 s8, 1772
    s_cbranch_scc1 .ap_174
    s_waitcnt vmcnt(8)
    s_cmpk_ge_u32 s8, 1672
    s_cbranch_scc1 .ap_174
    s_waitcnt vmcnt(7)
    s_bitcmp1_b64 s[14:15], 48
    s_cbranch_scc0 1
    s_waitcnt vmcnt(5)
    s_cmpk_ge_u32 s8, 1552
    s_cbranch_scc1 .ap_174
    s_waitcnt vmcnt(4)
.ap_174:
    s_add_u32 s63, s69, 262144
    buffer_load_dwordx4 v[224:227], v1, s[44:47], s63 offen nt
    s_branch .Lsk_b1_3
.Lst_b1_3:
    s_branch .Lrt_b1_3
.Lsk_b1_3:
    s_memrealtime s[8:9]
    s_waitcnt vmcnt(11)
    s_waitcnt lgkmcnt(0)
    s_sub_u32 s8, s8, s30
    s_cmpk_ge_u32 s8, 1804
    s_cbranch_scc1 .ap_175
    s_waitcnt vmcnt(8)
    s_cmpk_ge_u32 s8, 1704
    s_cbranch_scc1 .ap_175
    s_waitcnt vmcnt(7)
    s_bitcmp1_b64 s[14:15], 49
    s_cbranch_scc0 1
    s_waitcnt vmcnt(5)
    s_cmpk_ge_u32 s8, 1584
    s_cbranch_scc1 .ap_175
    s_waitcnt vmcnt(4)
.ap_175:
    s_add_u32 s63, s69, 270336
    buffer_load_dwordx4 v[228:231], v1, s[44:47], s63 offen nt
    s_and_b32 s56, s64, 0
    s_mul_i32 s56, s56, 18432
    s_mul_i32 s57, s3, 2304
    s_add_u32 s56, s56, s57
    s_add_u32 s56, s56, 0x49000
    buffer_load_dwordx4 v[56:59], v2, s[36:39], s56 offen offset:0 sc1
    buffer_load_dwordx4 v[64:67], v2, s[36:39], s56 offen offset:1024 sc1
    buffer_load_dwordx2 v[72:73], v5, s[36:39], s56 offen offset:0 sc1
    s_memrealtime s[8:9]
    s_waitcnt vmcnt(14)
    s_waitcnt lgkmcnt(0)
    s_sub_u32 s8, s8, s30
    s_cmpk_ge_u32 s8, 1836
    s_cbranch_scc1 .ap_176
    s_waitcnt vmcnt(11)
    s_cmpk_ge_u32 s8, 1736
    s_cbranch_scc1 .ap_176
    s_waitcnt vmcnt(10)
    s_bitcmp1_b64 s[14:15], 50
    s_cbranch_scc0 1
    s_waitcnt vmcnt(8)
    s_cmpk_ge_u32 s8, 1616
    s_cbranch_scc1 .ap_176
    s_waitcnt vmcnt(4)
.ap_176:
    s_add_u32 s63, s69, 278528
    buffer_load_dwordx4 v[232:235], v1, s[44:47], s63 offen nt
    s_memrealtime s[8:9]
    s_waitcnt vmcnt(14)
    s_waitcnt lgkmcnt(0)
    s_sub_u32 s8, s8, s30
    s_cmpk_ge_u32 s8, 1868
    s_cbranch_scc1 .ap_177
    s_waitcnt vmcnt(11)
    s_cmpk_ge_u32 s8, 1768
    s_cbranch_scc1 .ap_177
    s_waitcnt vmcnt(10)
    s_bitcmp1_b64 s[14:15], 51
    s_cbranch_scc0 1
    s_waitcnt vmcnt(5)
    s_cmpk_ge_u32 s8, 1648
    s_cbranch_scc1 .ap_177
    s_waitcnt vmcnt(4)
.ap_177:
    s_add_u32 s63, s69, 286720
    buffer_load_dwordx4 v[236:239], v1, s[44:47], s63 offen nt
    s_memrealtime s[8:9]
    s_waitcnt vmcnt(14)
    s_waitcnt lgkmcnt(0)
    s_sub_u32 s8, s8, s30
    s_cmpk_ge_u32 s8, 1900
    s_cbranch_scc1 .ap_178
    s_waitcnt vmcnt(11)
    s_cmpk_ge_u32 s8, 1800
    s_cbranch_scc1 .ap_178
    s_waitcnt vmcnt(10)
    s_bitcmp1_b64 s[14:15], 52
    s_cbranch_scc0 1
    s_waitcnt vmcnt(5)
    s_cmpk_ge_u32 s8, 1680
    s_cbranch_scc1 .ap_178
    s_waitcnt vmcnt(1)
.ap_178:
    s_add_u32 s63, s69, 294912
    buffer_load_dwordx4 v[240:243], v1, s[44:47], s63 offen nt
    s_memrealtime s[8:9]
    s_waitcnt vmcnt(14)
    s_waitcnt lgkmcnt(0)
    s_sub_u32 s8, s8, s30
    s_cmpk_ge_u32 s8, 1932
    s_cbranch_scc1 .ap_179
    s_waitcnt vmcnt(11)
    s_cmpk_ge_u32 s8, 1832
    s_cbranch_scc1 .ap_179
    s_waitcnt vmcnt(7)
    s_bitcmp1_b64 s[14:15], 53
    s_cbranch_scc0 1
    s_waitcnt vmcnt(2)
    s_cmpk_ge_u32 s8, 1712
    s_cbranch_scc1 .ap_179
    s_waitcnt vmcnt(1)
.ap_179:
    s_add_u32 s63, s69, 303104
    buffer_load_dwordx4 v[244:247], v1, s[44:47], s63 offen nt
    s_and_b32 s0, s0, 0xffffff80
    s_sub_u32 s0, s0, 1024
    buffer_load_dword v28, v4, s[36:39], s0 offen sc1
    buffer_load_dwordx4 v[24:27], v9, s[36:39], s59 offen offset:0 sc1
    s_memrealtime s[8:9]
    s_waitcnt vmcnt(15)
    s_waitcnt lgkmcnt(0)
    s_sub_u32 s8, s8, s30
    s_cmpk_ge_u32 s8, 1964
    s_cbranch_scc1 .ap_180
    s_waitcnt vmcnt(9)
    s_cmpk_ge_u32 s8, 1864
    s_cbranch_scc1 .ap_180
    s_waitcnt vmcnt(5)
    s_bitcmp1_b64 s[14:15], 54
    s_cbranch_scc0 1
    s_waitcnt vmcnt(3)
    s_cmpk_ge_u32 s8, 1744
    s_cbranch_scc1 .ap_180
    s_waitcnt vmcnt(2)
.ap_180:
    s_add_u32 s63, s69, 311296
    buffer_load_dwordx4 v[248:251], v1, s[44:47], s63 offen nt
    s_memrealtime s[8:9]
    s_waitcnt vmcnt(15)
    s_waitcnt lgkmcnt(0)
    s_sub_u32 s8, s8, s30
    s_cmpk_ge_u32 s8, 1996
    s_cbranch_scc1 .ap_181
    s_waitcnt vmcnt(6)
    s_cmpk_ge_u32 s8, 1896
    s_cbranch_scc1 .ap_181
    s_waitcnt vmcnt(5)
    s_bitcmp1_b64 s[14:15], 55
    s_cbranch_scc0 1
    s_waitcnt vmcnt(3)
    s_cmpk_ge_u32 s8, 1776
    s_cbranch_scc1 .ap_181
    s_waitcnt vmcnt(1)
.ap_181:
    s_add_u32 s63, s69, 319488
    buffer_load_dwordx4 v[252:255], v1, s[44:47], s63 offen nt
    s_memrealtime s[8:9]
    s_waitcnt vmcnt(12)
    s_waitcnt lgkmcnt(0)
    s_sub_u32 s8, s8, s30
    s_cmpk_ge_u32 s8, 2028
    s_cbranch_scc1 .ap_182
    s_waitcnt vmcnt(6)
    s_cmpk_ge_u32 s8, 1928
    s_cbranch_scc1 .ap_182
    s_waitcnt vmcnt(5)
    s_bitcmp1_b64 s[14:15], 56
    s_cbranch_scc0 1
    s_waitcnt vmcnt(2)
    s_cmpk_ge_u32 s8, 1808
    s_cbranch_scc1 .ap_182
    s_waitcnt vmcnt(1)
.ap_182:
    s_add_u32 s63, s69, 393216
    buffer_load_dwordx4 v[36:39], v1, s[44:47], s63 offen nt
    s_memrealtime s[8:9]
    s_waitcnt vmcnt(12)
    s_waitcnt lgkmcnt(0)
    s_sub_u32 s8, s8, s30
    s_cmpk_ge_u32 s8, 2060
    s_cbranch_scc1 .ap_183
    s_waitcnt vmcnt(6)
    s_cmpk_ge_u32 s8, 1960
    s_cbranch_scc1 .ap_183
    s_waitcnt vmcnt(5)
    s_bitcmp1_b64 s[14:15], 57
    s_cbranch_scc0 1
    s_waitcnt vmcnt(2)
    s_cmpk_ge_u32 s8, 1840
    s_cbranch_scc1 .ap_183
    s_waitcnt vmcnt(1)
.ap_183:
    s_add_u32 s63, s69, 401408
    buffer_load_dwordx4 v[44:47], v1, s[44:47], s63 offen nt
    s_memrealtime s[8:9]
    s_waitcnt vmcnt(9)
    s_waitcnt lgkmcnt(0)
    s_sub_u32 s8, s8, s30
    s_cmpk_ge_u32 s8, 2092
    s_cbranch_scc1 .ap_184
    s_waitcnt vmcnt(6)
    s_cmpk_ge_u32 s8, 1992
    s_cbranch_scc1 .ap_184
    s_waitcnt vmcnt(4)
    s_bitcmp1_b64 s[14:15], 58
    s_cbranch_scc0 1
    s_waitcnt vmcnt(2)
    s_cmpk_ge_u32 s8, 1872
    s_cbranch_scc1 .ap_184
    s_waitcnt vmcnt(1)
.ap_184:
    s_add_u32 s63, s69, 409600
    buffer_load_dwordx4 v[52:55], v1, s[44:47], s63 offen nt
    s_memrealtime s[8:9]
    s_waitcnt vmcnt(9)
    s_waitcnt lgkmcnt(0)
    s_sub_u32 s8, s8, s30
    s_cmpk_ge_u32 s8, 2124
    s_cbranch_scc1 .ap_185
    s_waitcnt vmcnt(5)
    s_cmpk_ge_u32 s8, 2024
    s_cbranch_scc1 .ap_185
    s_waitcnt vmcnt(4)
    s_bitcmp1_b64 s[14:15], 59
    s_cbranch_scc0 1
    s_waitcnt vmcnt(2)
    s_cmpk_ge_u32 s8, 1904
    s_cbranch_scc1 .ap_185
    s_waitcnt vmcnt(1)
.ap_185:
    s_add_u32 s63, s69, 417792
    buffer_load_dwordx4 v[60:63], v1, s[44:47], s63 offen nt
    s_memrealtime s[8:9]
    s_waitcnt vmcnt(9)
    s_waitcnt lgkmcnt(0)
    s_sub_u32 s8, s8, s30
    s_cmpk_ge_u32 s8, 2156
    s_cbranch_scc1 .ap_186
    s_waitcnt vmcnt(5)
    s_cmpk_ge_u32 s8, 2056
    s_cbranch_scc1 .ap_186
    s_waitcnt vmcnt(4)
    s_bitcmp1_b64 s[14:15], 60
    s_cbranch_scc0 1
    s_waitcnt vmcnt(2)
    s_cmpk_ge_u32 s8, 1936
    s_cbranch_scc1 .ap_186
    s_branch .Lsk_b1_4
.Lst_b1_4:
    s_branch .Lrt_b1_4
.Lsk_b1_4:
    s_waitcnt vmcnt(1)
.ap_186:
    s_add_u32 s63, s69, 425984
    buffer_load_dwordx4 v[68:71], v1, s[44:47], s63 offen nt
    s_memrealtime s[8:9]
    s_waitcnt vmcnt(9)
    s_waitcnt lgkmcnt(0)
    s_sub_u32 s8, s8, s30
    s_cmpk_ge_u32 s8, 2188
    s_cbranch_scc1 .ap_187
    s_waitcnt vmcnt(5)
    s_cmpk_ge_u32 s8, 2088
    s_cbranch_scc1 .ap_187
    s_waitcnt vmcnt(4)
    s_bitcmp1_b64 s[14:15], 61
    s_cbranch_scc0 1
    s_waitcnt vmcnt(2)
    s_cmpk_ge_u32 s8, 1968
    s_cbranch_scc1 .ap_187
    s_waitcnt vmcnt(1)
.ap_187:
    s_add_u32 s63, s69, 434176
    buffer_load_dwordx4 v[76:79], v1, s[44:47], s63 offen nt
    s_memrealtime s[8:9]
    s_waitcnt vmcnt(8)
    s_waitcnt lgkmcnt(0)
    s_sub_u32 s8, s8, s30
    s_cmpk_ge_u32 s8, 2220
    s_cbranch_scc1 .ap_188
    s_waitcnt vmcnt(5)
    s_cmpk_ge_u32 s8, 2120
    s_cbranch_scc1 .ap_188
    s_waitcnt vmcnt(4)
    s_bitcmp1_b64 s[14:15], 62
    s_cbranch_scc0 1
    s_waitcnt vmcnt(2)
    s_cmpk_ge_u32 s8, 2000
    s_cbranch_scc1 .ap_188
    s_waitcnt vmcnt(1)
.ap_188:
    s_add_u32 s63, s69, 442368
    buffer_load_dwordx4 v[84:87], v1, s[44:47], s63 offen nt
    s_memrealtime s[8:9]
    s_waitcnt vmcnt(8)
    s_waitcnt lgkmcnt(0)
    s_sub_u32 s8, s8, s30
    s_cmpk_ge_u32 s8, 2252
    s_cbranch_scc1 .ap_189
    s_waitcnt vmcnt(5)
    s_cmpk_ge_u32 s8, 2152
    s_cbranch_scc1 .ap_189
    s_waitcnt vmcnt(4)
    s_bitcmp1_b64 s[14:15], 63
    s_cbranch_scc0 1
    s_waitcnt vmcnt(2)
    s_cmpk_ge_u32 s8, 2032
    s_cbranch_scc1 .ap_189
    s_waitcnt vmcnt(1)
.ap_189:
    s_add_u32 s63, s69, 450560
    buffer_load_dwordx4 v[92:95], v1, s[44:47], s63 offen nt
    s_setprio 0
    s_branch .gpc_191
.gp_190:
    buffer_load_dwordx4 v[24:27], v9, s[36:39], s59 offen offset:0 sc1
    s_waitcnt vmcnt(0)
.gpc_191:
    v_cmp_eq_u32 vcc, s34, v26
    s_cmp_eq_u64 vcc, -1
    s_nop 3
    s_cbranch_scc1 .gpd_192
    s_sub_u32 s35, s35, 1
    s_cbranch_scc1 .Lexit
    s_sleep 1
    s_branch .gp_190
.gpd_192:
    v_cmp_eq_u32 vcc, s1, v28
    s_cmp_eq_u64 vcc, -1
    s_cselect_b32 s0, 0x800000, 0
    v_mov_b32 v16, v24
    s_nop 1
    v_max_f32_dpp v16, v16, v16 row_ror:4 row_mask:0xf bank_mask:0xf
    v_sub_f32 v17, v24, v16
    v_sub_f32 v18, v14, v16
    v_mul_f32 v17, 0x3fb8aa3b, v17
    v_mul_f32 v18, 0x3fb8aa3b, v18
    v_exp_f32 v17, v17
    v_exp_f32 v18, v18
    v_mul_f32 v17, v17, v25
    s_nop 1
    v_add_f32_dpp v17, v17, v17 row_ror:4 row_mask:0xf bank_mask:0xf
    v_rcp_f32 v19, v17
    s_nop 0
    v_fma_f32 v15, -v17, v19, 1.0
    v_fma_f32 v19, v15, v19, v19
    v_mul_f32 v18, v18, v19
    v_mul_f32 v10, v10, v18
    v_mul_f32 v11, v11, v18
    v_mul_f32 v12, v12, v18
    v_mul_f32 v13, v13, v18
    v_mov_b32_dpp v112, v10 quad_perm:[2,3,0,1] row_mask:0xf bank_mask:0xf
    v_mov_b32_dpp v113, v11 quad_perm:[2,3,0,1] row_mask:0xf bank_mask:0xf
    v_mov_b32_dpp v114, v12 quad_perm:[2,3,0,1] row_mask:0xf bank_mask:0xf
    v_mov_b32_dpp v115, v13 quad_perm:[2,3,0,1] row_mask:0xf bank_mask:0xf
    v_cvt_pk_bf16_f32 v96, v10, v112
    v_cvt_pk_bf16_f32 v100, v11, v113
    v_cvt_pk_bf16_f32 v104, v12, v114
    v_cvt_pk_bf16_f32 v108, v13, v115
    v_mov_b32_dpp v97, v96 row_ror:12 row_mask:0xf bank_mask:0xf
    v_mov_b32_dpp v101, v100 row_ror:12 row_mask:0xf bank_mask:0xf
    v_mov_b32_dpp v105, v104 row_ror:12 row_mask:0xf bank_mask:0xf
    v_mov_b32_dpp v109, v108 row_ror:12 row_mask:0xf bank_mask:0xf
    v_mov_b32_dpp v98, v96 row_ror:8 row_mask:0xf bank_mask:0xf
    v_mov_b32_dpp v102, v100 row_ror:8 row_mask:0xf bank_mask:0xf
    v_mov_b32_dpp v106, v104 row_ror:8 row_mask:0xf bank_mask:0xf
    v_mov_b32_dpp v110, v108 row_ror:8 row_mask:0xf bank_mask:0xf
    v_mov_b32_dpp v99, v96 row_ror:4 row_mask:0xf bank_mask:0xf
    v_mov_b32_dpp v103, v100 row_ror:4 row_mask:0xf bank_mask:0xf
    v_mov_b32_dpp v107, v104 row_ror:4 row_mask:0xf bank_mask:0xf
    v_mov_b32_dpp v111, v108 row_ror:4 row_mask:0xf bank_mask:0xf
    s_lshl_b32 s60, s3, 10
    s_add_u32 s60, s60, 147456
    v_lshlrev_b32 v10, 5, v0
    v_add_u32 v10, s60, v10
    v_perm_b32 v112, v164, v160, s94
    v_perm_b32 v113, v172, v168, s94
    v_perm_b32 v114, v180, v176, s94
    v_perm_b32 v115, v188, v184, s94
    s_nop 1
    v_mfma_f32_16x16x32_bf16 v[128:131], v[96:99], v[112:115], 0
    v_perm_b32 v116, v164, v160, s95
    v_perm_b32 v117, v172, v168, s95
    v_perm_b32 v118, v180, v176, s95
    v_perm_b32 v119, v188, v184, s95
    s_nop 1
    v_mfma_f32_16x16x32_bf16 v[132:135], v[96:99], v[116:119], 0
    v_perm_b32 v120, v165, v161, s94
    v_perm_b32 v121, v173, v169, s94
    v_perm_b32 v122, v181, v177, s94
    v_perm_b32 v123, v189, v185, s94
    s_nop 1
    v_mfma_f32_16x16x32_bf16 v[136:139], v[96:99], v[120:123], 0
    v_perm_b32 v124, v165, v161, s95
    v_perm_b32 v125, v173, v169, s95
    v_perm_b32 v126, v181, v177, s95
    v_perm_b32 v127, v189, v185, s95
    s_nop 1
    v_mfma_f32_16x16x32_bf16 v[140:143], v[96:99], v[124:127], 0
    v_perm_b32 v112, v166, v162, s94
    v_perm_b32 v113, v174, v170, s94
    v_perm_b32 v114, v182, v178, s94
    v_perm_b32 v115, v190, v186, s94
    s_nop 1
    v_mfma_f32_16x16x32_bf16 v[144:147], v[96:99], v[112:115], 0
    v_perm_b32 v116, v166, v162, s95
    v_perm_b32 v117, v174, v170, s95
    v_perm_b32 v118, v182, v178, s95
    v_perm_b32 v119, v190, v186, s95
    s_nop 1
    v_mfma_f32_16x16x32_bf16 v[148:151], v[96:99], v[116:119], 0
    v_perm_b32 v120, v167, v163, s94
    v_perm_b32 v121, v175, v171, s94
    v_perm_b32 v122, v183, v179, s94
    v_perm_b32 v123, v191, v187, s94
    s_nop 1
    v_mfma_f32_16x16x32_bf16 v[152:155], v[96:99], v[120:123], 0
    v_perm_b32 v124, v167, v163, s95
    v_perm_b32 v125, v175, v171, s95
    v_perm_b32 v126, v183, v179, s95
    v_perm_b32 v127, v191, v187, s95
    s_nop 1
    v_mfma_f32_16x16x32_bf16 v[156:159], v[96:99], v[124:127], 0
    v_perm_b32 v112, v196, v192, s94
    v_perm_b32 v113, v204, v200, s94
    v_perm_b32 v114, v212, v208, s94
    v_perm_b32 v115, v220, v216, s94
    s_nop 1
    v_mfma_f32_16x16x32_bf16 v[128:131], v[100:103], v[112:115], v[128:131]
    v_perm_b32 v116, v196, v192, s95
    v_perm_b32 v117, v204, v200, s95
    v_perm_b32 v118, v212, v208, s95
    v_perm_b32 v119, v220, v216, s95
    s_nop 1
    v_mfma_f32_16x16x32_bf16 v[132:135], v[100:103], v[116:119], v[132:135]
    v_perm_b32 v120, v197, v193, s94
    v_perm_b32 v121, v205, v201, s94
    s_branch .Lsk_b1_5
.Lst_b1_5:
    s_branch .Lrt_b1_5
.Lsk_b1_5:
    v_perm_b32 v122, v213, v209, s94
    v_perm_b32 v123, v221, v217, s94
    s_nop 1
    v_mfma_f32_16x16x32_bf16 v[136:139], v[100:103], v[120:123], v[136:139]
    v_perm_b32 v124, v197, v193, s95
    v_perm_b32 v125, v205, v201, s95
    v_perm_b32 v126, v213, v209, s95
    v_perm_b32 v127, v221, v217, s95
    s_nop 1
    v_mfma_f32_16x16x32_bf16 v[140:143], v[100:103], v[124:127], v[140:143]
    v_perm_b32 v112, v198, v194, s94
    v_perm_b32 v113, v206, v202, s94
    v_perm_b32 v114, v214, v210, s94
    v_perm_b32 v115, v222, v218, s94
    s_nop 1
    v_mfma_f32_16x16x32_bf16 v[144:147], v[100:103], v[112:115], v[144:147]
    v_perm_b32 v116, v198, v194, s95
    v_perm_b32 v117, v206, v202, s95
    v_perm_b32 v118, v214, v210, s95
    v_perm_b32 v119, v222, v218, s95
    s_nop 1
    v_mfma_f32_16x16x32_bf16 v[148:151], v[100:103], v[116:119], v[148:151]
    v_perm_b32 v120, v199, v195, s94
    v_perm_b32 v121, v207, v203, s94
    v_perm_b32 v122, v215, v211, s94
    v_perm_b32 v123, v223, v219, s94
    s_nop 1
    v_mfma_f32_16x16x32_bf16 v[152:155], v[100:103], v[120:123], v[152:155]
    v_perm_b32 v124, v199, v195, s95
    v_perm_b32 v125, v207, v203, s95
    v_perm_b32 v126, v215, v211, s95
    v_perm_b32 v127, v223, v219, s95
    s_nop 1
    v_mfma_f32_16x16x32_bf16 v[156:159], v[100:103], v[124:127], v[156:159]
    s_waitcnt vmcnt(8)
    v_perm_b32 v112, v228, v224, s94
    v_perm_b32 v113, v236, v232, s94
    v_perm_b32 v114, v244, v240, s94
    v_perm_b32 v115, v252, v248, s94
    s_nop 1
    v_mfma_f32_16x16x32_bf16 v[128:131], v[104:107], v[112:115], v[128:131]
    v_perm_b32 v116, v228, v224, s95
    v_perm_b32 v117, v236, v232, s95
    v_perm_b32 v118, v244, v240, s95
    v_perm_b32 v119, v252, v248, s95
    s_nop 1
    v_mfma_f32_16x16x32_bf16 v[132:135], v[104:107], v[116:119], v[132:135]
    v_perm_b32 v120, v229, v225, s94
    v_perm_b32 v121, v237, v233, s94
    v_perm_b32 v122, v245, v241, s94
    v_perm_b32 v123, v253, v249, s94
    s_nop 1
    v_mfma_f32_16x16x32_bf16 v[136:139], v[104:107], v[120:123], v[136:139]
    v_perm_b32 v124, v229, v225, s95
    v_perm_b32 v125, v237, v233, s95
    v_perm_b32 v126, v245, v241, s95
    v_perm_b32 v127, v253, v249, s95
    s_nop 1
    v_mfma_f32_16x16x32_bf16 v[140:143], v[104:107], v[124:127], v[140:143]
    v_perm_b32 v112, v230, v226, s94
    v_perm_b32 v113, v238, v234, s94
    v_perm_b32 v114, v246, v242, s94
    v_perm_b32 v115, v254, v250, s94
    s_nop 1
    v_mfma_f32_16x16x32_bf16 v[144:147], v[104:107], v[112:115], v[144:147]
    v_perm_b32 v116, v230, v226, s95
    v_perm_b32 v117, v238, v234, s95
    v_perm_b32 v118, v246, v242, s95
    v_perm_b32 v119, v254, v250, s95
    s_nop 1
    v_mfma_f32_16x16x32_bf16 v[148:151], v[104:107], v[116:119], v[148:151]
    v_perm_b32 v120, v231, v227, s94
    v_perm_b32 v121, v239, v235, s94
    v_perm_b32 v122, v247, v243, s94
    v_perm_b32 v123, v255, v251, s94
    s_nop 1
    v_mfma_f32_16x16x32_bf16 v[152:155], v[104:107], v[120:123], v[152:155]
    v_perm_b32 v124, v231, v227, s95
    v_perm_b32 v125, v239, v235, s95
    v_perm_b32 v126, v247, v243, s95
    v_perm_b32 v127, v255, v251, s95
    s_nop 1
    v_mfma_f32_16x16x32_bf16 v[156:159], v[104:107], v[124:127], v[156:159]
    s_waitcnt vmcnt(0)
    s_add_u32 m0, s101, 90112
    s_add_u32 s56, s100, 1179648
    buffer_load_dwordx4 v6, s[52:55], s56 offen nt lds
    s_add_u32 m0, s101, 98304
    s_add_u32 s56, s100, 1769472
    buffer_load_dwordx4 v6, s[52:55], s56 offen nt lds
    s_add_u32 m0, s101, 106496
    s_add_u32 s56, s100, 2359296
    buffer_load_dwordx4 v6, s[52:55], s56 offen nt lds
    s_add_u32 m0, s101, 114688
    s_add_u32 s56, s100, 2949120
    buffer_load_dwordx4 v6, s[52:55], s56 offen nt lds
    s_add_u32 m0, s101, 122880
    s_add_u32 s56, s100, 3538944
    buffer_load_dwordx4 v6, s[52:55], s56 offen nt lds
    s_add_u32 m0, s101, 131072
    s_add_u32 s56, s100, 4128768
    buffer_load_dwordx4 v6, s[52:55], s56 offen nt lds
    s_add_u32 m0, s101, 139264
    s_add_u32 s56, s100, 4718592
    buffer_load_dwordx4 v6, s[52:55], s56 offen nt lds
    v_perm_b32 v112, v44, v36, s94
    v_perm_b32 v113, v60, v52, s94
    v_perm_b32 v114, v76, v68, s94
    v_perm_b32 v115, v92, v84, s94
    s_nop 1
    v_mfma_f32_16x16x32_bf16 v[128:131], v[108:111], v[112:115], v[128:131]
    v_perm_b32 v116, v44, v36, s95
    v_perm_b32 v117, v60, v52, s95
    v_perm_b32 v118, v76, v68, s95
    v_perm_b32 v119, v92, v84, s95
    s_nop 1
    v_mfma_f32_16x16x32_bf16 v[132:135], v[108:111], v[116:119], v[132:135]
    v_perm_b32 v120, v45, v37, s94
    v_perm_b32 v121, v61, v53, s94
    v_perm_b32 v122, v77, v69, s94
    v_perm_b32 v123, v93, v85, s94
    s_nop 1
    v_mfma_f32_16x16x32_bf16 v[136:139], v[108:111], v[120:123], v[136:139]
    v_perm_b32 v124, v45, v37, s95
    v_perm_b32 v125, v61, v53, s95
    v_perm_b32 v126, v77, v69, s95
    v_perm_b32 v127, v93, v85, s95
    s_nop 1
    v_mfma_f32_16x16x32_bf16 v[140:143], v[108:111], v[124:127], v[140:143]
    v_perm_b32 v112, v46, v38, s94
    v_perm_b32 v113, v62, v54, s94
    v_perm_b32 v114, v78, v70, s94
    v_perm_b32 v115, v94, v86, s94
    s_nop 1
    v_mfma_f32_16x16x32_bf16 v[144:147], v[108:111], v[112:115], v[144:147]
    v_perm_b32 v116, v46, v38, s95
    v_perm_b32 v117, v62, v54, s95
    v_perm_b32 v118, v78, v70, s95
    v_perm_b32 v119, v94, v86, s95
    s_nop 1
    v_mfma_f32_16x16x32_bf16 v[148:151], v[108:111], v[116:119], v[148:151]
    v_perm_b32 v120, v47, v39, s94
    v_perm_b32 v121, v63, v55, s94
    v_perm_b32 v122, v79, v71, s94
    v_perm_b32 v123, v95, v87, s94
    s_nop 1
    s_branch .Lsk_b1_6
.Lst_b1_6:
    s_branch .Lrt_b1_6
.Lsk_b1_6:
    v_mfma_f32_16x16x32_bf16 v[152:155], v[108:111], v[120:123], v[152:155]
    v_perm_b32 v124, v47, v39, s95
    v_perm_b32 v125, v63, v55, s95
    v_perm_b32 v126, v79, v71, s95
    v_perm_b32 v127, v95, v87, s95
    s_nop 1
    v_mfma_f32_16x16x32_bf16 v[156:159], v[108:111], v[124:127], v[156:159]
    s_mov_b64 exec, 0xffff
    ds_write2_b32 v10, v128, v129 offset0:0 offset1:128
    ds_write2_b32 v10, v132, v133 offset0:1 offset1:129
    ds_write2_b32 v10, v136, v137 offset0:2 offset1:130
    ds_write2_b32 v10, v140, v141 offset0:3 offset1:131
    ds_write2_b32 v10, v144, v145 offset0:4 offset1:132
    ds_write2_b32 v10, v148, v149 offset0:5 offset1:133
    ds_write2_b32 v10, v152, v153 offset0:6 offset1:134
    ds_write2_b32 v10, v156, v157 offset0:7 offset1:135
    s_mov_b64 exec, -1
    s_waitcnt lgkmcnt(0)
    s_barrier
    s_cmp_lg_u32 s3, 7
    s_cbranch_scc1 .opub_193
    v_add_u32 v10, 147456, v2
    ds_read_b128 v[196:199], v10 offset:0
    ds_read_b128 v[200:203], v10 offset:1024
    ds_read_b128 v[204:207], v10 offset:2048
    ds_read_b128 v[208:211], v10 offset:3072
    ds_read_b128 v[212:215], v10 offset:4096
    ds_read_b128 v[216:219], v10 offset:5120
    ds_read_b128 v[220:223], v10 offset:6144
    ds_read_b128 v[224:227], v10 offset:7168
    v_lshrrev_b32 v11, 5, v0
    v_lshlrev_b32 v11, 13, v11
    v_and_b32 v12, 31, v0
    v_lshl_add_u32 v11, v12, 4, v11
    s_lshl4_add_u32 s56, s67, s66
    s_lshl1_add_u32 s56, s56, s68
    s_lshl_b32 s56, s56, 9
    s_add_u32 s56, s56, 0xa0000
    s_mov_b32 s60, 0x07060503
    s_mov_b32 s61, 0x07060502
    s_mov_b32 s62, 0x07060501
    v_mov_b32 v15, s34
    s_waitcnt lgkmcnt(6)
    v_pk_add_f32 v[196:197], v[196:197], v[200:201]
    v_pk_add_f32 v[198:199], v[198:199], v[202:203]
    s_waitcnt lgkmcnt(5)
    v_pk_add_f32 v[196:197], v[196:197], v[204:205]
    v_pk_add_f32 v[198:199], v[198:199], v[206:207]
    s_waitcnt lgkmcnt(4)
    v_pk_add_f32 v[196:197], v[196:197], v[208:209]
    v_pk_add_f32 v[198:199], v[198:199], v[210:211]
    s_waitcnt lgkmcnt(3)
    v_pk_add_f32 v[196:197], v[196:197], v[212:213]
    v_pk_add_f32 v[198:199], v[198:199], v[214:215]
    s_waitcnt lgkmcnt(2)
    v_pk_add_f32 v[196:197], v[196:197], v[216:217]
    v_pk_add_f32 v[198:199], v[198:199], v[218:219]
    s_waitcnt lgkmcnt(1)
    v_pk_add_f32 v[196:197], v[196:197], v[220:221]
    v_pk_add_f32 v[198:199], v[198:199], v[222:223]
    s_waitcnt lgkmcnt(0)
    v_pk_add_f32 v[196:197], v[196:197], v[224:225]
    v_pk_add_f32 v[198:199], v[198:199], v[226:227]
    v_perm_b32 v12, v196, v199, s60
    v_perm_b32 v13, v197, v199, s61
    v_perm_b32 v14, v198, v199, s62
    s_add_u32 s57, s56, 0x800000
    buffer_store_dwordx4 v[12:15], v11, s[36:39], s57 offen
    buffer_store_dwordx4 v[12:15], v11, s[36:39], s56 offen sc1
.opub_193:
    s_mov_b32 s61, s101
    v_lshrrev_b32 v25, 4, v0
    v_bfe_u32 v26, v0, 1, 1
    v_lshl_add_u32 v25, v25, 1, v26
    v_bfe_u32 v26, v0, 2, 2
    v_lshl_add_u32 v19, v25, 3, v26
    v_lshlrev_b32 v19, 7, v19
    v_and_b32 v25, 3, v25
    v_lshrrev_b32 v26, 1, v26
    v_lshl_add_u32 v25, v25, 1, v26
    v_xor_b32 v25, s3, v25
    v_lshl_add_u32 v19, v25, 4, v19
    v_and_b32 v25, 1, v0
    v_lshl_add_u32 v19, v25, 3, v19
    v_add_u32 v20, 32768, v19
    ds_read_b64_tr_b16 v[160:161], v19 offset:0
    ds_read_b64_tr_b16 v[162:163], v19 offset:512
    ds_read_b64_tr_b16 v[164:165], v19 offset:8192
    ds_read_b64_tr_b16 v[166:167], v19 offset:8704
    ds_read_b64_tr_b16 v[168:169], v19 offset:16384
    ds_read_b64_tr_b16 v[170:171], v19 offset:16896
    ds_read_b64_tr_b16 v[172:173], v19 offset:24576
    ds_read_b64_tr_b16 v[174:175], v19 offset:25088
    ds_read_b64_tr_b16 v[176:177], v20 offset:0
    ds_read_b64_tr_b16 v[178:179], v20 offset:512
    ds_read_b64_tr_b16 v[180:181], v20 offset:8192
    ds_read_b64_tr_b16 v[182:183], v20 offset:8704
    ds_read_b64_tr_b16 v[184:185], v20 offset:16384
    ds_read_b64_tr_b16 v[186:187], v20 offset:16896
    ds_read_b64_tr_b16 v[188:189], v20 offset:24576
    ds_read_b64_tr_b16 v[190:191], v20 offset:25088
    ds_read_b64_tr_b16 v[192:193], v20 offset:32768
    ds_read_b64_tr_b16 v[194:195], v20 offset:33280
    v_add_u32 v19, 73728, v19
    v_add_u32 v20, 73728, v20
    s_mov_b32 s48, s22
    s_and_b32 s49, s23, 0xffff
    s_mov_b32 s50, 0x510000
    s_mov_b32 s51, 0x00020000
    s_mul_i32 s69, s99, 73728
    s_mul_i32 s56, s3, 9216
    s_add_u32 s69, s69, s56
    v_bfe_u32 v25, v0, 4, 1
    s_and_b32 s56, s3, 1
    s_lshl_b32 s56, s56, 2
    v_lshl_or_b32 v25, v25, 1, s56
    v_and_b32 v26, 7, v0
    v_xor_b32 v25, v25, v26
    v_lshrrev_b32 v26, 3, v0
    v_mul_u32_u24 v26, 1152, v26
    v_lshl_add_u32 v24, v25, 4, v26
    s_branch .Lsk_b1_7
.Lst_b1_7:
    s_branch .Lrt_b1_7
.Lsk_b1_7:
    s_and_b32 s58, s64, 0
    s_mul_i32 s58, s58, 18432
    s_mul_i32 s59, s3, 2304
    s_add_u32 s58, s58, s59
    s_add_u32 s62, s58, 0x37000
    s_add_u32 s63, s58, 0x49000
    s_mul_i32 s101, s64, 18432
    s_add_u32 s101, s101, s59
    s_add_u32 s101, s101, 0x170000
    s_waitcnt lgkmcnt(0)
    s_barrier
    s_add_u32 m0, s61, 0
    s_nop 0
    buffer_load_dwordx4 v24, s[48:51], s69 offen offset:0 nt lds
    s_add_u32 m0, s61, 8064
    s_nop 0
    buffer_load_dwordx4 v24, s[48:51], s69 offen offset:128 nt lds
    s_add_u32 m0, s61, 16128
    s_nop 0
    buffer_load_dwordx4 v24, s[48:51], s69 offen offset:256 nt lds
    s_add_u32 m0, s61, 24192
    s_nop 0
    buffer_load_dwordx4 v24, s[48:51], s69 offen offset:384 nt lds
    s_add_u32 m0, s61, 32256
    s_nop 0
    buffer_load_dwordx4 v24, s[48:51], s69 offen offset:512 nt lds
    s_add_u32 m0, s61, 40320
    s_nop 0
    buffer_load_dwordx4 v24, s[48:51], s69 offen offset:640 nt lds
    s_add_u32 m0, s61, 48384
    s_nop 0
    buffer_load_dwordx4 v24, s[48:51], s69 offen offset:768 nt lds
    s_add_u32 m0, s61, 56448
    s_nop 0
    buffer_load_dwordx4 v24, s[48:51], s69 offen offset:896 nt lds
    s_add_u32 m0, s61, 64512
    s_nop 0
    buffer_load_dwordx4 v24, s[48:51], s69 offen offset:1024 nt lds
    v_bfe_u32 v16, v0, 1, 3
    v_mul_u32_u24 v16, 1312, v16
    v_lshrrev_b32 v25, 4, v0
    v_lshl_add_u32 v16, v25, 5, v16
    v_and_b32 v25, 1, v0
    v_lshl_add_u32 v16, v25, 4, v16
    v_add_u32 v16, 147456, v16
    s_mul_i32 s56, s3, 1312
    s_add_u32 s56, s56, 147456
    v_add_u32 v17, s56, v3
    v_add_u32 v18, s56, v4
    v_bfe_u32 v21, v0, 1, 3
    v_mul_u32_u24 v21, 144, v21
    v_bfe_u32 v25, v0, 4, 1
    v_lshl_add_u32 v21, v25, 3, v21
    v_lshrrev_b32 v25, 5, v0
    v_lshl_add_u32 v21, v25, 2, v21
    v_and_b32 v25, 1, v0
    v_lshl_add_u32 v21, v25, 1, v21
    s_lshl_b32 s56, s3, 4
    s_add_u32 s56, s56, 157952
    v_add_u32 v21, s56, v21
    v_and_b32 v22, 15, v0
    v_lshlrev_b32 v22, 3, v22
    s_mul_i32 s56, s3, 144
    s_add_u32 s56, s56, 157952
    v_add_u32 v22, s56, v22
    s_mov_b32 s56, 157952
    v_bfe_u32 v22, v0, 1, 3
    v_mul_u32_u24 v22, 144, v22
    v_and_b32 v25, 48, v0
    v_add3_u32 v22, v22, v25, s56
    v_bfe_u32 v23, v0, 1, 3
    v_mul_u32_u24 v23, 9216, v23
    v_and_b32 v25, 1, v0
    v_lshl_add_u32 v23, v25, 4, v23
    v_and_b32 v25, 48, v0
    v_lshl_add_u32 v23, v25, 1, v23
    v_lshrrev_b32 v25, 4, v0
    v_bfe_u32 v26, v0, 2, 2
    v_lshl_add_u32 v28, v25, 3, v26
    v_lshlrev_b32 v28, 7, v28
    v_and_b32 v25, 1, v25
    v_lshrrev_b32 v26, 1, v26
    v_lshl_add_u32 v25, v25, 1, v26
    s_and_b32 s56, s3, 1
    s_lshl_b32 s56, s56, 1
    v_xor_b32 v25, s56, v25
    v_and_b32 v26, 3, v0
    v_lshl_add_u32 v28, v26, 3, v28
    s_lshr_b32 s56, s3, 1
    s_lshl_b32 s56, s56, 13
    v_add_u32 v28, s56, v28
    v_xor_b32 v26, 1, v25
    v_lshl_add_u32 v29, v26, 5, v28
    v_lshl_add_u32 v28, v25, 5, v28
    v_add_u32 v30, 0x10000, v28
    v_add_u32 v31, 0x10000, v29
    s_mul_i32 s59, s3, 73728
    s_lshl_b32 s56, s99, 7
    s_add_u32 s59, s59, s56
    s_add_u32 s59, s59, 0x1a0000
    s_add_u32 s99, s59, 589824
    s_add_u32 s100, s59, 1179648
    s_branch .gpc_195
.gp_194:
    buffer_load_dwordx4 v[32:35], v2, s[36:39], s62 offen offset:0 sc1
    buffer_load_dwordx4 v[40:43], v2, s[36:39], s62 offen offset:1024 sc1
    buffer_load_dwordx2 v[48:49], v5, s[36:39], s62 offen offset:0 sc1
    buffer_load_dwordx4 v[56:59], v2, s[36:39], s63 offen offset:0 sc1
    buffer_load_dwordx4 v[64:67], v2, s[36:39], s63 offen offset:1024 sc1
    buffer_load_dwordx2 v[72:73], v5, s[36:39], s63 offen offset:0 sc1
    s_waitcnt vmcnt(0)
.gpc_195:
    v_min_u32 v25, v33, v35
    v_max_u32 v26, v33, v35
    v_min3_u32 v25, v25, v41, v43
    v_max3_u32 v26, v26, v41, v43
    v_min3_u32 v25, v25, v49, v57
    v_max3_u32 v26, v26, v49, v57
    v_min3_u32 v25, v25, v59, v65
    v_max3_u32 v26, v26, v59, v65
    v_min3_u32 v25, v25, v67, v73
    v_max3_u32 v26, v26, v67, v73
    v_cmp_eq_u32 vcc, s34, v25
    v_cmp_eq_u32 s[56:57], s34, v26
    s_and_b64 vcc, vcc, s[56:57]
    s_cmp_eq_u64 vcc, -1
    s_nop 2
    s_cbranch_scc1 .gpd_196
    s_sub_u32 s35, s35, 1
    s_cbranch_scc1 .Lexit
    s_sleep 2
    s_branch .gp_194
.gpd_196:
    v_lshlrev_b32 v206, 16, v32
    v_and_b32 v207, 0xffff0000, v32
    v_lshlrev_b32 v216, 16, v56
    v_and_b32 v217, 0xffff0000, v56
    v_lshlrev_b32 v208, 16, v34
    v_and_b32 v209, 0xffff0000, v34
    v_lshlrev_b32 v218, 16, v58
    v_and_b32 v219, 0xffff0000, v58
    v_lshlrev_b32 v210, 16, v40
    v_and_b32 v211, 0xffff0000, v40
    v_lshlrev_b32 v220, 16, v64
    v_and_b32 v221, 0xffff0000, v64
    v_lshlrev_b32 v212, 16, v42
    v_and_b32 v213, 0xffff0000, v42
    v_lshlrev_b32 v222, 16, v66
    v_and_b32 v223, 0xffff0000, v66
    v_lshlrev_b32 v214, 16, v48
    v_and_b32 v215, 0xffff0000, v48
    v_lshlrev_b32 v224, 16, v72
    v_and_b32 v225, 0xffff0000, v72
    s_waitcnt vmcnt(9)
    s_barrier
    ds_read_b64_tr_b16 v[68:69], v19 offset:0
    ds_read_b64_tr_b16 v[70:71], v19 offset:512
    ds_read_b64_tr_b16 v[72:73], v19 offset:8192
    ds_read_b64_tr_b16 v[74:75], v19 offset:8704
    ds_read_b64_tr_b16 v[76:77], v19 offset:16384
    ds_read_b64_tr_b16 v[78:79], v19 offset:16896
    ds_read_b64_tr_b16 v[80:81], v19 offset:24576
    ds_read_b64_tr_b16 v[82:83], v19 offset:25088
    ds_read_b64_tr_b16 v[84:85], v20 offset:0
    ds_read_b64_tr_b16 v[86:87], v20 offset:512
    ds_read_b64_tr_b16 v[88:89], v20 offset:8192
    ds_read_b64_tr_b16 v[90:91], v20 offset:8704
    ds_read_b64_tr_b16 v[92:93], v20 offset:16384
    ds_read_b64_tr_b16 v[94:95], v20 offset:16896
    ds_read_b64_tr_b16 v[96:97], v20 offset:24576
    ds_read_b64_tr_b16 v[98:99], v20 offset:25088
    ds_read_b64_tr_b16 v[100:101], v20 offset:32768
    s_branch .Lsk_b2_0
.Lst_b2_0:
    s_branch .Lrt_b2_0
.Lsk_b2_0:
    ds_read_b64_tr_b16 v[102:103], v20 offset:33280
    s_waitcnt vmcnt(0)
    s_barrier
    ds_read_b64_tr_b16 v[104:105], v28 offset:0
    ds_read_b64_tr_b16 v[106:107], v28 offset:512
    ds_read_b64_tr_b16 v[108:109], v29 offset:0
    ds_read_b64_tr_b16 v[110:111], v29 offset:512
    ds_read_b64_tr_b16 v[112:113], v28 offset:4096
    ds_read_b64_tr_b16 v[114:115], v28 offset:4608
    ds_read_b64_tr_b16 v[116:117], v29 offset:4096
    ds_read_b64_tr_b16 v[118:119], v29 offset:4608
    ds_read_b64_tr_b16 v[120:121], v28 offset:32768
    ds_read_b64_tr_b16 v[122:123], v28 offset:33280
    ds_read_b64_tr_b16 v[124:125], v29 offset:32768
    ds_read_b64_tr_b16 v[126:127], v29 offset:33280
    ds_read_b64_tr_b16 v[128:129], v28 offset:36864
    ds_read_b64_tr_b16 v[130:131], v28 offset:37376
    ds_read_b64_tr_b16 v[132:133], v29 offset:36864
    ds_read_b64_tr_b16 v[134:135], v29 offset:37376
    s_cmp_ge_u32 s3, 2
    s_cbranch_scc1 .Lbc_nodn3
    ds_read_b64_tr_b16 v[136:137], v30 offset:0
    ds_read_b64_tr_b16 v[138:139], v30 offset:512
    ds_read_b64_tr_b16 v[140:141], v31 offset:0
    ds_read_b64_tr_b16 v[142:143], v31 offset:512
    ds_read_b64_tr_b16 v[144:145], v30 offset:4096
    ds_read_b64_tr_b16 v[146:147], v30 offset:4608
    ds_read_b64_tr_b16 v[148:149], v31 offset:4096
    ds_read_b64_tr_b16 v[150:151], v31 offset:4608
.Lbc_nodn3:
    s_mov_b32 s69, 0
.gp_197:
    s_add_u32 s69, s69, 1
    s_and_b32 s56, s69, 0x41
    s_cmp_lg_u32 s56, 0x41
    s_cselect_b32 s56, s0, 0
    s_add_u32 s58, s101, s56
    buffer_load_dwordx4 v[196:199], v2, s[36:39], s58 offen offset:0 sc1
    buffer_load_dwordx4 v[200:203], v2, s[36:39], s58 offen offset:1024 sc1
    buffer_load_dwordx2 v[204:205], v5, s[36:39], s58 offen offset:0 sc1
    s_waitcnt vmcnt(0)
    v_min3_u32 v25, v197, v199, v201
    v_max3_u32 v26, v197, v199, v201
    v_min3_u32 v25, v25, v203, v205
    v_max3_u32 v26, v26, v203, v205
    v_cmp_eq_u32 vcc, s34, v25
    v_cmp_eq_u32 s[56:57], s34, v26
    s_and_b64 vcc, vcc, s[56:57]
    s_cmp_eq_u64 vcc, -1
    s_nop 2
    s_cbranch_scc1 .gpd_198
    s_sub_u32 s35, s35, 1
    s_cbranch_scc1 .Lexit
    s_branch .gp_197
.gpd_198:
    s_mov_b32 s56, 0x3f803f80
    v_dot2_f32_bf16 v236, v196, s56, 0
    v_dot2_f32_bf16 v237, v196, v196, 0
    v_dot2_f32_bf16 v236, v198, s56, v236
    v_dot2_f32_bf16 v237, v198, v198, v237
    v_dot2_f32_bf16 v236, v200, s56, v236
    v_dot2_f32_bf16 v237, v200, v200, v237
    v_dot2_f32_bf16 v236, v202, s56, v236
    v_dot2_f32_bf16 v237, v202, v202, v237
    s_mov_b64 exec, 0xffffffff
    v_dot2_f32_bf16 v236, v204, s56, v236
    v_dot2_f32_bf16 v237, v204, v204, v237
    s_mov_b64 exec, -1
    s_nop 1
    v_permlane32_swap_b32 v236, v237
    v_add_f32 v236, v236, v237
    v_mov_b32 v238, v236
    s_nop 1
    v_permlane16_swap_b32 v238, v236
    v_add_f32 v236, v238, v236
    v_lshlrev_b32 v226, 16, v196
    v_and_b32 v227, 0xffff0000, v196
    v_add_f32_dpp v236, v236, v236 row_ror:8 row_mask:0xf bank_mask:0xf
    v_lshlrev_b32 v228, 16, v198
    v_and_b32 v229, 0xffff0000, v198
    v_add_f32_dpp v236, v236, v236 row_ror:4 row_mask:0xf bank_mask:0xf
    v_lshlrev_b32 v230, 16, v200
    v_and_b32 v231, 0xffff0000, v200
    v_add_f32_dpp v236, v236, v236 quad_perm:[2,3,0,1] row_mask:0xf bank_mask:0xf
    v_lshlrev_b32 v232, 16, v202
    v_and_b32 v233, 0xffff0000, v202
    v_add_f32_dpp v236, v236, v236 quad_perm:[1,0,3,2] row_mask:0xf bank_mask:0xf
    v_mul_f32 v236, 0x3ae38e39, v236
    v_lshlrev_b32 v234, 16, v204
    v_and_b32 v235, 0xffff0000, v204
    v_readlane_b32 s56, v236, 0
    v_readlane_b32 s57, v236, 32
    s_nop 0
    v_mov_b32 v236, s56
    v_fma_f32 v237, -v236, v236, s57
    v_max_f32 v237, 0, v237
    v_cvt_pk_bf16_f32 v238, -v236, v237
    v_and_b32 v239, 0xffff0000, v238
    v_add_f32 v239, 0x3727c5ac, v239
    v_lshlrev_b32 v236, 16, v238
    v_cvt_pk_bf16_f32 v239, v239, v239
    v_lshlrev_b32 v239, 16, v239
    v_sqrt_f32 v239, v239
    v_mov_b32 v237, v236
    v_cvt_pk_bf16_f32 v239, v239, v239
    v_lshlrev_b32 v239, 16, v239
    v_rcp_f32 v238, v239
    v_rcp_f32 v239, v239
    v_pk_add_f32 v[226:227], v[226:227], v[236:237]
    v_pk_add_f32 v[228:229], v[228:229], v[236:237]
    v_pk_add_f32 v[230:231], v[230:231], v[236:237]
    v_pk_add_f32 v[232:233], v[232:233], v[236:237]
    v_pk_add_f32 v[234:235], v[234:235], v[236:237]
    v_cvt_pk_bf16_f32 v226, v226, v227
    v_and_b32 v227, 0xffff0000, v226
    v_lshlrev_b32 v226, 16, v226
    v_cvt_pk_bf16_f32 v228, v228, v229
    v_and_b32 v229, 0xffff0000, v228
    v_lshlrev_b32 v228, 16, v228
    v_cvt_pk_bf16_f32 v230, v230, v231
    v_and_b32 v231, 0xffff0000, v230
    v_lshlrev_b32 v230, 16, v230
    v_cvt_pk_bf16_f32 v232, v232, v233
    v_and_b32 v233, 0xffff0000, v232
    v_lshlrev_b32 v232, 16, v232
    v_cvt_pk_bf16_f32 v234, v234, v235
    v_and_b32 v235, 0xffff0000, v234
    v_lshlrev_b32 v234, 16, v234
    v_pk_mul_f32 v[226:227], v[226:227], v[238:239]
    v_pk_mul_f32 v[228:229], v[228:229], v[238:239]
    v_pk_mul_f32 v[230:231], v[230:231], v[238:239]
    v_pk_mul_f32 v[232:233], v[232:233], v[238:239]
    v_pk_mul_f32 v[234:235], v[234:235], v[238:239]
    v_cvt_pk_bf16_f32 v226, v226, v227
    v_and_b32 v227, 0xffff0000, v226
    v_lshlrev_b32 v226, 16, v226
    v_cvt_pk_bf16_f32 v228, v228, v229
    v_and_b32 v229, 0xffff0000, v228
    v_lshlrev_b32 v228, 16, v228
    v_cvt_pk_bf16_f32 v230, v230, v231
    v_and_b32 v231, 0xffff0000, v230
    v_lshlrev_b32 v230, 16, v230
    v_cvt_pk_bf16_f32 v232, v232, v233
    v_and_b32 v233, 0xffff0000, v232
    v_lshlrev_b32 v232, 16, v232
    v_cvt_pk_bf16_f32 v234, v234, v235
    v_and_b32 v235, 0xffff0000, v234
    v_lshlrev_b32 v234, 16, v234
    v_pk_mul_f32 v[226:227], v[226:227], v[216:217]
    v_pk_mul_f32 v[228:229], v[228:229], v[218:219]
    v_pk_mul_f32 v[230:231], v[230:231], v[220:221]
    v_pk_mul_f32 v[232:233], v[232:233], v[222:223]
    v_pk_mul_f32 v[234:235], v[234:235], v[224:225]
    v_cvt_pk_bf16_f32 v226, v226, v227
    v_and_b32 v227, 0xffff0000, v226
    v_lshlrev_b32 v226, 16, v226
    v_cvt_pk_bf16_f32 v228, v228, v229
    v_and_b32 v229, 0xffff0000, v228
    v_lshlrev_b32 v228, 16, v228
    v_cvt_pk_bf16_f32 v230, v230, v231
    v_and_b32 v231, 0xffff0000, v230
    v_lshlrev_b32 v230, 16, v230
    v_cvt_pk_bf16_f32 v232, v232, v233
    v_and_b32 v233, 0xffff0000, v232
    v_lshlrev_b32 v232, 16, v232
    s_branch .Lsk_b2_1
.Lst_b2_1:
    s_branch .Lrt_b2_1
.Lsk_b2_1:
    v_cvt_pk_bf16_f32 v234, v234, v235
    v_and_b32 v235, 0xffff0000, v234
    v_lshlrev_b32 v234, 16, v234
    v_pk_add_f32 v[226:227], v[226:227], v[206:207]
    v_pk_add_f32 v[228:229], v[228:229], v[208:209]
    v_pk_add_f32 v[230:231], v[230:231], v[210:211]
    v_pk_add_f32 v[232:233], v[232:233], v[212:213]
    v_pk_add_f32 v[234:235], v[234:235], v[214:215]
    v_cvt_pk_bf16_f32 v242, v226, v227
    v_cvt_pk_bf16_f32 v243, v228, v229
    v_cvt_pk_bf16_f32 v244, v230, v231
    v_cvt_pk_bf16_f32 v245, v232, v233
    v_cvt_pk_bf16_f32 v246, v234, v235
    ds_write_b64 v17, v[242:243] offset:0
    ds_write_b64 v17, v[244:245] offset:512
    ds_write_b32 v18, v246 offset:0
    s_waitcnt lgkmcnt(0)
    s_barrier
    ds_read_b128 v[32:35], v16 offset:0
    ds_read_b128 v[36:39], v16 offset:128
    ds_read_b128 v[40:43], v16 offset:256
    ds_read_b128 v[44:47], v16 offset:384
    ds_read_b128 v[48:51], v16 offset:512
    ds_read_b128 v[52:55], v16 offset:640
    ds_read_b128 v[56:59], v16 offset:768
    ds_read_b128 v[60:63], v16 offset:896
    ds_read_b128 v[64:67], v16 offset:1024
    s_waitcnt lgkmcnt(8)
    v_mfma_f32_16x16x32_bf16 v[152:155], v[160:163], v[32:35], 0
    v_mfma_f32_16x16x32_bf16 v[156:159], v[68:71], v[32:35], 0
    s_waitcnt lgkmcnt(7)
    v_mfma_f32_16x16x32_bf16 v[152:155], v[164:167], v[36:39], v[152:155]
    v_mfma_f32_16x16x32_bf16 v[156:159], v[72:75], v[36:39], v[156:159]
    s_waitcnt lgkmcnt(6)
    v_mfma_f32_16x16x32_bf16 v[152:155], v[168:171], v[40:43], v[152:155]
    v_mfma_f32_16x16x32_bf16 v[156:159], v[76:79], v[40:43], v[156:159]
    s_waitcnt lgkmcnt(5)
    v_mfma_f32_16x16x32_bf16 v[152:155], v[172:175], v[44:47], v[152:155]
    v_mfma_f32_16x16x32_bf16 v[156:159], v[80:83], v[44:47], v[156:159]
    s_waitcnt lgkmcnt(4)
    v_mfma_f32_16x16x32_bf16 v[152:155], v[176:179], v[48:51], v[152:155]
    v_mfma_f32_16x16x32_bf16 v[156:159], v[84:87], v[48:51], v[156:159]
    s_waitcnt lgkmcnt(3)
    v_mfma_f32_16x16x32_bf16 v[152:155], v[180:183], v[52:55], v[152:155]
    v_mfma_f32_16x16x32_bf16 v[156:159], v[88:91], v[52:55], v[156:159]
    s_waitcnt lgkmcnt(2)
    v_mfma_f32_16x16x32_bf16 v[152:155], v[184:187], v[56:59], v[152:155]
    v_mfma_f32_16x16x32_bf16 v[156:159], v[92:95], v[56:59], v[156:159]
    s_waitcnt lgkmcnt(1)
    v_mfma_f32_16x16x32_bf16 v[152:155], v[188:191], v[60:63], v[152:155]
    v_mfma_f32_16x16x32_bf16 v[156:159], v[96:99], v[60:63], v[156:159]
    s_waitcnt lgkmcnt(0)
    v_mfma_f32_16x16x32_bf16 v[152:155], v[192:195], v[64:67], v[152:155]
    v_mfma_f32_16x16x32_bf16 v[156:159], v[100:103], v[64:67], v[156:159]
    s_nop 6
    v_permlane32_swap_b32 v152, v154
    v_permlane32_swap_b32 v153, v155
    v_cndmask_b32 v153, v153, v154, s[96:97]
    v_cndmask_b32 v152, v152, v155, s[96:97]
    s_nop 1
    v_add_f32_dpp v12, v153, v152 quad_perm:[1,0,3,2] row_mask:0xf bank_mask:0xf
    v_permlane32_swap_b32 v156, v158
    v_permlane32_swap_b32 v157, v159
    v_cndmask_b32 v157, v157, v158, s[96:97]
    v_cndmask_b32 v156, v156, v159, s[96:97]
    s_nop 1
    v_add_f32_dpp v14, v157, v156 quad_perm:[1,0,3,2] row_mask:0xf bank_mask:0xf
    v_cvt_pk_bf16_f32 v12, v12, v12
    v_lshlrev_b32 v12, 16, v12
    v_cvt_pk_bf16_f32 v14, v14, v14
    v_lshlrev_b32 v14, 16, v14
    v_max_f32 v12, 0xc2ae0000, v12
    v_min_f32 v27, 0x43000000, v12
    v_mul_f32 v25, 0xbfb8aa3b, v27
    v_fma_f32 v26, v27, s98, -v25
    v_fmac_f32 v26, 0xb2a57060, v27
    v_exp_f32 v25, v25
    v_mul_f32 v26, 0x3f317218, v26
    v_fmac_f32 v25, v25, v26
    v_add_f32 v25, 1.0, v25
    v_rcp_f32 v26, v25
    s_nop 0
    v_mul_f32 v27, v12, v26
    v_fma_f32 v25, -v27, v25, v12
    v_fma_f32 v12, v25, v26, v27
    v_cvt_pk_bf16_f32 v12, v12, v12
    v_lshlrev_b32 v12, 16, v12
    v_mul_f32 v12, v12, v14
    v_cvt_pk_bf16_f32 v12, v12, v12
    ds_write_b16 v21, v12
    s_mov_b32 s60, 0x07060503
    s_mov_b32 s61, 0x07060502
    s_mov_b32 s62, 0x07060501
    s_mov_b32 vcc_lo, 0xaaaaaaaa
    s_mov_b32 vcc_hi, 0xaaaaaaaa
    v_mov_b32 v59, s34
    v_mov_b32 v63, s34
    v_mov_b32 v67, s34
    s_waitcnt lgkmcnt(0)
    s_barrier
    ds_read_b128 v[8:11], v22
    ds_read_b128 v[12:15], v22 offset:64
    s_waitcnt lgkmcnt(1)
    v_mfma_f32_16x16x32_bf16 v[32:35], v[104:107], v[8:11], 0
    v_mfma_f32_16x16x32_bf16 v[36:39], v[108:111], v[8:11], 0
    v_mfma_f32_16x16x32_bf16 v[40:43], v[120:123], v[8:11], 0
    v_mfma_f32_16x16x32_bf16 v[44:47], v[124:127], v[8:11], 0
    v_mfma_f32_16x16x32_bf16 v[48:51], v[136:139], v[8:11], 0
    v_mfma_f32_16x16x32_bf16 v[52:55], v[140:143], v[8:11], 0
    s_waitcnt lgkmcnt(0)
    v_mfma_f32_16x16x32_bf16 v[32:35], v[112:115], v[12:15], v[32:35]
    v_mfma_f32_16x16x32_bf16 v[36:39], v[116:119], v[12:15], v[36:39]
    v_mfma_f32_16x16x32_bf16 v[40:43], v[128:131], v[12:15], v[40:43]
    v_mfma_f32_16x16x32_bf16 v[44:47], v[132:135], v[12:15], v[44:47]
    v_mfma_f32_16x16x32_bf16 v[48:51], v[144:147], v[12:15], v[48:51]
    v_mfma_f32_16x16x32_bf16 v[52:55], v[148:151], v[12:15], v[52:55]
    s_nop 3
    v_cndmask_b32 v32, v32, v36, vcc
    v_cndmask_b32 v33, v33, v37, vcc
    v_cndmask_b32 v34, v34, v38, vcc
    v_cndmask_b32 v35, v35, v39, vcc
    v_perm_b32 v56, v32, v35, s60
    v_perm_b32 v57, v33, v35, s61
    v_perm_b32 v58, v34, v35, s62
    buffer_store_dwordx4 v[56:59], v23, s[36:39], s59 offen sc1
    v_cndmask_b32 v40, v40, v44, vcc
    v_cndmask_b32 v41, v41, v45, vcc
    v_cndmask_b32 v42, v42, v46, vcc
    v_cndmask_b32 v43, v43, v47, vcc
    v_perm_b32 v60, v40, v43, s60
    v_perm_b32 v61, v41, v43, s61
    v_perm_b32 v62, v42, v43, s62
    buffer_store_dwordx4 v[60:63], v23, s[36:39], s99 offen sc1
    v_cndmask_b32 v48, v48, v52, vcc
    v_cndmask_b32 v49, v49, v53, vcc
    v_cndmask_b32 v50, v50, v54, vcc
    v_cndmask_b32 v51, v51, v55, vcc
    v_perm_b32 v64, v48, v51, s60
    v_perm_b32 v65, v49, v51, s61
    v_perm_b32 v66, v50, v51, s62
    s_cmp_ge_u32 s3, 2
    s_nop 0
    s_cbranch_scc1 .Lbc_nost3
    buffer_store_dwordx4 v[64:67], v23, s[36:39], s100 offen sc1
.Lbc_nost3:
.Lexit:
.Lend:
s_endpgm
.section .rodata,"a"
.p2align 6
.amdhsa_kernel adaLN_cond__sliding_block_cached__moe_arch_mod__decode_kernel
  .amdhsa_next_free_vgpr 256
  .amdhsa_next_free_sgpr 102
  .amdhsa_accum_offset 256
  .amdhsa_group_segment_fixed_size 0
  .amdhsa_kernarg_size 120
  .amdhsa_user_sgpr_count 2
  .amdhsa_user_sgpr_kernarg_segment_ptr 1
  .amdhsa_system_sgpr_workgroup_id_x 1
.end_amdhsa_kernel
```

```asm
; @launch grid=(256,1,1) block=(512,1,1) lds=159360
.amdgcn_target "amdgcn-amd-amdhsa--gfx950"
.text
.p2align 12
.globl adaLN_cond__sliding_block_cached__moe_arch_mod__decode_kernel
.p2align 8
.type adaLN_cond__sliding_block_cached__moe_arch_mod__decode_kernel,@function
adaLN_cond__sliding_block_cached__moe_arch_mod__decode_kernel:
    s_cmp_ge_u32 s2, 256
    s_cbranch_scc1 .Lend
    s_load_dwordx16 s[4:19], s[0:1], 0
    s_load_dwordx8 s[20:27], s[0:1], 64
    s_load_dwordx4 s[28:31], s[0:1], 96
    s_load_dwordx2 s[32:33], s[0:1], 112
    s_memrealtime s[70:71]
    v_lshrrev_b32 v1, 6, v0
    v_and_b32 v0, 63, v0
    v_readfirstlane_b32 s3, v1
    s_cmp_lt_u32 s3, 4
    s_nop 3
    s_cbranch_scc1 .Ltw_done
    s_cmp_lt_u32 s2, 72
    s_cbranch_scc1 .Ltw_m
    s_cmp_lt_u32 s2, 144
    s_cbranch_scc1 .Ltw_b
    s_cmp_lt_u32 s2, 208
    s_cbranch_scc1 .Ltw_q
    s_cmp_eq_u32 s3, 4
    s_cbranch_scc1 .Lst_a0_0
    s_cmp_eq_u32 s3, 5
    s_cbranch_scc1 .Lst_a0_1
.Lrt_a0_0:
.Lrt_a0_1:
    s_branch .Ltw_done
.Ltw_m:
    s_cmp_eq_u32 s3, 4
    s_cbranch_scc1 .Lst_m0_0
    s_cmp_eq_u32 s3, 5
    s_cbranch_scc1 .Lst_m0_1
.Lrt_m0_1:
    s_cmp_eq_u32 s3, 6
    s_cbranch_scc1 .Lst_m0_2
.Lrt_m0_2:
    s_cmp_eq_u32 s3, 7
    s_cbranch_scc1 .Lst_m0_3
    s_cmp_eq_u32 s3, 5
    s_cbranch_scc1 .Lst_m0_4
    s_cmp_eq_u32 s3, 6
    s_cbranch_scc1 .Lst_m0_5
.Lrt_m0_0:
.Lrt_m0_3:
.Lrt_m0_4:
.Lrt_m0_5:
    s_branch .Ltw_done
.Ltw_b:
    s_cmp_eq_u32 s3, 4
    s_cbranch_scc1 .Lst_b0_0
    s_cmp_eq_u32 s3, 5
    s_cbranch_scc1 .Lst_b0_1
    s_cmp_eq_u32 s3, 6
    s_cbranch_scc1 .Lst_b0_2
    s_cmp_eq_u32 s3, 7
    s_cbranch_scc1 .Lst_b0_3
.Lrt_b0_0:
.Lrt_b0_1:
.Lrt_b0_2:
.Lrt_b0_3:
    s_branch .Ltw_done
.Ltw_q:
    s_cmp_eq_u32 s3, 4
    s_cbranch_scc1 .Lst_q0_0
    s_cmp_eq_u32 s3, 5
    s_cbranch_scc1 .Lst_q0_1
    s_cmp_eq_u32 s3, 6
    s_cbranch_scc1 .Lst_q0_2
    s_cmp_eq_u32 s3, 7
    s_cbranch_scc1 .Lst_q0_3
.Lrt_q0_0:
.Lrt_q0_1:
.Lrt_q0_2:
.Lrt_q0_3:
.Ltw_done:
    s_mov_b32 s35, 0x3ffff
    s_mov_b32 s98, 0xbfb8aa3b
    s_mov_b32 s94, 0x05040100
    s_mov_b32 s95, 0x07060302
    s_mov_b32 s96, 0xaaaaaaaa
    s_mov_b32 s97, 0xaaaaaaaa
    s_and_b32 s64, s2, 7
    s_lshr_b32 s65, s2, 3
    s_mov_b32 s58, 0x2554433
    s_mov_b32 s59, 0x2877661
    s_cmp_ge_u32 s65, 16
    s_cselect_b32 s58, 0xbb1aa998, s58
    s_cselect_b32 s59, 0xffeeddcc, s59
    s_lshl_b32 s57, s65, 2
    s_lshr_b64 s[58:59], s[58:59], s57
    s_lshl1_add_u32 s59, s64, 1
    s_mul_i32 s58, s58, s59
    s_add_u32 s58, s58, s64
    s_add_u32 s58, s58, s59
    s_and_b32 s66, s58, 7
    s_bfe_u32 s67, s58, 0x10003
    s_lshl1_add_u32 s67, s64, s67
    s_lshr_b32 s68, 0xaab5d42a, s65
    s_and_b32 s68, s68, 1
    s_movk_i32 s60, 0x7651
    s_cselect_b32 s60, 0x4320, s60
    s_lshl4_add_u32 s69, s66, s67
    s_lshl_b32 s69, s69, 21
    s_cmp_eq_u32 s64, 7
    s_cselect_b32 s58, 0x4040, 0
    s_or_b32 s58, s58, 0x208180
    s_bitcmp1_b32 s58, s65
    s_cselect_b32 s60, s60, 0x3210
    s_and_b32 s57, s3, 1
    s_and_b32 s59, s3, 6
    s_cmpk_eq_u32 s60, 0x3210
    s_cselect_b32 s57, s68, s57
    s_cselect_b32 s59, s3, s59
    s_lshl_b32 s57, s57, 16
    s_lshl_b32 s59, s59, 10
    s_add_u32 s69, s69, s57
    s_add_u32 s69, s69, s59
    s_add_u32 s69, s69, 0x180000
    v_bfe_u32 v1, v0, 2, 2
    v_lshlrev_b32 v1, 2, v1
    v_bfe_u32 v1, s60, v1, 4
    v_lshrrev_b32 v2, 4, v0
    v_lshl_add_u32 v1, v1, 2, v2
    v_and_b32 v2, 3, v0
    v_lshl_add_u32 v1, v1, 2, v2
    v_lshlrev_b32 v1, 4, v1
    v_lshlrev_b32 v2, 4, v0
    v_lshlrev_b32 v3, 3, v0
    v_and_b32 v4, 31, v0
    v_lshlrev_b32 v4, 2, v4
    v_add_u32 v4, 1024, v4
    v_lshlrev_b32 v5, 1, v4
    s_waitcnt lgkmcnt(0)
    s_load_dword s34, s[32:33], 0
    s_mov_b32 s40, s6
    s_and_b32 s41, s7, 0xffff
    s_mov_b32 s42, 0x10000000
    s_mov_b32 s43, 0x00020000
    s_mov_b32 s6, s60
    s_add_u32 s63, s69, 0
    buffer_load_dwordx4 v[32:35], v1, s[40:43], s63 offen nt
    s_add_u32 s63, s69, 8192
    buffer_load_dwordx4 v[36:39], v1, s[40:43], s63 offen nt
    s_add_u32 s63, s69, 16384
    buffer_load_dwordx4 v[64:67], v1, s[40:43], s63 offen nt
    s_add_u32 s63, s69, 24576
    buffer_load_dwordx4 v[68:71], v1, s[40:43], s63 offen nt
.Lnokpre:
    s_mov_b32 s44, s8
    s_and_b32 s45, s9, 0xffff
    s_mov_b32 s46, 0x10000000
    s_mov_b32 s47, 0x00020000
    s_cmp_eq_u32 s3, 0
    s_cselect_b64 exec, 1, 0
    buffer_load_dword v255, v2, s[44:47], s69 offen nt
    s_mov_b64 exec, -1
    s_mov_b32 s36, s32
    s_and_b32 s37, s33, 0xffff
    s_mov_b32 s38, 0x40000000
    s_mov_b32 s39, 0x00020000
    s_lshl3_add_u32 s56, s3, s2
    s_cmp_lt_u32 s56, 8
    s_cbranch_scc0 .Let_no
    s_lshl2_add_u32 s56, s2, 0x4a1000
    v_lshlrev_b32 v6, 8, v0
    v_mov_b32 v7, s70
    s_mov_b64 exec, 3
    buffer_store_dword v7, v6, s[36:39], s56 offen sc1
    s_mov_b64 exec, -1
.Let_no:
    v_mov_b32 v6, 159232
    v_mov_b32 v7, 0
    ds_write_b32 v6, v7
    s_waitcnt lgkmcnt(0)
    s_barrier
    s_cmp_lt_u32 s3, 4
    s_cbranch_scc1 1
    s_setprio 1
    s_cmp_lt_u32 s65, 9
    s_cbranch_scc1 .Lm
    s_cmp_lt_u32 s65, 18
    s_cbranch_scc1 .Lbc
    s_sub_u32 s65, s65, 18
    s_cmp_ge_u32 s65, 8
    s_cbranch_scc1 .La_early
    s_cmp_eq_u32 s65, 3
    s_mov_b32 s14, 0xb55aab55
    s_cselect_b32 s14, 0x8421084, s14
    s_mov_b32 s15, 0x5aab55aa
    s_cselect_b32 s15, 0x42108421, s15
    s_add_u32 s30, s70, 0
    s_mov_b32 s31, s70
    v_bfe_u32 v16, v0, 1, 3
    v_mul_u32_u24 v16, 1312, v16
    v_lshrrev_b32 v12, 4, v0
    v_lshl_add_u32 v16, v12, 5, v16
    v_and_b32 v12, 1, v0
    v_lshl_add_u32 v16, v12, 4, v16
    v_add_u32 v16, 147456, v16
    s_mul_i32 s56, s3, 1312
    s_add_u32 s56, s56, 147456
    v_add_u32 v17, s56, v3
    v_add_u32 v18, s56, v4
    v_lshrrev_b32 v12, 4, v0
    v_bfe_u32 v13, v0, 1, 1
    v_lshl_add_u32 v12, v12, 1, v13
    v_bfe_u32 v13, v0, 2, 2
    v_lshl_add_u32 v20, v12, 3, v13
    v_lshlrev_b32 v20, 7, v20
    v_and_b32 v12, 3, v12
    v_lshrrev_b32 v13, 1, v13
    v_lshl_add_u32 v12, v12, 1, v13
    v_xor_b32 v12, s3, v12
    v_lshl_add_u32 v20, v12, 4, v20
    v_and_b32 v12, 1, v0
    v_lshl_add_u32 v20, v12, 3, v20
    v_bfe_u32 v23, v0, 1, 3
    v_mul_u32_u24 v23, 144, v23
    v_bfe_u32 v12, v0, 4, 1
    v_lshl_add_u32 v23, v12, 3, v23
    s_branch .Lsk_q0_0
.Lst_q0_0:
    s_branch .Lrt_q0_0
.Lsk_q0_0:
    v_lshrrev_b32 v12, 5, v0
    v_lshl_add_u32 v23, v12, 2, v23
    v_and_b32 v12, 1, v0
    v_lshl_add_u32 v23, v12, 1, v23
    s_lshl_b32 s56, s3, 4
    s_add_u32 s56, s56, 157952
    v_add_u32 v23, s56, v23
    v_and_b32 v24, 15, v0
    v_lshlrev_b32 v24, 3, v24
    s_mul_i32 s56, s3, 144
    s_add_u32 s56, s56, 157952
    v_add_u32 v24, s56, v24
    v_add_u32 v21, 32768, v20
    s_lshl_b32 s100, s3, 10
    s_mul_i32 s58, s3, 1152
    s_mov_b32 s52, s4
    s_and_b32 s53, s5, 0xffff
    s_mov_b32 s54, 0x2400
    s_mov_b32 s55, 0x00020000
    buffer_load_dwordx2 v[246:247], v3, s[52:55], s58 offen
    buffer_load_dwordx2 v[248:249], v3, s[52:55], s58 offen offset:512
    buffer_load_dword v250, v4, s[52:55], s58 offen
    s_mov_b32 s48, s10
    s_and_b32 s49, s11, 0xffff
    s_mov_b32 s50, 0x480000
    s_mov_b32 s51, 0x00020000
    v_bfe_u32 v12, v0, 4, 1
    s_and_b32 s56, s3, 3
    s_lshl_b32 s56, s56, 1
    v_or_b32 v12, s56, v12
    v_and_b32 v19, 7, v0
    v_xor_b32 v12, v12, v19
    v_lshrrev_b32 v19, 3, v0
    v_mul_u32_u24 v19, 8192, v19
    v_lshl_add_u32 v19, v12, 4, v19
    s_lshl3_add_u32 s101, s64, s65
    s_lshl_b32 s57, s3, 16
    s_lshl_b32 s59, s101, 7
    s_add_u32 s57, s57, s59
    s_mov_b32 s99, s57
    s_add_u32 m0, s100, 0
    s_add_u32 s56, s99, 0
    buffer_load_dwordx4 v19, s[48:51], s56 offen nt lds
    s_add_u32 s63, s69, 32768
    buffer_load_dwordx4 v[96:99], v1, s[40:43], s63 offen nt
    s_waitcnt lgkmcnt(0)
    s_add_u32 s34, s34, 1
    s_getreg_b32 s1, hwreg(HW_REG_XCC_ID)
    s_lshl_b32 s1, s1, 24
    s_add_u32 s1, s1, s34
    s_lshr_b32 s0, s2, 3
    s_lshl_b32 s63, s64, 8
    s_add_u32 s0, s0, s63
    s_lshl2_add_u32 s0, s0, 0x480000
    v_mov_b32 v30, s1
    s_cmp_eq_u32 s3, 0
    s_cselect_b64 exec, 1, 0
    buffer_store_dword v30, v2, s[36:39], s0 offen sc1
    s_mov_b64 exec, -1
    s_and_b32 s58, s101, 1
    s_lshl_b32 s101, s101, 8
    s_lshl_b32 s58, s58, 7
    s_sub_u32 s101, s101, s58
    s_lshl_b32 s58, s3, 14
    s_add_u32 s101, s101, s58
    s_add_u32 s101, s101, 0x70000
    s_and_b32 s58, s64, 1
    s_mul_i32 s58, s58, 18432
    s_mul_i32 s59, s3, 2304
    s_add_u32 s58, s58, s59
    s_add_u32 s58, s58, 0x1000
    s_add_u32 s59, s58, 73728
    s_waitcnt vmcnt(5)
    s_add_u32 m0, s100, 8192
    s_add_u32 s56, s99, 524288
    buffer_load_dwordx4 v19, s[48:51], s56 offen nt lds
    s_waitcnt vmcnt(5)
    s_add_u32 s63, s69, 40960
    buffer_load_dwordx4 v[100:103], v1, s[40:43], s63 offen nt
    s_waitcnt vmcnt(5)
    s_add_u32 m0, s100, 16384
    s_add_u32 s56, s99, 1048576
    buffer_load_dwordx4 v19, s[48:51], s56 offen nt lds
    s_waitcnt vmcnt(5)
    s_add_u32 s63, s69, 49152
    buffer_load_dwordx4 v[128:131], v1, s[40:43], s63 offen nt
    v_lshlrev_b32 v236, 16, v246
    v_and_b32 v237, 0xffff0000, v246
    v_lshlrev_b32 v238, 16, v247
    v_and_b32 v239, 0xffff0000, v247
    v_lshlrev_b32 v240, 16, v248
    v_and_b32 v241, 0xffff0000, v248
    v_lshlrev_b32 v242, 16, v249
    v_and_b32 v243, 0xffff0000, v249
    v_lshlrev_b32 v244, 16, v250
    v_and_b32 v245, 0xffff0000, v250
    s_mov_b32 s56, 0x3f803f80
    v_dot2_f32_bf16 v10, v246, s56, 0
    v_dot2_f32_bf16 v11, v246, v246, 0
    v_dot2_f32_bf16 v10, v247, s56, v10
    v_dot2_f32_bf16 v11, v247, v247, v11
    v_dot2_f32_bf16 v10, v248, s56, v10
    v_dot2_f32_bf16 v11, v248, v248, v11
    v_dot2_f32_bf16 v10, v249, s56, v10
    v_dot2_f32_bf16 v11, v249, v249, v11
    s_mov_b64 exec, 0xffffffff
    v_dot2_f32_bf16 v10, v250, s56, v10
    v_dot2_f32_bf16 v11, v250, v250, v11
    s_mov_b64 exec, -1
    s_nop 1
    v_permlane32_swap_b32 v10, v11
    v_add_f32 v10, v10, v11
    v_mov_b32 v12, v10
    s_nop 1
    v_permlane16_swap_b32 v12, v10
    v_add_f32 v10, v12, v10
    s_nop 1
    v_add_f32_dpp v10, v10, v10 row_ror:8 row_mask:0xf bank_mask:0xf
    s_nop 1
    v_add_f32_dpp v10, v10, v10 row_ror:4 row_mask:0xf bank_mask:0xf
    s_nop 1
    v_add_f32_dpp v10, v10, v10 quad_perm:[2,3,0,1] row_mask:0xf bank_mask:0xf
    s_nop 1
    v_add_f32_dpp v10, v10, v10 quad_perm:[1,0,3,2] row_mask:0xf bank_mask:0xf
    v_mul_f32 v10, 0x3ae38e39, v10
    s_nop 0
    v_readlane_b32 s56, v10, 0
    v_readlane_b32 s57, v10, 32
    s_nop 0
    v_mov_b32 v10, s56
    v_fma_f32 v11, -v10, v10, s57
    v_max_f32 v11, 0, v11
    v_cvt_pk_bf16_f32 v12, -v10, v11
    v_and_b32 v13, 0xffff0000, v12
    v_add_f32 v13, 0x3727c5ac, v13
    v_lshlrev_b32 v10, 16, v12
    v_cvt_pk_bf16_f32 v13, v13, v13
    v_lshlrev_b32 v13, 16, v13
    v_sqrt_f32 v13, v13
    v_mov_b32 v11, v10
    v_cvt_pk_bf16_f32 v13, v13, v13
    v_lshlrev_b32 v13, 16, v13
    v_rcp_f32 v12, v13
    v_rcp_f32 v13, v13
    v_pk_add_f32 v[236:237], v[236:237], v[10:11]
    v_pk_add_f32 v[238:239], v[238:239], v[10:11]
    v_pk_add_f32 v[240:241], v[240:241], v[10:11]
    v_pk_add_f32 v[242:243], v[242:243], v[10:11]
    v_pk_add_f32 v[244:245], v[244:245], v[10:11]
    v_cvt_pk_bf16_f32 v236, v236, v237
    v_and_b32 v237, 0xffff0000, v236
    v_lshlrev_b32 v236, 16, v236
    v_cvt_pk_bf16_f32 v238, v238, v239
    v_and_b32 v239, 0xffff0000, v238
    v_lshlrev_b32 v238, 16, v238
    v_cvt_pk_bf16_f32 v240, v240, v241
    v_and_b32 v241, 0xffff0000, v240
    v_lshlrev_b32 v240, 16, v240
    v_cvt_pk_bf16_f32 v242, v242, v243
    v_and_b32 v243, 0xffff0000, v242
    v_lshlrev_b32 v242, 16, v242
    v_cvt_pk_bf16_f32 v244, v244, v245
    v_and_b32 v245, 0xffff0000, v244
    v_lshlrev_b32 v244, 16, v244
    v_pk_mul_f32 v[236:237], v[236:237], v[12:13]
    v_pk_mul_f32 v[238:239], v[238:239], v[12:13]
    v_pk_mul_f32 v[240:241], v[240:241], v[12:13]
    v_pk_mul_f32 v[242:243], v[242:243], v[12:13]
    v_pk_mul_f32 v[244:245], v[244:245], v[12:13]
    v_cvt_pk_bf16_f32 v236, v236, v237
    v_and_b32 v237, 0xffff0000, v236
    v_lshlrev_b32 v236, 16, v236
    v_cvt_pk_bf16_f32 v238, v238, v239
    v_and_b32 v239, 0xffff0000, v238
    v_lshlrev_b32 v238, 16, v238
    v_cvt_pk_bf16_f32 v240, v240, v241
    s_branch .Lsk_q0_1
.Lst_q0_1:
    s_branch .Lrt_q0_1
.Lsk_q0_1:
    v_and_b32 v241, 0xffff0000, v240
    v_lshlrev_b32 v240, 16, v240
    v_cvt_pk_bf16_f32 v242, v242, v243
    v_and_b32 v243, 0xffff0000, v242
    v_lshlrev_b32 v242, 16, v242
    v_cvt_pk_bf16_f32 v244, v244, v245
    v_and_b32 v245, 0xffff0000, v244
    v_lshlrev_b32 v244, 16, v244
    s_waitcnt vmcnt(5)
    s_add_u32 m0, s100, 24576
    s_add_u32 s56, s99, 1572864
    buffer_load_dwordx4 v19, s[48:51], s56 offen nt lds
    s_waitcnt vmcnt(4)
    s_add_u32 s63, s69, 57344
    buffer_load_dwordx4 v[132:135], v1, s[40:43], s63 offen nt
    s_waitcnt vmcnt(4)
    s_add_u32 m0, s100, 32768
    s_add_u32 s56, s99, 2097152
    buffer_load_dwordx4 v19, s[48:51], s56 offen nt lds
    s_waitcnt vmcnt(4)
    s_add_u32 s63, s69, 131072
    buffer_load_dwordx4 v[40:43], v1, s[40:43], s63 offen nt
    s_waitcnt vmcnt(4)
    s_add_u32 m0, s100, 40960
    s_add_u32 s56, s99, 2621440
    buffer_load_dwordx4 v19, s[48:51], s56 offen nt lds
    s_waitcnt vmcnt(4)
    s_add_u32 s63, s69, 139264
    buffer_load_dwordx4 v[44:47], v1, s[40:43], s63 offen nt
    s_waitcnt vmcnt(4)
    s_add_u32 m0, s100, 49152
    s_add_u32 s56, s99, 3145728
    buffer_load_dwordx4 v19, s[48:51], s56 offen nt lds
    s_waitcnt vmcnt(4)
    s_add_u32 s63, s69, 147456
    buffer_load_dwordx4 v[72:75], v1, s[40:43], s63 offen nt
    s_waitcnt vmcnt(4)
    s_add_u32 m0, s100, 57344
    s_add_u32 s56, s99, 3670016
    buffer_load_dwordx4 v19, s[48:51], s56 offen nt lds
    s_waitcnt vmcnt(4)
    s_add_u32 s63, s69, 155648
    buffer_load_dwordx4 v[76:79], v1, s[40:43], s63 offen nt
    s_waitcnt vmcnt(4)
    s_add_u32 m0, s100, 65536
    s_add_u32 s56, s99, 4194304
    buffer_load_dwordx4 v19, s[48:51], s56 offen nt lds
    s_waitcnt vmcnt(4)
    s_add_u32 s63, s69, 163840
    buffer_load_dwordx4 v[104:107], v1, s[40:43], s63 offen nt
    s_waitcnt vmcnt(4)
    s_add_u32 s63, s69, 172032
    buffer_load_dwordx4 v[108:111], v1, s[40:43], s63 offen nt
    s_waitcnt vmcnt(4)
    s_add_u32 s63, s69, 180224
    buffer_load_dwordx4 v[136:139], v1, s[40:43], s63 offen nt
    s_waitcnt vmcnt(4)
    s_add_u32 s63, s69, 188416
    buffer_load_dwordx4 v[140:143], v1, s[40:43], s63 offen nt
    s_waitcnt vmcnt(4)
    s_add_u32 s63, s69, 262144
    buffer_load_dwordx4 v[48:51], v1, s[40:43], s63 offen nt
    s_waitcnt vmcnt(4)
    s_add_u32 s63, s69, 270336
    buffer_load_dwordx4 v[52:55], v1, s[40:43], s63 offen nt
    buffer_load_dwordx4 v[196:199], v2, s[36:39], s58 offen offset:0 sc1
    buffer_load_dwordx4 v[200:203], v2, s[36:39], s58 offen offset:1024 sc1
    buffer_load_dwordx2 v[204:205], v5, s[36:39], s58 offen offset:0 sc1
    buffer_load_dwordx4 v[206:209], v2, s[36:39], s59 offen offset:0 sc1
    buffer_load_dwordx4 v[210:213], v2, s[36:39], s59 offen offset:1024 sc1
    buffer_load_dwordx2 v[214:215], v5, s[36:39], s59 offen offset:0 sc1
    s_add_u32 s63, s69, 278528
    buffer_load_dwordx4 v[80:83], v1, s[40:43], s63 offen nt
    s_add_u32 s63, s69, 286720
    buffer_load_dwordx4 v[84:87], v1, s[40:43], s63 offen nt
    s_add_u32 s63, s69, 294912
    buffer_load_dwordx4 v[112:115], v1, s[40:43], s63 offen nt
    s_barrier
    ds_read_b64_tr_b16 v[160:161], v20 offset:0
    ds_read_b64_tr_b16 v[162:163], v20 offset:512
    ds_read_b64_tr_b16 v[164:165], v20 offset:8192
    ds_read_b64_tr_b16 v[166:167], v20 offset:8704
    ds_read_b64_tr_b16 v[168:169], v20 offset:16384
    ds_read_b64_tr_b16 v[170:171], v20 offset:16896
    ds_read_b64_tr_b16 v[172:173], v20 offset:24576
    ds_read_b64_tr_b16 v[174:175], v20 offset:25088
    ds_read_b64_tr_b16 v[176:177], v21 offset:0
    ds_read_b64_tr_b16 v[178:179], v21 offset:512
    ds_read_b64_tr_b16 v[180:181], v21 offset:8192
    ds_read_b64_tr_b16 v[182:183], v21 offset:8704
    ds_read_b64_tr_b16 v[184:185], v21 offset:16384
    ds_read_b64_tr_b16 v[186:187], v21 offset:16896
    ds_read_b64_tr_b16 v[188:189], v21 offset:24576
    ds_read_b64_tr_b16 v[190:191], v21 offset:25088
    ds_read_b64_tr_b16 v[192:193], v21 offset:32768
    ds_read_b64_tr_b16 v[194:195], v21 offset:33280
    s_add_u32 s63, s69, 303104
    buffer_load_dwordx4 v[116:119], v1, s[40:43], s63 offen nt
    s_waitcnt vmcnt(4)
    s_branch .gpc_2
.gp_1:
    buffer_load_dwordx4 v[196:199], v2, s[36:39], s58 offen offset:0 sc1
    buffer_load_dwordx4 v[200:203], v2, s[36:39], s58 offen offset:1024 sc1
    buffer_load_dwordx2 v[204:205], v5, s[36:39], s58 offen offset:0 sc1
    buffer_load_dwordx4 v[206:209], v2, s[36:39], s59 offen offset:0 sc1
    buffer_load_dwordx4 v[210:213], v2, s[36:39], s59 offen offset:1024 sc1
    buffer_load_dwordx2 v[214:215], v5, s[36:39], s59 offen offset:0 sc1
    s_waitcnt vmcnt(0)
.gpc_2:
    v_min_u32 v10, v197, v199
    v_max_u32 v11, v197, v199
    v_min3_u32 v10, v10, v201, v203
    v_max3_u32 v11, v11, v201, v203
    v_min3_u32 v10, v10, v205, v207
    v_max3_u32 v11, v11, v205, v207
    v_min3_u32 v10, v10, v209, v211
    v_max3_u32 v11, v11, v209, v211
    v_min3_u32 v10, v10, v213, v215
    v_max3_u32 v11, v11, v213, v215
    v_cmp_eq_u32 vcc, s34, v10
    v_cmp_eq_u32 s[56:57], s34, v11
    s_and_b64 vcc, vcc, s[56:57]
    s_cmp_eq_u64 vcc, -1
    s_nop 2
    s_cbranch_scc1 .gpd_3
    s_sub_u32 s35, s35, 1
    s_cbranch_scc1 .Lexit
    s_branch .gp_1
.gpd_3:
    s_add_u32 s63, s69, 311296
    buffer_load_dwordx4 v[144:147], v1, s[40:43], s63 offen nt
    v_and_b32 v207, 0xffff0000, v206
    v_lshlrev_b32 v206, 16, v206
    v_and_b32 v209, 0xffff0000, v208
    v_lshlrev_b32 v208, 16, v208
    v_and_b32 v211, 0xffff0000, v210
    v_lshlrev_b32 v210, 16, v210
    v_and_b32 v213, 0xffff0000, v212
    v_lshlrev_b32 v212, 16, v212
    v_and_b32 v215, 0xffff0000, v214
    v_lshlrev_b32 v214, 16, v214
    v_and_b32 v197, 0xffff0000, v196
    v_lshlrev_b32 v196, 16, v196
    v_and_b32 v199, 0xffff0000, v198
    v_lshlrev_b32 v198, 16, v198
    v_and_b32 v201, 0xffff0000, v200
    v_lshlrev_b32 v200, 16, v200
    v_and_b32 v203, 0xffff0000, v202
    v_lshlrev_b32 v202, 16, v202
    v_and_b32 v205, 0xffff0000, v204
    v_lshlrev_b32 v204, 16, v204
    v_pk_mul_f32 v[236:237], v[236:237], v[206:207]
    v_pk_mul_f32 v[238:239], v[238:239], v[208:209]
    v_pk_mul_f32 v[240:241], v[240:241], v[210:211]
    v_pk_mul_f32 v[242:243], v[242:243], v[212:213]
    v_pk_mul_f32 v[244:245], v[244:245], v[214:215]
    v_cvt_pk_bf16_f32 v236, v236, v237
    v_and_b32 v237, 0xffff0000, v236
    v_lshlrev_b32 v236, 16, v236
    v_cvt_pk_bf16_f32 v238, v238, v239
    v_and_b32 v239, 0xffff0000, v238
    s_branch .Lsk_q0_2
.Lst_q0_2:
    s_branch .Lrt_q0_2
.Lsk_q0_2:
    v_lshlrev_b32 v238, 16, v238
    v_cvt_pk_bf16_f32 v240, v240, v241
    v_and_b32 v241, 0xffff0000, v240
    v_lshlrev_b32 v240, 16, v240
    v_cvt_pk_bf16_f32 v242, v242, v243
    v_and_b32 v243, 0xffff0000, v242
    v_lshlrev_b32 v242, 16, v242
    v_cvt_pk_bf16_f32 v244, v244, v245
    s_branch .Lsk_q0_3
.Lst_q0_3:
    s_branch .Lrt_q0_3
.Lsk_q0_3:
    v_and_b32 v245, 0xffff0000, v244
    v_lshlrev_b32 v244, 16, v244
    v_pk_add_f32 v[236:237], v[236:237], v[196:197]
    v_pk_add_f32 v[238:239], v[238:239], v[198:199]
    v_pk_add_f32 v[240:241], v[240:241], v[200:201]
    v_pk_add_f32 v[242:243], v[242:243], v[202:203]
    v_pk_add_f32 v[244:245], v[244:245], v[204:205]
    v_cvt_pk_bf16_f32 v246, v236, v237
    v_cvt_pk_bf16_f32 v247, v238, v239
    v_cvt_pk_bf16_f32 v248, v240, v241
    v_cvt_pk_bf16_f32 v249, v242, v243
    v_cvt_pk_bf16_f32 v250, v244, v245
    ds_write_b64 v17, v[246:247] offset:0
    ds_write_b64 v17, v[248:249] offset:512
    ds_write_b32 v18, v250 offset:0
    s_add_u32 s63, s69, 319488
    buffer_load_dwordx4 v[148:151], v1, s[40:43], s63 offen nt
    s_waitcnt lgkmcnt(0)
    s_barrier
    s_add_u32 s63, s69, 393216
    buffer_load_dwordx4 v[56:59], v1, s[40:43], s63 offen nt
    ds_read_b128 v[196:199], v16 offset:0
    ds_read_b128 v[200:203], v16 offset:128
    ds_read_b128 v[204:207], v16 offset:256
    ds_read_b128 v[208:211], v16 offset:384
    ds_read_b128 v[212:215], v16 offset:512
    ds_read_b128 v[216:219], v16 offset:640
    ds_read_b128 v[220:223], v16 offset:768
    ds_read_b128 v[224:227], v16 offset:896
    ds_read_b128 v[228:231], v16 offset:1024
    s_waitcnt lgkmcnt(8)
    v_mfma_f32_16x16x32_bf16 v[232:235], v[160:163], v[196:199], 0
    s_waitcnt lgkmcnt(7)
    v_mfma_f32_16x16x32_bf16 v[232:235], v[164:167], v[200:203], v[232:235]
    s_waitcnt lgkmcnt(6)
    v_mfma_f32_16x16x32_bf16 v[232:235], v[168:171], v[204:207], v[232:235]
    s_waitcnt lgkmcnt(5)
    v_mfma_f32_16x16x32_bf16 v[232:235], v[172:175], v[208:211], v[232:235]
    s_waitcnt lgkmcnt(4)
    v_mfma_f32_16x16x32_bf16 v[232:235], v[176:179], v[212:215], v[232:235]
    s_waitcnt lgkmcnt(3)
    v_mfma_f32_16x16x32_bf16 v[232:235], v[180:183], v[216:219], v[232:235]
    s_waitcnt lgkmcnt(2)
    v_mfma_f32_16x16x32_bf16 v[232:235], v[184:187], v[220:223], v[232:235]
    s_waitcnt lgkmcnt(1)
    v_mfma_f32_16x16x32_bf16 v[232:235], v[188:191], v[224:227], v[232:235]
    s_waitcnt lgkmcnt(0)
    v_mfma_f32_16x16x32_bf16 v[232:235], v[192:195], v[228:231], v[232:235]
    s_nop 7
    v_permlane32_swap_b32 v232, v234
    v_permlane32_swap_b32 v233, v235
    v_cndmask_b32 v233, v233, v234, s[96:97]
    v_cndmask_b32 v232, v232, v235, s[96:97]
    s_nop 1
    v_add_f32_dpp v236, v233, v232 quad_perm:[1,0,3,2] row_mask:0xf bank_mask:0xf
    v_and_b32 v12, 1, v0
    v_lshlrev_b32 v12, 8, v12
    v_bfe_u32 v13, v0, 1, 3
    v_lshl_add_u32 v12, v13, 4, v12
    v_cvt_pk_bf16_f32 v236, v236, v236
    ds_write_b16 v23, v236
    v_mov_b32 v243, s34
    s_waitcnt lgkmcnt(0)
    s_barrier
    ds_read2_b32 v[244:245], v24 offset1:1
    v_mov_b32 v241, s34
    s_waitcnt lgkmcnt(0)
    v_mov_b32 v240, v244
    v_mov_b32 v242, v245
    s_mov_b64 exec, 0xffff
    buffer_store_dwordx4 v[240:243], v12, s[36:39], s101 offen sc1
    s_mov_b64 exec, -1
    s_waitcnt vmcnt(3)
    s_bitcmp1_b64 s[14:15], 25
    s_cbranch_scc0 1
    s_waitcnt vmcnt(2)
    s_add_u32 s63, s69, 401408
    buffer_load_dwordx4 v[60:63], v1, s[40:43], s63 offen nt
    s_branch .Ln_att
.La_early:
    s_branch .Lsk_a0_0
.Lst_a0_0:
    s_branch .Lrt_a0_0
.Lsk_a0_0:
    s_mov_b32 s14, 0x6ddb76dd
    s_mov_b32 s15, 0xdb76ddb7
    s_add_u32 s30, s70, -60
    s_mov_b32 s31, s70
    s_cmp_ge_u32 s65, 11
    s_cselect_b32 s99, 1, 0
    s_mul_i32 s57, s99, 3
    s_sub_u32 s100, s65, s57
    s_sub_u32 s100, s100, 8
    s_lshl1_add_u32 s99, s64, s99
    s_mov_b32 s48, s12
    s_and_b32 s49, s13, 0xffff
    s_mov_b32 s50, 0x480000
    s_mov_b32 s51, 0x00020000
    v_bfe_u32 v12, v0, 4, 1
    s_and_b32 s56, s3, 1
    s_lshl_b32 s56, s56, 2
    v_lshl_or_b32 v12, v12, 1, s56
    v_and_b32 v13, 7, v0
    v_xor_b32 v12, v12, v13
    v_lshrrev_b32 v13, 3, v0
    v_mul_u32_u24 v13, 1152, v13
    v_lshl_add_u32 v6, v12, 4, v13
    s_mul_i32 s101, s99, 294912
    s_mul_i32 s56, s100, 384
    s_add_u32 s101, s101, s56
    s_mul_i32 s56, s3, 9216
    s_add_u32 s101, s101, s56
    s_lshl_b32 s57, s3, 10
    s_waitcnt vmcnt(4)
    s_add_u32 m0, s57, 0
    s_add_u32 s56, s101, 0
    buffer_load_dwordx4 v6, s[48:51], s56 offen nt lds
    s_waitcnt vmcnt(4)
    s_add_u32 m0, s57, 32768
    s_add_u32 s56, s101, 128
    buffer_load_dwordx4 v6, s[48:51], s56 offen nt lds
    s_waitcnt vmcnt(4)
    s_bitcmp1_b64 s[14:15], 4
    s_cbranch_scc0 1
    s_waitcnt vmcnt(3)
    s_add_u32 s63, s69, 32768
    buffer_load_dwordx4 v[96:99], v1, s[40:43], s63 offen nt
    s_waitcnt vmcnt(4)
    s_bitcmp1_b64 s[14:15], 5
    s_cbranch_scc0 1
    s_waitcnt vmcnt(2)
    s_add_u32 s63, s69, 40960
    buffer_load_dwordx4 v[100:103], v1, s[40:43], s63 offen nt
    s_waitcnt vmcnt(3)
    s_add_u32 m0, s57, 65536
    s_add_u32 s56, s101, 256
    buffer_load_dwordx4 v6, s[48:51], s56 offen nt lds
    s_waitcnt vmcnt(3)
    s_bitcmp1_b64 s[14:15], 6
    s_cbranch_scc0 1
    s_waitcnt vmcnt(2)
    s_add_u32 s63, s69, 49152
    buffer_load_dwordx4 v[128:131], v1, s[40:43], s63 offen nt
    s_waitcnt vmcnt(3)
    s_bitcmp1_b64 s[14:15], 7
    s_cbranch_scc0 1
    s_waitcnt vmcnt(2)
    s_add_u32 s63, s69, 57344
    buffer_load_dwordx4 v[132:135], v1, s[40:43], s63 offen nt
    s_waitcnt vmcnt(3)
    s_add_u32 m0, s57, 8192
    s_add_u32 s56, s101, 73728
    buffer_load_dwordx4 v6, s[48:51], s56 offen nt lds
    s_waitcnt vmcnt(3)
    s_bitcmp1_b64 s[14:15], 8
    s_cbranch_scc0 1
    s_waitcnt vmcnt(2)
    s_add_u32 s63, s69, 131072
    buffer_load_dwordx4 v[40:43], v1, s[40:43], s63 offen nt
    s_waitcnt vmcnt(3)
    s_bitcmp1_b64 s[14:15], 9
    s_cbranch_scc0 1
    s_waitcnt vmcnt(2)
    s_add_u32 s63, s69, 139264
    buffer_load_dwordx4 v[44:47], v1, s[40:43], s63 offen nt
    s_waitcnt vmcnt(3)
    s_add_u32 m0, s57, 40960
    s_add_u32 s56, s101, 73856
    buffer_load_dwordx4 v6, s[48:51], s56 offen nt lds
    s_waitcnt vmcnt(3)
    s_bitcmp1_b64 s[14:15], 10
    s_cbranch_scc0 1
    s_waitcnt vmcnt(2)
    s_add_u32 s63, s69, 147456
    buffer_load_dwordx4 v[72:75], v1, s[40:43], s63 offen nt
    s_waitcnt vmcnt(3)
    s_bitcmp1_b64 s[14:15], 11
    s_cbranch_scc0 1
    s_waitcnt vmcnt(2)
    s_add_u32 s63, s69, 155648
    buffer_load_dwordx4 v[76:79], v1, s[40:43], s63 offen nt
    s_waitcnt vmcnt(3)
    s_add_u32 m0, s57, 73728
    s_add_u32 s56, s101, 73984
    buffer_load_dwordx4 v6, s[48:51], s56 offen nt lds
    s_waitcnt vmcnt(3)
    s_waitcnt lgkmcnt(0)
    s_add_u32 s34, s34, 1
    s_getreg_b32 s1, hwreg(HW_REG_XCC_ID)
    s_lshl_b32 s1, s1, 24
    s_add_u32 s1, s1, s34
    s_lshr_b32 s0, s2, 3
    s_lshl_b32 s63, s64, 8
    s_add_u32 s0, s0, s63
    s_lshl2_add_u32 s0, s0, 0x480000
    v_mov_b32 v30, s1
    s_cmp_eq_u32 s3, 0
    s_cselect_b64 exec, 1, 0
    buffer_store_dword v30, v2, s[36:39], s0 offen sc1
    s_mov_b64 exec, -1
    s_bitcmp1_b64 s[14:15], 12
    s_cbranch_scc0 1
    s_waitcnt vmcnt(3)
    s_add_u32 s63, s69, 163840
    buffer_load_dwordx4 v[104:107], v1, s[40:43], s63 offen nt
    s_waitcnt vmcnt(4)
    s_bitcmp1_b64 s[14:15], 13
    s_cbranch_scc0 1
    s_waitcnt vmcnt(3)
    s_add_u32 s63, s69, 172032
    buffer_load_dwordx4 v[108:111], v1, s[40:43], s63 offen nt
    s_waitcnt vmcnt(4)
    s_add_u32 m0, s57, 16384
    s_add_u32 s56, s101, 147456
    buffer_load_dwordx4 v6, s[48:51], s56 offen nt lds
    s_waitcnt vmcnt(4)
    s_bitcmp1_b64 s[14:15], 14
    s_cbranch_scc0 1
    s_waitcnt vmcnt(2)
    s_add_u32 s63, s69, 180224
    buffer_load_dwordx4 v[136:139], v1, s[40:43], s63 offen nt
    s_waitcnt vmcnt(3)
    s_bitcmp1_b64 s[14:15], 15
    s_cbranch_scc0 1
    s_waitcnt vmcnt(2)
    s_add_u32 s63, s69, 188416
    buffer_load_dwordx4 v[140:143], v1, s[40:43], s63 offen nt
    s_waitcnt vmcnt(3)
    s_add_u32 m0, s57, 49152
    s_add_u32 s56, s101, 147584
    buffer_load_dwordx4 v6, s[48:51], s56 offen nt lds
    s_waitcnt vmcnt(3)
    s_bitcmp1_b64 s[14:15], 16
    s_cbranch_scc0 1
    s_waitcnt vmcnt(2)
    s_add_u32 s63, s69, 262144
    buffer_load_dwordx4 v[48:51], v1, s[40:43], s63 offen nt
    s_waitcnt vmcnt(3)
    s_bitcmp1_b64 s[14:15], 17
    s_cbranch_scc0 1
    s_waitcnt vmcnt(2)
    s_add_u32 s63, s69, 270336
    buffer_load_dwordx4 v[52:55], v1, s[40:43], s63 offen nt
    s_waitcnt vmcnt(3)
    s_add_u32 m0, s57, 81920
    s_add_u32 s56, s101, 147712
    buffer_load_dwordx4 v6, s[48:51], s56 offen nt lds
    s_waitcnt vmcnt(3)
    s_bitcmp1_b64 s[14:15], 18
    s_cbranch_scc0 1
    s_waitcnt vmcnt(2)
    s_add_u32 s63, s69, 278528
    buffer_load_dwordx4 v[80:83], v1, s[40:43], s63 offen nt
    s_waitcnt vmcnt(3)
    s_bitcmp1_b64 s[14:15], 19
    s_cbranch_scc0 1
    s_waitcnt vmcnt(2)
    s_add_u32 s63, s69, 286720
    buffer_load_dwordx4 v[84:87], v1, s[40:43], s63 offen nt
    s_waitcnt vmcnt(3)
    s_add_u32 m0, s57, 24576
    s_add_u32 s56, s101, 221184
    buffer_load_dwordx4 v6, s[48:51], s56 offen nt lds
    s_waitcnt vmcnt(3)
    s_bitcmp1_b64 s[14:15], 20
    s_cbranch_scc0 1
    s_waitcnt vmcnt(2)
    s_add_u32 s63, s69, 294912
    buffer_load_dwordx4 v[112:115], v1, s[40:43], s63 offen nt
    s_waitcnt vmcnt(3)
    s_bitcmp1_b64 s[14:15], 21
    s_cbranch_scc0 1
    s_waitcnt vmcnt(2)
    s_add_u32 s63, s69, 303104
    buffer_load_dwordx4 v[116:119], v1, s[40:43], s63 offen nt
    s_branch .Lsk_a0_1
.Lst_a0_1:
    s_branch .Lrt_a0_1
.Lsk_a0_1:
    s_waitcnt vmcnt(3)
    s_add_u32 m0, s57, 57344
    s_add_u32 s56, s101, 221312
    buffer_load_dwordx4 v6, s[48:51], s56 offen nt lds
    s_waitcnt vmcnt(3)
    s_bitcmp1_b64 s[14:15], 22
    s_cbranch_scc0 1
    s_waitcnt vmcnt(2)
    s_add_u32 s63, s69, 311296
    buffer_load_dwordx4 v[144:147], v1, s[40:43], s63 offen nt
    s_waitcnt vmcnt(3)
    s_bitcmp1_b64 s[14:15], 23
    s_cbranch_scc0 1
    s_waitcnt vmcnt(2)
    s_add_u32 s63, s69, 319488
    buffer_load_dwordx4 v[148:151], v1, s[40:43], s63 offen nt
    s_waitcnt vmcnt(3)
    s_add_u32 m0, s57, 90112
    s_add_u32 s56, s101, 221440
    buffer_load_dwordx4 v6, s[48:51], s56 offen nt lds
    s_waitcnt vmcnt(3)
    s_bitcmp1_b64 s[14:15], 24
    s_cbranch_scc0 1
    s_waitcnt vmcnt(2)
    s_add_u32 s63, s69, 393216
    buffer_load_dwordx4 v[56:59], v1, s[40:43], s63 offen nt
    s_waitcnt vmcnt(3)
    s_bitcmp1_b64 s[14:15], 25
    s_cbranch_scc0 1
    s_waitcnt vmcnt(2)
    s_add_u32 s63, s69, 401408
    buffer_load_dwordx4 v[60:63], v1, s[40:43], s63 offen nt
.Ln_att:
    v_and_b32 v8, 1, v0
    v_lshlrev_b32 v8, 8, v8
    v_and_b32 v9, 0x3c, v0
    v_lshl_add_u32 v9, v9, 2, v8
    v_add_u32 v7, v9, v8
    v_and_b32 v9, 0x3c, v0
    v_lshrrev_b32 v8, 4, v8
    v_and_b32 v9, 4, v0
    v_lshl_add_u32 v9, v9, 3, v8
    s_lshl_b32 s58, s66, 14
    s_lshl_b32 s59, s67, 10
    s_add_u32 s58, s58, s59
    s_add_u32 s58, s58, 0x70000
    s_lshl4_add_u32 s59, s66, s67
    s_lshl_b32 s59, s59, 7
    s_add_u32 s59, s59, 0x430000
    s_memrealtime s[8:9]
    s_waitcnt vmcnt(8)
    s_waitcnt lgkmcnt(0)
    s_sub_u32 s8, s8, s30
    s_cmpk_ge_u32 s8, 1211
    s_cbranch_scc1 .ap_4
    s_waitcnt vmcnt(5)
    s_cmpk_ge_u32 s8, 1111
    s_cbranch_scc1 .ap_4
    s_waitcnt vmcnt(3)
    s_bitcmp1_b64 s[14:15], 26
    s_cbranch_scc0 1
    s_waitcnt vmcnt(2)
    s_cmpk_ge_u32 s8, 991
    s_cbranch_scc1 .ap_4
    s_waitcnt vmcnt(1)
.ap_4:
    s_add_u32 s63, s69, 409600
    buffer_load_dwordx4 v[88:91], v1, s[40:43], s63 offen nt
    v_and_b32 v157, 7, v0
    v_lshlrev_b32 v157, 2, v157
    s_mov_b32 s63, 0x4a1000
    buffer_load_dword v156, v157, s[36:39], s63 offen
    s_cmp_eq_u32 s3, 0
    s_cbranch_scc1 .Lst_n1_0
.Lrt_n1_0:
    s_cmp_eq_u32 s3, 1
    s_cbranch_scc1 .Lst_n1_1
    s_cmp_eq_u32 s3, 2
    s_cbranch_scc1 .Lst_n1_2
    s_cmp_eq_u32 s3, 3
    s_cbranch_scc1 .Lst_n1_3
    s_cmp_eq_u32 s3, 4
    s_cbranch_scc1 .Lst_n1_4
    s_cmp_eq_u32 s3, 5
    s_cbranch_scc1 .Lst_n1_5
    s_cmp_eq_u32 s3, 6
    s_cbranch_scc1 .Lst_n1_6
    s_cmp_eq_u32 s3, 7
    s_cbranch_scc1 .Lst_n1_7
    s_cmp_eq_u32 s3, 0
    s_cbranch_scc1 .Lrt_n1_8
.Lrt_n1_1:
.Lrt_n1_2:
.Lrt_n1_3:
.Lrt_n1_4:
.Lrt_n1_5:
.Lrt_n1_6:
.Lrt_n1_7:
.Lrt_n1_8:
    s_memrealtime s[8:9]
    s_waitcnt vmcnt(9)
    s_waitcnt lgkmcnt(0)
    s_sub_u32 s8, s8, s30
    s_cmpk_ge_u32 s8, 1238
    s_cbranch_scc1 .ap_5
    s_waitcnt vmcnt(6)
    s_cmpk_ge_u32 s8, 1138
    s_cbranch_scc1 .ap_5
    s_waitcnt vmcnt(4)
    s_bitcmp1_b64 s[14:15], 27
    s_cbranch_scc0 1
    s_waitcnt vmcnt(3)
    s_cmpk_ge_u32 s8, 1018
    s_cbranch_scc1 .ap_5
    s_waitcnt vmcnt(2)
.ap_5:
    s_add_u32 s63, s69, 417792
    buffer_load_dwordx4 v[92:95], v1, s[40:43], s63 offen nt
    s_memrealtime s[8:9]
    s_waitcnt vmcnt(9)
    s_waitcnt lgkmcnt(0)
    s_sub_u32 s8, s8, s30
    s_cmpk_ge_u32 s8, 1265
    s_cbranch_scc1 .ap_6
    s_waitcnt vmcnt(6)
    s_cmpk_ge_u32 s8, 1165
    s_cbranch_scc1 .ap_6
    s_waitcnt vmcnt(4)
    s_bitcmp1_b64 s[14:15], 28
    s_cbranch_scc0 1
    s_waitcnt vmcnt(3)
    s_cmpk_ge_u32 s8, 1045
    s_cbranch_scc1 .ap_6
    s_waitcnt vmcnt(2)
.ap_6:
    s_add_u32 s63, s69, 425984
    buffer_load_dwordx4 v[120:123], v1, s[40:43], s63 offen nt
    s_memrealtime s[8:9]
    s_waitcnt vmcnt(9)
    s_waitcnt lgkmcnt(0)
    s_sub_u32 s8, s8, s30
    s_cmpk_ge_u32 s8, 1292
    s_cbranch_scc1 .ap_7
    s_waitcnt vmcnt(6)
    s_cmpk_ge_u32 s8, 1192
    s_cbranch_scc1 .ap_7
    s_waitcnt vmcnt(4)
    s_bitcmp1_b64 s[14:15], 29
    s_cbranch_scc0 1
    s_waitcnt vmcnt(3)
    s_cmpk_ge_u32 s8, 1072
    s_cbranch_scc1 .ap_7
    s_waitcnt vmcnt(1)
.ap_7:
    s_add_u32 s63, s69, 434176
    buffer_load_dwordx4 v[124:127], v1, s[40:43], s63 offen nt
    s_memrealtime s[8:9]
    s_waitcnt vmcnt(9)
    s_waitcnt lgkmcnt(0)
    s_sub_u32 s8, s8, s30
    s_cmpk_ge_u32 s8, 1320
    s_cbranch_scc1 .ap_8
    s_waitcnt vmcnt(6)
    s_cmpk_ge_u32 s8, 1220
    s_cbranch_scc1 .ap_8
    s_waitcnt vmcnt(4)
    s_bitcmp1_b64 s[14:15], 30
    s_cbranch_scc0 1
    s_waitcnt vmcnt(2)
    s_cmpk_ge_u32 s8, 1100
    s_cbranch_scc1 .ap_8
    s_waitcnt vmcnt(1)
.ap_8:
    s_add_u32 s63, s69, 442368
    buffer_load_dwordx4 v[152:155], v1, s[40:43], s63 offen nt
    s_waitcnt vmcnt(4)
    s_sub_u32 s63, s70, 300
    v_subrev_u32 v156, s63, v156
    v_mov_b32 v157, 600
    v_cmp_lt_u32 s[8:9], v156, v157
    v_add_u32_dpp v156, v156, v156 quad_perm:[1,0,3,2] row_mask:0xf bank_mask:0xf
    s_nop 1
    v_add_u32_dpp v156, v156, v156 quad_perm:[2,3,0,1] row_mask:0xf bank_mask:0xf
    s_nop 1
    v_add_u32_dpp v156, v156, v156 row_ror:4 row_mask:0xf bank_mask:0xf
    s_nop 0
    v_readfirstlane_b32 s63, v156
    s_cmp_eq_u64 s[8:9], -1
    s_nop 3
    s_cbranch_scc0 .et_9
    s_lshr_b32 s63, s63, 3
    s_sub_u32 s63, s63, 300
    s_add_u32 s30, s30, s63
    s_add_u32 s31, s31, s63
.et_9:
    s_memrealtime s[8:9]
    s_waitcnt lgkmcnt(0)
    s_sub_u32 s8, s8, s30
    s_cmpk_ge_u32 s8, 1347
    s_cbranch_scc1 .ap_10
    s_waitcnt vmcnt(4)
    s_cmpk_ge_u32 s8, 1247
    s_cbranch_scc1 .ap_10
    s_waitcnt vmcnt(3)
    s_bitcmp1_b64 s[14:15], 31
    s_cbranch_scc0 1
    s_waitcnt vmcnt(2)
    s_cmpk_ge_u32 s8, 1127
    s_cbranch_scc1 .ap_10
    s_waitcnt vmcnt(1)
.ap_10:
    s_add_u32 s63, s69, 450560
    buffer_load_dwordx4 v[156:159], v1, s[40:43], s63 offen nt
    s_memrealtime s[8:9]
    s_waitcnt lgkmcnt(0)
    s_sub_u32 s8, s8, s30
    s_cmpk_ge_u32 s8, 1374
    s_cbranch_scc1 .ap_11
    s_waitcnt vmcnt(5)
    s_cmpk_ge_u32 s8, 1274
    s_cbranch_scc1 .ap_11
    s_waitcnt vmcnt(3)
    s_bitcmp1_b64 s[14:15], 32
    s_cbranch_scc0 1
    s_waitcnt vmcnt(2)
    s_cmpk_ge_u32 s8, 1154
    s_cbranch_scc1 .ap_11
    s_waitcnt vmcnt(1)
.ap_11:
    v_bfe_u32 v1, v0, 4, 2
    v_and_b32 v10, 0xf0, v2
    v_lshlrev_b32 v1, 2, v1
    v_bfe_u32 v1, s6, v1, 4
    v_lshl_add_u32 v1, v1, 8, v10
    s_add_u32 s63, s69, 0
    buffer_load_dwordx4 v[160:163], v1, s[44:47], s63 offen nt
    s_memrealtime s[8:9]
    s_waitcnt lgkmcnt(0)
    s_sub_u32 s8, s8, s30
    s_cmpk_ge_u32 s8, 1401
    s_cbranch_scc1 .ap_12
    s_waitcnt vmcnt(5)
    s_cmpk_ge_u32 s8, 1301
    s_cbranch_scc1 .ap_12
    s_waitcnt vmcnt(3)
    s_bitcmp1_b64 s[14:15], 33
    s_cbranch_scc0 1
    s_waitcnt vmcnt(2)
    s_cmpk_ge_u32 s8, 1181
    s_cbranch_scc1 .ap_12
    s_waitcnt vmcnt(1)
.ap_12:
    s_add_u32 s63, s69, 8192
    buffer_load_dwordx4 v[164:167], v1, s[44:47], s63 offen nt
    s_memrealtime s[8:9]
    s_waitcnt lgkmcnt(0)
    s_sub_u32 s8, s8, s30
    s_cmpk_ge_u32 s8, 1428
    s_cbranch_scc1 .ap_13
    s_waitcnt vmcnt(5)
    s_cmpk_ge_u32 s8, 1328
    s_cbranch_scc1 .ap_13
    s_waitcnt vmcnt(3)
    s_bitcmp1_b64 s[14:15], 34
    s_cbranch_scc0 1
    s_waitcnt vmcnt(2)
    s_cmpk_ge_u32 s8, 1208
    s_cbranch_scc1 .ap_13
    s_waitcnt vmcnt(1)
.ap_13:
    s_add_u32 s63, s69, 16384
    buffer_load_dwordx4 v[168:171], v1, s[44:47], s63 offen nt
    s_memrealtime s[8:9]
    s_waitcnt lgkmcnt(0)
    s_sub_u32 s8, s8, s30
    s_cmpk_ge_u32 s8, 1456
    s_cbranch_scc1 .ap_14
    s_waitcnt vmcnt(5)
    s_cmpk_ge_u32 s8, 1356
    s_branch .Lsk_n1_0
.Lst_n1_0:
    s_branch .Lrt_n1_0
.Lsk_n1_0:
    s_cbranch_scc1 .ap_14
    s_waitcnt vmcnt(3)
    s_bitcmp1_b64 s[14:15], 35
    s_cbranch_scc0 1
    s_waitcnt vmcnt(2)
    s_cmpk_ge_u32 s8, 1236
    s_cbranch_scc1 .ap_14
    s_waitcnt vmcnt(1)
.ap_14:
    s_add_u32 s63, s69, 24576
    buffer_load_dwordx4 v[172:175], v1, s[44:47], s63 offen nt
    buffer_load_dwordx4 v[16:19], v7, s[36:39], s58 offen offset:0 sc1
    buffer_load_dwordx4 v[20:23], v7, s[36:39], s58 offen offset:256 sc1
    s_memrealtime s[8:9]
    s_waitcnt vmcnt(8)
    s_waitcnt lgkmcnt(0)
    s_sub_u32 s8, s8, s30
    s_cmpk_ge_u32 s8, 1486
    s_cbranch_scc1 .ap_15
    s_waitcnt vmcnt(5)
    s_cmpk_ge_u32 s8, 1386
    s_cbranch_scc1 .ap_15
    s_waitcnt vmcnt(3)
    s_bitcmp1_b64 s[14:15], 36
    s_cbranch_scc0 1
    s_waitcnt vmcnt(2)
    s_cmpk_ge_u32 s8, 1266
    s_cbranch_scc1 .ap_15
    s_waitcnt vmcnt(1)
.ap_15:
    s_add_u32 s63, s69, 32768
    buffer_load_dwordx4 v[176:179], v1, s[44:47], s63 offen nt
    s_memrealtime s[8:9]
    s_waitcnt vmcnt(8)
    s_waitcnt lgkmcnt(0)
    s_sub_u32 s8, s8, s30
    s_cmpk_ge_u32 s8, 1516
    s_cbranch_scc1 .ap_16
    s_waitcnt vmcnt(5)
    s_cmpk_ge_u32 s8, 1416
    s_cbranch_scc1 .ap_16
    s_waitcnt vmcnt(3)
    s_bitcmp1_b64 s[14:15], 37
    s_cbranch_scc0 1
    s_waitcnt vmcnt(2)
    s_cmpk_ge_u32 s8, 1296
    s_cbranch_scc1 .ap_16
    s_waitcnt vmcnt(1)
.ap_16:
    s_add_u32 s63, s69, 40960
    buffer_load_dwordx4 v[180:183], v1, s[44:47], s63 offen nt
    s_memrealtime s[8:9]
    s_waitcnt vmcnt(8)
    s_waitcnt lgkmcnt(0)
    s_sub_u32 s8, s8, s30
    s_cmpk_ge_u32 s8, 1546
    s_cbranch_scc1 .ap_17
    s_waitcnt vmcnt(5)
    s_cmpk_ge_u32 s8, 1446
    s_cbranch_scc1 .ap_17
    s_waitcnt vmcnt(3)
    s_bitcmp1_b64 s[14:15], 38
    s_cbranch_scc0 1
    s_waitcnt vmcnt(2)
    s_cmpk_ge_u32 s8, 1326
    s_cbranch_scc1 .ap_17
    s_waitcnt vmcnt(1)
.ap_17:
    s_add_u32 s63, s69, 49152
    buffer_load_dwordx4 v[184:187], v1, s[44:47], s63 offen nt
    s_waitcnt vmcnt(3)
    s_branch .gpc_19
.gp_18:
    buffer_load_dwordx4 v[16:19], v7, s[36:39], s58 offen offset:0 sc1
    buffer_load_dwordx4 v[20:23], v7, s[36:39], s58 offen offset:256 sc1
    s_waitcnt vmcnt(0)
.gpc_19:
    v_min_u32 v10, v17, v19
    v_max_u32 v11, v17, v19
    v_min3_u32 v10, v10, v21, v23
    v_max3_u32 v11, v11, v21, v23
    v_cmp_eq_u32 vcc, s34, v10
    v_cmp_eq_u32 s[56:57], s34, v11
    s_and_b64 vcc, vcc, s[56:57]
    s_cmp_eq_u64 vcc, -1
    s_nop 2
    s_cbranch_scc1 .gpd_20
    s_sub_u32 s35, s35, 1
    s_cbranch_scc1 .Lexit
    s_sleep 1
    s_branch .gp_18
.gpd_20:
    s_mov_b32 vcc_lo, 0xcccccccc
    s_mov_b32 vcc_hi, 0xcccccccc
    v_cndmask_b32_e64 v24, v16, 0, vcc
    v_cndmask_b32_e64 v25, v18, 0, vcc
    v_cndmask_b32_e64 v26, v20, 0, vcc
    v_cndmask_b32_e64 v27, v22, 0, vcc
    v_cndmask_b32_e32 v28, 0, v16, vcc
    v_cndmask_b32_e32 v29, 0, v18, vcc
    v_cndmask_b32_e32 v30, 0, v20, vcc
    v_cndmask_b32_e32 v31, 0, v22, vcc
    v_mfma_f32_16x16x32_bf16 v[16:19], v[32:35], v[24:27], 0
    v_mfma_f32_16x16x32_bf16 v[32:35], v[40:43], v[24:27], 0
    v_mfma_f32_16x16x32_bf16 v[16:19], v[36:39], v[28:31], v[16:19]
    v_mfma_f32_16x16x32_bf16 v[40:43], v[48:51], v[24:27], 0
    v_mfma_f32_16x16x32_bf16 v[32:35], v[44:47], v[28:31], v[32:35]
    v_mfma_f32_16x16x32_bf16 v[48:51], v[56:59], v[24:27], 0
    v_mfma_f32_16x16x32_bf16 v[40:43], v[52:55], v[28:31], v[40:43]
    v_mfma_f32_16x16x32_bf16 v[56:59], v[64:67], v[24:27], 0
    v_mfma_f32_16x16x32_bf16 v[48:51], v[60:63], v[28:31], v[48:51]
    s_nop 1
    v_add_f32_dpp v10, v17, v16 row_ror:12 row_mask:0xf bank_mask:0x1
    s_memrealtime s[8:9]
    s_waitcnt lgkmcnt(0)
    s_sub_u32 s8, s8, s30
    s_cmpk_ge_u32 s8, 1576
    s_nop 0
    s_cbranch_scc1 .ap_21
    s_waitcnt vmcnt(3)
    s_cmpk_ge_u32 s8, 1476
    s_cbranch_scc1 .ap_21
    s_waitcnt vmcnt(3)
    s_bitcmp1_b64 s[14:15], 39
    s_cbranch_scc0 1
    s_waitcnt vmcnt(2)
    s_cmpk_ge_u32 s8, 1356
    s_cbranch_scc1 .ap_21
    s_waitcnt vmcnt(1)
.ap_21:
    s_add_u32 s63, s69, 57344
    buffer_load_dwordx4 v[188:191], v1, s[44:47], s63 offen nt
    v_mfma_f32_16x16x32_bf16 v[64:67], v[72:75], v[24:27], 0
    v_mfma_f32_16x16x32_bf16 v[56:59], v[68:71], v[28:31], v[56:59]
    v_add_f32_dpp v11, v33, v32 row_ror:12 row_mask:0xf bank_mask:0x1
    v_add_f32_dpp v10, v18, v10 row_ror:8 row_mask:0xf bank_mask:0x1
    v_mfma_f32_16x16x32_bf16 v[72:75], v[80:83], v[24:27], 0
    v_mfma_f32_16x16x32_bf16 v[64:67], v[76:79], v[28:31], v[64:67]
    v_add_f32_dpp v12, v41, v40 row_ror:12 row_mask:0xf bank_mask:0x1
    v_add_f32_dpp v11, v34, v11 row_ror:8 row_mask:0xf bank_mask:0x1
    v_add_f32_dpp v10, v19, v10 row_ror:4 row_mask:0xf bank_mask:0x1
    v_mfma_f32_16x16x32_bf16 v[80:83], v[88:91], v[24:27], 0
    v_mfma_f32_16x16x32_bf16 v[72:75], v[84:87], v[28:31], v[72:75]
    v_add_f32_dpp v13, v49, v48 row_ror:12 row_mask:0xf bank_mask:0x1
    v_add_f32_dpp v12, v42, v12 row_ror:8 row_mask:0xf bank_mask:0x1
    v_add_f32_dpp v11, v35, v11 row_ror:4 row_mask:0xf bank_mask:0x1
    v_mfma_f32_16x16x32_bf16 v[88:91], v[96:99], v[24:27], 0
    v_mfma_f32_16x16x32_bf16 v[80:83], v[92:95], v[28:31], v[80:83]
    v_add_f32_dpp v10, v58, v57 row_ror:12 row_mask:0xf bank_mask:0x2
    v_add_f32_dpp v13, v50, v13 row_ror:8 row_mask:0xf bank_mask:0x1
    v_add_f32_dpp v12, v43, v12 row_ror:4 row_mask:0xf bank_mask:0x1
    s_memrealtime s[8:9]
    s_waitcnt lgkmcnt(0)
    s_sub_u32 s8, s8, s30
    s_cmpk_ge_u32 s8, 1606
    s_nop 0
    s_cbranch_scc1 .ap_22
    s_waitcnt vmcnt(4)
    s_cmpk_ge_u32 s8, 1506
    s_cbranch_scc1 .ap_22
    s_waitcnt vmcnt(3)
    s_bitcmp1_b64 s[14:15], 40
    s_cbranch_scc0 1
    s_waitcnt vmcnt(2)
    s_cmpk_ge_u32 s8, 1386
    s_cbranch_scc1 .ap_22
    s_waitcnt vmcnt(1)
.ap_22:
    s_add_u32 s63, s69, 131072
    buffer_load_dwordx4 v[192:195], v1, s[44:47], s63 offen nt
    v_mfma_f32_16x16x32_bf16 v[96:99], v[104:107], v[24:27], 0
    v_mfma_f32_16x16x32_bf16 v[88:91], v[100:103], v[28:31], v[88:91]
    v_add_f32_dpp v11, v66, v65 row_ror:12 row_mask:0xf bank_mask:0x2
    v_add_f32_dpp v10, v59, v10 row_ror:8 row_mask:0xf bank_mask:0x2
    v_add_f32_dpp v13, v51, v13 row_ror:4 row_mask:0xf bank_mask:0x1
    v_mfma_f32_16x16x32_bf16 v[104:107], v[112:115], v[24:27], 0
    v_mfma_f32_16x16x32_bf16 v[96:99], v[108:111], v[28:31], v[96:99]
    v_add_f32_dpp v12, v74, v73 row_ror:12 row_mask:0xf bank_mask:0x2
    v_add_f32_dpp v11, v67, v11 row_ror:8 row_mask:0xf bank_mask:0x2
    v_add_f32_dpp v10, v56, v10 row_ror:4 row_mask:0xf bank_mask:0x2
    v_mfma_f32_16x16x32_bf16 v[112:115], v[120:123], v[24:27], 0
    v_mfma_f32_16x16x32_bf16 v[104:107], v[116:119], v[28:31], v[104:107]
    v_add_f32_dpp v13, v82, v81 row_ror:12 row_mask:0xf bank_mask:0x2
    v_add_f32_dpp v12, v75, v12 row_ror:8 row_mask:0xf bank_mask:0x2
    v_add_f32_dpp v11, v64, v11 row_ror:4 row_mask:0xf bank_mask:0x2
    v_mfma_f32_16x16x32_bf16 v[120:123], v[128:131], v[24:27], 0
    v_mfma_f32_16x16x32_bf16 v[112:115], v[124:127], v[28:31], v[112:115]
    v_add_f32_dpp v10, v91, v90 row_ror:12 row_mask:0xf bank_mask:0x4
    v_add_f32_dpp v13, v83, v13 row_ror:8 row_mask:0xf bank_mask:0x2
    v_add_f32_dpp v12, v72, v12 row_ror:4 row_mask:0xf bank_mask:0x2
    s_memrealtime s[8:9]
    s_waitcnt lgkmcnt(0)
    s_sub_u32 s8, s8, s30
    s_cmpk_ge_u32 s8, 1636
    s_nop 0
    s_cbranch_scc1 .ap_23
    s_waitcnt vmcnt(5)
    s_cmpk_ge_u32 s8, 1536
    s_cbranch_scc1 .ap_23
    s_branch .Lsk_n1_1
.Lst_n1_1:
    s_branch .Lrt_n1_1
.Lsk_n1_1:
    s_waitcnt vmcnt(3)
    s_bitcmp1_b64 s[14:15], 41
    s_cbranch_scc0 1
    s_waitcnt vmcnt(2)
    s_cmpk_ge_u32 s8, 1416
    s_cbranch_scc1 .ap_23
    s_waitcnt vmcnt(1)
.ap_23:
    s_add_u32 s63, s69, 139264
    buffer_load_dwordx4 v[196:199], v1, s[44:47], s63 offen nt
    v_mfma_f32_16x16x32_bf16 v[128:131], v[136:139], v[24:27], 0
    v_mfma_f32_16x16x32_bf16 v[120:123], v[132:135], v[28:31], v[120:123]
    v_add_f32_dpp v11, v99, v98 row_ror:12 row_mask:0xf bank_mask:0x4
    v_add_f32_dpp v10, v88, v10 row_ror:8 row_mask:0xf bank_mask:0x4
    v_add_f32_dpp v13, v80, v13 row_ror:4 row_mask:0xf bank_mask:0x2
    v_mfma_f32_16x16x32_bf16 v[136:139], v[144:147], v[24:27], 0
    v_mfma_f32_16x16x32_bf16 v[128:131], v[140:143], v[28:31], v[128:131]
    v_add_f32_dpp v12, v107, v106 row_ror:12 row_mask:0xf bank_mask:0x4
    v_add_f32_dpp v11, v96, v11 row_ror:8 row_mask:0xf bank_mask:0x4
    v_add_f32_dpp v10, v89, v10 row_ror:4 row_mask:0xf bank_mask:0x4
    s_branch .Lsk_n1_2
.Lst_n1_2:
    s_branch .Lrt_n1_2
.Lsk_n1_2:
    v_mfma_f32_16x16x32_bf16 v[144:147], v[152:155], v[24:27], 0
    v_mfma_f32_16x16x32_bf16 v[136:139], v[148:151], v[28:31], v[136:139]
    v_add_f32_dpp v13, v115, v114 row_ror:12 row_mask:0xf bank_mask:0x4
    v_add_f32_dpp v12, v104, v12 row_ror:8 row_mask:0xf bank_mask:0x4
    v_add_f32_dpp v11, v97, v11 row_ror:4 row_mask:0xf bank_mask:0x4
    v_mfma_f32_16x16x32_bf16 v[144:147], v[156:159], v[28:31], v[144:147]
    v_add_f32_dpp v10, v120, v123 row_ror:12 row_mask:0xf bank_mask:0x8
    v_add_f32_dpp v13, v112, v13 row_ror:8 row_mask:0xf bank_mask:0x4
    v_add_f32_dpp v12, v105, v12 row_ror:4 row_mask:0xf bank_mask:0x4
    s_memrealtime s[8:9]
    s_waitcnt lgkmcnt(0)
    s_sub_u32 s8, s8, s30
    s_cmpk_ge_u32 s8, 1666
    s_nop 0
    s_cbranch_scc1 .ap_24
    s_waitcnt vmcnt(5)
    s_cmpk_ge_u32 s8, 1566
    s_cbranch_scc1 .ap_24
    s_waitcnt vmcnt(3)
    s_bitcmp1_b64 s[14:15], 42
    s_cbranch_scc0 1
    s_waitcnt vmcnt(2)
    s_cmpk_ge_u32 s8, 1446
    s_cbranch_scc1 .ap_24
    s_waitcnt vmcnt(1)
.ap_24:
    s_add_u32 s63, s69, 147456
    buffer_load_dwordx4 v[200:203], v1, s[44:47], s63 offen nt
    v_add_f32_dpp v11, v128, v131 row_ror:12 row_mask:0xf bank_mask:0x8
    v_add_f32_dpp v10, v121, v10 row_ror:8 row_mask:0xf bank_mask:0x8
    v_add_f32_dpp v13, v113, v13 row_ror:4 row_mask:0xf bank_mask:0x4
    v_add_f32_dpp v12, v136, v139 row_ror:12 row_mask:0xf bank_mask:0x8
    v_add_f32_dpp v11, v129, v11 row_ror:8 row_mask:0xf bank_mask:0x8
    v_add_f32_dpp v10, v122, v10 row_ror:4 row_mask:0xf bank_mask:0x8
    v_add_f32_dpp v13, v144, v147 row_ror:12 row_mask:0xf bank_mask:0x8
    v_add_f32_dpp v12, v137, v12 row_ror:8 row_mask:0xf bank_mask:0x8
    v_add_f32_dpp v11, v130, v11 row_ror:4 row_mask:0xf bank_mask:0x8
    v_add_f32_dpp v13, v145, v13 row_ror:8 row_mask:0xf bank_mask:0x8
    v_add_f32_dpp v12, v138, v12 row_ror:4 row_mask:0xf bank_mask:0x8
    s_memrealtime s[8:9]
    s_waitcnt lgkmcnt(0)
    s_sub_u32 s8, s8, s30
    s_cmpk_ge_u32 s8, 1696
    s_cbranch_scc1 .ap_25
    s_waitcnt vmcnt(5)
    s_cmpk_ge_u32 s8, 1596
    s_cbranch_scc1 .ap_25
    s_waitcnt vmcnt(3)
    s_bitcmp1_b64 s[14:15], 43
    s_cbranch_scc0 1
    s_waitcnt vmcnt(2)
    s_cmpk_ge_u32 s8, 1476
    s_cbranch_scc1 .ap_25
    s_waitcnt vmcnt(1)
.ap_25:
    s_add_u32 s63, s69, 155648
    buffer_load_dwordx4 v[204:207], v1, s[44:47], s63 offen nt
    v_add_f32_dpp v13, v146, v13 row_ror:4 row_mask:0xf bank_mask:0x8
    s_mov_b32 s60, 0x3db504f3
    s_mov_b32 s61, 0x3db504f3
    v_cvt_pk_bf16_f32 v10, v10, v11
    v_and_b32 v11, 0xffff0000, v10
    v_lshlrev_b32 v10, 16, v10
    v_cvt_pk_bf16_f32 v12, v12, v13
    v_and_b32 v13, 0xffff0000, v12
    v_lshlrev_b32 v12, 16, v12
    v_pk_mul_f32 v[10:11], v[10:11], s[60:61]
    v_pk_mul_f32 v[12:13], v[12:13], s[60:61]
    v_cvt_pk_bf16_f32 v10, v10, v11
    v_and_b32 v11, 0xffff0000, v10
    v_lshlrev_b32 v10, 16, v10
    v_cvt_pk_bf16_f32 v12, v12, v13
    v_and_b32 v13, 0xffff0000, v12
    v_lshlrev_b32 v12, 16, v12
    v_max_f32 v14, v10, v11
    v_max3_f32 v14, v14, v12, v13
    s_mov_b32 s60, 0x3fb8aa3b
    v_mov_b32 v22, s34
    v_mov_b32 v23, s34
    v_max_f32_dpp v14, v14, v14 quad_perm:[2,3,0,1] row_mask:0xf bank_mask:0xf
    s_nop 1
    v_max_f32_dpp v14, v14, v14 row_ror:4 row_mask:0xf bank_mask:0xf
    s_nop 1
    v_max_f32_dpp v14, v14, v14 row_ror:8 row_mask:0xf bank_mask:0xf
    v_mov_b32 v15, v14
    s_nop 1
    v_permlane16_swap_b32 v15, v14
    v_max_f32 v14, v15, v14
    v_mov_b32 v15, v14
    s_nop 1
    v_permlane32_swap_b32 v15, v14
    v_max_f32 v14, v15, v14
    v_mul_f32 v15, 0xbfb8aa3b, v14
    v_fma_f32 v10, v10, s60, v15
    v_fma_f32 v11, v11, s60, v15
    v_fma_f32 v12, v12, s60, v15
    v_fma_f32 v13, v13, s60, v15
    v_exp_f32 v10, v10
    v_exp_f32 v11, v11
    v_exp_f32 v12, v12
    v_exp_f32 v13, v13
    v_mov_b32 v20, v14
    v_pk_add_f32 v[16:17], v[10:11], v[12:13]
    v_add_f32 v21, v16, v17
    s_lshl_b32 s60, s68, 5
    s_lshl_b32 s61, s3, 4
    s_add_u32 s61, s61, 159104
    v_add_u32 v16, s61, v3
    v_mov_b32 v17, 159232
    v_mov_b32 v18, 1
    s_add_u32 s60, s60, s59
    v_add_f32_dpp v21, v21, v21 quad_perm:[2,3,0,1] row_mask:0xf bank_mask:0xf
    s_nop 1
    v_add_f32_dpp v21, v21, v21 row_ror:4 row_mask:0xf bank_mask:0xf
    s_nop 1
    v_add_f32_dpp v21, v21, v21 row_ror:8 row_mask:0xf bank_mask:0xf
    v_mov_b32 v15, v21
    s_nop 1
    v_permlane16_swap_b32 v15, v21
    v_add_f32 v21, v15, v21
    v_mov_b32 v15, v21
    s_nop 1
    v_permlane32_swap_b32 v15, v21
    v_add_f32 v21, v15, v21
    s_mov_b64 exec, 3
    ds_write_b64 v16, v[20:21]
    s_mov_b64 exec, 1
    ds_add_rtn_u32 v18, v17, v18
    s_mov_b64 exec, -1
    v_and_b32 v16, 0x78, v3
    v_or_b32 v16, 159104, v16
    s_waitcnt lgkmcnt(0)
    v_readfirstlane_b32 s61, v18
    s_cmp_eq_u32 s61, 7
    s_nop 3
    s_cbranch_scc0 .mlc_26
    ds_read_b64 v[18:19], v16
    s_waitcnt lgkmcnt(0)
    v_mov_b32 v20, v18
    s_nop 1
    v_max_f32_dpp v20, v20, v20 quad_perm:[2,3,0,1] row_mask:0xf bank_mask:0xf
    s_nop 1
    v_max_f32_dpp v20, v20, v20 row_ror:4 row_mask:0xf bank_mask:0xf
    s_nop 1
    v_max_f32_dpp v20, v20, v20 row_ror:8 row_mask:0xf bank_mask:0xf
    v_sub_f32 v18, v18, v20
    v_mul_f32 v18, 0x3fb8aa3b, v18
    v_exp_f32 v18, v18
    s_nop 0
    v_mul_f32 v21, v18, v19
    s_nop 1
    v_add_f32_dpp v21, v21, v21 quad_perm:[2,3,0,1] row_mask:0xf bank_mask:0xf
    s_nop 1
    v_add_f32_dpp v21, v21, v21 row_ror:4 row_mask:0xf bank_mask:0xf
    s_nop 1
    v_add_f32_dpp v21, v21, v21 row_ror:8 row_mask:0xf bank_mask:0xf
    s_mov_b64 exec, 3
    buffer_store_dwordx4 v[20:23], v2, s[36:39], s60 offen sc1
    s_mov_b64 exec, -1
.mlc_26:
    s_memrealtime s[8:9]
    s_waitcnt lgkmcnt(0)
    s_sub_u32 s8, s8, s30
    s_cmpk_ge_u32 s8, 1726
    s_cbranch_scc1 .ap_27
    s_waitcnt vmcnt(5)
    s_cmpk_ge_u32 s8, 1626
    s_cbranch_scc1 .ap_27
    s_waitcnt vmcnt(3)
    s_bitcmp1_b64 s[14:15], 44
    s_cbranch_scc0 1
    s_waitcnt vmcnt(2)
    s_cmpk_ge_u32 s8, 1506
    s_cbranch_scc1 .ap_27
    s_waitcnt vmcnt(1)
.ap_27:
    s_add_u32 s63, s69, 163840
    buffer_load_dwordx4 v[208:211], v1, s[44:47], s63 offen nt
    s_memrealtime s[8:9]
    s_waitcnt vmcnt(8)
    s_waitcnt lgkmcnt(0)
    s_sub_u32 s8, s8, s30
    s_cmpk_ge_u32 s8, 1756
    s_cbranch_scc1 .ap_28
    s_waitcnt vmcnt(5)
    s_cmpk_ge_u32 s8, 1656
    s_cbranch_scc1 .ap_28
    s_waitcnt vmcnt(3)
    s_bitcmp1_b64 s[14:15], 45
    s_cbranch_scc0 1
    s_waitcnt vmcnt(2)
    s_cmpk_ge_u32 s8, 1536
    s_cbranch_scc1 .ap_28
    s_waitcnt vmcnt(1)
.ap_28:
    s_add_u32 s63, s69, 172032
    buffer_load_dwordx4 v[212:215], v1, s[44:47], s63 offen nt
    s_memrealtime s[8:9]
    s_waitcnt vmcnt(8)
    s_branch .Lsk_n1_3
.Lst_n1_3:
    s_branch .Lrt_n1_3
.Lsk_n1_3:
    s_waitcnt lgkmcnt(0)
    s_sub_u32 s8, s8, s30
    s_cmpk_ge_u32 s8, 1788
    s_cbranch_scc1 .ap_29
    s_waitcnt vmcnt(5)
    s_cmpk_ge_u32 s8, 1688
    s_cbranch_scc1 .ap_29
    s_waitcnt vmcnt(3)
    s_bitcmp1_b64 s[14:15], 46
    s_cbranch_scc0 1
    s_waitcnt vmcnt(2)
    s_cmpk_ge_u32 s8, 1568
    s_cbranch_scc1 .ap_29
    s_waitcnt vmcnt(1)
.ap_29:
    s_add_u32 s63, s69, 180224
    buffer_load_dwordx4 v[216:219], v1, s[44:47], s63 offen nt
    s_memrealtime s[8:9]
    s_waitcnt vmcnt(8)
    s_waitcnt lgkmcnt(0)
    s_sub_u32 s8, s8, s30
    s_cmpk_ge_u32 s8, 1820
    s_cbranch_scc1 .ap_30
    s_waitcnt vmcnt(5)
    s_cmpk_ge_u32 s8, 1720
    s_cbranch_scc1 .ap_30
    s_waitcnt vmcnt(3)
    s_bitcmp1_b64 s[14:15], 47
    s_cbranch_scc0 1
    s_waitcnt vmcnt(2)
    s_cmpk_ge_u32 s8, 1600
    s_cbranch_scc1 .ap_30
    s_waitcnt vmcnt(1)
.ap_30:
    s_add_u32 s63, s69, 188416
    buffer_load_dwordx4 v[220:223], v1, s[44:47], s63 offen nt
    s_memrealtime s[8:9]
    s_waitcnt vmcnt(8)
    s_waitcnt lgkmcnt(0)
    s_sub_u32 s8, s8, s30
    s_cmpk_ge_u32 s8, 1852
    s_cbranch_scc1 .ap_31
    s_waitcnt vmcnt(5)
    s_cmpk_ge_u32 s8, 1752
    s_cbranch_scc1 .ap_31
    s_waitcnt vmcnt(3)
    s_bitcmp1_b64 s[14:15], 48
    s_cbranch_scc0 1
    s_waitcnt vmcnt(2)
    s_cmpk_ge_u32 s8, 1632
    s_cbranch_scc1 .ap_31
    s_waitcnt vmcnt(1)
.ap_31:
    s_add_u32 s63, s69, 262144
    buffer_load_dwordx4 v[224:227], v1, s[44:47], s63 offen nt
    s_memrealtime s[8:9]
    s_waitcnt vmcnt(8)
    s_waitcnt lgkmcnt(0)
    s_sub_u32 s8, s8, s30
    s_cmpk_ge_u32 s8, 1884
    s_cbranch_scc1 .ap_32
    s_waitcnt vmcnt(5)
    s_cmpk_ge_u32 s8, 1784
    s_cbranch_scc1 .ap_32
    s_waitcnt vmcnt(3)
    s_bitcmp1_b64 s[14:15], 49
    s_cbranch_scc0 1
    s_waitcnt vmcnt(2)
    s_cmpk_ge_u32 s8, 1664
    s_cbranch_scc1 .ap_32
    s_waitcnt vmcnt(1)
.ap_32:
    s_add_u32 s63, s69, 270336
    buffer_load_dwordx4 v[228:231], v1, s[44:47], s63 offen nt
    s_memrealtime s[8:9]
    s_waitcnt vmcnt(8)
    s_waitcnt lgkmcnt(0)
    s_sub_u32 s8, s8, s30
    s_cmpk_ge_u32 s8, 1916
    s_cbranch_scc1 .ap_33
    s_waitcnt vmcnt(5)
    s_cmpk_ge_u32 s8, 1816
    s_cbranch_scc1 .ap_33
    s_waitcnt vmcnt(3)
    s_bitcmp1_b64 s[14:15], 50
    s_cbranch_scc0 1
    s_waitcnt vmcnt(2)
    s_cmpk_ge_u32 s8, 1696
    s_cbranch_scc1 .ap_33
    s_waitcnt vmcnt(1)
.ap_33:
    s_add_u32 s63, s69, 278528
    buffer_load_dwordx4 v[232:235], v1, s[44:47], s63 offen nt
    s_memrealtime s[8:9]
    s_waitcnt vmcnt(8)
    s_waitcnt lgkmcnt(0)
    s_sub_u32 s8, s8, s30
    s_cmpk_ge_u32 s8, 1948
    s_cbranch_scc1 .ap_34
    s_waitcnt vmcnt(5)
    s_cmpk_ge_u32 s8, 1848
    s_cbranch_scc1 .ap_34
    s_waitcnt vmcnt(3)
    s_bitcmp1_b64 s[14:15], 51
    s_cbranch_scc0 1
    s_waitcnt vmcnt(2)
    s_cmpk_ge_u32 s8, 1728
    s_cbranch_scc1 .ap_34
    s_waitcnt vmcnt(1)
.ap_34:
    s_add_u32 s63, s69, 286720
    buffer_load_dwordx4 v[236:239], v1, s[44:47], s63 offen nt
    s_memrealtime s[8:9]
    s_waitcnt vmcnt(8)
    s_waitcnt lgkmcnt(0)
    s_sub_u32 s8, s8, s30
    s_cmpk_ge_u32 s8, 1980
    s_cbranch_scc1 .ap_35
    s_waitcnt vmcnt(5)
    s_cmpk_ge_u32 s8, 1880
    s_cbranch_scc1 .ap_35
    s_waitcnt vmcnt(3)
    s_bitcmp1_b64 s[14:15], 52
    s_cbranch_scc0 1
    s_waitcnt vmcnt(2)
    s_cmpk_ge_u32 s8, 1760
    s_cbranch_scc1 .ap_35
    s_waitcnt vmcnt(1)
.ap_35:
    s_add_u32 s63, s69, 294912
    buffer_load_dwordx4 v[240:243], v1, s[44:47], s63 offen nt
    s_memrealtime s[8:9]
    s_waitcnt vmcnt(8)
    s_waitcnt lgkmcnt(0)
    s_sub_u32 s8, s8, s30
    s_cmpk_ge_u32 s8, 2012
    s_cbranch_scc1 .ap_36
    s_waitcnt vmcnt(5)
    s_cmpk_ge_u32 s8, 1912
    s_cbranch_scc1 .ap_36
    s_waitcnt vmcnt(3)
    s_bitcmp1_b64 s[14:15], 53
    s_cbranch_scc0 1
    s_waitcnt vmcnt(2)
    s_cmpk_ge_u32 s8, 1792
    s_cbranch_scc1 .ap_36
    s_waitcnt vmcnt(1)
.ap_36:
    s_add_u32 s63, s69, 303104
    buffer_load_dwordx4 v[244:247], v1, s[44:47], s63 offen nt
    s_memrealtime s[8:9]
    s_waitcnt vmcnt(8)
    s_waitcnt lgkmcnt(0)
    s_sub_u32 s8, s8, s30
    s_cmpk_ge_u32 s8, 2044
    s_cbranch_scc1 .ap_37
    s_waitcnt vmcnt(5)
    s_cmpk_ge_u32 s8, 1944
    s_cbranch_scc1 .ap_37
    s_waitcnt vmcnt(3)
    s_bitcmp1_b64 s[14:15], 54
    s_cbranch_scc0 1
    s_waitcnt vmcnt(2)
    s_cmpk_ge_u32 s8, 1824
    s_cbranch_scc1 .ap_37
    s_waitcnt vmcnt(1)
.ap_37:
    s_add_u32 s63, s69, 311296
    buffer_load_dwordx4 v[248:251], v1, s[44:47], s63 offen nt
    s_memrealtime s[8:9]
    s_waitcnt vmcnt(8)
    s_waitcnt lgkmcnt(0)
    s_sub_u32 s8, s8, s30
    s_cmpk_ge_u32 s8, 2076
    s_cbranch_scc1 .ap_38
    s_waitcnt vmcnt(5)
    s_cmpk_ge_u32 s8, 1976
    s_cbranch_scc1 .ap_38
    s_waitcnt vmcnt(3)
    s_bitcmp1_b64 s[14:15], 55
    s_cbranch_scc0 1
    s_waitcnt vmcnt(2)
    s_cmpk_ge_u32 s8, 1856
    s_cbranch_scc1 .ap_38
    s_waitcnt vmcnt(1)
.ap_38:
    s_add_u32 s63, s69, 319488
    buffer_load_dwordx4 v[252:255], v1, s[44:47], s63 offen nt
    s_memrealtime s[8:9]
    s_waitcnt vmcnt(8)
    s_waitcnt lgkmcnt(0)
    s_sub_u32 s8, s8, s30
    s_cmpk_ge_u32 s8, 2108
    s_cbranch_scc1 .ap_39
    s_waitcnt vmcnt(5)
    s_cmpk_ge_u32 s8, 2008
    s_cbranch_scc1 .ap_39
    s_waitcnt vmcnt(3)
    s_bitcmp1_b64 s[14:15], 56
    s_cbranch_scc0 1
    s_waitcnt vmcnt(2)
    s_cmpk_ge_u32 s8, 1888
    s_cbranch_scc1 .ap_39
    s_waitcnt vmcnt(1)
.ap_39:
    s_add_u32 s63, s69, 393216
    buffer_load_dwordx4 v[36:39], v1, s[44:47], s63 offen nt
    s_memrealtime s[8:9]
    s_waitcnt vmcnt(8)
    s_waitcnt lgkmcnt(0)
    s_sub_u32 s8, s8, s30
    s_cmpk_ge_u32 s8, 2140
    s_cbranch_scc1 .ap_40
    s_waitcnt vmcnt(5)
    s_cmpk_ge_u32 s8, 2040
    s_cbranch_scc1 .ap_40
    s_waitcnt vmcnt(3)
    s_bitcmp1_b64 s[14:15], 57
    s_cbranch_scc0 1
    s_waitcnt vmcnt(2)
    s_cmpk_ge_u32 s8, 1920
    s_cbranch_scc1 .ap_40
    s_waitcnt vmcnt(1)
.ap_40:
    s_add_u32 s63, s69, 401408
    buffer_load_dwordx4 v[44:47], v1, s[44:47], s63 offen nt
    s_and_b32 s0, s0, 0xffffff80
    s_sub_u32 s0, s0, 1024
    buffer_load_dword v28, v4, s[36:39], s0 offen sc1
    buffer_load_dwordx4 v[24:27], v9, s[36:39], s59 offen offset:0 sc1
    s_memrealtime s[8:9]
    s_waitcnt vmcnt(9)
    s_waitcnt lgkmcnt(0)
    s_sub_u32 s8, s8, s30
    s_cmpk_ge_u32 s8, 2172
    s_cbranch_scc1 .ap_41
    s_waitcnt vmcnt(6)
    s_cmpk_ge_u32 s8, 2072
    s_cbranch_scc1 .ap_41
    s_waitcnt vmcnt(4)
    s_bitcmp1_b64 s[14:15], 58
    s_cbranch_scc0 1
    s_waitcnt vmcnt(3)
    s_branch .Lsk_n1_4
.Lst_n1_4:
    s_branch .Lrt_n1_4
.Lsk_n1_4:
    s_cmpk_ge_u32 s8, 1952
    s_cbranch_scc1 .ap_41
    s_waitcnt vmcnt(2)
.ap_41:
    s_add_u32 s63, s69, 409600
    buffer_load_dwordx4 v[52:55], v1, s[44:47], s63 offen nt
    s_memrealtime s[8:9]
    s_waitcnt vmcnt(9)
    s_waitcnt lgkmcnt(0)
    s_sub_u32 s8, s8, s30
    s_cmpk_ge_u32 s8, 2204
    s_cbranch_scc1 .ap_42
    s_waitcnt vmcnt(6)
    s_cmpk_ge_u32 s8, 2104
    s_cbranch_scc1 .ap_42
    s_waitcnt vmcnt(4)
    s_bitcmp1_b64 s[14:15], 59
    s_cbranch_scc0 1
    s_waitcnt vmcnt(3)
    s_cmpk_ge_u32 s8, 1984
    s_cbranch_scc1 .ap_42
    s_waitcnt vmcnt(1)
.ap_42:
    s_add_u32 s63, s69, 417792
    buffer_load_dwordx4 v[60:63], v1, s[44:47], s63 offen nt
    s_memrealtime s[8:9]
    s_waitcnt vmcnt(9)
    s_waitcnt lgkmcnt(0)
    s_sub_u32 s8, s8, s30
    s_cmpk_ge_u32 s8, 2236
    s_cbranch_scc1 .ap_43
    s_waitcnt vmcnt(6)
    s_cmpk_ge_u32 s8, 2136
    s_cbranch_scc1 .ap_43
    s_waitcnt vmcnt(4)
    s_bitcmp1_b64 s[14:15], 60
    s_cbranch_scc0 1
    s_waitcnt vmcnt(2)
    s_cmpk_ge_u32 s8, 2016
    s_cbranch_scc1 .ap_43
    s_waitcnt vmcnt(1)
.ap_43:
    s_add_u32 s63, s69, 425984
    buffer_load_dwordx4 v[68:71], v1, s[44:47], s63 offen nt
    s_memrealtime s[8:9]
    s_waitcnt vmcnt(9)
    s_waitcnt lgkmcnt(0)
    s_sub_u32 s8, s8, s30
    s_cmpk_ge_u32 s8, 2268
    s_cbranch_scc1 .ap_44
    s_waitcnt vmcnt(6)
    s_cmpk_ge_u32 s8, 2168
    s_cbranch_scc1 .ap_44
    s_waitcnt vmcnt(3)
    s_bitcmp1_b64 s[14:15], 61
    s_cbranch_scc0 1
    s_waitcnt vmcnt(2)
    s_cmpk_ge_u32 s8, 2048
    s_cbranch_scc1 .ap_44
    s_waitcnt vmcnt(1)
.ap_44:
    s_add_u32 s63, s69, 434176
    buffer_load_dwordx4 v[76:79], v1, s[44:47], s63 offen nt
    s_memrealtime s[8:9]
    s_waitcnt vmcnt(9)
    s_waitcnt lgkmcnt(0)
    s_sub_u32 s8, s8, s30
    s_cmpk_ge_u32 s8, 2300
    s_cbranch_scc1 .ap_45
    s_waitcnt vmcnt(6)
    s_cmpk_ge_u32 s8, 2200
    s_cbranch_scc1 .ap_45
    s_waitcnt vmcnt(3)
    s_bitcmp1_b64 s[14:15], 62
    s_cbranch_scc0 1
    s_waitcnt vmcnt(2)
    s_cmpk_ge_u32 s8, 2080
    s_cbranch_scc1 .ap_45
    s_waitcnt vmcnt(1)
.ap_45:
    s_add_u32 s63, s69, 442368
    buffer_load_dwordx4 v[84:87], v1, s[44:47], s63 offen nt
    s_memrealtime s[8:9]
    s_waitcnt vmcnt(9)
    s_waitcnt lgkmcnt(0)
    s_sub_u32 s8, s8, s30
    s_cmpk_ge_u32 s8, 2332
    s_cbranch_scc1 .ap_46
    s_waitcnt vmcnt(5)
    s_cmpk_ge_u32 s8, 2232
    s_cbranch_scc1 .ap_46
    s_waitcnt vmcnt(3)
    s_bitcmp1_b64 s[14:15], 63
    s_cbranch_scc0 1
    s_waitcnt vmcnt(2)
    s_cmpk_ge_u32 s8, 2112
    s_cbranch_scc1 .ap_46
    s_waitcnt vmcnt(1)
.ap_46:
    s_add_u32 s63, s69, 450560
    buffer_load_dwordx4 v[92:95], v1, s[44:47], s63 offen nt
    s_setprio 0
    s_waitcnt vmcnt(6)
    s_branch .gpc_48
.gp_47:
    buffer_load_dwordx4 v[24:27], v9, s[36:39], s59 offen offset:0 sc1
    s_waitcnt vmcnt(0)
.gpc_48:
    v_cmp_eq_u32 vcc, s34, v26
    s_cmp_eq_u64 vcc, -1
    s_nop 3
    s_cbranch_scc1 .gpd_49
    s_sub_u32 s35, s35, 1
    s_cbranch_scc1 .Lexit
    s_sleep 1
    s_branch .gp_47
.gpd_49:
    v_cmp_eq_u32 vcc, s1, v28
    s_cmp_eq_u64 vcc, -1
    s_cselect_b32 s0, 0x800000, 0
    v_mov_b32 v16, v24
    s_nop 1
    v_max_f32_dpp v16, v16, v16 row_ror:4 row_mask:0xf bank_mask:0xf
    v_sub_f32 v17, v24, v16
    v_sub_f32 v18, v14, v16
    v_mul_f32 v17, 0x3fb8aa3b, v17
    v_mul_f32 v18, 0x3fb8aa3b, v18
    v_exp_f32 v17, v17
    v_exp_f32 v18, v18
    v_mul_f32 v17, v17, v25
    s_nop 1
    v_add_f32_dpp v17, v17, v17 row_ror:4 row_mask:0xf bank_mask:0xf
    v_rcp_f32 v19, v17
    s_nop 0
    v_fma_f32 v15, -v17, v19, 1.0
    v_fma_f32 v19, v15, v19, v19
    v_mul_f32 v18, v18, v19
    v_mul_f32 v10, v10, v18
    v_mul_f32 v11, v11, v18
    v_mul_f32 v12, v12, v18
    v_mul_f32 v13, v13, v18
    v_mov_b32_dpp v112, v10 quad_perm:[2,3,0,1] row_mask:0xf bank_mask:0xf
    v_mov_b32_dpp v113, v11 quad_perm:[2,3,0,1] row_mask:0xf bank_mask:0xf
    v_mov_b32_dpp v114, v12 quad_perm:[2,3,0,1] row_mask:0xf bank_mask:0xf
    v_mov_b32_dpp v115, v13 quad_perm:[2,3,0,1] row_mask:0xf bank_mask:0xf
    v_cvt_pk_bf16_f32 v96, v10, v112
    v_cvt_pk_bf16_f32 v100, v11, v113
    v_cvt_pk_bf16_f32 v104, v12, v114
    v_cvt_pk_bf16_f32 v108, v13, v115
    v_mov_b32_dpp v97, v96 row_ror:12 row_mask:0xf bank_mask:0xf
    v_mov_b32_dpp v101, v100 row_ror:12 row_mask:0xf bank_mask:0xf
    v_mov_b32_dpp v105, v104 row_ror:12 row_mask:0xf bank_mask:0xf
    v_mov_b32_dpp v109, v108 row_ror:12 row_mask:0xf bank_mask:0xf
    v_mov_b32_dpp v98, v96 row_ror:8 row_mask:0xf bank_mask:0xf
    v_mov_b32_dpp v102, v100 row_ror:8 row_mask:0xf bank_mask:0xf
    v_mov_b32_dpp v106, v104 row_ror:8 row_mask:0xf bank_mask:0xf
    v_mov_b32_dpp v110, v108 row_ror:8 row_mask:0xf bank_mask:0xf
    v_mov_b32_dpp v99, v96 row_ror:4 row_mask:0xf bank_mask:0xf
    v_mov_b32_dpp v103, v100 row_ror:4 row_mask:0xf bank_mask:0xf
    v_mov_b32_dpp v107, v104 row_ror:4 row_mask:0xf bank_mask:0xf
    v_mov_b32_dpp v111, v108 row_ror:4 row_mask:0xf bank_mask:0xf
    s_lshl_b32 s60, s3, 10
    s_add_u32 s60, s60, 147456
    v_lshlrev_b32 v10, 5, v0
    v_add_u32 v10, s60, v10
    v_perm_b32 v112, v164, v160, s94
    v_perm_b32 v113, v172, v168, s94
    v_perm_b32 v114, v180, v176, s94
    v_perm_b32 v115, v188, v184, s94
    s_nop 1
    v_mfma_f32_16x16x32_bf16 v[128:131], v[96:99], v[112:115], 0
    v_perm_b32 v116, v164, v160, s95
    v_perm_b32 v117, v172, v168, s95
    v_perm_b32 v118, v180, v176, s95
    v_perm_b32 v119, v188, v184, s95
    s_nop 1
    v_mfma_f32_16x16x32_bf16 v[132:135], v[96:99], v[116:119], 0
    v_perm_b32 v120, v165, v161, s94
    v_perm_b32 v121, v173, v169, s94
    v_perm_b32 v122, v181, v177, s94
    v_perm_b32 v123, v189, v185, s94
    s_nop 1
    v_mfma_f32_16x16x32_bf16 v[136:139], v[96:99], v[120:123], 0
    v_perm_b32 v124, v165, v161, s95
    v_perm_b32 v125, v173, v169, s95
    v_perm_b32 v126, v181, v177, s95
    v_perm_b32 v127, v189, v185, s95
    s_nop 1
    v_mfma_f32_16x16x32_bf16 v[140:143], v[96:99], v[124:127], 0
    v_perm_b32 v112, v166, v162, s94
    v_perm_b32 v113, v174, v170, s94
    v_perm_b32 v114, v182, v178, s94
    v_perm_b32 v115, v190, v186, s94
    s_nop 1
    v_mfma_f32_16x16x32_bf16 v[144:147], v[96:99], v[112:115], 0
    v_perm_b32 v116, v166, v162, s95
    v_perm_b32 v117, v174, v170, s95
    v_perm_b32 v118, v182, v178, s95
    v_perm_b32 v119, v190, v186, s95
    s_nop 1
    v_mfma_f32_16x16x32_bf16 v[148:151], v[96:99], v[116:119], 0
    v_perm_b32 v120, v167, v163, s94
    s_branch .Lsk_n1_5
.Lst_n1_5:
    s_branch .Lrt_n1_5
.Lsk_n1_5:
    v_perm_b32 v121, v175, v171, s94
    v_perm_b32 v122, v183, v179, s94
    v_perm_b32 v123, v191, v187, s94
    s_nop 1
    v_mfma_f32_16x16x32_bf16 v[152:155], v[96:99], v[120:123], 0
    v_perm_b32 v124, v167, v163, s95
    v_perm_b32 v125, v175, v171, s95
    v_perm_b32 v126, v183, v179, s95
    v_perm_b32 v127, v191, v187, s95
    s_nop 1
    v_mfma_f32_16x16x32_bf16 v[156:159], v[96:99], v[124:127], 0
    v_perm_b32 v112, v196, v192, s94
    v_perm_b32 v113, v204, v200, s94
    v_perm_b32 v114, v212, v208, s94
    v_perm_b32 v115, v220, v216, s94
    s_nop 1
    v_mfma_f32_16x16x32_bf16 v[128:131], v[100:103], v[112:115], v[128:131]
    v_perm_b32 v116, v196, v192, s95
    v_perm_b32 v117, v204, v200, s95
    v_perm_b32 v118, v212, v208, s95
    v_perm_b32 v119, v220, v216, s95
    s_nop 1
    v_mfma_f32_16x16x32_bf16 v[132:135], v[100:103], v[116:119], v[132:135]
    v_perm_b32 v120, v197, v193, s94
    v_perm_b32 v121, v205, v201, s94
    v_perm_b32 v122, v213, v209, s94
    v_perm_b32 v123, v221, v217, s94
    s_nop 1
    v_mfma_f32_16x16x32_bf16 v[136:139], v[100:103], v[120:123], v[136:139]
    v_perm_b32 v124, v197, v193, s95
    v_perm_b32 v125, v205, v201, s95
    v_perm_b32 v126, v213, v209, s95
    v_perm_b32 v127, v221, v217, s95
    s_nop 1
    v_mfma_f32_16x16x32_bf16 v[140:143], v[100:103], v[124:127], v[140:143]
    v_perm_b32 v112, v198, v194, s94
    v_perm_b32 v113, v206, v202, s94
    v_perm_b32 v114, v214, v210, s94
    v_perm_b32 v115, v222, v218, s94
    s_nop 1
    v_mfma_f32_16x16x32_bf16 v[144:147], v[100:103], v[112:115], v[144:147]
    v_perm_b32 v116, v198, v194, s95
    v_perm_b32 v117, v206, v202, s95
    v_perm_b32 v118, v214, v210, s95
    v_perm_b32 v119, v222, v218, s95
    s_nop 1
    v_mfma_f32_16x16x32_bf16 v[148:151], v[100:103], v[116:119], v[148:151]
    v_perm_b32 v120, v199, v195, s94
    v_perm_b32 v121, v207, v203, s94
    v_perm_b32 v122, v215, v211, s94
    v_perm_b32 v123, v223, v219, s94
    s_nop 1
    v_mfma_f32_16x16x32_bf16 v[152:155], v[100:103], v[120:123], v[152:155]
    v_perm_b32 v124, v199, v195, s95
    v_perm_b32 v125, v207, v203, s95
    v_perm_b32 v126, v215, v211, s95
    v_perm_b32 v127, v223, v219, s95
    s_nop 1
    v_mfma_f32_16x16x32_bf16 v[156:159], v[100:103], v[124:127], v[156:159]
    v_perm_b32 v112, v228, v224, s94
    v_perm_b32 v113, v236, v232, s94
    v_perm_b32 v114, v244, v240, s94
    v_perm_b32 v115, v252, v248, s94
    s_nop 1
    v_mfma_f32_16x16x32_bf16 v[128:131], v[104:107], v[112:115], v[128:131]
    v_perm_b32 v116, v228, v224, s95
    v_perm_b32 v117, v236, v232, s95
    v_perm_b32 v118, v244, v240, s95
    v_perm_b32 v119, v252, v248, s95
    s_nop 1
    v_mfma_f32_16x16x32_bf16 v[132:135], v[104:107], v[116:119], v[132:135]
    v_perm_b32 v120, v229, v225, s94
    v_perm_b32 v121, v237, v233, s94
    v_perm_b32 v122, v245, v241, s94
    v_perm_b32 v123, v253, v249, s94
    s_nop 1
    v_mfma_f32_16x16x32_bf16 v[136:139], v[104:107], v[120:123], v[136:139]
    v_perm_b32 v124, v229, v225, s95
    v_perm_b32 v125, v237, v233, s95
    v_perm_b32 v126, v245, v241, s95
    v_perm_b32 v127, v253, v249, s95
    s_nop 1
    v_mfma_f32_16x16x32_bf16 v[140:143], v[104:107], v[124:127], v[140:143]
    v_perm_b32 v112, v230, v226, s94
    v_perm_b32 v113, v238, v234, s94
    v_perm_b32 v114, v246, v242, s94
    v_perm_b32 v115, v254, v250, s94
    s_nop 1
    v_mfma_f32_16x16x32_bf16 v[144:147], v[104:107], v[112:115], v[144:147]
    v_perm_b32 v116, v230, v226, s95
    v_perm_b32 v117, v238, v234, s95
    v_perm_b32 v118, v246, v242, s95
    v_perm_b32 v119, v254, v250, s95
    s_nop 1
    v_mfma_f32_16x16x32_bf16 v[148:151], v[104:107], v[116:119], v[148:151]
    v_perm_b32 v120, v231, v227, s94
    v_perm_b32 v121, v239, v235, s94
    v_perm_b32 v122, v247, v243, s94
    v_perm_b32 v123, v255, v251, s94
    s_nop 1
    v_mfma_f32_16x16x32_bf16 v[152:155], v[104:107], v[120:123], v[152:155]
    v_perm_b32 v124, v231, v227, s95
    v_perm_b32 v125, v239, v235, s95
    v_perm_b32 v126, v247, v243, s95
    v_perm_b32 v127, v255, v251, s95
    s_nop 1
    v_mfma_f32_16x16x32_bf16 v[156:159], v[104:107], v[124:127], v[156:159]
    s_waitcnt vmcnt(0)
    v_perm_b32 v112, v44, v36, s94
    v_perm_b32 v113, v60, v52, s94
    v_perm_b32 v114, v76, v68, s94
    v_perm_b32 v115, v92, v84, s94
    s_branch .Lsk_n1_6
.Lst_n1_6:
    s_branch .Lrt_n1_6
.Lsk_n1_6:
    s_nop 1
    v_mfma_f32_16x16x32_bf16 v[128:131], v[108:111], v[112:115], v[128:131]
    v_perm_b32 v116, v44, v36, s95
    v_perm_b32 v117, v60, v52, s95
    v_perm_b32 v118, v76, v68, s95
    v_perm_b32 v119, v92, v84, s95
    s_nop 1
    v_mfma_f32_16x16x32_bf16 v[132:135], v[108:111], v[116:119], v[132:135]
    v_perm_b32 v120, v45, v37, s94
    v_perm_b32 v121, v61, v53, s94
    v_perm_b32 v122, v77, v69, s94
    v_perm_b32 v123, v93, v85, s94
    s_nop 1
    v_mfma_f32_16x16x32_bf16 v[136:139], v[108:111], v[120:123], v[136:139]
    v_perm_b32 v124, v45, v37, s95
    v_perm_b32 v125, v61, v53, s95
    v_perm_b32 v126, v77, v69, s95
    v_perm_b32 v127, v93, v85, s95
    s_nop 1
    v_mfma_f32_16x16x32_bf16 v[140:143], v[108:111], v[124:127], v[140:143]
    v_perm_b32 v112, v46, v38, s94
    v_perm_b32 v113, v62, v54, s94
    v_perm_b32 v114, v78, v70, s94
    v_perm_b32 v115, v94, v86, s94
    s_nop 1
    v_mfma_f32_16x16x32_bf16 v[144:147], v[108:111], v[112:115], v[144:147]
    v_perm_b32 v116, v46, v38, s95
    v_perm_b32 v117, v62, v54, s95
    v_perm_b32 v118, v78, v70, s95
    v_perm_b32 v119, v94, v86, s95
    s_nop 1
    v_mfma_f32_16x16x32_bf16 v[148:151], v[108:111], v[116:119], v[148:151]
    v_perm_b32 v120, v47, v39, s94
    v_perm_b32 v121, v63, v55, s94
    v_perm_b32 v122, v79, v71, s94
    v_perm_b32 v123, v95, v87, s94
    s_nop 1
    v_mfma_f32_16x16x32_bf16 v[152:155], v[108:111], v[120:123], v[152:155]
    v_perm_b32 v124, v47, v39, s95
    v_perm_b32 v125, v63, v55, s95
    v_perm_b32 v126, v79, v71, s95
    v_perm_b32 v127, v95, v87, s95
    s_nop 1
    v_mfma_f32_16x16x32_bf16 v[156:159], v[108:111], v[124:127], v[156:159]
    s_mov_b64 exec, 0xffff
    ds_write2_b32 v10, v128, v129 offset0:0 offset1:128
    ds_write2_b32 v10, v132, v133 offset0:1 offset1:129
    ds_write2_b32 v10, v136, v137 offset0:2 offset1:130
    ds_write2_b32 v10, v140, v141 offset0:3 offset1:131
    ds_write2_b32 v10, v144, v145 offset0:4 offset1:132
    ds_write2_b32 v10, v148, v149 offset0:5 offset1:133
    ds_write2_b32 v10, v152, v153 offset0:6 offset1:134
    ds_write2_b32 v10, v156, v157 offset0:7 offset1:135
    s_mov_b64 exec, -1
    s_waitcnt lgkmcnt(0)
    s_barrier
    s_cmp_lg_u32 s3, 7
    s_cbranch_scc1 .opub_50
    v_add_u32 v10, 147456, v2
    ds_read_b128 v[196:199], v10 offset:0
    ds_read_b128 v[200:203], v10 offset:1024
    ds_read_b128 v[204:207], v10 offset:2048
    ds_read_b128 v[208:211], v10 offset:3072
    ds_read_b128 v[212:215], v10 offset:4096
    ds_read_b128 v[216:219], v10 offset:5120
    ds_read_b128 v[220:223], v10 offset:6144
    ds_read_b128 v[224:227], v10 offset:7168
    v_lshrrev_b32 v11, 5, v0
    v_lshlrev_b32 v11, 13, v11
    v_and_b32 v12, 31, v0
    v_lshl_add_u32 v11, v12, 4, v11
    s_lshl4_add_u32 s56, s67, s66
    s_lshl1_add_u32 s56, s56, s68
    s_lshl_b32 s56, s56, 9
    s_add_u32 s56, s56, 0xa0000
    s_mov_b32 s60, 0x07060503
    s_mov_b32 s61, 0x07060502
    s_mov_b32 s62, 0x07060501
    v_mov_b32 v15, s34
    s_waitcnt lgkmcnt(6)
    v_pk_add_f32 v[196:197], v[196:197], v[200:201]
    v_pk_add_f32 v[198:199], v[198:199], v[202:203]
    s_waitcnt lgkmcnt(5)
    v_pk_add_f32 v[196:197], v[196:197], v[204:205]
    v_pk_add_f32 v[198:199], v[198:199], v[206:207]
    s_waitcnt lgkmcnt(4)
    v_pk_add_f32 v[196:197], v[196:197], v[208:209]
    v_pk_add_f32 v[198:199], v[198:199], v[210:211]
    s_waitcnt lgkmcnt(3)
    v_pk_add_f32 v[196:197], v[196:197], v[212:213]
    v_pk_add_f32 v[198:199], v[198:199], v[214:215]
    s_waitcnt lgkmcnt(2)
    v_pk_add_f32 v[196:197], v[196:197], v[216:217]
    v_pk_add_f32 v[198:199], v[198:199], v[218:219]
    s_waitcnt lgkmcnt(1)
    v_pk_add_f32 v[196:197], v[196:197], v[220:221]
    v_pk_add_f32 v[198:199], v[198:199], v[222:223]
    s_waitcnt lgkmcnt(0)
    v_pk_add_f32 v[196:197], v[196:197], v[224:225]
    v_pk_add_f32 v[198:199], v[198:199], v[226:227]
    v_perm_b32 v12, v196, v199, s60
    v_perm_b32 v13, v197, v199, s61
    v_perm_b32 v14, v198, v199, s62
    s_add_u32 s57, s56, 0x800000
    buffer_store_dwordx4 v[12:15], v11, s[36:39], s57 offen
    buffer_store_dwordx4 v[12:15], v11, s[36:39], s56 offen sc1
.opub_50:
    s_cmp_lt_u32 s65, 8
    s_nop 0
    s_cbranch_scc1 .Lexit
    v_and_b32 v6, 31, v0
    v_lshlrev_b32 v6, 3, v6
    v_lshrrev_b32 v7, 5, v0
    v_lshl_add_u32 v6, v7, 2, v6
    s_mul_i32 s56, s3, 528
    s_add_u32 s56, s56, 131072
    v_add_u32 v6, s56, v6
    s_lshl4_add_u32 s101, s99, s3
    s_lshl_b32 s101, s101, 10
    s_add_u32 s101, s101, 0xa0000
    v_add_u32 v5, 8192, v2
    s_cmp_ge_u32 s3, 6
    s_nop 0
    s_cbranch_scc1 .La_poll
    v_lshrrev_b32 v16, 4, v0
    v_bfe_u32 v17, v0, 2, 2
    v_lshl_add_u32 v7, v16, 3, v17
    v_lshlrev_b32 v7, 7, v7
    v_and_b32 v16, 1, v16
    v_lshrrev_b32 v17, 1, v17
    v_lshl_add_u32 v16, v16, 1, v17
    s_and_b32 s56, s3, 1
    s_lshl_b32 s56, s56, 1
    v_xor_b32 v16, s56, v16
    v_and_b32 v17, 3, v0
    v_lshl_add_u32 v7, v17, 3, v7
    s_lshr_b32 s56, s3, 1
    s_lshl_b32 s56, s56, 15
    v_add_u32 v7, s56, v7
    v_xor_b32 v17, 1, v16
    v_lshl_add_u32 v8, v17, 5, v7
    v_lshl_add_u32 v7, v16, 5, v7
    ds_read_b64_tr_b16 v[32:33], v7 offset:0
    ds_read_b64_tr_b16 v[34:35], v7 offset:512
    ds_read_b64_tr_b16 v[64:65], v8 offset:0
    ds_read_b64_tr_b16 v[66:67], v8 offset:512
    ds_read_b64_tr_b16 v[36:37], v7 offset:4096
    ds_read_b64_tr_b16 v[38:39], v7 offset:4608
    ds_read_b64_tr_b16 v[68:69], v8 offset:4096
    ds_read_b64_tr_b16 v[70:71], v8 offset:4608
    ds_read_b64_tr_b16 v[40:41], v7 offset:8192
    ds_read_b64_tr_b16 v[42:43], v7 offset:8704
    ds_read_b64_tr_b16 v[72:73], v8 offset:8192
    ds_read_b64_tr_b16 v[74:75], v8 offset:8704
    ds_read_b64_tr_b16 v[44:45], v7 offset:12288
    ds_read_b64_tr_b16 v[46:47], v7 offset:12800
    ds_read_b64_tr_b16 v[76:77], v8 offset:12288
    ds_read_b64_tr_b16 v[78:79], v8 offset:12800
    ds_read_b64_tr_b16 v[48:49], v7 offset:16384
    ds_read_b64_tr_b16 v[50:51], v7 offset:16896
    ds_read_b64_tr_b16 v[80:81], v8 offset:16384
    ds_read_b64_tr_b16 v[82:83], v8 offset:16896
    s_branch .Lsk_n1_7
.Lst_n1_7:
    s_branch .Lrt_n1_7
.Lsk_n1_7:
    ds_read_b64_tr_b16 v[52:53], v7 offset:20480
    ds_read_b64_tr_b16 v[54:55], v7 offset:20992
    ds_read_b64_tr_b16 v[84:85], v8 offset:20480
    ds_read_b64_tr_b16 v[86:87], v8 offset:20992
    ds_read_b64_tr_b16 v[56:57], v7 offset:24576
    ds_read_b64_tr_b16 v[58:59], v7 offset:25088
    ds_read_b64_tr_b16 v[88:89], v8 offset:24576
    ds_read_b64_tr_b16 v[90:91], v8 offset:25088
    ds_read_b64_tr_b16 v[60:61], v7 offset:28672
    ds_read_b64_tr_b16 v[62:63], v7 offset:29184
    ds_read_b64_tr_b16 v[92:93], v8 offset:28672
    ds_read_b64_tr_b16 v[94:95], v8 offset:29184
    s_mov_b32 s56, 131072
    v_bfe_u32 v9, v0, 1, 3
    v_mul_u32_u24 v9, 528, v9
    v_and_b32 v16, 48, v0
    v_add3_u32 v9, v9, v16, s56
    v_bfe_u32 v10, v0, 1, 3
    v_mul_u32_u24 v10, 36864, v10
    v_and_b32 v16, 1, v0
    v_lshl_add_u32 v10, v16, 4, v10
    v_and_b32 v16, 48, v0
    v_lshl_add_u32 v10, v16, 1, v10
    s_mul_i32 s59, s100, 3
    s_lshr_b32 s56, s3, 1
    s_add_u32 s59, s59, s56
    s_lshl4_add_u32 s59, s59, s99
    s_and_b32 s56, s3, 1
    s_lshl1_add_u32 s59, s59, s56
    s_lshl_b32 s59, s59, 7
    s_add_u32 s59, s59, 0xe0000
    v_mov_b32 v139, s34
.La_poll:
    s_mov_b32 s60, 0x04000c0c
    s_mov_b32 s61, 0x0706000c
    s_mov_b32 s69, 0
.gp_51:
    s_add_u32 s69, s69, 1
    s_and_b32 s56, s69, 0x41
    s_cmp_lg_u32 s56, 0x41
    s_cselect_b32 s56, s0, 0
    s_add_u32 s58, s101, s56
    buffer_load_dwordx4 v[16:19], v2, s[36:39], s58 offen offset:0 sc1
    buffer_load_dwordx4 v[20:23], v5, s[36:39], s58 offen offset:0 sc1
    s_waitcnt vmcnt(0)
    v_cmp_eq_u32 vcc, s34, v19
    v_cmp_eq_u32 s[56:57], s34, v23
    s_and_b64 vcc, vcc, s[56:57]
    s_cmp_eq_u64 vcc, -1
    s_nop 2
    s_cbranch_scc1 .gpd_52
    s_sub_u32 s35, s35, 1
    s_cbranch_scc1 .Lexit
    s_branch .gp_51
.gpd_52:
    v_perm_b32 v19, v16, v17, s60
    v_perm_b32 v19, v19, v18, s61
    v_perm_b32 v23, v20, v21, s60
    v_perm_b32 v23, v23, v22, s61
    v_permlane32_swap_b32 v16, v18
    v_permlane32_swap_b32 v17, v19
    v_permlane32_swap_b32 v20, v22
    v_permlane32_swap_b32 v21, v23
    v_pk_add_f32 v[16:17], v[16:17], v[18:19]
    v_pk_add_f32 v[20:21], v[20:21], v[22:23]
    v_cvt_pk_bf16_f32 v16, v16, v17
    v_cvt_pk_bf16_f32 v20, v20, v21
    ds_write2_b32 v6, v16, v20 offset1:64
    s_mov_b32 s60, 0x07060503
    s_mov_b32 s61, 0x07060502
    s_mov_b32 s62, 0x07060501
    s_mov_b32 vcc_lo, 0xaaaaaaaa
    s_mov_b32 vcc_hi, 0xaaaaaaaa
    s_waitcnt lgkmcnt(0)
    s_barrier
    s_cmp_ge_u32 s3, 6
    s_cbranch_scc1 .Lexit
    ds_read_b128 v[96:99], v9 offset:0
    ds_read_b128 v[100:103], v9 offset:64
    ds_read_b128 v[104:107], v9 offset:128
    ds_read_b128 v[108:111], v9 offset:192
    ds_read_b128 v[112:115], v9 offset:256
    ds_read_b128 v[116:119], v9 offset:320
    ds_read_b128 v[120:123], v9 offset:384
    ds_read_b128 v[124:127], v9 offset:448
    s_waitcnt lgkmcnt(7)
    v_mfma_f32_16x16x32_bf16 v[128:131], v[32:35], v[96:99], 0
    v_mfma_f32_16x16x32_bf16 v[132:135], v[64:67], v[96:99], 0
    s_waitcnt lgkmcnt(6)
    v_mfma_f32_16x16x32_bf16 v[128:131], v[36:39], v[100:103], v[128:131]
    v_mfma_f32_16x16x32_bf16 v[132:135], v[68:71], v[100:103], v[132:135]
    s_waitcnt lgkmcnt(5)
    v_mfma_f32_16x16x32_bf16 v[128:131], v[40:43], v[104:107], v[128:131]
    v_mfma_f32_16x16x32_bf16 v[132:135], v[72:75], v[104:107], v[132:135]
    s_waitcnt lgkmcnt(4)
    v_mfma_f32_16x16x32_bf16 v[128:131], v[44:47], v[108:111], v[128:131]
    v_mfma_f32_16x16x32_bf16 v[132:135], v[76:79], v[108:111], v[132:135]
    s_waitcnt lgkmcnt(3)
    v_mfma_f32_16x16x32_bf16 v[128:131], v[48:51], v[112:115], v[128:131]
    v_mfma_f32_16x16x32_bf16 v[132:135], v[80:83], v[112:115], v[132:135]
    s_waitcnt lgkmcnt(2)
    v_mfma_f32_16x16x32_bf16 v[128:131], v[52:55], v[116:119], v[128:131]
    v_mfma_f32_16x16x32_bf16 v[132:135], v[84:87], v[116:119], v[132:135]
    s_waitcnt lgkmcnt(1)
    v_mfma_f32_16x16x32_bf16 v[128:131], v[56:59], v[120:123], v[128:131]
    v_mfma_f32_16x16x32_bf16 v[132:135], v[88:91], v[120:123], v[132:135]
    s_waitcnt lgkmcnt(0)
    v_mfma_f32_16x16x32_bf16 v[128:131], v[60:63], v[124:127], v[128:131]
    v_mfma_f32_16x16x32_bf16 v[132:135], v[92:95], v[124:127], v[132:135]
    s_nop 7
    v_cndmask_b32 v128, v128, v132, vcc
    v_cndmask_b32 v129, v129, v133, vcc
    v_cndmask_b32 v130, v130, v134, vcc
    v_cndmask_b32 v131, v131, v135, vcc
    v_perm_b32 v136, v128, v131, s60
    v_perm_b32 v137, v129, v131, s61
    v_perm_b32 v138, v130, v131, s62
    buffer_store_dwordx4 v[136:139], v10, s[36:39], s59 offen sc1
    s_nop 1
    s_branch .Lexit
.Lm:
    s_branch .Lsk_m0_0
.Lst_m0_0:
    s_branch .Lrt_m0_0
.Lsk_m0_0:
    s_cmp_lt_u32 s2, 54
    s_mov_b32 s14, 0xfdff7fdf
    s_cselect_b32 s14, 0x6b5ad6b5, s14
    s_mov_b32 s15, 0xff7fdff7
    s_cselect_b32 s15, 0x5ad6b5ad, s15
    s_add_u32 s30, s70, 0
    s_mov_b32 s31, s70
    v_bfe_u32 v16, v0, 1, 3
    v_mul_u32_u24 v16, 1312, v16
    v_lshrrev_b32 v12, 4, v0
    v_lshl_add_u32 v16, v12, 5, v16
    v_and_b32 v12, 1, v0
    v_lshl_add_u32 v16, v12, 4, v16
    v_add_u32 v16, 147456, v16
    s_mul_i32 s56, s3, 1312
    s_add_u32 s56, s56, 147456
    v_add_u32 v17, s56, v3
    v_add_u32 v18, s56, v4
    v_lshrrev_b32 v12, 4, v0
    v_bfe_u32 v13, v0, 1, 1
    v_lshl_add_u32 v12, v12, 1, v13
    v_bfe_u32 v13, v0, 2, 2
    v_lshl_add_u32 v20, v12, 3, v13
    v_lshlrev_b32 v20, 7, v20
    v_and_b32 v12, 3, v12
    v_lshrrev_b32 v13, 1, v13
    v_lshl_add_u32 v12, v12, 1, v13
    v_xor_b32 v12, s3, v12
    v_lshl_add_u32 v20, v12, 4, v20
    v_and_b32 v12, 1, v0
    v_lshl_add_u32 v20, v12, 3, v20
    v_bfe_u32 v23, v0, 1, 3
    v_mul_u32_u24 v23, 144, v23
    v_bfe_u32 v12, v0, 4, 1
    v_lshl_add_u32 v23, v12, 3, v23
    v_lshrrev_b32 v12, 5, v0
    v_lshl_add_u32 v23, v12, 2, v23
    v_and_b32 v12, 1, v0
    v_lshl_add_u32 v23, v12, 1, v23
    s_lshl_b32 s56, s3, 4
    s_add_u32 s56, s56, 157952
    v_add_u32 v23, s56, v23
    v_and_b32 v24, 15, v0
    v_lshlrev_b32 v24, 3, v24
    s_mul_i32 s56, s3, 144
    s_add_u32 s56, s56, 157952
    v_add_u32 v24, s56, v24
    v_add_u32 v21, 32768, v20
    s_lshl_b32 s100, s3, 10
    s_mov_b32 s99, s2
    s_cmp_ge_u32 s99, 18
    s_cbranch_scc1 .Lm_rel
    s_mul_i32 s58, s3, 1152
    s_mov_b32 s52, s24
    s_and_b32 s53, s25, 0xffff
    s_mov_b32 s54, 0x2400
    s_mov_b32 s55, 0x00020000
    buffer_load_dwordx2 v[246:247], v3, s[52:55], s58 offen
    buffer_load_dwordx2 v[248:249], v3, s[52:55], s58 offen offset:512
    buffer_load_dword v250, v4, s[52:55], s58 offen
    s_mov_b32 s48, s26
    s_and_b32 s49, s27, 0xffff
    s_mov_b32 s50, 0x3cc000
    s_mov_b32 s51, 0x00020000
    v_bfe_u32 v12, v0, 4, 1
    s_and_b32 s56, s3, 3
    s_lshl_b32 s56, s56, 1
    v_or_b32 v12, s56, v12
    v_and_b32 v19, 7, v0
    v_xor_b32 v12, v12, v19
    v_lshrrev_b32 v19, 3, v0
    v_mul_u32_u24 v19, 6912, v19
    v_lshl_add_u32 v19, v12, 4, v19
    s_mul_i32 s57, s3, 55296
    s_lshl_b32 s59, s99, 7
    s_add_u32 s57, s57, s59
    s_add_u32 m0, s100, 0
    s_add_u32 s56, s57, 0
    buffer_load_dwordx4 v19, s[48:51], s56 offen nt lds
    s_add_u32 m0, s100, 8192
    s_add_u32 s56, s57, 442368
    buffer_load_dwordx4 v19, s[48:51], s56 offen nt lds
    s_add_u32 m0, s100, 16384
    s_add_u32 s56, s57, 884736
    buffer_load_dwordx4 v19, s[48:51], s56 offen nt lds
    s_add_u32 m0, s100, 24576
    s_add_u32 s56, s57, 1327104
    buffer_load_dwordx4 v19, s[48:51], s56 offen nt lds
    s_add_u32 m0, s100, 32768
    s_add_u32 s56, s57, 1769472
    buffer_load_dwordx4 v19, s[48:51], s56 offen nt lds
    s_add_u32 m0, s100, 40960
    s_add_u32 s56, s57, 2211840
    buffer_load_dwordx4 v19, s[48:51], s56 offen nt lds
    s_add_u32 m0, s100, 49152
    s_add_u32 s56, s57, 2654208
    buffer_load_dwordx4 v19, s[48:51], s56 offen nt lds
    s_add_u32 m0, s100, 57344
    s_add_u32 s56, s57, 3096576
    buffer_load_dwordx4 v19, s[48:51], s56 offen nt lds
    s_add_u32 m0, s100, 65536
    s_add_u32 s56, s57, 3538944
    buffer_load_dwordx4 v19, s[48:51], s56 offen nt lds
    s_waitcnt lgkmcnt(0)
    s_add_u32 s34, s34, 1
    s_getreg_b32 s1, hwreg(HW_REG_XCC_ID)
    s_lshl_b32 s1, s1, 24
    s_add_u32 s1, s1, s34
    s_lshr_b32 s0, s2, 3
    s_lshl_b32 s63, s64, 8
    s_add_u32 s0, s0, s63
    s_lshl2_add_u32 s0, s0, 0x480000
    v_mov_b32 v30, s1
    s_cmp_eq_u32 s3, 0
    s_cselect_b64 exec, 1, 0
    buffer_store_dword v30, v2, s[36:39], s0 offen sc1
    s_mov_b64 exec, -1
    v_lshrrev_b32 v12, 4, v0
    v_mul_u32_u24 v12, 18432, v12
    v_and_b32 v13, 15, v0
    v_lshl_add_u32 v22, v13, 4, v12
    s_mul_i32 s57, s99, 57
    s_lshr_b32 s57, s57, 9
    s_mul_i32 s58, s57, 9
    s_sub_u32 s58, s99, s58
    s_mul_i32 s59, s57, 73728
    s_lshl_b32 s58, s58, 8
    s_add_u32 s59, s59, s58
    s_mul_i32 s58, s3, 2304
    s_add_u32 s59, s59, s58
    s_add_u32 s59, s59, 0x1000
    s_mov_b32 s58, 0
    s_cmp_eq_u32 s57, 1
    s_cselect_b32 s58, 1.0, s58
    s_cmp_eq_u32 s57, 4
    s_cselect_b32 s58, 1.0, s58
    s_waitcnt vmcnt(10)
    v_lshlrev_b32 v236, 16, v246
    v_and_b32 v237, 0xffff0000, v246
    v_max_f32 v236, 0xc2ae0000, v236
    v_min_f32 v242, 0x43000000, v236
    v_mul_f32 v238, 0xbfb8aa3b, v242
    v_fma_f32 v240, v242, s98, -v238
    v_fmac_f32 v240, 0xb2a57060, v242
    v_exp_f32 v238, v238
    v_mul_f32 v240, 0x3f317218, v240
    v_fmac_f32 v238, v238, v240
    v_add_f32 v238, 1.0, v238
    v_rcp_f32 v240, v238
    s_nop 0
    v_mul_f32 v242, v236, v240
    v_fma_f32 v238, -v242, v238, v236
    v_fma_f32 v236, v238, v240, v242
    v_max_f32 v237, 0xc2ae0000, v237
    v_min_f32 v243, 0x43000000, v237
    v_mul_f32 v239, 0xbfb8aa3b, v243
    v_fma_f32 v241, v243, s98, -v239
    v_fmac_f32 v241, 0xb2a57060, v243
    v_exp_f32 v239, v239
    v_mul_f32 v241, 0x3f317218, v241
    v_fmac_f32 v239, v239, v241
    v_add_f32 v239, 1.0, v239
    v_rcp_f32 v241, v239
    s_nop 0
    v_mul_f32 v243, v237, v241
    v_fma_f32 v239, -v243, v239, v237
    s_branch .Lsk_m0_1
.Lst_m0_1:
    s_branch .Lrt_m0_1
.Lsk_m0_1:
    v_fma_f32 v237, v239, v241, v243
    v_cvt_pk_bf16_f32 v246, v236, v237
    v_lshlrev_b32 v236, 16, v247
    v_and_b32 v237, 0xffff0000, v247
    v_max_f32 v236, 0xc2ae0000, v236
    v_min_f32 v242, 0x43000000, v236
    v_mul_f32 v238, 0xbfb8aa3b, v242
    v_fma_f32 v240, v242, s98, -v238
    v_fmac_f32 v240, 0xb2a57060, v242
    v_exp_f32 v238, v238
    v_mul_f32 v240, 0x3f317218, v240
    v_fmac_f32 v238, v238, v240
    v_add_f32 v238, 1.0, v238
    v_rcp_f32 v240, v238
    s_nop 0
    v_mul_f32 v242, v236, v240
    v_fma_f32 v238, -v242, v238, v236
    v_fma_f32 v236, v238, v240, v242
    v_max_f32 v237, 0xc2ae0000, v237
    v_min_f32 v243, 0x43000000, v237
    v_mul_f32 v239, 0xbfb8aa3b, v243
    v_fma_f32 v241, v243, s98, -v239
    v_fmac_f32 v241, 0xb2a57060, v243
    v_exp_f32 v239, v239
    v_mul_f32 v241, 0x3f317218, v241
    v_fmac_f32 v239, v239, v241
    v_add_f32 v239, 1.0, v239
    v_rcp_f32 v241, v239
    s_nop 0
    v_mul_f32 v243, v237, v241
    v_fma_f32 v239, -v243, v239, v237
    v_fma_f32 v237, v239, v241, v243
    v_cvt_pk_bf16_f32 v247, v236, v237
    v_lshlrev_b32 v236, 16, v248
    v_and_b32 v237, 0xffff0000, v248
    v_max_f32 v236, 0xc2ae0000, v236
    v_min_f32 v242, 0x43000000, v236
    v_mul_f32 v238, 0xbfb8aa3b, v242
    v_fma_f32 v240, v242, s98, -v238
    v_fmac_f32 v240, 0xb2a57060, v242
    v_exp_f32 v238, v238
    v_mul_f32 v240, 0x3f317218, v240
    v_fmac_f32 v238, v238, v240
    v_add_f32 v238, 1.0, v238
    v_rcp_f32 v240, v238
    s_nop 0
    v_mul_f32 v242, v236, v240
    v_fma_f32 v238, -v242, v238, v236
    v_fma_f32 v236, v238, v240, v242
    v_max_f32 v237, 0xc2ae0000, v237
    v_min_f32 v243, 0x43000000, v237
    v_mul_f32 v239, 0xbfb8aa3b, v243
    v_fma_f32 v241, v243, s98, -v239
    v_fmac_f32 v241, 0xb2a57060, v243
    v_exp_f32 v239, v239
    v_mul_f32 v241, 0x3f317218, v241
    v_fmac_f32 v239, v239, v241
    v_add_f32 v239, 1.0, v239
    v_rcp_f32 v241, v239
    s_nop 0
    v_mul_f32 v243, v237, v241
    v_fma_f32 v239, -v243, v239, v237
    v_fma_f32 v237, v239, v241, v243
    v_cvt_pk_bf16_f32 v248, v236, v237
    v_lshlrev_b32 v236, 16, v249
    v_and_b32 v237, 0xffff0000, v249
    v_max_f32 v236, 0xc2ae0000, v236
    v_min_f32 v242, 0x43000000, v236
    v_mul_f32 v238, 0xbfb8aa3b, v242
    v_fma_f32 v240, v242, s98, -v238
    v_fmac_f32 v240, 0xb2a57060, v242
    v_exp_f32 v238, v238
    v_mul_f32 v240, 0x3f317218, v240
    v_fmac_f32 v238, v238, v240
    v_add_f32 v238, 1.0, v238
    v_rcp_f32 v240, v238
    s_nop 0
    v_mul_f32 v242, v236, v240
    v_fma_f32 v238, -v242, v238, v236
    v_fma_f32 v236, v238, v240, v242
    v_max_f32 v237, 0xc2ae0000, v237
    v_min_f32 v243, 0x43000000, v237
    v_mul_f32 v239, 0xbfb8aa3b, v243
    v_fma_f32 v241, v243, s98, -v239
    v_fmac_f32 v241, 0xb2a57060, v243
    v_exp_f32 v239, v239
    v_mul_f32 v241, 0x3f317218, v241
    v_fmac_f32 v239, v239, v241
    v_add_f32 v239, 1.0, v239
    v_rcp_f32 v241, v239
    s_nop 0
    v_mul_f32 v243, v237, v241
    v_fma_f32 v239, -v243, v239, v237
    v_fma_f32 v237, v239, v241, v243
    v_cvt_pk_bf16_f32 v249, v236, v237
    v_lshlrev_b32 v236, 16, v250
    v_and_b32 v237, 0xffff0000, v250
    v_max_f32 v236, 0xc2ae0000, v236
    v_min_f32 v242, 0x43000000, v236
    v_mul_f32 v238, 0xbfb8aa3b, v242
    v_fma_f32 v240, v242, s98, -v238
    v_fmac_f32 v240, 0xb2a57060, v242
    v_exp_f32 v238, v238
    v_mul_f32 v240, 0x3f317218, v240
    v_fmac_f32 v238, v238, v240
    v_add_f32 v238, 1.0, v238
    v_rcp_f32 v240, v238
    s_nop 0
    v_mul_f32 v242, v236, v240
    v_fma_f32 v238, -v242, v238, v236
    v_fma_f32 v236, v238, v240, v242
    v_max_f32 v237, 0xc2ae0000, v237
    v_min_f32 v243, 0x43000000, v237
    v_mul_f32 v239, 0xbfb8aa3b, v243
    v_fma_f32 v241, v243, s98, -v239
    v_fmac_f32 v241, 0xb2a57060, v243
    v_exp_f32 v239, v239
    v_mul_f32 v241, 0x3f317218, v241
    v_fmac_f32 v239, v239, v241
    v_add_f32 v239, 1.0, v239
    v_rcp_f32 v241, v239
    s_nop 0
    v_mul_f32 v243, v237, v241
    v_fma_f32 v239, -v243, v239, v237
    v_fma_f32 v237, v239, v241, v243
    v_cvt_pk_bf16_f32 v250, v236, v237
    ds_write_b64 v17, v[246:247] offset:0
    ds_write_b64 v17, v[248:249] offset:512
    ds_write_b32 v18, v250 offset:0
    s_waitcnt vmcnt(1)
    s_waitcnt lgkmcnt(0)
    s_barrier
    ds_read_b64_tr_b16 v[160:161], v20 offset:0
    ds_read_b64_tr_b16 v[162:163], v20 offset:512
    ds_read_b64_tr_b16 v[164:165], v20 offset:8192
    ds_read_b64_tr_b16 v[166:167], v20 offset:8704
    ds_read_b64_tr_b16 v[168:169], v20 offset:16384
    ds_read_b64_tr_b16 v[170:171], v20 offset:16896
    ds_read_b64_tr_b16 v[172:173], v20 offset:24576
    ds_read_b64_tr_b16 v[174:175], v20 offset:25088
    ds_read_b64_tr_b16 v[176:177], v21 offset:0
    ds_read_b64_tr_b16 v[178:179], v21 offset:512
    ds_read_b64_tr_b16 v[180:181], v21 offset:8192
    ds_read_b64_tr_b16 v[182:183], v21 offset:8704
    ds_read_b64_tr_b16 v[184:185], v21 offset:16384
    ds_read_b64_tr_b16 v[186:187], v21 offset:16896
    ds_read_b64_tr_b16 v[188:189], v21 offset:24576
    ds_read_b64_tr_b16 v[190:191], v21 offset:25088
    ds_read_b64_tr_b16 v[192:193], v21 offset:32768
    ds_read_b64_tr_b16 v[194:195], v21 offset:33280
    ds_read_b128 v[196:199], v16 offset:0
    ds_read_b128 v[200:203], v16 offset:128
    ds_read_b128 v[204:207], v16 offset:256
    ds_read_b128 v[208:211], v16 offset:384
    ds_read_b128 v[212:215], v16 offset:512
    ds_read_b128 v[216:219], v16 offset:640
    ds_read_b128 v[220:223], v16 offset:768
    ds_read_b128 v[224:227], v16 offset:896
    ds_read_b128 v[228:231], v16 offset:1024
    s_waitcnt lgkmcnt(8)
    v_mfma_f32_16x16x32_bf16 v[232:235], v[160:163], v[196:199], 0
    s_waitcnt lgkmcnt(7)
    v_mfma_f32_16x16x32_bf16 v[232:235], v[164:167], v[200:203], v[232:235]
    s_waitcnt lgkmcnt(6)
    s_branch .Lsk_m0_2
.Lst_m0_2:
    s_branch .Lrt_m0_2
.Lsk_m0_2:
    v_mfma_f32_16x16x32_bf16 v[232:235], v[168:171], v[204:207], v[232:235]
    s_waitcnt lgkmcnt(5)
    v_mfma_f32_16x16x32_bf16 v[232:235], v[172:175], v[208:211], v[232:235]
    s_waitcnt lgkmcnt(4)
    v_mfma_f32_16x16x32_bf16 v[232:235], v[176:179], v[212:215], v[232:235]
    s_waitcnt lgkmcnt(3)
    v_mfma_f32_16x16x32_bf16 v[232:235], v[180:183], v[216:219], v[232:235]
    s_waitcnt lgkmcnt(2)
    v_mfma_f32_16x16x32_bf16 v[232:235], v[184:187], v[220:223], v[232:235]
    s_waitcnt lgkmcnt(1)
    v_mfma_f32_16x16x32_bf16 v[232:235], v[188:191], v[224:227], v[232:235]
    s_waitcnt lgkmcnt(0)
    v_mfma_f32_16x16x32_bf16 v[232:235], v[192:195], v[228:231], v[232:235]
    s_nop 7
    v_permlane32_swap_b32 v232, v234
    v_permlane32_swap_b32 v233, v235
    v_cndmask_b32 v233, v233, v234, s[96:97]
    v_cndmask_b32 v232, v232, v235, s[96:97]
    s_nop 1
    v_add_f32_dpp v236, v233, v232 quad_perm:[1,0,3,2] row_mask:0xf bank_mask:0xf
    s_branch .Lsk_m0_3
.Lst_m0_3:
    s_branch .Lrt_m0_3
.Lsk_m0_3:
    v_cvt_pk_bf16_f32 v236, v236, v236
    v_lshlrev_b32 v236, 16, v236
    v_add_f32 v236, s58, v236
    v_cvt_pk_bf16_f32 v236, v236, v236
    ds_write_b16 v23, v236
    v_mov_b32 v243, s34
    s_waitcnt lgkmcnt(0)
    s_barrier
    ds_read2_b32 v[244:245], v24 offset1:1
    v_mov_b32 v241, s34
    s_waitcnt lgkmcnt(0)
    v_mov_b32 v240, v244
    v_mov_b32 v242, v245
    s_bfm_b64 exec, 32, 0
    buffer_store_dwordx4 v[240:243], v22, s[36:39], s59 offen sc1
    s_mov_b64 exec, -1
    s_add_u32 s63, s69, 32768
    buffer_load_dwordx4 v[96:99], v1, s[40:43], s63 offen nt
    s_add_u32 s63, s69, 40960
    buffer_load_dwordx4 v[100:103], v1, s[40:43], s63 offen nt
    s_add_u32 s63, s69, 49152
    buffer_load_dwordx4 v[128:131], v1, s[40:43], s63 offen nt
    s_add_u32 s63, s69, 57344
    buffer_load_dwordx4 v[132:135], v1, s[40:43], s63 offen nt
    s_waitcnt vmcnt(3)
    s_add_u32 s63, s69, 131072
    buffer_load_dwordx4 v[40:43], v1, s[40:43], s63 offen nt
    s_waitcnt vmcnt(3)
    s_add_u32 s63, s69, 139264
    buffer_load_dwordx4 v[44:47], v1, s[40:43], s63 offen nt
    s_waitcnt vmcnt(3)
    s_add_u32 s63, s69, 147456
    buffer_load_dwordx4 v[72:75], v1, s[40:43], s63 offen nt
    s_waitcnt vmcnt(3)
    s_add_u32 s63, s69, 155648
    buffer_load_dwordx4 v[76:79], v1, s[40:43], s63 offen nt
    s_waitcnt vmcnt(3)
    s_add_u32 s63, s69, 163840
    buffer_load_dwordx4 v[104:107], v1, s[40:43], s63 offen nt
    s_waitcnt vmcnt(3)
    s_add_u32 s63, s69, 172032
    buffer_load_dwordx4 v[108:111], v1, s[40:43], s63 offen nt
    s_waitcnt vmcnt(3)
    s_add_u32 s63, s69, 180224
    buffer_load_dwordx4 v[136:139], v1, s[40:43], s63 offen nt
    s_waitcnt vmcnt(3)
    s_add_u32 s63, s69, 188416
    buffer_load_dwordx4 v[140:143], v1, s[40:43], s63 offen nt
    s_waitcnt vmcnt(3)
    s_add_u32 s63, s69, 262144
    buffer_load_dwordx4 v[48:51], v1, s[40:43], s63 offen nt
    s_waitcnt vmcnt(3)
    s_add_u32 s63, s69, 270336
    buffer_load_dwordx4 v[52:55], v1, s[40:43], s63 offen nt
    s_branch .Le_done
.Lm_rel:
    s_waitcnt vmcnt(4)
    s_bitcmp1_b64 s[14:15], 4
    s_cbranch_scc0 1
    s_waitcnt vmcnt(3)
    s_add_u32 s63, s69, 32768
    buffer_load_dwordx4 v[96:99], v1, s[40:43], s63 offen nt
    s_waitcnt vmcnt(4)
    s_bitcmp1_b64 s[14:15], 5
    s_cbranch_scc0 1
    s_waitcnt vmcnt(3)
    s_add_u32 s63, s69, 40960
    buffer_load_dwordx4 v[100:103], v1, s[40:43], s63 offen nt
    s_waitcnt vmcnt(4)
    s_bitcmp1_b64 s[14:15], 6
    s_cbranch_scc0 1
    s_waitcnt vmcnt(3)
    s_add_u32 s63, s69, 49152
    buffer_load_dwordx4 v[128:131], v1, s[40:43], s63 offen nt
    s_waitcnt vmcnt(4)
    s_bitcmp1_b64 s[14:15], 7
    s_cbranch_scc0 1
    s_waitcnt vmcnt(2)
    s_add_u32 s63, s69, 57344
    buffer_load_dwordx4 v[132:135], v1, s[40:43], s63 offen nt
    s_waitcnt vmcnt(3)
    s_bitcmp1_b64 s[14:15], 8
    s_cbranch_scc0 1
    s_waitcnt vmcnt(2)
    s_add_u32 s63, s69, 131072
    buffer_load_dwordx4 v[40:43], v1, s[40:43], s63 offen nt
    s_waitcnt vmcnt(3)
    s_bitcmp1_b64 s[14:15], 9
    s_cbranch_scc0 1
    s_waitcnt vmcnt(2)
    s_add_u32 s63, s69, 139264
    buffer_load_dwordx4 v[44:47], v1, s[40:43], s63 offen nt
    s_waitcnt lgkmcnt(0)
    s_add_u32 s34, s34, 1
    s_getreg_b32 s1, hwreg(HW_REG_XCC_ID)
    s_lshl_b32 s1, s1, 24
    s_add_u32 s1, s1, s34
    s_lshr_b32 s0, s2, 3
    s_lshl_b32 s63, s64, 8
    s_add_u32 s0, s0, s63
    s_lshl2_add_u32 s0, s0, 0x480000
    v_mov_b32 v30, s1
    s_cmp_eq_u32 s3, 0
    s_cselect_b64 exec, 1, 0
    buffer_store_dword v30, v2, s[36:39], s0 offen sc1
    s_mov_b64 exec, -1
    s_cmp_lt_u32 s99, 54
    s_cbranch_scc1 .Lmr_part
    s_waitcnt vmcnt(4)
    s_bitcmp1_b64 s[14:15], 10
    s_cbranch_scc0 1
    s_waitcnt vmcnt(3)
    s_add_u32 s63, s69, 147456
    buffer_load_dwordx4 v[72:75], v1, s[40:43], s63 offen nt
    s_waitcnt vmcnt(4)
    s_bitcmp1_b64 s[14:15], 11
    s_cbranch_scc0 1
    s_waitcnt vmcnt(3)
    s_add_u32 s63, s69, 155648
    buffer_load_dwordx4 v[76:79], v1, s[40:43], s63 offen nt
    s_waitcnt vmcnt(4)
    s_bitcmp1_b64 s[14:15], 12
    s_cbranch_scc0 1
    s_waitcnt vmcnt(3)
    s_add_u32 s63, s69, 163840
    buffer_load_dwordx4 v[104:107], v1, s[40:43], s63 offen nt
    s_waitcnt vmcnt(4)
    s_bitcmp1_b64 s[14:15], 13
    s_cbranch_scc0 1
    s_waitcnt vmcnt(2)
    s_add_u32 s63, s69, 172032
    buffer_load_dwordx4 v[108:111], v1, s[40:43], s63 offen nt
    s_waitcnt vmcnt(3)
    s_bitcmp1_b64 s[14:15], 14
    s_cbranch_scc0 1
    s_waitcnt vmcnt(2)
    s_add_u32 s63, s69, 180224
    buffer_load_dwordx4 v[136:139], v1, s[40:43], s63 offen nt
    s_waitcnt vmcnt(3)
    s_bitcmp1_b64 s[14:15], 15
    s_cbranch_scc0 1
    s_waitcnt vmcnt(2)
    s_add_u32 s63, s69, 188416
    buffer_load_dwordx4 v[140:143], v1, s[40:43], s63 offen nt
    s_waitcnt vmcnt(3)
    s_bitcmp1_b64 s[14:15], 16
    s_cbranch_scc0 1
    s_waitcnt vmcnt(2)
    s_add_u32 s63, s69, 262144
    buffer_load_dwordx4 v[48:51], v1, s[40:43], s63 offen nt
    s_waitcnt vmcnt(3)
    s_bitcmp1_b64 s[14:15], 17
    s_cbranch_scc0 1
    s_waitcnt vmcnt(2)
    s_add_u32 s63, s69, 270336
    buffer_load_dwordx4 v[52:55], v1, s[40:43], s63 offen nt
    s_branch .Le_done
.Lmr_part:
    s_mul_i32 s58, s3, 1152
    s_mov_b32 s52, s24
    s_and_b32 s53, s25, 0xffff
    s_mov_b32 s54, 0x2400
    s_mov_b32 s55, 0x00020000
    buffer_load_dwordx2 v[246:247], v3, s[52:55], s58 offen
    buffer_load_dwordx2 v[248:249], v3, s[52:55], s58 offen offset:512
    buffer_load_dword v250, v4, s[52:55], s58 offen
    s_mov_b32 s48, s26
    s_and_b32 s49, s27, 0xffff
    s_mov_b32 s50, 0x3cc000
    s_mov_b32 s51, 0x00020000
    v_bfe_u32 v12, v0, 4, 1
    s_and_b32 s56, s3, 3
    s_lshl_b32 s56, s56, 1
    v_or_b32 v12, s56, v12
    v_and_b32 v19, 7, v0
    v_xor_b32 v12, v12, v19
    v_lshrrev_b32 v19, 3, v0
    v_mul_u32_u24 v19, 6912, v19
    v_lshl_add_u32 v19, v12, 4, v19
    s_mul_i32 s57, s3, 55296
    s_lshl_b32 s59, s99, 7
    s_add_u32 s57, s57, s59
    s_add_u32 m0, s100, 0
    s_add_u32 s56, s57, 0
    buffer_load_dwordx4 v19, s[48:51], s56 offen nt lds
    s_add_u32 m0, s100, 8192
    s_add_u32 s56, s57, 442368
    buffer_load_dwordx4 v19, s[48:51], s56 offen nt lds
    s_add_u32 m0, s100, 16384
    s_add_u32 s56, s57, 884736
    s_branch .Lsk_m0_4
.Lst_m0_4:
    s_branch .Lrt_m0_4
.Lsk_m0_4:
    buffer_load_dwordx4 v19, s[48:51], s56 offen nt lds
    s_add_u32 m0, s100, 24576
    s_add_u32 s56, s57, 1327104
    buffer_load_dwordx4 v19, s[48:51], s56 offen nt lds
    s_add_u32 m0, s100, 32768
    s_add_u32 s56, s57, 1769472
    buffer_load_dwordx4 v19, s[48:51], s56 offen nt lds
    s_add_u32 m0, s100, 40960
    s_add_u32 s56, s57, 2211840
    buffer_load_dwordx4 v19, s[48:51], s56 offen nt lds
    s_add_u32 m0, s100, 49152
    s_add_u32 s56, s57, 2654208
    buffer_load_dwordx4 v19, s[48:51], s56 offen nt lds
    s_add_u32 m0, s100, 57344
    s_add_u32 s56, s57, 3096576
    buffer_load_dwordx4 v19, s[48:51], s56 offen nt lds
    s_add_u32 m0, s100, 65536
    s_add_u32 s56, s57, 3538944
    buffer_load_dwordx4 v19, s[48:51], s56 offen nt lds
    v_lshrrev_b32 v12, 4, v0
    v_mul_u32_u24 v12, 18432, v12
    v_and_b32 v13, 15, v0
    v_lshl_add_u32 v22, v13, 4, v12
    s_mul_i32 s57, s99, 57
    s_lshr_b32 s57, s57, 9
    s_mul_i32 s58, s57, 9
    s_sub_u32 s58, s99, s58
    s_mul_i32 s59, s57, 73728
    s_lshl_b32 s58, s58, 8
    s_add_u32 s59, s59, s58
    s_mul_i32 s58, s3, 2304
    s_add_u32 s59, s59, s58
    s_add_u32 s59, s59, 0x1000
    s_mov_b32 s58, 0
    s_cmp_eq_u32 s57, 1
    s_cselect_b32 s58, 1.0, s58
    s_cmp_eq_u32 s57, 4
    s_cselect_b32 s58, 1.0, s58
    s_waitcnt vmcnt(9)
    v_lshlrev_b32 v236, 16, v246
    v_and_b32 v237, 0xffff0000, v246
    v_max_f32 v236, 0xc2ae0000, v236
    v_min_f32 v242, 0x43000000, v236
    v_mul_f32 v238, 0xbfb8aa3b, v242
    v_fma_f32 v240, v242, s98, -v238
    v_fmac_f32 v240, 0xb2a57060, v242
    v_exp_f32 v238, v238
    v_mul_f32 v240, 0x3f317218, v240
    v_fmac_f32 v238, v238, v240
    v_add_f32 v238, 1.0, v238
    v_rcp_f32 v240, v238
    s_nop 0
    v_mul_f32 v242, v236, v240
    v_fma_f32 v238, -v242, v238, v236
    v_fma_f32 v236, v238, v240, v242
    v_max_f32 v237, 0xc2ae0000, v237
    v_min_f32 v243, 0x43000000, v237
    v_mul_f32 v239, 0xbfb8aa3b, v243
    v_fma_f32 v241, v243, s98, -v239
    v_fmac_f32 v241, 0xb2a57060, v243
    v_exp_f32 v239, v239
    v_mul_f32 v241, 0x3f317218, v241
    v_fmac_f32 v239, v239, v241
    v_add_f32 v239, 1.0, v239
    v_rcp_f32 v241, v239
    s_nop 0
    v_mul_f32 v243, v237, v241
    v_fma_f32 v239, -v243, v239, v237
    v_fma_f32 v237, v239, v241, v243
    v_cvt_pk_bf16_f32 v246, v236, v237
    v_lshlrev_b32 v236, 16, v247
    v_and_b32 v237, 0xffff0000, v247
    v_max_f32 v236, 0xc2ae0000, v236
    v_min_f32 v242, 0x43000000, v236
    v_mul_f32 v238, 0xbfb8aa3b, v242
    v_fma_f32 v240, v242, s98, -v238
    v_fmac_f32 v240, 0xb2a57060, v242
    v_exp_f32 v238, v238
    v_mul_f32 v240, 0x3f317218, v240
    v_fmac_f32 v238, v238, v240
    v_add_f32 v238, 1.0, v238
    v_rcp_f32 v240, v238
    s_nop 0
    v_mul_f32 v242, v236, v240
    v_fma_f32 v238, -v242, v238, v236
    v_fma_f32 v236, v238, v240, v242
    v_max_f32 v237, 0xc2ae0000, v237
    v_min_f32 v243, 0x43000000, v237
    v_mul_f32 v239, 0xbfb8aa3b, v243
    v_fma_f32 v241, v243, s98, -v239
    v_fmac_f32 v241, 0xb2a57060, v243
    v_exp_f32 v239, v239
    v_mul_f32 v241, 0x3f317218, v241
    v_fmac_f32 v239, v239, v241
    v_add_f32 v239, 1.0, v239
    v_rcp_f32 v241, v239
    s_nop 0
    v_mul_f32 v243, v237, v241
    v_fma_f32 v239, -v243, v239, v237
    v_fma_f32 v237, v239, v241, v243
    v_cvt_pk_bf16_f32 v247, v236, v237
    v_lshlrev_b32 v236, 16, v248
    v_and_b32 v237, 0xffff0000, v248
    v_max_f32 v236, 0xc2ae0000, v236
    v_min_f32 v242, 0x43000000, v236
    v_mul_f32 v238, 0xbfb8aa3b, v242
    v_fma_f32 v240, v242, s98, -v238
    v_fmac_f32 v240, 0xb2a57060, v242
    v_exp_f32 v238, v238
    v_mul_f32 v240, 0x3f317218, v240
    v_fmac_f32 v238, v238, v240
    v_add_f32 v238, 1.0, v238
    v_rcp_f32 v240, v238
    s_nop 0
    v_mul_f32 v242, v236, v240
    v_fma_f32 v238, -v242, v238, v236
    v_fma_f32 v236, v238, v240, v242
    v_max_f32 v237, 0xc2ae0000, v237
    v_min_f32 v243, 0x43000000, v237
    v_mul_f32 v239, 0xbfb8aa3b, v243
    v_fma_f32 v241, v243, s98, -v239
    v_fmac_f32 v241, 0xb2a57060, v243
    v_exp_f32 v239, v239
    v_mul_f32 v241, 0x3f317218, v241
    v_fmac_f32 v239, v239, v241
    v_add_f32 v239, 1.0, v239
    v_rcp_f32 v241, v239
    s_nop 0
    v_mul_f32 v243, v237, v241
    v_fma_f32 v239, -v243, v239, v237
    v_fma_f32 v237, v239, v241, v243
    v_cvt_pk_bf16_f32 v248, v236, v237
    v_lshlrev_b32 v236, 16, v249
    v_and_b32 v237, 0xffff0000, v249
    v_max_f32 v236, 0xc2ae0000, v236
    v_min_f32 v242, 0x43000000, v236
    v_mul_f32 v238, 0xbfb8aa3b, v242
    v_fma_f32 v240, v242, s98, -v238
    v_fmac_f32 v240, 0xb2a57060, v242
    v_exp_f32 v238, v238
    v_mul_f32 v240, 0x3f317218, v240
    v_fmac_f32 v238, v238, v240
    v_add_f32 v238, 1.0, v238
    v_rcp_f32 v240, v238
    s_nop 0
    v_mul_f32 v242, v236, v240
    v_fma_f32 v238, -v242, v238, v236
    v_fma_f32 v236, v238, v240, v242
    v_max_f32 v237, 0xc2ae0000, v237
    v_min_f32 v243, 0x43000000, v237
    v_mul_f32 v239, 0xbfb8aa3b, v243
    v_fma_f32 v241, v243, s98, -v239
    v_fmac_f32 v241, 0xb2a57060, v243
    v_exp_f32 v239, v239
    v_mul_f32 v241, 0x3f317218, v241
    v_fmac_f32 v239, v239, v241
    v_add_f32 v239, 1.0, v239
    v_rcp_f32 v241, v239
    s_nop 0
    v_mul_f32 v243, v237, v241
    v_fma_f32 v239, -v243, v239, v237
    v_fma_f32 v237, v239, v241, v243
    v_cvt_pk_bf16_f32 v249, v236, v237
    v_lshlrev_b32 v236, 16, v250
    v_and_b32 v237, 0xffff0000, v250
    v_max_f32 v236, 0xc2ae0000, v236
    v_min_f32 v242, 0x43000000, v236
    v_mul_f32 v238, 0xbfb8aa3b, v242
    v_fma_f32 v240, v242, s98, -v238
    s_branch .Lsk_m0_5
.Lst_m0_5:
    s_branch .Lrt_m0_5
.Lsk_m0_5:
    v_fmac_f32 v240, 0xb2a57060, v242
    v_exp_f32 v238, v238
    v_mul_f32 v240, 0x3f317218, v240
    v_fmac_f32 v238, v238, v240
    v_add_f32 v238, 1.0, v238
    v_rcp_f32 v240, v238
    s_nop 0
    v_mul_f32 v242, v236, v240
    v_fma_f32 v238, -v242, v238, v236
    v_fma_f32 v236, v238, v240, v242
    v_max_f32 v237, 0xc2ae0000, v237
    v_min_f32 v243, 0x43000000, v237
    v_mul_f32 v239, 0xbfb8aa3b, v243
    v_fma_f32 v241, v243, s98, -v239
    v_fmac_f32 v241, 0xb2a57060, v243
    v_exp_f32 v239, v239
    v_mul_f32 v241, 0x3f317218, v241
    v_fmac_f32 v239, v239, v241
    v_add_f32 v239, 1.0, v239
    v_rcp_f32 v241, v239
    s_nop 0
    v_mul_f32 v243, v237, v241
    v_fma_f32 v239, -v243, v239, v237
    v_fma_f32 v237, v239, v241, v243
    v_cvt_pk_bf16_f32 v250, v236, v237
    ds_write_b64 v17, v[246:247] offset:0
    ds_write_b64 v17, v[248:249] offset:512
    ds_write_b32 v18, v250 offset:0
    s_waitcnt vmcnt(3)
    s_add_u32 s63, s69, 147456
    buffer_load_dwordx4 v[72:75], v1, s[40:43], s63 offen nt
    s_waitcnt vmcnt(3)
    s_add_u32 s63, s69, 155648
    buffer_load_dwordx4 v[76:79], v1, s[40:43], s63 offen nt
    s_waitcnt vmcnt(3)
    s_add_u32 s63, s69, 163840
    buffer_load_dwordx4 v[104:107], v1, s[40:43], s63 offen nt
    s_waitcnt vmcnt(3)
    s_add_u32 s63, s69, 172032
    buffer_load_dwordx4 v[108:111], v1, s[40:43], s63 offen nt
    s_waitcnt vmcnt(3)
    s_add_u32 s63, s69, 180224
    buffer_load_dwordx4 v[136:139], v1, s[40:43], s63 offen nt
    s_waitcnt vmcnt(3)
    s_add_u32 s63, s69, 188416
    buffer_load_dwordx4 v[140:143], v1, s[40:43], s63 offen nt
    s_waitcnt vmcnt(3)
    s_add_u32 s63, s69, 262144
    buffer_load_dwordx4 v[48:51], v1, s[40:43], s63 offen nt
    s_waitcnt vmcnt(3)
    s_add_u32 s63, s69, 270336
    buffer_load_dwordx4 v[52:55], v1, s[40:43], s63 offen nt
    s_waitcnt lgkmcnt(0)
    s_barrier
    ds_read_b64_tr_b16 v[160:161], v20 offset:0
    ds_read_b64_tr_b16 v[162:163], v20 offset:512
    ds_read_b64_tr_b16 v[164:165], v20 offset:8192
    ds_read_b64_tr_b16 v[166:167], v20 offset:8704
    ds_read_b64_tr_b16 v[168:169], v20 offset:16384
    ds_read_b64_tr_b16 v[170:171], v20 offset:16896
    ds_read_b64_tr_b16 v[172:173], v20 offset:24576
    ds_read_b64_tr_b16 v[174:175], v20 offset:25088
    ds_read_b64_tr_b16 v[176:177], v21 offset:0
    ds_read_b64_tr_b16 v[178:179], v21 offset:512
    ds_read_b64_tr_b16 v[180:181], v21 offset:8192
    ds_read_b64_tr_b16 v[182:183], v21 offset:8704
    ds_read_b64_tr_b16 v[184:185], v21 offset:16384
    ds_read_b64_tr_b16 v[186:187], v21 offset:16896
    ds_read_b64_tr_b16 v[188:189], v21 offset:24576
    ds_read_b64_tr_b16 v[190:191], v21 offset:25088
    ds_read_b64_tr_b16 v[192:193], v21 offset:32768
    ds_read_b64_tr_b16 v[194:195], v21 offset:33280
    ds_read_b128 v[196:199], v16 offset:0
    ds_read_b128 v[200:203], v16 offset:128
    ds_read_b128 v[204:207], v16 offset:256
    ds_read_b128 v[208:211], v16 offset:384
    ds_read_b128 v[212:215], v16 offset:512
    ds_read_b128 v[216:219], v16 offset:640
    ds_read_b128 v[220:223], v16 offset:768
    ds_read_b128 v[224:227], v16 offset:896
    ds_read_b128 v[228:231], v16 offset:1024
    s_waitcnt lgkmcnt(8)
    v_mfma_f32_16x16x32_bf16 v[232:235], v[160:163], v[196:199], 0
    s_waitcnt lgkmcnt(7)
    v_mfma_f32_16x16x32_bf16 v[232:235], v[164:167], v[200:203], v[232:235]
    s_waitcnt lgkmcnt(6)
    v_mfma_f32_16x16x32_bf16 v[232:235], v[168:171], v[204:207], v[232:235]
    s_waitcnt lgkmcnt(5)
    v_mfma_f32_16x16x32_bf16 v[232:235], v[172:175], v[208:211], v[232:235]
    s_waitcnt lgkmcnt(4)
    v_mfma_f32_16x16x32_bf16 v[232:235], v[176:179], v[212:215], v[232:235]
    s_waitcnt lgkmcnt(3)
    v_mfma_f32_16x16x32_bf16 v[232:235], v[180:183], v[216:219], v[232:235]
    s_waitcnt lgkmcnt(2)
    v_mfma_f32_16x16x32_bf16 v[232:235], v[184:187], v[220:223], v[232:235]
    s_waitcnt lgkmcnt(1)
    v_mfma_f32_16x16x32_bf16 v[232:235], v[188:191], v[224:227], v[232:235]
    s_waitcnt lgkmcnt(0)
    v_mfma_f32_16x16x32_bf16 v[232:235], v[192:195], v[228:231], v[232:235]
    s_nop 7
    v_permlane32_swap_b32 v232, v234
    v_permlane32_swap_b32 v233, v235
    v_cndmask_b32 v233, v233, v234, s[96:97]
    v_cndmask_b32 v232, v232, v235, s[96:97]
    s_nop 1
    v_add_f32_dpp v236, v233, v232 quad_perm:[1,0,3,2] row_mask:0xf bank_mask:0xf
    v_cvt_pk_bf16_f32 v236, v236, v236
    v_lshlrev_b32 v236, 16, v236
    v_add_f32 v236, s58, v236
    v_cvt_pk_bf16_f32 v236, v236, v236
    ds_write_b16 v23, v236
    v_mov_b32 v243, s34
    s_waitcnt lgkmcnt(0)
    s_barrier
    ds_read2_b32 v[244:245], v24 offset1:1
    v_mov_b32 v241, s34
    s_waitcnt lgkmcnt(0)
    v_mov_b32 v240, v244
    v_mov_b32 v242, v245
    s_bfm_b64 exec, 16, 0
    buffer_store_dwordx4 v[240:243], v22, s[36:39], s59 offen sc1
    s_mov_b64 exec, -1
.Le_done:
    v_and_b32 v8, 1, v0
    v_lshlrev_b32 v8, 8, v8
    v_and_b32 v9, 0x3c, v0
    v_lshl_add_u32 v9, v9, 2, v8
    v_add_u32 v7, v9, v8
    v_and_b32 v9, 0x3c, v0
    v_lshrrev_b32 v8, 4, v8
    v_and_b32 v9, 4, v0
    v_lshl_add_u32 v9, v9, 3, v8
    s_lshl_b32 s58, s66, 14
    s_lshl_b32 s59, s67, 10
    s_add_u32 s58, s58, s59
    s_add_u32 s58, s58, 0x70000
    s_lshl4_add_u32 s59, s66, s67
    s_lshl_b32 s59, s59, 7
    s_add_u32 s59, s59, 0x430000
    s_waitcnt vmcnt(3)
    s_bitcmp1_b64 s[14:15], 18
    s_cbranch_scc0 1
    s_waitcnt vmcnt(2)
    s_add_u32 s63, s69, 278528
    buffer_load_dwordx4 v[80:83], v1, s[40:43], s63 offen nt
    v_and_b32 v157, 7, v0
    v_lshlrev_b32 v157, 2, v157
    s_mov_b32 s63, 0x4a1000
    buffer_load_dword v156, v157, s[36:39], s63 offen
    s_cmp_eq_u32 s3, 0
    s_cbranch_scc1 .Lst_m1_0
    s_cmp_eq_u32 s3, 1
    s_cbranch_scc1 .Lst_m1_1
    s_cmp_eq_u32 s3, 2
    s_cbranch_scc1 .Lst_m1_2
    s_cmp_eq_u32 s3, 3
    s_cbranch_scc1 .Lst_m1_3
    s_cmp_eq_u32 s3, 4
    s_cbranch_scc1 .Lst_m1_4
    s_cmp_eq_u32 s3, 5
    s_cbranch_scc1 .Lst_m1_5
    s_cmp_eq_u32 s3, 6
    s_cbranch_scc1 .Lst_m1_6
    s_cmp_eq_u32 s3, 7
    s_cbranch_scc1 .Lst_m1_7
.Lrt_m1_0:
.Lrt_m1_1:
.Lrt_m1_2:
.Lrt_m1_3:
.Lrt_m1_4:
.Lrt_m1_5:
.Lrt_m1_6:
.Lrt_m1_7:
    s_memrealtime s[8:9]
    s_waitcnt lgkmcnt(0)
    s_sub_u32 s8, s8, s30
    s_cmpk_ge_u32 s8, 912
    s_cbranch_scc1 .ap_53
    s_waitcnt vmcnt(5)
    s_cmpk_ge_u32 s8, 812
    s_cbranch_scc1 .ap_53
    s_waitcnt vmcnt(4)
    s_bitcmp1_b64 s[14:15], 19
    s_cbranch_scc0 1
    s_waitcnt vmcnt(3)
    s_cmpk_ge_u32 s8, 692
    s_cbranch_scc1 .ap_53
    s_waitcnt vmcnt(2)
.ap_53:
    s_add_u32 s63, s69, 286720
    buffer_load_dwordx4 v[84:87], v1, s[40:43], s63 offen nt
    s_memrealtime s[8:9]
    s_waitcnt lgkmcnt(0)
    s_sub_u32 s8, s8, s30
    s_cmpk_ge_u32 s8, 957
    s_cbranch_scc1 .ap_54
    s_waitcnt vmcnt(6)
    s_cmpk_ge_u32 s8, 857
    s_cbranch_scc1 .ap_54
    s_waitcnt vmcnt(4)
    s_bitcmp1_b64 s[14:15], 20
    s_cbranch_scc0 1
    s_waitcnt vmcnt(3)
    s_cmpk_ge_u32 s8, 737
    s_cbranch_scc1 .ap_54
    s_waitcnt vmcnt(2)
.ap_54:
    s_add_u32 s63, s69, 294912
    buffer_load_dwordx4 v[112:115], v1, s[40:43], s63 offen nt
    s_memrealtime s[8:9]
    s_waitcnt lgkmcnt(0)
    s_sub_u32 s8, s8, s30
    s_cmpk_ge_u32 s8, 1002
    s_cbranch_scc1 .ap_55
    s_waitcnt vmcnt(6)
    s_cmpk_ge_u32 s8, 902
    s_cbranch_scc1 .ap_55
    s_waitcnt vmcnt(4)
    s_bitcmp1_b64 s[14:15], 21
    s_cbranch_scc0 1
    s_waitcnt vmcnt(3)
    s_cmpk_ge_u32 s8, 782
    s_cbranch_scc1 .ap_55
    s_waitcnt vmcnt(1)
.ap_55:
    s_add_u32 s63, s69, 303104
    buffer_load_dwordx4 v[116:119], v1, s[40:43], s63 offen nt
    s_memrealtime s[8:9]
    s_waitcnt lgkmcnt(0)
    s_sub_u32 s8, s8, s30
    s_cmpk_ge_u32 s8, 1048
    s_cbranch_scc1 .ap_56
    s_waitcnt vmcnt(6)
    s_cmpk_ge_u32 s8, 948
    s_cbranch_scc1 .ap_56
    s_waitcnt vmcnt(4)
    s_bitcmp1_b64 s[14:15], 22
    s_cbranch_scc0 1
    s_waitcnt vmcnt(2)
    s_cmpk_ge_u32 s8, 828
    s_cbranch_scc1 .ap_56
    s_waitcnt vmcnt(1)
.ap_56:
    s_add_u32 s63, s69, 311296
    buffer_load_dwordx4 v[144:147], v1, s[40:43], s63 offen nt
    s_waitcnt vmcnt(4)
    s_sub_u32 s63, s70, 300
    v_subrev_u32 v156, s63, v156
    v_mov_b32 v157, 600
    v_cmp_lt_u32 s[8:9], v156, v157
    v_add_u32_dpp v156, v156, v156 quad_perm:[1,0,3,2] row_mask:0xf bank_mask:0xf
    s_nop 1
    v_add_u32_dpp v156, v156, v156 quad_perm:[2,3,0,1] row_mask:0xf bank_mask:0xf
    s_nop 1
    v_add_u32_dpp v156, v156, v156 row_ror:4 row_mask:0xf bank_mask:0xf
    s_nop 0
    v_readfirstlane_b32 s63, v156
    s_cmp_eq_u64 s[8:9], -1
    s_nop 3
    s_cbranch_scc0 .et_57
    s_lshr_b32 s63, s63, 3
    s_sub_u32 s63, s63, 300
    s_add_u32 s30, s30, s63
    s_add_u32 s31, s31, s63
.et_57:
    s_memrealtime s[8:9]
    s_waitcnt lgkmcnt(0)
    s_sub_u32 s8, s8, s30
    s_cmpk_ge_u32 s8, 1093
    s_cbranch_scc1 .ap_58
    s_waitcnt vmcnt(4)
    s_cmpk_ge_u32 s8, 993
    s_cbranch_scc1 .ap_58
    s_waitcnt vmcnt(3)
    s_bitcmp1_b64 s[14:15], 23
    s_cbranch_scc0 1
    s_waitcnt vmcnt(2)
    s_cmpk_ge_u32 s8, 873
    s_cbranch_scc1 .ap_58
    s_waitcnt vmcnt(1)
.ap_58:
    s_add_u32 s63, s69, 319488
    buffer_load_dwordx4 v[148:151], v1, s[40:43], s63 offen nt
    s_memrealtime s[8:9]
    s_waitcnt lgkmcnt(0)
    s_sub_u32 s8, s8, s30
    s_cmpk_ge_u32 s8, 1138
    s_cbranch_scc1 .ap_59
    s_waitcnt vmcnt(5)
    s_cmpk_ge_u32 s8, 1038
    s_cbranch_scc1 .ap_59
    s_waitcnt vmcnt(3)
    s_bitcmp1_b64 s[14:15], 24
    s_cbranch_scc0 1
    s_waitcnt vmcnt(2)
    s_cmpk_ge_u32 s8, 918
    s_cbranch_scc1 .ap_59
    s_waitcnt vmcnt(1)
.ap_59:
    s_add_u32 s63, s69, 393216
    buffer_load_dwordx4 v[56:59], v1, s[40:43], s63 offen nt
    s_memrealtime s[8:9]
    s_waitcnt lgkmcnt(0)
    s_sub_u32 s8, s8, s30
    s_cmpk_ge_u32 s8, 1184
    s_cbranch_scc1 .ap_60
    s_waitcnt vmcnt(5)
    s_cmpk_ge_u32 s8, 1084
    s_cbranch_scc1 .ap_60
    s_waitcnt vmcnt(3)
    s_bitcmp1_b64 s[14:15], 25
    s_cbranch_scc0 1
    s_waitcnt vmcnt(2)
    s_cmpk_ge_u32 s8, 964
    s_cbranch_scc1 .ap_60
    s_waitcnt vmcnt(1)
.ap_60:
    s_add_u32 s63, s69, 401408
    buffer_load_dwordx4 v[60:63], v1, s[40:43], s63 offen nt
    s_memrealtime s[8:9]
    s_waitcnt lgkmcnt(0)
    s_sub_u32 s8, s8, s30
    s_cmpk_ge_u32 s8, 1211
    s_cbranch_scc1 .ap_61
    s_waitcnt vmcnt(5)
    s_cmpk_ge_u32 s8, 1111
    s_cbranch_scc1 .ap_61
    s_waitcnt vmcnt(3)
    s_bitcmp1_b64 s[14:15], 26
    s_cbranch_scc0 1
    s_waitcnt vmcnt(2)
    s_cmpk_ge_u32 s8, 991
    s_cbranch_scc1 .ap_61
    s_waitcnt vmcnt(1)
.ap_61:
    s_add_u32 s63, s69, 409600
    buffer_load_dwordx4 v[88:91], v1, s[40:43], s63 offen nt
    s_memrealtime s[8:9]
    s_waitcnt lgkmcnt(0)
    s_sub_u32 s8, s8, s30
    s_cmpk_ge_u32 s8, 1238
    s_cbranch_scc1 .ap_62
    s_waitcnt vmcnt(5)
    s_cmpk_ge_u32 s8, 1138
    s_cbranch_scc1 .ap_62
    s_waitcnt vmcnt(3)
    s_bitcmp1_b64 s[14:15], 27
    s_cbranch_scc0 1
    s_waitcnt vmcnt(2)
    s_cmpk_ge_u32 s8, 1018
    s_cbranch_scc1 .ap_62
    s_waitcnt vmcnt(1)
.ap_62:
    s_add_u32 s63, s69, 417792
    buffer_load_dwordx4 v[92:95], v1, s[40:43], s63 offen nt
    s_memrealtime s[8:9]
    s_waitcnt vmcnt(8)
    s_waitcnt lgkmcnt(0)
    s_sub_u32 s8, s8, s30
    s_cmpk_ge_u32 s8, 1265
    s_cbranch_scc1 .ap_63
    s_branch .Lsk_m1_0
.Lst_m1_0:
    s_branch .Lrt_m1_0
.Lsk_m1_0:
    s_waitcnt vmcnt(5)
    s_cmpk_ge_u32 s8, 1165
    s_cbranch_scc1 .ap_63
    s_waitcnt vmcnt(3)
    s_bitcmp1_b64 s[14:15], 28
    s_cbranch_scc0 1
    s_waitcnt vmcnt(2)
    s_cmpk_ge_u32 s8, 1045
    s_cbranch_scc1 .ap_63
    s_waitcnt vmcnt(1)
.ap_63:
    s_add_u32 s63, s69, 425984
    buffer_load_dwordx4 v[120:123], v1, s[40:43], s63 offen nt
    s_branch .Lsk_m1_1
.Lst_m1_1:
    s_branch .Lrt_m1_1
.Lsk_m1_1:
    s_memrealtime s[8:9]
    s_waitcnt vmcnt(8)
    s_waitcnt lgkmcnt(0)
    s_sub_u32 s8, s8, s30
    s_cmpk_ge_u32 s8, 1292
    s_cbranch_scc1 .ap_64
    s_waitcnt vmcnt(5)
    s_cmpk_ge_u32 s8, 1192
    s_cbranch_scc1 .ap_64
    s_waitcnt vmcnt(3)
    s_bitcmp1_b64 s[14:15], 29
    s_cbranch_scc0 1
    s_waitcnt vmcnt(2)
    s_cmpk_ge_u32 s8, 1072
    s_cbranch_scc1 .ap_64
    s_waitcnt vmcnt(1)
.ap_64:
    s_add_u32 s63, s69, 434176
    buffer_load_dwordx4 v[124:127], v1, s[40:43], s63 offen nt
    s_memrealtime s[8:9]
    s_waitcnt vmcnt(8)
    s_waitcnt lgkmcnt(0)
    s_sub_u32 s8, s8, s30
    s_cmpk_ge_u32 s8, 1320
    s_cbranch_scc1 .ap_65
    s_waitcnt vmcnt(5)
    s_cmpk_ge_u32 s8, 1220
    s_cbranch_scc1 .ap_65
    s_waitcnt vmcnt(3)
    s_bitcmp1_b64 s[14:15], 30
    s_cbranch_scc0 1
    s_waitcnt vmcnt(2)
    s_cmpk_ge_u32 s8, 1100
    s_cbranch_scc1 .ap_65
    s_waitcnt vmcnt(1)
.ap_65:
    s_add_u32 s63, s69, 442368
    buffer_load_dwordx4 v[152:155], v1, s[40:43], s63 offen nt
    s_memrealtime s[8:9]
    s_waitcnt vmcnt(8)
    s_waitcnt lgkmcnt(0)
    s_sub_u32 s8, s8, s30
    s_cmpk_ge_u32 s8, 1347
    s_cbranch_scc1 .ap_66
    s_waitcnt vmcnt(5)
    s_cmpk_ge_u32 s8, 1247
    s_cbranch_scc1 .ap_66
    s_waitcnt vmcnt(3)
    s_bitcmp1_b64 s[14:15], 31
    s_cbranch_scc0 1
    s_waitcnt vmcnt(2)
    s_cmpk_ge_u32 s8, 1127
    s_cbranch_scc1 .ap_66
    s_waitcnt vmcnt(1)
.ap_66:
    s_add_u32 s63, s69, 450560
    buffer_load_dwordx4 v[156:159], v1, s[40:43], s63 offen nt
    s_memrealtime s[8:9]
    s_waitcnt vmcnt(8)
    s_waitcnt lgkmcnt(0)
    s_sub_u32 s8, s8, s30
    s_cmpk_ge_u32 s8, 1374
    s_cbranch_scc1 .ap_67
    s_waitcnt vmcnt(5)
    s_cmpk_ge_u32 s8, 1274
    s_cbranch_scc1 .ap_67
    s_waitcnt vmcnt(3)
    s_bitcmp1_b64 s[14:15], 32
    s_cbranch_scc0 1
    s_waitcnt vmcnt(2)
    s_cmpk_ge_u32 s8, 1154
    s_cbranch_scc1 .ap_67
    s_waitcnt vmcnt(1)
.ap_67:
    v_bfe_u32 v1, v0, 4, 2
    v_and_b32 v10, 0xf0, v2
    v_lshlrev_b32 v1, 2, v1
    v_bfe_u32 v1, s6, v1, 4
    v_lshl_add_u32 v1, v1, 8, v10
    s_add_u32 s63, s69, 0
    buffer_load_dwordx4 v[160:163], v1, s[44:47], s63 offen nt
    s_memrealtime s[8:9]
    s_waitcnt vmcnt(8)
    s_waitcnt lgkmcnt(0)
    s_sub_u32 s8, s8, s30
    s_cmpk_ge_u32 s8, 1401
    s_cbranch_scc1 .ap_68
    s_waitcnt vmcnt(5)
    s_cmpk_ge_u32 s8, 1301
    s_cbranch_scc1 .ap_68
    s_waitcnt vmcnt(3)
    s_bitcmp1_b64 s[14:15], 33
    s_cbranch_scc0 1
    s_waitcnt vmcnt(2)
    s_cmpk_ge_u32 s8, 1181
    s_cbranch_scc1 .ap_68
    s_waitcnt vmcnt(1)
.ap_68:
    s_add_u32 s63, s69, 8192
    buffer_load_dwordx4 v[164:167], v1, s[44:47], s63 offen nt
    s_memrealtime s[8:9]
    s_waitcnt vmcnt(8)
    s_waitcnt lgkmcnt(0)
    s_sub_u32 s8, s8, s30
    s_cmpk_ge_u32 s8, 1428
    s_cbranch_scc1 .ap_69
    s_waitcnt vmcnt(5)
    s_cmpk_ge_u32 s8, 1328
    s_cbranch_scc1 .ap_69
    s_waitcnt vmcnt(3)
    s_bitcmp1_b64 s[14:15], 34
    s_cbranch_scc0 1
    s_waitcnt vmcnt(2)
    s_cmpk_ge_u32 s8, 1208
    s_cbranch_scc1 .ap_69
    s_waitcnt vmcnt(1)
.ap_69:
    s_add_u32 s63, s69, 16384
    buffer_load_dwordx4 v[168:171], v1, s[44:47], s63 offen nt
    s_memrealtime s[8:9]
    s_waitcnt vmcnt(8)
    s_waitcnt lgkmcnt(0)
    s_sub_u32 s8, s8, s30
    s_cmpk_ge_u32 s8, 1456
    s_cbranch_scc1 .ap_70
    s_waitcnt vmcnt(5)
    s_cmpk_ge_u32 s8, 1356
    s_cbranch_scc1 .ap_70
    s_waitcnt vmcnt(3)
    s_bitcmp1_b64 s[14:15], 35
    s_cbranch_scc0 1
    s_waitcnt vmcnt(2)
    s_cmpk_ge_u32 s8, 1236
    s_cbranch_scc1 .ap_70
    s_waitcnt vmcnt(1)
.ap_70:
    s_add_u32 s63, s69, 24576
    buffer_load_dwordx4 v[172:175], v1, s[44:47], s63 offen nt
    buffer_load_dwordx4 v[16:19], v7, s[36:39], s58 offen offset:0 sc1
    buffer_load_dwordx4 v[20:23], v7, s[36:39], s58 offen offset:256 sc1
    s_memrealtime s[8:9]
    s_waitcnt vmcnt(8)
    s_waitcnt lgkmcnt(0)
    s_sub_u32 s8, s8, s30
    s_cmpk_ge_u32 s8, 1486
    s_cbranch_scc1 .ap_71
    s_waitcnt vmcnt(5)
    s_cmpk_ge_u32 s8, 1386
    s_cbranch_scc1 .ap_71
    s_waitcnt vmcnt(3)
    s_bitcmp1_b64 s[14:15], 36
    s_cbranch_scc0 1
    s_waitcnt vmcnt(2)
    s_cmpk_ge_u32 s8, 1266
    s_cbranch_scc1 .ap_71
    s_waitcnt vmcnt(1)
.ap_71:
    s_add_u32 s63, s69, 32768
    buffer_load_dwordx4 v[176:179], v1, s[44:47], s63 offen nt
    s_memrealtime s[8:9]
    s_waitcnt vmcnt(8)
    s_waitcnt lgkmcnt(0)
    s_sub_u32 s8, s8, s30
    s_cmpk_ge_u32 s8, 1516
    s_cbranch_scc1 .ap_72
    s_waitcnt vmcnt(5)
    s_cmpk_ge_u32 s8, 1416
    s_cbranch_scc1 .ap_72
    s_waitcnt vmcnt(3)
    s_bitcmp1_b64 s[14:15], 37
    s_cbranch_scc0 1
    s_waitcnt vmcnt(2)
    s_cmpk_ge_u32 s8, 1296
    s_cbranch_scc1 .ap_72
    s_waitcnt vmcnt(1)
.ap_72:
    s_add_u32 s63, s69, 40960
    buffer_load_dwordx4 v[180:183], v1, s[44:47], s63 offen nt
    s_memrealtime s[8:9]
    s_waitcnt vmcnt(8)
    s_waitcnt lgkmcnt(0)
    s_sub_u32 s8, s8, s30
    s_cmpk_ge_u32 s8, 1546
    s_cbranch_scc1 .ap_73
    s_waitcnt vmcnt(5)
    s_cmpk_ge_u32 s8, 1446
    s_cbranch_scc1 .ap_73
    s_waitcnt vmcnt(3)
    s_bitcmp1_b64 s[14:15], 38
    s_cbranch_scc0 1
    s_waitcnt vmcnt(2)
    s_cmpk_ge_u32 s8, 1326
    s_cbranch_scc1 .ap_73
    s_waitcnt vmcnt(1)
.ap_73:
    s_add_u32 s63, s69, 49152
    buffer_load_dwordx4 v[184:187], v1, s[44:47], s63 offen nt
    s_waitcnt vmcnt(3)
    s_branch .gpc_75
.gp_74:
    buffer_load_dwordx4 v[16:19], v7, s[36:39], s58 offen offset:0 sc1
    buffer_load_dwordx4 v[20:23], v7, s[36:39], s58 offen offset:256 sc1
    s_waitcnt vmcnt(0)
.gpc_75:
    v_min_u32 v10, v17, v19
    v_max_u32 v11, v17, v19
    v_min3_u32 v10, v10, v21, v23
    v_max3_u32 v11, v11, v21, v23
    v_cmp_eq_u32 vcc, s34, v10
    v_cmp_eq_u32 s[56:57], s34, v11
    s_and_b64 vcc, vcc, s[56:57]
    s_cmp_eq_u64 vcc, -1
    s_nop 2
    s_cbranch_scc1 .gpd_76
    s_sub_u32 s35, s35, 1
    s_cbranch_scc1 .Lexit
    s_sleep 1
    s_branch .gp_74
.gpd_76:
    s_mov_b32 vcc_lo, 0xcccccccc
    s_mov_b32 vcc_hi, 0xcccccccc
    v_cndmask_b32_e64 v24, v16, 0, vcc
    v_cndmask_b32_e64 v25, v18, 0, vcc
    v_cndmask_b32_e64 v26, v20, 0, vcc
    v_cndmask_b32_e64 v27, v22, 0, vcc
    v_cndmask_b32_e32 v28, 0, v16, vcc
    v_cndmask_b32_e32 v29, 0, v18, vcc
    v_cndmask_b32_e32 v30, 0, v20, vcc
    v_cndmask_b32_e32 v31, 0, v22, vcc
    v_mfma_f32_16x16x32_bf16 v[16:19], v[32:35], v[24:27], 0
    v_mfma_f32_16x16x32_bf16 v[32:35], v[40:43], v[24:27], 0
    v_mfma_f32_16x16x32_bf16 v[16:19], v[36:39], v[28:31], v[16:19]
    v_mfma_f32_16x16x32_bf16 v[40:43], v[48:51], v[24:27], 0
    s_branch .Lsk_m1_2
.Lst_m1_2:
    s_branch .Lrt_m1_2
.Lsk_m1_2:
    v_mfma_f32_16x16x32_bf16 v[32:35], v[44:47], v[28:31], v[32:35]
    v_mfma_f32_16x16x32_bf16 v[48:51], v[56:59], v[24:27], 0
    v_mfma_f32_16x16x32_bf16 v[40:43], v[52:55], v[28:31], v[40:43]
    v_mfma_f32_16x16x32_bf16 v[56:59], v[64:67], v[24:27], 0
    v_mfma_f32_16x16x32_bf16 v[48:51], v[60:63], v[28:31], v[48:51]
    s_nop 1
    v_add_f32_dpp v10, v17, v16 row_ror:12 row_mask:0xf bank_mask:0x1
    s_memrealtime s[8:9]
    s_waitcnt lgkmcnt(0)
    s_sub_u32 s8, s8, s30
    s_cmpk_ge_u32 s8, 1576
    s_nop 0
    s_cbranch_scc1 .ap_77
    s_waitcnt vmcnt(3)
    s_cmpk_ge_u32 s8, 1476
    s_cbranch_scc1 .ap_77
    s_waitcnt vmcnt(3)
    s_bitcmp1_b64 s[14:15], 39
    s_cbranch_scc0 1
    s_waitcnt vmcnt(2)
    s_cmpk_ge_u32 s8, 1356
    s_cbranch_scc1 .ap_77
    s_waitcnt vmcnt(1)
.ap_77:
    s_add_u32 s63, s69, 57344
    buffer_load_dwordx4 v[188:191], v1, s[44:47], s63 offen nt
    v_mfma_f32_16x16x32_bf16 v[64:67], v[72:75], v[24:27], 0
    v_mfma_f32_16x16x32_bf16 v[56:59], v[68:71], v[28:31], v[56:59]
    v_add_f32_dpp v11, v33, v32 row_ror:12 row_mask:0xf bank_mask:0x1
    v_add_f32_dpp v10, v18, v10 row_ror:8 row_mask:0xf bank_mask:0x1
    v_mfma_f32_16x16x32_bf16 v[72:75], v[80:83], v[24:27], 0
    v_mfma_f32_16x16x32_bf16 v[64:67], v[76:79], v[28:31], v[64:67]
    v_add_f32_dpp v12, v41, v40 row_ror:12 row_mask:0xf bank_mask:0x1
    v_add_f32_dpp v11, v34, v11 row_ror:8 row_mask:0xf bank_mask:0x1
    v_add_f32_dpp v10, v19, v10 row_ror:4 row_mask:0xf bank_mask:0x1
    v_mfma_f32_16x16x32_bf16 v[80:83], v[88:91], v[24:27], 0
    v_mfma_f32_16x16x32_bf16 v[72:75], v[84:87], v[28:31], v[72:75]
    v_add_f32_dpp v13, v49, v48 row_ror:12 row_mask:0xf bank_mask:0x1
    v_add_f32_dpp v12, v42, v12 row_ror:8 row_mask:0xf bank_mask:0x1
    v_add_f32_dpp v11, v35, v11 row_ror:4 row_mask:0xf bank_mask:0x1
    v_mfma_f32_16x16x32_bf16 v[88:91], v[96:99], v[24:27], 0
    v_mfma_f32_16x16x32_bf16 v[80:83], v[92:95], v[28:31], v[80:83]
    v_add_f32_dpp v10, v58, v57 row_ror:12 row_mask:0xf bank_mask:0x2
    v_add_f32_dpp v13, v50, v13 row_ror:8 row_mask:0xf bank_mask:0x1
    v_add_f32_dpp v12, v43, v12 row_ror:4 row_mask:0xf bank_mask:0x1
    s_memrealtime s[8:9]
    s_waitcnt lgkmcnt(0)
    s_sub_u32 s8, s8, s30
    s_cmpk_ge_u32 s8, 1606
    s_nop 0
    s_cbranch_scc1 .ap_78
    s_waitcnt vmcnt(4)
    s_cmpk_ge_u32 s8, 1506
    s_cbranch_scc1 .ap_78
    s_waitcnt vmcnt(3)
    s_bitcmp1_b64 s[14:15], 40
    s_cbranch_scc0 1
    s_waitcnt vmcnt(2)
    s_cmpk_ge_u32 s8, 1386
    s_cbranch_scc1 .ap_78
    s_waitcnt vmcnt(1)
.ap_78:
    s_add_u32 s63, s69, 131072
    buffer_load_dwordx4 v[192:195], v1, s[44:47], s63 offen nt
    v_mfma_f32_16x16x32_bf16 v[96:99], v[104:107], v[24:27], 0
    v_mfma_f32_16x16x32_bf16 v[88:91], v[100:103], v[28:31], v[88:91]
    v_add_f32_dpp v11, v66, v65 row_ror:12 row_mask:0xf bank_mask:0x2
    v_add_f32_dpp v10, v59, v10 row_ror:8 row_mask:0xf bank_mask:0x2
    v_add_f32_dpp v13, v51, v13 row_ror:4 row_mask:0xf bank_mask:0x1
    v_mfma_f32_16x16x32_bf16 v[104:107], v[112:115], v[24:27], 0
    v_mfma_f32_16x16x32_bf16 v[96:99], v[108:111], v[28:31], v[96:99]
    v_add_f32_dpp v12, v74, v73 row_ror:12 row_mask:0xf bank_mask:0x2
    v_add_f32_dpp v11, v67, v11 row_ror:8 row_mask:0xf bank_mask:0x2
    v_add_f32_dpp v10, v56, v10 row_ror:4 row_mask:0xf bank_mask:0x2
    v_mfma_f32_16x16x32_bf16 v[112:115], v[120:123], v[24:27], 0
    v_mfma_f32_16x16x32_bf16 v[104:107], v[116:119], v[28:31], v[104:107]
    v_add_f32_dpp v13, v82, v81 row_ror:12 row_mask:0xf bank_mask:0x2
    v_add_f32_dpp v12, v75, v12 row_ror:8 row_mask:0xf bank_mask:0x2
    v_add_f32_dpp v11, v64, v11 row_ror:4 row_mask:0xf bank_mask:0x2
    v_mfma_f32_16x16x32_bf16 v[120:123], v[128:131], v[24:27], 0
    v_mfma_f32_16x16x32_bf16 v[112:115], v[124:127], v[28:31], v[112:115]
    v_add_f32_dpp v10, v91, v90 row_ror:12 row_mask:0xf bank_mask:0x4
    v_add_f32_dpp v13, v83, v13 row_ror:8 row_mask:0xf bank_mask:0x2
    v_add_f32_dpp v12, v72, v12 row_ror:4 row_mask:0xf bank_mask:0x2
    s_memrealtime s[8:9]
    s_waitcnt lgkmcnt(0)
    s_sub_u32 s8, s8, s30
    s_cmpk_ge_u32 s8, 1636
    s_nop 0
    s_cbranch_scc1 .ap_79
    s_waitcnt vmcnt(5)
    s_cmpk_ge_u32 s8, 1536
    s_cbranch_scc1 .ap_79
    s_waitcnt vmcnt(3)
    s_bitcmp1_b64 s[14:15], 41
    s_cbranch_scc0 1
    s_waitcnt vmcnt(2)
    s_cmpk_ge_u32 s8, 1416
    s_cbranch_scc1 .ap_79
    s_waitcnt vmcnt(1)
.ap_79:
    s_add_u32 s63, s69, 139264
    buffer_load_dwordx4 v[196:199], v1, s[44:47], s63 offen nt
    v_mfma_f32_16x16x32_bf16 v[128:131], v[136:139], v[24:27], 0
    v_mfma_f32_16x16x32_bf16 v[120:123], v[132:135], v[28:31], v[120:123]
    v_add_f32_dpp v11, v99, v98 row_ror:12 row_mask:0xf bank_mask:0x4
    v_add_f32_dpp v10, v88, v10 row_ror:8 row_mask:0xf bank_mask:0x4
    v_add_f32_dpp v13, v80, v13 row_ror:4 row_mask:0xf bank_mask:0x2
    v_mfma_f32_16x16x32_bf16 v[136:139], v[144:147], v[24:27], 0
    v_mfma_f32_16x16x32_bf16 v[128:131], v[140:143], v[28:31], v[128:131]
    v_add_f32_dpp v12, v107, v106 row_ror:12 row_mask:0xf bank_mask:0x4
    v_add_f32_dpp v11, v96, v11 row_ror:8 row_mask:0xf bank_mask:0x4
    v_add_f32_dpp v10, v89, v10 row_ror:4 row_mask:0xf bank_mask:0x4
    v_mfma_f32_16x16x32_bf16 v[144:147], v[152:155], v[24:27], 0
    v_mfma_f32_16x16x32_bf16 v[136:139], v[148:151], v[28:31], v[136:139]
    v_add_f32_dpp v13, v115, v114 row_ror:12 row_mask:0xf bank_mask:0x4
    v_add_f32_dpp v12, v104, v12 row_ror:8 row_mask:0xf bank_mask:0x4
    v_add_f32_dpp v11, v97, v11 row_ror:4 row_mask:0xf bank_mask:0x4
    v_mfma_f32_16x16x32_bf16 v[144:147], v[156:159], v[28:31], v[144:147]
    v_add_f32_dpp v10, v120, v123 row_ror:12 row_mask:0xf bank_mask:0x8
    v_add_f32_dpp v13, v112, v13 row_ror:8 row_mask:0xf bank_mask:0x4
    v_add_f32_dpp v12, v105, v12 row_ror:4 row_mask:0xf bank_mask:0x4
    s_memrealtime s[8:9]
    s_waitcnt lgkmcnt(0)
    s_sub_u32 s8, s8, s30
    s_cmpk_ge_u32 s8, 1666
    s_nop 0
    s_cbranch_scc1 .ap_80
    s_waitcnt vmcnt(5)
    s_cmpk_ge_u32 s8, 1566
    s_cbranch_scc1 .ap_80
    s_waitcnt vmcnt(3)
    s_bitcmp1_b64 s[14:15], 42
    s_cbranch_scc0 1
    s_waitcnt vmcnt(2)
    s_cmpk_ge_u32 s8, 1446
    s_cbranch_scc1 .ap_80
    s_waitcnt vmcnt(1)
.ap_80:
    s_add_u32 s63, s69, 147456
    buffer_load_dwordx4 v[200:203], v1, s[44:47], s63 offen nt
    v_add_f32_dpp v11, v128, v131 row_ror:12 row_mask:0xf bank_mask:0x8
    v_add_f32_dpp v10, v121, v10 row_ror:8 row_mask:0xf bank_mask:0x8
    v_add_f32_dpp v13, v113, v13 row_ror:4 row_mask:0xf bank_mask:0x4
    v_add_f32_dpp v12, v136, v139 row_ror:12 row_mask:0xf bank_mask:0x8
    v_add_f32_dpp v11, v129, v11 row_ror:8 row_mask:0xf bank_mask:0x8
    v_add_f32_dpp v10, v122, v10 row_ror:4 row_mask:0xf bank_mask:0x8
    v_add_f32_dpp v13, v144, v147 row_ror:12 row_mask:0xf bank_mask:0x8
    v_add_f32_dpp v12, v137, v12 row_ror:8 row_mask:0xf bank_mask:0x8
    v_add_f32_dpp v11, v130, v11 row_ror:4 row_mask:0xf bank_mask:0x8
    v_add_f32_dpp v13, v145, v13 row_ror:8 row_mask:0xf bank_mask:0x8
    v_add_f32_dpp v12, v138, v12 row_ror:4 row_mask:0xf bank_mask:0x8
    s_memrealtime s[8:9]
    s_waitcnt lgkmcnt(0)
    s_sub_u32 s8, s8, s30
    s_cmpk_ge_u32 s8, 1696
    s_cbranch_scc1 .ap_81
    s_waitcnt vmcnt(5)
    s_cmpk_ge_u32 s8, 1596
    s_cbranch_scc1 .ap_81
    s_waitcnt vmcnt(3)
    s_bitcmp1_b64 s[14:15], 43
    s_cbranch_scc0 1
    s_waitcnt vmcnt(2)
    s_cmpk_ge_u32 s8, 1476
    s_cbranch_scc1 .ap_81
    s_waitcnt vmcnt(1)
.ap_81:
    s_add_u32 s63, s69, 155648
    buffer_load_dwordx4 v[204:207], v1, s[44:47], s63 offen nt
    v_add_f32_dpp v13, v146, v13 row_ror:4 row_mask:0xf bank_mask:0x8
    s_mov_b32 s60, 0x3db504f3
    s_mov_b32 s61, 0x3db504f3
    v_cvt_pk_bf16_f32 v10, v10, v11
    v_and_b32 v11, 0xffff0000, v10
    v_lshlrev_b32 v10, 16, v10
    v_cvt_pk_bf16_f32 v12, v12, v13
    v_and_b32 v13, 0xffff0000, v12
    s_branch .Lsk_m1_3
.Lst_m1_3:
    s_branch .Lrt_m1_3
.Lsk_m1_3:
    v_lshlrev_b32 v12, 16, v12
    v_pk_mul_f32 v[10:11], v[10:11], s[60:61]
    v_pk_mul_f32 v[12:13], v[12:13], s[60:61]
    v_cvt_pk_bf16_f32 v10, v10, v11
    v_and_b32 v11, 0xffff0000, v10
    v_lshlrev_b32 v10, 16, v10
    v_cvt_pk_bf16_f32 v12, v12, v13
    v_and_b32 v13, 0xffff0000, v12
    v_lshlrev_b32 v12, 16, v12
    v_max_f32 v14, v10, v11
    v_max3_f32 v14, v14, v12, v13
    s_mov_b32 s60, 0x3fb8aa3b
    v_mov_b32 v22, s34
    v_mov_b32 v23, s34
    v_max_f32_dpp v14, v14, v14 quad_perm:[2,3,0,1] row_mask:0xf bank_mask:0xf
    s_nop 1
    v_max_f32_dpp v14, v14, v14 row_ror:4 row_mask:0xf bank_mask:0xf
    s_nop 1
    v_max_f32_dpp v14, v14, v14 row_ror:8 row_mask:0xf bank_mask:0xf
    v_mov_b32 v15, v14
    s_nop 1
    v_permlane16_swap_b32 v15, v14
    v_max_f32 v14, v15, v14
    v_mov_b32 v15, v14
    s_nop 1
    v_permlane32_swap_b32 v15, v14
    v_max_f32 v14, v15, v14
    v_mul_f32 v15, 0xbfb8aa3b, v14
    v_fma_f32 v10, v10, s60, v15
    v_fma_f32 v11, v11, s60, v15
    v_fma_f32 v12, v12, s60, v15
    v_fma_f32 v13, v13, s60, v15
    v_exp_f32 v10, v10
    v_exp_f32 v11, v11
    v_exp_f32 v12, v12
    v_exp_f32 v13, v13
    v_mov_b32 v20, v14
    v_pk_add_f32 v[16:17], v[10:11], v[12:13]
    v_add_f32 v21, v16, v17
    s_lshl_b32 s60, s68, 5
    s_lshl_b32 s61, s3, 4
    s_add_u32 s61, s61, 159104
    v_add_u32 v16, s61, v3
    v_mov_b32 v17, 159232
    v_mov_b32 v18, 1
    s_add_u32 s60, s60, s59
    v_add_f32_dpp v21, v21, v21 quad_perm:[2,3,0,1] row_mask:0xf bank_mask:0xf
    s_nop 1
    v_add_f32_dpp v21, v21, v21 row_ror:4 row_mask:0xf bank_mask:0xf
    s_nop 1
    v_add_f32_dpp v21, v21, v21 row_ror:8 row_mask:0xf bank_mask:0xf
    v_mov_b32 v15, v21
    s_nop 1
    v_permlane16_swap_b32 v15, v21
    v_add_f32 v21, v15, v21
    v_mov_b32 v15, v21
    s_nop 1
    v_permlane32_swap_b32 v15, v21
    v_add_f32 v21, v15, v21
    s_mov_b64 exec, 3
    ds_write_b64 v16, v[20:21]
    s_mov_b64 exec, 1
    ds_add_rtn_u32 v18, v17, v18
    s_mov_b64 exec, -1
    v_and_b32 v16, 0x78, v3
    v_or_b32 v16, 159104, v16
    s_waitcnt lgkmcnt(0)
    v_readfirstlane_b32 s61, v18
    s_cmp_eq_u32 s61, 7
    s_nop 3
    s_cbranch_scc0 .mlc_82
    ds_read_b64 v[18:19], v16
    s_waitcnt lgkmcnt(0)
    v_mov_b32 v20, v18
    s_nop 1
    v_max_f32_dpp v20, v20, v20 quad_perm:[2,3,0,1] row_mask:0xf bank_mask:0xf
    s_nop 1
    v_max_f32_dpp v20, v20, v20 row_ror:4 row_mask:0xf bank_mask:0xf
    s_nop 1
    v_max_f32_dpp v20, v20, v20 row_ror:8 row_mask:0xf bank_mask:0xf
    v_sub_f32 v18, v18, v20
    v_mul_f32 v18, 0x3fb8aa3b, v18
    v_exp_f32 v18, v18
    s_nop 0
    v_mul_f32 v21, v18, v19
    s_nop 1
    v_add_f32_dpp v21, v21, v21 quad_perm:[2,3,0,1] row_mask:0xf bank_mask:0xf
    s_nop 1
    v_add_f32_dpp v21, v21, v21 row_ror:4 row_mask:0xf bank_mask:0xf
    s_nop 1
    v_add_f32_dpp v21, v21, v21 row_ror:8 row_mask:0xf bank_mask:0xf
    s_mov_b64 exec, 3
    buffer_store_dwordx4 v[20:23], v2, s[36:39], s60 offen sc1
    s_mov_b64 exec, -1
.mlc_82:
    s_memrealtime s[8:9]
    s_waitcnt lgkmcnt(0)
    s_sub_u32 s8, s8, s30
    s_cmpk_ge_u32 s8, 1726
    s_cbranch_scc1 .ap_83
    s_waitcnt vmcnt(5)
    s_cmpk_ge_u32 s8, 1626
    s_cbranch_scc1 .ap_83
    s_waitcnt vmcnt(3)
    s_bitcmp1_b64 s[14:15], 44
    s_cbranch_scc0 1
    s_waitcnt vmcnt(2)
    s_cmpk_ge_u32 s8, 1506
    s_cbranch_scc1 .ap_83
    s_waitcnt vmcnt(1)
.ap_83:
    s_add_u32 s63, s69, 163840
    buffer_load_dwordx4 v[208:211], v1, s[44:47], s63 offen nt
    s_cmp_eq_u32 s3, 0
    s_cbranch_scc1 .Lst_m2_0
    s_cmp_eq_u32 s3, 1
    s_cbranch_scc1 .Lst_m2_1
    s_cmp_eq_u32 s3, 2
    s_cbranch_scc1 .Lst_m2_2
    s_cmp_eq_u32 s3, 3
    s_cbranch_scc1 .Lrt_m2_3
.Lrt_m2_0:
.Lrt_m2_1:
.Lrt_m2_2:
.Lrt_m2_3:
    v_and_b32 v16, 8, v0
    v_and_b32 v17, 1, v0
    v_lshl_add_u32 v16, v17, 2, v16
    v_bfe_u32 v17, v0, 1, 2
    v_add_u32 v16, v16, v17
    v_lshrrev_b32 v17, 4, v0
    v_lshl_add_u32 v16, v16, 2, v17
    v_lshlrev_b32 v7, 1, v16
    v_and_b32 v8, 62, v16
    v_lshlrev_b32 v8, 2, v8
    s_mul_i32 s100, s3, 1152
    s_lshl_b32 s56, s65, 7
    s_add_u32 s100, s100, s56
    s_mov_b32 s52, s4
    s_and_b32 s53, s5, 0xffff
    s_mov_b32 s54, 0x2400
    s_mov_b32 s55, 0x00020000
    buffer_load_ushort v40, v7, s[52:55], s100 offen
    s_mov_b32 s48, s16
    s_and_b32 s49, s17, 0xffff
    s_mov_b32 s50, 0x480
    s_mov_b32 s51, 0x00020000
    buffer_load_dwordx2 v[48:49], v3, s[48:51], 0 offen
    buffer_load_dwordx2 v[50:51], v3, s[48:51], 0 offen offset:512
    buffer_load_dword v34, v4, s[48:51], 0 offen
    s_mov_b32 s48, s28
    s_and_b32 s49, s29, 0xffff
    s_mov_b32 s50, 0x2400
    s_mov_b32 s51, 0x00020000
    buffer_load_ushort v39, v7, s[48:51], s100 offen nt
    s_memrealtime s[8:9]
    s_waitcnt vmcnt(13)
    s_waitcnt lgkmcnt(0)
    s_sub_u32 s8, s8, s30
    s_cmpk_ge_u32 s8, 1756
    s_cbranch_scc1 .ap_84
    s_waitcnt vmcnt(10)
    s_cmpk_ge_u32 s8, 1656
    s_cbranch_scc1 .ap_84
    s_waitcnt vmcnt(8)
    s_bitcmp1_b64 s[14:15], 45
    s_cbranch_scc0 1
    s_waitcnt vmcnt(7)
    s_cmpk_ge_u32 s8, 1536
    s_cbranch_scc1 .ap_84
    s_waitcnt vmcnt(6)
.ap_84:
    s_add_u32 s63, s69, 172032
    buffer_load_dwordx4 v[212:215], v1, s[44:47], s63 offen nt
    s_memrealtime s[8:9]
    s_waitcnt vmcnt(13)
    s_waitcnt lgkmcnt(0)
    s_sub_u32 s8, s8, s30
    s_cmpk_ge_u32 s8, 1788
    s_cbranch_scc1 .ap_85
    s_waitcnt vmcnt(10)
    s_cmpk_ge_u32 s8, 1688
    s_cbranch_scc1 .ap_85
    s_waitcnt vmcnt(8)
    s_bitcmp1_b64 s[14:15], 46
    s_cbranch_scc0 1
    s_waitcnt vmcnt(7)
    s_cmpk_ge_u32 s8, 1568
    s_cbranch_scc1 .ap_85
    s_waitcnt vmcnt(6)
.ap_85:
    s_add_u32 s63, s69, 180224
    buffer_load_dwordx4 v[216:219], v1, s[44:47], s63 offen nt
    s_memrealtime s[8:9]
    s_waitcnt vmcnt(13)
    s_waitcnt lgkmcnt(0)
    s_sub_u32 s8, s8, s30
    s_cmpk_ge_u32 s8, 1820
    s_cbranch_scc1 .ap_86
    s_waitcnt vmcnt(10)
    s_cmpk_ge_u32 s8, 1720
    s_cbranch_scc1 .ap_86
    s_waitcnt vmcnt(8)
    s_bitcmp1_b64 s[14:15], 47
    s_cbranch_scc0 1
    s_waitcnt vmcnt(7)
    s_cmpk_ge_u32 s8, 1600
    s_cbranch_scc1 .ap_86
    s_waitcnt vmcnt(1)
.ap_86:
    s_add_u32 s63, s69, 188416
    buffer_load_dwordx4 v[220:223], v1, s[44:47], s63 offen nt
    s_memrealtime s[8:9]
    s_branch .Lsk_m1_4
.Lst_m1_4:
    s_branch .Lrt_m1_4
.Lsk_m1_4:
    s_waitcnt vmcnt(13)
    s_waitcnt lgkmcnt(0)
    s_sub_u32 s8, s8, s30
    s_cmpk_ge_u32 s8, 1852
    s_cbranch_scc1 .ap_87
    s_waitcnt vmcnt(10)
    s_cmpk_ge_u32 s8, 1752
    s_cbranch_scc1 .ap_87
    s_waitcnt vmcnt(8)
    s_bitcmp1_b64 s[14:15], 48
    s_cbranch_scc0 1
    s_waitcnt vmcnt(2)
    s_cmpk_ge_u32 s8, 1632
    s_cbranch_scc1 .ap_87
    s_waitcnt vmcnt(1)
.ap_87:
    s_add_u32 s63, s69, 262144
    buffer_load_dwordx4 v[224:227], v1, s[44:47], s63 offen nt
    s_memrealtime s[8:9]
    s_waitcnt vmcnt(13)
    s_waitcnt lgkmcnt(0)
    s_sub_u32 s8, s8, s30
    s_cmpk_ge_u32 s8, 1884
    s_cbranch_scc1 .ap_88
    s_waitcnt vmcnt(10)
    s_cmpk_ge_u32 s8, 1784
    s_cbranch_scc1 .ap_88
    s_waitcnt vmcnt(3)
    s_bitcmp1_b64 s[14:15], 49
    s_cbranch_scc0 1
    s_waitcnt vmcnt(2)
    s_cmpk_ge_u32 s8, 1664
    s_cbranch_scc1 .ap_88
    s_waitcnt vmcnt(1)
.ap_88:
    s_add_u32 s63, s69, 270336
    buffer_load_dwordx4 v[228:231], v1, s[44:47], s63 offen nt
    s_memrealtime s[8:9]
    s_waitcnt vmcnt(13)
    s_waitcnt lgkmcnt(0)
    s_sub_u32 s8, s8, s30
    s_cmpk_ge_u32 s8, 1916
    s_cbranch_scc1 .ap_89
    s_waitcnt vmcnt(10)
    s_cmpk_ge_u32 s8, 1816
    s_cbranch_scc1 .ap_89
    s_waitcnt vmcnt(3)
    s_bitcmp1_b64 s[14:15], 50
    s_cbranch_scc0 1
    s_waitcnt vmcnt(2)
    s_cmpk_ge_u32 s8, 1696
    s_cbranch_scc1 .ap_89
    s_waitcnt vmcnt(1)
.ap_89:
    s_add_u32 s63, s69, 278528
    buffer_load_dwordx4 v[232:235], v1, s[44:47], s63 offen nt
    s_memrealtime s[8:9]
    s_waitcnt vmcnt(13)
    s_waitcnt lgkmcnt(0)
    s_sub_u32 s8, s8, s30
    s_cmpk_ge_u32 s8, 1948
    s_cbranch_scc1 .ap_90
    s_waitcnt vmcnt(5)
    s_cmpk_ge_u32 s8, 1848
    s_cbranch_scc1 .ap_90
    s_waitcnt vmcnt(3)
    s_bitcmp1_b64 s[14:15], 51
    s_cbranch_scc0 1
    s_waitcnt vmcnt(2)
    s_cmpk_ge_u32 s8, 1728
    s_cbranch_scc1 .ap_90
    s_waitcnt vmcnt(1)
.ap_90:
    s_add_u32 s63, s69, 286720
    buffer_load_dwordx4 v[236:239], v1, s[44:47], s63 offen nt
    s_memrealtime s[8:9]
    s_waitcnt vmcnt(13)
    s_waitcnt lgkmcnt(0)
    s_sub_u32 s8, s8, s30
    s_cmpk_ge_u32 s8, 1980
    s_cbranch_scc1 .ap_91
    s_waitcnt vmcnt(5)
    s_cmpk_ge_u32 s8, 1880
    s_cbranch_scc1 .ap_91
    s_waitcnt vmcnt(3)
    s_bitcmp1_b64 s[14:15], 52
    s_cbranch_scc0 1
    s_waitcnt vmcnt(2)
    s_cmpk_ge_u32 s8, 1760
    s_cbranch_scc1 .ap_91
    s_waitcnt vmcnt(1)
.ap_91:
    s_add_u32 s63, s69, 294912
    buffer_load_dwordx4 v[240:243], v1, s[44:47], s63 offen nt
    s_memrealtime s[8:9]
    s_waitcnt vmcnt(13)
    s_waitcnt lgkmcnt(0)
    s_sub_u32 s8, s8, s30
    s_cmpk_ge_u32 s8, 2012
    s_cbranch_scc1 .ap_92
    s_waitcnt vmcnt(5)
    s_cmpk_ge_u32 s8, 1912
    s_cbranch_scc1 .ap_92
    s_waitcnt vmcnt(3)
    s_bitcmp1_b64 s[14:15], 53
    s_cbranch_scc0 1
    s_waitcnt vmcnt(2)
    s_cmpk_ge_u32 s8, 1792
    s_cbranch_scc1 .ap_92
    s_waitcnt vmcnt(1)
.ap_92:
    s_add_u32 s63, s69, 303104
    buffer_load_dwordx4 v[244:247], v1, s[44:47], s63 offen nt
    s_memrealtime s[8:9]
    s_waitcnt vmcnt(8)
    s_waitcnt lgkmcnt(0)
    s_sub_u32 s8, s8, s30
    s_cmpk_ge_u32 s8, 2044
    s_cbranch_scc1 .ap_93
    s_waitcnt vmcnt(5)
    s_cmpk_ge_u32 s8, 1944
    s_cbranch_scc1 .ap_93
    s_waitcnt vmcnt(3)
    s_bitcmp1_b64 s[14:15], 54
    s_cbranch_scc0 1
    s_waitcnt vmcnt(2)
    s_cmpk_ge_u32 s8, 1824
    s_cbranch_scc1 .ap_93
    s_waitcnt vmcnt(1)
.ap_93:
    s_add_u32 s63, s69, 311296
    buffer_load_dwordx4 v[248:251], v1, s[44:47], s63 offen nt
    s_memrealtime s[8:9]
    s_waitcnt vmcnt(8)
    s_waitcnt lgkmcnt(0)
    s_sub_u32 s8, s8, s30
    s_cmpk_ge_u32 s8, 2076
    s_cbranch_scc1 .ap_94
    s_waitcnt vmcnt(5)
    s_cmpk_ge_u32 s8, 1976
    s_cbranch_scc1 .ap_94
    s_waitcnt vmcnt(3)
    s_bitcmp1_b64 s[14:15], 55
    s_cbranch_scc0 1
    s_waitcnt vmcnt(2)
    s_cmpk_ge_u32 s8, 1856
    s_cbranch_scc1 .ap_94
    s_waitcnt vmcnt(1)
.ap_94:
    s_add_u32 s63, s69, 319488
    buffer_load_dwordx4 v[252:255], v1, s[44:47], s63 offen nt
    s_memrealtime s[8:9]
    s_waitcnt vmcnt(8)
    s_waitcnt lgkmcnt(0)
    s_sub_u32 s8, s8, s30
    s_cmpk_ge_u32 s8, 2108
    s_cbranch_scc1 .ap_95
    s_waitcnt vmcnt(5)
    s_cmpk_ge_u32 s8, 2008
    s_cbranch_scc1 .ap_95
    s_waitcnt vmcnt(3)
    s_bitcmp1_b64 s[14:15], 56
    s_cbranch_scc0 1
    s_waitcnt vmcnt(2)
    s_cmpk_ge_u32 s8, 1888
    s_cbranch_scc1 .ap_95
    s_waitcnt vmcnt(1)
.ap_95:
    s_add_u32 s63, s69, 393216
    buffer_load_dwordx4 v[36:39], v1, s[44:47], s63 offen nt
    s_memrealtime s[8:9]
    s_waitcnt vmcnt(8)
    s_waitcnt lgkmcnt(0)
    s_sub_u32 s8, s8, s30
    s_cmpk_ge_u32 s8, 2140
    s_cbranch_scc1 .ap_96
    s_waitcnt vmcnt(5)
    s_cmpk_ge_u32 s8, 2040
    s_cbranch_scc1 .ap_96
    s_waitcnt vmcnt(3)
    s_bitcmp1_b64 s[14:15], 57
    s_cbranch_scc0 1
    s_waitcnt vmcnt(2)
    s_cmpk_ge_u32 s8, 1920
    s_cbranch_scc1 .ap_96
    s_waitcnt vmcnt(1)
.ap_96:
    s_add_u32 s63, s69, 401408
    s_branch .Lsk_m1_5
.Lst_m1_5:
    s_branch .Lrt_m1_5
.Lsk_m1_5:
    buffer_load_dwordx4 v[44:47], v1, s[44:47], s63 offen nt
    s_and_b32 s0, s0, 0xffffff80
    s_sub_u32 s0, s0, 1024
    buffer_load_dword v28, v4, s[36:39], s0 offen sc1
    buffer_load_dwordx4 v[24:27], v9, s[36:39], s59 offen offset:0 sc1
    s_memrealtime s[8:9]
    s_waitcnt vmcnt(9)
    s_waitcnt lgkmcnt(0)
    s_sub_u32 s8, s8, s30
    s_cmpk_ge_u32 s8, 2172
    s_cbranch_scc1 .ap_97
    s_waitcnt vmcnt(6)
    s_cmpk_ge_u32 s8, 2072
    s_cbranch_scc1 .ap_97
    s_waitcnt vmcnt(4)
    s_bitcmp1_b64 s[14:15], 58
    s_cbranch_scc0 1
    s_waitcnt vmcnt(3)
    s_cmpk_ge_u32 s8, 1952
    s_cbranch_scc1 .ap_97
    s_waitcnt vmcnt(2)
.ap_97:
    s_add_u32 s63, s69, 409600
    buffer_load_dwordx4 v[52:55], v1, s[44:47], s63 offen nt
    s_memrealtime s[8:9]
    s_waitcnt vmcnt(9)
    s_waitcnt lgkmcnt(0)
    s_sub_u32 s8, s8, s30
    s_cmpk_ge_u32 s8, 2204
    s_cbranch_scc1 .ap_98
    s_waitcnt vmcnt(6)
    s_cmpk_ge_u32 s8, 2104
    s_cbranch_scc1 .ap_98
    s_waitcnt vmcnt(4)
    s_bitcmp1_b64 s[14:15], 59
    s_cbranch_scc0 1
    s_waitcnt vmcnt(3)
    s_cmpk_ge_u32 s8, 1984
    s_cbranch_scc1 .ap_98
    s_waitcnt vmcnt(1)
.ap_98:
    s_add_u32 s63, s69, 417792
    buffer_load_dwordx4 v[60:63], v1, s[44:47], s63 offen nt
    s_memrealtime s[8:9]
    s_waitcnt vmcnt(9)
    s_waitcnt lgkmcnt(0)
    s_sub_u32 s8, s8, s30
    s_cmpk_ge_u32 s8, 2236
    s_cbranch_scc1 .ap_99
    s_waitcnt vmcnt(6)
    s_cmpk_ge_u32 s8, 2136
    s_cbranch_scc1 .ap_99
    s_waitcnt vmcnt(4)
    s_bitcmp1_b64 s[14:15], 60
    s_cbranch_scc0 1
    s_waitcnt vmcnt(2)
    s_cmpk_ge_u32 s8, 2016
    s_cbranch_scc1 .ap_99
    s_waitcnt vmcnt(1)
.ap_99:
    s_add_u32 s63, s69, 425984
    buffer_load_dwordx4 v[68:71], v1, s[44:47], s63 offen nt
    s_memrealtime s[8:9]
    s_waitcnt vmcnt(9)
    s_waitcnt lgkmcnt(0)
    s_sub_u32 s8, s8, s30
    s_cmpk_ge_u32 s8, 2268
    s_cbranch_scc1 .ap_100
    s_waitcnt vmcnt(6)
    s_cmpk_ge_u32 s8, 2168
    s_cbranch_scc1 .ap_100
    s_waitcnt vmcnt(3)
    s_bitcmp1_b64 s[14:15], 61
    s_cbranch_scc0 1
    s_waitcnt vmcnt(2)
    s_cmpk_ge_u32 s8, 2048
    s_cbranch_scc1 .ap_100
    s_waitcnt vmcnt(1)
.ap_100:
    s_add_u32 s63, s69, 434176
    buffer_load_dwordx4 v[76:79], v1, s[44:47], s63 offen nt
    s_memrealtime s[8:9]
    s_waitcnt vmcnt(9)
    s_waitcnt lgkmcnt(0)
    s_sub_u32 s8, s8, s30
    s_cmpk_ge_u32 s8, 2300
    s_cbranch_scc1 .ap_101
    s_waitcnt vmcnt(6)
    s_cmpk_ge_u32 s8, 2200
    s_cbranch_scc1 .ap_101
    s_waitcnt vmcnt(3)
    s_bitcmp1_b64 s[14:15], 62
    s_cbranch_scc0 1
    s_waitcnt vmcnt(2)
    s_cmpk_ge_u32 s8, 2080
    s_cbranch_scc1 .ap_101
    s_waitcnt vmcnt(1)
.ap_101:
    s_add_u32 s63, s69, 442368
    buffer_load_dwordx4 v[84:87], v1, s[44:47], s63 offen nt
    s_memrealtime s[8:9]
    s_waitcnt vmcnt(9)
    s_waitcnt lgkmcnt(0)
    s_sub_u32 s8, s8, s30
    s_cmpk_ge_u32 s8, 2332
    s_cbranch_scc1 .ap_102
    s_waitcnt vmcnt(5)
    s_cmpk_ge_u32 s8, 2232
    s_cbranch_scc1 .ap_102
    s_waitcnt vmcnt(3)
    s_bitcmp1_b64 s[14:15], 63
    s_cbranch_scc0 1
    s_waitcnt vmcnt(2)
    s_cmpk_ge_u32 s8, 2112
    s_cbranch_scc1 .ap_102
    s_waitcnt vmcnt(1)
.ap_102:
    s_add_u32 s63, s69, 450560
    buffer_load_dwordx4 v[92:95], v1, s[44:47], s63 offen nt
    s_setprio 0
    s_waitcnt vmcnt(6)
    s_branch .gpc_104
.gp_103:
    buffer_load_dwordx4 v[24:27], v9, s[36:39], s59 offen offset:0 sc1
    s_waitcnt vmcnt(0)
.gpc_104:
    v_cmp_eq_u32 vcc, s34, v26
    s_cmp_eq_u64 vcc, -1
    s_nop 3
    s_cbranch_scc1 .gpd_105
    s_sub_u32 s35, s35, 1
    s_cbranch_scc1 .Lexit
    s_sleep 1
    s_branch .gp_103
.gpd_105:
    v_cmp_eq_u32 vcc, s1, v28
    s_cmp_eq_u64 vcc, -1
    s_cselect_b32 s0, 0x800000, 0
    v_mov_b32 v16, v24
    s_nop 1
    v_max_f32_dpp v16, v16, v16 row_ror:4 row_mask:0xf bank_mask:0xf
    v_sub_f32 v17, v24, v16
    v_sub_f32 v18, v14, v16
    v_mul_f32 v17, 0x3fb8aa3b, v17
    v_mul_f32 v18, 0x3fb8aa3b, v18
    v_exp_f32 v17, v17
    v_exp_f32 v18, v18
    v_mul_f32 v17, v17, v25
    s_nop 1
    v_add_f32_dpp v17, v17, v17 row_ror:4 row_mask:0xf bank_mask:0xf
    v_rcp_f32 v19, v17
    s_nop 0
    v_fma_f32 v15, -v17, v19, 1.0
    v_fma_f32 v19, v15, v19, v19
    v_mul_f32 v18, v18, v19
    v_mul_f32 v10, v10, v18
    v_mul_f32 v11, v11, v18
    v_mul_f32 v12, v12, v18
    v_mul_f32 v13, v13, v18
    v_mov_b32_dpp v112, v10 quad_perm:[2,3,0,1] row_mask:0xf bank_mask:0xf
    v_mov_b32_dpp v113, v11 quad_perm:[2,3,0,1] row_mask:0xf bank_mask:0xf
    v_mov_b32_dpp v114, v12 quad_perm:[2,3,0,1] row_mask:0xf bank_mask:0xf
    v_mov_b32_dpp v115, v13 quad_perm:[2,3,0,1] row_mask:0xf bank_mask:0xf
    v_cvt_pk_bf16_f32 v96, v10, v112
    v_cvt_pk_bf16_f32 v100, v11, v113
    v_cvt_pk_bf16_f32 v104, v12, v114
    v_cvt_pk_bf16_f32 v108, v13, v115
    v_mov_b32_dpp v97, v96 row_ror:12 row_mask:0xf bank_mask:0xf
    v_mov_b32_dpp v101, v100 row_ror:12 row_mask:0xf bank_mask:0xf
    v_mov_b32_dpp v105, v104 row_ror:12 row_mask:0xf bank_mask:0xf
    v_mov_b32_dpp v109, v108 row_ror:12 row_mask:0xf bank_mask:0xf
    v_mov_b32_dpp v98, v96 row_ror:8 row_mask:0xf bank_mask:0xf
    v_mov_b32_dpp v102, v100 row_ror:8 row_mask:0xf bank_mask:0xf
    v_mov_b32_dpp v106, v104 row_ror:8 row_mask:0xf bank_mask:0xf
    v_mov_b32_dpp v110, v108 row_ror:8 row_mask:0xf bank_mask:0xf
    v_mov_b32_dpp v99, v96 row_ror:4 row_mask:0xf bank_mask:0xf
    v_mov_b32_dpp v103, v100 row_ror:4 row_mask:0xf bank_mask:0xf
    v_mov_b32_dpp v107, v104 row_ror:4 row_mask:0xf bank_mask:0xf
    v_mov_b32_dpp v111, v108 row_ror:4 row_mask:0xf bank_mask:0xf
    s_lshl_b32 s60, s3, 10
    s_add_u32 s60, s60, 147456
    v_lshlrev_b32 v10, 5, v0
    v_add_u32 v10, s60, v10
    v_perm_b32 v112, v164, v160, s94
    v_perm_b32 v113, v172, v168, s94
    v_perm_b32 v114, v180, v176, s94
    v_perm_b32 v115, v188, v184, s94
    s_nop 1
    v_mfma_f32_16x16x32_bf16 v[128:131], v[96:99], v[112:115], 0
    v_perm_b32 v116, v164, v160, s95
    v_perm_b32 v117, v172, v168, s95
    v_perm_b32 v118, v180, v176, s95
    v_perm_b32 v119, v188, v184, s95
    s_nop 1
    v_mfma_f32_16x16x32_bf16 v[132:135], v[96:99], v[116:119], 0
    v_perm_b32 v120, v165, v161, s94
    v_perm_b32 v121, v173, v169, s94
    v_perm_b32 v122, v181, v177, s94
    v_perm_b32 v123, v189, v185, s94
    s_nop 1
    v_mfma_f32_16x16x32_bf16 v[136:139], v[96:99], v[120:123], 0
    v_perm_b32 v124, v165, v161, s95
    v_perm_b32 v125, v173, v169, s95
    v_perm_b32 v126, v181, v177, s95
    v_perm_b32 v127, v189, v185, s95
    s_nop 1
    v_mfma_f32_16x16x32_bf16 v[140:143], v[96:99], v[124:127], 0
    s_branch .Lsk_m1_6
.Lst_m1_6:
    s_branch .Lrt_m1_6
.Lsk_m1_6:
    v_perm_b32 v112, v166, v162, s94
    v_perm_b32 v113, v174, v170, s94
    v_perm_b32 v114, v182, v178, s94
    v_perm_b32 v115, v190, v186, s94
    s_nop 1
    v_mfma_f32_16x16x32_bf16 v[144:147], v[96:99], v[112:115], 0
    v_perm_b32 v116, v166, v162, s95
    v_perm_b32 v117, v174, v170, s95
    v_perm_b32 v118, v182, v178, s95
    v_perm_b32 v119, v190, v186, s95
    s_nop 1
    v_mfma_f32_16x16x32_bf16 v[148:151], v[96:99], v[116:119], 0
    v_perm_b32 v120, v167, v163, s94
    v_perm_b32 v121, v175, v171, s94
    v_perm_b32 v122, v183, v179, s94
    v_perm_b32 v123, v191, v187, s94
    s_nop 1
    v_mfma_f32_16x16x32_bf16 v[152:155], v[96:99], v[120:123], 0
    v_perm_b32 v124, v167, v163, s95
    v_perm_b32 v125, v175, v171, s95
    v_perm_b32 v126, v183, v179, s95
    v_perm_b32 v127, v191, v187, s95
    s_nop 1
    v_mfma_f32_16x16x32_bf16 v[156:159], v[96:99], v[124:127], 0
    v_perm_b32 v112, v196, v192, s94
    v_perm_b32 v113, v204, v200, s94
    v_perm_b32 v114, v212, v208, s94
    v_perm_b32 v115, v220, v216, s94
    s_nop 1
    v_mfma_f32_16x16x32_bf16 v[128:131], v[100:103], v[112:115], v[128:131]
    v_perm_b32 v116, v196, v192, s95
    v_perm_b32 v117, v204, v200, s95
    v_perm_b32 v118, v212, v208, s95
    v_perm_b32 v119, v220, v216, s95
    s_nop 1
    v_mfma_f32_16x16x32_bf16 v[132:135], v[100:103], v[116:119], v[132:135]
    v_perm_b32 v120, v197, v193, s94
    v_perm_b32 v121, v205, v201, s94
    v_perm_b32 v122, v213, v209, s94
    v_perm_b32 v123, v221, v217, s94
    s_nop 1
    v_mfma_f32_16x16x32_bf16 v[136:139], v[100:103], v[120:123], v[136:139]
    v_perm_b32 v124, v197, v193, s95
    v_perm_b32 v125, v205, v201, s95
    v_perm_b32 v126, v213, v209, s95
    v_perm_b32 v127, v221, v217, s95
    s_nop 1
    v_mfma_f32_16x16x32_bf16 v[140:143], v[100:103], v[124:127], v[140:143]
    v_perm_b32 v112, v198, v194, s94
    v_perm_b32 v113, v206, v202, s94
    v_perm_b32 v114, v214, v210, s94
    v_perm_b32 v115, v222, v218, s94
    s_nop 1
    v_mfma_f32_16x16x32_bf16 v[144:147], v[100:103], v[112:115], v[144:147]
    v_perm_b32 v116, v198, v194, s95
    v_perm_b32 v117, v206, v202, s95
    v_perm_b32 v118, v214, v210, s95
    v_perm_b32 v119, v222, v218, s95
    s_nop 1
    v_mfma_f32_16x16x32_bf16 v[148:151], v[100:103], v[116:119], v[148:151]
    v_perm_b32 v120, v199, v195, s94
    v_perm_b32 v121, v207, v203, s94
    v_perm_b32 v122, v215, v211, s94
    v_perm_b32 v123, v223, v219, s94
    s_nop 1
    v_mfma_f32_16x16x32_bf16 v[152:155], v[100:103], v[120:123], v[152:155]
    v_perm_b32 v124, v199, v195, s95
    v_perm_b32 v125, v207, v203, s95
    v_perm_b32 v126, v215, v211, s95
    v_perm_b32 v127, v223, v219, s95
    s_nop 1
    v_mfma_f32_16x16x32_bf16 v[156:159], v[100:103], v[124:127], v[156:159]
    v_perm_b32 v112, v228, v224, s94
    v_perm_b32 v113, v236, v232, s94
    v_perm_b32 v114, v244, v240, s94
    v_perm_b32 v115, v252, v248, s94
    s_nop 1
    v_mfma_f32_16x16x32_bf16 v[128:131], v[104:107], v[112:115], v[128:131]
    v_perm_b32 v116, v228, v224, s95
    v_perm_b32 v117, v236, v232, s95
    v_perm_b32 v118, v244, v240, s95
    v_perm_b32 v119, v252, v248, s95
    s_nop 1
    v_mfma_f32_16x16x32_bf16 v[132:135], v[104:107], v[116:119], v[132:135]
    v_perm_b32 v120, v229, v225, s94
    v_perm_b32 v121, v237, v233, s94
    v_perm_b32 v122, v245, v241, s94
    v_perm_b32 v123, v253, v249, s94
    s_nop 1
    v_mfma_f32_16x16x32_bf16 v[136:139], v[104:107], v[120:123], v[136:139]
    v_perm_b32 v124, v229, v225, s95
    v_perm_b32 v125, v237, v233, s95
    v_perm_b32 v126, v245, v241, s95
    v_perm_b32 v127, v253, v249, s95
    s_nop 1
    v_mfma_f32_16x16x32_bf16 v[140:143], v[104:107], v[124:127], v[140:143]
    v_perm_b32 v112, v230, v226, s94
    v_perm_b32 v113, v238, v234, s94
    v_perm_b32 v114, v246, v242, s94
    v_perm_b32 v115, v254, v250, s94
    s_nop 1
    v_mfma_f32_16x16x32_bf16 v[144:147], v[104:107], v[112:115], v[144:147]
    v_perm_b32 v116, v230, v226, s95
    v_perm_b32 v117, v238, v234, s95
    v_perm_b32 v118, v246, v242, s95
    v_perm_b32 v119, v254, v250, s95
    s_nop 1
    v_mfma_f32_16x16x32_bf16 v[148:151], v[104:107], v[116:119], v[148:151]
    v_perm_b32 v120, v231, v227, s94
    v_perm_b32 v121, v239, v235, s94
    v_perm_b32 v122, v247, v243, s94
    v_perm_b32 v123, v255, v251, s94
    s_nop 1
    v_mfma_f32_16x16x32_bf16 v[152:155], v[104:107], v[120:123], v[152:155]
    v_perm_b32 v124, v231, v227, s95
    v_perm_b32 v125, v239, v235, s95
    v_perm_b32 v126, v247, v243, s95
    v_perm_b32 v127, v255, v251, s95
    s_nop 1
    v_mfma_f32_16x16x32_bf16 v[156:159], v[104:107], v[124:127], v[156:159]
    s_waitcnt vmcnt(0)
    v_perm_b32 v112, v44, v36, s94
    v_perm_b32 v113, v60, v52, s94
    v_perm_b32 v114, v76, v68, s94
    v_perm_b32 v115, v92, v84, s94
    s_nop 1
    v_mfma_f32_16x16x32_bf16 v[128:131], v[108:111], v[112:115], v[128:131]
    v_perm_b32 v116, v44, v36, s95
    v_perm_b32 v117, v60, v52, s95
    v_perm_b32 v118, v76, v68, s95
    v_perm_b32 v119, v92, v84, s95
    s_nop 1
    v_mfma_f32_16x16x32_bf16 v[132:135], v[108:111], v[116:119], v[132:135]
    v_perm_b32 v120, v45, v37, s94
    v_perm_b32 v121, v61, v53, s94
    v_perm_b32 v122, v77, v69, s94
    v_perm_b32 v123, v93, v85, s94
    s_nop 1
    v_mfma_f32_16x16x32_bf16 v[136:139], v[108:111], v[120:123], v[136:139]
    v_perm_b32 v124, v45, v37, s95
    v_perm_b32 v125, v61, v53, s95
    v_perm_b32 v126, v77, v69, s95
    v_perm_b32 v127, v93, v85, s95
    s_nop 1
    v_mfma_f32_16x16x32_bf16 v[140:143], v[108:111], v[124:127], v[140:143]
    v_perm_b32 v112, v46, v38, s94
    v_perm_b32 v113, v62, v54, s94
    v_perm_b32 v114, v78, v70, s94
    s_branch .Lsk_m1_7
.Lst_m1_7:
    s_branch .Lrt_m1_7
.Lsk_m1_7:
    v_perm_b32 v115, v94, v86, s94
    s_nop 1
    v_mfma_f32_16x16x32_bf16 v[144:147], v[108:111], v[112:115], v[144:147]
    v_perm_b32 v116, v46, v38, s95
    v_perm_b32 v117, v62, v54, s95
    v_perm_b32 v118, v78, v70, s95
    v_perm_b32 v119, v94, v86, s95
    s_nop 1
    v_mfma_f32_16x16x32_bf16 v[148:151], v[108:111], v[116:119], v[148:151]
    v_perm_b32 v120, v47, v39, s94
    v_perm_b32 v121, v63, v55, s94
    v_perm_b32 v122, v79, v71, s94
    v_perm_b32 v123, v95, v87, s94
    s_nop 1
    v_mfma_f32_16x16x32_bf16 v[152:155], v[108:111], v[120:123], v[152:155]
    v_perm_b32 v124, v47, v39, s95
    v_perm_b32 v125, v63, v55, s95
    v_perm_b32 v126, v79, v71, s95
    v_perm_b32 v127, v95, v87, s95
    s_nop 1
    v_mfma_f32_16x16x32_bf16 v[156:159], v[108:111], v[124:127], v[156:159]
    s_mov_b64 exec, 0xffff
    ds_write2_b32 v10, v128, v129 offset0:0 offset1:128
    ds_write2_b32 v10, v132, v133 offset0:1 offset1:129
    ds_write2_b32 v10, v136, v137 offset0:2 offset1:130
    ds_write2_b32 v10, v140, v141 offset0:3 offset1:131
    ds_write2_b32 v10, v144, v145 offset0:4 offset1:132
    ds_write2_b32 v10, v148, v149 offset0:5 offset1:133
    ds_write2_b32 v10, v152, v153 offset0:6 offset1:134
    ds_write2_b32 v10, v156, v157 offset0:7 offset1:135
    s_mov_b64 exec, -1
    s_waitcnt lgkmcnt(0)
    s_barrier
    s_cmp_lg_u32 s3, 7
    s_cbranch_scc1 .opub_106
    v_add_u32 v10, 147456, v2
    ds_read_b128 v[196:199], v10 offset:0
    ds_read_b128 v[200:203], v10 offset:1024
    ds_read_b128 v[204:207], v10 offset:2048
    ds_read_b128 v[208:211], v10 offset:3072
    ds_read_b128 v[212:215], v10 offset:4096
    ds_read_b128 v[216:219], v10 offset:5120
    ds_read_b128 v[220:223], v10 offset:6144
    ds_read_b128 v[224:227], v10 offset:7168
    v_lshrrev_b32 v11, 5, v0
    v_lshlrev_b32 v11, 13, v11
    v_and_b32 v12, 31, v0
    v_lshl_add_u32 v11, v12, 4, v11
    s_lshl4_add_u32 s56, s67, s66
    s_lshl1_add_u32 s56, s56, s68
    s_lshl_b32 s56, s56, 9
    s_add_u32 s56, s56, 0xa0000
    s_mov_b32 s60, 0x07060503
    s_mov_b32 s61, 0x07060502
    s_mov_b32 s62, 0x07060501
    v_mov_b32 v15, s34
    s_waitcnt lgkmcnt(6)
    v_pk_add_f32 v[196:197], v[196:197], v[200:201]
    v_pk_add_f32 v[198:199], v[198:199], v[202:203]
    s_waitcnt lgkmcnt(5)
    v_pk_add_f32 v[196:197], v[196:197], v[204:205]
    v_pk_add_f32 v[198:199], v[198:199], v[206:207]
    s_waitcnt lgkmcnt(4)
    v_pk_add_f32 v[196:197], v[196:197], v[208:209]
    v_pk_add_f32 v[198:199], v[198:199], v[210:211]
    s_waitcnt lgkmcnt(3)
    v_pk_add_f32 v[196:197], v[196:197], v[212:213]
    v_pk_add_f32 v[198:199], v[198:199], v[214:215]
    s_waitcnt lgkmcnt(2)
    v_pk_add_f32 v[196:197], v[196:197], v[216:217]
    v_pk_add_f32 v[198:199], v[198:199], v[218:219]
    s_waitcnt lgkmcnt(1)
    v_pk_add_f32 v[196:197], v[196:197], v[220:221]
    v_pk_add_f32 v[198:199], v[198:199], v[222:223]
    s_waitcnt lgkmcnt(0)
    v_pk_add_f32 v[196:197], v[196:197], v[224:225]
    v_pk_add_f32 v[198:199], v[198:199], v[226:227]
    v_perm_b32 v12, v196, v199, s60
    v_perm_b32 v13, v197, v199, s61
    v_perm_b32 v14, v198, v199, s62
    s_add_u32 s57, s56, 0x800000
    buffer_store_dwordx4 v[12:15], v11, s[36:39], s57 offen
    buffer_store_dwordx4 v[12:15], v11, s[36:39], s56 offen sc1
.opub_106:
    s_and_b32 s58, s64, 0
    s_mul_i32 s58, s58, 18432
    s_mul_i32 s59, s3, 2304
    s_add_u32 s58, s58, s59
    s_add_u32 s62, s58, 0x37000
    s_add_u32 s63, s58, 0x49000
    s_mul_i32 s101, s64, 18432
    s_add_u32 s101, s101, s59
    s_add_u32 s101, s101, 0x170000
    v_and_b32 v16, 8, v0
    v_and_b32 v17, 1, v0
    v_lshl_add_u32 v16, v17, 2, v16
    v_bfe_u32 v17, v0, 1, 2
    v_add_u32 v16, v16, v17
    v_lshlrev_b32 v9, 4, v16
    s_lshl_b32 s56, s65, 8
    s_add_u32 s58, s58, s56
    s_add_u32 s58, s58, 0x25000
    s_add_u32 s99, s101, s56
    s_lshr_b32 s56, s64, 1
    s_and_b32 s57, s3, 3
    s_cmp_lg_u32 s56, s57
    s_cbranch_scc1 .Lr_ga
    s_add_u32 s59, s58, 73728
    s_add_u32 s60, s58, 147456
    s_add_u32 s61, s58, 221184
.gp_107:
    buffer_load_dwordx4 v[56:59], v2, s[36:39], s62 offen offset:0 sc1
    buffer_load_dwordx4 v[60:63], v2, s[36:39], s62 offen offset:1024 sc1
    buffer_load_dwordx2 v[64:65], v5, s[36:39], s62 offen offset:0 sc1
    buffer_load_dwordx4 v[66:69], v2, s[36:39], s63 offen offset:0 sc1
    buffer_load_dwordx4 v[70:73], v2, s[36:39], s63 offen offset:1024 sc1
    buffer_load_dwordx2 v[74:75], v5, s[36:39], s63 offen offset:0 sc1
    buffer_load_dwordx2 v[76:77], v8, s[36:39], s59 offen offset:0 sc1
    buffer_load_dwordx2 v[78:79], v8, s[36:39], s60 offen offset:0 sc1
    buffer_load_dwordx2 v[80:81], v8, s[36:39], s61 offen offset:0 sc1
    buffer_load_dwordx2 v[42:43], v8, s[36:39], s58 offen offset:0 sc1
    s_waitcnt vmcnt(0)
.gpc_108:
    v_min_u32 v24, v57, v59
    v_max_u32 v25, v57, v59
    v_min3_u32 v24, v24, v61, v63
    v_max3_u32 v25, v25, v61, v63
    v_min3_u32 v24, v24, v65, v67
    v_max3_u32 v25, v25, v65, v67
    v_min3_u32 v24, v24, v69, v71
    v_max3_u32 v25, v25, v69, v71
    v_min3_u32 v24, v24, v73, v75
    v_max3_u32 v25, v25, v73, v75
    v_min3_u32 v24, v24, v77, v79
    v_max3_u32 v25, v25, v77, v79
    v_min3_u32 v24, v24, v81, v43
    v_max3_u32 v25, v25, v81, v43
    v_cmp_eq_u32 vcc, s34, v24
    v_cmp_eq_u32 s[56:57], s34, v25
    s_and_b64 vcc, vcc, s[56:57]
    s_cmp_eq_u64 vcc, -1
    s_nop 2
    s_cbranch_scc1 .gpd_109
    s_sub_u32 s35, s35, 1
    s_cbranch_scc1 .Lexit
    s_sleep 2
    s_branch .gp_107
.gpd_109:
    v_and_b32 v57, 0xffff0000, v56
    v_lshlrev_b32 v56, 16, v56
    v_and_b32 v67, 0xffff0000, v66
    v_lshlrev_b32 v66, 16, v66
    v_and_b32 v59, 0xffff0000, v58
    v_lshlrev_b32 v58, 16, v58
    v_and_b32 v69, 0xffff0000, v68
    v_lshlrev_b32 v68, 16, v68
    v_and_b32 v61, 0xffff0000, v60
    v_lshlrev_b32 v60, 16, v60
    v_and_b32 v71, 0xffff0000, v70
    v_lshlrev_b32 v70, 16, v70
    v_and_b32 v63, 0xffff0000, v62
    v_lshlrev_b32 v62, 16, v62
    v_and_b32 v73, 0xffff0000, v72
    v_lshlrev_b32 v72, 16, v72
    v_and_b32 v65, 0xffff0000, v64
    v_lshlrev_b32 v64, 16, v64
    v_and_b32 v75, 0xffff0000, v74
    v_lshlrev_b32 v74, 16, v74
    s_branch .Lsk_m2_0
.Lst_m2_0:
    s_branch .Lrt_m2_0
.Lsk_m2_0:
    v_lshlrev_b32 v77, 16, v76
    v_and_b32 v76, 0xffff0000, v76
    s_mov_b32 vcc_lo, 0xffff0000
    s_mov_b32 vcc_hi, 0xffff0000
    v_cndmask_b32 v77, v77, v76, vcc
    v_lshlrev_b32 v79, 16, v78
    v_and_b32 v78, 0xffff0000, v78
    s_mov_b32 vcc_lo, 0xffff0000
    s_mov_b32 vcc_hi, 0xffff0000
    v_cndmask_b32 v79, v79, v78, vcc
    v_lshlrev_b32 v81, 16, v80
    v_and_b32 v80, 0xffff0000, v80
    s_mov_b32 vcc_lo, 0xffff0000
    s_mov_b32 vcc_hi, 0xffff0000
    v_cndmask_b32 v81, v81, v80, vcc
    s_nop 1
    s_branch .Lr_ga2
.Lr_ga:
.gp_110:
    buffer_load_dwordx2 v[42:43], v8, s[36:39], s58 offen offset:0 sc1
    s_waitcnt vmcnt(0)
.gpc_111:
    v_cmp_eq_u32 vcc, s34, v43
    s_cmp_eq_u64 vcc, -1
    s_nop 3
    s_cbranch_scc1 .gpd_112
    s_sub_u32 s35, s35, 1
    s_cbranch_scc1 .Lexit
    s_sleep 2
    s_branch .gp_110
.gpd_112:
.Lr_ga2:
    v_lshlrev_b32 v40, 16, v40
    v_lshlrev_b32 v41, 16, v42
    v_and_b32 v42, 0xffff0000, v42
    s_mov_b32 vcc_lo, 0xffff0000
    s_mov_b32 vcc_hi, 0xffff0000
    v_cndmask_b32 v41, v41, v42, vcc
    s_mul_i32 s59, s3, 9
    s_add_u32 s59, s59, s65
    s_lshl_b32 s59, s59, 12
    s_add_u32 s59, s59, 0xe0000
    s_mov_b32 s60, 0x04000c0c
    s_mov_b32 s61, 0x0706000c
    v_mov_b32 v45, s34
    v_mov_b32 v47, s34
.gp_113:
    buffer_load_dwordx4 v[16:19], v2, s[36:39], s59 offen offset:0 sc1
    buffer_load_dwordx4 v[20:23], v2, s[36:39], s59 offen offset:1024 sc1
    buffer_load_dwordx4 v[24:27], v2, s[36:39], s59 offen offset:2048 sc1
    buffer_load_dwordx4 v[28:31], v2, s[36:39], s59 offen offset:3072 sc1
    s_waitcnt vmcnt(0)
.gpc_114:
    v_min_u32 v32, v19, v23
    v_max_u32 v33, v19, v23
    v_min3_u32 v32, v32, v27, v31
    v_max3_u32 v33, v33, v27, v31
    v_cmp_eq_u32 vcc, s34, v32
    v_cmp_eq_u32 s[56:57], s34, v33
    s_and_b64 vcc, vcc, s[56:57]
    s_cmp_eq_u64 vcc, -1
    s_nop 2
    s_cbranch_scc1 .gpd_115
    s_sub_u32 s35, s35, 1
    s_cbranch_scc1 .Lexit
    s_branch .gp_113
.gpd_115:
    v_perm_b32 v19, v16, v17, s60
    v_perm_b32 v19, v19, v18, s61
    v_perm_b32 v23, v20, v21, s60
    v_perm_b32 v23, v23, v22, s61
    v_perm_b32 v27, v24, v25, s60
    v_perm_b32 v27, v27, v26, s61
    v_perm_b32 v31, v28, v29, s60
    v_perm_b32 v31, v31, v30, s61
    v_pk_add_f32 v[16:17], v[16:17], v[20:21]
    v_pk_add_f32 v[18:19], v[18:19], v[22:23]
    v_pk_add_f32 v[24:25], v[24:25], v[28:29]
    v_pk_add_f32 v[26:27], v[26:27], v[30:31]
    v_pk_add_f32 v[16:17], v[16:17], v[24:25]
    v_pk_add_f32 v[18:19], v[18:19], v[26:27]
    s_nop 1
    v_permlane32_swap_b32 v16, v18
    v_permlane32_swap_b32 v17, v19
    v_pk_add_f32 v[16:17], v[16:17], v[18:19]
    s_nop 1
    v_permlane16_swap_b32 v16, v17
    v_add_f32 v16, v16, v17
    v_cvt_pk_bf16_f32 v16, v16, v16
    v_lshlrev_b32 v16, 16, v16
    v_mul_f32 v16, v16, v41
    v_cvt_pk_bf16_f32 v16, v16, v16
    v_lshlrev_b32 v16, 16, v16
    v_add_f32 v17, v16, v40
    v_add_f32 v16, v16, v40
    v_mov_b32 v40, v16
    s_nop 0
    v_permlane16_swap_b32 v16, v17
    v_cvt_pk_bf16_f32 v44, v16, v17
    v_cvt_pk_bf16_f32 v46, v16, v17
    s_nop 1
    v_permlane32_swap_b32 v44, v46
    s_mov_b64 exec, 0xffff
    s_add_u32 s57, s99, 0x800000
    buffer_store_dwordx4 v[44:47], v9, s[36:39], s57 offen
    buffer_store_dwordx4 v[44:47], v9, s[36:39], s99 offen sc1
    s_mov_b64 exec, -1
    s_lshr_b32 s56, s64, 1
    s_and_b32 s57, s3, 3
    s_cmp_lg_u32 s56, s57
    s_cbranch_scc1 .Lexit
    v_cvt_pk_bf16_f32 v40, v40, v40
    v_lshlrev_b32 v40, 16, v40
    s_mov_b32 s69, 0
.gp_116:
    s_add_u32 s69, s69, 1
    s_and_b32 s56, s69, 0x41
    s_cmp_lg_u32 s56, 0x41
    s_cselect_b32 s56, s0, 0
    s_add_u32 s58, s101, s56
    buffer_load_dwordx4 v[84:87], v2, s[36:39], s58 offen offset:0 sc1
    buffer_load_dwordx4 v[88:91], v2, s[36:39], s58 offen offset:1024 sc1
    buffer_load_dwordx2 v[92:93], v5, s[36:39], s58 offen offset:0 sc1
    s_waitcnt vmcnt(0)
    v_min3_u32 v24, v85, v87, v89
    v_max3_u32 v25, v85, v87, v89
    v_min3_u32 v24, v24, v91, v93
    v_max3_u32 v25, v25, v91, v93
    v_cmp_eq_u32 vcc, s34, v24
    v_cmp_eq_u32 s[56:57], s34, v25
    s_and_b64 vcc, vcc, s[56:57]
    s_cmp_eq_u64 vcc, -1
    s_nop 2
    s_cbranch_scc1 .gpd_117
    s_sub_u32 s35, s35, 1
    s_cbranch_scc1 .Lexit
    s_sleep 1
    s_branch .gp_116
.gpd_117:
    s_mov_b32 s56, 0x3f803f80
    v_dot2_f32_bf16 v104, v84, s56, 0
    v_dot2_f32_bf16 v105, v84, v84, 0
    v_dot2_f32_bf16 v104, v86, s56, v104
    v_dot2_f32_bf16 v105, v86, v86, v105
    v_dot2_f32_bf16 v104, v88, s56, v104
    v_dot2_f32_bf16 v105, v88, v88, v105
    v_dot2_f32_bf16 v104, v90, s56, v104
    v_dot2_f32_bf16 v105, v90, v90, v105
    s_mov_b64 exec, 0xffffffff
    s_branch .Lsk_m2_1
.Lst_m2_1:
    s_branch .Lrt_m2_1
.Lsk_m2_1:
    v_dot2_f32_bf16 v104, v92, s56, v104
    v_dot2_f32_bf16 v105, v92, v92, v105
    s_mov_b64 exec, -1
    s_nop 1
    v_permlane32_swap_b32 v104, v105
    v_add_f32 v104, v104, v105
    v_mov_b32 v106, v104
    s_nop 1
    v_permlane16_swap_b32 v106, v104
    v_add_f32 v104, v106, v104
    v_lshlrev_b32 v94, 16, v84
    v_and_b32 v95, 0xffff0000, v84
    v_add_f32_dpp v104, v104, v104 row_ror:8 row_mask:0xf bank_mask:0xf
    v_lshlrev_b32 v96, 16, v86
    v_and_b32 v97, 0xffff0000, v86
    v_add_f32_dpp v104, v104, v104 row_ror:4 row_mask:0xf bank_mask:0xf
    v_lshlrev_b32 v98, 16, v88
    v_and_b32 v99, 0xffff0000, v88
    v_add_f32_dpp v104, v104, v104 quad_perm:[2,3,0,1] row_mask:0xf bank_mask:0xf
    v_lshlrev_b32 v100, 16, v90
    v_and_b32 v101, 0xffff0000, v90
    v_add_f32_dpp v104, v104, v104 quad_perm:[1,0,3,2] row_mask:0xf bank_mask:0xf
    v_mul_f32 v104, 0x3ae38e39, v104
    v_lshlrev_b32 v102, 16, v92
    v_and_b32 v103, 0xffff0000, v92
    v_readlane_b32 s56, v104, 0
    v_readlane_b32 s57, v104, 32
    s_nop 0
    v_mov_b32 v104, s56
    v_fma_f32 v105, -v104, v104, s57
    v_max_f32 v105, 0, v105
    v_cvt_pk_bf16_f32 v106, -v104, v105
    v_and_b32 v107, 0xffff0000, v106
    v_add_f32 v107, 0x3727c5ac, v107
    v_lshlrev_b32 v104, 16, v106
    v_cvt_pk_bf16_f32 v107, v107, v107
    v_lshlrev_b32 v107, 16, v107
    v_sqrt_f32 v107, v107
    v_mov_b32 v105, v104
    v_cvt_pk_bf16_f32 v107, v107, v107
    v_lshlrev_b32 v107, 16, v107
    v_rcp_f32 v106, v107
    v_rcp_f32 v107, v107
    v_pk_add_f32 v[94:95], v[94:95], v[104:105]
    v_pk_add_f32 v[96:97], v[96:97], v[104:105]
    v_pk_add_f32 v[98:99], v[98:99], v[104:105]
    v_pk_add_f32 v[100:101], v[100:101], v[104:105]
    v_pk_add_f32 v[102:103], v[102:103], v[104:105]
    v_cvt_pk_bf16_f32 v94, v94, v95
    v_and_b32 v95, 0xffff0000, v94
    v_lshlrev_b32 v94, 16, v94
    v_cvt_pk_bf16_f32 v96, v96, v97
    v_and_b32 v97, 0xffff0000, v96
    v_lshlrev_b32 v96, 16, v96
    v_cvt_pk_bf16_f32 v98, v98, v99
    v_and_b32 v99, 0xffff0000, v98
    v_lshlrev_b32 v98, 16, v98
    v_cvt_pk_bf16_f32 v100, v100, v101
    v_and_b32 v101, 0xffff0000, v100
    v_lshlrev_b32 v100, 16, v100
    v_cvt_pk_bf16_f32 v102, v102, v103
    v_and_b32 v103, 0xffff0000, v102
    v_lshlrev_b32 v102, 16, v102
    v_pk_mul_f32 v[94:95], v[94:95], v[106:107]
    v_pk_mul_f32 v[96:97], v[96:97], v[106:107]
    v_pk_mul_f32 v[98:99], v[98:99], v[106:107]
    v_pk_mul_f32 v[100:101], v[100:101], v[106:107]
    v_pk_mul_f32 v[102:103], v[102:103], v[106:107]
    v_cvt_pk_bf16_f32 v94, v94, v95
    v_and_b32 v95, 0xffff0000, v94
    v_lshlrev_b32 v94, 16, v94
    v_cvt_pk_bf16_f32 v96, v96, v97
    v_and_b32 v97, 0xffff0000, v96
    v_lshlrev_b32 v96, 16, v96
    v_cvt_pk_bf16_f32 v98, v98, v99
    v_and_b32 v99, 0xffff0000, v98
    v_lshlrev_b32 v98, 16, v98
    v_cvt_pk_bf16_f32 v100, v100, v101
    v_and_b32 v101, 0xffff0000, v100
    v_lshlrev_b32 v100, 16, v100
    v_cvt_pk_bf16_f32 v102, v102, v103
    v_and_b32 v103, 0xffff0000, v102
    v_lshlrev_b32 v102, 16, v102
    v_pk_mul_f32 v[94:95], v[94:95], v[66:67]
    v_pk_mul_f32 v[96:97], v[96:97], v[68:69]
    v_pk_mul_f32 v[98:99], v[98:99], v[70:71]
    v_pk_mul_f32 v[100:101], v[100:101], v[72:73]
    v_pk_mul_f32 v[102:103], v[102:103], v[74:75]
    v_cvt_pk_bf16_f32 v94, v94, v95
    v_and_b32 v95, 0xffff0000, v94
    v_lshlrev_b32 v94, 16, v94
    v_cvt_pk_bf16_f32 v96, v96, v97
    v_and_b32 v97, 0xffff0000, v96
    v_lshlrev_b32 v96, 16, v96
    v_cvt_pk_bf16_f32 v98, v98, v99
    v_and_b32 v99, 0xffff0000, v98
    v_lshlrev_b32 v98, 16, v98
    v_cvt_pk_bf16_f32 v100, v100, v101
    v_and_b32 v101, 0xffff0000, v100
    v_lshlrev_b32 v100, 16, v100
    v_cvt_pk_bf16_f32 v102, v102, v103
    v_and_b32 v103, 0xffff0000, v102
    v_lshlrev_b32 v102, 16, v102
    v_pk_add_f32 v[94:95], v[94:95], v[56:57]
    v_pk_add_f32 v[96:97], v[96:97], v[58:59]
    v_pk_add_f32 v[98:99], v[98:99], v[60:61]
    v_pk_add_f32 v[100:101], v[100:101], v[62:63]
    v_pk_add_f32 v[102:103], v[102:103], v[64:65]
    v_cvt_pk_bf16_f32 v110, v94, v95
    v_cvt_pk_bf16_f32 v111, v96, v97
    v_cvt_pk_bf16_f32 v112, v98, v99
    v_cvt_pk_bf16_f32 v113, v100, v101
    v_cvt_pk_bf16_f32 v114, v102, v103
    v_dot2_f32_bf16 v14, v110, v48, 0
    v_dot2_f32_bf16 v14, v111, v49, v14
    v_dot2_f32_bf16 v14, v112, v50, v14
    v_dot2_f32_bf16 v14, v113, v51, v14
    s_mov_b64 exec, 0xffffffff
    v_dot2_f32_bf16 v14, v114, v34, v14
    s_mov_b64 exec, -1
    s_nop 1
    v_mov_b32 v15, v14
    s_nop 1
    v_permlane32_swap_b32 v15, v14
    v_add_f32 v14, v15, v14
    v_mov_b32 v15, v14
    s_nop 1
    v_permlane16_swap_b32 v15, v14
    v_add_f32 v14, v15, v14
    s_nop 1
    v_add_f32_dpp v14, v14, v14 row_ror:8 row_mask:0xf bank_mask:0xf
    s_nop 1
    v_add_f32_dpp v14, v14, v14 row_ror:4 row_mask:0xf bank_mask:0xf
    s_nop 1
    v_add_f32_dpp v14, v14, v14 quad_perm:[2,3,0,1] row_mask:0xf bank_mask:0xf
    s_nop 1
    v_add_f32_dpp v14, v14, v14 quad_perm:[1,0,3,2] row_mask:0xf bank_mask:0xf
    v_cvt_pk_bf16_f32 v14, v14, v14
    v_lshlrev_b32 v14, 16, v14
    v_max_f32 v14, 0xc2ae0000, v14
    v_min_f32 v14, 0x43000000, v14
    v_mul_f32 v15, 0xbfb8aa3b, v14
    v_fma_f32 v16, v14, s98, -v15
    v_fmac_f32 v16, 0xb2a57060, v14
    v_exp_f32 v15, v15
    v_mul_f32 v16, 0x3f317218, v16
    v_fmac_f32 v15, v15, v16
    v_add_f32 v15, 1.0, v15
    v_rcp_f32 v16, v15
    s_nop 0
    v_fma_f32 v15, -v15, v16, 1.0
    v_fma_f32 v14, v15, v16, v16
    v_cvt_pk_bf16_f32 v14, v14, v14
    v_lshlrev_b32 v14, 16, v14
    v_add_f32 v41, v40, v104
    v_cvt_pk_bf16_f32 v41, v41, v41
    v_lshlrev_b32 v41, 16, v41
    v_mul_f32 v41, v41, v106
    v_cvt_pk_bf16_f32 v41, v41, v41
    v_lshlrev_b32 v41, 16, v41
    v_mul_f32 v41, v41, v79
    v_cvt_pk_bf16_f32 v41, v41, v41
    v_lshlrev_b32 v41, 16, v41
    v_add_f32 v41, v41, v77
    v_cvt_pk_bf16_f32 v41, v41, v41
    v_lshlrev_b32 v41, 16, v41
    s_and_b32 s62, s64, 1
    s_lshl1_add_u32 s58, s65, s62
    s_lshl3_add_u32 s58, s58, s3
    s_mul_i32 s58, s58, 9216
    s_branch .Lsk_m2_2
.Lst_m2_2:
    s_branch .Lrt_m2_2
.Lsk_m2_2:
    s_add_u32 s58, s58, 0x1a0000
    s_add_u32 s59, s58, 4096
    s_add_u32 s63, s58, 8192
    s_cmp_eq_u32 s62, 0
    s_mov_b32 s56, 0x00ff00ff
    s_cselect_b32 s62, s56, 0xff00ff00
    s_mov_b32 s60, 0x04000c0c
    s_mov_b32 s61, 0x0706000c
    s_mov_b32 s48, s28
    s_and_b32 s49, s29, 0xffff
    s_mov_b32 s50, 0x2400
    s_mov_b32 s51, 0x00020000
.gp_118:
    buffer_load_dwordx4 v[120:123], v2, s[36:39], s58 offen offset:0 sc1
    buffer_load_dwordx4 v[124:127], v2, s[36:39], s58 offen offset:1024 sc1
    buffer_load_dwordx4 v[128:131], v2, s[36:39], s58 offen offset:2048 sc1
    buffer_load_dwordx4 v[132:135], v2, s[36:39], s58 offen offset:3072 sc1
    buffer_load_dwordx4 v[136:139], v2, s[36:39], s59 offen offset:0 sc1
    buffer_load_dwordx4 v[140:143], v2, s[36:39], s59 offen offset:1024 sc1
    buffer_load_dwordx4 v[144:147], v2, s[36:39], s59 offen offset:2048 sc1
    buffer_load_dwordx4 v[148:151], v2, s[36:39], s59 offen offset:3072 sc1
    buffer_load_dwordx4 v[152:155], v2, s[36:39], s63 offen offset:0 sc1
    s_waitcnt vmcnt(0)
.gpc_119:
    v_min3_u32 v24, v123, v127, v131
    v_max3_u32 v25, v123, v127, v131
    v_min3_u32 v24, v24, v135, v139
    v_max3_u32 v25, v25, v135, v139
    v_min3_u32 v24, v24, v143, v147
    v_max3_u32 v25, v25, v143, v147
    v_min3_u32 v24, v24, v151, v155
    v_max3_u32 v25, v25, v151, v155
    v_cmp_eq_u32 vcc, s34, v24
    v_cmp_eq_u32 s[56:57], s34, v25
    s_and_b64 vcc, vcc, s[56:57]
    s_cmp_eq_u64 vcc, -1
    s_nop 2
    s_cbranch_scc1 .gpd_120
    s_sub_u32 s35, s35, 1
    s_cbranch_scc1 .Lexit
    s_branch .gp_118
.gpd_120:
    v_perm_b32 v123, v120, v121, s60
    v_perm_b32 v123, v123, v122, s61
    v_perm_b32 v127, v124, v125, s60
    v_perm_b32 v127, v127, v126, s61
    v_perm_b32 v131, v128, v129, s60
    v_perm_b32 v131, v131, v130, s61
    v_perm_b32 v135, v132, v133, s60
    v_perm_b32 v135, v135, v134, s61
    v_perm_b32 v139, v136, v137, s60
    v_perm_b32 v139, v139, v138, s61
    v_perm_b32 v143, v140, v141, s60
    v_perm_b32 v143, v143, v142, s61
    v_perm_b32 v147, v144, v145, s60
    v_perm_b32 v147, v147, v146, s61
    v_perm_b32 v151, v148, v149, s60
    v_perm_b32 v151, v151, v150, s61
    v_perm_b32 v155, v152, v153, s60
    v_perm_b32 v155, v155, v154, s61
    v_pk_add_f32 v[120:121], v[120:121], v[124:125]
    v_pk_add_f32 v[122:123], v[122:123], v[126:127]
    v_pk_add_f32 v[128:129], v[128:129], v[132:133]
    v_pk_add_f32 v[130:131], v[130:131], v[134:135]
    v_pk_add_f32 v[136:137], v[136:137], v[140:141]
    v_pk_add_f32 v[138:139], v[138:139], v[142:143]
    v_pk_add_f32 v[144:145], v[144:145], v[148:149]
    v_pk_add_f32 v[146:147], v[146:147], v[150:151]
    v_pk_add_f32 v[120:121], v[120:121], v[128:129]
    v_pk_add_f32 v[122:123], v[122:123], v[130:131]
    v_pk_add_f32 v[136:137], v[136:137], v[144:145]
    v_pk_add_f32 v[138:139], v[138:139], v[146:147]
    v_pk_add_f32 v[120:121], v[120:121], v[136:137]
    v_pk_add_f32 v[122:123], v[122:123], v[138:139]
    v_pk_add_f32 v[120:121], v[120:121], v[152:153]
    v_pk_add_f32 v[122:123], v[122:123], v[154:155]
    s_nop 1
    v_permlane32_swap_b32 v120, v122
    v_permlane32_swap_b32 v121, v123
    v_pk_add_f32 v[120:121], v[120:121], v[122:123]
    s_nop 1
    v_permlane16_swap_b32 v120, v121
    v_add_f32 v120, v120, v121
    s_nop 1
    v_add_f32_dpp v120, v120, v120 row_ror:8 row_mask:0xf bank_mask:0xf
    v_cvt_pk_bf16_f32 v120, v120, v120
    v_lshlrev_b32 v120, 16, v120
    v_mul_f32 v120, v120, v14
    v_cvt_pk_bf16_f32 v120, v120, v120
    v_lshlrev_b32 v120, 16, v120
    v_add_f32 v120, v120, v41
    v_cvt_pk_bf16_f32 v120, v120, v120
    v_lshlrev_b32 v120, 16, v120
    v_mul_f32 v120, v120, v81
    v_cvt_pk_bf16_f32 v120, v120, v120
    v_lshlrev_b32 v120, 16, v120
    v_add_f32 v120, v120, v40
    v_cvt_pk_bf16_f32 v120, v120, v120
    s_mov_b32 exec_lo, s62
    s_mov_b32 exec_hi, s62
    buffer_store_short v120, v7, s[48:51], s100 offen
    s_mov_b64 exec, -1
    s_or_b32 s56, s2, s3
    s_cmp_lg_u32 s56, 0
    s_cbranch_scc1 .Lexit
    v_mov_b32 v13, s34
    v_mov_b32 v12, 0
    s_mov_b64 exec, 1
    buffer_store_dword v13, v12, s[36:39], 0 offen
    s_mov_b64 exec, -1
    s_branch .Lexit
.Lbc:
    s_branch .Lsk_b0_0
.Lst_b0_0:
    s_branch .Lrt_b0_0
.Lsk_b0_0:
    s_sub_u32 s56, s65, 9
    s_mov_b32 s57, 0x63054210
    s_cmp_eq_u32 s65, 14
    s_cselect_b32 s56, s64, s56
    s_cselect_b32 s57, 0x37654210, s57
    s_cselect_b32 s99, 8, s64
    s_lshl_b32 s56, s56, 2
    s_lshr_b32 s56, s57, s56
    s_and_b32 s56, s56, 7
    s_cmp_eq_u32 s65, 17
    s_cselect_b32 s56, 7, s56
    s_lshl3_add_u32 s99, s99, s56
    s_and_b32 s56, s99, 7
    s_cmp_eq_u32 s56, 3
    s_mov_b32 s14, 0xb5b5b5b5
    s_cselect_b32 s14, 0x0, s14
    s_mov_b32 s15, 0xd6d6b6b6
    s_cselect_b32 s15, 0x0, s15
    s_cselect_b32 s30, -50, 0
    s_add_u32 s30, s30, 0
    s_add_u32 s30, s30, s70
    s_mov_b32 s31, s70
    s_mov_b32 s48, s18
    s_and_b32 s49, s19, 0xffff
    s_mov_b32 s50, 0x510000
    s_mov_b32 s51, 0x00020000
    s_mov_b32 s52, s20
    s_and_b32 s53, s21, 0xffff
    s_mov_b32 s54, 0x510000
    s_mov_b32 s55, 0x00020000
    v_bfe_u32 v12, v0, 4, 1
    s_and_b32 s56, s3, 3
    s_lshl_b32 s56, s56, 1
    v_or_b32 v12, s56, v12
    v_and_b32 v6, 7, v0
    v_xor_b32 v12, v12, v6
    v_lshrrev_b32 v6, 3, v0
    v_mul_u32_u24 v6, 9216, v6
    v_lshl_add_u32 v6, v12, 4, v6
    s_mul_i32 s100, s3, 73728
    s_lshl_b32 s56, s99, 7
    s_add_u32 s100, s100, s56
    s_lshl_b32 s101, s3, 10
    s_waitcnt lgkmcnt(0)
    s_add_u32 s34, s34, 1
    s_getreg_b32 s1, hwreg(HW_REG_XCC_ID)
    s_lshl_b32 s1, s1, 24
    s_add_u32 s1, s1, s34
    s_lshr_b32 s0, s2, 3
    s_lshl_b32 s63, s64, 8
    s_add_u32 s0, s0, s63
    s_lshl2_add_u32 s0, s0, 0x480000
    v_mov_b32 v30, s1
    s_cmp_eq_u32 s3, 0
    s_cselect_b64 exec, 1, 0
    buffer_store_dword v30, v2, s[36:39], s0 offen sc1
    s_mov_b64 exec, -1
    v_and_b32 v8, 1, v0
    v_lshlrev_b32 v8, 8, v8
    v_and_b32 v9, 0x3c, v0
    v_lshl_add_u32 v9, v9, 2, v8
    v_add_u32 v7, v9, v8
    v_and_b32 v9, 0x3c, v0
    v_lshrrev_b32 v8, 4, v8
    v_and_b32 v9, 4, v0
    v_lshl_add_u32 v9, v9, 3, v8
    s_lshl_b32 s58, s66, 14
    s_lshl_b32 s59, s67, 10
    s_add_u32 s58, s58, s59
    s_add_u32 s58, s58, 0x70000
    s_lshl4_add_u32 s59, s66, s67
    s_lshl_b32 s59, s59, 7
    s_add_u32 s59, s59, 0x430000
    s_bitcmp1_b64 s[14:15], 4
    s_cbranch_scc0 1
    s_waitcnt vmcnt(4)
    s_add_u32 s63, s69, 32768
    buffer_load_dwordx4 v[96:99], v1, s[40:43], s63 offen nt
    s_waitcnt vmcnt(6)
    s_add_u32 m0, s101, 0
    s_add_u32 s56, s100, 0
    buffer_load_dwordx4 v6, s[48:51], s56 offen nt lds
    s_waitcnt vmcnt(6)
    s_bitcmp1_b64 s[14:15], 5
    s_cbranch_scc0 1
    s_waitcnt vmcnt(4)
    s_add_u32 s63, s69, 40960
    buffer_load_dwordx4 v[100:103], v1, s[40:43], s63 offen nt
    s_waitcnt vmcnt(6)
    s_bitcmp1_b64 s[14:15], 6
    s_cbranch_scc0 1
    s_waitcnt vmcnt(2)
    s_add_u32 s63, s69, 49152
    buffer_load_dwordx4 v[128:131], v1, s[40:43], s63 offen nt
    s_cmp_eq_u32 s3, 0
    s_cbranch_scc1 .Lst_b1_0
    s_cmp_eq_u32 s3, 1
    s_cbranch_scc1 .Lst_b1_1
    s_cmp_eq_u32 s3, 2
    s_cbranch_scc1 .Lst_b1_2
    s_cmp_eq_u32 s3, 3
    s_cbranch_scc1 .Lst_b1_3
    s_cmp_eq_u32 s3, 4
    s_cbranch_scc1 .Lst_b1_4
    s_cmp_eq_u32 s3, 5
    s_cbranch_scc1 .Lst_b1_5
    s_cmp_eq_u32 s3, 6
    s_cbranch_scc1 .Lst_b1_6
    s_cmp_eq_u32 s3, 7
    s_cbranch_scc1 .Lst_b1_7
.Lrt_b1_0:
.Lrt_b1_1:
.Lrt_b1_2:
.Lrt_b1_3:
.Lrt_b1_4:
.Lrt_b1_5:
.Lrt_b1_6:
.Lrt_b1_7:
    s_waitcnt vmcnt(6)
    s_add_u32 m0, s101, 8192
    s_add_u32 s56, s100, 589824
    buffer_load_dwordx4 v6, s[48:51], s56 offen nt lds
    s_waitcnt vmcnt(4)
    s_bitcmp1_b64 s[14:15], 7
    s_cbranch_scc0 1
    s_waitcnt vmcnt(2)
    s_add_u32 s63, s69, 57344
    buffer_load_dwordx4 v[132:135], v1, s[40:43], s63 offen nt
    s_waitcnt vmcnt(4)
    s_bitcmp1_b64 s[14:15], 8
    s_cbranch_scc0 1
    s_waitcnt vmcnt(2)
    s_add_u32 s63, s69, 131072
    buffer_load_dwordx4 v[40:43], v1, s[40:43], s63 offen nt
    s_memrealtime s[8:9]
    s_waitcnt lgkmcnt(0)
    s_sub_u32 s8, s8, s30
    s_cmpk_ge_u32 s8, 437
    s_cbranch_scc1 .ap_121
    s_waitcnt vmcnt(5)
    s_cmpk_ge_u32 s8, 337
    s_cbranch_scc1 .ap_121
    s_waitcnt vmcnt(4)
    s_bitcmp1_b64 s[14:15], 9
    s_cbranch_scc0 1
    s_waitcnt vmcnt(2)
    s_cmpk_ge_u32 s8, 217
    s_cbranch_scc1 .ap_121
    s_waitcnt vmcnt(1)
.ap_121:
    s_add_u32 s63, s69, 139264
    buffer_load_dwordx4 v[44:47], v1, s[40:43], s63 offen nt
    s_memrealtime s[8:9]
    s_waitcnt lgkmcnt(0)
    s_sub_u32 s8, s8, s30
    s_cmpk_ge_u32 s8, 471
    s_cbranch_scc1 .ap_122
    s_waitcnt vmcnt(5)
    s_cmpk_ge_u32 s8, 371
    s_cbranch_scc1 .ap_122
    s_waitcnt vmcnt(4)
    s_bitcmp1_b64 s[14:15], 10
    s_cbranch_scc0 1
    s_waitcnt vmcnt(2)
    s_cmpk_ge_u32 s8, 251
    s_cbranch_scc1 .ap_122
    s_waitcnt vmcnt(1)
.ap_122:
    s_add_u32 s63, s69, 147456
    buffer_load_dwordx4 v[72:75], v1, s[40:43], s63 offen nt
    s_memrealtime s[8:9]
    s_waitcnt lgkmcnt(0)
    s_sub_u32 s8, s8, s30
    s_cmpk_ge_u32 s8, 505
    s_cbranch_scc1 .ap_123
    s_waitcnt vmcnt(5)
    s_cmpk_ge_u32 s8, 405
    s_cbranch_scc1 .ap_123
    s_waitcnt vmcnt(4)
    s_cmpk_ge_u32 s8, 285
    s_cbranch_scc1 .ap_123
    s_waitcnt vmcnt(1)
.ap_123:
    s_add_u32 m0, s101, 16384
    s_add_u32 s56, s100, 1179648
    buffer_load_dwordx4 v6, s[48:51], s56 offen nt lds
    s_memrealtime s[8:9]
    s_waitcnt lgkmcnt(0)
    s_sub_u32 s8, s8, s30
    s_cmpk_ge_u32 s8, 505
    s_cbranch_scc1 .ap_124
    s_waitcnt vmcnt(5)
    s_cmpk_ge_u32 s8, 405
    s_cbranch_scc1 .ap_124
    s_waitcnt vmcnt(4)
    s_bitcmp1_b64 s[14:15], 11
    s_cbranch_scc0 1
    s_waitcnt vmcnt(2)
    s_cmpk_ge_u32 s8, 285
    s_cbranch_scc1 .ap_124
    s_waitcnt vmcnt(1)
.ap_124:
    s_add_u32 s63, s69, 155648
    buffer_load_dwordx4 v[76:79], v1, s[40:43], s63 offen nt
    s_memrealtime s[8:9]
    s_waitcnt vmcnt(8)
    s_waitcnt lgkmcnt(0)
    s_sub_u32 s8, s8, s30
    s_cmpk_ge_u32 s8, 539
    s_cbranch_scc1 .ap_125
    s_waitcnt vmcnt(5)
    s_cmpk_ge_u32 s8, 439
    s_cbranch_scc1 .ap_125
    s_waitcnt vmcnt(4)
    s_bitcmp1_b64 s[14:15], 12
    s_cbranch_scc0 1
    s_waitcnt vmcnt(2)
    s_cmpk_ge_u32 s8, 319
    s_cbranch_scc1 .ap_125
    s_waitcnt vmcnt(1)
.ap_125:
    s_add_u32 s63, s69, 163840
    buffer_load_dwordx4 v[104:107], v1, s[40:43], s63 offen nt
    v_and_b32 v157, 7, v0
    v_lshlrev_b32 v157, 2, v157
    s_mov_b32 s63, 0x4a1100
    s_branch .Lsk_b0_1
.Lst_b0_1:
    s_branch .Lrt_b0_1
.Lsk_b0_1:
    buffer_load_dword v156, v157, s[36:39], s63 offen
    s_memrealtime s[8:9]
    s_waitcnt vmcnt(9)
    s_waitcnt lgkmcnt(0)
    s_sub_u32 s8, s8, s30
    s_cmpk_ge_u32 s8, 573
    s_cbranch_scc1 .ap_126
    s_waitcnt vmcnt(6)
    s_cmpk_ge_u32 s8, 473
    s_cbranch_scc1 .ap_126
    s_waitcnt vmcnt(5)
    s_bitcmp1_b64 s[14:15], 13
    s_cbranch_scc0 1
    s_waitcnt vmcnt(3)
    s_cmpk_ge_u32 s8, 353
    s_cbranch_scc1 .ap_126
    s_waitcnt vmcnt(2)
.ap_126:
    s_add_u32 s63, s69, 172032
    buffer_load_dwordx4 v[108:111], v1, s[40:43], s63 offen nt
    s_memrealtime s[8:9]
    s_waitcnt vmcnt(9)
    s_waitcnt lgkmcnt(0)
    s_sub_u32 s8, s8, s30
    s_cmpk_ge_u32 s8, 607
    s_cbranch_scc1 .ap_127
    s_waitcnt vmcnt(6)
    s_cmpk_ge_u32 s8, 507
    s_cbranch_scc1 .ap_127
    s_waitcnt vmcnt(5)
    s_bitcmp1_b64 s[14:15], 14
    s_cbranch_scc0 1
    s_waitcnt vmcnt(3)
    s_cmpk_ge_u32 s8, 387
    s_cbranch_scc1 .ap_127
    s_waitcnt vmcnt(2)
.ap_127:
    s_add_u32 s63, s69, 180224
    buffer_load_dwordx4 v[136:139], v1, s[40:43], s63 offen nt
    s_memrealtime s[8:9]
    s_waitcnt vmcnt(9)
    s_waitcnt lgkmcnt(0)
    s_sub_u32 s8, s8, s30
    s_cmpk_ge_u32 s8, 641
    s_cbranch_scc1 .ap_128
    s_waitcnt vmcnt(6)
    s_cmpk_ge_u32 s8, 541
    s_cbranch_scc1 .ap_128
    s_waitcnt vmcnt(5)
    s_cmpk_ge_u32 s8, 421
    s_cbranch_scc1 .ap_128
    s_waitcnt vmcnt(1)
.ap_128:
    s_add_u32 m0, s101, 24576
    s_add_u32 s56, s100, 1769472
    buffer_load_dwordx4 v6, s[48:51], s56 offen nt lds
    s_memrealtime s[8:9]
    s_waitcnt vmcnt(9)
    s_waitcnt lgkmcnt(0)
    s_sub_u32 s8, s8, s30
    s_cmpk_ge_u32 s8, 641
    s_cbranch_scc1 .ap_129
    s_waitcnt vmcnt(6)
    s_cmpk_ge_u32 s8, 541
    s_cbranch_scc1 .ap_129
    s_waitcnt vmcnt(5)
    s_bitcmp1_b64 s[14:15], 15
    s_cbranch_scc0 1
    s_waitcnt vmcnt(2)
    s_cmpk_ge_u32 s8, 421
    s_cbranch_scc1 .ap_129
    s_waitcnt vmcnt(1)
.ap_129:
    s_add_u32 s63, s69, 188416
    buffer_load_dwordx4 v[140:143], v1, s[40:43], s63 offen nt
    s_memrealtime s[8:9]
    s_waitcnt vmcnt(9)
    s_waitcnt lgkmcnt(0)
    s_sub_u32 s8, s8, s30
    s_cmpk_ge_u32 s8, 675
    s_cbranch_scc1 .ap_130
    s_waitcnt vmcnt(6)
    s_cmpk_ge_u32 s8, 575
    s_cbranch_scc1 .ap_130
    s_waitcnt vmcnt(5)
    s_bitcmp1_b64 s[14:15], 16
    s_cbranch_scc0 1
    s_waitcnt vmcnt(2)
    s_cmpk_ge_u32 s8, 455
    s_cbranch_scc1 .ap_130
    s_waitcnt vmcnt(1)
.ap_130:
    s_add_u32 s63, s69, 262144
    buffer_load_dwordx4 v[48:51], v1, s[40:43], s63 offen nt
    s_waitcnt vmcnt(5)
    s_sub_u32 s63, s70, 300
    v_subrev_u32 v156, s63, v156
    v_mov_b32 v157, 600
    v_cmp_lt_u32 s[8:9], v156, v157
    v_add_u32_dpp v156, v156, v156 quad_perm:[1,0,3,2] row_mask:0xf bank_mask:0xf
    s_nop 1
    v_add_u32_dpp v156, v156, v156 quad_perm:[2,3,0,1] row_mask:0xf bank_mask:0xf
    s_nop 1
    v_add_u32_dpp v156, v156, v156 row_ror:4 row_mask:0xf bank_mask:0xf
    s_nop 0
    v_readfirstlane_b32 s63, v156
    s_cmp_eq_u64 s[8:9], -1
    s_nop 3
    s_cbranch_scc0 .et_131
    s_lshr_b32 s63, s63, 3
    s_sub_u32 s63, s63, 300
    s_add_u32 s30, s30, s63
    s_add_u32 s31, s31, s63
.et_131:
    s_memrealtime s[8:9]
    s_waitcnt lgkmcnt(0)
    s_sub_u32 s8, s8, s30
    s_cmpk_ge_u32 s8, 709
    s_cbranch_scc1 .ap_132
    s_waitcnt vmcnt(5)
    s_cmpk_ge_u32 s8, 609
    s_cbranch_scc1 .ap_132
    s_waitcnt vmcnt(4)
    s_bitcmp1_b64 s[14:15], 17
    s_cbranch_scc0 1
    s_waitcnt vmcnt(2)
    s_cmpk_ge_u32 s8, 489
    s_cbranch_scc1 .ap_132
    s_waitcnt vmcnt(1)
.ap_132:
    s_add_u32 s63, s69, 270336
    buffer_load_dwordx4 v[52:55], v1, s[40:43], s63 offen nt
    s_memrealtime s[8:9]
    s_waitcnt lgkmcnt(0)
    s_sub_u32 s8, s8, s30
    s_cmpk_ge_u32 s8, 744
    s_cbranch_scc1 .ap_133
    s_waitcnt vmcnt(5)
    s_cmpk_ge_u32 s8, 644
    s_cbranch_scc1 .ap_133
    s_waitcnt vmcnt(4)
    s_bitcmp1_b64 s[14:15], 18
    s_cbranch_scc0 1
    s_waitcnt vmcnt(2)
    s_cmpk_ge_u32 s8, 524
    s_cbranch_scc1 .ap_133
    s_waitcnt vmcnt(1)
.ap_133:
    s_add_u32 s63, s69, 278528
    buffer_load_dwordx4 v[80:83], v1, s[40:43], s63 offen nt
    s_memrealtime s[8:9]
    s_waitcnt lgkmcnt(0)
    s_sub_u32 s8, s8, s30
    s_cmpk_ge_u32 s8, 779
    s_cbranch_scc1 .ap_134
    s_waitcnt vmcnt(5)
    s_cmpk_ge_u32 s8, 679
    s_cbranch_scc1 .ap_134
    s_waitcnt vmcnt(4)
    s_cmpk_ge_u32 s8, 559
    s_cbranch_scc1 .ap_134
    s_waitcnt vmcnt(1)
.ap_134:
    s_add_u32 m0, s101, 32768
    s_add_u32 s56, s100, 2359296
    buffer_load_dwordx4 v6, s[48:51], s56 offen nt lds
    s_memrealtime s[8:9]
    s_waitcnt lgkmcnt(0)
    s_sub_u32 s8, s8, s30
    s_cmpk_ge_u32 s8, 779
    s_cbranch_scc1 .ap_135
    s_waitcnt vmcnt(5)
    s_cmpk_ge_u32 s8, 679
    s_cbranch_scc1 .ap_135
    s_waitcnt vmcnt(4)
    s_bitcmp1_b64 s[14:15], 19
    s_cbranch_scc0 1
    s_waitcnt vmcnt(2)
    s_cmpk_ge_u32 s8, 559
    s_cbranch_scc1 .ap_135
    s_waitcnt vmcnt(1)
.ap_135:
    s_add_u32 s63, s69, 286720
    buffer_load_dwordx4 v[84:87], v1, s[40:43], s63 offen nt
    s_memrealtime s[8:9]
    s_waitcnt vmcnt(8)
    s_waitcnt lgkmcnt(0)
    s_sub_u32 s8, s8, s30
    s_cmpk_ge_u32 s8, 814
    s_cbranch_scc1 .ap_136
    s_waitcnt vmcnt(5)
    s_cmpk_ge_u32 s8, 714
    s_cbranch_scc1 .ap_136
    s_waitcnt vmcnt(4)
    s_bitcmp1_b64 s[14:15], 20
    s_cbranch_scc0 1
    s_waitcnt vmcnt(2)
    s_cmpk_ge_u32 s8, 594
    s_cbranch_scc1 .ap_136
    s_waitcnt vmcnt(1)
.ap_136:
    s_add_u32 s63, s69, 294912
    buffer_load_dwordx4 v[112:115], v1, s[40:43], s63 offen nt
    s_memrealtime s[8:9]
    s_waitcnt vmcnt(8)
    s_waitcnt lgkmcnt(0)
    s_sub_u32 s8, s8, s30
    s_cmpk_ge_u32 s8, 849
    s_cbranch_scc1 .ap_137
    s_waitcnt vmcnt(5)
    s_cmpk_ge_u32 s8, 749
    s_cbranch_scc1 .ap_137
    s_waitcnt vmcnt(4)
    s_bitcmp1_b64 s[14:15], 21
    s_cbranch_scc0 1
    s_waitcnt vmcnt(2)
    s_cmpk_ge_u32 s8, 629
    s_cbranch_scc1 .ap_137
    s_waitcnt vmcnt(1)
.ap_137:
    s_add_u32 s63, s69, 303104
    buffer_load_dwordx4 v[116:119], v1, s[40:43], s63 offen nt
    s_memrealtime s[8:9]
    s_waitcnt vmcnt(8)
    s_waitcnt lgkmcnt(0)
    s_sub_u32 s8, s8, s30
    s_cmpk_ge_u32 s8, 884
    s_cbranch_scc1 .ap_138
    s_waitcnt vmcnt(5)
    s_cmpk_ge_u32 s8, 784
    s_cbranch_scc1 .ap_138
    s_waitcnt vmcnt(4)
    s_bitcmp1_b64 s[14:15], 22
    s_cbranch_scc0 1
    s_waitcnt vmcnt(2)
    s_cmpk_ge_u32 s8, 664
    s_cbranch_scc1 .ap_138
    s_waitcnt vmcnt(1)
.ap_138:
    s_branch .Lsk_b0_2
.Lst_b0_2:
    s_branch .Lrt_b0_2
.Lsk_b0_2:
    s_add_u32 s63, s69, 311296
    buffer_load_dwordx4 v[144:147], v1, s[40:43], s63 offen nt
    s_memrealtime s[8:9]
    s_waitcnt vmcnt(8)
    s_waitcnt lgkmcnt(0)
    s_sub_u32 s8, s8, s30
    s_cmpk_ge_u32 s8, 919
    s_cbranch_scc1 .ap_139
    s_waitcnt vmcnt(5)
    s_cmpk_ge_u32 s8, 819
    s_cbranch_scc1 .ap_139
    s_waitcnt vmcnt(4)
    s_cmpk_ge_u32 s8, 699
    s_cbranch_scc1 .ap_139
    s_waitcnt vmcnt(1)
.ap_139:
    s_add_u32 m0, s101, 40960
    s_add_u32 s56, s100, 2949120
    buffer_load_dwordx4 v6, s[48:51], s56 offen nt lds
    s_memrealtime s[8:9]
    s_waitcnt vmcnt(8)
    s_waitcnt lgkmcnt(0)
    s_sub_u32 s8, s8, s30
    s_cmpk_ge_u32 s8, 919
    s_branch .Lsk_b0_3
.Lst_b0_3:
    s_branch .Lrt_b0_3
.Lsk_b0_3:
    s_cbranch_scc1 .ap_140
    s_waitcnt vmcnt(5)
    s_cmpk_ge_u32 s8, 819
    s_cbranch_scc1 .ap_140
    s_waitcnt vmcnt(4)
    s_bitcmp1_b64 s[14:15], 23
    s_cbranch_scc0 1
    s_waitcnt vmcnt(2)
    s_cmpk_ge_u32 s8, 699
    s_cbranch_scc1 .ap_140
    s_waitcnt vmcnt(1)
.ap_140:
    s_add_u32 s63, s69, 319488
    buffer_load_dwordx4 v[148:151], v1, s[40:43], s63 offen nt
    s_memrealtime s[8:9]
    s_waitcnt vmcnt(8)
    s_waitcnt lgkmcnt(0)
    s_sub_u32 s8, s8, s30
    s_cmpk_ge_u32 s8, 954
    s_cbranch_scc1 .ap_141
    s_waitcnt vmcnt(5)
    s_cmpk_ge_u32 s8, 854
    s_cbranch_scc1 .ap_141
    s_waitcnt vmcnt(4)
    s_bitcmp1_b64 s[14:15], 24
    s_cbranch_scc0 1
    s_waitcnt vmcnt(2)
    s_cmpk_ge_u32 s8, 734
    s_cbranch_scc1 .ap_141
    s_waitcnt vmcnt(1)
.ap_141:
    s_add_u32 s63, s69, 393216
    buffer_load_dwordx4 v[56:59], v1, s[40:43], s63 offen nt
    s_memrealtime s[8:9]
    s_waitcnt vmcnt(8)
    s_waitcnt lgkmcnt(0)
    s_sub_u32 s8, s8, s30
    s_cmpk_ge_u32 s8, 990
    s_cbranch_scc1 .ap_142
    s_waitcnt vmcnt(5)
    s_cmpk_ge_u32 s8, 890
    s_cbranch_scc1 .ap_142
    s_waitcnt vmcnt(4)
    s_bitcmp1_b64 s[14:15], 25
    s_cbranch_scc0 1
    s_waitcnt vmcnt(2)
    s_cmpk_ge_u32 s8, 770
    s_cbranch_scc1 .ap_142
    s_waitcnt vmcnt(1)
.ap_142:
    s_add_u32 s63, s69, 401408
    buffer_load_dwordx4 v[60:63], v1, s[40:43], s63 offen nt
    s_memrealtime s[8:9]
    s_waitcnt vmcnt(8)
    s_waitcnt lgkmcnt(0)
    s_sub_u32 s8, s8, s30
    s_cmpk_ge_u32 s8, 1028
    s_cbranch_scc1 .ap_143
    s_waitcnt vmcnt(5)
    s_cmpk_ge_u32 s8, 928
    s_cbranch_scc1 .ap_143
    s_waitcnt vmcnt(4)
    s_bitcmp1_b64 s[14:15], 26
    s_cbranch_scc0 1
    s_waitcnt vmcnt(2)
    s_cmpk_ge_u32 s8, 808
    s_cbranch_scc1 .ap_143
    s_waitcnt vmcnt(1)
.ap_143:
    s_add_u32 s63, s69, 409600
    buffer_load_dwordx4 v[88:91], v1, s[40:43], s63 offen nt
    s_memrealtime s[8:9]
    s_waitcnt vmcnt(8)
    s_waitcnt lgkmcnt(0)
    s_sub_u32 s8, s8, s30
    s_cmpk_ge_u32 s8, 1067
    s_cbranch_scc1 .ap_144
    s_waitcnt vmcnt(5)
    s_cmpk_ge_u32 s8, 967
    s_cbranch_scc1 .ap_144
    s_waitcnt vmcnt(4)
    s_cmpk_ge_u32 s8, 847
    s_cbranch_scc1 .ap_144
    s_waitcnt vmcnt(1)
.ap_144:
    s_add_u32 m0, s101, 49152
    s_add_u32 s56, s100, 3538944
    buffer_load_dwordx4 v6, s[48:51], s56 offen nt lds
    s_memrealtime s[8:9]
    s_waitcnt vmcnt(8)
    s_waitcnt lgkmcnt(0)
    s_sub_u32 s8, s8, s30
    s_cmpk_ge_u32 s8, 1067
    s_cbranch_scc1 .ap_145
    s_waitcnt vmcnt(5)
    s_cmpk_ge_u32 s8, 967
    s_cbranch_scc1 .ap_145
    s_waitcnt vmcnt(4)
    s_bitcmp1_b64 s[14:15], 27
    s_cbranch_scc0 1
    s_waitcnt vmcnt(2)
    s_cmpk_ge_u32 s8, 847
    s_cbranch_scc1 .ap_145
    s_waitcnt vmcnt(1)
.ap_145:
    s_add_u32 s63, s69, 417792
    buffer_load_dwordx4 v[92:95], v1, s[40:43], s63 offen nt
    s_memrealtime s[8:9]
    s_waitcnt vmcnt(8)
    s_waitcnt lgkmcnt(0)
    s_sub_u32 s8, s8, s30
    s_cmpk_ge_u32 s8, 1106
    s_cbranch_scc1 .ap_146
    s_waitcnt vmcnt(5)
    s_cmpk_ge_u32 s8, 1006
    s_cbranch_scc1 .ap_146
    s_waitcnt vmcnt(4)
    s_bitcmp1_b64 s[14:15], 28
    s_cbranch_scc0 1
    s_waitcnt vmcnt(2)
    s_cmpk_ge_u32 s8, 886
    s_cbranch_scc1 .ap_146
    s_waitcnt vmcnt(1)
.ap_146:
    s_add_u32 s63, s69, 425984
    buffer_load_dwordx4 v[120:123], v1, s[40:43], s63 offen nt
    s_memrealtime s[8:9]
    s_waitcnt vmcnt(8)
    s_waitcnt lgkmcnt(0)
    s_sub_u32 s8, s8, s30
    s_cmpk_ge_u32 s8, 1145
    s_cbranch_scc1 .ap_147
    s_waitcnt vmcnt(5)
    s_cmpk_ge_u32 s8, 1045
    s_cbranch_scc1 .ap_147
    s_waitcnt vmcnt(4)
    s_bitcmp1_b64 s[14:15], 29
    s_cbranch_scc0 1
    s_waitcnt vmcnt(2)
    s_cmpk_ge_u32 s8, 925
    s_cbranch_scc1 .ap_147
    s_waitcnt vmcnt(1)
.ap_147:
    s_add_u32 s63, s69, 434176
    buffer_load_dwordx4 v[124:127], v1, s[40:43], s63 offen nt
    s_memrealtime s[8:9]
    s_waitcnt vmcnt(8)
    s_waitcnt lgkmcnt(0)
    s_sub_u32 s8, s8, s30
    s_cmpk_ge_u32 s8, 1184
    s_cbranch_scc1 .ap_148
    s_waitcnt vmcnt(5)
    s_cmpk_ge_u32 s8, 1084
    s_cbranch_scc1 .ap_148
    s_waitcnt vmcnt(4)
    s_bitcmp1_b64 s[14:15], 30
    s_cbranch_scc0 1
    s_waitcnt vmcnt(2)
    s_cmpk_ge_u32 s8, 964
    s_cbranch_scc1 .ap_148
    s_waitcnt vmcnt(1)
.ap_148:
    s_add_u32 s63, s69, 442368
    buffer_load_dwordx4 v[152:155], v1, s[40:43], s63 offen nt
    s_memrealtime s[8:9]
    s_waitcnt vmcnt(8)
    s_waitcnt lgkmcnt(0)
    s_sub_u32 s8, s8, s30
    s_cmpk_ge_u32 s8, 1223
    s_cbranch_scc1 .ap_149
    s_waitcnt vmcnt(5)
    s_cmpk_ge_u32 s8, 1123
    s_cbranch_scc1 .ap_149
    s_waitcnt vmcnt(4)
    s_cmpk_ge_u32 s8, 1003
    s_cbranch_scc1 .ap_149
    s_waitcnt vmcnt(1)
.ap_149:
    s_add_u32 m0, s101, 57344
    s_add_u32 s56, s100, 4128768
    buffer_load_dwordx4 v6, s[48:51], s56 offen nt lds
    s_memrealtime s[8:9]
    s_waitcnt vmcnt(8)
    s_waitcnt lgkmcnt(0)
    s_sub_u32 s8, s8, s30
    s_cmpk_ge_u32 s8, 1223
    s_cbranch_scc1 .ap_150
    s_waitcnt vmcnt(5)
    s_cmpk_ge_u32 s8, 1123
    s_cbranch_scc1 .ap_150
    s_waitcnt vmcnt(4)
    s_bitcmp1_b64 s[14:15], 31
    s_cbranch_scc0 1
    s_waitcnt vmcnt(2)
    s_cmpk_ge_u32 s8, 1003
    s_cbranch_scc1 .ap_150
    s_waitcnt vmcnt(1)
.ap_150:
    s_add_u32 s63, s69, 450560
    buffer_load_dwordx4 v[156:159], v1, s[40:43], s63 offen nt
    s_memrealtime s[8:9]
    s_waitcnt vmcnt(8)
    s_waitcnt lgkmcnt(0)
    s_sub_u32 s8, s8, s30
    s_cmpk_ge_u32 s8, 1262
    s_cbranch_scc1 .ap_151
    s_waitcnt vmcnt(5)
    s_cmpk_ge_u32 s8, 1162
    s_cbranch_scc1 .ap_151
    s_waitcnt vmcnt(4)
    s_bitcmp1_b64 s[14:15], 32
    s_cbranch_scc0 1
    s_waitcnt vmcnt(2)
    s_cmpk_ge_u32 s8, 1042
    s_cbranch_scc1 .ap_151
    s_waitcnt vmcnt(1)
.ap_151:
    v_bfe_u32 v1, v0, 4, 2
    v_and_b32 v10, 0xf0, v2
    v_lshlrev_b32 v1, 2, v1
    v_bfe_u32 v1, s6, v1, 4
    v_lshl_add_u32 v1, v1, 8, v10
    s_add_u32 s63, s69, 0
    buffer_load_dwordx4 v[160:163], v1, s[44:47], s63 offen nt
    s_memrealtime s[8:9]
    s_waitcnt vmcnt(8)
    s_waitcnt lgkmcnt(0)
    s_sub_u32 s8, s8, s30
    s_cmpk_ge_u32 s8, 1298
    s_cbranch_scc1 .ap_152
    s_waitcnt vmcnt(5)
    s_cmpk_ge_u32 s8, 1198
    s_cbranch_scc1 .ap_152
    s_waitcnt vmcnt(4)
    s_bitcmp1_b64 s[14:15], 33
    s_cbranch_scc0 1
    s_waitcnt vmcnt(2)
    s_cmpk_ge_u32 s8, 1078
    s_cbranch_scc1 .ap_152
    s_waitcnt vmcnt(1)
.ap_152:
    s_add_u32 s63, s69, 8192
    s_branch .Lsk_b1_0
.Lst_b1_0:
    s_branch .Lrt_b1_0
.Lsk_b1_0:
    buffer_load_dwordx4 v[164:167], v1, s[44:47], s63 offen nt
    s_memrealtime s[8:9]
    s_waitcnt vmcnt(8)
    s_waitcnt lgkmcnt(0)
    s_sub_u32 s8, s8, s30
    s_cmpk_ge_u32 s8, 1335
    s_cbranch_scc1 .ap_153
    s_waitcnt vmcnt(5)
    s_cmpk_ge_u32 s8, 1235
    s_cbranch_scc1 .ap_153
    s_waitcnt vmcnt(4)
    s_bitcmp1_b64 s[14:15], 34
    s_cbranch_scc0 1
    s_waitcnt vmcnt(2)
    s_cmpk_ge_u32 s8, 1115
    s_cbranch_scc1 .ap_153
    s_waitcnt vmcnt(1)
.ap_153:
    s_add_u32 s63, s69, 16384
    buffer_load_dwordx4 v[168:171], v1, s[44:47], s63 offen nt
    s_memrealtime s[8:9]
    s_waitcnt vmcnt(8)
    s_waitcnt lgkmcnt(0)
    s_sub_u32 s8, s8, s30
    s_cmpk_ge_u32 s8, 1371
    s_cbranch_scc1 .ap_154
    s_waitcnt vmcnt(5)
    s_cmpk_ge_u32 s8, 1271
    s_cbranch_scc1 .ap_154
    s_waitcnt vmcnt(4)
    s_cmpk_ge_u32 s8, 1151
    s_cbranch_scc1 .ap_154
    s_waitcnt vmcnt(1)
.ap_154:
    s_add_u32 m0, s101, 65536
    s_add_u32 s56, s100, 4718592
    buffer_load_dwordx4 v6, s[48:51], s56 offen nt lds
    s_memrealtime s[8:9]
    s_waitcnt vmcnt(8)
    s_waitcnt lgkmcnt(0)
    s_sub_u32 s8, s8, s30
    s_cmpk_ge_u32 s8, 1371
    s_cbranch_scc1 .ap_155
    s_waitcnt vmcnt(5)
    s_cmpk_ge_u32 s8, 1271
    s_cbranch_scc1 .ap_155
    s_waitcnt vmcnt(4)
    s_bitcmp1_b64 s[14:15], 35
    s_cbranch_scc0 1
    s_waitcnt vmcnt(2)
    s_cmpk_ge_u32 s8, 1151
    s_cbranch_scc1 .ap_155
    s_waitcnt vmcnt(1)
.ap_155:
    s_add_u32 s63, s69, 24576
    buffer_load_dwordx4 v[172:175], v1, s[44:47], s63 offen nt
    s_memrealtime s[8:9]
    s_waitcnt vmcnt(8)
    s_waitcnt lgkmcnt(0)
    s_sub_u32 s8, s8, s30
    s_cmpk_ge_u32 s8, 1408
    s_cbranch_scc1 .ap_156
    s_waitcnt vmcnt(5)
    s_cmpk_ge_u32 s8, 1308
    s_cbranch_scc1 .ap_156
    s_waitcnt vmcnt(4)
    s_bitcmp1_b64 s[14:15], 36
    s_cbranch_scc0 1
    s_waitcnt vmcnt(2)
    s_cmpk_ge_u32 s8, 1188
    s_cbranch_scc1 .ap_156
    s_waitcnt vmcnt(1)
.ap_156:
    s_add_u32 s63, s69, 32768
    buffer_load_dwordx4 v[176:179], v1, s[44:47], s63 offen nt
    buffer_load_dwordx4 v[16:19], v7, s[36:39], s58 offen offset:0 sc1
    buffer_load_dwordx4 v[20:23], v7, s[36:39], s58 offen offset:256 sc1
    s_memrealtime s[8:9]
    s_waitcnt vmcnt(8)
    s_waitcnt lgkmcnt(0)
    s_sub_u32 s8, s8, s30
    s_cmpk_ge_u32 s8, 1444
    s_cbranch_scc1 .ap_157
    s_waitcnt vmcnt(5)
    s_cmpk_ge_u32 s8, 1344
    s_cbranch_scc1 .ap_157
    s_waitcnt vmcnt(4)
    s_bitcmp1_b64 s[14:15], 37
    s_cbranch_scc0 1
    s_waitcnt vmcnt(2)
    s_cmpk_ge_u32 s8, 1224
    s_cbranch_scc1 .ap_157
    s_waitcnt vmcnt(1)
.ap_157:
    s_add_u32 s63, s69, 40960
    buffer_load_dwordx4 v[180:183], v1, s[44:47], s63 offen nt
    s_memrealtime s[8:9]
    s_waitcnt vmcnt(8)
    s_waitcnt lgkmcnt(0)
    s_sub_u32 s8, s8, s30
    s_cmpk_ge_u32 s8, 1481
    s_cbranch_scc1 .ap_158
    s_waitcnt vmcnt(5)
    s_cmpk_ge_u32 s8, 1381
    s_cbranch_scc1 .ap_158
    s_waitcnt vmcnt(4)
    s_bitcmp1_b64 s[14:15], 38
    s_cbranch_scc0 1
    s_waitcnt vmcnt(2)
    s_cmpk_ge_u32 s8, 1261
    s_cbranch_scc1 .ap_158
    s_waitcnt vmcnt(1)
.ap_158:
    s_add_u32 s63, s69, 49152
    buffer_load_dwordx4 v[184:187], v1, s[44:47], s63 offen nt
    s_memrealtime s[8:9]
    s_waitcnt vmcnt(8)
    s_waitcnt lgkmcnt(0)
    s_sub_u32 s8, s8, s30
    s_cmpk_ge_u32 s8, 1517
    s_cbranch_scc1 .ap_159
    s_waitcnt vmcnt(5)
    s_cmpk_ge_u32 s8, 1417
    s_cbranch_scc1 .ap_159
    s_waitcnt vmcnt(4)
    s_cmpk_ge_u32 s8, 1297
    s_cbranch_scc1 .ap_159
    s_waitcnt vmcnt(1)
.ap_159:
    s_add_u32 m0, s101, 73728
    s_add_u32 s56, s100, 0
    buffer_load_dwordx4 v6, s[52:55], s56 offen nt lds
    s_memrealtime s[8:9]
    s_waitcnt vmcnt(8)
    s_waitcnt lgkmcnt(0)
    s_sub_u32 s8, s8, s30
    s_cmpk_ge_u32 s8, 1517
    s_cbranch_scc1 .ap_160
    s_waitcnt vmcnt(5)
    s_cmpk_ge_u32 s8, 1417
    s_cbranch_scc1 .ap_160
    s_waitcnt vmcnt(4)
    s_bitcmp1_b64 s[14:15], 39
    s_cbranch_scc0 1
    s_waitcnt vmcnt(2)
    s_cmpk_ge_u32 s8, 1297
    s_cbranch_scc1 .ap_160
    s_waitcnt vmcnt(1)
.ap_160:
    s_add_u32 s63, s69, 57344
    buffer_load_dwordx4 v[188:191], v1, s[44:47], s63 offen nt
    s_memrealtime s[8:9]
    s_waitcnt vmcnt(8)
    s_waitcnt lgkmcnt(0)
    s_sub_u32 s8, s8, s30
    s_cmpk_ge_u32 s8, 1554
    s_cbranch_scc1 .ap_161
    s_waitcnt vmcnt(5)
    s_cmpk_ge_u32 s8, 1454
    s_cbranch_scc1 .ap_161
    s_waitcnt vmcnt(4)
    s_bitcmp1_b64 s[14:15], 40
    s_cbranch_scc0 1
    s_waitcnt vmcnt(2)
    s_cmpk_ge_u32 s8, 1334
    s_cbranch_scc1 .ap_161
    s_waitcnt vmcnt(1)
.ap_161:
    s_add_u32 s63, s69, 131072
    buffer_load_dwordx4 v[192:195], v1, s[44:47], s63 offen nt
    s_waitcnt vmcnt(5)
    s_branch .gpc_163
.gp_162:
    buffer_load_dwordx4 v[16:19], v7, s[36:39], s58 offen offset:0 sc1
    buffer_load_dwordx4 v[20:23], v7, s[36:39], s58 offen offset:256 sc1
    s_waitcnt vmcnt(0)
.gpc_163:
    v_min_u32 v10, v17, v19
    v_max_u32 v11, v17, v19
    v_min3_u32 v10, v10, v21, v23
    v_max3_u32 v11, v11, v21, v23
    v_cmp_eq_u32 vcc, s34, v10
    v_cmp_eq_u32 s[56:57], s34, v11
    s_and_b64 vcc, vcc, s[56:57]
    s_cmp_eq_u64 vcc, -1
    s_nop 2
    s_cbranch_scc1 .gpd_164
    s_sub_u32 s35, s35, 1
    s_cbranch_scc1 .Lexit
    s_sleep 1
    s_branch .gp_162
.gpd_164:
    s_mov_b32 vcc_lo, 0xcccccccc
    s_mov_b32 vcc_hi, 0xcccccccc
    v_cndmask_b32_e64 v24, v16, 0, vcc
    v_cndmask_b32_e64 v25, v18, 0, vcc
    v_cndmask_b32_e64 v26, v20, 0, vcc
    v_cndmask_b32_e64 v27, v22, 0, vcc
    v_cndmask_b32_e32 v28, 0, v16, vcc
    v_cndmask_b32_e32 v29, 0, v18, vcc
    v_cndmask_b32_e32 v30, 0, v20, vcc
    v_cndmask_b32_e32 v31, 0, v22, vcc
    v_mfma_f32_16x16x32_bf16 v[16:19], v[32:35], v[24:27], 0
    v_mfma_f32_16x16x32_bf16 v[32:35], v[40:43], v[24:27], 0
    v_mfma_f32_16x16x32_bf16 v[16:19], v[36:39], v[28:31], v[16:19]
    v_mfma_f32_16x16x32_bf16 v[40:43], v[48:51], v[24:27], 0
    v_mfma_f32_16x16x32_bf16 v[32:35], v[44:47], v[28:31], v[32:35]
    v_mfma_f32_16x16x32_bf16 v[48:51], v[56:59], v[24:27], 0
    v_mfma_f32_16x16x32_bf16 v[40:43], v[52:55], v[28:31], v[40:43]
    v_mfma_f32_16x16x32_bf16 v[56:59], v[64:67], v[24:27], 0
    v_mfma_f32_16x16x32_bf16 v[48:51], v[60:63], v[28:31], v[48:51]
    s_nop 1
    v_add_f32_dpp v10, v17, v16 row_ror:12 row_mask:0xf bank_mask:0x1
    s_memrealtime s[8:9]
    s_waitcnt lgkmcnt(0)
    s_sub_u32 s8, s8, s30
    s_cmpk_ge_u32 s8, 1591
    s_nop 0
    s_cbranch_scc1 .ap_165
    s_waitcnt vmcnt(5)
    s_cmpk_ge_u32 s8, 1491
    s_cbranch_scc1 .ap_165
    s_waitcnt vmcnt(4)
    s_bitcmp1_b64 s[14:15], 41
    s_cbranch_scc0 1
    s_waitcnt vmcnt(2)
    s_cmpk_ge_u32 s8, 1371
    s_cbranch_scc1 .ap_165
    s_branch .Lsk_b1_1
.Lst_b1_1:
    s_branch .Lrt_b1_1
.Lsk_b1_1:
    s_waitcnt vmcnt(1)
.ap_165:
    s_add_u32 s63, s69, 139264
    buffer_load_dwordx4 v[196:199], v1, s[44:47], s63 offen nt
    v_mfma_f32_16x16x32_bf16 v[64:67], v[72:75], v[24:27], 0
    v_mfma_f32_16x16x32_bf16 v[56:59], v[68:71], v[28:31], v[56:59]
    v_add_f32_dpp v11, v33, v32 row_ror:12 row_mask:0xf bank_mask:0x1
    v_add_f32_dpp v10, v18, v10 row_ror:8 row_mask:0xf bank_mask:0x1
    v_mfma_f32_16x16x32_bf16 v[72:75], v[80:83], v[24:27], 0
    v_mfma_f32_16x16x32_bf16 v[64:67], v[76:79], v[28:31], v[64:67]
    v_add_f32_dpp v12, v41, v40 row_ror:12 row_mask:0xf bank_mask:0x1
    v_add_f32_dpp v11, v34, v11 row_ror:8 row_mask:0xf bank_mask:0x1
    v_add_f32_dpp v10, v19, v10 row_ror:4 row_mask:0xf bank_mask:0x1
    v_mfma_f32_16x16x32_bf16 v[80:83], v[88:91], v[24:27], 0
    v_mfma_f32_16x16x32_bf16 v[72:75], v[84:87], v[28:31], v[72:75]
    v_add_f32_dpp v13, v49, v48 row_ror:12 row_mask:0xf bank_mask:0x1
    v_add_f32_dpp v12, v42, v12 row_ror:8 row_mask:0xf bank_mask:0x1
    v_add_f32_dpp v11, v35, v11 row_ror:4 row_mask:0xf bank_mask:0x1
    v_mfma_f32_16x16x32_bf16 v[88:91], v[96:99], v[24:27], 0
    v_mfma_f32_16x16x32_bf16 v[80:83], v[92:95], v[28:31], v[80:83]
    v_add_f32_dpp v10, v58, v57 row_ror:12 row_mask:0xf bank_mask:0x2
    v_add_f32_dpp v13, v50, v13 row_ror:8 row_mask:0xf bank_mask:0x1
    v_add_f32_dpp v12, v43, v12 row_ror:4 row_mask:0xf bank_mask:0x1
    s_memrealtime s[8:9]
    s_waitcnt lgkmcnt(0)
    s_sub_u32 s8, s8, s30
    s_cmpk_ge_u32 s8, 1612
    s_nop 0
    s_cbranch_scc1 .ap_166
    s_waitcnt vmcnt(5)
    s_cmpk_ge_u32 s8, 1512
    s_cbranch_scc1 .ap_166
    s_waitcnt vmcnt(4)
    s_bitcmp1_b64 s[14:15], 42
    s_cbranch_scc0 1
    s_waitcnt vmcnt(2)
    s_cmpk_ge_u32 s8, 1392
    s_cbranch_scc1 .ap_166
    s_waitcnt vmcnt(1)
.ap_166:
    s_add_u32 s63, s69, 147456
    buffer_load_dwordx4 v[200:203], v1, s[44:47], s63 offen nt
    s_memrealtime s[8:9]
    s_waitcnt lgkmcnt(0)
    s_sub_u32 s8, s8, s30
    s_cmpk_ge_u32 s8, 1633
    s_cbranch_scc1 .ap_167
    s_waitcnt vmcnt(5)
    s_cmpk_ge_u32 s8, 1533
    s_cbranch_scc1 .ap_167
    s_waitcnt vmcnt(4)
    s_cmpk_ge_u32 s8, 1413
    s_cbranch_scc1 .ap_167
    s_waitcnt vmcnt(1)
.ap_167:
    s_add_u32 m0, s101, 81920
    s_add_u32 s56, s100, 589824
    buffer_load_dwordx4 v6, s[52:55], s56 offen nt lds
    v_mfma_f32_16x16x32_bf16 v[96:99], v[104:107], v[24:27], 0
    v_mfma_f32_16x16x32_bf16 v[88:91], v[100:103], v[28:31], v[88:91]
    v_add_f32_dpp v11, v66, v65 row_ror:12 row_mask:0xf bank_mask:0x2
    v_add_f32_dpp v10, v59, v10 row_ror:8 row_mask:0xf bank_mask:0x2
    v_add_f32_dpp v13, v51, v13 row_ror:4 row_mask:0xf bank_mask:0x1
    v_mfma_f32_16x16x32_bf16 v[104:107], v[112:115], v[24:27], 0
    v_mfma_f32_16x16x32_bf16 v[96:99], v[108:111], v[28:31], v[96:99]
    v_add_f32_dpp v12, v74, v73 row_ror:12 row_mask:0xf bank_mask:0x2
    v_add_f32_dpp v11, v67, v11 row_ror:8 row_mask:0xf bank_mask:0x2
    v_add_f32_dpp v10, v56, v10 row_ror:4 row_mask:0xf bank_mask:0x2
    v_mfma_f32_16x16x32_bf16 v[112:115], v[120:123], v[24:27], 0
    v_mfma_f32_16x16x32_bf16 v[104:107], v[116:119], v[28:31], v[104:107]
    v_add_f32_dpp v13, v82, v81 row_ror:12 row_mask:0xf bank_mask:0x2
    v_add_f32_dpp v12, v75, v12 row_ror:8 row_mask:0xf bank_mask:0x2
    v_add_f32_dpp v11, v64, v11 row_ror:4 row_mask:0xf bank_mask:0x2
    v_mfma_f32_16x16x32_bf16 v[120:123], v[128:131], v[24:27], 0
    v_mfma_f32_16x16x32_bf16 v[112:115], v[124:127], v[28:31], v[112:115]
    v_add_f32_dpp v10, v91, v90 row_ror:12 row_mask:0xf bank_mask:0x4
    v_add_f32_dpp v13, v83, v13 row_ror:8 row_mask:0xf bank_mask:0x2
    v_add_f32_dpp v12, v72, v12 row_ror:4 row_mask:0xf bank_mask:0x2
    s_memrealtime s[8:9]
    s_waitcnt lgkmcnt(0)
    s_sub_u32 s8, s8, s30
    s_cmpk_ge_u32 s8, 1633
    s_nop 0
    s_cbranch_scc1 .ap_168
    s_waitcnt vmcnt(5)
    s_cmpk_ge_u32 s8, 1533
    s_cbranch_scc1 .ap_168
    s_waitcnt vmcnt(4)
    s_bitcmp1_b64 s[14:15], 43
    s_cbranch_scc0 1
    s_waitcnt vmcnt(2)
    s_cmpk_ge_u32 s8, 1413
    s_cbranch_scc1 .ap_168
    s_waitcnt vmcnt(1)
.ap_168:
    s_add_u32 s63, s69, 155648
    buffer_load_dwordx4 v[204:207], v1, s[44:47], s63 offen nt
    v_mfma_f32_16x16x32_bf16 v[128:131], v[136:139], v[24:27], 0
    v_mfma_f32_16x16x32_bf16 v[120:123], v[132:135], v[28:31], v[120:123]
    v_add_f32_dpp v11, v99, v98 row_ror:12 row_mask:0xf bank_mask:0x4
    v_add_f32_dpp v10, v88, v10 row_ror:8 row_mask:0xf bank_mask:0x4
    v_add_f32_dpp v13, v80, v13 row_ror:4 row_mask:0xf bank_mask:0x2
    v_mfma_f32_16x16x32_bf16 v[136:139], v[144:147], v[24:27], 0
    v_mfma_f32_16x16x32_bf16 v[128:131], v[140:143], v[28:31], v[128:131]
    v_add_f32_dpp v12, v107, v106 row_ror:12 row_mask:0xf bank_mask:0x4
    v_add_f32_dpp v11, v96, v11 row_ror:8 row_mask:0xf bank_mask:0x4
    v_add_f32_dpp v10, v89, v10 row_ror:4 row_mask:0xf bank_mask:0x4
    v_mfma_f32_16x16x32_bf16 v[144:147], v[152:155], v[24:27], 0
    v_mfma_f32_16x16x32_bf16 v[136:139], v[148:151], v[28:31], v[136:139]
    v_add_f32_dpp v13, v115, v114 row_ror:12 row_mask:0xf bank_mask:0x4
    v_add_f32_dpp v12, v104, v12 row_ror:8 row_mask:0xf bank_mask:0x4
    v_add_f32_dpp v11, v97, v11 row_ror:4 row_mask:0xf bank_mask:0x4
    v_mfma_f32_16x16x32_bf16 v[144:147], v[156:159], v[28:31], v[144:147]
    v_add_f32_dpp v10, v120, v123 row_ror:12 row_mask:0xf bank_mask:0x8
    v_add_f32_dpp v13, v112, v13 row_ror:8 row_mask:0xf bank_mask:0x4
    v_add_f32_dpp v12, v105, v12 row_ror:4 row_mask:0xf bank_mask:0x4
    s_memrealtime s[8:9]
    s_waitcnt vmcnt(8)
    s_waitcnt lgkmcnt(0)
    s_sub_u32 s8, s8, s30
    s_cmpk_ge_u32 s8, 1654
    s_cbranch_scc1 .ap_169
    s_waitcnt vmcnt(5)
    s_cmpk_ge_u32 s8, 1554
    s_cbranch_scc1 .ap_169
    s_waitcnt vmcnt(4)
    s_bitcmp1_b64 s[14:15], 44
    s_cbranch_scc0 1
    s_waitcnt vmcnt(2)
    s_cmpk_ge_u32 s8, 1434
    s_cbranch_scc1 .ap_169
    s_waitcnt vmcnt(1)
.ap_169:
    s_add_u32 s63, s69, 163840
    buffer_load_dwordx4 v[208:211], v1, s[44:47], s63 offen nt
    s_cmp_eq_u32 s3, 0
    s_cbranch_scc1 .Lst_b2_0
    s_cmp_eq_u32 s3, 1
    s_cbranch_scc1 .Lst_b2_1
    s_cmp_eq_u32 s3, 2
    s_cbranch_scc1 .Lrt_b2_2
    s_cmp_eq_u32 s3, 3
    s_cbranch_scc1 .Lrt_b2_3
.Lrt_b2_0:
.Lrt_b2_1:
.Lrt_b2_2:
.Lrt_b2_3:
    v_add_f32_dpp v11, v128, v131 row_ror:12 row_mask:0xf bank_mask:0x8
    v_add_f32_dpp v10, v121, v10 row_ror:8 row_mask:0xf bank_mask:0x8
    v_add_f32_dpp v13, v113, v13 row_ror:4 row_mask:0xf bank_mask:0x4
    v_add_f32_dpp v12, v136, v139 row_ror:12 row_mask:0xf bank_mask:0x8
    v_add_f32_dpp v11, v129, v11 row_ror:8 row_mask:0xf bank_mask:0x8
    v_add_f32_dpp v10, v122, v10 row_ror:4 row_mask:0xf bank_mask:0x8
    v_add_f32_dpp v13, v144, v147 row_ror:12 row_mask:0xf bank_mask:0x8
    v_add_f32_dpp v12, v137, v12 row_ror:8 row_mask:0xf bank_mask:0x8
    v_add_f32_dpp v11, v130, v11 row_ror:4 row_mask:0xf bank_mask:0x8
    v_add_f32_dpp v13, v145, v13 row_ror:8 row_mask:0xf bank_mask:0x8
    v_add_f32_dpp v12, v138, v12 row_ror:4 row_mask:0xf bank_mask:0x8
    s_memrealtime s[8:9]
    s_waitcnt vmcnt(8)
    s_waitcnt lgkmcnt(0)
    s_sub_u32 s8, s8, s30
    s_cmpk_ge_u32 s8, 1676
    s_cbranch_scc1 .ap_170
    s_waitcnt vmcnt(5)
    s_cmpk_ge_u32 s8, 1576
    s_cbranch_scc1 .ap_170
    s_waitcnt vmcnt(4)
    s_bitcmp1_b64 s[14:15], 45
    s_cbranch_scc0 1
    s_waitcnt vmcnt(2)
    s_cmpk_ge_u32 s8, 1456
    s_cbranch_scc1 .ap_170
    s_waitcnt vmcnt(1)
.ap_170:
    s_add_u32 s63, s69, 172032
    buffer_load_dwordx4 v[212:215], v1, s[44:47], s63 offen nt
    v_add_f32_dpp v13, v146, v13 row_ror:4 row_mask:0xf bank_mask:0x8
    s_mov_b32 s60, 0x3db504f3
    s_mov_b32 s61, 0x3db504f3
    v_cvt_pk_bf16_f32 v10, v10, v11
    v_and_b32 v11, 0xffff0000, v10
    v_lshlrev_b32 v10, 16, v10
    v_cvt_pk_bf16_f32 v12, v12, v13
    v_and_b32 v13, 0xffff0000, v12
    v_lshlrev_b32 v12, 16, v12
    s_branch .Lsk_b1_2
.Lst_b1_2:
    s_branch .Lrt_b1_2
.Lsk_b1_2:
    v_pk_mul_f32 v[10:11], v[10:11], s[60:61]
    v_pk_mul_f32 v[12:13], v[12:13], s[60:61]
    v_cvt_pk_bf16_f32 v10, v10, v11
    v_and_b32 v11, 0xffff0000, v10
    v_lshlrev_b32 v10, 16, v10
    v_cvt_pk_bf16_f32 v12, v12, v13
    v_and_b32 v13, 0xffff0000, v12
    v_lshlrev_b32 v12, 16, v12
    v_max_f32 v14, v10, v11
    v_max3_f32 v14, v14, v12, v13
    s_mov_b32 s60, 0x3fb8aa3b
    v_mov_b32 v22, s34
    v_mov_b32 v23, s34
    v_max_f32_dpp v14, v14, v14 quad_perm:[2,3,0,1] row_mask:0xf bank_mask:0xf
    s_nop 1
    v_max_f32_dpp v14, v14, v14 row_ror:4 row_mask:0xf bank_mask:0xf
    s_nop 1
    v_max_f32_dpp v14, v14, v14 row_ror:8 row_mask:0xf bank_mask:0xf
    v_mov_b32 v15, v14
    s_nop 1
    v_permlane16_swap_b32 v15, v14
    v_max_f32 v14, v15, v14
    v_mov_b32 v15, v14
    s_nop 1
    v_permlane32_swap_b32 v15, v14
    v_max_f32 v14, v15, v14
    v_mul_f32 v15, 0xbfb8aa3b, v14
    v_fma_f32 v10, v10, s60, v15
    v_fma_f32 v11, v11, s60, v15
    v_fma_f32 v12, v12, s60, v15
    v_fma_f32 v13, v13, s60, v15
    v_exp_f32 v10, v10
    v_exp_f32 v11, v11
    v_exp_f32 v12, v12
    v_exp_f32 v13, v13
    v_mov_b32 v20, v14
    v_pk_add_f32 v[16:17], v[10:11], v[12:13]
    v_add_f32 v21, v16, v17
    s_lshl_b32 s60, s68, 5
    s_lshl_b32 s61, s3, 4
    s_add_u32 s61, s61, 159104
    v_add_u32 v16, s61, v3
    v_mov_b32 v17, 159232
    v_mov_b32 v18, 1
    s_add_u32 s60, s60, s59
    v_add_f32_dpp v21, v21, v21 quad_perm:[2,3,0,1] row_mask:0xf bank_mask:0xf
    s_nop 1
    v_add_f32_dpp v21, v21, v21 row_ror:4 row_mask:0xf bank_mask:0xf
    s_nop 1
    v_add_f32_dpp v21, v21, v21 row_ror:8 row_mask:0xf bank_mask:0xf
    v_mov_b32 v15, v21
    s_nop 1
    v_permlane16_swap_b32 v15, v21
    v_add_f32 v21, v15, v21
    v_mov_b32 v15, v21
    s_nop 1
    v_permlane32_swap_b32 v15, v21
    v_add_f32 v21, v15, v21
    s_mov_b64 exec, 3
    ds_write_b64 v16, v[20:21]
    s_mov_b64 exec, 1
    ds_add_rtn_u32 v18, v17, v18
    s_mov_b64 exec, -1
    v_and_b32 v16, 0x78, v3
    v_or_b32 v16, 159104, v16
    s_waitcnt lgkmcnt(0)
    v_readfirstlane_b32 s61, v18
    s_cmp_eq_u32 s61, 7
    s_nop 3
    s_cbranch_scc0 .mlc_171
    ds_read_b64 v[18:19], v16
    s_waitcnt lgkmcnt(0)
    v_mov_b32 v20, v18
    s_nop 1
    v_max_f32_dpp v20, v20, v20 quad_perm:[2,3,0,1] row_mask:0xf bank_mask:0xf
    s_nop 1
    v_max_f32_dpp v20, v20, v20 row_ror:4 row_mask:0xf bank_mask:0xf
    s_nop 1
    v_max_f32_dpp v20, v20, v20 row_ror:8 row_mask:0xf bank_mask:0xf
    v_sub_f32 v18, v18, v20
    v_mul_f32 v18, 0x3fb8aa3b, v18
    v_exp_f32 v18, v18
    s_nop 0
    v_mul_f32 v21, v18, v19
    s_nop 1
    v_add_f32_dpp v21, v21, v21 quad_perm:[2,3,0,1] row_mask:0xf bank_mask:0xf
    s_nop 1
    v_add_f32_dpp v21, v21, v21 row_ror:4 row_mask:0xf bank_mask:0xf
    s_nop 1
    v_add_f32_dpp v21, v21, v21 row_ror:8 row_mask:0xf bank_mask:0xf
    s_mov_b64 exec, 3
    buffer_store_dwordx4 v[20:23], v2, s[36:39], s60 offen sc1
    s_mov_b64 exec, -1
.mlc_171:
    s_memrealtime s[8:9]
    s_waitcnt vmcnt(8)
    s_waitcnt lgkmcnt(0)
    s_sub_u32 s8, s8, s30
    s_cmpk_ge_u32 s8, 1708
    s_cbranch_scc1 .ap_172
    s_waitcnt vmcnt(5)
    s_cmpk_ge_u32 s8, 1608
    s_cbranch_scc1 .ap_172
    s_waitcnt vmcnt(4)
    s_bitcmp1_b64 s[14:15], 46
    s_cbranch_scc0 1
    s_waitcnt vmcnt(2)
    s_cmpk_ge_u32 s8, 1488
    s_cbranch_scc1 .ap_172
    s_waitcnt vmcnt(1)
.ap_172:
    s_add_u32 s63, s69, 180224
    buffer_load_dwordx4 v[216:219], v1, s[44:47], s63 offen nt
    s_memrealtime s[8:9]
    s_waitcnt vmcnt(8)
    s_waitcnt lgkmcnt(0)
    s_sub_u32 s8, s8, s30
    s_cmpk_ge_u32 s8, 1740
    s_cbranch_scc1 .ap_173
    s_waitcnt vmcnt(5)
    s_cmpk_ge_u32 s8, 1640
    s_cbranch_scc1 .ap_173
    s_waitcnt vmcnt(4)
    s_bitcmp1_b64 s[14:15], 47
    s_cbranch_scc0 1
    s_waitcnt vmcnt(2)
    s_cmpk_ge_u32 s8, 1520
    s_cbranch_scc1 .ap_173
    s_waitcnt vmcnt(1)
.ap_173:
    s_add_u32 s63, s69, 188416
    buffer_load_dwordx4 v[220:223], v1, s[44:47], s63 offen nt
    s_and_b32 s56, s64, 0
    s_mul_i32 s56, s56, 18432
    s_mul_i32 s57, s3, 2304
    s_add_u32 s56, s56, s57
    s_add_u32 s56, s56, 0x37000
    buffer_load_dwordx4 v[32:35], v2, s[36:39], s56 offen offset:0 sc1
    buffer_load_dwordx4 v[40:43], v2, s[36:39], s56 offen offset:1024 sc1
    buffer_load_dwordx2 v[48:49], v5, s[36:39], s56 offen offset:0 sc1
    s_memrealtime s[8:9]
    s_waitcnt vmcnt(11)
    s_waitcnt lgkmcnt(0)
    s_sub_u32 s8, s8, s30
    s_cmpk_ge_u32 s8, 1772
    s_cbranch_scc1 .ap_174
    s_waitcnt vmcnt(8)
    s_cmpk_ge_u32 s8, 1672
    s_cbranch_scc1 .ap_174
    s_waitcnt vmcnt(7)
    s_bitcmp1_b64 s[14:15], 48
    s_cbranch_scc0 1
    s_waitcnt vmcnt(5)
    s_cmpk_ge_u32 s8, 1552
    s_cbranch_scc1 .ap_174
    s_waitcnt vmcnt(4)
.ap_174:
    s_add_u32 s63, s69, 262144
    buffer_load_dwordx4 v[224:227], v1, s[44:47], s63 offen nt
    s_memrealtime s[8:9]
    s_branch .Lsk_b1_3
.Lst_b1_3:
    s_branch .Lrt_b1_3
.Lsk_b1_3:
    s_waitcnt vmcnt(11)
    s_waitcnt lgkmcnt(0)
    s_sub_u32 s8, s8, s30
    s_cmpk_ge_u32 s8, 1804
    s_cbranch_scc1 .ap_175
    s_waitcnt vmcnt(8)
    s_cmpk_ge_u32 s8, 1704
    s_cbranch_scc1 .ap_175
    s_waitcnt vmcnt(7)
    s_bitcmp1_b64 s[14:15], 49
    s_cbranch_scc0 1
    s_waitcnt vmcnt(5)
    s_cmpk_ge_u32 s8, 1584
    s_cbranch_scc1 .ap_175
    s_waitcnt vmcnt(4)
.ap_175:
    s_add_u32 s63, s69, 270336
    buffer_load_dwordx4 v[228:231], v1, s[44:47], s63 offen nt
    s_and_b32 s56, s64, 0
    s_mul_i32 s56, s56, 18432
    s_mul_i32 s57, s3, 2304
    s_add_u32 s56, s56, s57
    s_add_u32 s56, s56, 0x49000
    buffer_load_dwordx4 v[56:59], v2, s[36:39], s56 offen offset:0 sc1
    buffer_load_dwordx4 v[64:67], v2, s[36:39], s56 offen offset:1024 sc1
    buffer_load_dwordx2 v[72:73], v5, s[36:39], s56 offen offset:0 sc1
    s_memrealtime s[8:9]
    s_waitcnt vmcnt(14)
    s_waitcnt lgkmcnt(0)
    s_sub_u32 s8, s8, s30
    s_cmpk_ge_u32 s8, 1836
    s_cbranch_scc1 .ap_176
    s_waitcnt vmcnt(11)
    s_cmpk_ge_u32 s8, 1736
    s_cbranch_scc1 .ap_176
    s_waitcnt vmcnt(10)
    s_bitcmp1_b64 s[14:15], 50
    s_cbranch_scc0 1
    s_waitcnt vmcnt(8)
    s_cmpk_ge_u32 s8, 1616
    s_cbranch_scc1 .ap_176
    s_waitcnt vmcnt(4)
.ap_176:
    s_add_u32 s63, s69, 278528
    buffer_load_dwordx4 v[232:235], v1, s[44:47], s63 offen nt
    s_memrealtime s[8:9]
    s_waitcnt vmcnt(14)
    s_waitcnt lgkmcnt(0)
    s_sub_u32 s8, s8, s30
    s_cmpk_ge_u32 s8, 1868
    s_cbranch_scc1 .ap_177
    s_waitcnt vmcnt(11)
    s_cmpk_ge_u32 s8, 1768
    s_cbranch_scc1 .ap_177
    s_waitcnt vmcnt(10)
    s_bitcmp1_b64 s[14:15], 51
    s_cbranch_scc0 1
    s_waitcnt vmcnt(5)
    s_cmpk_ge_u32 s8, 1648
    s_cbranch_scc1 .ap_177
    s_waitcnt vmcnt(4)
.ap_177:
    s_add_u32 s63, s69, 286720
    buffer_load_dwordx4 v[236:239], v1, s[44:47], s63 offen nt
    s_memrealtime s[8:9]
    s_waitcnt vmcnt(14)
    s_waitcnt lgkmcnt(0)
    s_sub_u32 s8, s8, s30
    s_cmpk_ge_u32 s8, 1900
    s_cbranch_scc1 .ap_178
    s_waitcnt vmcnt(11)
    s_cmpk_ge_u32 s8, 1800
    s_cbranch_scc1 .ap_178
    s_waitcnt vmcnt(10)
    s_bitcmp1_b64 s[14:15], 52
    s_cbranch_scc0 1
    s_waitcnt vmcnt(5)
    s_cmpk_ge_u32 s8, 1680
    s_cbranch_scc1 .ap_178
    s_waitcnt vmcnt(1)
.ap_178:
    s_add_u32 s63, s69, 294912
    buffer_load_dwordx4 v[240:243], v1, s[44:47], s63 offen nt
    s_memrealtime s[8:9]
    s_waitcnt vmcnt(14)
    s_waitcnt lgkmcnt(0)
    s_sub_u32 s8, s8, s30
    s_cmpk_ge_u32 s8, 1932
    s_cbranch_scc1 .ap_179
    s_waitcnt vmcnt(11)
    s_cmpk_ge_u32 s8, 1832
    s_cbranch_scc1 .ap_179
    s_waitcnt vmcnt(7)
    s_bitcmp1_b64 s[14:15], 53
    s_cbranch_scc0 1
    s_waitcnt vmcnt(2)
    s_cmpk_ge_u32 s8, 1712
    s_cbranch_scc1 .ap_179
    s_waitcnt vmcnt(1)
.ap_179:
    s_add_u32 s63, s69, 303104
    buffer_load_dwordx4 v[244:247], v1, s[44:47], s63 offen nt
    s_memrealtime s[8:9]
    s_waitcnt vmcnt(14)
    s_waitcnt lgkmcnt(0)
    s_sub_u32 s8, s8, s30
    s_cmpk_ge_u32 s8, 1964
    s_cbranch_scc1 .ap_180
    s_waitcnt vmcnt(8)
    s_cmpk_ge_u32 s8, 1864
    s_cbranch_scc1 .ap_180
    s_waitcnt vmcnt(7)
    s_bitcmp1_b64 s[14:15], 54
    s_cbranch_scc0 1
    s_waitcnt vmcnt(2)
    s_cmpk_ge_u32 s8, 1744
    s_cbranch_scc1 .ap_180
    s_waitcnt vmcnt(1)
.ap_180:
    s_add_u32 s63, s69, 311296
    buffer_load_dwordx4 v[248:251], v1, s[44:47], s63 offen nt
    s_memrealtime s[8:9]
    s_waitcnt vmcnt(14)
    s_waitcnt lgkmcnt(0)
    s_sub_u32 s8, s8, s30
    s_cmpk_ge_u32 s8, 1996
    s_cbranch_scc1 .ap_181
    s_waitcnt vmcnt(8)
    s_cmpk_ge_u32 s8, 1896
    s_cbranch_scc1 .ap_181
    s_waitcnt vmcnt(4)
    s_bitcmp1_b64 s[14:15], 55
    s_cbranch_scc0 1
    s_waitcnt vmcnt(2)
    s_cmpk_ge_u32 s8, 1776
    s_cbranch_scc1 .ap_181
    s_waitcnt vmcnt(1)
.ap_181:
    s_add_u32 s63, s69, 319488
    buffer_load_dwordx4 v[252:255], v1, s[44:47], s63 offen nt
    s_memrealtime s[8:9]
    s_waitcnt vmcnt(14)
    s_waitcnt lgkmcnt(0)
    s_sub_u32 s8, s8, s30
    s_cmpk_ge_u32 s8, 2028
    s_cbranch_scc1 .ap_182
    s_waitcnt vmcnt(5)
    s_cmpk_ge_u32 s8, 1928
    s_cbranch_scc1 .ap_182
    s_waitcnt vmcnt(4)
    s_bitcmp1_b64 s[14:15], 56
    s_cbranch_scc0 1
    s_waitcnt vmcnt(2)
    s_cmpk_ge_u32 s8, 1808
    s_cbranch_scc1 .ap_182
    s_waitcnt vmcnt(1)
.ap_182:
    s_add_u32 s63, s69, 393216
    buffer_load_dwordx4 v[36:39], v1, s[44:47], s63 offen nt
    s_memrealtime s[8:9]
    s_waitcnt vmcnt(11)
    s_waitcnt lgkmcnt(0)
    s_sub_u32 s8, s8, s30
    s_cmpk_ge_u32 s8, 2060
    s_cbranch_scc1 .ap_183
    s_waitcnt vmcnt(5)
    s_cmpk_ge_u32 s8, 1960
    s_cbranch_scc1 .ap_183
    s_waitcnt vmcnt(4)
    s_bitcmp1_b64 s[14:15], 57
    s_cbranch_scc0 1
    s_waitcnt vmcnt(2)
    s_cmpk_ge_u32 s8, 1840
    s_cbranch_scc1 .ap_183
    s_waitcnt vmcnt(1)
.ap_183:
    s_add_u32 s63, s69, 401408
    buffer_load_dwordx4 v[44:47], v1, s[44:47], s63 offen nt
    s_and_b32 s0, s0, 0xffffff80
    s_sub_u32 s0, s0, 1024
    buffer_load_dword v28, v4, s[36:39], s0 offen sc1
    buffer_load_dwordx4 v[24:27], v9, s[36:39], s59 offen offset:0 sc1
    s_memrealtime s[8:9]
    s_waitcnt vmcnt(9)
    s_waitcnt lgkmcnt(0)
    s_sub_u32 s8, s8, s30
    s_cmpk_ge_u32 s8, 2092
    s_cbranch_scc1 .ap_184
    s_waitcnt vmcnt(6)
    s_cmpk_ge_u32 s8, 1992
    s_cbranch_scc1 .ap_184
    s_waitcnt vmcnt(5)
    s_bitcmp1_b64 s[14:15], 58
    s_cbranch_scc0 1
    s_waitcnt vmcnt(3)
    s_cmpk_ge_u32 s8, 1872
    s_cbranch_scc1 .ap_184
    s_waitcnt vmcnt(2)
.ap_184:
    s_add_u32 s63, s69, 409600
    buffer_load_dwordx4 v[52:55], v1, s[44:47], s63 offen nt
    s_memrealtime s[8:9]
    s_waitcnt vmcnt(9)
    s_waitcnt lgkmcnt(0)
    s_sub_u32 s8, s8, s30
    s_cmpk_ge_u32 s8, 2124
    s_cbranch_scc1 .ap_185
    s_waitcnt vmcnt(6)
    s_cmpk_ge_u32 s8, 2024
    s_cbranch_scc1 .ap_185
    s_waitcnt vmcnt(5)
    s_bitcmp1_b64 s[14:15], 59
    s_cbranch_scc0 1
    s_waitcnt vmcnt(3)
    s_cmpk_ge_u32 s8, 1904
    s_cbranch_scc1 .ap_185
    s_waitcnt vmcnt(1)
.ap_185:
    s_add_u32 s63, s69, 417792
    buffer_load_dwordx4 v[60:63], v1, s[44:47], s63 offen nt
    s_memrealtime s[8:9]
    s_waitcnt vmcnt(9)
    s_waitcnt lgkmcnt(0)
    s_sub_u32 s8, s8, s30
    s_cmpk_ge_u32 s8, 2156
    s_cbranch_scc1 .ap_186
    s_waitcnt vmcnt(6)
    s_cmpk_ge_u32 s8, 2056
    s_cbranch_scc1 .ap_186
    s_waitcnt vmcnt(5)
    s_bitcmp1_b64 s[14:15], 60
    s_cbranch_scc0 1
    s_waitcnt vmcnt(2)
    s_cmpk_ge_u32 s8, 1936
    s_cbranch_scc1 .ap_186
    s_waitcnt vmcnt(1)
.ap_186:
    s_add_u32 s63, s69, 425984
    s_branch .Lsk_b1_4
.Lst_b1_4:
    s_branch .Lrt_b1_4
.Lsk_b1_4:
    buffer_load_dwordx4 v[68:71], v1, s[44:47], s63 offen nt
    s_memrealtime s[8:9]
    s_waitcnt vmcnt(9)
    s_waitcnt lgkmcnt(0)
    s_sub_u32 s8, s8, s30
    s_cmpk_ge_u32 s8, 2188
    s_cbranch_scc1 .ap_187
    s_waitcnt vmcnt(6)
    s_cmpk_ge_u32 s8, 2088
    s_cbranch_scc1 .ap_187
    s_waitcnt vmcnt(5)
    s_bitcmp1_b64 s[14:15], 61
    s_cbranch_scc0 1
    s_waitcnt vmcnt(2)
    s_cmpk_ge_u32 s8, 1968
    s_cbranch_scc1 .ap_187
    s_waitcnt vmcnt(1)
.ap_187:
    s_add_u32 s63, s69, 434176
    buffer_load_dwordx4 v[76:79], v1, s[44:47], s63 offen nt
    s_memrealtime s[8:9]
    s_waitcnt vmcnt(9)
    s_waitcnt lgkmcnt(0)
    s_sub_u32 s8, s8, s30
    s_cmpk_ge_u32 s8, 2220
    s_cbranch_scc1 .ap_188
    s_waitcnt vmcnt(6)
    s_cmpk_ge_u32 s8, 2120
    s_cbranch_scc1 .ap_188
    s_waitcnt vmcnt(4)
    s_bitcmp1_b64 s[14:15], 62
    s_cbranch_scc0 1
    s_waitcnt vmcnt(2)
    s_cmpk_ge_u32 s8, 2000
    s_cbranch_scc1 .ap_188
    s_waitcnt vmcnt(1)
.ap_188:
    s_add_u32 s63, s69, 442368
    buffer_load_dwordx4 v[84:87], v1, s[44:47], s63 offen nt
    s_memrealtime s[8:9]
    s_waitcnt vmcnt(9)
    s_waitcnt lgkmcnt(0)
    s_sub_u32 s8, s8, s30
    s_cmpk_ge_u32 s8, 2252
    s_cbranch_scc1 .ap_189
    s_waitcnt vmcnt(5)
    s_cmpk_ge_u32 s8, 2152
    s_cbranch_scc1 .ap_189
    s_waitcnt vmcnt(4)
    s_bitcmp1_b64 s[14:15], 63
    s_cbranch_scc0 1
    s_waitcnt vmcnt(2)
    s_cmpk_ge_u32 s8, 2032
    s_cbranch_scc1 .ap_189
    s_waitcnt vmcnt(1)
.ap_189:
    s_add_u32 s63, s69, 450560
    buffer_load_dwordx4 v[92:95], v1, s[44:47], s63 offen nt
    s_setprio 0
    s_waitcnt vmcnt(6)
    s_branch .gpc_191
.gp_190:
    buffer_load_dwordx4 v[24:27], v9, s[36:39], s59 offen offset:0 sc1
    s_waitcnt vmcnt(0)
.gpc_191:
    v_cmp_eq_u32 vcc, s34, v26
    s_cmp_eq_u64 vcc, -1
    s_nop 3
    s_cbranch_scc1 .gpd_192
    s_sub_u32 s35, s35, 1
    s_cbranch_scc1 .Lexit
    s_sleep 1
    s_branch .gp_190
.gpd_192:
    v_cmp_eq_u32 vcc, s1, v28
    s_cmp_eq_u64 vcc, -1
    s_cselect_b32 s0, 0x800000, 0
    v_mov_b32 v16, v24
    s_nop 1
    v_max_f32_dpp v16, v16, v16 row_ror:4 row_mask:0xf bank_mask:0xf
    v_sub_f32 v17, v24, v16
    v_sub_f32 v18, v14, v16
    v_mul_f32 v17, 0x3fb8aa3b, v17
    v_mul_f32 v18, 0x3fb8aa3b, v18
    v_exp_f32 v17, v17
    v_exp_f32 v18, v18
    v_mul_f32 v17, v17, v25
    s_nop 1
    v_add_f32_dpp v17, v17, v17 row_ror:4 row_mask:0xf bank_mask:0xf
    v_rcp_f32 v19, v17
    s_nop 0
    v_fma_f32 v15, -v17, v19, 1.0
    v_fma_f32 v19, v15, v19, v19
    v_mul_f32 v18, v18, v19
    v_mul_f32 v10, v10, v18
    v_mul_f32 v11, v11, v18
    v_mul_f32 v12, v12, v18
    v_mul_f32 v13, v13, v18
    v_mov_b32_dpp v112, v10 quad_perm:[2,3,0,1] row_mask:0xf bank_mask:0xf
    v_mov_b32_dpp v113, v11 quad_perm:[2,3,0,1] row_mask:0xf bank_mask:0xf
    v_mov_b32_dpp v114, v12 quad_perm:[2,3,0,1] row_mask:0xf bank_mask:0xf
    v_mov_b32_dpp v115, v13 quad_perm:[2,3,0,1] row_mask:0xf bank_mask:0xf
    v_cvt_pk_bf16_f32 v96, v10, v112
    v_cvt_pk_bf16_f32 v100, v11, v113
    v_cvt_pk_bf16_f32 v104, v12, v114
    v_cvt_pk_bf16_f32 v108, v13, v115
    v_mov_b32_dpp v97, v96 row_ror:12 row_mask:0xf bank_mask:0xf
    v_mov_b32_dpp v101, v100 row_ror:12 row_mask:0xf bank_mask:0xf
    v_mov_b32_dpp v105, v104 row_ror:12 row_mask:0xf bank_mask:0xf
    v_mov_b32_dpp v109, v108 row_ror:12 row_mask:0xf bank_mask:0xf
    v_mov_b32_dpp v98, v96 row_ror:8 row_mask:0xf bank_mask:0xf
    v_mov_b32_dpp v102, v100 row_ror:8 row_mask:0xf bank_mask:0xf
    v_mov_b32_dpp v106, v104 row_ror:8 row_mask:0xf bank_mask:0xf
    v_mov_b32_dpp v110, v108 row_ror:8 row_mask:0xf bank_mask:0xf
    v_mov_b32_dpp v99, v96 row_ror:4 row_mask:0xf bank_mask:0xf
    v_mov_b32_dpp v103, v100 row_ror:4 row_mask:0xf bank_mask:0xf
    v_mov_b32_dpp v107, v104 row_ror:4 row_mask:0xf bank_mask:0xf
    v_mov_b32_dpp v111, v108 row_ror:4 row_mask:0xf bank_mask:0xf
    s_lshl_b32 s60, s3, 10
    s_add_u32 s60, s60, 147456
    v_lshlrev_b32 v10, 5, v0
    v_add_u32 v10, s60, v10
    v_perm_b32 v112, v164, v160, s94
    v_perm_b32 v113, v172, v168, s94
    v_perm_b32 v114, v180, v176, s94
    v_perm_b32 v115, v188, v184, s94
    s_nop 1
    v_mfma_f32_16x16x32_bf16 v[128:131], v[96:99], v[112:115], 0
    v_perm_b32 v116, v164, v160, s95
    v_perm_b32 v117, v172, v168, s95
    v_perm_b32 v118, v180, v176, s95
    v_perm_b32 v119, v188, v184, s95
    s_nop 1
    v_mfma_f32_16x16x32_bf16 v[132:135], v[96:99], v[116:119], 0
    v_perm_b32 v120, v165, v161, s94
    v_perm_b32 v121, v173, v169, s94
    v_perm_b32 v122, v181, v177, s94
    v_perm_b32 v123, v189, v185, s94
    s_nop 1
    v_mfma_f32_16x16x32_bf16 v[136:139], v[96:99], v[120:123], 0
    v_perm_b32 v124, v165, v161, s95
    v_perm_b32 v125, v173, v169, s95
    v_perm_b32 v126, v181, v177, s95
    v_perm_b32 v127, v189, v185, s95
    s_nop 1
    v_mfma_f32_16x16x32_bf16 v[140:143], v[96:99], v[124:127], 0
    v_perm_b32 v112, v166, v162, s94
    v_perm_b32 v113, v174, v170, s94
    v_perm_b32 v114, v182, v178, s94
    v_perm_b32 v115, v190, v186, s94
    s_nop 1
    v_mfma_f32_16x16x32_bf16 v[144:147], v[96:99], v[112:115], 0
    v_perm_b32 v116, v166, v162, s95
    v_perm_b32 v117, v174, v170, s95
    v_perm_b32 v118, v182, v178, s95
    v_perm_b32 v119, v190, v186, s95
    s_nop 1
    v_mfma_f32_16x16x32_bf16 v[148:151], v[96:99], v[116:119], 0
    v_perm_b32 v120, v167, v163, s94
    v_perm_b32 v121, v175, v171, s94
    v_perm_b32 v122, v183, v179, s94
    v_perm_b32 v123, v191, v187, s94
    s_nop 1
    v_mfma_f32_16x16x32_bf16 v[152:155], v[96:99], v[120:123], 0
    v_perm_b32 v124, v167, v163, s95
    v_perm_b32 v125, v175, v171, s95
    v_perm_b32 v126, v183, v179, s95
    v_perm_b32 v127, v191, v187, s95
    s_nop 1
    v_mfma_f32_16x16x32_bf16 v[156:159], v[96:99], v[124:127], 0
    v_perm_b32 v112, v196, v192, s94
    v_perm_b32 v113, v204, v200, s94
    v_perm_b32 v114, v212, v208, s94
    v_perm_b32 v115, v220, v216, s94
    s_nop 1
    v_mfma_f32_16x16x32_bf16 v[128:131], v[100:103], v[112:115], v[128:131]
    v_perm_b32 v116, v196, v192, s95
    v_perm_b32 v117, v204, v200, s95
    v_perm_b32 v118, v212, v208, s95
    v_perm_b32 v119, v220, v216, s95
    s_nop 1
    v_mfma_f32_16x16x32_bf16 v[132:135], v[100:103], v[116:119], v[132:135]
    v_perm_b32 v120, v197, v193, s94
    v_perm_b32 v121, v205, v201, s94
    s_branch .Lsk_b1_5
.Lst_b1_5:
    s_branch .Lrt_b1_5
.Lsk_b1_5:
    v_perm_b32 v122, v213, v209, s94
    v_perm_b32 v123, v221, v217, s94
    s_nop 1
    v_mfma_f32_16x16x32_bf16 v[136:139], v[100:103], v[120:123], v[136:139]
    v_perm_b32 v124, v197, v193, s95
    v_perm_b32 v125, v205, v201, s95
    v_perm_b32 v126, v213, v209, s95
    v_perm_b32 v127, v221, v217, s95
    s_nop 1
    v_mfma_f32_16x16x32_bf16 v[140:143], v[100:103], v[124:127], v[140:143]
    v_perm_b32 v112, v198, v194, s94
    v_perm_b32 v113, v206, v202, s94
    v_perm_b32 v114, v214, v210, s94
    v_perm_b32 v115, v222, v218, s94
    s_nop 1
    v_mfma_f32_16x16x32_bf16 v[144:147], v[100:103], v[112:115], v[144:147]
    v_perm_b32 v116, v198, v194, s95
    v_perm_b32 v117, v206, v202, s95
    v_perm_b32 v118, v214, v210, s95
    v_perm_b32 v119, v222, v218, s95
    s_nop 1
    v_mfma_f32_16x16x32_bf16 v[148:151], v[100:103], v[116:119], v[148:151]
    v_perm_b32 v120, v199, v195, s94
    v_perm_b32 v121, v207, v203, s94
    v_perm_b32 v122, v215, v211, s94
    v_perm_b32 v123, v223, v219, s94
    s_nop 1
    v_mfma_f32_16x16x32_bf16 v[152:155], v[100:103], v[120:123], v[152:155]
    v_perm_b32 v124, v199, v195, s95
    v_perm_b32 v125, v207, v203, s95
    v_perm_b32 v126, v215, v211, s95
    v_perm_b32 v127, v223, v219, s95
    s_nop 1
    v_mfma_f32_16x16x32_bf16 v[156:159], v[100:103], v[124:127], v[156:159]
    v_perm_b32 v112, v228, v224, s94
    v_perm_b32 v113, v236, v232, s94
    v_perm_b32 v114, v244, v240, s94
    v_perm_b32 v115, v252, v248, s94
    s_nop 1
    v_mfma_f32_16x16x32_bf16 v[128:131], v[104:107], v[112:115], v[128:131]
    v_perm_b32 v116, v228, v224, s95
    v_perm_b32 v117, v236, v232, s95
    v_perm_b32 v118, v244, v240, s95
    v_perm_b32 v119, v252, v248, s95
    s_nop 1
    v_mfma_f32_16x16x32_bf16 v[132:135], v[104:107], v[116:119], v[132:135]
    v_perm_b32 v120, v229, v225, s94
    v_perm_b32 v121, v237, v233, s94
    v_perm_b32 v122, v245, v241, s94
    v_perm_b32 v123, v253, v249, s94
    s_nop 1
    v_mfma_f32_16x16x32_bf16 v[136:139], v[104:107], v[120:123], v[136:139]
    v_perm_b32 v124, v229, v225, s95
    v_perm_b32 v125, v237, v233, s95
    v_perm_b32 v126, v245, v241, s95
    v_perm_b32 v127, v253, v249, s95
    s_nop 1
    v_mfma_f32_16x16x32_bf16 v[140:143], v[104:107], v[124:127], v[140:143]
    v_perm_b32 v112, v230, v226, s94
    v_perm_b32 v113, v238, v234, s94
    v_perm_b32 v114, v246, v242, s94
    v_perm_b32 v115, v254, v250, s94
    s_nop 1
    v_mfma_f32_16x16x32_bf16 v[144:147], v[104:107], v[112:115], v[144:147]
    v_perm_b32 v116, v230, v226, s95
    v_perm_b32 v117, v238, v234, s95
    v_perm_b32 v118, v246, v242, s95
    v_perm_b32 v119, v254, v250, s95
    s_nop 1
    v_mfma_f32_16x16x32_bf16 v[148:151], v[104:107], v[116:119], v[148:151]
    v_perm_b32 v120, v231, v227, s94
    v_perm_b32 v121, v239, v235, s94
    v_perm_b32 v122, v247, v243, s94
    v_perm_b32 v123, v255, v251, s94
    s_nop 1
    v_mfma_f32_16x16x32_bf16 v[152:155], v[104:107], v[120:123], v[152:155]
    v_perm_b32 v124, v231, v227, s95
    v_perm_b32 v125, v239, v235, s95
    v_perm_b32 v126, v247, v243, s95
    v_perm_b32 v127, v255, v251, s95
    s_nop 1
    v_mfma_f32_16x16x32_bf16 v[156:159], v[104:107], v[124:127], v[156:159]
    s_waitcnt vmcnt(0)
    s_add_u32 m0, s101, 90112
    s_add_u32 s56, s100, 1179648
    buffer_load_dwordx4 v6, s[52:55], s56 offen nt lds
    s_add_u32 m0, s101, 98304
    s_add_u32 s56, s100, 1769472
    buffer_load_dwordx4 v6, s[52:55], s56 offen nt lds
    s_add_u32 m0, s101, 106496
    s_add_u32 s56, s100, 2359296
    buffer_load_dwordx4 v6, s[52:55], s56 offen nt lds
    s_add_u32 m0, s101, 114688
    s_add_u32 s56, s100, 2949120
    buffer_load_dwordx4 v6, s[52:55], s56 offen nt lds
    s_add_u32 m0, s101, 122880
    s_add_u32 s56, s100, 3538944
    buffer_load_dwordx4 v6, s[52:55], s56 offen nt lds
    s_add_u32 m0, s101, 131072
    s_add_u32 s56, s100, 4128768
    buffer_load_dwordx4 v6, s[52:55], s56 offen nt lds
    s_add_u32 m0, s101, 139264
    s_add_u32 s56, s100, 4718592
    buffer_load_dwordx4 v6, s[52:55], s56 offen nt lds
    v_perm_b32 v112, v44, v36, s94
    v_perm_b32 v113, v60, v52, s94
    v_perm_b32 v114, v76, v68, s94
    v_perm_b32 v115, v92, v84, s94
    s_nop 1
    v_mfma_f32_16x16x32_bf16 v[128:131], v[108:111], v[112:115], v[128:131]
    v_perm_b32 v116, v44, v36, s95
    v_perm_b32 v117, v60, v52, s95
    v_perm_b32 v118, v76, v68, s95
    v_perm_b32 v119, v92, v84, s95
    s_nop 1
    v_mfma_f32_16x16x32_bf16 v[132:135], v[108:111], v[116:119], v[132:135]
    v_perm_b32 v120, v45, v37, s94
    v_perm_b32 v121, v61, v53, s94
    v_perm_b32 v122, v77, v69, s94
    v_perm_b32 v123, v93, v85, s94
    s_nop 1
    v_mfma_f32_16x16x32_bf16 v[136:139], v[108:111], v[120:123], v[136:139]
    v_perm_b32 v124, v45, v37, s95
    v_perm_b32 v125, v61, v53, s95
    v_perm_b32 v126, v77, v69, s95
    v_perm_b32 v127, v93, v85, s95
    s_nop 1
    v_mfma_f32_16x16x32_bf16 v[140:143], v[108:111], v[124:127], v[140:143]
    v_perm_b32 v112, v46, v38, s94
    v_perm_b32 v113, v62, v54, s94
    v_perm_b32 v114, v78, v70, s94
    v_perm_b32 v115, v94, v86, s94
    s_nop 1
    v_mfma_f32_16x16x32_bf16 v[144:147], v[108:111], v[112:115], v[144:147]
    v_perm_b32 v116, v46, v38, s95
    v_perm_b32 v117, v62, v54, s95
    v_perm_b32 v118, v78, v70, s95
    v_perm_b32 v119, v94, v86, s95
    s_nop 1
    v_mfma_f32_16x16x32_bf16 v[148:151], v[108:111], v[116:119], v[148:151]
    v_perm_b32 v120, v47, v39, s94
    v_perm_b32 v121, v63, v55, s94
    v_perm_b32 v122, v79, v71, s94
    v_perm_b32 v123, v95, v87, s94
    s_nop 1
    v_mfma_f32_16x16x32_bf16 v[152:155], v[108:111], v[120:123], v[152:155]
    s_branch .Lsk_b1_6
.Lst_b1_6:
    s_branch .Lrt_b1_6
.Lsk_b1_6:
    v_perm_b32 v124, v47, v39, s95
    v_perm_b32 v125, v63, v55, s95
    v_perm_b32 v126, v79, v71, s95
    v_perm_b32 v127, v95, v87, s95
    s_nop 1
    v_mfma_f32_16x16x32_bf16 v[156:159], v[108:111], v[124:127], v[156:159]
    s_mov_b64 exec, 0xffff
    ds_write2_b32 v10, v128, v129 offset0:0 offset1:128
    ds_write2_b32 v10, v132, v133 offset0:1 offset1:129
    ds_write2_b32 v10, v136, v137 offset0:2 offset1:130
    ds_write2_b32 v10, v140, v141 offset0:3 offset1:131
    ds_write2_b32 v10, v144, v145 offset0:4 offset1:132
    ds_write2_b32 v10, v148, v149 offset0:5 offset1:133
    ds_write2_b32 v10, v152, v153 offset0:6 offset1:134
    ds_write2_b32 v10, v156, v157 offset0:7 offset1:135
    s_mov_b64 exec, -1
    s_waitcnt lgkmcnt(0)
    s_barrier
    s_cmp_lg_u32 s3, 7
    s_cbranch_scc1 .opub_193
    v_add_u32 v10, 147456, v2
    ds_read_b128 v[196:199], v10 offset:0
    ds_read_b128 v[200:203], v10 offset:1024
    ds_read_b128 v[204:207], v10 offset:2048
    ds_read_b128 v[208:211], v10 offset:3072
    ds_read_b128 v[212:215], v10 offset:4096
    ds_read_b128 v[216:219], v10 offset:5120
    ds_read_b128 v[220:223], v10 offset:6144
    ds_read_b128 v[224:227], v10 offset:7168
    v_lshrrev_b32 v11, 5, v0
    v_lshlrev_b32 v11, 13, v11
    v_and_b32 v12, 31, v0
    v_lshl_add_u32 v11, v12, 4, v11
    s_lshl4_add_u32 s56, s67, s66
    s_lshl1_add_u32 s56, s56, s68
    s_lshl_b32 s56, s56, 9
    s_add_u32 s56, s56, 0xa0000
    s_mov_b32 s60, 0x07060503
    s_mov_b32 s61, 0x07060502
    s_mov_b32 s62, 0x07060501
    v_mov_b32 v15, s34
    s_waitcnt lgkmcnt(6)
    v_pk_add_f32 v[196:197], v[196:197], v[200:201]
    v_pk_add_f32 v[198:199], v[198:199], v[202:203]
    s_waitcnt lgkmcnt(5)
    v_pk_add_f32 v[196:197], v[196:197], v[204:205]
    v_pk_add_f32 v[198:199], v[198:199], v[206:207]
    s_waitcnt lgkmcnt(4)
    v_pk_add_f32 v[196:197], v[196:197], v[208:209]
    v_pk_add_f32 v[198:199], v[198:199], v[210:211]
    s_waitcnt lgkmcnt(3)
    v_pk_add_f32 v[196:197], v[196:197], v[212:213]
    v_pk_add_f32 v[198:199], v[198:199], v[214:215]
    s_waitcnt lgkmcnt(2)
    v_pk_add_f32 v[196:197], v[196:197], v[216:217]
    v_pk_add_f32 v[198:199], v[198:199], v[218:219]
    s_waitcnt lgkmcnt(1)
    v_pk_add_f32 v[196:197], v[196:197], v[220:221]
    v_pk_add_f32 v[198:199], v[198:199], v[222:223]
    s_waitcnt lgkmcnt(0)
    v_pk_add_f32 v[196:197], v[196:197], v[224:225]
    v_pk_add_f32 v[198:199], v[198:199], v[226:227]
    v_perm_b32 v12, v196, v199, s60
    v_perm_b32 v13, v197, v199, s61
    v_perm_b32 v14, v198, v199, s62
    s_add_u32 s57, s56, 0x800000
    buffer_store_dwordx4 v[12:15], v11, s[36:39], s57 offen
    buffer_store_dwordx4 v[12:15], v11, s[36:39], s56 offen sc1
.opub_193:
    s_mov_b32 s61, s101
    v_lshrrev_b32 v25, 4, v0
    v_bfe_u32 v26, v0, 1, 1
    v_lshl_add_u32 v25, v25, 1, v26
    v_bfe_u32 v26, v0, 2, 2
    v_lshl_add_u32 v19, v25, 3, v26
    v_lshlrev_b32 v19, 7, v19
    v_and_b32 v25, 3, v25
    v_lshrrev_b32 v26, 1, v26
    v_lshl_add_u32 v25, v25, 1, v26
    v_xor_b32 v25, s3, v25
    v_lshl_add_u32 v19, v25, 4, v19
    v_and_b32 v25, 1, v0
    v_lshl_add_u32 v19, v25, 3, v19
    v_add_u32 v20, 32768, v19
    ds_read_b64_tr_b16 v[160:161], v19 offset:0
    ds_read_b64_tr_b16 v[162:163], v19 offset:512
    ds_read_b64_tr_b16 v[164:165], v19 offset:8192
    ds_read_b64_tr_b16 v[166:167], v19 offset:8704
    ds_read_b64_tr_b16 v[168:169], v19 offset:16384
    ds_read_b64_tr_b16 v[170:171], v19 offset:16896
    ds_read_b64_tr_b16 v[172:173], v19 offset:24576
    ds_read_b64_tr_b16 v[174:175], v19 offset:25088
    ds_read_b64_tr_b16 v[176:177], v20 offset:0
    ds_read_b64_tr_b16 v[178:179], v20 offset:512
    ds_read_b64_tr_b16 v[180:181], v20 offset:8192
    ds_read_b64_tr_b16 v[182:183], v20 offset:8704
    ds_read_b64_tr_b16 v[184:185], v20 offset:16384
    ds_read_b64_tr_b16 v[186:187], v20 offset:16896
    ds_read_b64_tr_b16 v[188:189], v20 offset:24576
    ds_read_b64_tr_b16 v[190:191], v20 offset:25088
    ds_read_b64_tr_b16 v[192:193], v20 offset:32768
    ds_read_b64_tr_b16 v[194:195], v20 offset:33280
    v_add_u32 v19, 73728, v19
    v_add_u32 v20, 73728, v20
    s_mov_b32 s48, s22
    s_and_b32 s49, s23, 0xffff
    s_mov_b32 s50, 0x510000
    s_mov_b32 s51, 0x00020000
    s_mul_i32 s69, s99, 73728
    s_mul_i32 s56, s3, 9216
    s_add_u32 s69, s69, s56
    v_bfe_u32 v25, v0, 4, 1
    s_and_b32 s56, s3, 1
    s_lshl_b32 s56, s56, 2
    v_lshl_or_b32 v25, v25, 1, s56
    v_and_b32 v26, 7, v0
    v_xor_b32 v25, v25, v26
    v_lshrrev_b32 v26, 3, v0
    v_mul_u32_u24 v26, 1152, v26
    v_lshl_add_u32 v24, v25, 4, v26
    s_and_b32 s58, s64, 0
    s_mul_i32 s58, s58, 18432
    s_branch .Lsk_b1_7
.Lst_b1_7:
    s_branch .Lrt_b1_7
.Lsk_b1_7:
    s_mul_i32 s59, s3, 2304
    s_add_u32 s58, s58, s59
    s_add_u32 s62, s58, 0x37000
    s_add_u32 s63, s58, 0x49000
    s_mul_i32 s101, s64, 18432
    s_add_u32 s101, s101, s59
    s_add_u32 s101, s101, 0x170000
    s_waitcnt lgkmcnt(0)
    s_barrier
    s_add_u32 m0, s61, 0
    s_nop 0
    buffer_load_dwordx4 v24, s[48:51], s69 offen offset:0 nt lds
    s_add_u32 m0, s61, 8064
    s_nop 0
    buffer_load_dwordx4 v24, s[48:51], s69 offen offset:128 nt lds
    s_add_u32 m0, s61, 16128
    s_nop 0
    buffer_load_dwordx4 v24, s[48:51], s69 offen offset:256 nt lds
    s_add_u32 m0, s61, 24192
    s_nop 0
    buffer_load_dwordx4 v24, s[48:51], s69 offen offset:384 nt lds
    s_add_u32 m0, s61, 32256
    s_nop 0
    buffer_load_dwordx4 v24, s[48:51], s69 offen offset:512 nt lds
    s_add_u32 m0, s61, 40320
    s_nop 0
    buffer_load_dwordx4 v24, s[48:51], s69 offen offset:640 nt lds
    s_add_u32 m0, s61, 48384
    s_nop 0
    buffer_load_dwordx4 v24, s[48:51], s69 offen offset:768 nt lds
    s_add_u32 m0, s61, 56448
    s_nop 0
    buffer_load_dwordx4 v24, s[48:51], s69 offen offset:896 nt lds
    s_add_u32 m0, s61, 64512
    s_nop 0
    buffer_load_dwordx4 v24, s[48:51], s69 offen offset:1024 nt lds
    v_bfe_u32 v16, v0, 1, 3
    v_mul_u32_u24 v16, 1312, v16
    v_lshrrev_b32 v25, 4, v0
    v_lshl_add_u32 v16, v25, 5, v16
    v_and_b32 v25, 1, v0
    v_lshl_add_u32 v16, v25, 4, v16
    v_add_u32 v16, 147456, v16
    s_mul_i32 s56, s3, 1312
    s_add_u32 s56, s56, 147456
    v_add_u32 v17, s56, v3
    v_add_u32 v18, s56, v4
    v_bfe_u32 v21, v0, 1, 3
    v_mul_u32_u24 v21, 144, v21
    v_bfe_u32 v25, v0, 4, 1
    v_lshl_add_u32 v21, v25, 3, v21
    v_lshrrev_b32 v25, 5, v0
    v_lshl_add_u32 v21, v25, 2, v21
    v_and_b32 v25, 1, v0
    v_lshl_add_u32 v21, v25, 1, v21
    s_lshl_b32 s56, s3, 4
    s_add_u32 s56, s56, 157952
    v_add_u32 v21, s56, v21
    v_and_b32 v22, 15, v0
    v_lshlrev_b32 v22, 3, v22
    s_mul_i32 s56, s3, 144
    s_add_u32 s56, s56, 157952
    v_add_u32 v22, s56, v22
    s_mov_b32 s56, 157952
    v_bfe_u32 v22, v0, 1, 3
    v_mul_u32_u24 v22, 144, v22
    v_and_b32 v25, 48, v0
    v_add3_u32 v22, v22, v25, s56
    v_bfe_u32 v23, v0, 1, 3
    v_mul_u32_u24 v23, 9216, v23
    v_and_b32 v25, 1, v0
    v_lshl_add_u32 v23, v25, 4, v23
    v_and_b32 v25, 48, v0
    v_lshl_add_u32 v23, v25, 1, v23
    v_lshrrev_b32 v25, 4, v0
    v_bfe_u32 v26, v0, 2, 2
    v_lshl_add_u32 v28, v25, 3, v26
    v_lshlrev_b32 v28, 7, v28
    v_and_b32 v25, 1, v25
    v_lshrrev_b32 v26, 1, v26
    v_lshl_add_u32 v25, v25, 1, v26
    s_and_b32 s56, s3, 1
    s_lshl_b32 s56, s56, 1
    v_xor_b32 v25, s56, v25
    v_and_b32 v26, 3, v0
    v_lshl_add_u32 v28, v26, 3, v28
    s_lshr_b32 s56, s3, 1
    s_lshl_b32 s56, s56, 13
    v_add_u32 v28, s56, v28
    v_xor_b32 v26, 1, v25
    v_lshl_add_u32 v29, v26, 5, v28
    v_lshl_add_u32 v28, v25, 5, v28
    v_add_u32 v30, 0x10000, v28
    v_add_u32 v31, 0x10000, v29
    s_mul_i32 s59, s3, 73728
    s_lshl_b32 s56, s99, 7
    s_add_u32 s59, s59, s56
    s_add_u32 s59, s59, 0x1a0000
    s_add_u32 s99, s59, 589824
    s_add_u32 s100, s59, 1179648
    s_branch .gpc_195
.gp_194:
    buffer_load_dwordx4 v[32:35], v2, s[36:39], s62 offen offset:0 sc1
    buffer_load_dwordx4 v[40:43], v2, s[36:39], s62 offen offset:1024 sc1
    buffer_load_dwordx2 v[48:49], v5, s[36:39], s62 offen offset:0 sc1
    buffer_load_dwordx4 v[56:59], v2, s[36:39], s63 offen offset:0 sc1
    buffer_load_dwordx4 v[64:67], v2, s[36:39], s63 offen offset:1024 sc1
    buffer_load_dwordx2 v[72:73], v5, s[36:39], s63 offen offset:0 sc1
    s_waitcnt vmcnt(0)
.gpc_195:
    v_min_u32 v25, v33, v35
    v_max_u32 v26, v33, v35
    v_min3_u32 v25, v25, v41, v43
    v_max3_u32 v26, v26, v41, v43
    v_min3_u32 v25, v25, v49, v57
    v_max3_u32 v26, v26, v49, v57
    v_min3_u32 v25, v25, v59, v65
    v_max3_u32 v26, v26, v59, v65
    v_min3_u32 v25, v25, v67, v73
    v_max3_u32 v26, v26, v67, v73
    v_cmp_eq_u32 vcc, s34, v25
    v_cmp_eq_u32 s[56:57], s34, v26
    s_and_b64 vcc, vcc, s[56:57]
    s_cmp_eq_u64 vcc, -1
    s_nop 2
    s_cbranch_scc1 .gpd_196
    s_sub_u32 s35, s35, 1
    s_cbranch_scc1 .Lexit
    s_sleep 2
    s_branch .gp_194
.gpd_196:
    v_lshlrev_b32 v206, 16, v32
    v_and_b32 v207, 0xffff0000, v32
    v_lshlrev_b32 v216, 16, v56
    v_and_b32 v217, 0xffff0000, v56
    v_lshlrev_b32 v208, 16, v34
    v_and_b32 v209, 0xffff0000, v34
    v_lshlrev_b32 v218, 16, v58
    v_and_b32 v219, 0xffff0000, v58
    v_lshlrev_b32 v210, 16, v40
    v_and_b32 v211, 0xffff0000, v40
    v_lshlrev_b32 v220, 16, v64
    v_and_b32 v221, 0xffff0000, v64
    v_lshlrev_b32 v212, 16, v42
    v_and_b32 v213, 0xffff0000, v42
    v_lshlrev_b32 v222, 16, v66
    v_and_b32 v223, 0xffff0000, v66
    v_lshlrev_b32 v214, 16, v48
    v_and_b32 v215, 0xffff0000, v48
    v_lshlrev_b32 v224, 16, v72
    v_and_b32 v225, 0xffff0000, v72
    s_waitcnt vmcnt(9)
    s_barrier
    ds_read_b64_tr_b16 v[68:69], v19 offset:0
    ds_read_b64_tr_b16 v[70:71], v19 offset:512
    ds_read_b64_tr_b16 v[72:73], v19 offset:8192
    ds_read_b64_tr_b16 v[74:75], v19 offset:8704
    ds_read_b64_tr_b16 v[76:77], v19 offset:16384
    ds_read_b64_tr_b16 v[78:79], v19 offset:16896
    ds_read_b64_tr_b16 v[80:81], v19 offset:24576
    ds_read_b64_tr_b16 v[82:83], v19 offset:25088
    ds_read_b64_tr_b16 v[84:85], v20 offset:0
    ds_read_b64_tr_b16 v[86:87], v20 offset:512
    ds_read_b64_tr_b16 v[88:89], v20 offset:8192
    ds_read_b64_tr_b16 v[90:91], v20 offset:8704
    ds_read_b64_tr_b16 v[92:93], v20 offset:16384
    ds_read_b64_tr_b16 v[94:95], v20 offset:16896
    ds_read_b64_tr_b16 v[96:97], v20 offset:24576
    ds_read_b64_tr_b16 v[98:99], v20 offset:25088
    ds_read_b64_tr_b16 v[100:101], v20 offset:32768
    ds_read_b64_tr_b16 v[102:103], v20 offset:33280
    s_branch .Lsk_b2_0
.Lst_b2_0:
    s_branch .Lrt_b2_0
.Lsk_b2_0:
    s_waitcnt vmcnt(0)
    s_barrier
    ds_read_b64_tr_b16 v[104:105], v28 offset:0
    ds_read_b64_tr_b16 v[106:107], v28 offset:512
    ds_read_b64_tr_b16 v[108:109], v29 offset:0
    ds_read_b64_tr_b16 v[110:111], v29 offset:512
    ds_read_b64_tr_b16 v[112:113], v28 offset:4096
    ds_read_b64_tr_b16 v[114:115], v28 offset:4608
    ds_read_b64_tr_b16 v[116:117], v29 offset:4096
    ds_read_b64_tr_b16 v[118:119], v29 offset:4608
    ds_read_b64_tr_b16 v[120:121], v28 offset:32768
    ds_read_b64_tr_b16 v[122:123], v28 offset:33280
    ds_read_b64_tr_b16 v[124:125], v29 offset:32768
    ds_read_b64_tr_b16 v[126:127], v29 offset:33280
    ds_read_b64_tr_b16 v[128:129], v28 offset:36864
    ds_read_b64_tr_b16 v[130:131], v28 offset:37376
    ds_read_b64_tr_b16 v[132:133], v29 offset:36864
    ds_read_b64_tr_b16 v[134:135], v29 offset:37376
    s_cmp_ge_u32 s3, 2
    s_cbranch_scc1 .Lbc_nodn3
    ds_read_b64_tr_b16 v[136:137], v30 offset:0
    ds_read_b64_tr_b16 v[138:139], v30 offset:512
    ds_read_b64_tr_b16 v[140:141], v31 offset:0
    ds_read_b64_tr_b16 v[142:143], v31 offset:512
    ds_read_b64_tr_b16 v[144:145], v30 offset:4096
    ds_read_b64_tr_b16 v[146:147], v30 offset:4608
    ds_read_b64_tr_b16 v[148:149], v31 offset:4096
    ds_read_b64_tr_b16 v[150:151], v31 offset:4608
.Lbc_nodn3:
    s_mov_b32 s69, 0
.gp_197:
    s_add_u32 s69, s69, 1
    s_and_b32 s56, s69, 0x41
    s_cmp_lg_u32 s56, 0x41
    s_cselect_b32 s56, s0, 0
    s_add_u32 s58, s101, s56
    buffer_load_dwordx4 v[196:199], v2, s[36:39], s58 offen offset:0 sc1
    buffer_load_dwordx4 v[200:203], v2, s[36:39], s58 offen offset:1024 sc1
    buffer_load_dwordx2 v[204:205], v5, s[36:39], s58 offen offset:0 sc1
    s_waitcnt vmcnt(0)
    v_min3_u32 v25, v197, v199, v201
    v_max3_u32 v26, v197, v199, v201
    v_min3_u32 v25, v25, v203, v205
    v_max3_u32 v26, v26, v203, v205
    v_cmp_eq_u32 vcc, s34, v25
    v_cmp_eq_u32 s[56:57], s34, v26
    s_and_b64 vcc, vcc, s[56:57]
    s_cmp_eq_u64 vcc, -1
    s_nop 2
    s_cbranch_scc1 .gpd_198
    s_sub_u32 s35, s35, 1
    s_cbranch_scc1 .Lexit
    s_branch .gp_197
.gpd_198:
    s_mov_b32 s56, 0x3f803f80
    v_dot2_f32_bf16 v236, v196, s56, 0
    v_dot2_f32_bf16 v237, v196, v196, 0
    v_dot2_f32_bf16 v236, v198, s56, v236
    v_dot2_f32_bf16 v237, v198, v198, v237
    v_dot2_f32_bf16 v236, v200, s56, v236
    v_dot2_f32_bf16 v237, v200, v200, v237
    v_dot2_f32_bf16 v236, v202, s56, v236
    v_dot2_f32_bf16 v237, v202, v202, v237
    s_mov_b64 exec, 0xffffffff
    v_dot2_f32_bf16 v236, v204, s56, v236
    v_dot2_f32_bf16 v237, v204, v204, v237
    s_mov_b64 exec, -1
    s_nop 1
    v_permlane32_swap_b32 v236, v237
    v_add_f32 v236, v236, v237
    v_mov_b32 v238, v236
    s_nop 1
    v_permlane16_swap_b32 v238, v236
    v_add_f32 v236, v238, v236
    v_lshlrev_b32 v226, 16, v196
    v_and_b32 v227, 0xffff0000, v196
    v_add_f32_dpp v236, v236, v236 row_ror:8 row_mask:0xf bank_mask:0xf
    v_lshlrev_b32 v228, 16, v198
    v_and_b32 v229, 0xffff0000, v198
    v_add_f32_dpp v236, v236, v236 row_ror:4 row_mask:0xf bank_mask:0xf
    v_lshlrev_b32 v230, 16, v200
    v_and_b32 v231, 0xffff0000, v200
    v_add_f32_dpp v236, v236, v236 quad_perm:[2,3,0,1] row_mask:0xf bank_mask:0xf
    v_lshlrev_b32 v232, 16, v202
    v_and_b32 v233, 0xffff0000, v202
    v_add_f32_dpp v236, v236, v236 quad_perm:[1,0,3,2] row_mask:0xf bank_mask:0xf
    v_mul_f32 v236, 0x3ae38e39, v236
    v_lshlrev_b32 v234, 16, v204
    v_and_b32 v235, 0xffff0000, v204
    v_readlane_b32 s56, v236, 0
    v_readlane_b32 s57, v236, 32
    s_nop 0
    v_mov_b32 v236, s56
    v_fma_f32 v237, -v236, v236, s57
    v_max_f32 v237, 0, v237
    v_cvt_pk_bf16_f32 v238, -v236, v237
    v_and_b32 v239, 0xffff0000, v238
    v_add_f32 v239, 0x3727c5ac, v239
    v_lshlrev_b32 v236, 16, v238
    v_cvt_pk_bf16_f32 v239, v239, v239
    v_lshlrev_b32 v239, 16, v239
    v_sqrt_f32 v239, v239
    v_mov_b32 v237, v236
    v_cvt_pk_bf16_f32 v239, v239, v239
    v_lshlrev_b32 v239, 16, v239
    v_rcp_f32 v238, v239
    v_rcp_f32 v239, v239
    v_pk_add_f32 v[226:227], v[226:227], v[236:237]
    v_pk_add_f32 v[228:229], v[228:229], v[236:237]
    v_pk_add_f32 v[230:231], v[230:231], v[236:237]
    v_pk_add_f32 v[232:233], v[232:233], v[236:237]
    v_pk_add_f32 v[234:235], v[234:235], v[236:237]
    v_cvt_pk_bf16_f32 v226, v226, v227
    v_and_b32 v227, 0xffff0000, v226
    v_lshlrev_b32 v226, 16, v226
    v_cvt_pk_bf16_f32 v228, v228, v229
    v_and_b32 v229, 0xffff0000, v228
    v_lshlrev_b32 v228, 16, v228
    v_cvt_pk_bf16_f32 v230, v230, v231
    v_and_b32 v231, 0xffff0000, v230
    v_lshlrev_b32 v230, 16, v230
    v_cvt_pk_bf16_f32 v232, v232, v233
    v_and_b32 v233, 0xffff0000, v232
    v_lshlrev_b32 v232, 16, v232
    v_cvt_pk_bf16_f32 v234, v234, v235
    v_and_b32 v235, 0xffff0000, v234
    v_lshlrev_b32 v234, 16, v234
    v_pk_mul_f32 v[226:227], v[226:227], v[238:239]
    v_pk_mul_f32 v[228:229], v[228:229], v[238:239]
    v_pk_mul_f32 v[230:231], v[230:231], v[238:239]
    v_pk_mul_f32 v[232:233], v[232:233], v[238:239]
    v_pk_mul_f32 v[234:235], v[234:235], v[238:239]
    v_cvt_pk_bf16_f32 v226, v226, v227
    v_and_b32 v227, 0xffff0000, v226
    v_lshlrev_b32 v226, 16, v226
    v_cvt_pk_bf16_f32 v228, v228, v229
    v_and_b32 v229, 0xffff0000, v228
    v_lshlrev_b32 v228, 16, v228
    v_cvt_pk_bf16_f32 v230, v230, v231
    v_and_b32 v231, 0xffff0000, v230
    v_lshlrev_b32 v230, 16, v230
    v_cvt_pk_bf16_f32 v232, v232, v233
    v_and_b32 v233, 0xffff0000, v232
    v_lshlrev_b32 v232, 16, v232
    v_cvt_pk_bf16_f32 v234, v234, v235
    v_and_b32 v235, 0xffff0000, v234
    v_lshlrev_b32 v234, 16, v234
    v_pk_mul_f32 v[226:227], v[226:227], v[216:217]
    v_pk_mul_f32 v[228:229], v[228:229], v[218:219]
    v_pk_mul_f32 v[230:231], v[230:231], v[220:221]
    v_pk_mul_f32 v[232:233], v[232:233], v[222:223]
    v_pk_mul_f32 v[234:235], v[234:235], v[224:225]
    v_cvt_pk_bf16_f32 v226, v226, v227
    v_and_b32 v227, 0xffff0000, v226
    v_lshlrev_b32 v226, 16, v226
    v_cvt_pk_bf16_f32 v228, v228, v229
    v_and_b32 v229, 0xffff0000, v228
    v_lshlrev_b32 v228, 16, v228
    v_cvt_pk_bf16_f32 v230, v230, v231
    v_and_b32 v231, 0xffff0000, v230
    v_lshlrev_b32 v230, 16, v230
    v_cvt_pk_bf16_f32 v232, v232, v233
    v_and_b32 v233, 0xffff0000, v232
    v_lshlrev_b32 v232, 16, v232
    v_cvt_pk_bf16_f32 v234, v234, v235
    s_branch .Lsk_b2_1
.Lst_b2_1:
    s_branch .Lrt_b2_1
.Lsk_b2_1:
    v_and_b32 v235, 0xffff0000, v234
    v_lshlrev_b32 v234, 16, v234
    v_pk_add_f32 v[226:227], v[226:227], v[206:207]
    v_pk_add_f32 v[228:229], v[228:229], v[208:209]
    v_pk_add_f32 v[230:231], v[230:231], v[210:211]
    v_pk_add_f32 v[232:233], v[232:233], v[212:213]
    v_pk_add_f32 v[234:235], v[234:235], v[214:215]
    v_cvt_pk_bf16_f32 v242, v226, v227
    v_cvt_pk_bf16_f32 v243, v228, v229
    v_cvt_pk_bf16_f32 v244, v230, v231
    v_cvt_pk_bf16_f32 v245, v232, v233
    v_cvt_pk_bf16_f32 v246, v234, v235
    ds_write_b64 v17, v[242:243] offset:0
    ds_write_b64 v17, v[244:245] offset:512
    ds_write_b32 v18, v246 offset:0
    s_waitcnt lgkmcnt(0)
    s_barrier
    ds_read_b128 v[32:35], v16 offset:0
    ds_read_b128 v[36:39], v16 offset:128
    ds_read_b128 v[40:43], v16 offset:256
    ds_read_b128 v[44:47], v16 offset:384
    ds_read_b128 v[48:51], v16 offset:512
    ds_read_b128 v[52:55], v16 offset:640
    ds_read_b128 v[56:59], v16 offset:768
    ds_read_b128 v[60:63], v16 offset:896
    ds_read_b128 v[64:67], v16 offset:1024
    s_waitcnt lgkmcnt(8)
    v_mfma_f32_16x16x32_bf16 v[152:155], v[160:163], v[32:35], 0
    v_mfma_f32_16x16x32_bf16 v[156:159], v[68:71], v[32:35], 0
    s_waitcnt lgkmcnt(7)
    v_mfma_f32_16x16x32_bf16 v[152:155], v[164:167], v[36:39], v[152:155]
    v_mfma_f32_16x16x32_bf16 v[156:159], v[72:75], v[36:39], v[156:159]
    s_waitcnt lgkmcnt(6)
    v_mfma_f32_16x16x32_bf16 v[152:155], v[168:171], v[40:43], v[152:155]
    v_mfma_f32_16x16x32_bf16 v[156:159], v[76:79], v[40:43], v[156:159]
    s_waitcnt lgkmcnt(5)
    v_mfma_f32_16x16x32_bf16 v[152:155], v[172:175], v[44:47], v[152:155]
    v_mfma_f32_16x16x32_bf16 v[156:159], v[80:83], v[44:47], v[156:159]
    s_waitcnt lgkmcnt(4)
    v_mfma_f32_16x16x32_bf16 v[152:155], v[176:179], v[48:51], v[152:155]
    v_mfma_f32_16x16x32_bf16 v[156:159], v[84:87], v[48:51], v[156:159]
    s_waitcnt lgkmcnt(3)
    v_mfma_f32_16x16x32_bf16 v[152:155], v[180:183], v[52:55], v[152:155]
    v_mfma_f32_16x16x32_bf16 v[156:159], v[88:91], v[52:55], v[156:159]
    s_waitcnt lgkmcnt(2)
    v_mfma_f32_16x16x32_bf16 v[152:155], v[184:187], v[56:59], v[152:155]
    v_mfma_f32_16x16x32_bf16 v[156:159], v[92:95], v[56:59], v[156:159]
    s_waitcnt lgkmcnt(1)
    v_mfma_f32_16x16x32_bf16 v[152:155], v[188:191], v[60:63], v[152:155]
    v_mfma_f32_16x16x32_bf16 v[156:159], v[96:99], v[60:63], v[156:159]
    s_waitcnt lgkmcnt(0)
    v_mfma_f32_16x16x32_bf16 v[152:155], v[192:195], v[64:67], v[152:155]
    v_mfma_f32_16x16x32_bf16 v[156:159], v[100:103], v[64:67], v[156:159]
    s_nop 6
    v_permlane32_swap_b32 v152, v154
    v_permlane32_swap_b32 v153, v155
    v_cndmask_b32 v153, v153, v154, s[96:97]
    v_cndmask_b32 v152, v152, v155, s[96:97]
    s_nop 1
    v_add_f32_dpp v12, v153, v152 quad_perm:[1,0,3,2] row_mask:0xf bank_mask:0xf
    v_permlane32_swap_b32 v156, v158
    v_permlane32_swap_b32 v157, v159
    v_cndmask_b32 v157, v157, v158, s[96:97]
    v_cndmask_b32 v156, v156, v159, s[96:97]
    s_nop 1
    v_add_f32_dpp v14, v157, v156 quad_perm:[1,0,3,2] row_mask:0xf bank_mask:0xf
    v_cvt_pk_bf16_f32 v12, v12, v12
    v_lshlrev_b32 v12, 16, v12
    v_cvt_pk_bf16_f32 v14, v14, v14
    v_lshlrev_b32 v14, 16, v14
    v_max_f32 v12, 0xc2ae0000, v12
    v_min_f32 v27, 0x43000000, v12
    v_mul_f32 v25, 0xbfb8aa3b, v27
    v_fma_f32 v26, v27, s98, -v25
    v_fmac_f32 v26, 0xb2a57060, v27
    v_exp_f32 v25, v25
    v_mul_f32 v26, 0x3f317218, v26
    v_fmac_f32 v25, v25, v26
    v_add_f32 v25, 1.0, v25
    v_rcp_f32 v26, v25
    s_nop 0
    v_mul_f32 v27, v12, v26
    v_fma_f32 v25, -v27, v25, v12
    v_fma_f32 v12, v25, v26, v27
    v_cvt_pk_bf16_f32 v12, v12, v12
    v_lshlrev_b32 v12, 16, v12
    v_mul_f32 v12, v12, v14
    v_cvt_pk_bf16_f32 v12, v12, v12
    ds_write_b16 v21, v12
    s_mov_b32 s60, 0x07060503
    s_mov_b32 s61, 0x07060502
    s_mov_b32 s62, 0x07060501
    s_mov_b32 vcc_lo, 0xaaaaaaaa
    s_mov_b32 vcc_hi, 0xaaaaaaaa
    v_mov_b32 v59, s34
    v_mov_b32 v63, s34
    v_mov_b32 v67, s34
    s_waitcnt lgkmcnt(0)
    s_barrier
    ds_read_b128 v[8:11], v22
    ds_read_b128 v[12:15], v22 offset:64
    s_waitcnt lgkmcnt(1)
    v_mfma_f32_16x16x32_bf16 v[32:35], v[104:107], v[8:11], 0
    v_mfma_f32_16x16x32_bf16 v[36:39], v[108:111], v[8:11], 0
    v_mfma_f32_16x16x32_bf16 v[40:43], v[120:123], v[8:11], 0
    v_mfma_f32_16x16x32_bf16 v[44:47], v[124:127], v[8:11], 0
    v_mfma_f32_16x16x32_bf16 v[48:51], v[136:139], v[8:11], 0
    v_mfma_f32_16x16x32_bf16 v[52:55], v[140:143], v[8:11], 0
    s_waitcnt lgkmcnt(0)
    v_mfma_f32_16x16x32_bf16 v[32:35], v[112:115], v[12:15], v[32:35]
    v_mfma_f32_16x16x32_bf16 v[36:39], v[116:119], v[12:15], v[36:39]
    v_mfma_f32_16x16x32_bf16 v[40:43], v[128:131], v[12:15], v[40:43]
    v_mfma_f32_16x16x32_bf16 v[44:47], v[132:135], v[12:15], v[44:47]
    v_mfma_f32_16x16x32_bf16 v[48:51], v[144:147], v[12:15], v[48:51]
    v_mfma_f32_16x16x32_bf16 v[52:55], v[148:151], v[12:15], v[52:55]
    s_nop 3
    v_cndmask_b32 v32, v32, v36, vcc
    v_cndmask_b32 v33, v33, v37, vcc
    v_cndmask_b32 v34, v34, v38, vcc
    v_cndmask_b32 v35, v35, v39, vcc
    v_perm_b32 v56, v32, v35, s60
    v_perm_b32 v57, v33, v35, s61
    v_perm_b32 v58, v34, v35, s62
    buffer_store_dwordx4 v[56:59], v23, s[36:39], s59 offen sc1
    v_cndmask_b32 v40, v40, v44, vcc
    v_cndmask_b32 v41, v41, v45, vcc
    v_cndmask_b32 v42, v42, v46, vcc
    v_cndmask_b32 v43, v43, v47, vcc
    v_perm_b32 v60, v40, v43, s60
    v_perm_b32 v61, v41, v43, s61
    v_perm_b32 v62, v42, v43, s62
    buffer_store_dwordx4 v[60:63], v23, s[36:39], s99 offen sc1
    v_cndmask_b32 v48, v48, v52, vcc
    v_cndmask_b32 v49, v49, v53, vcc
    v_cndmask_b32 v50, v50, v54, vcc
    v_cndmask_b32 v51, v51, v55, vcc
    v_perm_b32 v64, v48, v51, s60
    v_perm_b32 v65, v49, v51, s61
    v_perm_b32 v66, v50, v51, s62
    s_cmp_ge_u32 s3, 2
    s_nop 0
    s_cbranch_scc1 .Lbc_nost3
    buffer_store_dwordx4 v[64:67], v23, s[36:39], s100 offen sc1
.Lbc_nost3:
.Lexit:
.Lend:
s_endpgm
.section .rodata,"a"
.p2align 6
.amdhsa_kernel adaLN_cond__sliding_block_cached__moe_arch_mod__decode_kernel
  .amdhsa_next_free_vgpr 256
  .amdhsa_next_free_sgpr 102
  .amdhsa_accum_offset 256
  .amdhsa_group_segment_fixed_size 0
  .amdhsa_kernarg_size 120
  .amdhsa_user_sgpr_count 2
  .amdhsa_user_sgpr_kernarg_segment_ptr 1
  .amdhsa_system_sgpr_workgroup_id_x 1
.end_amdhsa_kernel
```

```asm
; @launch grid=(256,1,1) block=(512,1,1) lds=159360
.amdgcn_target "amdgcn-amd-amdhsa--gfx950"
.text
.p2align 12
.globl adaLN_cond__sliding_block_cached__moe_arch_mod__decode_kernel
.p2align 8
.type adaLN_cond__sliding_block_cached__moe_arch_mod__decode_kernel,@function
adaLN_cond__sliding_block_cached__moe_arch_mod__decode_kernel:
    s_cmp_ge_u32 s2, 256
    s_cbranch_scc1 .Lend
    s_load_dwordx16 s[4:19], s[0:1], 0
    s_load_dwordx8 s[20:27], s[0:1], 64
    s_load_dwordx4 s[28:31], s[0:1], 96
    s_load_dwordx2 s[32:33], s[0:1], 112
    s_memrealtime s[70:71]
    v_lshrrev_b32 v1, 6, v0
    v_and_b32 v0, 63, v0
    v_readfirstlane_b32 s3, v1
    s_cmp_lt_u32 s3, 4
    s_nop 3
    s_cbranch_scc1 .Ltw_done
    s_cmp_lt_u32 s2, 72
    s_cbranch_scc1 .Ltw_m
    s_cmp_lt_u32 s2, 144
    s_cbranch_scc1 .Ltw_b
    s_cmp_lt_u32 s2, 208
    s_cbranch_scc1 .Ltw_q
    s_cmp_eq_u32 s3, 4
    s_cbranch_scc1 .Lst_a0_0
    s_cmp_eq_u32 s3, 5
    s_cbranch_scc1 .Lst_a0_1
.Lrt_a0_0:
.Lrt_a0_1:
    s_branch .Ltw_done
.Ltw_m:
    s_cmp_eq_u32 s3, 4
    s_cbranch_scc1 .Lst_m0_0
    s_cmp_eq_u32 s3, 5
    s_cbranch_scc1 .Lst_m0_1
.Lrt_m0_1:
    s_cmp_eq_u32 s3, 6
    s_cbranch_scc1 .Lst_m0_2
.Lrt_m0_2:
    s_cmp_eq_u32 s3, 7
    s_cbranch_scc1 .Lst_m0_3
    s_cmp_eq_u32 s3, 5
    s_cbranch_scc1 .Lst_m0_4
    s_cmp_eq_u32 s3, 6
    s_cbranch_scc1 .Lst_m0_5
.Lrt_m0_0:
.Lrt_m0_3:
.Lrt_m0_4:
.Lrt_m0_5:
    s_branch .Ltw_done
.Ltw_b:
    s_cmp_eq_u32 s3, 4
    s_cbranch_scc1 .Lst_b0_0
    s_cmp_eq_u32 s3, 5
    s_cbranch_scc1 .Lst_b0_1
    s_cmp_eq_u32 s3, 6
    s_cbranch_scc1 .Lst_b0_2
    s_cmp_eq_u32 s3, 7
    s_cbranch_scc1 .Lst_b0_3
.Lrt_b0_0:
.Lrt_b0_1:
.Lrt_b0_2:
.Lrt_b0_3:
    s_branch .Ltw_done
.Ltw_q:
    s_cmp_eq_u32 s3, 4
    s_cbranch_scc1 .Lst_q0_0
    s_cmp_eq_u32 s3, 5
    s_cbranch_scc1 .Lst_q0_1
    s_cmp_eq_u32 s3, 6
    s_cbranch_scc1 .Lst_q0_2
    s_cmp_eq_u32 s3, 7
    s_cbranch_scc1 .Lst_q0_3
.Lrt_q0_0:
.Lrt_q0_1:
.Lrt_q0_2:
.Lrt_q0_3:
.Ltw_done:
    s_mov_b32 s35, 0x3ffff
    s_mov_b32 s98, 0xbfb8aa3b
    s_mov_b32 s94, 0x05040100
    s_mov_b32 s95, 0x07060302
    s_mov_b32 s96, 0xaaaaaaaa
    s_mov_b32 s97, 0xaaaaaaaa
    s_and_b32 s64, s2, 7
    s_lshr_b32 s65, s2, 3
    s_mov_b32 s58, 0x2554433
    s_mov_b32 s59, 0x2877661
    s_cmp_ge_u32 s65, 16
    s_cselect_b32 s58, 0xbb1aa998, s58
    s_cselect_b32 s59, 0xffeeddcc, s59
    s_lshl_b32 s57, s65, 2
    s_lshr_b64 s[58:59], s[58:59], s57
    s_lshl1_add_u32 s59, s64, 1
    s_mul_i32 s58, s58, s59
    s_add_u32 s58, s58, s64
    s_add_u32 s58, s58, s59
    s_and_b32 s66, s58, 7
    s_bfe_u32 s67, s58, 0x10003
    s_lshl1_add_u32 s67, s64, s67
    s_lshr_b32 s68, 0xaab5d42a, s65
    s_and_b32 s68, s68, 1
    s_movk_i32 s60, 0x7651
    s_cselect_b32 s60, 0x4320, s60
    s_lshl4_add_u32 s69, s66, s67
    s_lshl_b32 s69, s69, 21
    s_cmp_eq_u32 s64, 7
    s_cselect_b32 s58, 0x4040, 0
    s_or_b32 s58, s58, 0x208180
    s_bitcmp1_b32 s58, s65
    s_cselect_b32 s60, s60, 0x3210
    s_and_b32 s57, s3, 1
    s_and_b32 s59, s3, 6
    s_cmpk_eq_u32 s60, 0x3210
    s_cselect_b32 s57, s68, s57
    s_cselect_b32 s59, s3, s59
    s_lshl_b32 s57, s57, 16
    s_lshl_b32 s59, s59, 10
    s_add_u32 s69, s69, s57
    s_add_u32 s69, s69, s59
    s_add_u32 s69, s69, 0x180000
    v_bfe_u32 v1, v0, 2, 2
    v_lshlrev_b32 v1, 2, v1
    v_bfe_u32 v1, s60, v1, 4
    v_lshrrev_b32 v2, 4, v0
    v_lshl_add_u32 v1, v1, 2, v2
    v_and_b32 v2, 3, v0
    v_lshl_add_u32 v1, v1, 2, v2
    v_lshlrev_b32 v1, 4, v1
    v_lshlrev_b32 v2, 4, v0
    v_lshlrev_b32 v3, 3, v0
    v_and_b32 v4, 31, v0
    v_lshlrev_b32 v4, 2, v4
    v_add_u32 v4, 1024, v4
    v_lshlrev_b32 v5, 1, v4
    s_waitcnt lgkmcnt(0)
    s_load_dword s34, s[32:33], 0
    s_mov_b32 s40, s6
    s_and_b32 s41, s7, 0xffff
    s_mov_b32 s42, 0x10000000
    s_mov_b32 s43, 0x00020000
    s_mov_b32 s6, s60
    s_add_u32 s63, s69, 0
    buffer_load_dwordx4 v[32:35], v1, s[40:43], s63 offen nt
    s_add_u32 s63, s69, 8192
    buffer_load_dwordx4 v[36:39], v1, s[40:43], s63 offen nt
    s_add_u32 s63, s69, 16384
    buffer_load_dwordx4 v[64:67], v1, s[40:43], s63 offen nt
    s_add_u32 s63, s69, 24576
    buffer_load_dwordx4 v[68:71], v1, s[40:43], s63 offen nt
.Lnokpre:
    s_mov_b32 s44, s8
    s_and_b32 s45, s9, 0xffff
    s_mov_b32 s46, 0x10000000
    s_mov_b32 s47, 0x00020000
    s_cmp_eq_u32 s3, 0
    s_cselect_b64 exec, 1, 0
    buffer_load_dword v255, v2, s[44:47], s69 offen nt
    s_mov_b64 exec, -1
    s_mov_b32 s36, s32
    s_and_b32 s37, s33, 0xffff
    s_mov_b32 s38, 0x40000000
    s_mov_b32 s39, 0x00020000
    s_lshl3_add_u32 s56, s3, s2
    s_cmp_lt_u32 s56, 8
    s_cbranch_scc0 .Let_no
    s_lshl2_add_u32 s56, s2, 0x4a1000
    v_lshlrev_b32 v6, 8, v0
    v_mov_b32 v7, s70
    s_mov_b64 exec, 3
    buffer_store_dword v7, v6, s[36:39], s56 offen sc1
    s_mov_b64 exec, -1
.Let_no:
    v_mov_b32 v6, 159232
    v_mov_b32 v7, 0
    ds_write_b32 v6, v7
    s_waitcnt lgkmcnt(0)
    s_barrier
    s_cmp_lt_u32 s3, 4
    s_cbranch_scc1 1
    s_setprio 1
    s_cmp_lt_u32 s65, 9
    s_cbranch_scc1 .Lm
    s_cmp_lt_u32 s65, 18
    s_cbranch_scc1 .Lbc
    s_sub_u32 s65, s65, 18
    s_cmp_ge_u32 s65, 8
    s_cbranch_scc1 .La_early
    s_cmp_eq_u32 s65, 3
    s_mov_b32 s14, 0xb55aab55
    s_cselect_b32 s14, 0x8421084, s14
    s_mov_b32 s15, 0x5aab55aa
    s_cselect_b32 s15, 0x42108421, s15
    s_add_u32 s30, s70, 0
    s_mov_b32 s31, s70
    v_bfe_u32 v16, v0, 1, 3
    v_mul_u32_u24 v16, 1312, v16
    v_lshrrev_b32 v12, 4, v0
    v_lshl_add_u32 v16, v12, 5, v16
    v_and_b32 v12, 1, v0
    v_lshl_add_u32 v16, v12, 4, v16
    v_add_u32 v16, 147456, v16
    s_mul_i32 s56, s3, 1312
    s_add_u32 s56, s56, 147456
    v_add_u32 v17, s56, v3
    v_add_u32 v18, s56, v4
    v_lshrrev_b32 v12, 4, v0
    v_bfe_u32 v13, v0, 1, 1
    v_lshl_add_u32 v12, v12, 1, v13
    v_bfe_u32 v13, v0, 2, 2
    v_lshl_add_u32 v20, v12, 3, v13
    v_lshlrev_b32 v20, 7, v20
    v_and_b32 v12, 3, v12
    v_lshrrev_b32 v13, 1, v13
    v_lshl_add_u32 v12, v12, 1, v13
    v_xor_b32 v12, s3, v12
    v_lshl_add_u32 v20, v12, 4, v20
    v_and_b32 v12, 1, v0
    v_lshl_add_u32 v20, v12, 3, v20
    v_bfe_u32 v23, v0, 1, 3
    v_mul_u32_u24 v23, 144, v23
    v_bfe_u32 v12, v0, 4, 1
    v_lshl_add_u32 v23, v12, 3, v23
    s_branch .Lsk_q0_0
.Lst_q0_0:
    s_branch .Lrt_q0_0
.Lsk_q0_0:
    v_lshrrev_b32 v12, 5, v0
    v_lshl_add_u32 v23, v12, 2, v23
    v_and_b32 v12, 1, v0
    v_lshl_add_u32 v23, v12, 1, v23
    s_lshl_b32 s56, s3, 4
    s_add_u32 s56, s56, 157952
    v_add_u32 v23, s56, v23
    v_and_b32 v24, 15, v0
    v_lshlrev_b32 v24, 3, v24
    s_mul_i32 s56, s3, 144
    s_add_u32 s56, s56, 157952
    v_add_u32 v24, s56, v24
    v_add_u32 v21, 32768, v20
    s_lshl_b32 s100, s3, 10
    s_mul_i32 s58, s3, 1152
    s_mov_b32 s52, s4
    s_and_b32 s53, s5, 0xffff
    s_mov_b32 s54, 0x2400
    s_mov_b32 s55, 0x00020000
    buffer_load_dwordx2 v[246:247], v3, s[52:55], s58 offen
    buffer_load_dwordx2 v[248:249], v3, s[52:55], s58 offen offset:512
    buffer_load_dword v250, v4, s[52:55], s58 offen
    s_mov_b32 s48, s10
    s_and_b32 s49, s11, 0xffff
    s_mov_b32 s50, 0x480000
    s_mov_b32 s51, 0x00020000
    v_bfe_u32 v12, v0, 4, 1
    s_and_b32 s56, s3, 3
    s_lshl_b32 s56, s56, 1
    v_or_b32 v12, s56, v12
    v_and_b32 v19, 7, v0
    v_xor_b32 v12, v12, v19
    v_lshrrev_b32 v19, 3, v0
    v_mul_u32_u24 v19, 8192, v19
    v_lshl_add_u32 v19, v12, 4, v19
    s_lshl3_add_u32 s101, s64, s65
    s_lshl_b32 s57, s3, 16
    s_lshl_b32 s59, s101, 7
    s_add_u32 s57, s57, s59
    s_mov_b32 s99, s57
    s_add_u32 m0, s100, 0
    s_add_u32 s56, s99, 0
    buffer_load_dwordx4 v19, s[48:51], s56 offen nt lds
    s_add_u32 s63, s69, 32768
    buffer_load_dwordx4 v[96:99], v1, s[40:43], s63 offen nt
    s_waitcnt lgkmcnt(0)
    s_add_u32 s34, s34, 1
    s_getreg_b32 s1, hwreg(HW_REG_XCC_ID)
    s_lshl_b32 s1, s1, 24
    s_add_u32 s1, s1, s34
    s_lshr_b32 s0, s2, 3
    s_lshl_b32 s63, s64, 8
    s_add_u32 s0, s0, s63
    s_lshl2_add_u32 s0, s0, 0x480000
    v_mov_b32 v30, s1
    s_cmp_eq_u32 s3, 0
    s_cselect_b64 exec, 1, 0
    buffer_store_dword v30, v2, s[36:39], s0 offen sc1
    s_mov_b64 exec, -1
    s_and_b32 s58, s101, 1
    s_lshl_b32 s101, s101, 8
    s_lshl_b32 s58, s58, 7
    s_sub_u32 s101, s101, s58
    s_lshl_b32 s58, s3, 14
    s_add_u32 s101, s101, s58
    s_add_u32 s101, s101, 0x70000
    s_and_b32 s58, s64, 1
    s_mul_i32 s58, s58, 18432
    s_mul_i32 s59, s3, 2304
    s_add_u32 s58, s58, s59
    s_add_u32 s58, s58, 0x1000
    s_add_u32 s59, s58, 73728
    s_waitcnt vmcnt(5)
    s_add_u32 m0, s100, 8192
    s_add_u32 s56, s99, 524288
    buffer_load_dwordx4 v19, s[48:51], s56 offen nt lds
    s_waitcnt vmcnt(5)
    s_add_u32 s63, s69, 40960
    buffer_load_dwordx4 v[100:103], v1, s[40:43], s63 offen nt
    s_waitcnt vmcnt(5)
    s_add_u32 m0, s100, 16384
    s_add_u32 s56, s99, 1048576
    buffer_load_dwordx4 v19, s[48:51], s56 offen nt lds
    s_waitcnt vmcnt(5)
    s_add_u32 s63, s69, 49152
    buffer_load_dwordx4 v[128:131], v1, s[40:43], s63 offen nt
    v_lshlrev_b32 v236, 16, v246
    v_and_b32 v237, 0xffff0000, v246
    v_lshlrev_b32 v238, 16, v247
    v_and_b32 v239, 0xffff0000, v247
    v_lshlrev_b32 v240, 16, v248
    v_and_b32 v241, 0xffff0000, v248
    v_lshlrev_b32 v242, 16, v249
    v_and_b32 v243, 0xffff0000, v249
    v_lshlrev_b32 v244, 16, v250
    v_and_b32 v245, 0xffff0000, v250
    s_mov_b32 s56, 0x3f803f80
    v_dot2_f32_bf16 v10, v246, s56, 0
    v_dot2_f32_bf16 v11, v246, v246, 0
    v_dot2_f32_bf16 v10, v247, s56, v10
    v_dot2_f32_bf16 v11, v247, v247, v11
    v_dot2_f32_bf16 v10, v248, s56, v10
    v_dot2_f32_bf16 v11, v248, v248, v11
    v_dot2_f32_bf16 v10, v249, s56, v10
    v_dot2_f32_bf16 v11, v249, v249, v11
    s_mov_b64 exec, 0xffffffff
    v_dot2_f32_bf16 v10, v250, s56, v10
    v_dot2_f32_bf16 v11, v250, v250, v11
    s_mov_b64 exec, -1
    s_nop 1
    v_permlane32_swap_b32 v10, v11
    v_add_f32 v10, v10, v11
    v_mov_b32 v12, v10
    s_nop 1
    v_permlane16_swap_b32 v12, v10
    v_add_f32 v10, v12, v10
    s_nop 1
    v_add_f32_dpp v10, v10, v10 row_ror:8 row_mask:0xf bank_mask:0xf
    s_nop 1
    v_add_f32_dpp v10, v10, v10 row_ror:4 row_mask:0xf bank_mask:0xf
    s_nop 1
    v_add_f32_dpp v10, v10, v10 quad_perm:[2,3,0,1] row_mask:0xf bank_mask:0xf
    s_nop 1
    v_add_f32_dpp v10, v10, v10 quad_perm:[1,0,3,2] row_mask:0xf bank_mask:0xf
    v_mul_f32 v10, 0x3ae38e39, v10
    s_nop 0
    v_readlane_b32 s56, v10, 0
    v_readlane_b32 s57, v10, 32
    s_nop 0
    v_mov_b32 v10, s56
    v_fma_f32 v11, -v10, v10, s57
    v_max_f32 v11, 0, v11
    v_cvt_pk_bf16_f32 v12, -v10, v11
    v_and_b32 v13, 0xffff0000, v12
    v_add_f32 v13, 0x3727c5ac, v13
    v_lshlrev_b32 v10, 16, v12
    v_cvt_pk_bf16_f32 v13, v13, v13
    v_lshlrev_b32 v13, 16, v13
    v_sqrt_f32 v13, v13
    v_mov_b32 v11, v10
    v_cvt_pk_bf16_f32 v13, v13, v13
    v_lshlrev_b32 v13, 16, v13
    v_rcp_f32 v12, v13
    v_rcp_f32 v13, v13
    v_pk_add_f32 v[236:237], v[236:237], v[10:11]
    v_pk_add_f32 v[238:239], v[238:239], v[10:11]
    v_pk_add_f32 v[240:241], v[240:241], v[10:11]
    v_pk_add_f32 v[242:243], v[242:243], v[10:11]
    v_pk_add_f32 v[244:245], v[244:245], v[10:11]
    v_cvt_pk_bf16_f32 v236, v236, v237
    v_and_b32 v237, 0xffff0000, v236
    v_lshlrev_b32 v236, 16, v236
    v_cvt_pk_bf16_f32 v238, v238, v239
    v_and_b32 v239, 0xffff0000, v238
    v_lshlrev_b32 v238, 16, v238
    v_cvt_pk_bf16_f32 v240, v240, v241
    v_and_b32 v241, 0xffff0000, v240
    v_lshlrev_b32 v240, 16, v240
    v_cvt_pk_bf16_f32 v242, v242, v243
    v_and_b32 v243, 0xffff0000, v242
    v_lshlrev_b32 v242, 16, v242
    v_cvt_pk_bf16_f32 v244, v244, v245
    v_and_b32 v245, 0xffff0000, v244
    v_lshlrev_b32 v244, 16, v244
    v_pk_mul_f32 v[236:237], v[236:237], v[12:13]
    v_pk_mul_f32 v[238:239], v[238:239], v[12:13]
    v_pk_mul_f32 v[240:241], v[240:241], v[12:13]
    v_pk_mul_f32 v[242:243], v[242:243], v[12:13]
    v_pk_mul_f32 v[244:245], v[244:245], v[12:13]
    v_cvt_pk_bf16_f32 v236, v236, v237
    v_and_b32 v237, 0xffff0000, v236
    v_lshlrev_b32 v236, 16, v236
    v_cvt_pk_bf16_f32 v238, v238, v239
    v_and_b32 v239, 0xffff0000, v238
    v_lshlrev_b32 v238, 16, v238
    v_cvt_pk_bf16_f32 v240, v240, v241
    s_branch .Lsk_q0_1
.Lst_q0_1:
    s_branch .Lrt_q0_1
.Lsk_q0_1:
    v_and_b32 v241, 0xffff0000, v240
    v_lshlrev_b32 v240, 16, v240
    v_cvt_pk_bf16_f32 v242, v242, v243
    v_and_b32 v243, 0xffff0000, v242
    v_lshlrev_b32 v242, 16, v242
    v_cvt_pk_bf16_f32 v244, v244, v245
    v_and_b32 v245, 0xffff0000, v244
    v_lshlrev_b32 v244, 16, v244
    s_waitcnt vmcnt(5)
    s_add_u32 m0, s100, 24576
    s_add_u32 s56, s99, 1572864
    buffer_load_dwordx4 v19, s[48:51], s56 offen nt lds
    s_waitcnt vmcnt(4)
    s_add_u32 s63, s69, 57344
    buffer_load_dwordx4 v[132:135], v1, s[40:43], s63 offen nt
    s_waitcnt vmcnt(4)
    s_add_u32 m0, s100, 32768
    s_add_u32 s56, s99, 2097152
    buffer_load_dwordx4 v19, s[48:51], s56 offen nt lds
    s_waitcnt vmcnt(4)
    s_add_u32 s63, s69, 131072
    buffer_load_dwordx4 v[40:43], v1, s[40:43], s63 offen nt
    s_waitcnt vmcnt(4)
    s_add_u32 m0, s100, 40960
    s_add_u32 s56, s99, 2621440
    buffer_load_dwordx4 v19, s[48:51], s56 offen nt lds
    s_waitcnt vmcnt(4)
    s_add_u32 s63, s69, 139264
    buffer_load_dwordx4 v[44:47], v1, s[40:43], s63 offen nt
    s_waitcnt vmcnt(4)
    s_add_u32 m0, s100, 49152
    s_add_u32 s56, s99, 3145728
    buffer_load_dwordx4 v19, s[48:51], s56 offen nt lds
    s_waitcnt vmcnt(4)
    s_add_u32 s63, s69, 147456
    buffer_load_dwordx4 v[72:75], v1, s[40:43], s63 offen nt
    s_waitcnt vmcnt(4)
    s_add_u32 m0, s100, 57344
    s_add_u32 s56, s99, 3670016
    buffer_load_dwordx4 v19, s[48:51], s56 offen nt lds
    s_waitcnt vmcnt(4)
    s_add_u32 s63, s69, 155648
    buffer_load_dwordx4 v[76:79], v1, s[40:43], s63 offen nt
    s_waitcnt vmcnt(4)
    s_add_u32 m0, s100, 65536
    s_add_u32 s56, s99, 4194304
    buffer_load_dwordx4 v19, s[48:51], s56 offen nt lds
    s_waitcnt vmcnt(4)
    s_add_u32 s63, s69, 163840
    buffer_load_dwordx4 v[104:107], v1, s[40:43], s63 offen nt
    s_waitcnt vmcnt(4)
    s_add_u32 s63, s69, 172032
    buffer_load_dwordx4 v[108:111], v1, s[40:43], s63 offen nt
    s_waitcnt vmcnt(4)
    s_add_u32 s63, s69, 180224
    buffer_load_dwordx4 v[136:139], v1, s[40:43], s63 offen nt
    s_waitcnt vmcnt(4)
    s_add_u32 s63, s69, 188416
    buffer_load_dwordx4 v[140:143], v1, s[40:43], s63 offen nt
    s_waitcnt vmcnt(4)
    s_add_u32 s63, s69, 262144
    buffer_load_dwordx4 v[48:51], v1, s[40:43], s63 offen nt
    s_waitcnt vmcnt(4)
    s_add_u32 s63, s69, 270336
    buffer_load_dwordx4 v[52:55], v1, s[40:43], s63 offen nt
    buffer_load_dwordx4 v[196:199], v2, s[36:39], s58 offen offset:0 sc1
    buffer_load_dwordx4 v[200:203], v2, s[36:39], s58 offen offset:1024 sc1
    buffer_load_dwordx2 v[204:205], v5, s[36:39], s58 offen offset:0 sc1
    buffer_load_dwordx4 v[206:209], v2, s[36:39], s59 offen offset:0 sc1
    buffer_load_dwordx4 v[210:213], v2, s[36:39], s59 offen offset:1024 sc1
    buffer_load_dwordx2 v[214:215], v5, s[36:39], s59 offen offset:0 sc1
    s_add_u32 s63, s69, 278528
    buffer_load_dwordx4 v[80:83], v1, s[40:43], s63 offen nt
    s_add_u32 s63, s69, 286720
    buffer_load_dwordx4 v[84:87], v1, s[40:43], s63 offen nt
    s_add_u32 s63, s69, 294912
    buffer_load_dwordx4 v[112:115], v1, s[40:43], s63 offen nt
    s_barrier
    ds_read_b64_tr_b16 v[160:161], v20 offset:0
    ds_read_b64_tr_b16 v[162:163], v20 offset:512
    ds_read_b64_tr_b16 v[164:165], v20 offset:8192
    ds_read_b64_tr_b16 v[166:167], v20 offset:8704
    ds_read_b64_tr_b16 v[168:169], v20 offset:16384
    ds_read_b64_tr_b16 v[170:171], v20 offset:16896
    ds_read_b64_tr_b16 v[172:173], v20 offset:24576
    ds_read_b64_tr_b16 v[174:175], v20 offset:25088
    ds_read_b64_tr_b16 v[176:177], v21 offset:0
    ds_read_b64_tr_b16 v[178:179], v21 offset:512
    ds_read_b64_tr_b16 v[180:181], v21 offset:8192
    ds_read_b64_tr_b16 v[182:183], v21 offset:8704
    ds_read_b64_tr_b16 v[184:185], v21 offset:16384
    ds_read_b64_tr_b16 v[186:187], v21 offset:16896
    ds_read_b64_tr_b16 v[188:189], v21 offset:24576
    ds_read_b64_tr_b16 v[190:191], v21 offset:25088
    ds_read_b64_tr_b16 v[192:193], v21 offset:32768
    ds_read_b64_tr_b16 v[194:195], v21 offset:33280
    s_add_u32 s63, s69, 303104
    buffer_load_dwordx4 v[116:119], v1, s[40:43], s63 offen nt
    s_waitcnt vmcnt(4)
    s_branch .gpc_2
.gp_1:
    buffer_load_dwordx4 v[196:199], v2, s[36:39], s58 offen offset:0 sc1
    buffer_load_dwordx4 v[200:203], v2, s[36:39], s58 offen offset:1024 sc1
    buffer_load_dwordx2 v[204:205], v5, s[36:39], s58 offen offset:0 sc1
    buffer_load_dwordx4 v[206:209], v2, s[36:39], s59 offen offset:0 sc1
    buffer_load_dwordx4 v[210:213], v2, s[36:39], s59 offen offset:1024 sc1
    buffer_load_dwordx2 v[214:215], v5, s[36:39], s59 offen offset:0 sc1
    s_waitcnt vmcnt(0)
.gpc_2:
    v_min_u32 v10, v197, v199
    v_max_u32 v11, v197, v199
    v_min3_u32 v10, v10, v201, v203
    v_max3_u32 v11, v11, v201, v203
    v_min3_u32 v10, v10, v205, v207
    v_max3_u32 v11, v11, v205, v207
    v_min3_u32 v10, v10, v209, v211
    v_max3_u32 v11, v11, v209, v211
    v_min3_u32 v10, v10, v213, v215
    v_max3_u32 v11, v11, v213, v215
    v_cmp_eq_u32 vcc, s34, v10
    v_cmp_eq_u32 s[56:57], s34, v11
    s_and_b64 vcc, vcc, s[56:57]
    s_cmp_eq_u64 vcc, -1
    s_nop 2
    s_cbranch_scc1 .gpd_3
    s_sub_u32 s35, s35, 1
    s_cbranch_scc1 .Lexit
    s_branch .gp_1
.gpd_3:
    s_add_u32 s63, s69, 311296
    buffer_load_dwordx4 v[144:147], v1, s[40:43], s63 offen nt
    v_and_b32 v207, 0xffff0000, v206
    v_lshlrev_b32 v206, 16, v206
    v_and_b32 v209, 0xffff0000, v208
    v_lshlrev_b32 v208, 16, v208
    v_and_b32 v211, 0xffff0000, v210
    v_lshlrev_b32 v210, 16, v210
    v_and_b32 v213, 0xffff0000, v212
    v_lshlrev_b32 v212, 16, v212
    v_and_b32 v215, 0xffff0000, v214
    v_lshlrev_b32 v214, 16, v214
    v_and_b32 v197, 0xffff0000, v196
    v_lshlrev_b32 v196, 16, v196
    v_and_b32 v199, 0xffff0000, v198
    v_lshlrev_b32 v198, 16, v198
    v_and_b32 v201, 0xffff0000, v200
    v_lshlrev_b32 v200, 16, v200
    v_and_b32 v203, 0xffff0000, v202
    v_lshlrev_b32 v202, 16, v202
    v_and_b32 v205, 0xffff0000, v204
    v_lshlrev_b32 v204, 16, v204
    v_pk_mul_f32 v[236:237], v[236:237], v[206:207]
    v_pk_mul_f32 v[238:239], v[238:239], v[208:209]
    v_pk_mul_f32 v[240:241], v[240:241], v[210:211]
    v_pk_mul_f32 v[242:243], v[242:243], v[212:213]
    v_pk_mul_f32 v[244:245], v[244:245], v[214:215]
    v_cvt_pk_bf16_f32 v236, v236, v237
    v_and_b32 v237, 0xffff0000, v236
    v_lshlrev_b32 v236, 16, v236
    v_cvt_pk_bf16_f32 v238, v238, v239
    v_and_b32 v239, 0xffff0000, v238
    s_branch .Lsk_q0_2
.Lst_q0_2:
    s_branch .Lrt_q0_2
.Lsk_q0_2:
    v_lshlrev_b32 v238, 16, v238
    v_cvt_pk_bf16_f32 v240, v240, v241
    v_and_b32 v241, 0xffff0000, v240
    v_lshlrev_b32 v240, 16, v240
    v_cvt_pk_bf16_f32 v242, v242, v243
    v_and_b32 v243, 0xffff0000, v242
    v_lshlrev_b32 v242, 16, v242
    v_cvt_pk_bf16_f32 v244, v244, v245
    s_branch .Lsk_q0_3
.Lst_q0_3:
    s_branch .Lrt_q0_3
.Lsk_q0_3:
    v_and_b32 v245, 0xffff0000, v244
    v_lshlrev_b32 v244, 16, v244
    v_pk_add_f32 v[236:237], v[236:237], v[196:197]
    v_pk_add_f32 v[238:239], v[238:239], v[198:199]
    v_pk_add_f32 v[240:241], v[240:241], v[200:201]
    v_pk_add_f32 v[242:243], v[242:243], v[202:203]
    v_pk_add_f32 v[244:245], v[244:245], v[204:205]
    v_cvt_pk_bf16_f32 v246, v236, v237
    v_cvt_pk_bf16_f32 v247, v238, v239
    v_cvt_pk_bf16_f32 v248, v240, v241
    v_cvt_pk_bf16_f32 v249, v242, v243
    v_cvt_pk_bf16_f32 v250, v244, v245
    ds_write_b64 v17, v[246:247] offset:0
    ds_write_b64 v17, v[248:249] offset:512
    ds_write_b32 v18, v250 offset:0
    s_add_u32 s63, s69, 319488
    buffer_load_dwordx4 v[148:151], v1, s[40:43], s63 offen nt
    s_waitcnt lgkmcnt(0)
    s_barrier
    s_add_u32 s63, s69, 393216
    buffer_load_dwordx4 v[56:59], v1, s[40:43], s63 offen nt
    ds_read_b128 v[196:199], v16 offset:0
    ds_read_b128 v[200:203], v16 offset:128
    ds_read_b128 v[204:207], v16 offset:256
    ds_read_b128 v[208:211], v16 offset:384
    ds_read_b128 v[212:215], v16 offset:512
    ds_read_b128 v[216:219], v16 offset:640
    ds_read_b128 v[220:223], v16 offset:768
    ds_read_b128 v[224:227], v16 offset:896
    ds_read_b128 v[228:231], v16 offset:1024
    s_waitcnt lgkmcnt(8)
    v_mfma_f32_16x16x32_bf16 v[232:235], v[160:163], v[196:199], 0
    s_waitcnt lgkmcnt(7)
    v_mfma_f32_16x16x32_bf16 v[232:235], v[164:167], v[200:203], v[232:235]
    s_waitcnt lgkmcnt(6)
    v_mfma_f32_16x16x32_bf16 v[232:235], v[168:171], v[204:207], v[232:235]
    s_waitcnt lgkmcnt(5)
    v_mfma_f32_16x16x32_bf16 v[232:235], v[172:175], v[208:211], v[232:235]
    s_waitcnt lgkmcnt(4)
    v_mfma_f32_16x16x32_bf16 v[232:235], v[176:179], v[212:215], v[232:235]
    s_waitcnt lgkmcnt(3)
    v_mfma_f32_16x16x32_bf16 v[232:235], v[180:183], v[216:219], v[232:235]
    s_waitcnt lgkmcnt(2)
    v_mfma_f32_16x16x32_bf16 v[232:235], v[184:187], v[220:223], v[232:235]
    s_waitcnt lgkmcnt(1)
    v_mfma_f32_16x16x32_bf16 v[232:235], v[188:191], v[224:227], v[232:235]
    s_waitcnt lgkmcnt(0)
    v_mfma_f32_16x16x32_bf16 v[232:235], v[192:195], v[228:231], v[232:235]
    s_nop 7
    v_permlane32_swap_b32 v232, v234
    v_permlane32_swap_b32 v233, v235
    v_cndmask_b32 v233, v233, v234, s[96:97]
    v_cndmask_b32 v232, v232, v235, s[96:97]
    s_nop 1
    v_add_f32_dpp v236, v233, v232 quad_perm:[1,0,3,2] row_mask:0xf bank_mask:0xf
    v_and_b32 v12, 1, v0
    v_lshlrev_b32 v12, 8, v12
    v_bfe_u32 v13, v0, 1, 3
    v_lshl_add_u32 v12, v13, 4, v12
    v_cvt_pk_bf16_f32 v236, v236, v236
    ds_write_b16 v23, v236
    v_mov_b32 v243, s34
    s_waitcnt lgkmcnt(0)
    s_barrier
    ds_read2_b32 v[244:245], v24 offset1:1
    v_mov_b32 v241, s34
    s_waitcnt lgkmcnt(0)
    v_mov_b32 v240, v244
    v_mov_b32 v242, v245
    s_mov_b64 exec, 0xffff
    buffer_store_dwordx4 v[240:243], v12, s[36:39], s101 offen sc1
    s_mov_b64 exec, -1
    s_waitcnt vmcnt(3)
    s_bitcmp1_b64 s[14:15], 25
    s_cbranch_scc0 1
    s_waitcnt vmcnt(2)
    s_add_u32 s63, s69, 401408
    buffer_load_dwordx4 v[60:63], v1, s[40:43], s63 offen nt
    s_branch .Ln_att
.La_early:
    s_branch .Lsk_a0_0
.Lst_a0_0:
    s_branch .Lrt_a0_0
.Lsk_a0_0:
    s_mov_b32 s14, 0x6ddb76dd
    s_mov_b32 s15, 0xdb76ddb7
    s_add_u32 s30, s70, -60
    s_mov_b32 s31, s70
    s_cmp_ge_u32 s65, 11
    s_cselect_b32 s99, 1, 0
    s_mul_i32 s57, s99, 3
    s_sub_u32 s100, s65, s57
    s_sub_u32 s100, s100, 8
    s_lshl1_add_u32 s99, s64, s99
    s_mov_b32 s48, s12
    s_and_b32 s49, s13, 0xffff
    s_mov_b32 s50, 0x480000
    s_mov_b32 s51, 0x00020000
    v_bfe_u32 v12, v0, 4, 1
    s_and_b32 s56, s3, 1
    s_lshl_b32 s56, s56, 2
    v_lshl_or_b32 v12, v12, 1, s56
    v_and_b32 v13, 7, v0
    v_xor_b32 v12, v12, v13
    v_lshrrev_b32 v13, 3, v0
    v_mul_u32_u24 v13, 1152, v13
    v_lshl_add_u32 v6, v12, 4, v13
    s_mul_i32 s101, s99, 294912
    s_mul_i32 s56, s100, 384
    s_add_u32 s101, s101, s56
    s_mul_i32 s56, s3, 9216
    s_add_u32 s101, s101, s56
    s_lshl_b32 s57, s3, 10
    s_waitcnt vmcnt(4)
    s_add_u32 m0, s57, 0
    s_add_u32 s56, s101, 0
    buffer_load_dwordx4 v6, s[48:51], s56 offen nt lds
    s_waitcnt vmcnt(4)
    s_add_u32 m0, s57, 32768
    s_add_u32 s56, s101, 128
    buffer_load_dwordx4 v6, s[48:51], s56 offen nt lds
    s_waitcnt vmcnt(4)
    s_bitcmp1_b64 s[14:15], 4
    s_cbranch_scc0 1
    s_waitcnt vmcnt(3)
    s_add_u32 s63, s69, 32768
    buffer_load_dwordx4 v[96:99], v1, s[40:43], s63 offen nt
    s_waitcnt vmcnt(4)
    s_bitcmp1_b64 s[14:15], 5
    s_cbranch_scc0 1
    s_waitcnt vmcnt(2)
    s_add_u32 s63, s69, 40960
    buffer_load_dwordx4 v[100:103], v1, s[40:43], s63 offen nt
    s_waitcnt vmcnt(3)
    s_add_u32 m0, s57, 65536
    s_add_u32 s56, s101, 256
    buffer_load_dwordx4 v6, s[48:51], s56 offen nt lds
    s_waitcnt vmcnt(3)
    s_bitcmp1_b64 s[14:15], 6
    s_cbranch_scc0 1
    s_waitcnt vmcnt(2)
    s_add_u32 s63, s69, 49152
    buffer_load_dwordx4 v[128:131], v1, s[40:43], s63 offen nt
    s_waitcnt vmcnt(3)
    s_bitcmp1_b64 s[14:15], 7
    s_cbranch_scc0 1
    s_waitcnt vmcnt(2)
    s_add_u32 s63, s69, 57344
    buffer_load_dwordx4 v[132:135], v1, s[40:43], s63 offen nt
    s_waitcnt vmcnt(3)
    s_add_u32 m0, s57, 8192
    s_add_u32 s56, s101, 73728
    buffer_load_dwordx4 v6, s[48:51], s56 offen nt lds
    s_waitcnt vmcnt(3)
    s_bitcmp1_b64 s[14:15], 8
    s_cbranch_scc0 1
    s_waitcnt vmcnt(2)
    s_add_u32 s63, s69, 131072
    buffer_load_dwordx4 v[40:43], v1, s[40:43], s63 offen nt
    s_waitcnt vmcnt(3)
    s_bitcmp1_b64 s[14:15], 9
    s_cbranch_scc0 1
    s_waitcnt vmcnt(2)
    s_add_u32 s63, s69, 139264
    buffer_load_dwordx4 v[44:47], v1, s[40:43], s63 offen nt
    s_waitcnt vmcnt(3)
    s_add_u32 m0, s57, 40960
    s_add_u32 s56, s101, 73856
    buffer_load_dwordx4 v6, s[48:51], s56 offen nt lds
    s_waitcnt vmcnt(3)
    s_bitcmp1_b64 s[14:15], 10
    s_cbranch_scc0 1
    s_waitcnt vmcnt(2)
    s_add_u32 s63, s69, 147456
    buffer_load_dwordx4 v[72:75], v1, s[40:43], s63 offen nt
    s_waitcnt vmcnt(3)
    s_bitcmp1_b64 s[14:15], 11
    s_cbranch_scc0 1
    s_waitcnt vmcnt(2)
    s_add_u32 s63, s69, 155648
    buffer_load_dwordx4 v[76:79], v1, s[40:43], s63 offen nt
    s_waitcnt vmcnt(3)
    s_add_u32 m0, s57, 73728
    s_add_u32 s56, s101, 73984
    buffer_load_dwordx4 v6, s[48:51], s56 offen nt lds
    s_waitcnt vmcnt(3)
    s_waitcnt lgkmcnt(0)
    s_add_u32 s34, s34, 1
    s_getreg_b32 s1, hwreg(HW_REG_XCC_ID)
    s_lshl_b32 s1, s1, 24
    s_add_u32 s1, s1, s34
    s_lshr_b32 s0, s2, 3
    s_lshl_b32 s63, s64, 8
    s_add_u32 s0, s0, s63
    s_lshl2_add_u32 s0, s0, 0x480000
    v_mov_b32 v30, s1
    s_cmp_eq_u32 s3, 0
    s_cselect_b64 exec, 1, 0
    buffer_store_dword v30, v2, s[36:39], s0 offen sc1
    s_mov_b64 exec, -1
    s_bitcmp1_b64 s[14:15], 12
    s_cbranch_scc0 1
    s_waitcnt vmcnt(3)
    s_add_u32 s63, s69, 163840
    buffer_load_dwordx4 v[104:107], v1, s[40:43], s63 offen nt
    s_waitcnt vmcnt(4)
    s_bitcmp1_b64 s[14:15], 13
    s_cbranch_scc0 1
    s_waitcnt vmcnt(3)
    s_add_u32 s63, s69, 172032
    buffer_load_dwordx4 v[108:111], v1, s[40:43], s63 offen nt
    s_waitcnt vmcnt(4)
    s_add_u32 m0, s57, 16384
    s_add_u32 s56, s101, 147456
    buffer_load_dwordx4 v6, s[48:51], s56 offen nt lds
    s_waitcnt vmcnt(4)
    s_bitcmp1_b64 s[14:15], 14
    s_cbranch_scc0 1
    s_waitcnt vmcnt(2)
    s_add_u32 s63, s69, 180224
    buffer_load_dwordx4 v[136:139], v1, s[40:43], s63 offen nt
    s_waitcnt vmcnt(3)
    s_bitcmp1_b64 s[14:15], 15
    s_cbranch_scc0 1
    s_waitcnt vmcnt(2)
    s_add_u32 s63, s69, 188416
    buffer_load_dwordx4 v[140:143], v1, s[40:43], s63 offen nt
    s_waitcnt vmcnt(3)
    s_add_u32 m0, s57, 49152
    s_add_u32 s56, s101, 147584
    buffer_load_dwordx4 v6, s[48:51], s56 offen nt lds
    s_waitcnt vmcnt(3)
    s_bitcmp1_b64 s[14:15], 16
    s_cbranch_scc0 1
    s_waitcnt vmcnt(2)
    s_add_u32 s63, s69, 262144
    buffer_load_dwordx4 v[48:51], v1, s[40:43], s63 offen nt
    s_waitcnt vmcnt(3)
    s_bitcmp1_b64 s[14:15], 17
    s_cbranch_scc0 1
    s_waitcnt vmcnt(2)
    s_add_u32 s63, s69, 270336
    buffer_load_dwordx4 v[52:55], v1, s[40:43], s63 offen nt
    s_waitcnt vmcnt(3)
    s_add_u32 m0, s57, 81920
    s_add_u32 s56, s101, 147712
    buffer_load_dwordx4 v6, s[48:51], s56 offen nt lds
    s_waitcnt vmcnt(3)
    s_bitcmp1_b64 s[14:15], 18
    s_cbranch_scc0 1
    s_waitcnt vmcnt(2)
    s_add_u32 s63, s69, 278528
    buffer_load_dwordx4 v[80:83], v1, s[40:43], s63 offen nt
    s_waitcnt vmcnt(3)
    s_bitcmp1_b64 s[14:15], 19
    s_cbranch_scc0 1
    s_waitcnt vmcnt(2)
    s_add_u32 s63, s69, 286720
    buffer_load_dwordx4 v[84:87], v1, s[40:43], s63 offen nt
    s_waitcnt vmcnt(3)
    s_add_u32 m0, s57, 24576
    s_add_u32 s56, s101, 221184
    buffer_load_dwordx4 v6, s[48:51], s56 offen nt lds
    s_waitcnt vmcnt(3)
    s_bitcmp1_b64 s[14:15], 20
    s_cbranch_scc0 1
    s_waitcnt vmcnt(2)
    s_add_u32 s63, s69, 294912
    buffer_load_dwordx4 v[112:115], v1, s[40:43], s63 offen nt
    s_waitcnt vmcnt(3)
    s_bitcmp1_b64 s[14:15], 21
    s_cbranch_scc0 1
    s_waitcnt vmcnt(2)
    s_add_u32 s63, s69, 303104
    buffer_load_dwordx4 v[116:119], v1, s[40:43], s63 offen nt
    s_branch .Lsk_a0_1
.Lst_a0_1:
    s_branch .Lrt_a0_1
.Lsk_a0_1:
    s_waitcnt vmcnt(3)
    s_add_u32 m0, s57, 57344
    s_add_u32 s56, s101, 221312
    buffer_load_dwordx4 v6, s[48:51], s56 offen nt lds
    s_waitcnt vmcnt(3)
    s_bitcmp1_b64 s[14:15], 22
    s_cbranch_scc0 1
    s_waitcnt vmcnt(2)
    s_add_u32 s63, s69, 311296
    buffer_load_dwordx4 v[144:147], v1, s[40:43], s63 offen nt
    s_waitcnt vmcnt(3)
    s_bitcmp1_b64 s[14:15], 23
    s_cbranch_scc0 1
    s_waitcnt vmcnt(2)
    s_add_u32 s63, s69, 319488
    buffer_load_dwordx4 v[148:151], v1, s[40:43], s63 offen nt
    s_waitcnt vmcnt(3)
    s_add_u32 m0, s57, 90112
    s_add_u32 s56, s101, 221440
    buffer_load_dwordx4 v6, s[48:51], s56 offen nt lds
    s_waitcnt vmcnt(3)
    s_bitcmp1_b64 s[14:15], 24
    s_cbranch_scc0 1
    s_waitcnt vmcnt(2)
    s_add_u32 s63, s69, 393216
    buffer_load_dwordx4 v[56:59], v1, s[40:43], s63 offen nt
    s_waitcnt vmcnt(3)
    s_bitcmp1_b64 s[14:15], 25
    s_cbranch_scc0 1
    s_waitcnt vmcnt(2)
    s_add_u32 s63, s69, 401408
    buffer_load_dwordx4 v[60:63], v1, s[40:43], s63 offen nt
.Ln_att:
    v_and_b32 v8, 1, v0
    v_lshlrev_b32 v8, 8, v8
    v_and_b32 v9, 0x3c, v0
    v_lshl_add_u32 v9, v9, 2, v8
    v_add_u32 v7, v9, v8
    v_and_b32 v9, 0x3c, v0
    v_lshrrev_b32 v8, 4, v8
    v_and_b32 v9, 4, v0
    v_lshl_add_u32 v9, v9, 3, v8
    s_lshl_b32 s58, s66, 14
    s_lshl_b32 s59, s67, 10
    s_add_u32 s58, s58, s59
    s_add_u32 s58, s58, 0x70000
    s_lshl4_add_u32 s59, s66, s67
    s_lshl_b32 s59, s59, 7
    s_add_u32 s59, s59, 0x430000
    s_memrealtime s[8:9]
    s_waitcnt vmcnt(8)
    s_waitcnt lgkmcnt(0)
    s_sub_u32 s8, s8, s30
    s_cmpk_ge_u32 s8, 1211
    s_cbranch_scc1 .ap_4
    s_waitcnt vmcnt(5)
    s_cmpk_ge_u32 s8, 1111
    s_cbranch_scc1 .ap_4
    s_waitcnt vmcnt(3)
    s_bitcmp1_b64 s[14:15], 26
    s_cbranch_scc0 1
    s_waitcnt vmcnt(2)
    s_cmpk_ge_u32 s8, 991
    s_cbranch_scc1 .ap_4
    s_waitcnt vmcnt(1)
.ap_4:
    s_add_u32 s63, s69, 409600
    buffer_load_dwordx4 v[88:91], v1, s[40:43], s63 offen nt
    v_and_b32 v157, 7, v0
    v_lshlrev_b32 v157, 2, v157
    s_mov_b32 s63, 0x4a1000
    buffer_load_dword v156, v157, s[36:39], s63 offen
    s_cmp_eq_u32 s3, 0
    s_cbranch_scc1 .Lst_n1_0
.Lrt_n1_0:
    s_cmp_eq_u32 s3, 1
    s_cbranch_scc1 .Lst_n1_1
    s_cmp_eq_u32 s3, 2
    s_cbranch_scc1 .Lst_n1_2
    s_cmp_eq_u32 s3, 3
    s_cbranch_scc1 .Lst_n1_3
    s_cmp_eq_u32 s3, 4
    s_cbranch_scc1 .Lst_n1_4
    s_cmp_eq_u32 s3, 5
    s_cbranch_scc1 .Lst_n1_5
    s_cmp_eq_u32 s3, 6
    s_cbranch_scc1 .Lst_n1_6
    s_cmp_eq_u32 s3, 7
    s_cbranch_scc1 .Lst_n1_7
    s_cmp_eq_u32 s3, 0
    s_cbranch_scc1 .Lrt_n1_8
.Lrt_n1_1:
.Lrt_n1_2:
.Lrt_n1_3:
.Lrt_n1_4:
.Lrt_n1_5:
.Lrt_n1_6:
.Lrt_n1_7:
.Lrt_n1_8:
    s_memrealtime s[8:9]
    s_waitcnt vmcnt(9)
    s_waitcnt lgkmcnt(0)
    s_sub_u32 s8, s8, s30
    s_cmpk_ge_u32 s8, 1238
    s_cbranch_scc1 .ap_5
    s_waitcnt vmcnt(6)
    s_cmpk_ge_u32 s8, 1138
    s_cbranch_scc1 .ap_5
    s_waitcnt vmcnt(4)
    s_bitcmp1_b64 s[14:15], 27
    s_cbranch_scc0 1
    s_waitcnt vmcnt(3)
    s_cmpk_ge_u32 s8, 1018
    s_cbranch_scc1 .ap_5
    s_waitcnt vmcnt(2)
.ap_5:
    s_add_u32 s63, s69, 417792
    buffer_load_dwordx4 v[92:95], v1, s[40:43], s63 offen nt
    s_memrealtime s[8:9]
    s_waitcnt vmcnt(9)
    s_waitcnt lgkmcnt(0)
    s_sub_u32 s8, s8, s30
    s_cmpk_ge_u32 s8, 1265
    s_cbranch_scc1 .ap_6
    s_waitcnt vmcnt(6)
    s_cmpk_ge_u32 s8, 1165
    s_cbranch_scc1 .ap_6
    s_waitcnt vmcnt(4)
    s_bitcmp1_b64 s[14:15], 28
    s_cbranch_scc0 1
    s_waitcnt vmcnt(3)
    s_cmpk_ge_u32 s8, 1045
    s_cbranch_scc1 .ap_6
    s_waitcnt vmcnt(2)
.ap_6:
    s_add_u32 s63, s69, 425984
    buffer_load_dwordx4 v[120:123], v1, s[40:43], s63 offen nt
    s_memrealtime s[8:9]
    s_waitcnt vmcnt(9)
    s_waitcnt lgkmcnt(0)
    s_sub_u32 s8, s8, s30
    s_cmpk_ge_u32 s8, 1292
    s_cbranch_scc1 .ap_7
    s_waitcnt vmcnt(6)
    s_cmpk_ge_u32 s8, 1192
    s_cbranch_scc1 .ap_7
    s_waitcnt vmcnt(4)
    s_bitcmp1_b64 s[14:15], 29
    s_cbranch_scc0 1
    s_waitcnt vmcnt(3)
    s_cmpk_ge_u32 s8, 1072
    s_cbranch_scc1 .ap_7
    s_waitcnt vmcnt(1)
.ap_7:
    s_add_u32 s63, s69, 434176
    buffer_load_dwordx4 v[124:127], v1, s[40:43], s63 offen nt
    s_memrealtime s[8:9]
    s_waitcnt vmcnt(9)
    s_waitcnt lgkmcnt(0)
    s_sub_u32 s8, s8, s30
    s_cmpk_ge_u32 s8, 1320
    s_cbranch_scc1 .ap_8
    s_waitcnt vmcnt(6)
    s_cmpk_ge_u32 s8, 1220
    s_cbranch_scc1 .ap_8
    s_waitcnt vmcnt(4)
    s_bitcmp1_b64 s[14:15], 30
    s_cbranch_scc0 1
    s_waitcnt vmcnt(2)
    s_cmpk_ge_u32 s8, 1100
    s_cbranch_scc1 .ap_8
    s_waitcnt vmcnt(1)
.ap_8:
    s_add_u32 s63, s69, 442368
    buffer_load_dwordx4 v[152:155], v1, s[40:43], s63 offen nt
    s_waitcnt vmcnt(4)
    s_sub_u32 s63, s70, 300
    v_subrev_u32 v156, s63, v156
    v_mov_b32 v157, 600
    v_cmp_lt_u32 s[8:9], v156, v157
    v_add_u32_dpp v156, v156, v156 quad_perm:[1,0,3,2] row_mask:0xf bank_mask:0xf
    s_nop 1
    v_add_u32_dpp v156, v156, v156 quad_perm:[2,3,0,1] row_mask:0xf bank_mask:0xf
    s_nop 1
    v_add_u32_dpp v156, v156, v156 row_ror:4 row_mask:0xf bank_mask:0xf
    s_nop 0
    v_readfirstlane_b32 s63, v156
    s_cmp_eq_u64 s[8:9], -1
    s_nop 3
    s_cbranch_scc0 .et_9
    s_lshr_b32 s63, s63, 3
    s_sub_u32 s63, s63, 300
    s_add_u32 s30, s30, s63
    s_add_u32 s31, s31, s63
.et_9:
    s_memrealtime s[8:9]
    s_waitcnt lgkmcnt(0)
    s_sub_u32 s8, s8, s30
    s_cmpk_ge_u32 s8, 1347
    s_cbranch_scc1 .ap_10
    s_waitcnt vmcnt(4)
    s_cmpk_ge_u32 s8, 1247
    s_cbranch_scc1 .ap_10
    s_waitcnt vmcnt(3)
    s_bitcmp1_b64 s[14:15], 31
    s_cbranch_scc0 1
    s_waitcnt vmcnt(2)
    s_cmpk_ge_u32 s8, 1127
    s_cbranch_scc1 .ap_10
    s_waitcnt vmcnt(1)
.ap_10:
    s_add_u32 s63, s69, 450560
    buffer_load_dwordx4 v[156:159], v1, s[40:43], s63 offen nt
    s_memrealtime s[8:9]
    s_waitcnt lgkmcnt(0)
    s_sub_u32 s8, s8, s30
    s_cmpk_ge_u32 s8, 1374
    s_cbranch_scc1 .ap_11
    s_waitcnt vmcnt(5)
    s_cmpk_ge_u32 s8, 1274
    s_cbranch_scc1 .ap_11
    s_waitcnt vmcnt(3)
    s_bitcmp1_b64 s[14:15], 32
    s_cbranch_scc0 1
    s_waitcnt vmcnt(2)
    s_cmpk_ge_u32 s8, 1154
    s_cbranch_scc1 .ap_11
    s_waitcnt vmcnt(1)
.ap_11:
    v_bfe_u32 v1, v0, 4, 2
    v_and_b32 v10, 0xf0, v2
    v_lshlrev_b32 v1, 2, v1
    v_bfe_u32 v1, s6, v1, 4
    v_lshl_add_u32 v1, v1, 8, v10
    s_add_u32 s63, s69, 0
    buffer_load_dwordx4 v[160:163], v1, s[44:47], s63 offen nt
    s_memrealtime s[8:9]
    s_waitcnt lgkmcnt(0)
    s_sub_u32 s8, s8, s30
    s_cmpk_ge_u32 s8, 1401
    s_cbranch_scc1 .ap_12
    s_waitcnt vmcnt(5)
    s_cmpk_ge_u32 s8, 1301
    s_cbranch_scc1 .ap_12
    s_waitcnt vmcnt(3)
    s_bitcmp1_b64 s[14:15], 33
    s_cbranch_scc0 1
    s_waitcnt vmcnt(2)
    s_cmpk_ge_u32 s8, 1181
    s_cbranch_scc1 .ap_12
    s_waitcnt vmcnt(1)
.ap_12:
    s_add_u32 s63, s69, 8192
    buffer_load_dwordx4 v[164:167], v1, s[44:47], s63 offen nt
    s_memrealtime s[8:9]
    s_waitcnt lgkmcnt(0)
    s_sub_u32 s8, s8, s30
    s_cmpk_ge_u32 s8, 1428
    s_cbranch_scc1 .ap_13
    s_waitcnt vmcnt(5)
    s_cmpk_ge_u32 s8, 1328
    s_cbranch_scc1 .ap_13
    s_waitcnt vmcnt(3)
    s_bitcmp1_b64 s[14:15], 34
    s_cbranch_scc0 1
    s_waitcnt vmcnt(2)
    s_cmpk_ge_u32 s8, 1208
    s_cbranch_scc1 .ap_13
    s_waitcnt vmcnt(1)
.ap_13:
    s_add_u32 s63, s69, 16384
    buffer_load_dwordx4 v[168:171], v1, s[44:47], s63 offen nt
    s_memrealtime s[8:9]
    s_waitcnt lgkmcnt(0)
    s_sub_u32 s8, s8, s30
    s_cmpk_ge_u32 s8, 1456
    s_cbranch_scc1 .ap_14
    s_waitcnt vmcnt(5)
    s_cmpk_ge_u32 s8, 1356
    s_branch .Lsk_n1_0
.Lst_n1_0:
    s_branch .Lrt_n1_0
.Lsk_n1_0:
    s_cbranch_scc1 .ap_14
    s_waitcnt vmcnt(3)
    s_bitcmp1_b64 s[14:15], 35
    s_cbranch_scc0 1
    s_waitcnt vmcnt(2)
    s_cmpk_ge_u32 s8, 1236
    s_cbranch_scc1 .ap_14
    s_waitcnt vmcnt(1)
.ap_14:
    s_add_u32 s63, s69, 24576
    buffer_load_dwordx4 v[172:175], v1, s[44:47], s63 offen nt
    buffer_load_dwordx4 v[16:19], v7, s[36:39], s58 offen offset:0 sc1
    buffer_load_dwordx4 v[20:23], v7, s[36:39], s58 offen offset:256 sc1
    s_memrealtime s[8:9]
    s_waitcnt vmcnt(8)
    s_waitcnt lgkmcnt(0)
    s_sub_u32 s8, s8, s30
    s_cmpk_ge_u32 s8, 1486
    s_cbranch_scc1 .ap_15
    s_waitcnt vmcnt(5)
    s_cmpk_ge_u32 s8, 1386
    s_cbranch_scc1 .ap_15
    s_waitcnt vmcnt(3)
    s_bitcmp1_b64 s[14:15], 36
    s_cbranch_scc0 1
    s_waitcnt vmcnt(2)
    s_cmpk_ge_u32 s8, 1266
    s_cbranch_scc1 .ap_15
    s_waitcnt vmcnt(1)
.ap_15:
    s_add_u32 s63, s69, 32768
    buffer_load_dwordx4 v[176:179], v1, s[44:47], s63 offen nt
    s_memrealtime s[8:9]
    s_waitcnt vmcnt(8)
    s_waitcnt lgkmcnt(0)
    s_sub_u32 s8, s8, s30
    s_cmpk_ge_u32 s8, 1516
    s_cbranch_scc1 .ap_16
    s_waitcnt vmcnt(5)
    s_cmpk_ge_u32 s8, 1416
    s_cbranch_scc1 .ap_16
    s_waitcnt vmcnt(3)
    s_bitcmp1_b64 s[14:15], 37
    s_cbranch_scc0 1
    s_waitcnt vmcnt(2)
    s_cmpk_ge_u32 s8, 1296
    s_cbranch_scc1 .ap_16
    s_waitcnt vmcnt(1)
.ap_16:
    s_add_u32 s63, s69, 40960
    buffer_load_dwordx4 v[180:183], v1, s[44:47], s63 offen nt
    s_memrealtime s[8:9]
    s_waitcnt vmcnt(8)
    s_waitcnt lgkmcnt(0)
    s_sub_u32 s8, s8, s30
    s_cmpk_ge_u32 s8, 1546
    s_cbranch_scc1 .ap_17
    s_waitcnt vmcnt(5)
    s_cmpk_ge_u32 s8, 1446
    s_cbranch_scc1 .ap_17
    s_waitcnt vmcnt(3)
    s_bitcmp1_b64 s[14:15], 38
    s_cbranch_scc0 1
    s_waitcnt vmcnt(2)
    s_cmpk_ge_u32 s8, 1326
    s_cbranch_scc1 .ap_17
    s_waitcnt vmcnt(1)
.ap_17:
    s_add_u32 s63, s69, 49152
    buffer_load_dwordx4 v[184:187], v1, s[44:47], s63 offen nt
    s_waitcnt vmcnt(3)
    s_branch .gpc_19
.gp_18:
    buffer_load_dwordx4 v[16:19], v7, s[36:39], s58 offen offset:0 sc1
    buffer_load_dwordx4 v[20:23], v7, s[36:39], s58 offen offset:256 sc1
    s_waitcnt vmcnt(0)
.gpc_19:
    v_min_u32 v10, v17, v19
    v_max_u32 v11, v17, v19
    v_min3_u32 v10, v10, v21, v23
    v_max3_u32 v11, v11, v21, v23
    v_cmp_eq_u32 vcc, s34, v10
    v_cmp_eq_u32 s[56:57], s34, v11
    s_and_b64 vcc, vcc, s[56:57]
    s_cmp_eq_u64 vcc, -1
    s_nop 2
    s_cbranch_scc1 .gpd_20
    s_sub_u32 s35, s35, 1
    s_cbranch_scc1 .Lexit
    s_sleep 1
    s_branch .gp_18
.gpd_20:
    s_mov_b32 vcc_lo, 0xcccccccc
    s_mov_b32 vcc_hi, 0xcccccccc
    v_cndmask_b32_e64 v24, v16, 0, vcc
    v_cndmask_b32_e64 v25, v18, 0, vcc
    v_cndmask_b32_e64 v26, v20, 0, vcc
    v_cndmask_b32_e64 v27, v22, 0, vcc
    v_cndmask_b32_e32 v28, 0, v16, vcc
    v_cndmask_b32_e32 v29, 0, v18, vcc
    v_cndmask_b32_e32 v30, 0, v20, vcc
    v_cndmask_b32_e32 v31, 0, v22, vcc
    v_mfma_f32_16x16x32_bf16 v[16:19], v[32:35], v[24:27], 0
    v_mfma_f32_16x16x32_bf16 v[32:35], v[40:43], v[24:27], 0
    v_mfma_f32_16x16x32_bf16 v[16:19], v[36:39], v[28:31], v[16:19]
    v_mfma_f32_16x16x32_bf16 v[40:43], v[48:51], v[24:27], 0
    v_mfma_f32_16x16x32_bf16 v[32:35], v[44:47], v[28:31], v[32:35]
    v_mfma_f32_16x16x32_bf16 v[48:51], v[56:59], v[24:27], 0
    v_mfma_f32_16x16x32_bf16 v[40:43], v[52:55], v[28:31], v[40:43]
    v_mfma_f32_16x16x32_bf16 v[56:59], v[64:67], v[24:27], 0
    v_mfma_f32_16x16x32_bf16 v[48:51], v[60:63], v[28:31], v[48:51]
    s_nop 1
    v_add_f32_dpp v10, v17, v16 row_ror:12 row_mask:0xf bank_mask:0x1
    s_memrealtime s[8:9]
    s_waitcnt lgkmcnt(0)
    s_sub_u32 s8, s8, s30
    s_cmpk_ge_u32 s8, 1576
    s_nop 0
    s_cbranch_scc1 .ap_21
    s_waitcnt vmcnt(3)
    s_cmpk_ge_u32 s8, 1476
    s_cbranch_scc1 .ap_21
    s_waitcnt vmcnt(3)
    s_bitcmp1_b64 s[14:15], 39
    s_cbranch_scc0 1
    s_waitcnt vmcnt(2)
    s_cmpk_ge_u32 s8, 1356
    s_cbranch_scc1 .ap_21
    s_waitcnt vmcnt(1)
.ap_21:
    s_add_u32 s63, s69, 57344
    buffer_load_dwordx4 v[188:191], v1, s[44:47], s63 offen nt
    v_mfma_f32_16x16x32_bf16 v[64:67], v[72:75], v[24:27], 0
    v_mfma_f32_16x16x32_bf16 v[56:59], v[68:71], v[28:31], v[56:59]
    v_add_f32_dpp v11, v33, v32 row_ror:12 row_mask:0xf bank_mask:0x1
    v_add_f32_dpp v10, v18, v10 row_ror:8 row_mask:0xf bank_mask:0x1
    v_mfma_f32_16x16x32_bf16 v[72:75], v[80:83], v[24:27], 0
    v_mfma_f32_16x16x32_bf16 v[64:67], v[76:79], v[28:31], v[64:67]
    v_add_f32_dpp v12, v41, v40 row_ror:12 row_mask:0xf bank_mask:0x1
    v_add_f32_dpp v11, v34, v11 row_ror:8 row_mask:0xf bank_mask:0x1
    v_add_f32_dpp v10, v19, v10 row_ror:4 row_mask:0xf bank_mask:0x1
    v_mfma_f32_16x16x32_bf16 v[80:83], v[88:91], v[24:27], 0
    v_mfma_f32_16x16x32_bf16 v[72:75], v[84:87], v[28:31], v[72:75]
    v_add_f32_dpp v13, v49, v48 row_ror:12 row_mask:0xf bank_mask:0x1
    v_add_f32_dpp v12, v42, v12 row_ror:8 row_mask:0xf bank_mask:0x1
    v_add_f32_dpp v11, v35, v11 row_ror:4 row_mask:0xf bank_mask:0x1
    v_mfma_f32_16x16x32_bf16 v[88:91], v[96:99], v[24:27], 0
    v_mfma_f32_16x16x32_bf16 v[80:83], v[92:95], v[28:31], v[80:83]
    v_add_f32_dpp v10, v58, v57 row_ror:12 row_mask:0xf bank_mask:0x2
    v_add_f32_dpp v13, v50, v13 row_ror:8 row_mask:0xf bank_mask:0x1
    v_add_f32_dpp v12, v43, v12 row_ror:4 row_mask:0xf bank_mask:0x1
    s_memrealtime s[8:9]
    s_waitcnt lgkmcnt(0)
    s_sub_u32 s8, s8, s30
    s_cmpk_ge_u32 s8, 1606
    s_nop 0
    s_cbranch_scc1 .ap_22
    s_waitcnt vmcnt(4)
    s_cmpk_ge_u32 s8, 1506
    s_cbranch_scc1 .ap_22
    s_waitcnt vmcnt(3)
    s_bitcmp1_b64 s[14:15], 40
    s_cbranch_scc0 1
    s_waitcnt vmcnt(2)
    s_cmpk_ge_u32 s8, 1386
    s_cbranch_scc1 .ap_22
    s_waitcnt vmcnt(1)
.ap_22:
    s_add_u32 s63, s69, 131072
    buffer_load_dwordx4 v[192:195], v1, s[44:47], s63 offen nt
    v_mfma_f32_16x16x32_bf16 v[96:99], v[104:107], v[24:27], 0
    v_mfma_f32_16x16x32_bf16 v[88:91], v[100:103], v[28:31], v[88:91]
    v_add_f32_dpp v11, v66, v65 row_ror:12 row_mask:0xf bank_mask:0x2
    v_add_f32_dpp v10, v59, v10 row_ror:8 row_mask:0xf bank_mask:0x2
    v_add_f32_dpp v13, v51, v13 row_ror:4 row_mask:0xf bank_mask:0x1
    v_mfma_f32_16x16x32_bf16 v[104:107], v[112:115], v[24:27], 0
    v_mfma_f32_16x16x32_bf16 v[96:99], v[108:111], v[28:31], v[96:99]
    v_add_f32_dpp v12, v74, v73 row_ror:12 row_mask:0xf bank_mask:0x2
    v_add_f32_dpp v11, v67, v11 row_ror:8 row_mask:0xf bank_mask:0x2
    v_add_f32_dpp v10, v56, v10 row_ror:4 row_mask:0xf bank_mask:0x2
    v_mfma_f32_16x16x32_bf16 v[112:115], v[120:123], v[24:27], 0
    v_mfma_f32_16x16x32_bf16 v[104:107], v[116:119], v[28:31], v[104:107]
    v_add_f32_dpp v13, v82, v81 row_ror:12 row_mask:0xf bank_mask:0x2
    v_add_f32_dpp v12, v75, v12 row_ror:8 row_mask:0xf bank_mask:0x2
    v_add_f32_dpp v11, v64, v11 row_ror:4 row_mask:0xf bank_mask:0x2
    v_mfma_f32_16x16x32_bf16 v[120:123], v[128:131], v[24:27], 0
    v_mfma_f32_16x16x32_bf16 v[112:115], v[124:127], v[28:31], v[112:115]
    v_add_f32_dpp v10, v91, v90 row_ror:12 row_mask:0xf bank_mask:0x4
    v_add_f32_dpp v13, v83, v13 row_ror:8 row_mask:0xf bank_mask:0x2
    v_add_f32_dpp v12, v72, v12 row_ror:4 row_mask:0xf bank_mask:0x2
    s_memrealtime s[8:9]
    s_waitcnt lgkmcnt(0)
    s_sub_u32 s8, s8, s30
    s_cmpk_ge_u32 s8, 1636
    s_nop 0
    s_cbranch_scc1 .ap_23
    s_waitcnt vmcnt(5)
    s_cmpk_ge_u32 s8, 1536
    s_cbranch_scc1 .ap_23
    s_branch .Lsk_n1_1
.Lst_n1_1:
    s_branch .Lrt_n1_1
.Lsk_n1_1:
    s_waitcnt vmcnt(3)
    s_bitcmp1_b64 s[14:15], 41
    s_cbranch_scc0 1
    s_waitcnt vmcnt(2)
    s_cmpk_ge_u32 s8, 1416
    s_cbranch_scc1 .ap_23
    s_waitcnt vmcnt(1)
.ap_23:
    s_add_u32 s63, s69, 139264
    buffer_load_dwordx4 v[196:199], v1, s[44:47], s63 offen nt
    v_mfma_f32_16x16x32_bf16 v[128:131], v[136:139], v[24:27], 0
    v_mfma_f32_16x16x32_bf16 v[120:123], v[132:135], v[28:31], v[120:123]
    v_add_f32_dpp v11, v99, v98 row_ror:12 row_mask:0xf bank_mask:0x4
    v_add_f32_dpp v10, v88, v10 row_ror:8 row_mask:0xf bank_mask:0x4
    v_add_f32_dpp v13, v80, v13 row_ror:4 row_mask:0xf bank_mask:0x2
    v_mfma_f32_16x16x32_bf16 v[136:139], v[144:147], v[24:27], 0
    v_mfma_f32_16x16x32_bf16 v[128:131], v[140:143], v[28:31], v[128:131]
    v_add_f32_dpp v12, v107, v106 row_ror:12 row_mask:0xf bank_mask:0x4
    v_add_f32_dpp v11, v96, v11 row_ror:8 row_mask:0xf bank_mask:0x4
    v_add_f32_dpp v10, v89, v10 row_ror:4 row_mask:0xf bank_mask:0x4
    s_branch .Lsk_n1_2
.Lst_n1_2:
    s_branch .Lrt_n1_2
.Lsk_n1_2:
    v_mfma_f32_16x16x32_bf16 v[144:147], v[152:155], v[24:27], 0
    v_mfma_f32_16x16x32_bf16 v[136:139], v[148:151], v[28:31], v[136:139]
    v_add_f32_dpp v13, v115, v114 row_ror:12 row_mask:0xf bank_mask:0x4
    v_add_f32_dpp v12, v104, v12 row_ror:8 row_mask:0xf bank_mask:0x4
    v_add_f32_dpp v11, v97, v11 row_ror:4 row_mask:0xf bank_mask:0x4
    v_mfma_f32_16x16x32_bf16 v[144:147], v[156:159], v[28:31], v[144:147]
    v_add_f32_dpp v10, v120, v123 row_ror:12 row_mask:0xf bank_mask:0x8
    v_add_f32_dpp v13, v112, v13 row_ror:8 row_mask:0xf bank_mask:0x4
    v_add_f32_dpp v12, v105, v12 row_ror:4 row_mask:0xf bank_mask:0x4
    s_memrealtime s[8:9]
    s_waitcnt lgkmcnt(0)
    s_sub_u32 s8, s8, s30
    s_cmpk_ge_u32 s8, 1666
    s_nop 0
    s_cbranch_scc1 .ap_24
    s_waitcnt vmcnt(5)
    s_cmpk_ge_u32 s8, 1566
    s_cbranch_scc1 .ap_24
    s_waitcnt vmcnt(3)
    s_bitcmp1_b64 s[14:15], 42
    s_cbranch_scc0 1
    s_waitcnt vmcnt(2)
    s_cmpk_ge_u32 s8, 1446
    s_cbranch_scc1 .ap_24
    s_waitcnt vmcnt(1)
.ap_24:
    s_add_u32 s63, s69, 147456
    buffer_load_dwordx4 v[200:203], v1, s[44:47], s63 offen nt
    v_add_f32_dpp v11, v128, v131 row_ror:12 row_mask:0xf bank_mask:0x8
    v_add_f32_dpp v10, v121, v10 row_ror:8 row_mask:0xf bank_mask:0x8
    v_add_f32_dpp v13, v113, v13 row_ror:4 row_mask:0xf bank_mask:0x4
    v_add_f32_dpp v12, v136, v139 row_ror:12 row_mask:0xf bank_mask:0x8
    v_add_f32_dpp v11, v129, v11 row_ror:8 row_mask:0xf bank_mask:0x8
    v_add_f32_dpp v10, v122, v10 row_ror:4 row_mask:0xf bank_mask:0x8
    v_add_f32_dpp v13, v144, v147 row_ror:12 row_mask:0xf bank_mask:0x8
    v_add_f32_dpp v12, v137, v12 row_ror:8 row_mask:0xf bank_mask:0x8
    v_add_f32_dpp v11, v130, v11 row_ror:4 row_mask:0xf bank_mask:0x8
    v_add_f32_dpp v13, v145, v13 row_ror:8 row_mask:0xf bank_mask:0x8
    v_add_f32_dpp v12, v138, v12 row_ror:4 row_mask:0xf bank_mask:0x8
    s_memrealtime s[8:9]
    s_waitcnt lgkmcnt(0)
    s_sub_u32 s8, s8, s30
    s_cmpk_ge_u32 s8, 1696
    s_cbranch_scc1 .ap_25
    s_waitcnt vmcnt(5)
    s_cmpk_ge_u32 s8, 1596
    s_cbranch_scc1 .ap_25
    s_waitcnt vmcnt(3)
    s_bitcmp1_b64 s[14:15], 43
    s_cbranch_scc0 1
    s_waitcnt vmcnt(2)
    s_cmpk_ge_u32 s8, 1476
    s_cbranch_scc1 .ap_25
    s_waitcnt vmcnt(1)
.ap_25:
    s_add_u32 s63, s69, 155648
    buffer_load_dwordx4 v[204:207], v1, s[44:47], s63 offen nt
    v_add_f32_dpp v13, v146, v13 row_ror:4 row_mask:0xf bank_mask:0x8
    s_mov_b32 s60, 0x3db504f3
    s_mov_b32 s61, 0x3db504f3
    v_cvt_pk_bf16_f32 v10, v10, v11
    v_and_b32 v11, 0xffff0000, v10
    v_lshlrev_b32 v10, 16, v10
    v_cvt_pk_bf16_f32 v12, v12, v13
    v_and_b32 v13, 0xffff0000, v12
    v_lshlrev_b32 v12, 16, v12
    v_pk_mul_f32 v[10:11], v[10:11], s[60:61]
    v_pk_mul_f32 v[12:13], v[12:13], s[60:61]
    v_cvt_pk_bf16_f32 v10, v10, v11
    v_and_b32 v11, 0xffff0000, v10
    v_lshlrev_b32 v10, 16, v10
    v_cvt_pk_bf16_f32 v12, v12, v13
    v_and_b32 v13, 0xffff0000, v12
    v_lshlrev_b32 v12, 16, v12
    v_max_f32 v14, v10, v11
    v_max3_f32 v14, v14, v12, v13
    s_mov_b32 s60, 0x3fb8aa3b
    v_mov_b32 v22, s34
    v_mov_b32 v23, s34
    v_max_f32_dpp v14, v14, v14 quad_perm:[2,3,0,1] row_mask:0xf bank_mask:0xf
    s_nop 1
    v_max_f32_dpp v14, v14, v14 row_ror:4 row_mask:0xf bank_mask:0xf
    s_nop 1
    v_max_f32_dpp v14, v14, v14 row_ror:8 row_mask:0xf bank_mask:0xf
    v_mov_b32 v15, v14
    s_nop 1
    v_permlane16_swap_b32 v15, v14
    v_max_f32 v14, v15, v14
    v_mov_b32 v15, v14
    s_nop 1
    v_permlane32_swap_b32 v15, v14
    v_max_f32 v14, v15, v14
    v_mul_f32 v15, 0xbfb8aa3b, v14
    v_fma_f32 v10, v10, s60, v15
    v_fma_f32 v11, v11, s60, v15
    v_fma_f32 v12, v12, s60, v15
    v_fma_f32 v13, v13, s60, v15
    v_exp_f32 v10, v10
    v_exp_f32 v11, v11
    v_exp_f32 v12, v12
    v_exp_f32 v13, v13
    v_mov_b32 v20, v14
    v_pk_add_f32 v[16:17], v[10:11], v[12:13]
    v_add_f32 v21, v16, v17
    s_lshl_b32 s60, s68, 5
    s_lshl_b32 s61, s3, 4
    s_add_u32 s61, s61, 159104
    v_add_u32 v16, s61, v3
    v_mov_b32 v17, 159232
    v_mov_b32 v18, 1
    s_add_u32 s60, s60, s59
    v_add_f32_dpp v21, v21, v21 quad_perm:[2,3,0,1] row_mask:0xf bank_mask:0xf
    s_nop 1
    v_add_f32_dpp v21, v21, v21 row_ror:4 row_mask:0xf bank_mask:0xf
    s_nop 1
    v_add_f32_dpp v21, v21, v21 row_ror:8 row_mask:0xf bank_mask:0xf
    v_mov_b32 v15, v21
    s_nop 1
    v_permlane16_swap_b32 v15, v21
    v_add_f32 v21, v15, v21
    v_mov_b32 v15, v21
    s_nop 1
    v_permlane32_swap_b32 v15, v21
    v_add_f32 v21, v15, v21
    s_mov_b64 exec, 3
    ds_write_b64 v16, v[20:21]
    s_mov_b64 exec, 1
    ds_add_rtn_u32 v18, v17, v18
    s_mov_b64 exec, -1
    v_and_b32 v16, 0x78, v3
    v_or_b32 v16, 159104, v16
    s_waitcnt lgkmcnt(0)
    v_readfirstlane_b32 s61, v18
    s_cmp_eq_u32 s61, 7
    s_nop 3
    s_cbranch_scc0 .mlc_26
    ds_read_b64 v[18:19], v16
    s_waitcnt lgkmcnt(0)
    v_mov_b32 v20, v18
    s_nop 1
    v_max_f32_dpp v20, v20, v20 quad_perm:[2,3,0,1] row_mask:0xf bank_mask:0xf
    s_nop 1
    v_max_f32_dpp v20, v20, v20 row_ror:4 row_mask:0xf bank_mask:0xf
    s_nop 1
    v_max_f32_dpp v20, v20, v20 row_ror:8 row_mask:0xf bank_mask:0xf
    v_sub_f32 v18, v18, v20
    v_mul_f32 v18, 0x3fb8aa3b, v18
    v_exp_f32 v18, v18
    s_nop 0
    v_mul_f32 v21, v18, v19
    s_nop 1
    v_add_f32_dpp v21, v21, v21 quad_perm:[2,3,0,1] row_mask:0xf bank_mask:0xf
    s_nop 1
    v_add_f32_dpp v21, v21, v21 row_ror:4 row_mask:0xf bank_mask:0xf
    s_nop 1
    v_add_f32_dpp v21, v21, v21 row_ror:8 row_mask:0xf bank_mask:0xf
    s_mov_b64 exec, 3
    buffer_store_dwordx4 v[20:23], v2, s[36:39], s60 offen sc1
    s_mov_b64 exec, -1
.mlc_26:
    s_memrealtime s[8:9]
    s_waitcnt lgkmcnt(0)
    s_sub_u32 s8, s8, s30
    s_cmpk_ge_u32 s8, 1726
    s_cbranch_scc1 .ap_27
    s_waitcnt vmcnt(5)
    s_cmpk_ge_u32 s8, 1626
    s_cbranch_scc1 .ap_27
    s_waitcnt vmcnt(3)
    s_bitcmp1_b64 s[14:15], 44
    s_cbranch_scc0 1
    s_waitcnt vmcnt(2)
    s_cmpk_ge_u32 s8, 1506
    s_cbranch_scc1 .ap_27
    s_waitcnt vmcnt(1)
.ap_27:
    s_add_u32 s63, s69, 163840
    buffer_load_dwordx4 v[208:211], v1, s[44:47], s63 offen nt
    s_memrealtime s[8:9]
    s_waitcnt vmcnt(8)
    s_waitcnt lgkmcnt(0)
    s_sub_u32 s8, s8, s30
    s_cmpk_ge_u32 s8, 1756
    s_cbranch_scc1 .ap_28
    s_waitcnt vmcnt(5)
    s_cmpk_ge_u32 s8, 1656
    s_cbranch_scc1 .ap_28
    s_waitcnt vmcnt(3)
    s_bitcmp1_b64 s[14:15], 45
    s_cbranch_scc0 1
    s_waitcnt vmcnt(2)
    s_cmpk_ge_u32 s8, 1536
    s_cbranch_scc1 .ap_28
    s_waitcnt vmcnt(1)
.ap_28:
    s_add_u32 s63, s69, 172032
    buffer_load_dwordx4 v[212:215], v1, s[44:47], s63 offen nt
    s_memrealtime s[8:9]
    s_waitcnt vmcnt(8)
    s_branch .Lsk_n1_3
.Lst_n1_3:
    s_branch .Lrt_n1_3
.Lsk_n1_3:
    s_waitcnt lgkmcnt(0)
    s_sub_u32 s8, s8, s30
    s_cmpk_ge_u32 s8, 1788
    s_cbranch_scc1 .ap_29
    s_waitcnt vmcnt(5)
    s_cmpk_ge_u32 s8, 1688
    s_cbranch_scc1 .ap_29
    s_waitcnt vmcnt(3)
    s_bitcmp1_b64 s[14:15], 46
    s_cbranch_scc0 1
    s_waitcnt vmcnt(2)
    s_cmpk_ge_u32 s8, 1568
    s_cbranch_scc1 .ap_29
    s_waitcnt vmcnt(1)
.ap_29:
    s_add_u32 s63, s69, 180224
    buffer_load_dwordx4 v[216:219], v1, s[44:47], s63 offen nt
    s_memrealtime s[8:9]
    s_waitcnt vmcnt(8)
    s_waitcnt lgkmcnt(0)
    s_sub_u32 s8, s8, s30
    s_cmpk_ge_u32 s8, 1820
    s_cbranch_scc1 .ap_30
    s_waitcnt vmcnt(5)
    s_cmpk_ge_u32 s8, 1720
    s_cbranch_scc1 .ap_30
    s_waitcnt vmcnt(3)
    s_bitcmp1_b64 s[14:15], 47
    s_cbranch_scc0 1
    s_waitcnt vmcnt(2)
    s_cmpk_ge_u32 s8, 1600
    s_cbranch_scc1 .ap_30
    s_waitcnt vmcnt(1)
.ap_30:
    s_add_u32 s63, s69, 188416
    buffer_load_dwordx4 v[220:223], v1, s[44:47], s63 offen nt
    s_memrealtime s[8:9]
    s_waitcnt vmcnt(8)
    s_waitcnt lgkmcnt(0)
    s_sub_u32 s8, s8, s30
    s_cmpk_ge_u32 s8, 1852
    s_cbranch_scc1 .ap_31
    s_waitcnt vmcnt(5)
    s_cmpk_ge_u32 s8, 1752
    s_cbranch_scc1 .ap_31
    s_waitcnt vmcnt(3)
    s_bitcmp1_b64 s[14:15], 48
    s_cbranch_scc0 1
    s_waitcnt vmcnt(2)
    s_cmpk_ge_u32 s8, 1632
    s_cbranch_scc1 .ap_31
    s_waitcnt vmcnt(1)
.ap_31:
    s_add_u32 s63, s69, 262144
    buffer_load_dwordx4 v[224:227], v1, s[44:47], s63 offen nt
    s_memrealtime s[8:9]
    s_waitcnt vmcnt(8)
    s_waitcnt lgkmcnt(0)
    s_sub_u32 s8, s8, s30
    s_cmpk_ge_u32 s8, 1884
    s_cbranch_scc1 .ap_32
    s_waitcnt vmcnt(5)
    s_cmpk_ge_u32 s8, 1784
    s_cbranch_scc1 .ap_32
    s_waitcnt vmcnt(3)
    s_bitcmp1_b64 s[14:15], 49
    s_cbranch_scc0 1
    s_waitcnt vmcnt(2)
    s_cmpk_ge_u32 s8, 1664
    s_cbranch_scc1 .ap_32
    s_waitcnt vmcnt(1)
.ap_32:
    s_add_u32 s63, s69, 270336
    buffer_load_dwordx4 v[228:231], v1, s[44:47], s63 offen nt
    s_memrealtime s[8:9]
    s_waitcnt vmcnt(8)
    s_waitcnt lgkmcnt(0)
    s_sub_u32 s8, s8, s30
    s_cmpk_ge_u32 s8, 1916
    s_cbranch_scc1 .ap_33
    s_waitcnt vmcnt(5)
    s_cmpk_ge_u32 s8, 1816
    s_cbranch_scc1 .ap_33
    s_waitcnt vmcnt(3)
    s_bitcmp1_b64 s[14:15], 50
    s_cbranch_scc0 1
    s_waitcnt vmcnt(2)
    s_cmpk_ge_u32 s8, 1696
    s_cbranch_scc1 .ap_33
    s_waitcnt vmcnt(1)
.ap_33:
    s_add_u32 s63, s69, 278528
    buffer_load_dwordx4 v[232:235], v1, s[44:47], s63 offen nt
    s_memrealtime s[8:9]
    s_waitcnt vmcnt(8)
    s_waitcnt lgkmcnt(0)
    s_sub_u32 s8, s8, s30
    s_cmpk_ge_u32 s8, 1948
    s_cbranch_scc1 .ap_34
    s_waitcnt vmcnt(5)
    s_cmpk_ge_u32 s8, 1848
    s_cbranch_scc1 .ap_34
    s_waitcnt vmcnt(3)
    s_bitcmp1_b64 s[14:15], 51
    s_cbranch_scc0 1
    s_waitcnt vmcnt(2)
    s_cmpk_ge_u32 s8, 1728
    s_cbranch_scc1 .ap_34
    s_waitcnt vmcnt(1)
.ap_34:
    s_add_u32 s63, s69, 286720
    buffer_load_dwordx4 v[236:239], v1, s[44:47], s63 offen nt
    s_memrealtime s[8:9]
    s_waitcnt vmcnt(8)
    s_waitcnt lgkmcnt(0)
    s_sub_u32 s8, s8, s30
    s_cmpk_ge_u32 s8, 1980
    s_cbranch_scc1 .ap_35
    s_waitcnt vmcnt(5)
    s_cmpk_ge_u32 s8, 1880
    s_cbranch_scc1 .ap_35
    s_waitcnt vmcnt(3)
    s_bitcmp1_b64 s[14:15], 52
    s_cbranch_scc0 1
    s_waitcnt vmcnt(2)
    s_cmpk_ge_u32 s8, 1760
    s_cbranch_scc1 .ap_35
    s_waitcnt vmcnt(1)
.ap_35:
    s_add_u32 s63, s69, 294912
    buffer_load_dwordx4 v[240:243], v1, s[44:47], s63 offen nt
    s_memrealtime s[8:9]
    s_waitcnt vmcnt(8)
    s_waitcnt lgkmcnt(0)
    s_sub_u32 s8, s8, s30
    s_cmpk_ge_u32 s8, 2012
    s_cbranch_scc1 .ap_36
    s_waitcnt vmcnt(5)
    s_cmpk_ge_u32 s8, 1912
    s_cbranch_scc1 .ap_36
    s_waitcnt vmcnt(3)
    s_bitcmp1_b64 s[14:15], 53
    s_cbranch_scc0 1
    s_waitcnt vmcnt(2)
    s_cmpk_ge_u32 s8, 1792
    s_cbranch_scc1 .ap_36
    s_waitcnt vmcnt(1)
.ap_36:
    s_add_u32 s63, s69, 303104
    buffer_load_dwordx4 v[244:247], v1, s[44:47], s63 offen nt
    s_memrealtime s[8:9]
    s_waitcnt vmcnt(8)
    s_waitcnt lgkmcnt(0)
    s_sub_u32 s8, s8, s30
    s_cmpk_ge_u32 s8, 2044
    s_cbranch_scc1 .ap_37
    s_waitcnt vmcnt(5)
    s_cmpk_ge_u32 s8, 1944
    s_cbranch_scc1 .ap_37
    s_waitcnt vmcnt(3)
    s_bitcmp1_b64 s[14:15], 54
    s_cbranch_scc0 1
    s_waitcnt vmcnt(2)
    s_cmpk_ge_u32 s8, 1824
    s_cbranch_scc1 .ap_37
    s_waitcnt vmcnt(1)
.ap_37:
    s_add_u32 s63, s69, 311296
    buffer_load_dwordx4 v[248:251], v1, s[44:47], s63 offen nt
    s_memrealtime s[8:9]
    s_waitcnt vmcnt(8)
    s_waitcnt lgkmcnt(0)
    s_sub_u32 s8, s8, s30
    s_cmpk_ge_u32 s8, 2076
    s_cbranch_scc1 .ap_38
    s_waitcnt vmcnt(5)
    s_cmpk_ge_u32 s8, 1976
    s_cbranch_scc1 .ap_38
    s_waitcnt vmcnt(3)
    s_bitcmp1_b64 s[14:15], 55
    s_cbranch_scc0 1
    s_waitcnt vmcnt(2)
    s_cmpk_ge_u32 s8, 1856
    s_cbranch_scc1 .ap_38
    s_waitcnt vmcnt(1)
.ap_38:
    s_add_u32 s63, s69, 319488
    buffer_load_dwordx4 v[252:255], v1, s[44:47], s63 offen nt
    s_memrealtime s[8:9]
    s_waitcnt vmcnt(8)
    s_waitcnt lgkmcnt(0)
    s_sub_u32 s8, s8, s30
    s_cmpk_ge_u32 s8, 2108
    s_cbranch_scc1 .ap_39
    s_waitcnt vmcnt(5)
    s_cmpk_ge_u32 s8, 2008
    s_cbranch_scc1 .ap_39
    s_waitcnt vmcnt(3)
    s_bitcmp1_b64 s[14:15], 56
    s_cbranch_scc0 1
    s_waitcnt vmcnt(2)
    s_cmpk_ge_u32 s8, 1888
    s_cbranch_scc1 .ap_39
    s_waitcnt vmcnt(1)
.ap_39:
    s_add_u32 s63, s69, 393216
    buffer_load_dwordx4 v[36:39], v1, s[44:47], s63 offen nt
    s_memrealtime s[8:9]
    s_waitcnt vmcnt(8)
    s_waitcnt lgkmcnt(0)
    s_sub_u32 s8, s8, s30
    s_cmpk_ge_u32 s8, 2140
    s_cbranch_scc1 .ap_40
    s_waitcnt vmcnt(5)
    s_cmpk_ge_u32 s8, 2040
    s_cbranch_scc1 .ap_40
    s_waitcnt vmcnt(3)
    s_bitcmp1_b64 s[14:15], 57
    s_cbranch_scc0 1
    s_waitcnt vmcnt(2)
    s_cmpk_ge_u32 s8, 1920
    s_cbranch_scc1 .ap_40
    s_waitcnt vmcnt(1)
.ap_40:
    s_add_u32 s63, s69, 401408
    buffer_load_dwordx4 v[44:47], v1, s[44:47], s63 offen nt
    s_and_b32 s0, s0, 0xffffff80
    s_sub_u32 s0, s0, 1024
    buffer_load_dword v28, v4, s[36:39], s0 offen sc1
    buffer_load_dwordx4 v[24:27], v9, s[36:39], s59 offen offset:0 sc1
    s_memrealtime s[8:9]
    s_waitcnt vmcnt(9)
    s_waitcnt lgkmcnt(0)
    s_sub_u32 s8, s8, s30
    s_cmpk_ge_u32 s8, 2172
    s_cbranch_scc1 .ap_41
    s_waitcnt vmcnt(6)
    s_cmpk_ge_u32 s8, 2072
    s_cbranch_scc1 .ap_41
    s_waitcnt vmcnt(4)
    s_bitcmp1_b64 s[14:15], 58
    s_cbranch_scc0 1
    s_waitcnt vmcnt(3)
    s_branch .Lsk_n1_4
.Lst_n1_4:
    s_branch .Lrt_n1_4
.Lsk_n1_4:
    s_cmpk_ge_u32 s8, 1952
    s_cbranch_scc1 .ap_41
    s_waitcnt vmcnt(2)
.ap_41:
    s_add_u32 s63, s69, 409600
    buffer_load_dwordx4 v[52:55], v1, s[44:47], s63 offen nt
    s_memrealtime s[8:9]
    s_waitcnt vmcnt(9)
    s_waitcnt lgkmcnt(0)
    s_sub_u32 s8, s8, s30
    s_cmpk_ge_u32 s8, 2204
    s_cbranch_scc1 .ap_42
    s_waitcnt vmcnt(6)
    s_cmpk_ge_u32 s8, 2104
    s_cbranch_scc1 .ap_42
    s_waitcnt vmcnt(4)
    s_bitcmp1_b64 s[14:15], 59
    s_cbranch_scc0 1
    s_waitcnt vmcnt(3)
    s_cmpk_ge_u32 s8, 1984
    s_cbranch_scc1 .ap_42
    s_waitcnt vmcnt(1)
.ap_42:
    s_add_u32 s63, s69, 417792
    buffer_load_dwordx4 v[60:63], v1, s[44:47], s63 offen nt
    s_memrealtime s[8:9]
    s_waitcnt vmcnt(9)
    s_waitcnt lgkmcnt(0)
    s_sub_u32 s8, s8, s30
    s_cmpk_ge_u32 s8, 2236
    s_cbranch_scc1 .ap_43
    s_waitcnt vmcnt(6)
    s_cmpk_ge_u32 s8, 2136
    s_cbranch_scc1 .ap_43
    s_waitcnt vmcnt(4)
    s_bitcmp1_b64 s[14:15], 60
    s_cbranch_scc0 1
    s_waitcnt vmcnt(2)
    s_cmpk_ge_u32 s8, 2016
    s_cbranch_scc1 .ap_43
    s_waitcnt vmcnt(1)
.ap_43:
    s_add_u32 s63, s69, 425984
    buffer_load_dwordx4 v[68:71], v1, s[44:47], s63 offen nt
    s_memrealtime s[8:9]
    s_waitcnt vmcnt(9)
    s_waitcnt lgkmcnt(0)
    s_sub_u32 s8, s8, s30
    s_cmpk_ge_u32 s8, 2268
    s_cbranch_scc1 .ap_44
    s_waitcnt vmcnt(6)
    s_cmpk_ge_u32 s8, 2168
    s_cbranch_scc1 .ap_44
    s_waitcnt vmcnt(3)
    s_bitcmp1_b64 s[14:15], 61
    s_cbranch_scc0 1
    s_waitcnt vmcnt(2)
    s_cmpk_ge_u32 s8, 2048
    s_cbranch_scc1 .ap_44
    s_waitcnt vmcnt(1)
.ap_44:
    s_add_u32 s63, s69, 434176
    buffer_load_dwordx4 v[76:79], v1, s[44:47], s63 offen nt
    s_memrealtime s[8:9]
    s_waitcnt vmcnt(9)
    s_waitcnt lgkmcnt(0)
    s_sub_u32 s8, s8, s30
    s_cmpk_ge_u32 s8, 2300
    s_cbranch_scc1 .ap_45
    s_waitcnt vmcnt(6)
    s_cmpk_ge_u32 s8, 2200
    s_cbranch_scc1 .ap_45
    s_waitcnt vmcnt(3)
    s_bitcmp1_b64 s[14:15], 62
    s_cbranch_scc0 1
    s_waitcnt vmcnt(2)
    s_cmpk_ge_u32 s8, 2080
    s_cbranch_scc1 .ap_45
    s_waitcnt vmcnt(1)
.ap_45:
    s_add_u32 s63, s69, 442368
    buffer_load_dwordx4 v[84:87], v1, s[44:47], s63 offen nt
    s_memrealtime s[8:9]
    s_waitcnt vmcnt(9)
    s_waitcnt lgkmcnt(0)
    s_sub_u32 s8, s8, s30
    s_cmpk_ge_u32 s8, 2332
    s_cbranch_scc1 .ap_46
    s_waitcnt vmcnt(5)
    s_cmpk_ge_u32 s8, 2232
    s_cbranch_scc1 .ap_46
    s_waitcnt vmcnt(3)
    s_bitcmp1_b64 s[14:15], 63
    s_cbranch_scc0 1
    s_waitcnt vmcnt(2)
    s_cmpk_ge_u32 s8, 2112
    s_cbranch_scc1 .ap_46
    s_waitcnt vmcnt(1)
.ap_46:
    s_add_u32 s63, s69, 450560
    buffer_load_dwordx4 v[92:95], v1, s[44:47], s63 offen nt
    s_setprio 0
    s_waitcnt vmcnt(6)
    s_branch .gpc_48
.gp_47:
    buffer_load_dwordx4 v[24:27], v9, s[36:39], s59 offen offset:0 sc1
    s_waitcnt vmcnt(0)
.gpc_48:
    v_cmp_eq_u32 vcc, s34, v26
    s_cmp_eq_u64 vcc, -1
    s_nop 3
    s_cbranch_scc1 .gpd_49
    s_sub_u32 s35, s35, 1
    s_cbranch_scc1 .Lexit
    s_sleep 1
    s_branch .gp_47
.gpd_49:
    v_cmp_eq_u32 vcc, s1, v28
    s_cmp_eq_u64 vcc, -1
    s_cselect_b32 s0, 0x800000, 0
    v_mov_b32 v16, v24
    s_nop 1
    v_max_f32_dpp v16, v16, v16 row_ror:4 row_mask:0xf bank_mask:0xf
    v_sub_f32 v17, v24, v16
    v_sub_f32 v18, v14, v16
    v_mul_f32 v17, 0x3fb8aa3b, v17
    v_mul_f32 v18, 0x3fb8aa3b, v18
    v_exp_f32 v17, v17
    v_exp_f32 v18, v18
    v_mul_f32 v17, v17, v25
    s_nop 1
    v_add_f32_dpp v17, v17, v17 row_ror:4 row_mask:0xf bank_mask:0xf
    v_rcp_f32 v19, v17
    s_nop 0
    v_fma_f32 v15, -v17, v19, 1.0
    v_fma_f32 v19, v15, v19, v19
    v_mul_f32 v18, v18, v19
    v_mul_f32 v10, v10, v18
    v_mul_f32 v11, v11, v18
    v_mul_f32 v12, v12, v18
    v_mul_f32 v13, v13, v18
    v_mov_b32_dpp v112, v10 quad_perm:[2,3,0,1] row_mask:0xf bank_mask:0xf
    v_mov_b32_dpp v113, v11 quad_perm:[2,3,0,1] row_mask:0xf bank_mask:0xf
    v_mov_b32_dpp v114, v12 quad_perm:[2,3,0,1] row_mask:0xf bank_mask:0xf
    v_mov_b32_dpp v115, v13 quad_perm:[2,3,0,1] row_mask:0xf bank_mask:0xf
    v_cvt_pk_bf16_f32 v96, v10, v112
    v_cvt_pk_bf16_f32 v100, v11, v113
    v_cvt_pk_bf16_f32 v104, v12, v114
    v_cvt_pk_bf16_f32 v108, v13, v115
    v_mov_b32_dpp v97, v96 row_ror:12 row_mask:0xf bank_mask:0xf
    v_mov_b32_dpp v101, v100 row_ror:12 row_mask:0xf bank_mask:0xf
    v_mov_b32_dpp v105, v104 row_ror:12 row_mask:0xf bank_mask:0xf
    v_mov_b32_dpp v109, v108 row_ror:12 row_mask:0xf bank_mask:0xf
    v_mov_b32_dpp v98, v96 row_ror:8 row_mask:0xf bank_mask:0xf
    v_mov_b32_dpp v102, v100 row_ror:8 row_mask:0xf bank_mask:0xf
    v_mov_b32_dpp v106, v104 row_ror:8 row_mask:0xf bank_mask:0xf
    v_mov_b32_dpp v110, v108 row_ror:8 row_mask:0xf bank_mask:0xf
    v_mov_b32_dpp v99, v96 row_ror:4 row_mask:0xf bank_mask:0xf
    v_mov_b32_dpp v103, v100 row_ror:4 row_mask:0xf bank_mask:0xf
    v_mov_b32_dpp v107, v104 row_ror:4 row_mask:0xf bank_mask:0xf
    v_mov_b32_dpp v111, v108 row_ror:4 row_mask:0xf bank_mask:0xf
    s_lshl_b32 s60, s3, 10
    s_add_u32 s60, s60, 147456
    v_lshlrev_b32 v10, 5, v0
    v_add_u32 v10, s60, v10
    v_perm_b32 v112, v164, v160, s94
    v_perm_b32 v113, v172, v168, s94
    v_perm_b32 v114, v180, v176, s94
    v_perm_b32 v115, v188, v184, s94
    s_nop 1
    v_mfma_f32_16x16x32_bf16 v[128:131], v[96:99], v[112:115], 0
    v_perm_b32 v116, v164, v160, s95
    v_perm_b32 v117, v172, v168, s95
    v_perm_b32 v118, v180, v176, s95
    v_perm_b32 v119, v188, v184, s95
    s_nop 1
    v_mfma_f32_16x16x32_bf16 v[132:135], v[96:99], v[116:119], 0
    v_perm_b32 v120, v165, v161, s94
    v_perm_b32 v121, v173, v169, s94
    v_perm_b32 v122, v181, v177, s94
    v_perm_b32 v123, v189, v185, s94
    s_nop 1
    v_mfma_f32_16x16x32_bf16 v[136:139], v[96:99], v[120:123], 0
    v_perm_b32 v124, v165, v161, s95
    v_perm_b32 v125, v173, v169, s95
    v_perm_b32 v126, v181, v177, s95
    v_perm_b32 v127, v189, v185, s95
    s_nop 1
    v_mfma_f32_16x16x32_bf16 v[140:143], v[96:99], v[124:127], 0
    v_perm_b32 v112, v166, v162, s94
    v_perm_b32 v113, v174, v170, s94
    v_perm_b32 v114, v182, v178, s94
    v_perm_b32 v115, v190, v186, s94
    s_nop 1
    v_mfma_f32_16x16x32_bf16 v[144:147], v[96:99], v[112:115], 0
    v_perm_b32 v116, v166, v162, s95
    v_perm_b32 v117, v174, v170, s95
    v_perm_b32 v118, v182, v178, s95
    v_perm_b32 v119, v190, v186, s95
    s_nop 1
    v_mfma_f32_16x16x32_bf16 v[148:151], v[96:99], v[116:119], 0
    v_perm_b32 v120, v167, v163, s94
    s_branch .Lsk_n1_5
.Lst_n1_5:
    s_branch .Lrt_n1_5
.Lsk_n1_5:
    v_perm_b32 v121, v175, v171, s94
    v_perm_b32 v122, v183, v179, s94
    v_perm_b32 v123, v191, v187, s94
    s_nop 1
    v_mfma_f32_16x16x32_bf16 v[152:155], v[96:99], v[120:123], 0
    v_perm_b32 v124, v167, v163, s95
    v_perm_b32 v125, v175, v171, s95
    v_perm_b32 v126, v183, v179, s95
    v_perm_b32 v127, v191, v187, s95
    s_nop 1
    v_mfma_f32_16x16x32_bf16 v[156:159], v[96:99], v[124:127], 0
    v_perm_b32 v112, v196, v192, s94
    v_perm_b32 v113, v204, v200, s94
    v_perm_b32 v114, v212, v208, s94
    v_perm_b32 v115, v220, v216, s94
    s_nop 1
    v_mfma_f32_16x16x32_bf16 v[128:131], v[100:103], v[112:115], v[128:131]
    v_perm_b32 v116, v196, v192, s95
    v_perm_b32 v117, v204, v200, s95
    v_perm_b32 v118, v212, v208, s95
    v_perm_b32 v119, v220, v216, s95
    s_nop 1
    v_mfma_f32_16x16x32_bf16 v[132:135], v[100:103], v[116:119], v[132:135]
    v_perm_b32 v120, v197, v193, s94
    v_perm_b32 v121, v205, v201, s94
    v_perm_b32 v122, v213, v209, s94
    v_perm_b32 v123, v221, v217, s94
    s_nop 1
    v_mfma_f32_16x16x32_bf16 v[136:139], v[100:103], v[120:123], v[136:139]
    v_perm_b32 v124, v197, v193, s95
    v_perm_b32 v125, v205, v201, s95
    v_perm_b32 v126, v213, v209, s95
    v_perm_b32 v127, v221, v217, s95
    s_nop 1
    v_mfma_f32_16x16x32_bf16 v[140:143], v[100:103], v[124:127], v[140:143]
    v_perm_b32 v112, v198, v194, s94
    v_perm_b32 v113, v206, v202, s94
    v_perm_b32 v114, v214, v210, s94
    v_perm_b32 v115, v222, v218, s94
    s_nop 1
    v_mfma_f32_16x16x32_bf16 v[144:147], v[100:103], v[112:115], v[144:147]
    v_perm_b32 v116, v198, v194, s95
    v_perm_b32 v117, v206, v202, s95
    v_perm_b32 v118, v214, v210, s95
    v_perm_b32 v119, v222, v218, s95
    s_nop 1
    v_mfma_f32_16x16x32_bf16 v[148:151], v[100:103], v[116:119], v[148:151]
    v_perm_b32 v120, v199, v195, s94
    v_perm_b32 v121, v207, v203, s94
    v_perm_b32 v122, v215, v211, s94
    v_perm_b32 v123, v223, v219, s94
    s_nop 1
    v_mfma_f32_16x16x32_bf16 v[152:155], v[100:103], v[120:123], v[152:155]
    v_perm_b32 v124, v199, v195, s95
    v_perm_b32 v125, v207, v203, s95
    v_perm_b32 v126, v215, v211, s95
    v_perm_b32 v127, v223, v219, s95
    s_nop 1
    v_mfma_f32_16x16x32_bf16 v[156:159], v[100:103], v[124:127], v[156:159]
    v_perm_b32 v112, v228, v224, s94
    v_perm_b32 v113, v236, v232, s94
    v_perm_b32 v114, v244, v240, s94
    v_perm_b32 v115, v252, v248, s94
    s_nop 1
    v_mfma_f32_16x16x32_bf16 v[128:131], v[104:107], v[112:115], v[128:131]
    v_perm_b32 v116, v228, v224, s95
    v_perm_b32 v117, v236, v232, s95
    v_perm_b32 v118, v244, v240, s95
    v_perm_b32 v119, v252, v248, s95
    s_nop 1
    v_mfma_f32_16x16x32_bf16 v[132:135], v[104:107], v[116:119], v[132:135]
    v_perm_b32 v120, v229, v225, s94
    v_perm_b32 v121, v237, v233, s94
    v_perm_b32 v122, v245, v241, s94
    v_perm_b32 v123, v253, v249, s94
    s_nop 1
    v_mfma_f32_16x16x32_bf16 v[136:139], v[104:107], v[120:123], v[136:139]
    v_perm_b32 v124, v229, v225, s95
    v_perm_b32 v125, v237, v233, s95
    v_perm_b32 v126, v245, v241, s95
    v_perm_b32 v127, v253, v249, s95
    s_nop 1
    v_mfma_f32_16x16x32_bf16 v[140:143], v[104:107], v[124:127], v[140:143]
    v_perm_b32 v112, v230, v226, s94
    v_perm_b32 v113, v238, v234, s94
    v_perm_b32 v114, v246, v242, s94
    v_perm_b32 v115, v254, v250, s94
    s_nop 1
    v_mfma_f32_16x16x32_bf16 v[144:147], v[104:107], v[112:115], v[144:147]
    v_perm_b32 v116, v230, v226, s95
    v_perm_b32 v117, v238, v234, s95
    v_perm_b32 v118, v246, v242, s95
    v_perm_b32 v119, v254, v250, s95
    s_nop 1
    v_mfma_f32_16x16x32_bf16 v[148:151], v[104:107], v[116:119], v[148:151]
    v_perm_b32 v120, v231, v227, s94
    v_perm_b32 v121, v239, v235, s94
    v_perm_b32 v122, v247, v243, s94
    v_perm_b32 v123, v255, v251, s94
    s_nop 1
    v_mfma_f32_16x16x32_bf16 v[152:155], v[104:107], v[120:123], v[152:155]
    v_perm_b32 v124, v231, v227, s95
    v_perm_b32 v125, v239, v235, s95
    v_perm_b32 v126, v247, v243, s95
    v_perm_b32 v127, v255, v251, s95
    s_nop 1
    v_mfma_f32_16x16x32_bf16 v[156:159], v[104:107], v[124:127], v[156:159]
    s_waitcnt vmcnt(0)
    v_perm_b32 v112, v44, v36, s94
    v_perm_b32 v113, v60, v52, s94
    v_perm_b32 v114, v76, v68, s94
    v_perm_b32 v115, v92, v84, s94
    s_branch .Lsk_n1_6
.Lst_n1_6:
    s_branch .Lrt_n1_6
.Lsk_n1_6:
    s_nop 1
    v_mfma_f32_16x16x32_bf16 v[128:131], v[108:111], v[112:115], v[128:131]
    v_perm_b32 v116, v44, v36, s95
    v_perm_b32 v117, v60, v52, s95
    v_perm_b32 v118, v76, v68, s95
    v_perm_b32 v119, v92, v84, s95
    s_nop 1
    v_mfma_f32_16x16x32_bf16 v[132:135], v[108:111], v[116:119], v[132:135]
    v_perm_b32 v120, v45, v37, s94
    v_perm_b32 v121, v61, v53, s94
    v_perm_b32 v122, v77, v69, s94
    v_perm_b32 v123, v93, v85, s94
    s_nop 1
    v_mfma_f32_16x16x32_bf16 v[136:139], v[108:111], v[120:123], v[136:139]
    v_perm_b32 v124, v45, v37, s95
    v_perm_b32 v125, v61, v53, s95
    v_perm_b32 v126, v77, v69, s95
    v_perm_b32 v127, v93, v85, s95
    s_nop 1
    v_mfma_f32_16x16x32_bf16 v[140:143], v[108:111], v[124:127], v[140:143]
    v_perm_b32 v112, v46, v38, s94
    v_perm_b32 v113, v62, v54, s94
    v_perm_b32 v114, v78, v70, s94
    v_perm_b32 v115, v94, v86, s94
    s_nop 1
    v_mfma_f32_16x16x32_bf16 v[144:147], v[108:111], v[112:115], v[144:147]
    v_perm_b32 v116, v46, v38, s95
    v_perm_b32 v117, v62, v54, s95
    v_perm_b32 v118, v78, v70, s95
    v_perm_b32 v119, v94, v86, s95
    s_nop 1
    v_mfma_f32_16x16x32_bf16 v[148:151], v[108:111], v[116:119], v[148:151]
    v_perm_b32 v120, v47, v39, s94
    v_perm_b32 v121, v63, v55, s94
    v_perm_b32 v122, v79, v71, s94
    v_perm_b32 v123, v95, v87, s94
    s_nop 1
    v_mfma_f32_16x16x32_bf16 v[152:155], v[108:111], v[120:123], v[152:155]
    v_perm_b32 v124, v47, v39, s95
    v_perm_b32 v125, v63, v55, s95
    v_perm_b32 v126, v79, v71, s95
    v_perm_b32 v127, v95, v87, s95
    s_nop 1
    v_mfma_f32_16x16x32_bf16 v[156:159], v[108:111], v[124:127], v[156:159]
    s_mov_b64 exec, 0xffff
    ds_write2_b32 v10, v128, v129 offset0:0 offset1:128
    ds_write2_b32 v10, v132, v133 offset0:1 offset1:129
    ds_write2_b32 v10, v136, v137 offset0:2 offset1:130
    ds_write2_b32 v10, v140, v141 offset0:3 offset1:131
    ds_write2_b32 v10, v144, v145 offset0:4 offset1:132
    ds_write2_b32 v10, v148, v149 offset0:5 offset1:133
    ds_write2_b32 v10, v152, v153 offset0:6 offset1:134
    ds_write2_b32 v10, v156, v157 offset0:7 offset1:135
    s_mov_b64 exec, -1
    s_waitcnt lgkmcnt(0)
    s_barrier
    s_cmp_lg_u32 s3, 7
    s_cbranch_scc1 .opub_50
    v_add_u32 v10, 147456, v2
    ds_read_b128 v[196:199], v10 offset:0
    ds_read_b128 v[200:203], v10 offset:1024
    ds_read_b128 v[204:207], v10 offset:2048
    ds_read_b128 v[208:211], v10 offset:3072
    ds_read_b128 v[212:215], v10 offset:4096
    ds_read_b128 v[216:219], v10 offset:5120
    ds_read_b128 v[220:223], v10 offset:6144
    ds_read_b128 v[224:227], v10 offset:7168
    v_lshrrev_b32 v11, 5, v0
    v_lshlrev_b32 v11, 13, v11
    v_and_b32 v12, 31, v0
    v_lshl_add_u32 v11, v12, 4, v11
    s_lshl4_add_u32 s56, s67, s66
    s_lshl1_add_u32 s56, s56, s68
    s_lshl_b32 s56, s56, 9
    s_add_u32 s56, s56, 0xa0000
    s_mov_b32 s60, 0x07060503
    s_mov_b32 s61, 0x07060502
    s_mov_b32 s62, 0x07060501
    v_mov_b32 v15, s34
    s_waitcnt lgkmcnt(6)
    v_pk_add_f32 v[196:197], v[196:197], v[200:201]
    v_pk_add_f32 v[198:199], v[198:199], v[202:203]
    s_waitcnt lgkmcnt(5)
    v_pk_add_f32 v[196:197], v[196:197], v[204:205]
    v_pk_add_f32 v[198:199], v[198:199], v[206:207]
    s_waitcnt lgkmcnt(4)
    v_pk_add_f32 v[196:197], v[196:197], v[208:209]
    v_pk_add_f32 v[198:199], v[198:199], v[210:211]
    s_waitcnt lgkmcnt(3)
    v_pk_add_f32 v[196:197], v[196:197], v[212:213]
    v_pk_add_f32 v[198:199], v[198:199], v[214:215]
    s_waitcnt lgkmcnt(2)
    v_pk_add_f32 v[196:197], v[196:197], v[216:217]
    v_pk_add_f32 v[198:199], v[198:199], v[218:219]
    s_waitcnt lgkmcnt(1)
    v_pk_add_f32 v[196:197], v[196:197], v[220:221]
    v_pk_add_f32 v[198:199], v[198:199], v[222:223]
    s_waitcnt lgkmcnt(0)
    v_pk_add_f32 v[196:197], v[196:197], v[224:225]
    v_pk_add_f32 v[198:199], v[198:199], v[226:227]
    v_perm_b32 v12, v196, v199, s60
    v_perm_b32 v13, v197, v199, s61
    v_perm_b32 v14, v198, v199, s62
    s_add_u32 s57, s56, 0x800000
    buffer_store_dwordx4 v[12:15], v11, s[36:39], s57 offen
    buffer_store_dwordx4 v[12:15], v11, s[36:39], s56 offen sc1
.opub_50:
    s_cmp_lt_u32 s65, 8
    s_nop 0
    s_cbranch_scc1 .Lexit
    v_and_b32 v6, 31, v0
    v_lshlrev_b32 v6, 3, v6
    v_lshrrev_b32 v7, 5, v0
    v_lshl_add_u32 v6, v7, 2, v6
    s_mul_i32 s56, s3, 528
    s_add_u32 s56, s56, 131072
    v_add_u32 v6, s56, v6
    s_lshl4_add_u32 s101, s99, s3
    s_lshl_b32 s101, s101, 10
    s_add_u32 s101, s101, 0xa0000
    v_add_u32 v5, 8192, v2
    s_cmp_ge_u32 s3, 6
    s_nop 0
    s_cbranch_scc1 .La_poll
    v_lshrrev_b32 v16, 4, v0
    v_bfe_u32 v17, v0, 2, 2
    v_lshl_add_u32 v7, v16, 3, v17
    v_lshlrev_b32 v7, 7, v7
    v_and_b32 v16, 1, v16
    v_lshrrev_b32 v17, 1, v17
    v_lshl_add_u32 v16, v16, 1, v17
    s_and_b32 s56, s3, 1
    s_lshl_b32 s56, s56, 1
    v_xor_b32 v16, s56, v16
    v_and_b32 v17, 3, v0
    v_lshl_add_u32 v7, v17, 3, v7
    s_lshr_b32 s56, s3, 1
    s_lshl_b32 s56, s56, 15
    v_add_u32 v7, s56, v7
    v_xor_b32 v17, 1, v16
    v_lshl_add_u32 v8, v17, 5, v7
    v_lshl_add_u32 v7, v16, 5, v7
    ds_read_b64_tr_b16 v[32:33], v7 offset:0
    ds_read_b64_tr_b16 v[34:35], v7 offset:512
    ds_read_b64_tr_b16 v[64:65], v8 offset:0
    ds_read_b64_tr_b16 v[66:67], v8 offset:512
    ds_read_b64_tr_b16 v[36:37], v7 offset:4096
    ds_read_b64_tr_b16 v[38:39], v7 offset:4608
    ds_read_b64_tr_b16 v[68:69], v8 offset:4096
    ds_read_b64_tr_b16 v[70:71], v8 offset:4608
    ds_read_b64_tr_b16 v[40:41], v7 offset:8192
    ds_read_b64_tr_b16 v[42:43], v7 offset:8704
    ds_read_b64_tr_b16 v[72:73], v8 offset:8192
    ds_read_b64_tr_b16 v[74:75], v8 offset:8704
    ds_read_b64_tr_b16 v[44:45], v7 offset:12288
    ds_read_b64_tr_b16 v[46:47], v7 offset:12800
    ds_read_b64_tr_b16 v[76:77], v8 offset:12288
    ds_read_b64_tr_b16 v[78:79], v8 offset:12800
    ds_read_b64_tr_b16 v[48:49], v7 offset:16384
    ds_read_b64_tr_b16 v[50:51], v7 offset:16896
    ds_read_b64_tr_b16 v[80:81], v8 offset:16384
    ds_read_b64_tr_b16 v[82:83], v8 offset:16896
    s_branch .Lsk_n1_7
.Lst_n1_7:
    s_branch .Lrt_n1_7
.Lsk_n1_7:
    ds_read_b64_tr_b16 v[52:53], v7 offset:20480
    ds_read_b64_tr_b16 v[54:55], v7 offset:20992
    ds_read_b64_tr_b16 v[84:85], v8 offset:20480
    ds_read_b64_tr_b16 v[86:87], v8 offset:20992
    ds_read_b64_tr_b16 v[56:57], v7 offset:24576
    ds_read_b64_tr_b16 v[58:59], v7 offset:25088
    ds_read_b64_tr_b16 v[88:89], v8 offset:24576
    ds_read_b64_tr_b16 v[90:91], v8 offset:25088
    ds_read_b64_tr_b16 v[60:61], v7 offset:28672
    ds_read_b64_tr_b16 v[62:63], v7 offset:29184
    ds_read_b64_tr_b16 v[92:93], v8 offset:28672
    ds_read_b64_tr_b16 v[94:95], v8 offset:29184
    s_mov_b32 s56, 131072
    v_bfe_u32 v9, v0, 1, 3
    v_mul_u32_u24 v9, 528, v9
    v_and_b32 v16, 48, v0
    v_add3_u32 v9, v9, v16, s56
    v_bfe_u32 v10, v0, 1, 3
    v_mul_u32_u24 v10, 36864, v10
    v_and_b32 v16, 1, v0
    v_lshl_add_u32 v10, v16, 4, v10
    v_and_b32 v16, 48, v0
    v_lshl_add_u32 v10, v16, 1, v10
    s_mul_i32 s59, s100, 3
    s_lshr_b32 s56, s3, 1
    s_add_u32 s59, s59, s56
    s_lshl4_add_u32 s59, s59, s99
    s_and_b32 s56, s3, 1
    s_lshl1_add_u32 s59, s59, s56
    s_lshl_b32 s59, s59, 7
    s_add_u32 s59, s59, 0xe0000
    v_mov_b32 v139, s34
.La_poll:
    s_mov_b32 s60, 0x04000c0c
    s_mov_b32 s61, 0x0706000c
    s_mov_b32 s69, 0
.gp_51:
    s_add_u32 s69, s69, 1
    s_and_b32 s56, s69, 0x41
    s_cmp_lg_u32 s56, 0x41
    s_cselect_b32 s56, s0, 0
    s_add_u32 s58, s101, s56
    buffer_load_dwordx4 v[16:19], v2, s[36:39], s58 offen offset:0 sc1
    buffer_load_dwordx4 v[20:23], v5, s[36:39], s58 offen offset:0 sc1
    s_waitcnt vmcnt(0)
    v_cmp_eq_u32 vcc, s34, v19
    v_cmp_eq_u32 s[56:57], s34, v23
    s_and_b64 vcc, vcc, s[56:57]
    s_cmp_eq_u64 vcc, -1
    s_nop 2
    s_cbranch_scc1 .gpd_52
    s_sub_u32 s35, s35, 1
    s_cbranch_scc1 .Lexit
    s_branch .gp_51
.gpd_52:
    v_perm_b32 v19, v16, v17, s60
    v_perm_b32 v19, v19, v18, s61
    v_perm_b32 v23, v20, v21, s60
    v_perm_b32 v23, v23, v22, s61
    v_permlane32_swap_b32 v16, v18
    v_permlane32_swap_b32 v17, v19
    v_permlane32_swap_b32 v20, v22
    v_permlane32_swap_b32 v21, v23
    v_pk_add_f32 v[16:17], v[16:17], v[18:19]
    v_pk_add_f32 v[20:21], v[20:21], v[22:23]
    v_cvt_pk_bf16_f32 v16, v16, v17
    v_cvt_pk_bf16_f32 v20, v20, v21
    ds_write2_b32 v6, v16, v20 offset1:64
    s_mov_b32 s60, 0x07060503
    s_mov_b32 s61, 0x07060502
    s_mov_b32 s62, 0x07060501
    s_mov_b32 vcc_lo, 0xaaaaaaaa
    s_mov_b32 vcc_hi, 0xaaaaaaaa
    s_waitcnt lgkmcnt(0)
    s_barrier
    s_cmp_ge_u32 s3, 6
    s_cbranch_scc1 .Lexit
    ds_read_b128 v[96:99], v9 offset:0
    ds_read_b128 v[100:103], v9 offset:64
    ds_read_b128 v[104:107], v9 offset:128
    ds_read_b128 v[108:111], v9 offset:192
    ds_read_b128 v[112:115], v9 offset:256
    ds_read_b128 v[116:119], v9 offset:320
    ds_read_b128 v[120:123], v9 offset:384
    ds_read_b128 v[124:127], v9 offset:448
    s_waitcnt lgkmcnt(7)
    v_mfma_f32_16x16x32_bf16 v[128:131], v[32:35], v[96:99], 0
    v_mfma_f32_16x16x32_bf16 v[132:135], v[64:67], v[96:99], 0
    s_waitcnt lgkmcnt(6)
    v_mfma_f32_16x16x32_bf16 v[128:131], v[36:39], v[100:103], v[128:131]
    v_mfma_f32_16x16x32_bf16 v[132:135], v[68:71], v[100:103], v[132:135]
    s_waitcnt lgkmcnt(5)
    v_mfma_f32_16x16x32_bf16 v[128:131], v[40:43], v[104:107], v[128:131]
    v_mfma_f32_16x16x32_bf16 v[132:135], v[72:75], v[104:107], v[132:135]
    s_waitcnt lgkmcnt(4)
    v_mfma_f32_16x16x32_bf16 v[128:131], v[44:47], v[108:111], v[128:131]
    v_mfma_f32_16x16x32_bf16 v[132:135], v[76:79], v[108:111], v[132:135]
    s_waitcnt lgkmcnt(3)
    v_mfma_f32_16x16x32_bf16 v[128:131], v[48:51], v[112:115], v[128:131]
    v_mfma_f32_16x16x32_bf16 v[132:135], v[80:83], v[112:115], v[132:135]
    s_waitcnt lgkmcnt(2)
    v_mfma_f32_16x16x32_bf16 v[128:131], v[52:55], v[116:119], v[128:131]
    v_mfma_f32_16x16x32_bf16 v[132:135], v[84:87], v[116:119], v[132:135]
    s_waitcnt lgkmcnt(1)
    v_mfma_f32_16x16x32_bf16 v[128:131], v[56:59], v[120:123], v[128:131]
    v_mfma_f32_16x16x32_bf16 v[132:135], v[88:91], v[120:123], v[132:135]
    s_waitcnt lgkmcnt(0)
    v_mfma_f32_16x16x32_bf16 v[128:131], v[60:63], v[124:127], v[128:131]
    v_mfma_f32_16x16x32_bf16 v[132:135], v[92:95], v[124:127], v[132:135]
    s_nop 7
    v_cndmask_b32 v128, v128, v132, vcc
    v_cndmask_b32 v129, v129, v133, vcc
    v_cndmask_b32 v130, v130, v134, vcc
    v_cndmask_b32 v131, v131, v135, vcc
    v_perm_b32 v136, v128, v131, s60
    v_perm_b32 v137, v129, v131, s61
    v_perm_b32 v138, v130, v131, s62
    buffer_store_dwordx4 v[136:139], v10, s[36:39], s59 offen sc1
    s_nop 1
    s_branch .Lexit
.Lm:
    s_branch .Lsk_m0_0
.Lst_m0_0:
    s_branch .Lrt_m0_0
.Lsk_m0_0:
    s_cmp_lt_u32 s2, 54
    s_mov_b32 s14, 0xfdff7fdf
    s_cselect_b32 s14, 0x6b5ad6b5, s14
    s_mov_b32 s15, 0xff7fdff7
    s_cselect_b32 s15, 0x5ad6b5ad, s15
    s_add_u32 s30, s70, 0
    s_mov_b32 s31, s70
    v_bfe_u32 v16, v0, 1, 3
    v_mul_u32_u24 v16, 1312, v16
    v_lshrrev_b32 v12, 4, v0
    v_lshl_add_u32 v16, v12, 5, v16
    v_and_b32 v12, 1, v0
    v_lshl_add_u32 v16, v12, 4, v16
    v_add_u32 v16, 147456, v16
    s_mul_i32 s56, s3, 1312
    s_add_u32 s56, s56, 147456
    v_add_u32 v17, s56, v3
    v_add_u32 v18, s56, v4
    v_lshrrev_b32 v12, 4, v0
    v_bfe_u32 v13, v0, 1, 1
    v_lshl_add_u32 v12, v12, 1, v13
    v_bfe_u32 v13, v0, 2, 2
    v_lshl_add_u32 v20, v12, 3, v13
    v_lshlrev_b32 v20, 7, v20
    v_and_b32 v12, 3, v12
    v_lshrrev_b32 v13, 1, v13
    v_lshl_add_u32 v12, v12, 1, v13
    v_xor_b32 v12, s3, v12
    v_lshl_add_u32 v20, v12, 4, v20
    v_and_b32 v12, 1, v0
    v_lshl_add_u32 v20, v12, 3, v20
    v_bfe_u32 v23, v0, 1, 3
    v_mul_u32_u24 v23, 144, v23
    v_bfe_u32 v12, v0, 4, 1
    v_lshl_add_u32 v23, v12, 3, v23
    v_lshrrev_b32 v12, 5, v0
    v_lshl_add_u32 v23, v12, 2, v23
    v_and_b32 v12, 1, v0
    v_lshl_add_u32 v23, v12, 1, v23
    s_lshl_b32 s56, s3, 4
    s_add_u32 s56, s56, 157952
    v_add_u32 v23, s56, v23
    v_and_b32 v24, 15, v0
    v_lshlrev_b32 v24, 3, v24
    s_mul_i32 s56, s3, 144
    s_add_u32 s56, s56, 157952
    v_add_u32 v24, s56, v24
    v_add_u32 v21, 32768, v20
    s_lshl_b32 s100, s3, 10
    s_mov_b32 s99, s2
    s_cmp_ge_u32 s99, 18
    s_cbranch_scc1 .Lm_rel
    s_mul_i32 s58, s3, 1152
    s_mov_b32 s52, s24
    s_and_b32 s53, s25, 0xffff
    s_mov_b32 s54, 0x2400
    s_mov_b32 s55, 0x00020000
    buffer_load_dwordx2 v[246:247], v3, s[52:55], s58 offen
    buffer_load_dwordx2 v[248:249], v3, s[52:55], s58 offen offset:512
    buffer_load_dword v250, v4, s[52:55], s58 offen
    s_mov_b32 s48, s26
    s_and_b32 s49, s27, 0xffff
    s_mov_b32 s50, 0x3cc000
    s_mov_b32 s51, 0x00020000
    v_bfe_u32 v12, v0, 4, 1
    s_and_b32 s56, s3, 3
    s_lshl_b32 s56, s56, 1
    v_or_b32 v12, s56, v12
    v_and_b32 v19, 7, v0
    v_xor_b32 v12, v12, v19
    v_lshrrev_b32 v19, 3, v0
    v_mul_u32_u24 v19, 6912, v19
    v_lshl_add_u32 v19, v12, 4, v19
    s_mul_i32 s57, s3, 55296
    s_lshl_b32 s59, s99, 7
    s_add_u32 s57, s57, s59
    s_add_u32 m0, s100, 0
    s_add_u32 s56, s57, 0
    buffer_load_dwordx4 v19, s[48:51], s56 offen nt lds
    s_add_u32 m0, s100, 8192
    s_add_u32 s56, s57, 442368
    buffer_load_dwordx4 v19, s[48:51], s56 offen nt lds
    s_add_u32 m0, s100, 16384
    s_add_u32 s56, s57, 884736
    buffer_load_dwordx4 v19, s[48:51], s56 offen nt lds
    s_add_u32 m0, s100, 24576
    s_add_u32 s56, s57, 1327104
    buffer_load_dwordx4 v19, s[48:51], s56 offen nt lds
    s_add_u32 m0, s100, 32768
    s_add_u32 s56, s57, 1769472
    buffer_load_dwordx4 v19, s[48:51], s56 offen nt lds
    s_add_u32 m0, s100, 40960
    s_add_u32 s56, s57, 2211840
    buffer_load_dwordx4 v19, s[48:51], s56 offen nt lds
    s_add_u32 m0, s100, 49152
    s_add_u32 s56, s57, 2654208
    buffer_load_dwordx4 v19, s[48:51], s56 offen nt lds
    s_add_u32 m0, s100, 57344
    s_add_u32 s56, s57, 3096576
    buffer_load_dwordx4 v19, s[48:51], s56 offen nt lds
    s_add_u32 m0, s100, 65536
    s_add_u32 s56, s57, 3538944
    buffer_load_dwordx4 v19, s[48:51], s56 offen nt lds
    s_waitcnt lgkmcnt(0)
    s_add_u32 s34, s34, 1
    s_getreg_b32 s1, hwreg(HW_REG_XCC_ID)
    s_lshl_b32 s1, s1, 24
    s_add_u32 s1, s1, s34
    s_lshr_b32 s0, s2, 3
    s_lshl_b32 s63, s64, 8
    s_add_u32 s0, s0, s63
    s_lshl2_add_u32 s0, s0, 0x480000
    v_mov_b32 v30, s1
    s_cmp_eq_u32 s3, 0
    s_cselect_b64 exec, 1, 0
    buffer_store_dword v30, v2, s[36:39], s0 offen sc1
    s_mov_b64 exec, -1
    v_lshrrev_b32 v12, 4, v0
    v_mul_u32_u24 v12, 18432, v12
    v_and_b32 v13, 15, v0
    v_lshl_add_u32 v22, v13, 4, v12
    s_mul_i32 s57, s99, 57
    s_lshr_b32 s57, s57, 9
    s_mul_i32 s58, s57, 9
    s_sub_u32 s58, s99, s58
    s_mul_i32 s59, s57, 73728
    s_lshl_b32 s58, s58, 8
    s_add_u32 s59, s59, s58
    s_mul_i32 s58, s3, 2304
    s_add_u32 s59, s59, s58
    s_add_u32 s59, s59, 0x1000
    s_mov_b32 s58, 0
    s_cmp_eq_u32 s57, 1
    s_cselect_b32 s58, 1.0, s58
    s_cmp_eq_u32 s57, 4
    s_cselect_b32 s58, 1.0, s58
    s_waitcnt vmcnt(10)
    v_lshlrev_b32 v236, 16, v246
    v_and_b32 v237, 0xffff0000, v246
    v_max_f32 v236, 0xc2ae0000, v236
    v_min_f32 v242, 0x43000000, v236
    v_mul_f32 v238, 0xbfb8aa3b, v242
    v_fma_f32 v240, v242, s98, -v238
    v_fmac_f32 v240, 0xb2a57060, v242
    v_exp_f32 v238, v238
    v_mul_f32 v240, 0x3f317218, v240
    v_fmac_f32 v238, v238, v240
    v_add_f32 v238, 1.0, v238
    v_rcp_f32 v240, v238
    s_nop 0
    v_mul_f32 v242, v236, v240
    v_fma_f32 v238, -v242, v238, v236
    v_fma_f32 v236, v238, v240, v242
    v_max_f32 v237, 0xc2ae0000, v237
    v_min_f32 v243, 0x43000000, v237
    v_mul_f32 v239, 0xbfb8aa3b, v243
    v_fma_f32 v241, v243, s98, -v239
    v_fmac_f32 v241, 0xb2a57060, v243
    v_exp_f32 v239, v239
    v_mul_f32 v241, 0x3f317218, v241
    v_fmac_f32 v239, v239, v241
    v_add_f32 v239, 1.0, v239
    v_rcp_f32 v241, v239
    s_nop 0
    v_mul_f32 v243, v237, v241
    v_fma_f32 v239, -v243, v239, v237
    s_branch .Lsk_m0_1
.Lst_m0_1:
    s_branch .Lrt_m0_1
.Lsk_m0_1:
    v_fma_f32 v237, v239, v241, v243
    v_cvt_pk_bf16_f32 v246, v236, v237
    v_lshlrev_b32 v236, 16, v247
    v_and_b32 v237, 0xffff0000, v247
    v_max_f32 v236, 0xc2ae0000, v236
    v_min_f32 v242, 0x43000000, v236
    v_mul_f32 v238, 0xbfb8aa3b, v242
    v_fma_f32 v240, v242, s98, -v238
    v_fmac_f32 v240, 0xb2a57060, v242
    v_exp_f32 v238, v238
    v_mul_f32 v240, 0x3f317218, v240
    v_fmac_f32 v238, v238, v240
    v_add_f32 v238, 1.0, v238
    v_rcp_f32 v240, v238
    s_nop 0
    v_mul_f32 v242, v236, v240
    v_fma_f32 v238, -v242, v238, v236
    v_fma_f32 v236, v238, v240, v242
    v_max_f32 v237, 0xc2ae0000, v237
    v_min_f32 v243, 0x43000000, v237
    v_mul_f32 v239, 0xbfb8aa3b, v243
    v_fma_f32 v241, v243, s98, -v239
    v_fmac_f32 v241, 0xb2a57060, v243
    v_exp_f32 v239, v239
    v_mul_f32 v241, 0x3f317218, v241
    v_fmac_f32 v239, v239, v241
    v_add_f32 v239, 1.0, v239
    v_rcp_f32 v241, v239
    s_nop 0
    v_mul_f32 v243, v237, v241
    v_fma_f32 v239, -v243, v239, v237
    v_fma_f32 v237, v239, v241, v243
    v_cvt_pk_bf16_f32 v247, v236, v237
    v_lshlrev_b32 v236, 16, v248
    v_and_b32 v237, 0xffff0000, v248
    v_max_f32 v236, 0xc2ae0000, v236
    v_min_f32 v242, 0x43000000, v236
    v_mul_f32 v238, 0xbfb8aa3b, v242
    v_fma_f32 v240, v242, s98, -v238
    v_fmac_f32 v240, 0xb2a57060, v242
    v_exp_f32 v238, v238
    v_mul_f32 v240, 0x3f317218, v240
    v_fmac_f32 v238, v238, v240
    v_add_f32 v238, 1.0, v238
    v_rcp_f32 v240, v238
    s_nop 0
    v_mul_f32 v242, v236, v240
    v_fma_f32 v238, -v242, v238, v236
    v_fma_f32 v236, v238, v240, v242
    v_max_f32 v237, 0xc2ae0000, v237
    v_min_f32 v243, 0x43000000, v237
    v_mul_f32 v239, 0xbfb8aa3b, v243
    v_fma_f32 v241, v243, s98, -v239
    v_fmac_f32 v241, 0xb2a57060, v243
    v_exp_f32 v239, v239
    v_mul_f32 v241, 0x3f317218, v241
    v_fmac_f32 v239, v239, v241
    v_add_f32 v239, 1.0, v239
    v_rcp_f32 v241, v239
    s_nop 0
    v_mul_f32 v243, v237, v241
    v_fma_f32 v239, -v243, v239, v237
    v_fma_f32 v237, v239, v241, v243
    v_cvt_pk_bf16_f32 v248, v236, v237
    v_lshlrev_b32 v236, 16, v249
    v_and_b32 v237, 0xffff0000, v249
    v_max_f32 v236, 0xc2ae0000, v236
    v_min_f32 v242, 0x43000000, v236
    v_mul_f32 v238, 0xbfb8aa3b, v242
    v_fma_f32 v240, v242, s98, -v238
    v_fmac_f32 v240, 0xb2a57060, v242
    v_exp_f32 v238, v238
    v_mul_f32 v240, 0x3f317218, v240
    v_fmac_f32 v238, v238, v240
    v_add_f32 v238, 1.0, v238
    v_rcp_f32 v240, v238
    s_nop 0
    v_mul_f32 v242, v236, v240
    v_fma_f32 v238, -v242, v238, v236
    v_fma_f32 v236, v238, v240, v242
    v_max_f32 v237, 0xc2ae0000, v237
    v_min_f32 v243, 0x43000000, v237
    v_mul_f32 v239, 0xbfb8aa3b, v243
    v_fma_f32 v241, v243, s98, -v239
    v_fmac_f32 v241, 0xb2a57060, v243
    v_exp_f32 v239, v239
    v_mul_f32 v241, 0x3f317218, v241
    v_fmac_f32 v239, v239, v241
    v_add_f32 v239, 1.0, v239
    v_rcp_f32 v241, v239
    s_nop 0
    v_mul_f32 v243, v237, v241
    v_fma_f32 v239, -v243, v239, v237
    v_fma_f32 v237, v239, v241, v243
    v_cvt_pk_bf16_f32 v249, v236, v237
    v_lshlrev_b32 v236, 16, v250
    v_and_b32 v237, 0xffff0000, v250
    v_max_f32 v236, 0xc2ae0000, v236
    v_min_f32 v242, 0x43000000, v236
    v_mul_f32 v238, 0xbfb8aa3b, v242
    v_fma_f32 v240, v242, s98, -v238
    v_fmac_f32 v240, 0xb2a57060, v242
    v_exp_f32 v238, v238
    v_mul_f32 v240, 0x3f317218, v240
    v_fmac_f32 v238, v238, v240
    v_add_f32 v238, 1.0, v238
    v_rcp_f32 v240, v238
    s_nop 0
    v_mul_f32 v242, v236, v240
    v_fma_f32 v238, -v242, v238, v236
    v_fma_f32 v236, v238, v240, v242
    v_max_f32 v237, 0xc2ae0000, v237
    v_min_f32 v243, 0x43000000, v237
    v_mul_f32 v239, 0xbfb8aa3b, v243
    v_fma_f32 v241, v243, s98, -v239
    v_fmac_f32 v241, 0xb2a57060, v243
    v_exp_f32 v239, v239
    v_mul_f32 v241, 0x3f317218, v241
    v_fmac_f32 v239, v239, v241
    v_add_f32 v239, 1.0, v239
    v_rcp_f32 v241, v239
    s_nop 0
    v_mul_f32 v243, v237, v241
    v_fma_f32 v239, -v243, v239, v237
    v_fma_f32 v237, v239, v241, v243
    v_cvt_pk_bf16_f32 v250, v236, v237
    ds_write_b64 v17, v[246:247] offset:0
    ds_write_b64 v17, v[248:249] offset:512
    ds_write_b32 v18, v250 offset:0
    s_waitcnt vmcnt(1)
    s_waitcnt lgkmcnt(0)
    s_barrier
    ds_read_b64_tr_b16 v[160:161], v20 offset:0
    ds_read_b64_tr_b16 v[162:163], v20 offset:512
    ds_read_b64_tr_b16 v[164:165], v20 offset:8192
    ds_read_b64_tr_b16 v[166:167], v20 offset:8704
    ds_read_b64_tr_b16 v[168:169], v20 offset:16384
    ds_read_b64_tr_b16 v[170:171], v20 offset:16896
    ds_read_b64_tr_b16 v[172:173], v20 offset:24576
    ds_read_b64_tr_b16 v[174:175], v20 offset:25088
    ds_read_b64_tr_b16 v[176:177], v21 offset:0
    ds_read_b64_tr_b16 v[178:179], v21 offset:512
    ds_read_b64_tr_b16 v[180:181], v21 offset:8192
    ds_read_b64_tr_b16 v[182:183], v21 offset:8704
    ds_read_b64_tr_b16 v[184:185], v21 offset:16384
    ds_read_b64_tr_b16 v[186:187], v21 offset:16896
    ds_read_b64_tr_b16 v[188:189], v21 offset:24576
    ds_read_b64_tr_b16 v[190:191], v21 offset:25088
    ds_read_b64_tr_b16 v[192:193], v21 offset:32768
    ds_read_b64_tr_b16 v[194:195], v21 offset:33280
    ds_read_b128 v[196:199], v16 offset:0
    ds_read_b128 v[200:203], v16 offset:128
    ds_read_b128 v[204:207], v16 offset:256
    ds_read_b128 v[208:211], v16 offset:384
    ds_read_b128 v[212:215], v16 offset:512
    ds_read_b128 v[216:219], v16 offset:640
    ds_read_b128 v[220:223], v16 offset:768
    ds_read_b128 v[224:227], v16 offset:896
    ds_read_b128 v[228:231], v16 offset:1024
    s_waitcnt lgkmcnt(8)
    v_mfma_f32_16x16x32_bf16 v[232:235], v[160:163], v[196:199], 0
    s_waitcnt lgkmcnt(7)
    v_mfma_f32_16x16x32_bf16 v[232:235], v[164:167], v[200:203], v[232:235]
    s_waitcnt lgkmcnt(6)
    s_branch .Lsk_m0_2
.Lst_m0_2:
    s_branch .Lrt_m0_2
.Lsk_m0_2:
    v_mfma_f32_16x16x32_bf16 v[232:235], v[168:171], v[204:207], v[232:235]
    s_waitcnt lgkmcnt(5)
    v_mfma_f32_16x16x32_bf16 v[232:235], v[172:175], v[208:211], v[232:235]
    s_waitcnt lgkmcnt(4)
    v_mfma_f32_16x16x32_bf16 v[232:235], v[176:179], v[212:215], v[232:235]
    s_waitcnt lgkmcnt(3)
    v_mfma_f32_16x16x32_bf16 v[232:235], v[180:183], v[216:219], v[232:235]
    s_waitcnt lgkmcnt(2)
    v_mfma_f32_16x16x32_bf16 v[232:235], v[184:187], v[220:223], v[232:235]
    s_waitcnt lgkmcnt(1)
    v_mfma_f32_16x16x32_bf16 v[232:235], v[188:191], v[224:227], v[232:235]
    s_waitcnt lgkmcnt(0)
    v_mfma_f32_16x16x32_bf16 v[232:235], v[192:195], v[228:231], v[232:235]
    s_nop 7
    v_permlane32_swap_b32 v232, v234
    v_permlane32_swap_b32 v233, v235
    v_cndmask_b32 v233, v233, v234, s[96:97]
    v_cndmask_b32 v232, v232, v235, s[96:97]
    s_nop 1
    v_add_f32_dpp v236, v233, v232 quad_perm:[1,0,3,2] row_mask:0xf bank_mask:0xf
    s_branch .Lsk_m0_3
.Lst_m0_3:
    s_branch .Lrt_m0_3
.Lsk_m0_3:
    v_cvt_pk_bf16_f32 v236, v236, v236
    v_lshlrev_b32 v236, 16, v236
    v_add_f32 v236, s58, v236
    v_cvt_pk_bf16_f32 v236, v236, v236
    ds_write_b16 v23, v236
    v_mov_b32 v243, s34
    s_waitcnt lgkmcnt(0)
    s_barrier
    ds_read2_b32 v[244:245], v24 offset1:1
    v_mov_b32 v241, s34
    s_waitcnt lgkmcnt(0)
    v_mov_b32 v240, v244
    v_mov_b32 v242, v245
    s_bfm_b64 exec, 32, 0
    buffer_store_dwordx4 v[240:243], v22, s[36:39], s59 offen sc1
    s_mov_b64 exec, -1
    s_add_u32 s63, s69, 32768
    buffer_load_dwordx4 v[96:99], v1, s[40:43], s63 offen nt
    s_add_u32 s63, s69, 40960
    buffer_load_dwordx4 v[100:103], v1, s[40:43], s63 offen nt
    s_add_u32 s63, s69, 49152
    buffer_load_dwordx4 v[128:131], v1, s[40:43], s63 offen nt
    s_add_u32 s63, s69, 57344
    buffer_load_dwordx4 v[132:135], v1, s[40:43], s63 offen nt
    s_waitcnt vmcnt(3)
    s_add_u32 s63, s69, 131072
    buffer_load_dwordx4 v[40:43], v1, s[40:43], s63 offen nt
    s_waitcnt vmcnt(3)
    s_add_u32 s63, s69, 139264
    buffer_load_dwordx4 v[44:47], v1, s[40:43], s63 offen nt
    s_waitcnt vmcnt(3)
    s_add_u32 s63, s69, 147456
    buffer_load_dwordx4 v[72:75], v1, s[40:43], s63 offen nt
    s_waitcnt vmcnt(3)
    s_add_u32 s63, s69, 155648
    buffer_load_dwordx4 v[76:79], v1, s[40:43], s63 offen nt
    s_waitcnt vmcnt(3)
    s_add_u32 s63, s69, 163840
    buffer_load_dwordx4 v[104:107], v1, s[40:43], s63 offen nt
    s_waitcnt vmcnt(3)
    s_add_u32 s63, s69, 172032
    buffer_load_dwordx4 v[108:111], v1, s[40:43], s63 offen nt
    s_waitcnt vmcnt(3)
    s_add_u32 s63, s69, 180224
    buffer_load_dwordx4 v[136:139], v1, s[40:43], s63 offen nt
    s_waitcnt vmcnt(3)
    s_add_u32 s63, s69, 188416
    buffer_load_dwordx4 v[140:143], v1, s[40:43], s63 offen nt
    s_waitcnt vmcnt(3)
    s_add_u32 s63, s69, 262144
    buffer_load_dwordx4 v[48:51], v1, s[40:43], s63 offen nt
    s_waitcnt vmcnt(3)
    s_add_u32 s63, s69, 270336
    buffer_load_dwordx4 v[52:55], v1, s[40:43], s63 offen nt
    s_branch .Le_done
.Lm_rel:
    s_waitcnt vmcnt(4)
    s_bitcmp1_b64 s[14:15], 4
    s_cbranch_scc0 1
    s_waitcnt vmcnt(3)
    s_add_u32 s63, s69, 32768
    buffer_load_dwordx4 v[96:99], v1, s[40:43], s63 offen nt
    s_waitcnt vmcnt(4)
    s_bitcmp1_b64 s[14:15], 5
    s_cbranch_scc0 1
    s_waitcnt vmcnt(3)
    s_add_u32 s63, s69, 40960
    buffer_load_dwordx4 v[100:103], v1, s[40:43], s63 offen nt
    s_waitcnt vmcnt(4)
    s_bitcmp1_b64 s[14:15], 6
    s_cbranch_scc0 1
    s_waitcnt vmcnt(3)
    s_add_u32 s63, s69, 49152
    buffer_load_dwordx4 v[128:131], v1, s[40:43], s63 offen nt
    s_waitcnt vmcnt(4)
    s_bitcmp1_b64 s[14:15], 7
    s_cbranch_scc0 1
    s_waitcnt vmcnt(2)
    s_add_u32 s63, s69, 57344
    buffer_load_dwordx4 v[132:135], v1, s[40:43], s63 offen nt
    s_waitcnt vmcnt(3)
    s_bitcmp1_b64 s[14:15], 8
    s_cbranch_scc0 1
    s_waitcnt vmcnt(2)
    s_add_u32 s63, s69, 131072
    buffer_load_dwordx4 v[40:43], v1, s[40:43], s63 offen nt
    s_waitcnt vmcnt(3)
    s_bitcmp1_b64 s[14:15], 9
    s_cbranch_scc0 1
    s_waitcnt vmcnt(2)
    s_add_u32 s63, s69, 139264
    buffer_load_dwordx4 v[44:47], v1, s[40:43], s63 offen nt
    s_waitcnt lgkmcnt(0)
    s_add_u32 s34, s34, 1
    s_getreg_b32 s1, hwreg(HW_REG_XCC_ID)
    s_lshl_b32 s1, s1, 24
    s_add_u32 s1, s1, s34
    s_lshr_b32 s0, s2, 3
    s_lshl_b32 s63, s64, 8
    s_add_u32 s0, s0, s63
    s_lshl2_add_u32 s0, s0, 0x480000
    v_mov_b32 v30, s1
    s_cmp_eq_u32 s3, 0
    s_cselect_b64 exec, 1, 0
    buffer_store_dword v30, v2, s[36:39], s0 offen sc1
    s_mov_b64 exec, -1
    s_cmp_lt_u32 s99, 54
    s_cbranch_scc1 .Lmr_part
    s_waitcnt vmcnt(4)
    s_bitcmp1_b64 s[14:15], 10
    s_cbranch_scc0 1
    s_waitcnt vmcnt(3)
    s_add_u32 s63, s69, 147456
    buffer_load_dwordx4 v[72:75], v1, s[40:43], s63 offen nt
    s_waitcnt vmcnt(4)
    s_bitcmp1_b64 s[14:15], 11
    s_cbranch_scc0 1
    s_waitcnt vmcnt(3)
    s_add_u32 s63, s69, 155648
    buffer_load_dwordx4 v[76:79], v1, s[40:43], s63 offen nt
    s_waitcnt vmcnt(4)
    s_bitcmp1_b64 s[14:15], 12
    s_cbranch_scc0 1
    s_waitcnt vmcnt(3)
    s_add_u32 s63, s69, 163840
    buffer_load_dwordx4 v[104:107], v1, s[40:43], s63 offen nt
    s_waitcnt vmcnt(4)
    s_bitcmp1_b64 s[14:15], 13
    s_cbranch_scc0 1
    s_waitcnt vmcnt(2)
    s_add_u32 s63, s69, 172032
    buffer_load_dwordx4 v[108:111], v1, s[40:43], s63 offen nt
    s_waitcnt vmcnt(3)
    s_bitcmp1_b64 s[14:15], 14
    s_cbranch_scc0 1
    s_waitcnt vmcnt(2)
    s_add_u32 s63, s69, 180224
    buffer_load_dwordx4 v[136:139], v1, s[40:43], s63 offen nt
    s_waitcnt vmcnt(3)
    s_bitcmp1_b64 s[14:15], 15
    s_cbranch_scc0 1
    s_waitcnt vmcnt(2)
    s_add_u32 s63, s69, 188416
    buffer_load_dwordx4 v[140:143], v1, s[40:43], s63 offen nt
    s_waitcnt vmcnt(3)
    s_bitcmp1_b64 s[14:15], 16
    s_cbranch_scc0 1
    s_waitcnt vmcnt(2)
    s_add_u32 s63, s69, 262144
    buffer_load_dwordx4 v[48:51], v1, s[40:43], s63 offen nt
    s_waitcnt vmcnt(3)
    s_bitcmp1_b64 s[14:15], 17
    s_cbranch_scc0 1
    s_waitcnt vmcnt(2)
    s_add_u32 s63, s69, 270336
    buffer_load_dwordx4 v[52:55], v1, s[40:43], s63 offen nt
    s_branch .Le_done
.Lmr_part:
    s_mul_i32 s58, s3, 1152
    s_mov_b32 s52, s24
    s_and_b32 s53, s25, 0xffff
    s_mov_b32 s54, 0x2400
    s_mov_b32 s55, 0x00020000
    buffer_load_dwordx2 v[246:247], v3, s[52:55], s58 offen
    buffer_load_dwordx2 v[248:249], v3, s[52:55], s58 offen offset:512
    buffer_load_dword v250, v4, s[52:55], s58 offen
    s_mov_b32 s48, s26
    s_and_b32 s49, s27, 0xffff
    s_mov_b32 s50, 0x3cc000
    s_mov_b32 s51, 0x00020000
    v_bfe_u32 v12, v0, 4, 1
    s_and_b32 s56, s3, 3
    s_lshl_b32 s56, s56, 1
    v_or_b32 v12, s56, v12
    v_and_b32 v19, 7, v0
    v_xor_b32 v12, v12, v19
    v_lshrrev_b32 v19, 3, v0
    v_mul_u32_u24 v19, 6912, v19
    v_lshl_add_u32 v19, v12, 4, v19
    s_mul_i32 s57, s3, 55296
    s_lshl_b32 s59, s99, 7
    s_add_u32 s57, s57, s59
    s_add_u32 m0, s100, 0
    s_add_u32 s56, s57, 0
    buffer_load_dwordx4 v19, s[48:51], s56 offen nt lds
    s_add_u32 m0, s100, 8192
    s_add_u32 s56, s57, 442368
    buffer_load_dwordx4 v19, s[48:51], s56 offen nt lds
    s_add_u32 m0, s100, 16384
    s_add_u32 s56, s57, 884736
    s_branch .Lsk_m0_4
.Lst_m0_4:
    s_branch .Lrt_m0_4
.Lsk_m0_4:
    buffer_load_dwordx4 v19, s[48:51], s56 offen nt lds
    s_add_u32 m0, s100, 24576
    s_add_u32 s56, s57, 1327104
    buffer_load_dwordx4 v19, s[48:51], s56 offen nt lds
    s_add_u32 m0, s100, 32768
    s_add_u32 s56, s57, 1769472
    buffer_load_dwordx4 v19, s[48:51], s56 offen nt lds
    s_add_u32 m0, s100, 40960
    s_add_u32 s56, s57, 2211840
    buffer_load_dwordx4 v19, s[48:51], s56 offen nt lds
    s_add_u32 m0, s100, 49152
    s_add_u32 s56, s57, 2654208
    buffer_load_dwordx4 v19, s[48:51], s56 offen nt lds
    s_add_u32 m0, s100, 57344
    s_add_u32 s56, s57, 3096576
    buffer_load_dwordx4 v19, s[48:51], s56 offen nt lds
    s_add_u32 m0, s100, 65536
    s_add_u32 s56, s57, 3538944
    buffer_load_dwordx4 v19, s[48:51], s56 offen nt lds
    v_lshrrev_b32 v12, 4, v0
    v_mul_u32_u24 v12, 18432, v12
    v_and_b32 v13, 15, v0
    v_lshl_add_u32 v22, v13, 4, v12
    s_mul_i32 s57, s99, 57
    s_lshr_b32 s57, s57, 9
    s_mul_i32 s58, s57, 9
    s_sub_u32 s58, s99, s58
    s_mul_i32 s59, s57, 73728
    s_lshl_b32 s58, s58, 8
    s_add_u32 s59, s59, s58
    s_mul_i32 s58, s3, 2304
    s_add_u32 s59, s59, s58
    s_add_u32 s59, s59, 0x1000
    s_mov_b32 s58, 0
    s_cmp_eq_u32 s57, 1
    s_cselect_b32 s58, 1.0, s58
    s_cmp_eq_u32 s57, 4
    s_cselect_b32 s58, 1.0, s58
    s_waitcnt vmcnt(9)
    v_lshlrev_b32 v236, 16, v246
    v_and_b32 v237, 0xffff0000, v246
    v_max_f32 v236, 0xc2ae0000, v236
    v_min_f32 v242, 0x43000000, v236
    v_mul_f32 v238, 0xbfb8aa3b, v242
    v_fma_f32 v240, v242, s98, -v238
    v_fmac_f32 v240, 0xb2a57060, v242
    v_exp_f32 v238, v238
    v_mul_f32 v240, 0x3f317218, v240
    v_fmac_f32 v238, v238, v240
    v_add_f32 v238, 1.0, v238
    v_rcp_f32 v240, v238
    s_nop 0
    v_mul_f32 v242, v236, v240
    v_fma_f32 v238, -v242, v238, v236
    v_fma_f32 v236, v238, v240, v242
    v_max_f32 v237, 0xc2ae0000, v237
    v_min_f32 v243, 0x43000000, v237
    v_mul_f32 v239, 0xbfb8aa3b, v243
    v_fma_f32 v241, v243, s98, -v239
    v_fmac_f32 v241, 0xb2a57060, v243
    v_exp_f32 v239, v239
    v_mul_f32 v241, 0x3f317218, v241
    v_fmac_f32 v239, v239, v241
    v_add_f32 v239, 1.0, v239
    v_rcp_f32 v241, v239
    s_nop 0
    v_mul_f32 v243, v237, v241
    v_fma_f32 v239, -v243, v239, v237
    v_fma_f32 v237, v239, v241, v243
    v_cvt_pk_bf16_f32 v246, v236, v237
    v_lshlrev_b32 v236, 16, v247
    v_and_b32 v237, 0xffff0000, v247
    v_max_f32 v236, 0xc2ae0000, v236
    v_min_f32 v242, 0x43000000, v236
    v_mul_f32 v238, 0xbfb8aa3b, v242
    v_fma_f32 v240, v242, s98, -v238
    v_fmac_f32 v240, 0xb2a57060, v242
    v_exp_f32 v238, v238
    v_mul_f32 v240, 0x3f317218, v240
    v_fmac_f32 v238, v238, v240
    v_add_f32 v238, 1.0, v238
    v_rcp_f32 v240, v238
    s_nop 0
    v_mul_f32 v242, v236, v240
    v_fma_f32 v238, -v242, v238, v236
    v_fma_f32 v236, v238, v240, v242
    v_max_f32 v237, 0xc2ae0000, v237
    v_min_f32 v243, 0x43000000, v237
    v_mul_f32 v239, 0xbfb8aa3b, v243
    v_fma_f32 v241, v243, s98, -v239
    v_fmac_f32 v241, 0xb2a57060, v243
    v_exp_f32 v239, v239
    v_mul_f32 v241, 0x3f317218, v241
    v_fmac_f32 v239, v239, v241
    v_add_f32 v239, 1.0, v239
    v_rcp_f32 v241, v239
    s_nop 0
    v_mul_f32 v243, v237, v241
    v_fma_f32 v239, -v243, v239, v237
    v_fma_f32 v237, v239, v241, v243
    v_cvt_pk_bf16_f32 v247, v236, v237
    v_lshlrev_b32 v236, 16, v248
    v_and_b32 v237, 0xffff0000, v248
    v_max_f32 v236, 0xc2ae0000, v236
    v_min_f32 v242, 0x43000000, v236
    v_mul_f32 v238, 0xbfb8aa3b, v242
    v_fma_f32 v240, v242, s98, -v238
    v_fmac_f32 v240, 0xb2a57060, v242
    v_exp_f32 v238, v238
    v_mul_f32 v240, 0x3f317218, v240
    v_fmac_f32 v238, v238, v240
    v_add_f32 v238, 1.0, v238
    v_rcp_f32 v240, v238
    s_nop 0
    v_mul_f32 v242, v236, v240
    v_fma_f32 v238, -v242, v238, v236
    v_fma_f32 v236, v238, v240, v242
    v_max_f32 v237, 0xc2ae0000, v237
    v_min_f32 v243, 0x43000000, v237
    v_mul_f32 v239, 0xbfb8aa3b, v243
    v_fma_f32 v241, v243, s98, -v239
    v_fmac_f32 v241, 0xb2a57060, v243
    v_exp_f32 v239, v239
    v_mul_f32 v241, 0x3f317218, v241
    v_fmac_f32 v239, v239, v241
    v_add_f32 v239, 1.0, v239
    v_rcp_f32 v241, v239
    s_nop 0
    v_mul_f32 v243, v237, v241
    v_fma_f32 v239, -v243, v239, v237
    v_fma_f32 v237, v239, v241, v243
    v_cvt_pk_bf16_f32 v248, v236, v237
    v_lshlrev_b32 v236, 16, v249
    v_and_b32 v237, 0xffff0000, v249
    v_max_f32 v236, 0xc2ae0000, v236
    v_min_f32 v242, 0x43000000, v236
    v_mul_f32 v238, 0xbfb8aa3b, v242
    v_fma_f32 v240, v242, s98, -v238
    v_fmac_f32 v240, 0xb2a57060, v242
    v_exp_f32 v238, v238
    v_mul_f32 v240, 0x3f317218, v240
    v_fmac_f32 v238, v238, v240
    v_add_f32 v238, 1.0, v238
    v_rcp_f32 v240, v238
    s_nop 0
    v_mul_f32 v242, v236, v240
    v_fma_f32 v238, -v242, v238, v236
    v_fma_f32 v236, v238, v240, v242
    v_max_f32 v237, 0xc2ae0000, v237
    v_min_f32 v243, 0x43000000, v237
    v_mul_f32 v239, 0xbfb8aa3b, v243
    v_fma_f32 v241, v243, s98, -v239
    v_fmac_f32 v241, 0xb2a57060, v243
    v_exp_f32 v239, v239
    v_mul_f32 v241, 0x3f317218, v241
    v_fmac_f32 v239, v239, v241
    v_add_f32 v239, 1.0, v239
    v_rcp_f32 v241, v239
    s_nop 0
    v_mul_f32 v243, v237, v241
    v_fma_f32 v239, -v243, v239, v237
    v_fma_f32 v237, v239, v241, v243
    v_cvt_pk_bf16_f32 v249, v236, v237
    v_lshlrev_b32 v236, 16, v250
    v_and_b32 v237, 0xffff0000, v250
    v_max_f32 v236, 0xc2ae0000, v236
    v_min_f32 v242, 0x43000000, v236
    v_mul_f32 v238, 0xbfb8aa3b, v242
    v_fma_f32 v240, v242, s98, -v238
    s_branch .Lsk_m0_5
.Lst_m0_5:
    s_branch .Lrt_m0_5
.Lsk_m0_5:
    v_fmac_f32 v240, 0xb2a57060, v242
    v_exp_f32 v238, v238
    v_mul_f32 v240, 0x3f317218, v240
    v_fmac_f32 v238, v238, v240
    v_add_f32 v238, 1.0, v238
    v_rcp_f32 v240, v238
    s_nop 0
    v_mul_f32 v242, v236, v240
    v_fma_f32 v238, -v242, v238, v236
    v_fma_f32 v236, v238, v240, v242
    v_max_f32 v237, 0xc2ae0000, v237
    v_min_f32 v243, 0x43000000, v237
    v_mul_f32 v239, 0xbfb8aa3b, v243
    v_fma_f32 v241, v243, s98, -v239
    v_fmac_f32 v241, 0xb2a57060, v243
    v_exp_f32 v239, v239
    v_mul_f32 v241, 0x3f317218, v241
    v_fmac_f32 v239, v239, v241
    v_add_f32 v239, 1.0, v239
    v_rcp_f32 v241, v239
    s_nop 0
    v_mul_f32 v243, v237, v241
    v_fma_f32 v239, -v243, v239, v237
    v_fma_f32 v237, v239, v241, v243
    v_cvt_pk_bf16_f32 v250, v236, v237
    ds_write_b64 v17, v[246:247] offset:0
    ds_write_b64 v17, v[248:249] offset:512
    ds_write_b32 v18, v250 offset:0
    s_waitcnt vmcnt(3)
    s_add_u32 s63, s69, 147456
    buffer_load_dwordx4 v[72:75], v1, s[40:43], s63 offen nt
    s_waitcnt vmcnt(3)
    s_add_u32 s63, s69, 155648
    buffer_load_dwordx4 v[76:79], v1, s[40:43], s63 offen nt
    s_waitcnt vmcnt(3)
    s_add_u32 s63, s69, 163840
    buffer_load_dwordx4 v[104:107], v1, s[40:43], s63 offen nt
    s_waitcnt vmcnt(3)
    s_add_u32 s63, s69, 172032
    buffer_load_dwordx4 v[108:111], v1, s[40:43], s63 offen nt
    s_waitcnt vmcnt(3)
    s_add_u32 s63, s69, 180224
    buffer_load_dwordx4 v[136:139], v1, s[40:43], s63 offen nt
    s_waitcnt vmcnt(3)
    s_add_u32 s63, s69, 188416
    buffer_load_dwordx4 v[140:143], v1, s[40:43], s63 offen nt
    s_waitcnt vmcnt(3)
    s_add_u32 s63, s69, 262144
    buffer_load_dwordx4 v[48:51], v1, s[40:43], s63 offen nt
    s_waitcnt vmcnt(3)
    s_add_u32 s63, s69, 270336
    buffer_load_dwordx4 v[52:55], v1, s[40:43], s63 offen nt
    s_waitcnt lgkmcnt(0)
    s_barrier
    ds_read_b64_tr_b16 v[160:161], v20 offset:0
    ds_read_b64_tr_b16 v[162:163], v20 offset:512
    ds_read_b64_tr_b16 v[164:165], v20 offset:8192
    ds_read_b64_tr_b16 v[166:167], v20 offset:8704
    ds_read_b64_tr_b16 v[168:169], v20 offset:16384
    ds_read_b64_tr_b16 v[170:171], v20 offset:16896
    ds_read_b64_tr_b16 v[172:173], v20 offset:24576
    ds_read_b64_tr_b16 v[174:175], v20 offset:25088
    ds_read_b64_tr_b16 v[176:177], v21 offset:0
    ds_read_b64_tr_b16 v[178:179], v21 offset:512
    ds_read_b64_tr_b16 v[180:181], v21 offset:8192
    ds_read_b64_tr_b16 v[182:183], v21 offset:8704
    ds_read_b64_tr_b16 v[184:185], v21 offset:16384
    ds_read_b64_tr_b16 v[186:187], v21 offset:16896
    ds_read_b64_tr_b16 v[188:189], v21 offset:24576
    ds_read_b64_tr_b16 v[190:191], v21 offset:25088
    ds_read_b64_tr_b16 v[192:193], v21 offset:32768
    ds_read_b64_tr_b16 v[194:195], v21 offset:33280
    ds_read_b128 v[196:199], v16 offset:0
    ds_read_b128 v[200:203], v16 offset:128
    ds_read_b128 v[204:207], v16 offset:256
    ds_read_b128 v[208:211], v16 offset:384
    ds_read_b128 v[212:215], v16 offset:512
    ds_read_b128 v[216:219], v16 offset:640
    ds_read_b128 v[220:223], v16 offset:768
    ds_read_b128 v[224:227], v16 offset:896
    ds_read_b128 v[228:231], v16 offset:1024
    s_waitcnt lgkmcnt(8)
    v_mfma_f32_16x16x32_bf16 v[232:235], v[160:163], v[196:199], 0
    s_waitcnt lgkmcnt(7)
    v_mfma_f32_16x16x32_bf16 v[232:235], v[164:167], v[200:203], v[232:235]
    s_waitcnt lgkmcnt(6)
    v_mfma_f32_16x16x32_bf16 v[232:235], v[168:171], v[204:207], v[232:235]
    s_waitcnt lgkmcnt(5)
    v_mfma_f32_16x16x32_bf16 v[232:235], v[172:175], v[208:211], v[232:235]
    s_waitcnt lgkmcnt(4)
    v_mfma_f32_16x16x32_bf16 v[232:235], v[176:179], v[212:215], v[232:235]
    s_waitcnt lgkmcnt(3)
    v_mfma_f32_16x16x32_bf16 v[232:235], v[180:183], v[216:219], v[232:235]
    s_waitcnt lgkmcnt(2)
    v_mfma_f32_16x16x32_bf16 v[232:235], v[184:187], v[220:223], v[232:235]
    s_waitcnt lgkmcnt(1)
    v_mfma_f32_16x16x32_bf16 v[232:235], v[188:191], v[224:227], v[232:235]
    s_waitcnt lgkmcnt(0)
    v_mfma_f32_16x16x32_bf16 v[232:235], v[192:195], v[228:231], v[232:235]
    s_nop 7
    v_permlane32_swap_b32 v232, v234
    v_permlane32_swap_b32 v233, v235
    v_cndmask_b32 v233, v233, v234, s[96:97]
    v_cndmask_b32 v232, v232, v235, s[96:97]
    s_nop 1
    v_add_f32_dpp v236, v233, v232 quad_perm:[1,0,3,2] row_mask:0xf bank_mask:0xf
    v_cvt_pk_bf16_f32 v236, v236, v236
    v_lshlrev_b32 v236, 16, v236
    v_add_f32 v236, s58, v236
    v_cvt_pk_bf16_f32 v236, v236, v236
    ds_write_b16 v23, v236
    v_mov_b32 v243, s34
    s_waitcnt lgkmcnt(0)
    s_barrier
    ds_read2_b32 v[244:245], v24 offset1:1
    v_mov_b32 v241, s34
    s_waitcnt lgkmcnt(0)
    v_mov_b32 v240, v244
    v_mov_b32 v242, v245
    s_bfm_b64 exec, 16, 0
    buffer_store_dwordx4 v[240:243], v22, s[36:39], s59 offen sc1
    s_mov_b64 exec, -1
.Le_done:
    v_and_b32 v8, 1, v0
    v_lshlrev_b32 v8, 8, v8
    v_and_b32 v9, 0x3c, v0
    v_lshl_add_u32 v9, v9, 2, v8
    v_add_u32 v7, v9, v8
    v_and_b32 v9, 0x3c, v0
    v_lshrrev_b32 v8, 4, v8
    v_and_b32 v9, 4, v0
    v_lshl_add_u32 v9, v9, 3, v8
    s_lshl_b32 s58, s66, 14
    s_lshl_b32 s59, s67, 10
    s_add_u32 s58, s58, s59
    s_add_u32 s58, s58, 0x70000
    s_lshl4_add_u32 s59, s66, s67
    s_lshl_b32 s59, s59, 7
    s_add_u32 s59, s59, 0x430000
    s_waitcnt vmcnt(3)
    s_bitcmp1_b64 s[14:15], 18
    s_cbranch_scc0 1
    s_waitcnt vmcnt(2)
    s_add_u32 s63, s69, 278528
    buffer_load_dwordx4 v[80:83], v1, s[40:43], s63 offen nt
    v_and_b32 v157, 7, v0
    v_lshlrev_b32 v157, 2, v157
    s_mov_b32 s63, 0x4a1000
    buffer_load_dword v156, v157, s[36:39], s63 offen
    s_cmp_eq_u32 s3, 0
    s_cbranch_scc1 .Lst_m1_0
    s_cmp_eq_u32 s3, 1
    s_cbranch_scc1 .Lst_m1_1
    s_cmp_eq_u32 s3, 2
    s_cbranch_scc1 .Lst_m1_2
    s_cmp_eq_u32 s3, 3
    s_cbranch_scc1 .Lst_m1_3
    s_cmp_eq_u32 s3, 4
    s_cbranch_scc1 .Lst_m1_4
    s_cmp_eq_u32 s3, 5
    s_cbranch_scc1 .Lst_m1_5
    s_cmp_eq_u32 s3, 6
    s_cbranch_scc1 .Lst_m1_6
    s_cmp_eq_u32 s3, 7
    s_cbranch_scc1 .Lst_m1_7
.Lrt_m1_0:
.Lrt_m1_1:
.Lrt_m1_2:
.Lrt_m1_3:
.Lrt_m1_4:
.Lrt_m1_5:
.Lrt_m1_6:
.Lrt_m1_7:
    s_memrealtime s[8:9]
    s_waitcnt lgkmcnt(0)
    s_sub_u32 s8, s8, s30
    s_cmpk_ge_u32 s8, 912
    s_cbranch_scc1 .ap_53
    s_waitcnt vmcnt(5)
    s_cmpk_ge_u32 s8, 812
    s_cbranch_scc1 .ap_53
    s_waitcnt vmcnt(4)
    s_bitcmp1_b64 s[14:15], 19
    s_cbranch_scc0 1
    s_waitcnt vmcnt(3)
    s_cmpk_ge_u32 s8, 692
    s_cbranch_scc1 .ap_53
    s_waitcnt vmcnt(2)
.ap_53:
    s_add_u32 s63, s69, 286720
    buffer_load_dwordx4 v[84:87], v1, s[40:43], s63 offen nt
    s_memrealtime s[8:9]
    s_waitcnt lgkmcnt(0)
    s_sub_u32 s8, s8, s30
    s_cmpk_ge_u32 s8, 957
    s_cbranch_scc1 .ap_54
    s_waitcnt vmcnt(6)
    s_cmpk_ge_u32 s8, 857
    s_cbranch_scc1 .ap_54
    s_waitcnt vmcnt(4)
    s_bitcmp1_b64 s[14:15], 20
    s_cbranch_scc0 1
    s_waitcnt vmcnt(3)
    s_cmpk_ge_u32 s8, 737
    s_cbranch_scc1 .ap_54
    s_waitcnt vmcnt(2)
.ap_54:
    s_add_u32 s63, s69, 294912
    buffer_load_dwordx4 v[112:115], v1, s[40:43], s63 offen nt
    s_memrealtime s[8:9]
    s_waitcnt lgkmcnt(0)
    s_sub_u32 s8, s8, s30
    s_cmpk_ge_u32 s8, 1002
    s_cbranch_scc1 .ap_55
    s_waitcnt vmcnt(6)
    s_cmpk_ge_u32 s8, 902
    s_cbranch_scc1 .ap_55
    s_waitcnt vmcnt(4)
    s_bitcmp1_b64 s[14:15], 21
    s_cbranch_scc0 1
    s_waitcnt vmcnt(3)
    s_cmpk_ge_u32 s8, 782
    s_cbranch_scc1 .ap_55
    s_waitcnt vmcnt(1)
.ap_55:
    s_add_u32 s63, s69, 303104
    buffer_load_dwordx4 v[116:119], v1, s[40:43], s63 offen nt
    s_memrealtime s[8:9]
    s_waitcnt lgkmcnt(0)
    s_sub_u32 s8, s8, s30
    s_cmpk_ge_u32 s8, 1048
    s_cbranch_scc1 .ap_56
    s_waitcnt vmcnt(6)
    s_cmpk_ge_u32 s8, 948
    s_cbranch_scc1 .ap_56
    s_waitcnt vmcnt(4)
    s_bitcmp1_b64 s[14:15], 22
    s_cbranch_scc0 1
    s_waitcnt vmcnt(2)
    s_cmpk_ge_u32 s8, 828
    s_cbranch_scc1 .ap_56
    s_waitcnt vmcnt(1)
.ap_56:
    s_add_u32 s63, s69, 311296
    buffer_load_dwordx4 v[144:147], v1, s[40:43], s63 offen nt
    s_waitcnt vmcnt(4)
    s_sub_u32 s63, s70, 300
    v_subrev_u32 v156, s63, v156
    v_mov_b32 v157, 600
    v_cmp_lt_u32 s[8:9], v156, v157
    v_add_u32_dpp v156, v156, v156 quad_perm:[1,0,3,2] row_mask:0xf bank_mask:0xf
    s_nop 1
    v_add_u32_dpp v156, v156, v156 quad_perm:[2,3,0,1] row_mask:0xf bank_mask:0xf
    s_nop 1
    v_add_u32_dpp v156, v156, v156 row_ror:4 row_mask:0xf bank_mask:0xf
    s_nop 0
    v_readfirstlane_b32 s63, v156
    s_cmp_eq_u64 s[8:9], -1
    s_nop 3
    s_cbranch_scc0 .et_57
    s_lshr_b32 s63, s63, 3
    s_sub_u32 s63, s63, 300
    s_add_u32 s30, s30, s63
    s_add_u32 s31, s31, s63
.et_57:
    s_memrealtime s[8:9]
    s_waitcnt lgkmcnt(0)
    s_sub_u32 s8, s8, s30
    s_cmpk_ge_u32 s8, 1093
    s_cbranch_scc1 .ap_58
    s_waitcnt vmcnt(4)
    s_cmpk_ge_u32 s8, 993
    s_cbranch_scc1 .ap_58
    s_waitcnt vmcnt(3)
    s_bitcmp1_b64 s[14:15], 23
    s_cbranch_scc0 1
    s_waitcnt vmcnt(2)
    s_cmpk_ge_u32 s8, 873
    s_cbranch_scc1 .ap_58
    s_waitcnt vmcnt(1)
.ap_58:
    s_add_u32 s63, s69, 319488
    buffer_load_dwordx4 v[148:151], v1, s[40:43], s63 offen nt
    s_memrealtime s[8:9]
    s_waitcnt lgkmcnt(0)
    s_sub_u32 s8, s8, s30
    s_cmpk_ge_u32 s8, 1138
    s_cbranch_scc1 .ap_59
    s_waitcnt vmcnt(5)
    s_cmpk_ge_u32 s8, 1038
    s_cbranch_scc1 .ap_59
    s_waitcnt vmcnt(3)
    s_bitcmp1_b64 s[14:15], 24
    s_cbranch_scc0 1
    s_waitcnt vmcnt(2)
    s_cmpk_ge_u32 s8, 918
    s_cbranch_scc1 .ap_59
    s_waitcnt vmcnt(1)
.ap_59:
    s_add_u32 s63, s69, 393216
    buffer_load_dwordx4 v[56:59], v1, s[40:43], s63 offen nt
    s_memrealtime s[8:9]
    s_waitcnt lgkmcnt(0)
    s_sub_u32 s8, s8, s30
    s_cmpk_ge_u32 s8, 1184
    s_cbranch_scc1 .ap_60
    s_waitcnt vmcnt(5)
    s_cmpk_ge_u32 s8, 1084
    s_cbranch_scc1 .ap_60
    s_waitcnt vmcnt(3)
    s_bitcmp1_b64 s[14:15], 25
    s_cbranch_scc0 1
    s_waitcnt vmcnt(2)
    s_cmpk_ge_u32 s8, 964
    s_cbranch_scc1 .ap_60
    s_waitcnt vmcnt(1)
.ap_60:
    s_add_u32 s63, s69, 401408
    buffer_load_dwordx4 v[60:63], v1, s[40:43], s63 offen nt
    s_memrealtime s[8:9]
    s_waitcnt lgkmcnt(0)
    s_sub_u32 s8, s8, s30
    s_cmpk_ge_u32 s8, 1211
    s_cbranch_scc1 .ap_61
    s_waitcnt vmcnt(5)
    s_cmpk_ge_u32 s8, 1111
    s_cbranch_scc1 .ap_61
    s_waitcnt vmcnt(3)
    s_bitcmp1_b64 s[14:15], 26
    s_cbranch_scc0 1
    s_waitcnt vmcnt(2)
    s_cmpk_ge_u32 s8, 991
    s_cbranch_scc1 .ap_61
    s_waitcnt vmcnt(1)
.ap_61:
    s_add_u32 s63, s69, 409600
    buffer_load_dwordx4 v[88:91], v1, s[40:43], s63 offen nt
    s_memrealtime s[8:9]
    s_waitcnt lgkmcnt(0)
    s_sub_u32 s8, s8, s30
    s_cmpk_ge_u32 s8, 1238
    s_cbranch_scc1 .ap_62
    s_waitcnt vmcnt(5)
    s_cmpk_ge_u32 s8, 1138
    s_cbranch_scc1 .ap_62
    s_waitcnt vmcnt(3)
    s_bitcmp1_b64 s[14:15], 27
    s_cbranch_scc0 1
    s_waitcnt vmcnt(2)
    s_cmpk_ge_u32 s8, 1018
    s_cbranch_scc1 .ap_62
    s_waitcnt vmcnt(1)
.ap_62:
    s_add_u32 s63, s69, 417792
    buffer_load_dwordx4 v[92:95], v1, s[40:43], s63 offen nt
    s_memrealtime s[8:9]
    s_waitcnt vmcnt(8)
    s_waitcnt lgkmcnt(0)
    s_sub_u32 s8, s8, s30
    s_cmpk_ge_u32 s8, 1265
    s_cbranch_scc1 .ap_63
    s_branch .Lsk_m1_0
.Lst_m1_0:
    s_branch .Lrt_m1_0
.Lsk_m1_0:
    s_waitcnt vmcnt(5)
    s_cmpk_ge_u32 s8, 1165
    s_cbranch_scc1 .ap_63
    s_waitcnt vmcnt(3)
    s_bitcmp1_b64 s[14:15], 28
    s_cbranch_scc0 1
    s_waitcnt vmcnt(2)
    s_cmpk_ge_u32 s8, 1045
    s_cbranch_scc1 .ap_63
    s_waitcnt vmcnt(1)
.ap_63:
    s_add_u32 s63, s69, 425984
    buffer_load_dwordx4 v[120:123], v1, s[40:43], s63 offen nt
    s_branch .Lsk_m1_1
.Lst_m1_1:
    s_branch .Lrt_m1_1
.Lsk_m1_1:
    s_memrealtime s[8:9]
    s_waitcnt vmcnt(8)
    s_waitcnt lgkmcnt(0)
    s_sub_u32 s8, s8, s30
    s_cmpk_ge_u32 s8, 1292
    s_cbranch_scc1 .ap_64
    s_waitcnt vmcnt(5)
    s_cmpk_ge_u32 s8, 1192
    s_cbranch_scc1 .ap_64
    s_waitcnt vmcnt(3)
    s_bitcmp1_b64 s[14:15], 29
    s_cbranch_scc0 1
    s_waitcnt vmcnt(2)
    s_cmpk_ge_u32 s8, 1072
    s_cbranch_scc1 .ap_64
    s_waitcnt vmcnt(1)
.ap_64:
    s_add_u32 s63, s69, 434176
    buffer_load_dwordx4 v[124:127], v1, s[40:43], s63 offen nt
    s_memrealtime s[8:9]
    s_waitcnt vmcnt(8)
    s_waitcnt lgkmcnt(0)
    s_sub_u32 s8, s8, s30
    s_cmpk_ge_u32 s8, 1320
    s_cbranch_scc1 .ap_65
    s_waitcnt vmcnt(5)
    s_cmpk_ge_u32 s8, 1220
    s_cbranch_scc1 .ap_65
    s_waitcnt vmcnt(3)
    s_bitcmp1_b64 s[14:15], 30
    s_cbranch_scc0 1
    s_waitcnt vmcnt(2)
    s_cmpk_ge_u32 s8, 1100
    s_cbranch_scc1 .ap_65
    s_waitcnt vmcnt(1)
.ap_65:
    s_add_u32 s63, s69, 442368
    buffer_load_dwordx4 v[152:155], v1, s[40:43], s63 offen nt
    s_memrealtime s[8:9]
    s_waitcnt vmcnt(8)
    s_waitcnt lgkmcnt(0)
    s_sub_u32 s8, s8, s30
    s_cmpk_ge_u32 s8, 1347
    s_cbranch_scc1 .ap_66
    s_waitcnt vmcnt(5)
    s_cmpk_ge_u32 s8, 1247
    s_cbranch_scc1 .ap_66
    s_waitcnt vmcnt(3)
    s_bitcmp1_b64 s[14:15], 31
    s_cbranch_scc0 1
    s_waitcnt vmcnt(2)
    s_cmpk_ge_u32 s8, 1127
    s_cbranch_scc1 .ap_66
    s_waitcnt vmcnt(1)
.ap_66:
    s_add_u32 s63, s69, 450560
    buffer_load_dwordx4 v[156:159], v1, s[40:43], s63 offen nt
    s_memrealtime s[8:9]
    s_waitcnt vmcnt(8)
    s_waitcnt lgkmcnt(0)
    s_sub_u32 s8, s8, s30
    s_cmpk_ge_u32 s8, 1374
    s_cbranch_scc1 .ap_67
    s_waitcnt vmcnt(5)
    s_cmpk_ge_u32 s8, 1274
    s_cbranch_scc1 .ap_67
    s_waitcnt vmcnt(3)
    s_bitcmp1_b64 s[14:15], 32
    s_cbranch_scc0 1
    s_waitcnt vmcnt(2)
    s_cmpk_ge_u32 s8, 1154
    s_cbranch_scc1 .ap_67
    s_waitcnt vmcnt(1)
.ap_67:
    v_bfe_u32 v1, v0, 4, 2
    v_and_b32 v10, 0xf0, v2
    v_lshlrev_b32 v1, 2, v1
    v_bfe_u32 v1, s6, v1, 4
    v_lshl_add_u32 v1, v1, 8, v10
    s_add_u32 s63, s69, 0
    buffer_load_dwordx4 v[160:163], v1, s[44:47], s63 offen nt
    s_memrealtime s[8:9]
    s_waitcnt vmcnt(8)
    s_waitcnt lgkmcnt(0)
    s_sub_u32 s8, s8, s30
    s_cmpk_ge_u32 s8, 1401
    s_cbranch_scc1 .ap_68
    s_waitcnt vmcnt(5)
    s_cmpk_ge_u32 s8, 1301
    s_cbranch_scc1 .ap_68
    s_waitcnt vmcnt(3)
    s_bitcmp1_b64 s[14:15], 33
    s_cbranch_scc0 1
    s_waitcnt vmcnt(2)
    s_cmpk_ge_u32 s8, 1181
    s_cbranch_scc1 .ap_68
    s_waitcnt vmcnt(1)
.ap_68:
    s_add_u32 s63, s69, 8192
    buffer_load_dwordx4 v[164:167], v1, s[44:47], s63 offen nt
    s_memrealtime s[8:9]
    s_waitcnt vmcnt(8)
    s_waitcnt lgkmcnt(0)
    s_sub_u32 s8, s8, s30
    s_cmpk_ge_u32 s8, 1428
    s_cbranch_scc1 .ap_69
    s_waitcnt vmcnt(5)
    s_cmpk_ge_u32 s8, 1328
    s_cbranch_scc1 .ap_69
    s_waitcnt vmcnt(3)
    s_bitcmp1_b64 s[14:15], 34
    s_cbranch_scc0 1
    s_waitcnt vmcnt(2)
    s_cmpk_ge_u32 s8, 1208
    s_cbranch_scc1 .ap_69
    s_waitcnt vmcnt(1)
.ap_69:
    s_add_u32 s63, s69, 16384
    buffer_load_dwordx4 v[168:171], v1, s[44:47], s63 offen nt
    s_memrealtime s[8:9]
    s_waitcnt vmcnt(8)
    s_waitcnt lgkmcnt(0)
    s_sub_u32 s8, s8, s30
    s_cmpk_ge_u32 s8, 1456
    s_cbranch_scc1 .ap_70
    s_waitcnt vmcnt(5)
    s_cmpk_ge_u32 s8, 1356
    s_cbranch_scc1 .ap_70
    s_waitcnt vmcnt(3)
    s_bitcmp1_b64 s[14:15], 35
    s_cbranch_scc0 1
    s_waitcnt vmcnt(2)
    s_cmpk_ge_u32 s8, 1236
    s_cbranch_scc1 .ap_70
    s_waitcnt vmcnt(1)
.ap_70:
    s_add_u32 s63, s69, 24576
    buffer_load_dwordx4 v[172:175], v1, s[44:47], s63 offen nt
    buffer_load_dwordx4 v[16:19], v7, s[36:39], s58 offen offset:0 sc1
    buffer_load_dwordx4 v[20:23], v7, s[36:39], s58 offen offset:256 sc1
    s_memrealtime s[8:9]
    s_waitcnt vmcnt(8)
    s_waitcnt lgkmcnt(0)
    s_sub_u32 s8, s8, s30
    s_cmpk_ge_u32 s8, 1486
    s_cbranch_scc1 .ap_71
    s_waitcnt vmcnt(5)
    s_cmpk_ge_u32 s8, 1386
    s_cbranch_scc1 .ap_71
    s_waitcnt vmcnt(3)
    s_bitcmp1_b64 s[14:15], 36
    s_cbranch_scc0 1
    s_waitcnt vmcnt(2)
    s_cmpk_ge_u32 s8, 1266
    s_cbranch_scc1 .ap_71
    s_waitcnt vmcnt(1)
.ap_71:
    s_add_u32 s63, s69, 32768
    buffer_load_dwordx4 v[176:179], v1, s[44:47], s63 offen nt
    s_memrealtime s[8:9]
    s_waitcnt vmcnt(8)
    s_waitcnt lgkmcnt(0)
    s_sub_u32 s8, s8, s30
    s_cmpk_ge_u32 s8, 1516
    s_cbranch_scc1 .ap_72
    s_waitcnt vmcnt(5)
    s_cmpk_ge_u32 s8, 1416
    s_cbranch_scc1 .ap_72
    s_waitcnt vmcnt(3)
    s_bitcmp1_b64 s[14:15], 37
    s_cbranch_scc0 1
    s_waitcnt vmcnt(2)
    s_cmpk_ge_u32 s8, 1296
    s_cbranch_scc1 .ap_72
    s_waitcnt vmcnt(1)
.ap_72:
    s_add_u32 s63, s69, 40960
    buffer_load_dwordx4 v[180:183], v1, s[44:47], s63 offen nt
    s_memrealtime s[8:9]
    s_waitcnt vmcnt(8)
    s_waitcnt lgkmcnt(0)
    s_sub_u32 s8, s8, s30
    s_cmpk_ge_u32 s8, 1546
    s_cbranch_scc1 .ap_73
    s_waitcnt vmcnt(5)
    s_cmpk_ge_u32 s8, 1446
    s_cbranch_scc1 .ap_73
    s_waitcnt vmcnt(3)
    s_bitcmp1_b64 s[14:15], 38
    s_cbranch_scc0 1
    s_waitcnt vmcnt(2)
    s_cmpk_ge_u32 s8, 1326
    s_cbranch_scc1 .ap_73
    s_waitcnt vmcnt(1)
.ap_73:
    s_add_u32 s63, s69, 49152
    buffer_load_dwordx4 v[184:187], v1, s[44:47], s63 offen nt
    s_waitcnt vmcnt(3)
    s_branch .gpc_75
.gp_74:
    buffer_load_dwordx4 v[16:19], v7, s[36:39], s58 offen offset:0 sc1
    buffer_load_dwordx4 v[20:23], v7, s[36:39], s58 offen offset:256 sc1
    s_waitcnt vmcnt(0)
.gpc_75:
    v_min_u32 v10, v17, v19
    v_max_u32 v11, v17, v19
    v_min3_u32 v10, v10, v21, v23
    v_max3_u32 v11, v11, v21, v23
    v_cmp_eq_u32 vcc, s34, v10
    v_cmp_eq_u32 s[56:57], s34, v11
    s_and_b64 vcc, vcc, s[56:57]
    s_cmp_eq_u64 vcc, -1
    s_nop 2
    s_cbranch_scc1 .gpd_76
    s_sub_u32 s35, s35, 1
    s_cbranch_scc1 .Lexit
    s_sleep 1
    s_branch .gp_74
.gpd_76:
    s_mov_b32 vcc_lo, 0xcccccccc
    s_mov_b32 vcc_hi, 0xcccccccc
    v_cndmask_b32_e64 v24, v16, 0, vcc
    v_cndmask_b32_e64 v25, v18, 0, vcc
    v_cndmask_b32_e64 v26, v20, 0, vcc
    v_cndmask_b32_e64 v27, v22, 0, vcc
    v_cndmask_b32_e32 v28, 0, v16, vcc
    v_cndmask_b32_e32 v29, 0, v18, vcc
    v_cndmask_b32_e32 v30, 0, v20, vcc
    v_cndmask_b32_e32 v31, 0, v22, vcc
    v_mfma_f32_16x16x32_bf16 v[16:19], v[32:35], v[24:27], 0
    v_mfma_f32_16x16x32_bf16 v[32:35], v[40:43], v[24:27], 0
    v_mfma_f32_16x16x32_bf16 v[16:19], v[36:39], v[28:31], v[16:19]
    v_mfma_f32_16x16x32_bf16 v[40:43], v[48:51], v[24:27], 0
    s_branch .Lsk_m1_2
.Lst_m1_2:
    s_branch .Lrt_m1_2
.Lsk_m1_2:
    v_mfma_f32_16x16x32_bf16 v[32:35], v[44:47], v[28:31], v[32:35]
    v_mfma_f32_16x16x32_bf16 v[48:51], v[56:59], v[24:27], 0
    v_mfma_f32_16x16x32_bf16 v[40:43], v[52:55], v[28:31], v[40:43]
    v_mfma_f32_16x16x32_bf16 v[56:59], v[64:67], v[24:27], 0
    v_mfma_f32_16x16x32_bf16 v[48:51], v[60:63], v[28:31], v[48:51]
    s_nop 1
    v_add_f32_dpp v10, v17, v16 row_ror:12 row_mask:0xf bank_mask:0x1
    s_memrealtime s[8:9]
    s_waitcnt lgkmcnt(0)
    s_sub_u32 s8, s8, s30
    s_cmpk_ge_u32 s8, 1576
    s_nop 0
    s_cbranch_scc1 .ap_77
    s_waitcnt vmcnt(3)
    s_cmpk_ge_u32 s8, 1476
    s_cbranch_scc1 .ap_77
    s_waitcnt vmcnt(3)
    s_bitcmp1_b64 s[14:15], 39
    s_cbranch_scc0 1
    s_waitcnt vmcnt(2)
    s_cmpk_ge_u32 s8, 1356
    s_cbranch_scc1 .ap_77
    s_waitcnt vmcnt(1)
.ap_77:
    s_add_u32 s63, s69, 57344
    buffer_load_dwordx4 v[188:191], v1, s[44:47], s63 offen nt
    v_mfma_f32_16x16x32_bf16 v[64:67], v[72:75], v[24:27], 0
    v_mfma_f32_16x16x32_bf16 v[56:59], v[68:71], v[28:31], v[56:59]
    v_add_f32_dpp v11, v33, v32 row_ror:12 row_mask:0xf bank_mask:0x1
    v_add_f32_dpp v10, v18, v10 row_ror:8 row_mask:0xf bank_mask:0x1
    v_mfma_f32_16x16x32_bf16 v[72:75], v[80:83], v[24:27], 0
    v_mfma_f32_16x16x32_bf16 v[64:67], v[76:79], v[28:31], v[64:67]
    v_add_f32_dpp v12, v41, v40 row_ror:12 row_mask:0xf bank_mask:0x1
    v_add_f32_dpp v11, v34, v11 row_ror:8 row_mask:0xf bank_mask:0x1
    v_add_f32_dpp v10, v19, v10 row_ror:4 row_mask:0xf bank_mask:0x1
    v_mfma_f32_16x16x32_bf16 v[80:83], v[88:91], v[24:27], 0
    v_mfma_f32_16x16x32_bf16 v[72:75], v[84:87], v[28:31], v[72:75]
    v_add_f32_dpp v13, v49, v48 row_ror:12 row_mask:0xf bank_mask:0x1
    v_add_f32_dpp v12, v42, v12 row_ror:8 row_mask:0xf bank_mask:0x1
    v_add_f32_dpp v11, v35, v11 row_ror:4 row_mask:0xf bank_mask:0x1
    v_mfma_f32_16x16x32_bf16 v[88:91], v[96:99], v[24:27], 0
    v_mfma_f32_16x16x32_bf16 v[80:83], v[92:95], v[28:31], v[80:83]
    v_add_f32_dpp v10, v58, v57 row_ror:12 row_mask:0xf bank_mask:0x2
    v_add_f32_dpp v13, v50, v13 row_ror:8 row_mask:0xf bank_mask:0x1
    v_add_f32_dpp v12, v43, v12 row_ror:4 row_mask:0xf bank_mask:0x1
    s_memrealtime s[8:9]
    s_waitcnt lgkmcnt(0)
    s_sub_u32 s8, s8, s30
    s_cmpk_ge_u32 s8, 1606
    s_nop 0
    s_cbranch_scc1 .ap_78
    s_waitcnt vmcnt(4)
    s_cmpk_ge_u32 s8, 1506
    s_cbranch_scc1 .ap_78
    s_waitcnt vmcnt(3)
    s_bitcmp1_b64 s[14:15], 40
    s_cbranch_scc0 1
    s_waitcnt vmcnt(2)
    s_cmpk_ge_u32 s8, 1386
    s_cbranch_scc1 .ap_78
    s_waitcnt vmcnt(1)
.ap_78:
    s_add_u32 s63, s69, 131072
    buffer_load_dwordx4 v[192:195], v1, s[44:47], s63 offen nt
    v_mfma_f32_16x16x32_bf16 v[96:99], v[104:107], v[24:27], 0
    v_mfma_f32_16x16x32_bf16 v[88:91], v[100:103], v[28:31], v[88:91]
    v_add_f32_dpp v11, v66, v65 row_ror:12 row_mask:0xf bank_mask:0x2
    v_add_f32_dpp v10, v59, v10 row_ror:8 row_mask:0xf bank_mask:0x2
    v_add_f32_dpp v13, v51, v13 row_ror:4 row_mask:0xf bank_mask:0x1
    v_mfma_f32_16x16x32_bf16 v[104:107], v[112:115], v[24:27], 0
    v_mfma_f32_16x16x32_bf16 v[96:99], v[108:111], v[28:31], v[96:99]
    v_add_f32_dpp v12, v74, v73 row_ror:12 row_mask:0xf bank_mask:0x2
    v_add_f32_dpp v11, v67, v11 row_ror:8 row_mask:0xf bank_mask:0x2
    v_add_f32_dpp v10, v56, v10 row_ror:4 row_mask:0xf bank_mask:0x2
    v_mfma_f32_16x16x32_bf16 v[112:115], v[120:123], v[24:27], 0
    v_mfma_f32_16x16x32_bf16 v[104:107], v[116:119], v[28:31], v[104:107]
    v_add_f32_dpp v13, v82, v81 row_ror:12 row_mask:0xf bank_mask:0x2
    v_add_f32_dpp v12, v75, v12 row_ror:8 row_mask:0xf bank_mask:0x2
    v_add_f32_dpp v11, v64, v11 row_ror:4 row_mask:0xf bank_mask:0x2
    v_mfma_f32_16x16x32_bf16 v[120:123], v[128:131], v[24:27], 0
    v_mfma_f32_16x16x32_bf16 v[112:115], v[124:127], v[28:31], v[112:115]
    v_add_f32_dpp v10, v91, v90 row_ror:12 row_mask:0xf bank_mask:0x4
    v_add_f32_dpp v13, v83, v13 row_ror:8 row_mask:0xf bank_mask:0x2
    v_add_f32_dpp v12, v72, v12 row_ror:4 row_mask:0xf bank_mask:0x2
    s_memrealtime s[8:9]
    s_waitcnt lgkmcnt(0)
    s_sub_u32 s8, s8, s30
    s_cmpk_ge_u32 s8, 1636
    s_nop 0
    s_cbranch_scc1 .ap_79
    s_waitcnt vmcnt(5)
    s_cmpk_ge_u32 s8, 1536
    s_cbranch_scc1 .ap_79
    s_waitcnt vmcnt(3)
    s_bitcmp1_b64 s[14:15], 41
    s_cbranch_scc0 1
    s_waitcnt vmcnt(2)
    s_cmpk_ge_u32 s8, 1416
    s_cbranch_scc1 .ap_79
    s_waitcnt vmcnt(1)
.ap_79:
    s_add_u32 s63, s69, 139264
    buffer_load_dwordx4 v[196:199], v1, s[44:47], s63 offen nt
    v_mfma_f32_16x16x32_bf16 v[128:131], v[136:139], v[24:27], 0
    v_mfma_f32_16x16x32_bf16 v[120:123], v[132:135], v[28:31], v[120:123]
    v_add_f32_dpp v11, v99, v98 row_ror:12 row_mask:0xf bank_mask:0x4
    v_add_f32_dpp v10, v88, v10 row_ror:8 row_mask:0xf bank_mask:0x4
    v_add_f32_dpp v13, v80, v13 row_ror:4 row_mask:0xf bank_mask:0x2
    v_mfma_f32_16x16x32_bf16 v[136:139], v[144:147], v[24:27], 0
    v_mfma_f32_16x16x32_bf16 v[128:131], v[140:143], v[28:31], v[128:131]
    v_add_f32_dpp v12, v107, v106 row_ror:12 row_mask:0xf bank_mask:0x4
    v_add_f32_dpp v11, v96, v11 row_ror:8 row_mask:0xf bank_mask:0x4
    v_add_f32_dpp v10, v89, v10 row_ror:4 row_mask:0xf bank_mask:0x4
    v_mfma_f32_16x16x32_bf16 v[144:147], v[152:155], v[24:27], 0
    v_mfma_f32_16x16x32_bf16 v[136:139], v[148:151], v[28:31], v[136:139]
    v_add_f32_dpp v13, v115, v114 row_ror:12 row_mask:0xf bank_mask:0x4
    v_add_f32_dpp v12, v104, v12 row_ror:8 row_mask:0xf bank_mask:0x4
    v_add_f32_dpp v11, v97, v11 row_ror:4 row_mask:0xf bank_mask:0x4
    v_mfma_f32_16x16x32_bf16 v[144:147], v[156:159], v[28:31], v[144:147]
    v_add_f32_dpp v10, v120, v123 row_ror:12 row_mask:0xf bank_mask:0x8
    v_add_f32_dpp v13, v112, v13 row_ror:8 row_mask:0xf bank_mask:0x4
    v_add_f32_dpp v12, v105, v12 row_ror:4 row_mask:0xf bank_mask:0x4
    s_memrealtime s[8:9]
    s_waitcnt lgkmcnt(0)
    s_sub_u32 s8, s8, s30
    s_cmpk_ge_u32 s8, 1666
    s_nop 0
    s_cbranch_scc1 .ap_80
    s_waitcnt vmcnt(5)
    s_cmpk_ge_u32 s8, 1566
    s_cbranch_scc1 .ap_80
    s_waitcnt vmcnt(3)
    s_bitcmp1_b64 s[14:15], 42
    s_cbranch_scc0 1
    s_waitcnt vmcnt(2)
    s_cmpk_ge_u32 s8, 1446
    s_cbranch_scc1 .ap_80
    s_waitcnt vmcnt(1)
.ap_80:
    s_add_u32 s63, s69, 147456
    buffer_load_dwordx4 v[200:203], v1, s[44:47], s63 offen nt
    v_add_f32_dpp v11, v128, v131 row_ror:12 row_mask:0xf bank_mask:0x8
    v_add_f32_dpp v10, v121, v10 row_ror:8 row_mask:0xf bank_mask:0x8
    v_add_f32_dpp v13, v113, v13 row_ror:4 row_mask:0xf bank_mask:0x4
    v_add_f32_dpp v12, v136, v139 row_ror:12 row_mask:0xf bank_mask:0x8
    v_add_f32_dpp v11, v129, v11 row_ror:8 row_mask:0xf bank_mask:0x8
    v_add_f32_dpp v10, v122, v10 row_ror:4 row_mask:0xf bank_mask:0x8
    v_add_f32_dpp v13, v144, v147 row_ror:12 row_mask:0xf bank_mask:0x8
    v_add_f32_dpp v12, v137, v12 row_ror:8 row_mask:0xf bank_mask:0x8
    v_add_f32_dpp v11, v130, v11 row_ror:4 row_mask:0xf bank_mask:0x8
    v_add_f32_dpp v13, v145, v13 row_ror:8 row_mask:0xf bank_mask:0x8
    v_add_f32_dpp v12, v138, v12 row_ror:4 row_mask:0xf bank_mask:0x8
    s_memrealtime s[8:9]
    s_waitcnt lgkmcnt(0)
    s_sub_u32 s8, s8, s30
    s_cmpk_ge_u32 s8, 1696
    s_cbranch_scc1 .ap_81
    s_waitcnt vmcnt(5)
    s_cmpk_ge_u32 s8, 1596
    s_cbranch_scc1 .ap_81
    s_waitcnt vmcnt(3)
    s_bitcmp1_b64 s[14:15], 43
    s_cbranch_scc0 1
    s_waitcnt vmcnt(2)
    s_cmpk_ge_u32 s8, 1476
    s_cbranch_scc1 .ap_81
    s_waitcnt vmcnt(1)
.ap_81:
    s_add_u32 s63, s69, 155648
    buffer_load_dwordx4 v[204:207], v1, s[44:47], s63 offen nt
    v_add_f32_dpp v13, v146, v13 row_ror:4 row_mask:0xf bank_mask:0x8
    s_mov_b32 s60, 0x3db504f3
    s_mov_b32 s61, 0x3db504f3
    v_cvt_pk_bf16_f32 v10, v10, v11
    v_and_b32 v11, 0xffff0000, v10
    v_lshlrev_b32 v10, 16, v10
    v_cvt_pk_bf16_f32 v12, v12, v13
    v_and_b32 v13, 0xffff0000, v12
    s_branch .Lsk_m1_3
.Lst_m1_3:
    s_branch .Lrt_m1_3
.Lsk_m1_3:
    v_lshlrev_b32 v12, 16, v12
    v_pk_mul_f32 v[10:11], v[10:11], s[60:61]
    v_pk_mul_f32 v[12:13], v[12:13], s[60:61]
    v_cvt_pk_bf16_f32 v10, v10, v11
    v_and_b32 v11, 0xffff0000, v10
    v_lshlrev_b32 v10, 16, v10
    v_cvt_pk_bf16_f32 v12, v12, v13
    v_and_b32 v13, 0xffff0000, v12
    v_lshlrev_b32 v12, 16, v12
    v_max_f32 v14, v10, v11
    v_max3_f32 v14, v14, v12, v13
    s_mov_b32 s60, 0x3fb8aa3b
    v_mov_b32 v22, s34
    v_mov_b32 v23, s34
    v_max_f32_dpp v14, v14, v14 quad_perm:[2,3,0,1] row_mask:0xf bank_mask:0xf
    s_nop 1
    v_max_f32_dpp v14, v14, v14 row_ror:4 row_mask:0xf bank_mask:0xf
    s_nop 1
    v_max_f32_dpp v14, v14, v14 row_ror:8 row_mask:0xf bank_mask:0xf
    v_mov_b32 v15, v14
    s_nop 1
    v_permlane16_swap_b32 v15, v14
    v_max_f32 v14, v15, v14
    v_mov_b32 v15, v14
    s_nop 1
    v_permlane32_swap_b32 v15, v14
    v_max_f32 v14, v15, v14
    v_mul_f32 v15, 0xbfb8aa3b, v14
    v_fma_f32 v10, v10, s60, v15
    v_fma_f32 v11, v11, s60, v15
    v_fma_f32 v12, v12, s60, v15
    v_fma_f32 v13, v13, s60, v15
    v_exp_f32 v10, v10
    v_exp_f32 v11, v11
    v_exp_f32 v12, v12
    v_exp_f32 v13, v13
    v_mov_b32 v20, v14
    v_pk_add_f32 v[16:17], v[10:11], v[12:13]
    v_add_f32 v21, v16, v17
    s_lshl_b32 s60, s68, 5
    s_lshl_b32 s61, s3, 4
    s_add_u32 s61, s61, 159104
    v_add_u32 v16, s61, v3
    v_mov_b32 v17, 159232
    v_mov_b32 v18, 1
    s_add_u32 s60, s60, s59
    v_add_f32_dpp v21, v21, v21 quad_perm:[2,3,0,1] row_mask:0xf bank_mask:0xf
    s_nop 1
    v_add_f32_dpp v21, v21, v21 row_ror:4 row_mask:0xf bank_mask:0xf
    s_nop 1
    v_add_f32_dpp v21, v21, v21 row_ror:8 row_mask:0xf bank_mask:0xf
    v_mov_b32 v15, v21
    s_nop 1
    v_permlane16_swap_b32 v15, v21
    v_add_f32 v21, v15, v21
    v_mov_b32 v15, v21
    s_nop 1
    v_permlane32_swap_b32 v15, v21
    v_add_f32 v21, v15, v21
    s_mov_b64 exec, 3
    ds_write_b64 v16, v[20:21]
    s_mov_b64 exec, 1
    ds_add_rtn_u32 v18, v17, v18
    s_mov_b64 exec, -1
    v_and_b32 v16, 0x78, v3
    v_or_b32 v16, 159104, v16
    s_waitcnt lgkmcnt(0)
    v_readfirstlane_b32 s61, v18
    s_cmp_eq_u32 s61, 7
    s_nop 3
    s_cbranch_scc0 .mlc_82
    ds_read_b64 v[18:19], v16
    s_waitcnt lgkmcnt(0)
    v_mov_b32 v20, v18
    s_nop 1
    v_max_f32_dpp v20, v20, v20 quad_perm:[2,3,0,1] row_mask:0xf bank_mask:0xf
    s_nop 1
    v_max_f32_dpp v20, v20, v20 row_ror:4 row_mask:0xf bank_mask:0xf
    s_nop 1
    v_max_f32_dpp v20, v20, v20 row_ror:8 row_mask:0xf bank_mask:0xf
    v_sub_f32 v18, v18, v20
    v_mul_f32 v18, 0x3fb8aa3b, v18
    v_exp_f32 v18, v18
    s_nop 0
    v_mul_f32 v21, v18, v19
    s_nop 1
    v_add_f32_dpp v21, v21, v21 quad_perm:[2,3,0,1] row_mask:0xf bank_mask:0xf
    s_nop 1
    v_add_f32_dpp v21, v21, v21 row_ror:4 row_mask:0xf bank_mask:0xf
    s_nop 1
    v_add_f32_dpp v21, v21, v21 row_ror:8 row_mask:0xf bank_mask:0xf
    s_mov_b64 exec, 3
    buffer_store_dwordx4 v[20:23], v2, s[36:39], s60 offen sc1
    s_mov_b64 exec, -1
.mlc_82:
    s_memrealtime s[8:9]
    s_waitcnt lgkmcnt(0)
    s_sub_u32 s8, s8, s30
    s_cmpk_ge_u32 s8, 1726
    s_cbranch_scc1 .ap_83
    s_waitcnt vmcnt(5)
    s_cmpk_ge_u32 s8, 1626
    s_cbranch_scc1 .ap_83
    s_waitcnt vmcnt(3)
    s_bitcmp1_b64 s[14:15], 44
    s_cbranch_scc0 1
    s_waitcnt vmcnt(2)
    s_cmpk_ge_u32 s8, 1506
    s_cbranch_scc1 .ap_83
    s_waitcnt vmcnt(1)
.ap_83:
    s_add_u32 s63, s69, 163840
    buffer_load_dwordx4 v[208:211], v1, s[44:47], s63 offen nt
    s_cmp_eq_u32 s3, 0
    s_cbranch_scc1 .Lst_m2_0
    s_cmp_eq_u32 s3, 1
    s_cbranch_scc1 .Lst_m2_1
    s_cmp_eq_u32 s3, 2
    s_cbranch_scc1 .Lst_m2_2
    s_cmp_eq_u32 s3, 3
    s_cbranch_scc1 .Lrt_m2_3
.Lrt_m2_0:
.Lrt_m2_1:
.Lrt_m2_2:
.Lrt_m2_3:
    v_and_b32 v16, 8, v0
    v_and_b32 v17, 1, v0
    v_lshl_add_u32 v16, v17, 2, v16
    v_bfe_u32 v17, v0, 1, 2
    v_add_u32 v16, v16, v17
    v_lshrrev_b32 v17, 4, v0
    v_lshl_add_u32 v16, v16, 2, v17
    v_lshlrev_b32 v7, 1, v16
    v_and_b32 v8, 62, v16
    v_lshlrev_b32 v8, 2, v8
    s_mul_i32 s100, s3, 1152
    s_lshl_b32 s56, s65, 7
    s_add_u32 s100, s100, s56
    s_mov_b32 s52, s4
    s_and_b32 s53, s5, 0xffff
    s_mov_b32 s54, 0x2400
    s_mov_b32 s55, 0x00020000
    buffer_load_ushort v40, v7, s[52:55], s100 offen
    s_lshr_b32 s56, s64, 1
    s_and_b32 s57, s3, 3
    s_cmp_lg_u32 s56, s57
    s_cselect_b64 exec, 0, -1
    s_mov_b32 s48, s16
    s_and_b32 s49, s17, 0xffff
    s_mov_b32 s50, 0x480
    s_mov_b32 s51, 0x00020000
    buffer_load_dwordx2 v[48:49], v3, s[48:51], 0 offen
    buffer_load_dwordx2 v[50:51], v3, s[48:51], 0 offen offset:512
    buffer_load_dword v34, v4, s[48:51], 0 offen
    s_mov_b32 s48, s28
    s_and_b32 s49, s29, 0xffff
    s_mov_b32 s50, 0x2400
    s_mov_b32 s51, 0x00020000
    buffer_load_ushort v39, v7, s[48:51], s100 offen nt
    s_mov_b64 exec, -1
    s_memrealtime s[8:9]
    s_waitcnt vmcnt(13)
    s_waitcnt lgkmcnt(0)
    s_sub_u32 s8, s8, s30
    s_cmpk_ge_u32 s8, 1756
    s_cbranch_scc1 .ap_84
    s_waitcnt vmcnt(10)
    s_cmpk_ge_u32 s8, 1656
    s_cbranch_scc1 .ap_84
    s_waitcnt vmcnt(8)
    s_bitcmp1_b64 s[14:15], 45
    s_cbranch_scc0 1
    s_waitcnt vmcnt(7)
    s_cmpk_ge_u32 s8, 1536
    s_cbranch_scc1 .ap_84
    s_waitcnt vmcnt(6)
.ap_84:
    s_add_u32 s63, s69, 172032
    buffer_load_dwordx4 v[212:215], v1, s[44:47], s63 offen nt
    s_memrealtime s[8:9]
    s_waitcnt vmcnt(13)
    s_waitcnt lgkmcnt(0)
    s_sub_u32 s8, s8, s30
    s_cmpk_ge_u32 s8, 1788
    s_cbranch_scc1 .ap_85
    s_waitcnt vmcnt(10)
    s_cmpk_ge_u32 s8, 1688
    s_cbranch_scc1 .ap_85
    s_waitcnt vmcnt(8)
    s_bitcmp1_b64 s[14:15], 46
    s_cbranch_scc0 1
    s_waitcnt vmcnt(7)
    s_cmpk_ge_u32 s8, 1568
    s_cbranch_scc1 .ap_85
    s_waitcnt vmcnt(6)
.ap_85:
    s_add_u32 s63, s69, 180224
    buffer_load_dwordx4 v[216:219], v1, s[44:47], s63 offen nt
    s_memrealtime s[8:9]
    s_waitcnt vmcnt(13)
    s_waitcnt lgkmcnt(0)
    s_sub_u32 s8, s8, s30
    s_cmpk_ge_u32 s8, 1820
    s_cbranch_scc1 .ap_86
    s_waitcnt vmcnt(10)
    s_cmpk_ge_u32 s8, 1720
    s_cbranch_scc1 .ap_86
    s_waitcnt vmcnt(8)
    s_bitcmp1_b64 s[14:15], 47
    s_cbranch_scc0 1
    s_waitcnt vmcnt(7)
    s_cmpk_ge_u32 s8, 1600
    s_cbranch_scc1 .ap_86
    s_waitcnt vmcnt(1)
.ap_86:
    s_add_u32 s63, s69, 188416
    s_branch .Lsk_m1_4
.Lst_m1_4:
    s_branch .Lrt_m1_4
.Lsk_m1_4:
    buffer_load_dwordx4 v[220:223], v1, s[44:47], s63 offen nt
    s_memrealtime s[8:9]
    s_waitcnt vmcnt(13)
    s_waitcnt lgkmcnt(0)
    s_sub_u32 s8, s8, s30
    s_cmpk_ge_u32 s8, 1852
    s_cbranch_scc1 .ap_87
    s_waitcnt vmcnt(10)
    s_cmpk_ge_u32 s8, 1752
    s_cbranch_scc1 .ap_87
    s_waitcnt vmcnt(8)
    s_bitcmp1_b64 s[14:15], 48
    s_cbranch_scc0 1
    s_waitcnt vmcnt(2)
    s_cmpk_ge_u32 s8, 1632
    s_cbranch_scc1 .ap_87
    s_waitcnt vmcnt(1)
.ap_87:
    s_add_u32 s63, s69, 262144
    buffer_load_dwordx4 v[224:227], v1, s[44:47], s63 offen nt
    s_memrealtime s[8:9]
    s_waitcnt vmcnt(13)
    s_waitcnt lgkmcnt(0)
    s_sub_u32 s8, s8, s30
    s_cmpk_ge_u32 s8, 1884
    s_cbranch_scc1 .ap_88
    s_waitcnt vmcnt(10)
    s_cmpk_ge_u32 s8, 1784
    s_cbranch_scc1 .ap_88
    s_waitcnt vmcnt(3)
    s_bitcmp1_b64 s[14:15], 49
    s_cbranch_scc0 1
    s_waitcnt vmcnt(2)
    s_cmpk_ge_u32 s8, 1664
    s_cbranch_scc1 .ap_88
    s_waitcnt vmcnt(1)
.ap_88:
    s_add_u32 s63, s69, 270336
    buffer_load_dwordx4 v[228:231], v1, s[44:47], s63 offen nt
    s_memrealtime s[8:9]
    s_waitcnt vmcnt(13)
    s_waitcnt lgkmcnt(0)
    s_sub_u32 s8, s8, s30
    s_cmpk_ge_u32 s8, 1916
    s_cbranch_scc1 .ap_89
    s_waitcnt vmcnt(10)
    s_cmpk_ge_u32 s8, 1816
    s_cbranch_scc1 .ap_89
    s_waitcnt vmcnt(3)
    s_bitcmp1_b64 s[14:15], 50
    s_cbranch_scc0 1
    s_waitcnt vmcnt(2)
    s_cmpk_ge_u32 s8, 1696
    s_cbranch_scc1 .ap_89
    s_waitcnt vmcnt(1)
.ap_89:
    s_add_u32 s63, s69, 278528
    buffer_load_dwordx4 v[232:235], v1, s[44:47], s63 offen nt
    s_memrealtime s[8:9]
    s_waitcnt vmcnt(13)
    s_waitcnt lgkmcnt(0)
    s_sub_u32 s8, s8, s30
    s_cmpk_ge_u32 s8, 1948
    s_cbranch_scc1 .ap_90
    s_waitcnt vmcnt(5)
    s_cmpk_ge_u32 s8, 1848
    s_cbranch_scc1 .ap_90
    s_waitcnt vmcnt(3)
    s_bitcmp1_b64 s[14:15], 51
    s_cbranch_scc0 1
    s_waitcnt vmcnt(2)
    s_cmpk_ge_u32 s8, 1728
    s_cbranch_scc1 .ap_90
    s_waitcnt vmcnt(1)
.ap_90:
    s_add_u32 s63, s69, 286720
    buffer_load_dwordx4 v[236:239], v1, s[44:47], s63 offen nt
    s_memrealtime s[8:9]
    s_waitcnt vmcnt(13)
    s_waitcnt lgkmcnt(0)
    s_sub_u32 s8, s8, s30
    s_cmpk_ge_u32 s8, 1980
    s_cbranch_scc1 .ap_91
    s_waitcnt vmcnt(5)
    s_cmpk_ge_u32 s8, 1880
    s_cbranch_scc1 .ap_91
    s_waitcnt vmcnt(3)
    s_bitcmp1_b64 s[14:15], 52
    s_cbranch_scc0 1
    s_waitcnt vmcnt(2)
    s_cmpk_ge_u32 s8, 1760
    s_cbranch_scc1 .ap_91
    s_waitcnt vmcnt(1)
.ap_91:
    s_add_u32 s63, s69, 294912
    buffer_load_dwordx4 v[240:243], v1, s[44:47], s63 offen nt
    s_memrealtime s[8:9]
    s_waitcnt vmcnt(13)
    s_waitcnt lgkmcnt(0)
    s_sub_u32 s8, s8, s30
    s_cmpk_ge_u32 s8, 2012
    s_cbranch_scc1 .ap_92
    s_waitcnt vmcnt(5)
    s_cmpk_ge_u32 s8, 1912
    s_cbranch_scc1 .ap_92
    s_waitcnt vmcnt(3)
    s_bitcmp1_b64 s[14:15], 53
    s_cbranch_scc0 1
    s_waitcnt vmcnt(2)
    s_cmpk_ge_u32 s8, 1792
    s_cbranch_scc1 .ap_92
    s_waitcnt vmcnt(1)
.ap_92:
    s_add_u32 s63, s69, 303104
    buffer_load_dwordx4 v[244:247], v1, s[44:47], s63 offen nt
    s_memrealtime s[8:9]
    s_waitcnt vmcnt(8)
    s_waitcnt lgkmcnt(0)
    s_sub_u32 s8, s8, s30
    s_cmpk_ge_u32 s8, 2044
    s_cbranch_scc1 .ap_93
    s_waitcnt vmcnt(5)
    s_cmpk_ge_u32 s8, 1944
    s_cbranch_scc1 .ap_93
    s_waitcnt vmcnt(3)
    s_bitcmp1_b64 s[14:15], 54
    s_cbranch_scc0 1
    s_waitcnt vmcnt(2)
    s_cmpk_ge_u32 s8, 1824
    s_cbranch_scc1 .ap_93
    s_waitcnt vmcnt(1)
.ap_93:
    s_add_u32 s63, s69, 311296
    buffer_load_dwordx4 v[248:251], v1, s[44:47], s63 offen nt
    s_memrealtime s[8:9]
    s_waitcnt vmcnt(8)
    s_waitcnt lgkmcnt(0)
    s_sub_u32 s8, s8, s30
    s_cmpk_ge_u32 s8, 2076
    s_cbranch_scc1 .ap_94
    s_waitcnt vmcnt(5)
    s_cmpk_ge_u32 s8, 1976
    s_cbranch_scc1 .ap_94
    s_waitcnt vmcnt(3)
    s_bitcmp1_b64 s[14:15], 55
    s_cbranch_scc0 1
    s_waitcnt vmcnt(2)
    s_cmpk_ge_u32 s8, 1856
    s_cbranch_scc1 .ap_94
    s_waitcnt vmcnt(1)
.ap_94:
    s_add_u32 s63, s69, 319488
    buffer_load_dwordx4 v[252:255], v1, s[44:47], s63 offen nt
    s_memrealtime s[8:9]
    s_waitcnt vmcnt(8)
    s_waitcnt lgkmcnt(0)
    s_sub_u32 s8, s8, s30
    s_cmpk_ge_u32 s8, 2108
    s_cbranch_scc1 .ap_95
    s_waitcnt vmcnt(5)
    s_cmpk_ge_u32 s8, 2008
    s_cbranch_scc1 .ap_95
    s_waitcnt vmcnt(3)
    s_bitcmp1_b64 s[14:15], 56
    s_cbranch_scc0 1
    s_waitcnt vmcnt(2)
    s_cmpk_ge_u32 s8, 1888
    s_cbranch_scc1 .ap_95
    s_waitcnt vmcnt(1)
.ap_95:
    s_add_u32 s63, s69, 393216
    buffer_load_dwordx4 v[36:39], v1, s[44:47], s63 offen nt
    s_memrealtime s[8:9]
    s_waitcnt vmcnt(8)
    s_waitcnt lgkmcnt(0)
    s_sub_u32 s8, s8, s30
    s_cmpk_ge_u32 s8, 2140
    s_cbranch_scc1 .ap_96
    s_waitcnt vmcnt(5)
    s_cmpk_ge_u32 s8, 2040
    s_cbranch_scc1 .ap_96
    s_waitcnt vmcnt(3)
    s_bitcmp1_b64 s[14:15], 57
    s_cbranch_scc0 1
    s_waitcnt vmcnt(2)
    s_branch .Lsk_m1_5
.Lst_m1_5:
    s_branch .Lrt_m1_5
.Lsk_m1_5:
    s_cmpk_ge_u32 s8, 1920
    s_cbranch_scc1 .ap_96
    s_waitcnt vmcnt(1)
.ap_96:
    s_add_u32 s63, s69, 401408
    buffer_load_dwordx4 v[44:47], v1, s[44:47], s63 offen nt
    s_and_b32 s0, s0, 0xffffff80
    s_sub_u32 s0, s0, 1024
    buffer_load_dword v28, v4, s[36:39], s0 offen sc1
    buffer_load_dwordx4 v[24:27], v9, s[36:39], s59 offen offset:0 sc1
    s_memrealtime s[8:9]
    s_waitcnt vmcnt(9)
    s_waitcnt lgkmcnt(0)
    s_sub_u32 s8, s8, s30
    s_cmpk_ge_u32 s8, 2172
    s_cbranch_scc1 .ap_97
    s_waitcnt vmcnt(6)
    s_cmpk_ge_u32 s8, 2072
    s_cbranch_scc1 .ap_97
    s_waitcnt vmcnt(4)
    s_bitcmp1_b64 s[14:15], 58
    s_cbranch_scc0 1
    s_waitcnt vmcnt(3)
    s_cmpk_ge_u32 s8, 1952
    s_cbranch_scc1 .ap_97
    s_waitcnt vmcnt(2)
.ap_97:
    s_add_u32 s63, s69, 409600
    buffer_load_dwordx4 v[52:55], v1, s[44:47], s63 offen nt
    s_memrealtime s[8:9]
    s_waitcnt vmcnt(9)
    s_waitcnt lgkmcnt(0)
    s_sub_u32 s8, s8, s30
    s_cmpk_ge_u32 s8, 2204
    s_cbranch_scc1 .ap_98
    s_waitcnt vmcnt(6)
    s_cmpk_ge_u32 s8, 2104
    s_cbranch_scc1 .ap_98
    s_waitcnt vmcnt(4)
    s_bitcmp1_b64 s[14:15], 59
    s_cbranch_scc0 1
    s_waitcnt vmcnt(3)
    s_cmpk_ge_u32 s8, 1984
    s_cbranch_scc1 .ap_98
    s_waitcnt vmcnt(1)
.ap_98:
    s_add_u32 s63, s69, 417792
    buffer_load_dwordx4 v[60:63], v1, s[44:47], s63 offen nt
    s_memrealtime s[8:9]
    s_waitcnt vmcnt(9)
    s_waitcnt lgkmcnt(0)
    s_sub_u32 s8, s8, s30
    s_cmpk_ge_u32 s8, 2236
    s_cbranch_scc1 .ap_99
    s_waitcnt vmcnt(6)
    s_cmpk_ge_u32 s8, 2136
    s_cbranch_scc1 .ap_99
    s_waitcnt vmcnt(4)
    s_bitcmp1_b64 s[14:15], 60
    s_cbranch_scc0 1
    s_waitcnt vmcnt(2)
    s_cmpk_ge_u32 s8, 2016
    s_cbranch_scc1 .ap_99
    s_waitcnt vmcnt(1)
.ap_99:
    s_add_u32 s63, s69, 425984
    buffer_load_dwordx4 v[68:71], v1, s[44:47], s63 offen nt
    s_memrealtime s[8:9]
    s_waitcnt vmcnt(9)
    s_waitcnt lgkmcnt(0)
    s_sub_u32 s8, s8, s30
    s_cmpk_ge_u32 s8, 2268
    s_cbranch_scc1 .ap_100
    s_waitcnt vmcnt(6)
    s_cmpk_ge_u32 s8, 2168
    s_cbranch_scc1 .ap_100
    s_waitcnt vmcnt(3)
    s_bitcmp1_b64 s[14:15], 61
    s_cbranch_scc0 1
    s_waitcnt vmcnt(2)
    s_cmpk_ge_u32 s8, 2048
    s_cbranch_scc1 .ap_100
    s_waitcnt vmcnt(1)
.ap_100:
    s_add_u32 s63, s69, 434176
    buffer_load_dwordx4 v[76:79], v1, s[44:47], s63 offen nt
    s_memrealtime s[8:9]
    s_waitcnt vmcnt(9)
    s_waitcnt lgkmcnt(0)
    s_sub_u32 s8, s8, s30
    s_cmpk_ge_u32 s8, 2300
    s_cbranch_scc1 .ap_101
    s_waitcnt vmcnt(6)
    s_cmpk_ge_u32 s8, 2200
    s_cbranch_scc1 .ap_101
    s_waitcnt vmcnt(3)
    s_bitcmp1_b64 s[14:15], 62
    s_cbranch_scc0 1
    s_waitcnt vmcnt(2)
    s_cmpk_ge_u32 s8, 2080
    s_cbranch_scc1 .ap_101
    s_waitcnt vmcnt(1)
.ap_101:
    s_add_u32 s63, s69, 442368
    buffer_load_dwordx4 v[84:87], v1, s[44:47], s63 offen nt
    s_memrealtime s[8:9]
    s_waitcnt vmcnt(9)
    s_waitcnt lgkmcnt(0)
    s_sub_u32 s8, s8, s30
    s_cmpk_ge_u32 s8, 2332
    s_cbranch_scc1 .ap_102
    s_waitcnt vmcnt(5)
    s_cmpk_ge_u32 s8, 2232
    s_cbranch_scc1 .ap_102
    s_waitcnt vmcnt(3)
    s_bitcmp1_b64 s[14:15], 63
    s_cbranch_scc0 1
    s_waitcnt vmcnt(2)
    s_cmpk_ge_u32 s8, 2112
    s_cbranch_scc1 .ap_102
    s_waitcnt vmcnt(1)
.ap_102:
    s_add_u32 s63, s69, 450560
    buffer_load_dwordx4 v[92:95], v1, s[44:47], s63 offen nt
    s_setprio 0
    s_waitcnt vmcnt(6)
    s_branch .gpc_104
.gp_103:
    buffer_load_dwordx4 v[24:27], v9, s[36:39], s59 offen offset:0 sc1
    s_waitcnt vmcnt(0)
.gpc_104:
    v_cmp_eq_u32 vcc, s34, v26
    s_cmp_eq_u64 vcc, -1
    s_nop 3
    s_cbranch_scc1 .gpd_105
    s_sub_u32 s35, s35, 1
    s_cbranch_scc1 .Lexit
    s_sleep 1
    s_branch .gp_103
.gpd_105:
    v_cmp_eq_u32 vcc, s1, v28
    s_cmp_eq_u64 vcc, -1
    s_cselect_b32 s0, 0x800000, 0
    v_mov_b32 v16, v24
    s_nop 1
    v_max_f32_dpp v16, v16, v16 row_ror:4 row_mask:0xf bank_mask:0xf
    v_sub_f32 v17, v24, v16
    v_sub_f32 v18, v14, v16
    v_mul_f32 v17, 0x3fb8aa3b, v17
    v_mul_f32 v18, 0x3fb8aa3b, v18
    v_exp_f32 v17, v17
    v_exp_f32 v18, v18
    v_mul_f32 v17, v17, v25
    s_nop 1
    v_add_f32_dpp v17, v17, v17 row_ror:4 row_mask:0xf bank_mask:0xf
    v_rcp_f32 v19, v17
    s_nop 0
    v_fma_f32 v15, -v17, v19, 1.0
    v_fma_f32 v19, v15, v19, v19
    v_mul_f32 v18, v18, v19
    v_mul_f32 v10, v10, v18
    v_mul_f32 v11, v11, v18
    v_mul_f32 v12, v12, v18
    v_mul_f32 v13, v13, v18
    v_mov_b32_dpp v112, v10 quad_perm:[2,3,0,1] row_mask:0xf bank_mask:0xf
    v_mov_b32_dpp v113, v11 quad_perm:[2,3,0,1] row_mask:0xf bank_mask:0xf
    v_mov_b32_dpp v114, v12 quad_perm:[2,3,0,1] row_mask:0xf bank_mask:0xf
    v_mov_b32_dpp v115, v13 quad_perm:[2,3,0,1] row_mask:0xf bank_mask:0xf
    v_cvt_pk_bf16_f32 v96, v10, v112
    v_cvt_pk_bf16_f32 v100, v11, v113
    v_cvt_pk_bf16_f32 v104, v12, v114
    v_cvt_pk_bf16_f32 v108, v13, v115
    v_mov_b32_dpp v97, v96 row_ror:12 row_mask:0xf bank_mask:0xf
    v_mov_b32_dpp v101, v100 row_ror:12 row_mask:0xf bank_mask:0xf
    v_mov_b32_dpp v105, v104 row_ror:12 row_mask:0xf bank_mask:0xf
    v_mov_b32_dpp v109, v108 row_ror:12 row_mask:0xf bank_mask:0xf
    v_mov_b32_dpp v98, v96 row_ror:8 row_mask:0xf bank_mask:0xf
    v_mov_b32_dpp v102, v100 row_ror:8 row_mask:0xf bank_mask:0xf
    v_mov_b32_dpp v106, v104 row_ror:8 row_mask:0xf bank_mask:0xf
    v_mov_b32_dpp v110, v108 row_ror:8 row_mask:0xf bank_mask:0xf
    v_mov_b32_dpp v99, v96 row_ror:4 row_mask:0xf bank_mask:0xf
    v_mov_b32_dpp v103, v100 row_ror:4 row_mask:0xf bank_mask:0xf
    v_mov_b32_dpp v107, v104 row_ror:4 row_mask:0xf bank_mask:0xf
    v_mov_b32_dpp v111, v108 row_ror:4 row_mask:0xf bank_mask:0xf
    s_lshl_b32 s60, s3, 10
    s_add_u32 s60, s60, 147456
    v_lshlrev_b32 v10, 5, v0
    v_add_u32 v10, s60, v10
    v_perm_b32 v112, v164, v160, s94
    v_perm_b32 v113, v172, v168, s94
    v_perm_b32 v114, v180, v176, s94
    v_perm_b32 v115, v188, v184, s94
    s_nop 1
    v_mfma_f32_16x16x32_bf16 v[128:131], v[96:99], v[112:115], 0
    v_perm_b32 v116, v164, v160, s95
    v_perm_b32 v117, v172, v168, s95
    v_perm_b32 v118, v180, v176, s95
    v_perm_b32 v119, v188, v184, s95
    s_nop 1
    v_mfma_f32_16x16x32_bf16 v[132:135], v[96:99], v[116:119], 0
    v_perm_b32 v120, v165, v161, s94
    v_perm_b32 v121, v173, v169, s94
    v_perm_b32 v122, v181, v177, s94
    v_perm_b32 v123, v189, v185, s94
    s_nop 1
    v_mfma_f32_16x16x32_bf16 v[136:139], v[96:99], v[120:123], 0
    v_perm_b32 v124, v165, v161, s95
    v_perm_b32 v125, v173, v169, s95
    v_perm_b32 v126, v181, v177, s95
    s_branch .Lsk_m1_6
.Lst_m1_6:
    s_branch .Lrt_m1_6
.Lsk_m1_6:
    v_perm_b32 v127, v189, v185, s95
    s_nop 1
    v_mfma_f32_16x16x32_bf16 v[140:143], v[96:99], v[124:127], 0
    v_perm_b32 v112, v166, v162, s94
    v_perm_b32 v113, v174, v170, s94
    v_perm_b32 v114, v182, v178, s94
    v_perm_b32 v115, v190, v186, s94
    s_nop 1
    v_mfma_f32_16x16x32_bf16 v[144:147], v[96:99], v[112:115], 0
    v_perm_b32 v116, v166, v162, s95
    v_perm_b32 v117, v174, v170, s95
    v_perm_b32 v118, v182, v178, s95
    v_perm_b32 v119, v190, v186, s95
    s_nop 1
    v_mfma_f32_16x16x32_bf16 v[148:151], v[96:99], v[116:119], 0
    v_perm_b32 v120, v167, v163, s94
    v_perm_b32 v121, v175, v171, s94
    v_perm_b32 v122, v183, v179, s94
    v_perm_b32 v123, v191, v187, s94
    s_nop 1
    v_mfma_f32_16x16x32_bf16 v[152:155], v[96:99], v[120:123], 0
    v_perm_b32 v124, v167, v163, s95
    v_perm_b32 v125, v175, v171, s95
    v_perm_b32 v126, v183, v179, s95
    v_perm_b32 v127, v191, v187, s95
    s_nop 1
    v_mfma_f32_16x16x32_bf16 v[156:159], v[96:99], v[124:127], 0
    v_perm_b32 v112, v196, v192, s94
    v_perm_b32 v113, v204, v200, s94
    v_perm_b32 v114, v212, v208, s94
    v_perm_b32 v115, v220, v216, s94
    s_nop 1
    v_mfma_f32_16x16x32_bf16 v[128:131], v[100:103], v[112:115], v[128:131]
    v_perm_b32 v116, v196, v192, s95
    v_perm_b32 v117, v204, v200, s95
    v_perm_b32 v118, v212, v208, s95
    v_perm_b32 v119, v220, v216, s95
    s_nop 1
    v_mfma_f32_16x16x32_bf16 v[132:135], v[100:103], v[116:119], v[132:135]
    v_perm_b32 v120, v197, v193, s94
    v_perm_b32 v121, v205, v201, s94
    v_perm_b32 v122, v213, v209, s94
    v_perm_b32 v123, v221, v217, s94
    s_nop 1
    v_mfma_f32_16x16x32_bf16 v[136:139], v[100:103], v[120:123], v[136:139]
    v_perm_b32 v124, v197, v193, s95
    v_perm_b32 v125, v205, v201, s95
    v_perm_b32 v126, v213, v209, s95
    v_perm_b32 v127, v221, v217, s95
    s_nop 1
    v_mfma_f32_16x16x32_bf16 v[140:143], v[100:103], v[124:127], v[140:143]
    v_perm_b32 v112, v198, v194, s94
    v_perm_b32 v113, v206, v202, s94
    v_perm_b32 v114, v214, v210, s94
    v_perm_b32 v115, v222, v218, s94
    s_nop 1
    v_mfma_f32_16x16x32_bf16 v[144:147], v[100:103], v[112:115], v[144:147]
    v_perm_b32 v116, v198, v194, s95
    v_perm_b32 v117, v206, v202, s95
    v_perm_b32 v118, v214, v210, s95
    v_perm_b32 v119, v222, v218, s95
    s_nop 1
    v_mfma_f32_16x16x32_bf16 v[148:151], v[100:103], v[116:119], v[148:151]
    v_perm_b32 v120, v199, v195, s94
    v_perm_b32 v121, v207, v203, s94
    v_perm_b32 v122, v215, v211, s94
    v_perm_b32 v123, v223, v219, s94
    s_nop 1
    v_mfma_f32_16x16x32_bf16 v[152:155], v[100:103], v[120:123], v[152:155]
    v_perm_b32 v124, v199, v195, s95
    v_perm_b32 v125, v207, v203, s95
    v_perm_b32 v126, v215, v211, s95
    v_perm_b32 v127, v223, v219, s95
    s_nop 1
    v_mfma_f32_16x16x32_bf16 v[156:159], v[100:103], v[124:127], v[156:159]
    v_perm_b32 v112, v228, v224, s94
    v_perm_b32 v113, v236, v232, s94
    v_perm_b32 v114, v244, v240, s94
    v_perm_b32 v115, v252, v248, s94
    s_nop 1
    v_mfma_f32_16x16x32_bf16 v[128:131], v[104:107], v[112:115], v[128:131]
    v_perm_b32 v116, v228, v224, s95
    v_perm_b32 v117, v236, v232, s95
    v_perm_b32 v118, v244, v240, s95
    v_perm_b32 v119, v252, v248, s95
    s_nop 1
    v_mfma_f32_16x16x32_bf16 v[132:135], v[104:107], v[116:119], v[132:135]
    v_perm_b32 v120, v229, v225, s94
    v_perm_b32 v121, v237, v233, s94
    v_perm_b32 v122, v245, v241, s94
    v_perm_b32 v123, v253, v249, s94
    s_nop 1
    v_mfma_f32_16x16x32_bf16 v[136:139], v[104:107], v[120:123], v[136:139]
    v_perm_b32 v124, v229, v225, s95
    v_perm_b32 v125, v237, v233, s95
    v_perm_b32 v126, v245, v241, s95
    v_perm_b32 v127, v253, v249, s95
    s_nop 1
    v_mfma_f32_16x16x32_bf16 v[140:143], v[104:107], v[124:127], v[140:143]
    v_perm_b32 v112, v230, v226, s94
    v_perm_b32 v113, v238, v234, s94
    v_perm_b32 v114, v246, v242, s94
    v_perm_b32 v115, v254, v250, s94
    s_nop 1
    v_mfma_f32_16x16x32_bf16 v[144:147], v[104:107], v[112:115], v[144:147]
    v_perm_b32 v116, v230, v226, s95
    v_perm_b32 v117, v238, v234, s95
    v_perm_b32 v118, v246, v242, s95
    v_perm_b32 v119, v254, v250, s95
    s_nop 1
    v_mfma_f32_16x16x32_bf16 v[148:151], v[104:107], v[116:119], v[148:151]
    v_perm_b32 v120, v231, v227, s94
    v_perm_b32 v121, v239, v235, s94
    v_perm_b32 v122, v247, v243, s94
    v_perm_b32 v123, v255, v251, s94
    s_nop 1
    v_mfma_f32_16x16x32_bf16 v[152:155], v[104:107], v[120:123], v[152:155]
    v_perm_b32 v124, v231, v227, s95
    v_perm_b32 v125, v239, v235, s95
    v_perm_b32 v126, v247, v243, s95
    v_perm_b32 v127, v255, v251, s95
    s_nop 1
    v_mfma_f32_16x16x32_bf16 v[156:159], v[104:107], v[124:127], v[156:159]
    s_waitcnt vmcnt(0)
    v_perm_b32 v112, v44, v36, s94
    v_perm_b32 v113, v60, v52, s94
    v_perm_b32 v114, v76, v68, s94
    v_perm_b32 v115, v92, v84, s94
    s_nop 1
    v_mfma_f32_16x16x32_bf16 v[128:131], v[108:111], v[112:115], v[128:131]
    v_perm_b32 v116, v44, v36, s95
    v_perm_b32 v117, v60, v52, s95
    v_perm_b32 v118, v76, v68, s95
    v_perm_b32 v119, v92, v84, s95
    s_nop 1
    v_mfma_f32_16x16x32_bf16 v[132:135], v[108:111], v[116:119], v[132:135]
    v_perm_b32 v120, v45, v37, s94
    v_perm_b32 v121, v61, v53, s94
    v_perm_b32 v122, v77, v69, s94
    v_perm_b32 v123, v93, v85, s94
    s_nop 1
    v_mfma_f32_16x16x32_bf16 v[136:139], v[108:111], v[120:123], v[136:139]
    v_perm_b32 v124, v45, v37, s95
    v_perm_b32 v125, v61, v53, s95
    v_perm_b32 v126, v77, v69, s95
    v_perm_b32 v127, v93, v85, s95
    s_nop 1
    v_mfma_f32_16x16x32_bf16 v[140:143], v[108:111], v[124:127], v[140:143]
    s_branch .Lsk_m1_7
.Lst_m1_7:
    s_branch .Lrt_m1_7
.Lsk_m1_7:
    v_perm_b32 v112, v46, v38, s94
    v_perm_b32 v113, v62, v54, s94
    v_perm_b32 v114, v78, v70, s94
    v_perm_b32 v115, v94, v86, s94
    s_nop 1
    v_mfma_f32_16x16x32_bf16 v[144:147], v[108:111], v[112:115], v[144:147]
    v_perm_b32 v116, v46, v38, s95
    v_perm_b32 v117, v62, v54, s95
    v_perm_b32 v118, v78, v70, s95
    v_perm_b32 v119, v94, v86, s95
    s_nop 1
    v_mfma_f32_16x16x32_bf16 v[148:151], v[108:111], v[116:119], v[148:151]
    v_perm_b32 v120, v47, v39, s94
    v_perm_b32 v121, v63, v55, s94
    v_perm_b32 v122, v79, v71, s94
    v_perm_b32 v123, v95, v87, s94
    s_nop 1
    v_mfma_f32_16x16x32_bf16 v[152:155], v[108:111], v[120:123], v[152:155]
    v_perm_b32 v124, v47, v39, s95
    v_perm_b32 v125, v63, v55, s95
    v_perm_b32 v126, v79, v71, s95
    v_perm_b32 v127, v95, v87, s95
    s_nop 1
    v_mfma_f32_16x16x32_bf16 v[156:159], v[108:111], v[124:127], v[156:159]
    s_mov_b64 exec, 0xffff
    ds_write2_b32 v10, v128, v129 offset0:0 offset1:128
    ds_write2_b32 v10, v132, v133 offset0:1 offset1:129
    ds_write2_b32 v10, v136, v137 offset0:2 offset1:130
    ds_write2_b32 v10, v140, v141 offset0:3 offset1:131
    ds_write2_b32 v10, v144, v145 offset0:4 offset1:132
    ds_write2_b32 v10, v148, v149 offset0:5 offset1:133
    ds_write2_b32 v10, v152, v153 offset0:6 offset1:134
    ds_write2_b32 v10, v156, v157 offset0:7 offset1:135
    s_mov_b64 exec, -1
    s_waitcnt lgkmcnt(0)
    s_barrier
    s_cmp_lg_u32 s3, 7
    s_cbranch_scc1 .opub_106
    v_add_u32 v10, 147456, v2
    ds_read_b128 v[196:199], v10 offset:0
    ds_read_b128 v[200:203], v10 offset:1024
    ds_read_b128 v[204:207], v10 offset:2048
    ds_read_b128 v[208:211], v10 offset:3072
    ds_read_b128 v[212:215], v10 offset:4096
    ds_read_b128 v[216:219], v10 offset:5120
    ds_read_b128 v[220:223], v10 offset:6144
    ds_read_b128 v[224:227], v10 offset:7168
    v_lshrrev_b32 v11, 5, v0
    v_lshlrev_b32 v11, 13, v11
    v_and_b32 v12, 31, v0
    v_lshl_add_u32 v11, v12, 4, v11
    s_lshl4_add_u32 s56, s67, s66
    s_lshl1_add_u32 s56, s56, s68
    s_lshl_b32 s56, s56, 9
    s_add_u32 s56, s56, 0xa0000
    s_mov_b32 s60, 0x07060503
    s_mov_b32 s61, 0x07060502
    s_mov_b32 s62, 0x07060501
    v_mov_b32 v15, s34
    s_waitcnt lgkmcnt(6)
    v_pk_add_f32 v[196:197], v[196:197], v[200:201]
    v_pk_add_f32 v[198:199], v[198:199], v[202:203]
    s_waitcnt lgkmcnt(5)
    v_pk_add_f32 v[196:197], v[196:197], v[204:205]
    v_pk_add_f32 v[198:199], v[198:199], v[206:207]
    s_waitcnt lgkmcnt(4)
    v_pk_add_f32 v[196:197], v[196:197], v[208:209]
    v_pk_add_f32 v[198:199], v[198:199], v[210:211]
    s_waitcnt lgkmcnt(3)
    v_pk_add_f32 v[196:197], v[196:197], v[212:213]
    v_pk_add_f32 v[198:199], v[198:199], v[214:215]
    s_waitcnt lgkmcnt(2)
    v_pk_add_f32 v[196:197], v[196:197], v[216:217]
    v_pk_add_f32 v[198:199], v[198:199], v[218:219]
    s_waitcnt lgkmcnt(1)
    v_pk_add_f32 v[196:197], v[196:197], v[220:221]
    v_pk_add_f32 v[198:199], v[198:199], v[222:223]
    s_waitcnt lgkmcnt(0)
    v_pk_add_f32 v[196:197], v[196:197], v[224:225]
    v_pk_add_f32 v[198:199], v[198:199], v[226:227]
    v_perm_b32 v12, v196, v199, s60
    v_perm_b32 v13, v197, v199, s61
    v_perm_b32 v14, v198, v199, s62
    s_add_u32 s57, s56, 0x800000
    buffer_store_dwordx4 v[12:15], v11, s[36:39], s57 offen
    buffer_store_dwordx4 v[12:15], v11, s[36:39], s56 offen sc1
.opub_106:
    s_and_b32 s58, s64, 0
    s_mul_i32 s58, s58, 18432
    s_mul_i32 s59, s3, 2304
    s_add_u32 s58, s58, s59
    s_add_u32 s62, s58, 0x37000
    s_add_u32 s63, s58, 0x49000
    s_mul_i32 s101, s64, 18432
    s_add_u32 s101, s101, s59
    s_add_u32 s101, s101, 0x170000
    v_and_b32 v16, 8, v0
    v_and_b32 v17, 1, v0
    v_lshl_add_u32 v16, v17, 2, v16
    v_bfe_u32 v17, v0, 1, 2
    v_add_u32 v16, v16, v17
    v_lshlrev_b32 v9, 4, v16
    s_lshl_b32 s56, s65, 8
    s_add_u32 s58, s58, s56
    s_add_u32 s58, s58, 0x25000
    s_add_u32 s99, s101, s56
    s_lshr_b32 s56, s64, 1
    s_and_b32 s57, s3, 3
    s_cmp_lg_u32 s56, s57
    s_cbranch_scc1 .Lr_ga
    s_add_u32 s59, s58, 73728
    s_add_u32 s60, s58, 147456
    s_add_u32 s61, s58, 221184
.gp_107:
    buffer_load_dwordx4 v[56:59], v2, s[36:39], s62 offen offset:0 sc1
    buffer_load_dwordx4 v[60:63], v2, s[36:39], s62 offen offset:1024 sc1
    buffer_load_dwordx2 v[64:65], v5, s[36:39], s62 offen offset:0 sc1
    buffer_load_dwordx4 v[66:69], v2, s[36:39], s63 offen offset:0 sc1
    buffer_load_dwordx4 v[70:73], v2, s[36:39], s63 offen offset:1024 sc1
    buffer_load_dwordx2 v[74:75], v5, s[36:39], s63 offen offset:0 sc1
    buffer_load_dwordx2 v[76:77], v8, s[36:39], s59 offen offset:0 sc1
    buffer_load_dwordx2 v[78:79], v8, s[36:39], s60 offen offset:0 sc1
    buffer_load_dwordx2 v[80:81], v8, s[36:39], s61 offen offset:0 sc1
    buffer_load_dwordx2 v[42:43], v8, s[36:39], s58 offen offset:0 sc1
    s_waitcnt vmcnt(0)
.gpc_108:
    v_min_u32 v24, v57, v59
    v_max_u32 v25, v57, v59
    v_min3_u32 v24, v24, v61, v63
    v_max3_u32 v25, v25, v61, v63
    v_min3_u32 v24, v24, v65, v67
    v_max3_u32 v25, v25, v65, v67
    v_min3_u32 v24, v24, v69, v71
    v_max3_u32 v25, v25, v69, v71
    v_min3_u32 v24, v24, v73, v75
    v_max3_u32 v25, v25, v73, v75
    v_min3_u32 v24, v24, v77, v79
    v_max3_u32 v25, v25, v77, v79
    v_min3_u32 v24, v24, v81, v43
    v_max3_u32 v25, v25, v81, v43
    v_cmp_eq_u32 vcc, s34, v24
    v_cmp_eq_u32 s[56:57], s34, v25
    s_and_b64 vcc, vcc, s[56:57]
    s_cmp_eq_u64 vcc, -1
    s_nop 2
    s_cbranch_scc1 .gpd_109
    s_sub_u32 s35, s35, 1
    s_cbranch_scc1 .Lexit
    s_sleep 2
    s_branch .gp_107
.gpd_109:
    v_and_b32 v57, 0xffff0000, v56
    v_lshlrev_b32 v56, 16, v56
    v_and_b32 v67, 0xffff0000, v66
    v_lshlrev_b32 v66, 16, v66
    v_and_b32 v59, 0xffff0000, v58
    v_lshlrev_b32 v58, 16, v58
    v_and_b32 v69, 0xffff0000, v68
    v_lshlrev_b32 v68, 16, v68
    v_and_b32 v61, 0xffff0000, v60
    v_lshlrev_b32 v60, 16, v60
    v_and_b32 v71, 0xffff0000, v70
    v_lshlrev_b32 v70, 16, v70
    v_and_b32 v63, 0xffff0000, v62
    v_lshlrev_b32 v62, 16, v62
    v_and_b32 v73, 0xffff0000, v72
    v_lshlrev_b32 v72, 16, v72
    v_and_b32 v65, 0xffff0000, v64
    s_branch .Lsk_m2_0
.Lst_m2_0:
    s_branch .Lrt_m2_0
.Lsk_m2_0:
    v_lshlrev_b32 v64, 16, v64
    v_and_b32 v75, 0xffff0000, v74
    v_lshlrev_b32 v74, 16, v74
    v_lshlrev_b32 v77, 16, v76
    v_and_b32 v76, 0xffff0000, v76
    s_mov_b32 vcc_lo, 0xffff0000
    s_mov_b32 vcc_hi, 0xffff0000
    v_cndmask_b32 v77, v77, v76, vcc
    v_lshlrev_b32 v79, 16, v78
    v_and_b32 v78, 0xffff0000, v78
    s_mov_b32 vcc_lo, 0xffff0000
    s_mov_b32 vcc_hi, 0xffff0000
    v_cndmask_b32 v79, v79, v78, vcc
    v_lshlrev_b32 v81, 16, v80
    v_and_b32 v80, 0xffff0000, v80
    s_mov_b32 vcc_lo, 0xffff0000
    s_mov_b32 vcc_hi, 0xffff0000
    v_cndmask_b32 v81, v81, v80, vcc
    s_nop 1
    s_branch .Lr_ga2
.Lr_ga:
.gp_110:
    buffer_load_dwordx2 v[42:43], v8, s[36:39], s58 offen offset:0 sc1
    s_waitcnt vmcnt(0)
.gpc_111:
    v_cmp_eq_u32 vcc, s34, v43
    s_cmp_eq_u64 vcc, -1
    s_nop 3
    s_cbranch_scc1 .gpd_112
    s_sub_u32 s35, s35, 1
    s_cbranch_scc1 .Lexit
    s_sleep 2
    s_branch .gp_110
.gpd_112:
.Lr_ga2:
    v_lshlrev_b32 v40, 16, v40
    v_lshlrev_b32 v41, 16, v42
    v_and_b32 v42, 0xffff0000, v42
    s_mov_b32 vcc_lo, 0xffff0000
    s_mov_b32 vcc_hi, 0xffff0000
    v_cndmask_b32 v41, v41, v42, vcc
    s_mul_i32 s59, s3, 9
    s_add_u32 s59, s59, s65
    s_lshl_b32 s59, s59, 12
    s_add_u32 s59, s59, 0xe0000
    s_mov_b32 s60, 0x04000c0c
    s_mov_b32 s61, 0x0706000c
    v_mov_b32 v45, s34
    v_mov_b32 v47, s34
.gp_113:
    buffer_load_dwordx4 v[16:19], v2, s[36:39], s59 offen offset:0 sc1
    buffer_load_dwordx4 v[20:23], v2, s[36:39], s59 offen offset:1024 sc1
    buffer_load_dwordx4 v[24:27], v2, s[36:39], s59 offen offset:2048 sc1
    buffer_load_dwordx4 v[28:31], v2, s[36:39], s59 offen offset:3072 sc1
    s_waitcnt vmcnt(0)
.gpc_114:
    v_min_u32 v32, v19, v23
    v_max_u32 v33, v19, v23
    v_min3_u32 v32, v32, v27, v31
    v_max3_u32 v33, v33, v27, v31
    v_cmp_eq_u32 vcc, s34, v32
    v_cmp_eq_u32 s[56:57], s34, v33
    s_and_b64 vcc, vcc, s[56:57]
    s_cmp_eq_u64 vcc, -1
    s_nop 2
    s_cbranch_scc1 .gpd_115
    s_sub_u32 s35, s35, 1
    s_cbranch_scc1 .Lexit
    s_branch .gp_113
.gpd_115:
    v_perm_b32 v19, v16, v17, s60
    v_perm_b32 v19, v19, v18, s61
    v_perm_b32 v23, v20, v21, s60
    v_perm_b32 v23, v23, v22, s61
    v_perm_b32 v27, v24, v25, s60
    v_perm_b32 v27, v27, v26, s61
    v_perm_b32 v31, v28, v29, s60
    v_perm_b32 v31, v31, v30, s61
    v_pk_add_f32 v[16:17], v[16:17], v[20:21]
    v_pk_add_f32 v[18:19], v[18:19], v[22:23]
    v_pk_add_f32 v[24:25], v[24:25], v[28:29]
    v_pk_add_f32 v[26:27], v[26:27], v[30:31]
    v_pk_add_f32 v[16:17], v[16:17], v[24:25]
    v_pk_add_f32 v[18:19], v[18:19], v[26:27]
    s_nop 1
    v_permlane32_swap_b32 v16, v18
    v_permlane32_swap_b32 v17, v19
    v_pk_add_f32 v[16:17], v[16:17], v[18:19]
    s_nop 1
    v_permlane16_swap_b32 v16, v17
    v_add_f32 v16, v16, v17
    v_cvt_pk_bf16_f32 v16, v16, v16
    v_lshlrev_b32 v16, 16, v16
    v_mul_f32 v16, v16, v41
    v_cvt_pk_bf16_f32 v16, v16, v16
    v_lshlrev_b32 v16, 16, v16
    v_add_f32 v17, v16, v40
    v_add_f32 v16, v16, v40
    v_mov_b32 v40, v16
    s_nop 0
    v_permlane16_swap_b32 v16, v17
    v_cvt_pk_bf16_f32 v44, v16, v17
    v_cvt_pk_bf16_f32 v46, v16, v17
    s_nop 1
    v_permlane32_swap_b32 v44, v46
    s_mov_b64 exec, 0xffff
    s_add_u32 s57, s99, 0x800000
    buffer_store_dwordx4 v[44:47], v9, s[36:39], s57 offen
    buffer_store_dwordx4 v[44:47], v9, s[36:39], s99 offen sc1
    s_mov_b64 exec, -1
    s_lshr_b32 s56, s64, 1
    s_and_b32 s57, s3, 3
    s_cmp_lg_u32 s56, s57
    s_cbranch_scc1 .Lexit
    v_cvt_pk_bf16_f32 v40, v40, v40
    v_lshlrev_b32 v40, 16, v40
    s_mov_b32 s69, 0
.gp_116:
    s_add_u32 s69, s69, 1
    s_and_b32 s56, s69, 0x41
    s_cmp_lg_u32 s56, 0x41
    s_cselect_b32 s56, s0, 0
    s_add_u32 s58, s101, s56
    buffer_load_dwordx4 v[84:87], v2, s[36:39], s58 offen offset:0 sc1
    buffer_load_dwordx4 v[88:91], v2, s[36:39], s58 offen offset:1024 sc1
    buffer_load_dwordx2 v[92:93], v5, s[36:39], s58 offen offset:0 sc1
    s_waitcnt vmcnt(0)
    v_min3_u32 v24, v85, v87, v89
    v_max3_u32 v25, v85, v87, v89
    v_min3_u32 v24, v24, v91, v93
    v_max3_u32 v25, v25, v91, v93
    v_cmp_eq_u32 vcc, s34, v24
    v_cmp_eq_u32 s[56:57], s34, v25
    s_and_b64 vcc, vcc, s[56:57]
    s_cmp_eq_u64 vcc, -1
    s_nop 2
    s_cbranch_scc1 .gpd_117
    s_sub_u32 s35, s35, 1
    s_cbranch_scc1 .Lexit
    s_sleep 1
    s_branch .gp_116
.gpd_117:
    s_mov_b32 s56, 0x3f803f80
    v_dot2_f32_bf16 v104, v84, s56, 0
    v_dot2_f32_bf16 v105, v84, v84, 0
    v_dot2_f32_bf16 v104, v86, s56, v104
    v_dot2_f32_bf16 v105, v86, v86, v105
    v_dot2_f32_bf16 v104, v88, s56, v104
    v_dot2_f32_bf16 v105, v88, v88, v105
    v_dot2_f32_bf16 v104, v90, s56, v104
    s_branch .Lsk_m2_1
.Lst_m2_1:
    s_branch .Lrt_m2_1
.Lsk_m2_1:
    v_dot2_f32_bf16 v105, v90, v90, v105
    s_mov_b64 exec, 0xffffffff
    v_dot2_f32_bf16 v104, v92, s56, v104
    v_dot2_f32_bf16 v105, v92, v92, v105
    s_mov_b64 exec, -1
    s_nop 1
    v_permlane32_swap_b32 v104, v105
    v_add_f32 v104, v104, v105
    v_mov_b32 v106, v104
    s_nop 1
    v_permlane16_swap_b32 v106, v104
    v_add_f32 v104, v106, v104
    v_lshlrev_b32 v94, 16, v84
    v_and_b32 v95, 0xffff0000, v84
    v_add_f32_dpp v104, v104, v104 row_ror:8 row_mask:0xf bank_mask:0xf
    v_lshlrev_b32 v96, 16, v86
    v_and_b32 v97, 0xffff0000, v86
    v_add_f32_dpp v104, v104, v104 row_ror:4 row_mask:0xf bank_mask:0xf
    v_lshlrev_b32 v98, 16, v88
    v_and_b32 v99, 0xffff0000, v88
    v_add_f32_dpp v104, v104, v104 quad_perm:[2,3,0,1] row_mask:0xf bank_mask:0xf
    v_lshlrev_b32 v100, 16, v90
    v_and_b32 v101, 0xffff0000, v90
    v_add_f32_dpp v104, v104, v104 quad_perm:[1,0,3,2] row_mask:0xf bank_mask:0xf
    v_mul_f32 v104, 0x3ae38e39, v104
    v_lshlrev_b32 v102, 16, v92
    v_and_b32 v103, 0xffff0000, v92
    v_readlane_b32 s56, v104, 0
    v_readlane_b32 s57, v104, 32
    s_nop 0
    v_mov_b32 v104, s56
    v_fma_f32 v105, -v104, v104, s57
    v_max_f32 v105, 0, v105
    v_cvt_pk_bf16_f32 v106, -v104, v105
    v_and_b32 v107, 0xffff0000, v106
    v_add_f32 v107, 0x3727c5ac, v107
    v_lshlrev_b32 v104, 16, v106
    v_cvt_pk_bf16_f32 v107, v107, v107
    v_lshlrev_b32 v107, 16, v107
    v_sqrt_f32 v107, v107
    v_mov_b32 v105, v104
    v_cvt_pk_bf16_f32 v107, v107, v107
    v_lshlrev_b32 v107, 16, v107
    v_rcp_f32 v106, v107
    v_rcp_f32 v107, v107
    v_pk_add_f32 v[94:95], v[94:95], v[104:105]
    v_pk_add_f32 v[96:97], v[96:97], v[104:105]
    v_pk_add_f32 v[98:99], v[98:99], v[104:105]
    v_pk_add_f32 v[100:101], v[100:101], v[104:105]
    v_pk_add_f32 v[102:103], v[102:103], v[104:105]
    v_cvt_pk_bf16_f32 v94, v94, v95
    v_and_b32 v95, 0xffff0000, v94
    v_lshlrev_b32 v94, 16, v94
    v_cvt_pk_bf16_f32 v96, v96, v97
    v_and_b32 v97, 0xffff0000, v96
    v_lshlrev_b32 v96, 16, v96
    v_cvt_pk_bf16_f32 v98, v98, v99
    v_and_b32 v99, 0xffff0000, v98
    v_lshlrev_b32 v98, 16, v98
    v_cvt_pk_bf16_f32 v100, v100, v101
    v_and_b32 v101, 0xffff0000, v100
    v_lshlrev_b32 v100, 16, v100
    v_cvt_pk_bf16_f32 v102, v102, v103
    v_and_b32 v103, 0xffff0000, v102
    v_lshlrev_b32 v102, 16, v102
    v_pk_mul_f32 v[94:95], v[94:95], v[106:107]
    v_pk_mul_f32 v[96:97], v[96:97], v[106:107]
    v_pk_mul_f32 v[98:99], v[98:99], v[106:107]
    v_pk_mul_f32 v[100:101], v[100:101], v[106:107]
    v_pk_mul_f32 v[102:103], v[102:103], v[106:107]
    v_cvt_pk_bf16_f32 v94, v94, v95
    v_and_b32 v95, 0xffff0000, v94
    v_lshlrev_b32 v94, 16, v94
    v_cvt_pk_bf16_f32 v96, v96, v97
    v_and_b32 v97, 0xffff0000, v96
    v_lshlrev_b32 v96, 16, v96
    v_cvt_pk_bf16_f32 v98, v98, v99
    v_and_b32 v99, 0xffff0000, v98
    v_lshlrev_b32 v98, 16, v98
    v_cvt_pk_bf16_f32 v100, v100, v101
    v_and_b32 v101, 0xffff0000, v100
    v_lshlrev_b32 v100, 16, v100
    v_cvt_pk_bf16_f32 v102, v102, v103
    v_and_b32 v103, 0xffff0000, v102
    v_lshlrev_b32 v102, 16, v102
    v_pk_mul_f32 v[94:95], v[94:95], v[66:67]
    v_pk_mul_f32 v[96:97], v[96:97], v[68:69]
    v_pk_mul_f32 v[98:99], v[98:99], v[70:71]
    v_pk_mul_f32 v[100:101], v[100:101], v[72:73]
    v_pk_mul_f32 v[102:103], v[102:103], v[74:75]
    v_cvt_pk_bf16_f32 v94, v94, v95
    v_and_b32 v95, 0xffff0000, v94
    v_lshlrev_b32 v94, 16, v94
    v_cvt_pk_bf16_f32 v96, v96, v97
    v_and_b32 v97, 0xffff0000, v96
    v_lshlrev_b32 v96, 16, v96
    v_cvt_pk_bf16_f32 v98, v98, v99
    v_and_b32 v99, 0xffff0000, v98
    v_lshlrev_b32 v98, 16, v98
    v_cvt_pk_bf16_f32 v100, v100, v101
    v_and_b32 v101, 0xffff0000, v100
    v_lshlrev_b32 v100, 16, v100
    v_cvt_pk_bf16_f32 v102, v102, v103
    v_and_b32 v103, 0xffff0000, v102
    v_lshlrev_b32 v102, 16, v102
    v_pk_add_f32 v[94:95], v[94:95], v[56:57]
    v_pk_add_f32 v[96:97], v[96:97], v[58:59]
    v_pk_add_f32 v[98:99], v[98:99], v[60:61]
    v_pk_add_f32 v[100:101], v[100:101], v[62:63]
    v_pk_add_f32 v[102:103], v[102:103], v[64:65]
    v_cvt_pk_bf16_f32 v110, v94, v95
    v_cvt_pk_bf16_f32 v111, v96, v97
    v_cvt_pk_bf16_f32 v112, v98, v99
    v_cvt_pk_bf16_f32 v113, v100, v101
    v_cvt_pk_bf16_f32 v114, v102, v103
    v_dot2_f32_bf16 v14, v110, v48, 0
    v_dot2_f32_bf16 v14, v111, v49, v14
    v_dot2_f32_bf16 v14, v112, v50, v14
    v_dot2_f32_bf16 v14, v113, v51, v14
    s_mov_b64 exec, 0xffffffff
    v_dot2_f32_bf16 v14, v114, v34, v14
    s_mov_b64 exec, -1
    s_nop 1
    v_mov_b32 v15, v14
    s_nop 1
    v_permlane32_swap_b32 v15, v14
    v_add_f32 v14, v15, v14
    v_mov_b32 v15, v14
    s_nop 1
    v_permlane16_swap_b32 v15, v14
    v_add_f32 v14, v15, v14
    s_nop 1
    v_add_f32_dpp v14, v14, v14 row_ror:8 row_mask:0xf bank_mask:0xf
    s_nop 1
    v_add_f32_dpp v14, v14, v14 row_ror:4 row_mask:0xf bank_mask:0xf
    s_nop 1
    v_add_f32_dpp v14, v14, v14 quad_perm:[2,3,0,1] row_mask:0xf bank_mask:0xf
    s_nop 1
    v_add_f32_dpp v14, v14, v14 quad_perm:[1,0,3,2] row_mask:0xf bank_mask:0xf
    v_cvt_pk_bf16_f32 v14, v14, v14
    v_lshlrev_b32 v14, 16, v14
    v_max_f32 v14, 0xc2ae0000, v14
    v_min_f32 v14, 0x43000000, v14
    v_mul_f32 v15, 0xbfb8aa3b, v14
    v_fma_f32 v16, v14, s98, -v15
    v_fmac_f32 v16, 0xb2a57060, v14
    v_exp_f32 v15, v15
    v_mul_f32 v16, 0x3f317218, v16
    v_fmac_f32 v15, v15, v16
    v_add_f32 v15, 1.0, v15
    v_rcp_f32 v16, v15
    s_nop 0
    v_fma_f32 v15, -v15, v16, 1.0
    v_fma_f32 v14, v15, v16, v16
    v_cvt_pk_bf16_f32 v14, v14, v14
    v_lshlrev_b32 v14, 16, v14
    v_add_f32 v41, v40, v104
    v_cvt_pk_bf16_f32 v41, v41, v41
    v_lshlrev_b32 v41, 16, v41
    v_mul_f32 v41, v41, v106
    v_cvt_pk_bf16_f32 v41, v41, v41
    v_lshlrev_b32 v41, 16, v41
    v_mul_f32 v41, v41, v79
    v_cvt_pk_bf16_f32 v41, v41, v41
    v_lshlrev_b32 v41, 16, v41
    v_add_f32 v41, v41, v77
    v_cvt_pk_bf16_f32 v41, v41, v41
    v_lshlrev_b32 v41, 16, v41
    s_branch .Lsk_m2_2
.Lst_m2_2:
    s_branch .Lrt_m2_2
.Lsk_m2_2:
    s_and_b32 s62, s64, 1
    s_lshl1_add_u32 s58, s65, s62
    s_lshl3_add_u32 s58, s58, s3
    s_mul_i32 s58, s58, 9216
    s_add_u32 s58, s58, 0x1a0000
    s_add_u32 s59, s58, 4096
    s_add_u32 s63, s58, 8192
    s_cmp_eq_u32 s62, 0
    s_mov_b32 s56, 0x00ff00ff
    s_cselect_b32 s62, s56, 0xff00ff00
    s_mov_b32 s60, 0x04000c0c
    s_mov_b32 s61, 0x0706000c
    s_mov_b32 s48, s28
    s_and_b32 s49, s29, 0xffff
    s_mov_b32 s50, 0x2400
    s_mov_b32 s51, 0x00020000
.gp_118:
    buffer_load_dwordx4 v[120:123], v2, s[36:39], s58 offen offset:0 sc1
    buffer_load_dwordx4 v[124:127], v2, s[36:39], s58 offen offset:1024 sc1
    buffer_load_dwordx4 v[128:131], v2, s[36:39], s58 offen offset:2048 sc1
    buffer_load_dwordx4 v[132:135], v2, s[36:39], s58 offen offset:3072 sc1
    buffer_load_dwordx4 v[136:139], v2, s[36:39], s59 offen offset:0 sc1
    buffer_load_dwordx4 v[140:143], v2, s[36:39], s59 offen offset:1024 sc1
    buffer_load_dwordx4 v[144:147], v2, s[36:39], s59 offen offset:2048 sc1
    buffer_load_dwordx4 v[148:151], v2, s[36:39], s59 offen offset:3072 sc1
    buffer_load_dwordx4 v[152:155], v2, s[36:39], s63 offen offset:0 sc1
    s_waitcnt vmcnt(0)
.gpc_119:
    v_min3_u32 v24, v123, v127, v131
    v_max3_u32 v25, v123, v127, v131
    v_min3_u32 v24, v24, v135, v139
    v_max3_u32 v25, v25, v135, v139
    v_min3_u32 v24, v24, v143, v147
    v_max3_u32 v25, v25, v143, v147
    v_min3_u32 v24, v24, v151, v155
    v_max3_u32 v25, v25, v151, v155
    v_cmp_eq_u32 vcc, s34, v24
    v_cmp_eq_u32 s[56:57], s34, v25
    s_and_b64 vcc, vcc, s[56:57]
    s_cmp_eq_u64 vcc, -1
    s_nop 2
    s_cbranch_scc1 .gpd_120
    s_sub_u32 s35, s35, 1
    s_cbranch_scc1 .Lexit
    s_branch .gp_118
.gpd_120:
    v_perm_b32 v123, v120, v121, s60
    v_perm_b32 v123, v123, v122, s61
    v_perm_b32 v127, v124, v125, s60
    v_perm_b32 v127, v127, v126, s61
    v_perm_b32 v131, v128, v129, s60
    v_perm_b32 v131, v131, v130, s61
    v_perm_b32 v135, v132, v133, s60
    v_perm_b32 v135, v135, v134, s61
    v_perm_b32 v139, v136, v137, s60
    v_perm_b32 v139, v139, v138, s61
    v_perm_b32 v143, v140, v141, s60
    v_perm_b32 v143, v143, v142, s61
    v_perm_b32 v147, v144, v145, s60
    v_perm_b32 v147, v147, v146, s61
    v_perm_b32 v151, v148, v149, s60
    v_perm_b32 v151, v151, v150, s61
    v_perm_b32 v155, v152, v153, s60
    v_perm_b32 v155, v155, v154, s61
    v_pk_add_f32 v[120:121], v[120:121], v[124:125]
    v_pk_add_f32 v[122:123], v[122:123], v[126:127]
    v_pk_add_f32 v[128:129], v[128:129], v[132:133]
    v_pk_add_f32 v[130:131], v[130:131], v[134:135]
    v_pk_add_f32 v[136:137], v[136:137], v[140:141]
    v_pk_add_f32 v[138:139], v[138:139], v[142:143]
    v_pk_add_f32 v[144:145], v[144:145], v[148:149]
    v_pk_add_f32 v[146:147], v[146:147], v[150:151]
    v_pk_add_f32 v[120:121], v[120:121], v[128:129]
    v_pk_add_f32 v[122:123], v[122:123], v[130:131]
    v_pk_add_f32 v[136:137], v[136:137], v[144:145]
    v_pk_add_f32 v[138:139], v[138:139], v[146:147]
    v_pk_add_f32 v[120:121], v[120:121], v[136:137]
    v_pk_add_f32 v[122:123], v[122:123], v[138:139]
    v_pk_add_f32 v[120:121], v[120:121], v[152:153]
    v_pk_add_f32 v[122:123], v[122:123], v[154:155]
    s_nop 1
    v_permlane32_swap_b32 v120, v122
    v_permlane32_swap_b32 v121, v123
    v_pk_add_f32 v[120:121], v[120:121], v[122:123]
    s_nop 1
    v_permlane16_swap_b32 v120, v121
    v_add_f32 v120, v120, v121
    s_nop 1
    v_add_f32_dpp v120, v120, v120 row_ror:8 row_mask:0xf bank_mask:0xf
    v_cvt_pk_bf16_f32 v120, v120, v120
    v_lshlrev_b32 v120, 16, v120
    v_mul_f32 v120, v120, v14
    v_cvt_pk_bf16_f32 v120, v120, v120
    v_lshlrev_b32 v120, 16, v120
    v_add_f32 v120, v120, v41
    v_cvt_pk_bf16_f32 v120, v120, v120
    v_lshlrev_b32 v120, 16, v120
    v_mul_f32 v120, v120, v81
    v_cvt_pk_bf16_f32 v120, v120, v120
    v_lshlrev_b32 v120, 16, v120
    v_add_f32 v120, v120, v40
    v_cvt_pk_bf16_f32 v120, v120, v120
    s_mov_b32 exec_lo, s62
    s_mov_b32 exec_hi, s62
    buffer_store_short v120, v7, s[48:51], s100 offen
    s_mov_b64 exec, -1
    s_or_b32 s56, s2, s3
    s_cmp_lg_u32 s56, 0
    s_cbranch_scc1 .Lexit
    v_mov_b32 v13, s34
    v_mov_b32 v12, 0
    s_mov_b64 exec, 1
    buffer_store_dword v13, v12, s[36:39], 0 offen
    s_mov_b64 exec, -1
    s_branch .Lexit
.Lbc:
    s_branch .Lsk_b0_0
.Lst_b0_0:
    s_branch .Lrt_b0_0
.Lsk_b0_0:
    s_sub_u32 s56, s65, 9
    s_mov_b32 s57, 0x63054210
    s_cmp_eq_u32 s65, 14
    s_cselect_b32 s56, s64, s56
    s_cselect_b32 s57, 0x37654210, s57
    s_cselect_b32 s99, 8, s64
    s_lshl_b32 s56, s56, 2
    s_lshr_b32 s56, s57, s56
    s_and_b32 s56, s56, 7
    s_cmp_eq_u32 s65, 17
    s_cselect_b32 s56, 7, s56
    s_lshl3_add_u32 s99, s99, s56
    s_and_b32 s56, s99, 7
    s_cmp_eq_u32 s56, 3
    s_mov_b32 s14, 0xb5b5b5b5
    s_cselect_b32 s14, 0x0, s14
    s_mov_b32 s15, 0xd6d6b6b6
    s_cselect_b32 s15, 0x0, s15
    s_cselect_b32 s30, -50, 0
    s_add_u32 s30, s30, 0
    s_add_u32 s30, s30, s70
    s_mov_b32 s31, s70
    s_mov_b32 s48, s18
    s_and_b32 s49, s19, 0xffff
    s_mov_b32 s50, 0x510000
    s_mov_b32 s51, 0x00020000
    s_mov_b32 s52, s20
    s_and_b32 s53, s21, 0xffff
    s_mov_b32 s54, 0x510000
    s_mov_b32 s55, 0x00020000
    v_bfe_u32 v12, v0, 4, 1
    s_and_b32 s56, s3, 3
    s_lshl_b32 s56, s56, 1
    v_or_b32 v12, s56, v12
    v_and_b32 v6, 7, v0
    v_xor_b32 v12, v12, v6
    v_lshrrev_b32 v6, 3, v0
    v_mul_u32_u24 v6, 9216, v6
    v_lshl_add_u32 v6, v12, 4, v6
    s_mul_i32 s100, s3, 73728
    s_lshl_b32 s56, s99, 7
    s_add_u32 s100, s100, s56
    s_lshl_b32 s101, s3, 10
    s_waitcnt lgkmcnt(0)
    s_add_u32 s34, s34, 1
    s_getreg_b32 s1, hwreg(HW_REG_XCC_ID)
    s_lshl_b32 s1, s1, 24
    s_add_u32 s1, s1, s34
    s_lshr_b32 s0, s2, 3
    s_lshl_b32 s63, s64, 8
    s_add_u32 s0, s0, s63
    s_lshl2_add_u32 s0, s0, 0x480000
    v_mov_b32 v30, s1
    s_cmp_eq_u32 s3, 0
    s_cselect_b64 exec, 1, 0
    buffer_store_dword v30, v2, s[36:39], s0 offen sc1
    s_mov_b64 exec, -1
    v_and_b32 v8, 1, v0
    v_lshlrev_b32 v8, 8, v8
    v_and_b32 v9, 0x3c, v0
    v_lshl_add_u32 v9, v9, 2, v8
    v_add_u32 v7, v9, v8
    v_and_b32 v9, 0x3c, v0
    v_lshrrev_b32 v8, 4, v8
    v_and_b32 v9, 4, v0
    v_lshl_add_u32 v9, v9, 3, v8
    s_lshl_b32 s58, s66, 14
    s_lshl_b32 s59, s67, 10
    s_add_u32 s58, s58, s59
    s_add_u32 s58, s58, 0x70000
    s_lshl4_add_u32 s59, s66, s67
    s_lshl_b32 s59, s59, 7
    s_add_u32 s59, s59, 0x430000
    s_bitcmp1_b64 s[14:15], 4
    s_cbranch_scc0 1
    s_waitcnt vmcnt(4)
    s_add_u32 s63, s69, 32768
    buffer_load_dwordx4 v[96:99], v1, s[40:43], s63 offen nt
    s_waitcnt vmcnt(6)
    s_add_u32 m0, s101, 0
    s_add_u32 s56, s100, 0
    buffer_load_dwordx4 v6, s[48:51], s56 offen nt lds
    s_waitcnt vmcnt(6)
    s_bitcmp1_b64 s[14:15], 5
    s_cbranch_scc0 1
    s_waitcnt vmcnt(4)
    s_add_u32 s63, s69, 40960
    buffer_load_dwordx4 v[100:103], v1, s[40:43], s63 offen nt
    s_waitcnt vmcnt(6)
    s_bitcmp1_b64 s[14:15], 6
    s_cbranch_scc0 1
    s_waitcnt vmcnt(2)
    s_add_u32 s63, s69, 49152
    buffer_load_dwordx4 v[128:131], v1, s[40:43], s63 offen nt
    s_cmp_eq_u32 s3, 0
    s_cbranch_scc1 .Lst_b1_0
    s_cmp_eq_u32 s3, 1
    s_cbranch_scc1 .Lst_b1_1
    s_cmp_eq_u32 s3, 2
    s_cbranch_scc1 .Lst_b1_2
    s_cmp_eq_u32 s3, 3
    s_cbranch_scc1 .Lst_b1_3
    s_cmp_eq_u32 s3, 4
    s_cbranch_scc1 .Lst_b1_4
    s_cmp_eq_u32 s3, 5
    s_cbranch_scc1 .Lst_b1_5
    s_cmp_eq_u32 s3, 6
    s_cbranch_scc1 .Lst_b1_6
    s_cmp_eq_u32 s3, 7
    s_cbranch_scc1 .Lst_b1_7
.Lrt_b1_0:
.Lrt_b1_1:
.Lrt_b1_2:
.Lrt_b1_3:
.Lrt_b1_4:
.Lrt_b1_5:
.Lrt_b1_6:
.Lrt_b1_7:
    s_waitcnt vmcnt(6)
    s_add_u32 m0, s101, 8192
    s_add_u32 s56, s100, 589824
    buffer_load_dwordx4 v6, s[48:51], s56 offen nt lds
    s_waitcnt vmcnt(4)
    s_bitcmp1_b64 s[14:15], 7
    s_cbranch_scc0 1
    s_waitcnt vmcnt(2)
    s_add_u32 s63, s69, 57344
    buffer_load_dwordx4 v[132:135], v1, s[40:43], s63 offen nt
    s_waitcnt vmcnt(4)
    s_bitcmp1_b64 s[14:15], 8
    s_cbranch_scc0 1
    s_waitcnt vmcnt(2)
    s_add_u32 s63, s69, 131072
    buffer_load_dwordx4 v[40:43], v1, s[40:43], s63 offen nt
    s_memrealtime s[8:9]
    s_waitcnt lgkmcnt(0)
    s_sub_u32 s8, s8, s30
    s_cmpk_ge_u32 s8, 437
    s_cbranch_scc1 .ap_121
    s_waitcnt vmcnt(5)
    s_cmpk_ge_u32 s8, 337
    s_cbranch_scc1 .ap_121
    s_waitcnt vmcnt(4)
    s_bitcmp1_b64 s[14:15], 9
    s_cbranch_scc0 1
    s_waitcnt vmcnt(2)
    s_cmpk_ge_u32 s8, 217
    s_cbranch_scc1 .ap_121
    s_waitcnt vmcnt(1)
.ap_121:
    s_add_u32 s63, s69, 139264
    buffer_load_dwordx4 v[44:47], v1, s[40:43], s63 offen nt
    s_memrealtime s[8:9]
    s_waitcnt lgkmcnt(0)
    s_sub_u32 s8, s8, s30
    s_cmpk_ge_u32 s8, 471
    s_cbranch_scc1 .ap_122
    s_waitcnt vmcnt(5)
    s_cmpk_ge_u32 s8, 371
    s_cbranch_scc1 .ap_122
    s_waitcnt vmcnt(4)
    s_bitcmp1_b64 s[14:15], 10
    s_cbranch_scc0 1
    s_waitcnt vmcnt(2)
    s_cmpk_ge_u32 s8, 251
    s_cbranch_scc1 .ap_122
    s_waitcnt vmcnt(1)
.ap_122:
    s_add_u32 s63, s69, 147456
    buffer_load_dwordx4 v[72:75], v1, s[40:43], s63 offen nt
    s_memrealtime s[8:9]
    s_waitcnt lgkmcnt(0)
    s_sub_u32 s8, s8, s30
    s_cmpk_ge_u32 s8, 505
    s_cbranch_scc1 .ap_123
    s_waitcnt vmcnt(5)
    s_cmpk_ge_u32 s8, 405
    s_cbranch_scc1 .ap_123
    s_waitcnt vmcnt(4)
    s_cmpk_ge_u32 s8, 285
    s_cbranch_scc1 .ap_123
    s_waitcnt vmcnt(1)
.ap_123:
    s_add_u32 m0, s101, 16384
    s_add_u32 s56, s100, 1179648
    buffer_load_dwordx4 v6, s[48:51], s56 offen nt lds
    s_memrealtime s[8:9]
    s_waitcnt lgkmcnt(0)
    s_sub_u32 s8, s8, s30
    s_cmpk_ge_u32 s8, 505
    s_cbranch_scc1 .ap_124
    s_waitcnt vmcnt(5)
    s_cmpk_ge_u32 s8, 405
    s_cbranch_scc1 .ap_124
    s_waitcnt vmcnt(4)
    s_bitcmp1_b64 s[14:15], 11
    s_cbranch_scc0 1
    s_waitcnt vmcnt(2)
    s_cmpk_ge_u32 s8, 285
    s_cbranch_scc1 .ap_124
    s_waitcnt vmcnt(1)
.ap_124:
    s_add_u32 s63, s69, 155648
    buffer_load_dwordx4 v[76:79], v1, s[40:43], s63 offen nt
    s_memrealtime s[8:9]
    s_waitcnt vmcnt(8)
    s_waitcnt lgkmcnt(0)
    s_sub_u32 s8, s8, s30
    s_cmpk_ge_u32 s8, 539
    s_cbranch_scc1 .ap_125
    s_waitcnt vmcnt(5)
    s_cmpk_ge_u32 s8, 439
    s_cbranch_scc1 .ap_125
    s_waitcnt vmcnt(4)
    s_bitcmp1_b64 s[14:15], 12
    s_cbranch_scc0 1
    s_waitcnt vmcnt(2)
    s_cmpk_ge_u32 s8, 319
    s_cbranch_scc1 .ap_125
    s_waitcnt vmcnt(1)
.ap_125:
    s_add_u32 s63, s69, 163840
    buffer_load_dwordx4 v[104:107], v1, s[40:43], s63 offen nt
    s_branch .Lsk_b0_1
.Lst_b0_1:
    s_branch .Lrt_b0_1
.Lsk_b0_1:
    v_and_b32 v157, 7, v0
    v_lshlrev_b32 v157, 2, v157
    s_mov_b32 s63, 0x4a1100
    buffer_load_dword v156, v157, s[36:39], s63 offen
    s_memrealtime s[8:9]
    s_waitcnt vmcnt(9)
    s_waitcnt lgkmcnt(0)
    s_sub_u32 s8, s8, s30
    s_cmpk_ge_u32 s8, 573
    s_cbranch_scc1 .ap_126
    s_waitcnt vmcnt(6)
    s_cmpk_ge_u32 s8, 473
    s_cbranch_scc1 .ap_126
    s_waitcnt vmcnt(5)
    s_bitcmp1_b64 s[14:15], 13
    s_cbranch_scc0 1
    s_waitcnt vmcnt(3)
    s_cmpk_ge_u32 s8, 353
    s_cbranch_scc1 .ap_126
    s_waitcnt vmcnt(2)
.ap_126:
    s_add_u32 s63, s69, 172032
    buffer_load_dwordx4 v[108:111], v1, s[40:43], s63 offen nt
    s_memrealtime s[8:9]
    s_waitcnt vmcnt(9)
    s_waitcnt lgkmcnt(0)
    s_sub_u32 s8, s8, s30
    s_cmpk_ge_u32 s8, 607
    s_cbranch_scc1 .ap_127
    s_waitcnt vmcnt(6)
    s_cmpk_ge_u32 s8, 507
    s_cbranch_scc1 .ap_127
    s_waitcnt vmcnt(5)
    s_bitcmp1_b64 s[14:15], 14
    s_cbranch_scc0 1
    s_waitcnt vmcnt(3)
    s_cmpk_ge_u32 s8, 387
    s_cbranch_scc1 .ap_127
    s_waitcnt vmcnt(2)
.ap_127:
    s_add_u32 s63, s69, 180224
    buffer_load_dwordx4 v[136:139], v1, s[40:43], s63 offen nt
    s_memrealtime s[8:9]
    s_waitcnt vmcnt(9)
    s_waitcnt lgkmcnt(0)
    s_sub_u32 s8, s8, s30
    s_cmpk_ge_u32 s8, 641
    s_cbranch_scc1 .ap_128
    s_waitcnt vmcnt(6)
    s_cmpk_ge_u32 s8, 541
    s_cbranch_scc1 .ap_128
    s_waitcnt vmcnt(5)
    s_cmpk_ge_u32 s8, 421
    s_cbranch_scc1 .ap_128
    s_waitcnt vmcnt(1)
.ap_128:
    s_add_u32 m0, s101, 24576
    s_add_u32 s56, s100, 1769472
    buffer_load_dwordx4 v6, s[48:51], s56 offen nt lds
    s_memrealtime s[8:9]
    s_waitcnt vmcnt(9)
    s_waitcnt lgkmcnt(0)
    s_sub_u32 s8, s8, s30
    s_cmpk_ge_u32 s8, 641
    s_cbranch_scc1 .ap_129
    s_waitcnt vmcnt(6)
    s_cmpk_ge_u32 s8, 541
    s_cbranch_scc1 .ap_129
    s_waitcnt vmcnt(5)
    s_bitcmp1_b64 s[14:15], 15
    s_cbranch_scc0 1
    s_waitcnt vmcnt(2)
    s_cmpk_ge_u32 s8, 421
    s_cbranch_scc1 .ap_129
    s_waitcnt vmcnt(1)
.ap_129:
    s_add_u32 s63, s69, 188416
    buffer_load_dwordx4 v[140:143], v1, s[40:43], s63 offen nt
    s_memrealtime s[8:9]
    s_waitcnt vmcnt(9)
    s_waitcnt lgkmcnt(0)
    s_sub_u32 s8, s8, s30
    s_cmpk_ge_u32 s8, 675
    s_cbranch_scc1 .ap_130
    s_waitcnt vmcnt(6)
    s_cmpk_ge_u32 s8, 575
    s_cbranch_scc1 .ap_130
    s_waitcnt vmcnt(5)
    s_bitcmp1_b64 s[14:15], 16
    s_cbranch_scc0 1
    s_waitcnt vmcnt(2)
    s_cmpk_ge_u32 s8, 455
    s_cbranch_scc1 .ap_130
    s_waitcnt vmcnt(1)
.ap_130:
    s_add_u32 s63, s69, 262144
    buffer_load_dwordx4 v[48:51], v1, s[40:43], s63 offen nt
    s_waitcnt vmcnt(5)
    s_sub_u32 s63, s70, 300
    v_subrev_u32 v156, s63, v156
    v_mov_b32 v157, 600
    v_cmp_lt_u32 s[8:9], v156, v157
    v_add_u32_dpp v156, v156, v156 quad_perm:[1,0,3,2] row_mask:0xf bank_mask:0xf
    s_nop 1
    v_add_u32_dpp v156, v156, v156 quad_perm:[2,3,0,1] row_mask:0xf bank_mask:0xf
    s_nop 1
    v_add_u32_dpp v156, v156, v156 row_ror:4 row_mask:0xf bank_mask:0xf
    s_nop 0
    v_readfirstlane_b32 s63, v156
    s_cmp_eq_u64 s[8:9], -1
    s_nop 3
    s_cbranch_scc0 .et_131
    s_lshr_b32 s63, s63, 3
    s_sub_u32 s63, s63, 300
    s_add_u32 s30, s30, s63
    s_add_u32 s31, s31, s63
.et_131:
    s_memrealtime s[8:9]
    s_waitcnt lgkmcnt(0)
    s_sub_u32 s8, s8, s30
    s_cmpk_ge_u32 s8, 709
    s_cbranch_scc1 .ap_132
    s_waitcnt vmcnt(5)
    s_cmpk_ge_u32 s8, 609
    s_cbranch_scc1 .ap_132
    s_waitcnt vmcnt(4)
    s_bitcmp1_b64 s[14:15], 17
    s_cbranch_scc0 1
    s_waitcnt vmcnt(2)
    s_cmpk_ge_u32 s8, 489
    s_cbranch_scc1 .ap_132
    s_waitcnt vmcnt(1)
.ap_132:
    s_add_u32 s63, s69, 270336
    buffer_load_dwordx4 v[52:55], v1, s[40:43], s63 offen nt
    s_memrealtime s[8:9]
    s_waitcnt lgkmcnt(0)
    s_sub_u32 s8, s8, s30
    s_cmpk_ge_u32 s8, 744
    s_cbranch_scc1 .ap_133
    s_waitcnt vmcnt(5)
    s_cmpk_ge_u32 s8, 644
    s_cbranch_scc1 .ap_133
    s_waitcnt vmcnt(4)
    s_bitcmp1_b64 s[14:15], 18
    s_cbranch_scc0 1
    s_waitcnt vmcnt(2)
    s_cmpk_ge_u32 s8, 524
    s_cbranch_scc1 .ap_133
    s_waitcnt vmcnt(1)
.ap_133:
    s_add_u32 s63, s69, 278528
    buffer_load_dwordx4 v[80:83], v1, s[40:43], s63 offen nt
    s_memrealtime s[8:9]
    s_waitcnt lgkmcnt(0)
    s_sub_u32 s8, s8, s30
    s_cmpk_ge_u32 s8, 779
    s_cbranch_scc1 .ap_134
    s_waitcnt vmcnt(5)
    s_cmpk_ge_u32 s8, 679
    s_cbranch_scc1 .ap_134
    s_waitcnt vmcnt(4)
    s_cmpk_ge_u32 s8, 559
    s_cbranch_scc1 .ap_134
    s_waitcnt vmcnt(1)
.ap_134:
    s_add_u32 m0, s101, 32768
    s_add_u32 s56, s100, 2359296
    buffer_load_dwordx4 v6, s[48:51], s56 offen nt lds
    s_memrealtime s[8:9]
    s_waitcnt lgkmcnt(0)
    s_sub_u32 s8, s8, s30
    s_cmpk_ge_u32 s8, 779
    s_cbranch_scc1 .ap_135
    s_waitcnt vmcnt(5)
    s_cmpk_ge_u32 s8, 679
    s_cbranch_scc1 .ap_135
    s_waitcnt vmcnt(4)
    s_bitcmp1_b64 s[14:15], 19
    s_cbranch_scc0 1
    s_waitcnt vmcnt(2)
    s_cmpk_ge_u32 s8, 559
    s_cbranch_scc1 .ap_135
    s_waitcnt vmcnt(1)
.ap_135:
    s_add_u32 s63, s69, 286720
    buffer_load_dwordx4 v[84:87], v1, s[40:43], s63 offen nt
    s_memrealtime s[8:9]
    s_waitcnt vmcnt(8)
    s_waitcnt lgkmcnt(0)
    s_sub_u32 s8, s8, s30
    s_cmpk_ge_u32 s8, 814
    s_cbranch_scc1 .ap_136
    s_waitcnt vmcnt(5)
    s_cmpk_ge_u32 s8, 714
    s_cbranch_scc1 .ap_136
    s_waitcnt vmcnt(4)
    s_bitcmp1_b64 s[14:15], 20
    s_cbranch_scc0 1
    s_waitcnt vmcnt(2)
    s_cmpk_ge_u32 s8, 594
    s_cbranch_scc1 .ap_136
    s_waitcnt vmcnt(1)
.ap_136:
    s_add_u32 s63, s69, 294912
    buffer_load_dwordx4 v[112:115], v1, s[40:43], s63 offen nt
    s_memrealtime s[8:9]
    s_waitcnt vmcnt(8)
    s_waitcnt lgkmcnt(0)
    s_sub_u32 s8, s8, s30
    s_cmpk_ge_u32 s8, 849
    s_cbranch_scc1 .ap_137
    s_waitcnt vmcnt(5)
    s_cmpk_ge_u32 s8, 749
    s_cbranch_scc1 .ap_137
    s_waitcnt vmcnt(4)
    s_bitcmp1_b64 s[14:15], 21
    s_cbranch_scc0 1
    s_waitcnt vmcnt(2)
    s_cmpk_ge_u32 s8, 629
    s_cbranch_scc1 .ap_137
    s_waitcnt vmcnt(1)
.ap_137:
    s_add_u32 s63, s69, 303104
    buffer_load_dwordx4 v[116:119], v1, s[40:43], s63 offen nt
    s_memrealtime s[8:9]
    s_waitcnt vmcnt(8)
    s_waitcnt lgkmcnt(0)
    s_sub_u32 s8, s8, s30
    s_cmpk_ge_u32 s8, 884
    s_cbranch_scc1 .ap_138
    s_waitcnt vmcnt(5)
    s_cmpk_ge_u32 s8, 784
    s_cbranch_scc1 .ap_138
    s_waitcnt vmcnt(4)
    s_bitcmp1_b64 s[14:15], 22
    s_branch .Lsk_b0_2
.Lst_b0_2:
    s_branch .Lrt_b0_2
.Lsk_b0_2:
    s_cbranch_scc0 1
    s_waitcnt vmcnt(2)
    s_cmpk_ge_u32 s8, 664
    s_cbranch_scc1 .ap_138
    s_waitcnt vmcnt(1)
.ap_138:
    s_add_u32 s63, s69, 311296
    buffer_load_dwordx4 v[144:147], v1, s[40:43], s63 offen nt
    s_memrealtime s[8:9]
    s_waitcnt vmcnt(8)
    s_waitcnt lgkmcnt(0)
    s_sub_u32 s8, s8, s30
    s_cmpk_ge_u32 s8, 919
    s_cbranch_scc1 .ap_139
    s_waitcnt vmcnt(5)
    s_cmpk_ge_u32 s8, 819
    s_cbranch_scc1 .ap_139
    s_waitcnt vmcnt(4)
    s_cmpk_ge_u32 s8, 699
    s_cbranch_scc1 .ap_139
    s_waitcnt vmcnt(1)
.ap_139:
    s_add_u32 m0, s101, 40960
    s_add_u32 s56, s100, 2949120
    buffer_load_dwordx4 v6, s[48:51], s56 offen nt lds
    s_memrealtime s[8:9]
    s_branch .Lsk_b0_3
.Lst_b0_3:
    s_branch .Lrt_b0_3
.Lsk_b0_3:
    s_waitcnt vmcnt(8)
    s_waitcnt lgkmcnt(0)
    s_sub_u32 s8, s8, s30
    s_cmpk_ge_u32 s8, 919
    s_cbranch_scc1 .ap_140
    s_waitcnt vmcnt(5)
    s_cmpk_ge_u32 s8, 819
    s_cbranch_scc1 .ap_140
    s_waitcnt vmcnt(4)
    s_bitcmp1_b64 s[14:15], 23
    s_cbranch_scc0 1
    s_waitcnt vmcnt(2)
    s_cmpk_ge_u32 s8, 699
    s_cbranch_scc1 .ap_140
    s_waitcnt vmcnt(1)
.ap_140:
    s_add_u32 s63, s69, 319488
    buffer_load_dwordx4 v[148:151], v1, s[40:43], s63 offen nt
    s_memrealtime s[8:9]
    s_waitcnt vmcnt(8)
    s_waitcnt lgkmcnt(0)
    s_sub_u32 s8, s8, s30
    s_cmpk_ge_u32 s8, 954
    s_cbranch_scc1 .ap_141
    s_waitcnt vmcnt(5)
    s_cmpk_ge_u32 s8, 854
    s_cbranch_scc1 .ap_141
    s_waitcnt vmcnt(4)
    s_bitcmp1_b64 s[14:15], 24
    s_cbranch_scc0 1
    s_waitcnt vmcnt(2)
    s_cmpk_ge_u32 s8, 734
    s_cbranch_scc1 .ap_141
    s_waitcnt vmcnt(1)
.ap_141:
    s_add_u32 s63, s69, 393216
    buffer_load_dwordx4 v[56:59], v1, s[40:43], s63 offen nt
    s_memrealtime s[8:9]
    s_waitcnt vmcnt(8)
    s_waitcnt lgkmcnt(0)
    s_sub_u32 s8, s8, s30
    s_cmpk_ge_u32 s8, 990
    s_cbranch_scc1 .ap_142
    s_waitcnt vmcnt(5)
    s_cmpk_ge_u32 s8, 890
    s_cbranch_scc1 .ap_142
    s_waitcnt vmcnt(4)
    s_bitcmp1_b64 s[14:15], 25
    s_cbranch_scc0 1
    s_waitcnt vmcnt(2)
    s_cmpk_ge_u32 s8, 770
    s_cbranch_scc1 .ap_142
    s_waitcnt vmcnt(1)
.ap_142:
    s_add_u32 s63, s69, 401408
    buffer_load_dwordx4 v[60:63], v1, s[40:43], s63 offen nt
    s_memrealtime s[8:9]
    s_waitcnt vmcnt(8)
    s_waitcnt lgkmcnt(0)
    s_sub_u32 s8, s8, s30
    s_cmpk_ge_u32 s8, 1028
    s_cbranch_scc1 .ap_143
    s_waitcnt vmcnt(5)
    s_cmpk_ge_u32 s8, 928
    s_cbranch_scc1 .ap_143
    s_waitcnt vmcnt(4)
    s_bitcmp1_b64 s[14:15], 26
    s_cbranch_scc0 1
    s_waitcnt vmcnt(2)
    s_cmpk_ge_u32 s8, 808
    s_cbranch_scc1 .ap_143
    s_waitcnt vmcnt(1)
.ap_143:
    s_add_u32 s63, s69, 409600
    buffer_load_dwordx4 v[88:91], v1, s[40:43], s63 offen nt
    s_memrealtime s[8:9]
    s_waitcnt vmcnt(8)
    s_waitcnt lgkmcnt(0)
    s_sub_u32 s8, s8, s30
    s_cmpk_ge_u32 s8, 1067
    s_cbranch_scc1 .ap_144
    s_waitcnt vmcnt(5)
    s_cmpk_ge_u32 s8, 967
    s_cbranch_scc1 .ap_144
    s_waitcnt vmcnt(4)
    s_cmpk_ge_u32 s8, 847
    s_cbranch_scc1 .ap_144
    s_waitcnt vmcnt(1)
.ap_144:
    s_add_u32 m0, s101, 49152
    s_add_u32 s56, s100, 3538944
    buffer_load_dwordx4 v6, s[48:51], s56 offen nt lds
    s_memrealtime s[8:9]
    s_waitcnt vmcnt(8)
    s_waitcnt lgkmcnt(0)
    s_sub_u32 s8, s8, s30
    s_cmpk_ge_u32 s8, 1067
    s_cbranch_scc1 .ap_145
    s_waitcnt vmcnt(5)
    s_cmpk_ge_u32 s8, 967
    s_cbranch_scc1 .ap_145
    s_waitcnt vmcnt(4)
    s_bitcmp1_b64 s[14:15], 27
    s_cbranch_scc0 1
    s_waitcnt vmcnt(2)
    s_cmpk_ge_u32 s8, 847
    s_cbranch_scc1 .ap_145
    s_waitcnt vmcnt(1)
.ap_145:
    s_add_u32 s63, s69, 417792
    buffer_load_dwordx4 v[92:95], v1, s[40:43], s63 offen nt
    s_memrealtime s[8:9]
    s_waitcnt vmcnt(8)
    s_waitcnt lgkmcnt(0)
    s_sub_u32 s8, s8, s30
    s_cmpk_ge_u32 s8, 1106
    s_cbranch_scc1 .ap_146
    s_waitcnt vmcnt(5)
    s_cmpk_ge_u32 s8, 1006
    s_cbranch_scc1 .ap_146
    s_waitcnt vmcnt(4)
    s_bitcmp1_b64 s[14:15], 28
    s_cbranch_scc0 1
    s_waitcnt vmcnt(2)
    s_cmpk_ge_u32 s8, 886
    s_cbranch_scc1 .ap_146
    s_waitcnt vmcnt(1)
.ap_146:
    s_add_u32 s63, s69, 425984
    buffer_load_dwordx4 v[120:123], v1, s[40:43], s63 offen nt
    s_memrealtime s[8:9]
    s_waitcnt vmcnt(8)
    s_waitcnt lgkmcnt(0)
    s_sub_u32 s8, s8, s30
    s_cmpk_ge_u32 s8, 1145
    s_cbranch_scc1 .ap_147
    s_waitcnt vmcnt(5)
    s_cmpk_ge_u32 s8, 1045
    s_cbranch_scc1 .ap_147
    s_waitcnt vmcnt(4)
    s_bitcmp1_b64 s[14:15], 29
    s_cbranch_scc0 1
    s_waitcnt vmcnt(2)
    s_cmpk_ge_u32 s8, 925
    s_cbranch_scc1 .ap_147
    s_waitcnt vmcnt(1)
.ap_147:
    s_add_u32 s63, s69, 434176
    buffer_load_dwordx4 v[124:127], v1, s[40:43], s63 offen nt
    s_memrealtime s[8:9]
    s_waitcnt vmcnt(8)
    s_waitcnt lgkmcnt(0)
    s_sub_u32 s8, s8, s30
    s_cmpk_ge_u32 s8, 1184
    s_cbranch_scc1 .ap_148
    s_waitcnt vmcnt(5)
    s_cmpk_ge_u32 s8, 1084
    s_cbranch_scc1 .ap_148
    s_waitcnt vmcnt(4)
    s_bitcmp1_b64 s[14:15], 30
    s_cbranch_scc0 1
    s_waitcnt vmcnt(2)
    s_cmpk_ge_u32 s8, 964
    s_cbranch_scc1 .ap_148
    s_waitcnt vmcnt(1)
.ap_148:
    s_add_u32 s63, s69, 442368
    buffer_load_dwordx4 v[152:155], v1, s[40:43], s63 offen nt
    s_memrealtime s[8:9]
    s_waitcnt vmcnt(8)
    s_waitcnt lgkmcnt(0)
    s_sub_u32 s8, s8, s30
    s_cmpk_ge_u32 s8, 1223
    s_cbranch_scc1 .ap_149
    s_waitcnt vmcnt(5)
    s_cmpk_ge_u32 s8, 1123
    s_cbranch_scc1 .ap_149
    s_waitcnt vmcnt(4)
    s_cmpk_ge_u32 s8, 1003
    s_cbranch_scc1 .ap_149
    s_waitcnt vmcnt(1)
.ap_149:
    s_add_u32 m0, s101, 57344
    s_add_u32 s56, s100, 4128768
    buffer_load_dwordx4 v6, s[48:51], s56 offen nt lds
    s_memrealtime s[8:9]
    s_waitcnt vmcnt(8)
    s_waitcnt lgkmcnt(0)
    s_sub_u32 s8, s8, s30
    s_cmpk_ge_u32 s8, 1223
    s_cbranch_scc1 .ap_150
    s_waitcnt vmcnt(5)
    s_cmpk_ge_u32 s8, 1123
    s_cbranch_scc1 .ap_150
    s_waitcnt vmcnt(4)
    s_bitcmp1_b64 s[14:15], 31
    s_cbranch_scc0 1
    s_waitcnt vmcnt(2)
    s_cmpk_ge_u32 s8, 1003
    s_cbranch_scc1 .ap_150
    s_waitcnt vmcnt(1)
.ap_150:
    s_add_u32 s63, s69, 450560
    buffer_load_dwordx4 v[156:159], v1, s[40:43], s63 offen nt
    s_memrealtime s[8:9]
    s_waitcnt vmcnt(8)
    s_waitcnt lgkmcnt(0)
    s_sub_u32 s8, s8, s30
    s_cmpk_ge_u32 s8, 1262
    s_cbranch_scc1 .ap_151
    s_waitcnt vmcnt(5)
    s_cmpk_ge_u32 s8, 1162
    s_cbranch_scc1 .ap_151
    s_waitcnt vmcnt(4)
    s_bitcmp1_b64 s[14:15], 32
    s_cbranch_scc0 1
    s_waitcnt vmcnt(2)
    s_cmpk_ge_u32 s8, 1042
    s_cbranch_scc1 .ap_151
    s_waitcnt vmcnt(1)
.ap_151:
    v_bfe_u32 v1, v0, 4, 2
    v_and_b32 v10, 0xf0, v2
    v_lshlrev_b32 v1, 2, v1
    v_bfe_u32 v1, s6, v1, 4
    v_lshl_add_u32 v1, v1, 8, v10
    s_add_u32 s63, s69, 0
    buffer_load_dwordx4 v[160:163], v1, s[44:47], s63 offen nt
    s_memrealtime s[8:9]
    s_waitcnt vmcnt(8)
    s_waitcnt lgkmcnt(0)
    s_sub_u32 s8, s8, s30
    s_cmpk_ge_u32 s8, 1298
    s_cbranch_scc1 .ap_152
    s_waitcnt vmcnt(5)
    s_cmpk_ge_u32 s8, 1198
    s_cbranch_scc1 .ap_152
    s_waitcnt vmcnt(4)
    s_bitcmp1_b64 s[14:15], 33
    s_cbranch_scc0 1
    s_waitcnt vmcnt(2)
    s_branch .Lsk_b1_0
.Lst_b1_0:
    s_branch .Lrt_b1_0
.Lsk_b1_0:
    s_cmpk_ge_u32 s8, 1078
    s_cbranch_scc1 .ap_152
    s_waitcnt vmcnt(1)
.ap_152:
    s_add_u32 s63, s69, 8192
    buffer_load_dwordx4 v[164:167], v1, s[44:47], s63 offen nt
    s_memrealtime s[8:9]
    s_waitcnt vmcnt(8)
    s_waitcnt lgkmcnt(0)
    s_sub_u32 s8, s8, s30
    s_cmpk_ge_u32 s8, 1335
    s_cbranch_scc1 .ap_153
    s_waitcnt vmcnt(5)
    s_cmpk_ge_u32 s8, 1235
    s_cbranch_scc1 .ap_153
    s_waitcnt vmcnt(4)
    s_bitcmp1_b64 s[14:15], 34
    s_cbranch_scc0 1
    s_waitcnt vmcnt(2)
    s_cmpk_ge_u32 s8, 1115
    s_cbranch_scc1 .ap_153
    s_waitcnt vmcnt(1)
.ap_153:
    s_add_u32 s63, s69, 16384
    buffer_load_dwordx4 v[168:171], v1, s[44:47], s63 offen nt
    s_memrealtime s[8:9]
    s_waitcnt vmcnt(8)
    s_waitcnt lgkmcnt(0)
    s_sub_u32 s8, s8, s30
    s_cmpk_ge_u32 s8, 1371
    s_cbranch_scc1 .ap_154
    s_waitcnt vmcnt(5)
    s_cmpk_ge_u32 s8, 1271
    s_cbranch_scc1 .ap_154
    s_waitcnt vmcnt(4)
    s_cmpk_ge_u32 s8, 1151
    s_cbranch_scc1 .ap_154
    s_waitcnt vmcnt(1)
.ap_154:
    s_add_u32 m0, s101, 65536
    s_add_u32 s56, s100, 4718592
    buffer_load_dwordx4 v6, s[48:51], s56 offen nt lds
    s_memrealtime s[8:9]
    s_waitcnt vmcnt(8)
    s_waitcnt lgkmcnt(0)
    s_sub_u32 s8, s8, s30
    s_cmpk_ge_u32 s8, 1371
    s_cbranch_scc1 .ap_155
    s_waitcnt vmcnt(5)
    s_cmpk_ge_u32 s8, 1271
    s_cbranch_scc1 .ap_155
    s_waitcnt vmcnt(4)
    s_bitcmp1_b64 s[14:15], 35
    s_cbranch_scc0 1
    s_waitcnt vmcnt(2)
    s_cmpk_ge_u32 s8, 1151
    s_cbranch_scc1 .ap_155
    s_waitcnt vmcnt(1)
.ap_155:
    s_add_u32 s63, s69, 24576
    buffer_load_dwordx4 v[172:175], v1, s[44:47], s63 offen nt
    s_memrealtime s[8:9]
    s_waitcnt vmcnt(8)
    s_waitcnt lgkmcnt(0)
    s_sub_u32 s8, s8, s30
    s_cmpk_ge_u32 s8, 1408
    s_cbranch_scc1 .ap_156
    s_waitcnt vmcnt(5)
    s_cmpk_ge_u32 s8, 1308
    s_cbranch_scc1 .ap_156
    s_waitcnt vmcnt(4)
    s_bitcmp1_b64 s[14:15], 36
    s_cbranch_scc0 1
    s_waitcnt vmcnt(2)
    s_cmpk_ge_u32 s8, 1188
    s_cbranch_scc1 .ap_156
    s_waitcnt vmcnt(1)
.ap_156:
    s_add_u32 s63, s69, 32768
    buffer_load_dwordx4 v[176:179], v1, s[44:47], s63 offen nt
    buffer_load_dwordx4 v[16:19], v7, s[36:39], s58 offen offset:0 sc1
    buffer_load_dwordx4 v[20:23], v7, s[36:39], s58 offen offset:256 sc1
    s_memrealtime s[8:9]
    s_waitcnt vmcnt(8)
    s_waitcnt lgkmcnt(0)
    s_sub_u32 s8, s8, s30
    s_cmpk_ge_u32 s8, 1444
    s_cbranch_scc1 .ap_157
    s_waitcnt vmcnt(5)
    s_cmpk_ge_u32 s8, 1344
    s_cbranch_scc1 .ap_157
    s_waitcnt vmcnt(4)
    s_bitcmp1_b64 s[14:15], 37
    s_cbranch_scc0 1
    s_waitcnt vmcnt(2)
    s_cmpk_ge_u32 s8, 1224
    s_cbranch_scc1 .ap_157
    s_waitcnt vmcnt(1)
.ap_157:
    s_add_u32 s63, s69, 40960
    buffer_load_dwordx4 v[180:183], v1, s[44:47], s63 offen nt
    s_memrealtime s[8:9]
    s_waitcnt vmcnt(8)
    s_waitcnt lgkmcnt(0)
    s_sub_u32 s8, s8, s30
    s_cmpk_ge_u32 s8, 1481
    s_cbranch_scc1 .ap_158
    s_waitcnt vmcnt(5)
    s_cmpk_ge_u32 s8, 1381
    s_cbranch_scc1 .ap_158
    s_waitcnt vmcnt(4)
    s_bitcmp1_b64 s[14:15], 38
    s_cbranch_scc0 1
    s_waitcnt vmcnt(2)
    s_cmpk_ge_u32 s8, 1261
    s_cbranch_scc1 .ap_158
    s_waitcnt vmcnt(1)
.ap_158:
    s_add_u32 s63, s69, 49152
    buffer_load_dwordx4 v[184:187], v1, s[44:47], s63 offen nt
    s_memrealtime s[8:9]
    s_waitcnt vmcnt(8)
    s_waitcnt lgkmcnt(0)
    s_sub_u32 s8, s8, s30
    s_cmpk_ge_u32 s8, 1517
    s_cbranch_scc1 .ap_159
    s_waitcnt vmcnt(5)
    s_cmpk_ge_u32 s8, 1417
    s_cbranch_scc1 .ap_159
    s_waitcnt vmcnt(4)
    s_cmpk_ge_u32 s8, 1297
    s_cbranch_scc1 .ap_159
    s_waitcnt vmcnt(1)
.ap_159:
    s_add_u32 m0, s101, 73728
    s_add_u32 s56, s100, 0
    buffer_load_dwordx4 v6, s[52:55], s56 offen nt lds
    s_memrealtime s[8:9]
    s_waitcnt vmcnt(8)
    s_waitcnt lgkmcnt(0)
    s_sub_u32 s8, s8, s30
    s_cmpk_ge_u32 s8, 1517
    s_cbranch_scc1 .ap_160
    s_waitcnt vmcnt(5)
    s_cmpk_ge_u32 s8, 1417
    s_cbranch_scc1 .ap_160
    s_waitcnt vmcnt(4)
    s_bitcmp1_b64 s[14:15], 39
    s_cbranch_scc0 1
    s_waitcnt vmcnt(2)
    s_cmpk_ge_u32 s8, 1297
    s_cbranch_scc1 .ap_160
    s_waitcnt vmcnt(1)
.ap_160:
    s_add_u32 s63, s69, 57344
    buffer_load_dwordx4 v[188:191], v1, s[44:47], s63 offen nt
    s_memrealtime s[8:9]
    s_waitcnt vmcnt(8)
    s_waitcnt lgkmcnt(0)
    s_sub_u32 s8, s8, s30
    s_cmpk_ge_u32 s8, 1554
    s_cbranch_scc1 .ap_161
    s_waitcnt vmcnt(5)
    s_cmpk_ge_u32 s8, 1454
    s_cbranch_scc1 .ap_161
    s_waitcnt vmcnt(4)
    s_bitcmp1_b64 s[14:15], 40
    s_cbranch_scc0 1
    s_waitcnt vmcnt(2)
    s_cmpk_ge_u32 s8, 1334
    s_cbranch_scc1 .ap_161
    s_waitcnt vmcnt(1)
.ap_161:
    s_add_u32 s63, s69, 131072
    buffer_load_dwordx4 v[192:195], v1, s[44:47], s63 offen nt
    s_waitcnt vmcnt(5)
    s_branch .gpc_163
.gp_162:
    buffer_load_dwordx4 v[16:19], v7, s[36:39], s58 offen offset:0 sc1
    buffer_load_dwordx4 v[20:23], v7, s[36:39], s58 offen offset:256 sc1
    s_waitcnt vmcnt(0)
.gpc_163:
    v_min_u32 v10, v17, v19
    v_max_u32 v11, v17, v19
    v_min3_u32 v10, v10, v21, v23
    v_max3_u32 v11, v11, v21, v23
    v_cmp_eq_u32 vcc, s34, v10
    v_cmp_eq_u32 s[56:57], s34, v11
    s_and_b64 vcc, vcc, s[56:57]
    s_cmp_eq_u64 vcc, -1
    s_nop 2
    s_cbranch_scc1 .gpd_164
    s_sub_u32 s35, s35, 1
    s_cbranch_scc1 .Lexit
    s_sleep 1
    s_branch .gp_162
.gpd_164:
    s_mov_b32 vcc_lo, 0xcccccccc
    s_mov_b32 vcc_hi, 0xcccccccc
    v_cndmask_b32_e64 v24, v16, 0, vcc
    v_cndmask_b32_e64 v25, v18, 0, vcc
    v_cndmask_b32_e64 v26, v20, 0, vcc
    v_cndmask_b32_e64 v27, v22, 0, vcc
    v_cndmask_b32_e32 v28, 0, v16, vcc
    v_cndmask_b32_e32 v29, 0, v18, vcc
    v_cndmask_b32_e32 v30, 0, v20, vcc
    v_cndmask_b32_e32 v31, 0, v22, vcc
    v_mfma_f32_16x16x32_bf16 v[16:19], v[32:35], v[24:27], 0
    v_mfma_f32_16x16x32_bf16 v[32:35], v[40:43], v[24:27], 0
    v_mfma_f32_16x16x32_bf16 v[16:19], v[36:39], v[28:31], v[16:19]
    v_mfma_f32_16x16x32_bf16 v[40:43], v[48:51], v[24:27], 0
    v_mfma_f32_16x16x32_bf16 v[32:35], v[44:47], v[28:31], v[32:35]
    v_mfma_f32_16x16x32_bf16 v[48:51], v[56:59], v[24:27], 0
    v_mfma_f32_16x16x32_bf16 v[40:43], v[52:55], v[28:31], v[40:43]
    v_mfma_f32_16x16x32_bf16 v[56:59], v[64:67], v[24:27], 0
    v_mfma_f32_16x16x32_bf16 v[48:51], v[60:63], v[28:31], v[48:51]
    s_nop 1
    v_add_f32_dpp v10, v17, v16 row_ror:12 row_mask:0xf bank_mask:0x1
    s_memrealtime s[8:9]
    s_waitcnt lgkmcnt(0)
    s_sub_u32 s8, s8, s30
    s_cmpk_ge_u32 s8, 1591
    s_nop 0
    s_cbranch_scc1 .ap_165
    s_waitcnt vmcnt(5)
    s_cmpk_ge_u32 s8, 1491
    s_cbranch_scc1 .ap_165
    s_waitcnt vmcnt(4)
    s_branch .Lsk_b1_1
.Lst_b1_1:
    s_branch .Lrt_b1_1
.Lsk_b1_1:
    s_bitcmp1_b64 s[14:15], 41
    s_cbranch_scc0 1
    s_waitcnt vmcnt(2)
    s_cmpk_ge_u32 s8, 1371
    s_cbranch_scc1 .ap_165
    s_waitcnt vmcnt(1)
.ap_165:
    s_add_u32 s63, s69, 139264
    buffer_load_dwordx4 v[196:199], v1, s[44:47], s63 offen nt
    v_mfma_f32_16x16x32_bf16 v[64:67], v[72:75], v[24:27], 0
    v_mfma_f32_16x16x32_bf16 v[56:59], v[68:71], v[28:31], v[56:59]
    v_add_f32_dpp v11, v33, v32 row_ror:12 row_mask:0xf bank_mask:0x1
    v_add_f32_dpp v10, v18, v10 row_ror:8 row_mask:0xf bank_mask:0x1
    v_mfma_f32_16x16x32_bf16 v[72:75], v[80:83], v[24:27], 0
    v_mfma_f32_16x16x32_bf16 v[64:67], v[76:79], v[28:31], v[64:67]
    v_add_f32_dpp v12, v41, v40 row_ror:12 row_mask:0xf bank_mask:0x1
    v_add_f32_dpp v11, v34, v11 row_ror:8 row_mask:0xf bank_mask:0x1
    v_add_f32_dpp v10, v19, v10 row_ror:4 row_mask:0xf bank_mask:0x1
    v_mfma_f32_16x16x32_bf16 v[80:83], v[88:91], v[24:27], 0
    v_mfma_f32_16x16x32_bf16 v[72:75], v[84:87], v[28:31], v[72:75]
    v_add_f32_dpp v13, v49, v48 row_ror:12 row_mask:0xf bank_mask:0x1
    v_add_f32_dpp v12, v42, v12 row_ror:8 row_mask:0xf bank_mask:0x1
    v_add_f32_dpp v11, v35, v11 row_ror:4 row_mask:0xf bank_mask:0x1
    v_mfma_f32_16x16x32_bf16 v[88:91], v[96:99], v[24:27], 0
    v_mfma_f32_16x16x32_bf16 v[80:83], v[92:95], v[28:31], v[80:83]
    v_add_f32_dpp v10, v58, v57 row_ror:12 row_mask:0xf bank_mask:0x2
    v_add_f32_dpp v13, v50, v13 row_ror:8 row_mask:0xf bank_mask:0x1
    v_add_f32_dpp v12, v43, v12 row_ror:4 row_mask:0xf bank_mask:0x1
    s_memrealtime s[8:9]
    s_waitcnt lgkmcnt(0)
    s_sub_u32 s8, s8, s30
    s_cmpk_ge_u32 s8, 1612
    s_nop 0
    s_cbranch_scc1 .ap_166
    s_waitcnt vmcnt(5)
    s_cmpk_ge_u32 s8, 1512
    s_cbranch_scc1 .ap_166
    s_waitcnt vmcnt(4)
    s_bitcmp1_b64 s[14:15], 42
    s_cbranch_scc0 1
    s_waitcnt vmcnt(2)
    s_cmpk_ge_u32 s8, 1392
    s_cbranch_scc1 .ap_166
    s_waitcnt vmcnt(1)
.ap_166:
    s_add_u32 s63, s69, 147456
    buffer_load_dwordx4 v[200:203], v1, s[44:47], s63 offen nt
    s_memrealtime s[8:9]
    s_waitcnt lgkmcnt(0)
    s_sub_u32 s8, s8, s30
    s_cmpk_ge_u32 s8, 1633
    s_cbranch_scc1 .ap_167
    s_waitcnt vmcnt(5)
    s_cmpk_ge_u32 s8, 1533
    s_cbranch_scc1 .ap_167
    s_waitcnt vmcnt(4)
    s_cmpk_ge_u32 s8, 1413
    s_cbranch_scc1 .ap_167
    s_waitcnt vmcnt(1)
.ap_167:
    s_add_u32 m0, s101, 81920
    s_add_u32 s56, s100, 589824
    buffer_load_dwordx4 v6, s[52:55], s56 offen nt lds
    v_mfma_f32_16x16x32_bf16 v[96:99], v[104:107], v[24:27], 0
    v_mfma_f32_16x16x32_bf16 v[88:91], v[100:103], v[28:31], v[88:91]
    v_add_f32_dpp v11, v66, v65 row_ror:12 row_mask:0xf bank_mask:0x2
    v_add_f32_dpp v10, v59, v10 row_ror:8 row_mask:0xf bank_mask:0x2
    v_add_f32_dpp v13, v51, v13 row_ror:4 row_mask:0xf bank_mask:0x1
    v_mfma_f32_16x16x32_bf16 v[104:107], v[112:115], v[24:27], 0
    v_mfma_f32_16x16x32_bf16 v[96:99], v[108:111], v[28:31], v[96:99]
    v_add_f32_dpp v12, v74, v73 row_ror:12 row_mask:0xf bank_mask:0x2
    v_add_f32_dpp v11, v67, v11 row_ror:8 row_mask:0xf bank_mask:0x2
    v_add_f32_dpp v10, v56, v10 row_ror:4 row_mask:0xf bank_mask:0x2
    v_mfma_f32_16x16x32_bf16 v[112:115], v[120:123], v[24:27], 0
    v_mfma_f32_16x16x32_bf16 v[104:107], v[116:119], v[28:31], v[104:107]
    v_add_f32_dpp v13, v82, v81 row_ror:12 row_mask:0xf bank_mask:0x2
    v_add_f32_dpp v12, v75, v12 row_ror:8 row_mask:0xf bank_mask:0x2
    v_add_f32_dpp v11, v64, v11 row_ror:4 row_mask:0xf bank_mask:0x2
    v_mfma_f32_16x16x32_bf16 v[120:123], v[128:131], v[24:27], 0
    v_mfma_f32_16x16x32_bf16 v[112:115], v[124:127], v[28:31], v[112:115]
    v_add_f32_dpp v10, v91, v90 row_ror:12 row_mask:0xf bank_mask:0x4
    v_add_f32_dpp v13, v83, v13 row_ror:8 row_mask:0xf bank_mask:0x2
    v_add_f32_dpp v12, v72, v12 row_ror:4 row_mask:0xf bank_mask:0x2
    s_memrealtime s[8:9]
    s_waitcnt lgkmcnt(0)
    s_sub_u32 s8, s8, s30
    s_cmpk_ge_u32 s8, 1633
    s_nop 0
    s_cbranch_scc1 .ap_168
    s_waitcnt vmcnt(5)
    s_cmpk_ge_u32 s8, 1533
    s_cbranch_scc1 .ap_168
    s_waitcnt vmcnt(4)
    s_bitcmp1_b64 s[14:15], 43
    s_cbranch_scc0 1
    s_waitcnt vmcnt(2)
    s_cmpk_ge_u32 s8, 1413
    s_cbranch_scc1 .ap_168
    s_waitcnt vmcnt(1)
.ap_168:
    s_add_u32 s63, s69, 155648
    buffer_load_dwordx4 v[204:207], v1, s[44:47], s63 offen nt
    v_mfma_f32_16x16x32_bf16 v[128:131], v[136:139], v[24:27], 0
    v_mfma_f32_16x16x32_bf16 v[120:123], v[132:135], v[28:31], v[120:123]
    v_add_f32_dpp v11, v99, v98 row_ror:12 row_mask:0xf bank_mask:0x4
    v_add_f32_dpp v10, v88, v10 row_ror:8 row_mask:0xf bank_mask:0x4
    v_add_f32_dpp v13, v80, v13 row_ror:4 row_mask:0xf bank_mask:0x2
    v_mfma_f32_16x16x32_bf16 v[136:139], v[144:147], v[24:27], 0
    v_mfma_f32_16x16x32_bf16 v[128:131], v[140:143], v[28:31], v[128:131]
    v_add_f32_dpp v12, v107, v106 row_ror:12 row_mask:0xf bank_mask:0x4
    v_add_f32_dpp v11, v96, v11 row_ror:8 row_mask:0xf bank_mask:0x4
    v_add_f32_dpp v10, v89, v10 row_ror:4 row_mask:0xf bank_mask:0x4
    v_mfma_f32_16x16x32_bf16 v[144:147], v[152:155], v[24:27], 0
    v_mfma_f32_16x16x32_bf16 v[136:139], v[148:151], v[28:31], v[136:139]
    v_add_f32_dpp v13, v115, v114 row_ror:12 row_mask:0xf bank_mask:0x4
    v_add_f32_dpp v12, v104, v12 row_ror:8 row_mask:0xf bank_mask:0x4
    v_add_f32_dpp v11, v97, v11 row_ror:4 row_mask:0xf bank_mask:0x4
    v_mfma_f32_16x16x32_bf16 v[144:147], v[156:159], v[28:31], v[144:147]
    v_add_f32_dpp v10, v120, v123 row_ror:12 row_mask:0xf bank_mask:0x8
    v_add_f32_dpp v13, v112, v13 row_ror:8 row_mask:0xf bank_mask:0x4
    v_add_f32_dpp v12, v105, v12 row_ror:4 row_mask:0xf bank_mask:0x4
    s_memrealtime s[8:9]
    s_waitcnt vmcnt(8)
    s_waitcnt lgkmcnt(0)
    s_sub_u32 s8, s8, s30
    s_cmpk_ge_u32 s8, 1654
    s_cbranch_scc1 .ap_169
    s_waitcnt vmcnt(5)
    s_cmpk_ge_u32 s8, 1554
    s_cbranch_scc1 .ap_169
    s_waitcnt vmcnt(4)
    s_bitcmp1_b64 s[14:15], 44
    s_cbranch_scc0 1
    s_waitcnt vmcnt(2)
    s_cmpk_ge_u32 s8, 1434
    s_cbranch_scc1 .ap_169
    s_waitcnt vmcnt(1)
.ap_169:
    s_add_u32 s63, s69, 163840
    buffer_load_dwordx4 v[208:211], v1, s[44:47], s63 offen nt
    s_cmp_eq_u32 s3, 0
    s_cbranch_scc1 .Lst_b2_0
    s_cmp_eq_u32 s3, 1
    s_cbranch_scc1 .Lst_b2_1
    s_cmp_eq_u32 s3, 2
    s_cbranch_scc1 .Lrt_b2_2
    s_cmp_eq_u32 s3, 3
    s_cbranch_scc1 .Lrt_b2_3
.Lrt_b2_0:
.Lrt_b2_1:
.Lrt_b2_2:
.Lrt_b2_3:
    v_add_f32_dpp v11, v128, v131 row_ror:12 row_mask:0xf bank_mask:0x8
    v_add_f32_dpp v10, v121, v10 row_ror:8 row_mask:0xf bank_mask:0x8
    v_add_f32_dpp v13, v113, v13 row_ror:4 row_mask:0xf bank_mask:0x4
    v_add_f32_dpp v12, v136, v139 row_ror:12 row_mask:0xf bank_mask:0x8
    v_add_f32_dpp v11, v129, v11 row_ror:8 row_mask:0xf bank_mask:0x8
    v_add_f32_dpp v10, v122, v10 row_ror:4 row_mask:0xf bank_mask:0x8
    v_add_f32_dpp v13, v144, v147 row_ror:12 row_mask:0xf bank_mask:0x8
    v_add_f32_dpp v12, v137, v12 row_ror:8 row_mask:0xf bank_mask:0x8
    v_add_f32_dpp v11, v130, v11 row_ror:4 row_mask:0xf bank_mask:0x8
    v_add_f32_dpp v13, v145, v13 row_ror:8 row_mask:0xf bank_mask:0x8
    v_add_f32_dpp v12, v138, v12 row_ror:4 row_mask:0xf bank_mask:0x8
    s_memrealtime s[8:9]
    s_waitcnt vmcnt(8)
    s_waitcnt lgkmcnt(0)
    s_sub_u32 s8, s8, s30
    s_cmpk_ge_u32 s8, 1676
    s_cbranch_scc1 .ap_170
    s_waitcnt vmcnt(5)
    s_cmpk_ge_u32 s8, 1576
    s_cbranch_scc1 .ap_170
    s_waitcnt vmcnt(4)
    s_bitcmp1_b64 s[14:15], 45
    s_cbranch_scc0 1
    s_waitcnt vmcnt(2)
    s_cmpk_ge_u32 s8, 1456
    s_cbranch_scc1 .ap_170
    s_waitcnt vmcnt(1)
.ap_170:
    s_add_u32 s63, s69, 172032
    buffer_load_dwordx4 v[212:215], v1, s[44:47], s63 offen nt
    v_add_f32_dpp v13, v146, v13 row_ror:4 row_mask:0xf bank_mask:0x8
    s_mov_b32 s60, 0x3db504f3
    s_mov_b32 s61, 0x3db504f3
    v_cvt_pk_bf16_f32 v10, v10, v11
    v_and_b32 v11, 0xffff0000, v10
    v_lshlrev_b32 v10, 16, v10
    s_branch .Lsk_b1_2
.Lst_b1_2:
    s_branch .Lrt_b1_2
.Lsk_b1_2:
    v_cvt_pk_bf16_f32 v12, v12, v13
    v_and_b32 v13, 0xffff0000, v12
    v_lshlrev_b32 v12, 16, v12
    v_pk_mul_f32 v[10:11], v[10:11], s[60:61]
    v_pk_mul_f32 v[12:13], v[12:13], s[60:61]
    v_cvt_pk_bf16_f32 v10, v10, v11
    v_and_b32 v11, 0xffff0000, v10
    v_lshlrev_b32 v10, 16, v10
    v_cvt_pk_bf16_f32 v12, v12, v13
    v_and_b32 v13, 0xffff0000, v12
    v_lshlrev_b32 v12, 16, v12
    v_max_f32 v14, v10, v11
    v_max3_f32 v14, v14, v12, v13
    s_mov_b32 s60, 0x3fb8aa3b
    v_mov_b32 v22, s34
    v_mov_b32 v23, s34
    v_max_f32_dpp v14, v14, v14 quad_perm:[2,3,0,1] row_mask:0xf bank_mask:0xf
    s_nop 1
    v_max_f32_dpp v14, v14, v14 row_ror:4 row_mask:0xf bank_mask:0xf
    s_nop 1
    v_max_f32_dpp v14, v14, v14 row_ror:8 row_mask:0xf bank_mask:0xf
    v_mov_b32 v15, v14
    s_nop 1
    v_permlane16_swap_b32 v15, v14
    v_max_f32 v14, v15, v14
    v_mov_b32 v15, v14
    s_nop 1
    v_permlane32_swap_b32 v15, v14
    v_max_f32 v14, v15, v14
    v_mul_f32 v15, 0xbfb8aa3b, v14
    v_fma_f32 v10, v10, s60, v15
    v_fma_f32 v11, v11, s60, v15
    v_fma_f32 v12, v12, s60, v15
    v_fma_f32 v13, v13, s60, v15
    v_exp_f32 v10, v10
    v_exp_f32 v11, v11
    v_exp_f32 v12, v12
    v_exp_f32 v13, v13
    v_mov_b32 v20, v14
    v_pk_add_f32 v[16:17], v[10:11], v[12:13]
    v_add_f32 v21, v16, v17
    s_lshl_b32 s60, s68, 5
    s_lshl_b32 s61, s3, 4
    s_add_u32 s61, s61, 159104
    v_add_u32 v16, s61, v3
    v_mov_b32 v17, 159232
    v_mov_b32 v18, 1
    s_add_u32 s60, s60, s59
    v_add_f32_dpp v21, v21, v21 quad_perm:[2,3,0,1] row_mask:0xf bank_mask:0xf
    s_nop 1
    v_add_f32_dpp v21, v21, v21 row_ror:4 row_mask:0xf bank_mask:0xf
    s_nop 1
    v_add_f32_dpp v21, v21, v21 row_ror:8 row_mask:0xf bank_mask:0xf
    v_mov_b32 v15, v21
    s_nop 1
    v_permlane16_swap_b32 v15, v21
    v_add_f32 v21, v15, v21
    v_mov_b32 v15, v21
    s_nop 1
    v_permlane32_swap_b32 v15, v21
    v_add_f32 v21, v15, v21
    s_mov_b64 exec, 3
    ds_write_b64 v16, v[20:21]
    s_mov_b64 exec, 1
    ds_add_rtn_u32 v18, v17, v18
    s_mov_b64 exec, -1
    v_and_b32 v16, 0x78, v3
    v_or_b32 v16, 159104, v16
    s_waitcnt lgkmcnt(0)
    v_readfirstlane_b32 s61, v18
    s_cmp_eq_u32 s61, 7
    s_nop 3
    s_cbranch_scc0 .mlc_171
    ds_read_b64 v[18:19], v16
    s_waitcnt lgkmcnt(0)
    v_mov_b32 v20, v18
    s_nop 1
    v_max_f32_dpp v20, v20, v20 quad_perm:[2,3,0,1] row_mask:0xf bank_mask:0xf
    s_nop 1
    v_max_f32_dpp v20, v20, v20 row_ror:4 row_mask:0xf bank_mask:0xf
    s_nop 1
    v_max_f32_dpp v20, v20, v20 row_ror:8 row_mask:0xf bank_mask:0xf
    v_sub_f32 v18, v18, v20
    v_mul_f32 v18, 0x3fb8aa3b, v18
    v_exp_f32 v18, v18
    s_nop 0
    v_mul_f32 v21, v18, v19
    s_nop 1
    v_add_f32_dpp v21, v21, v21 quad_perm:[2,3,0,1] row_mask:0xf bank_mask:0xf
    s_nop 1
    v_add_f32_dpp v21, v21, v21 row_ror:4 row_mask:0xf bank_mask:0xf
    s_nop 1
    v_add_f32_dpp v21, v21, v21 row_ror:8 row_mask:0xf bank_mask:0xf
    s_mov_b64 exec, 3
    buffer_store_dwordx4 v[20:23], v2, s[36:39], s60 offen sc1
    s_mov_b64 exec, -1
.mlc_171:
    s_memrealtime s[8:9]
    s_waitcnt vmcnt(8)
    s_waitcnt lgkmcnt(0)
    s_sub_u32 s8, s8, s30
    s_cmpk_ge_u32 s8, 1708
    s_cbranch_scc1 .ap_172
    s_waitcnt vmcnt(5)
    s_cmpk_ge_u32 s8, 1608
    s_cbranch_scc1 .ap_172
    s_waitcnt vmcnt(4)
    s_bitcmp1_b64 s[14:15], 46
    s_cbranch_scc0 1
    s_waitcnt vmcnt(2)
    s_cmpk_ge_u32 s8, 1488
    s_cbranch_scc1 .ap_172
    s_waitcnt vmcnt(1)
.ap_172:
    s_add_u32 s63, s69, 180224
    buffer_load_dwordx4 v[216:219], v1, s[44:47], s63 offen nt
    s_memrealtime s[8:9]
    s_waitcnt vmcnt(8)
    s_waitcnt lgkmcnt(0)
    s_sub_u32 s8, s8, s30
    s_cmpk_ge_u32 s8, 1740
    s_cbranch_scc1 .ap_173
    s_waitcnt vmcnt(5)
    s_cmpk_ge_u32 s8, 1640
    s_cbranch_scc1 .ap_173
    s_waitcnt vmcnt(4)
    s_bitcmp1_b64 s[14:15], 47
    s_cbranch_scc0 1
    s_waitcnt vmcnt(2)
    s_cmpk_ge_u32 s8, 1520
    s_cbranch_scc1 .ap_173
    s_waitcnt vmcnt(1)
.ap_173:
    s_add_u32 s63, s69, 188416
    buffer_load_dwordx4 v[220:223], v1, s[44:47], s63 offen nt
    s_and_b32 s56, s64, 0
    s_mul_i32 s56, s56, 18432
    s_mul_i32 s57, s3, 2304
    s_add_u32 s56, s56, s57
    s_add_u32 s56, s56, 0x37000
    buffer_load_dwordx4 v[32:35], v2, s[36:39], s56 offen offset:0 sc1
    buffer_load_dwordx4 v[40:43], v2, s[36:39], s56 offen offset:1024 sc1
    buffer_load_dwordx2 v[48:49], v5, s[36:39], s56 offen offset:0 sc1
    s_memrealtime s[8:9]
    s_waitcnt vmcnt(11)
    s_waitcnt lgkmcnt(0)
    s_sub_u32 s8, s8, s30
    s_cmpk_ge_u32 s8, 1772
    s_cbranch_scc1 .ap_174
    s_waitcnt vmcnt(8)
    s_cmpk_ge_u32 s8, 1672
    s_cbranch_scc1 .ap_174
    s_waitcnt vmcnt(7)
    s_bitcmp1_b64 s[14:15], 48
    s_cbranch_scc0 1
    s_waitcnt vmcnt(5)
    s_cmpk_ge_u32 s8, 1552
    s_cbranch_scc1 .ap_174
    s_waitcnt vmcnt(4)
.ap_174:
    s_branch .Lsk_b1_3
.Lst_b1_3:
    s_branch .Lrt_b1_3
.Lsk_b1_3:
    s_add_u32 s63, s69, 262144
    buffer_load_dwordx4 v[224:227], v1, s[44:47], s63 offen nt
    s_memrealtime s[8:9]
    s_waitcnt vmcnt(11)
    s_waitcnt lgkmcnt(0)
    s_sub_u32 s8, s8, s30
    s_cmpk_ge_u32 s8, 1804
    s_cbranch_scc1 .ap_175
    s_waitcnt vmcnt(8)
    s_cmpk_ge_u32 s8, 1704
    s_cbranch_scc1 .ap_175
    s_waitcnt vmcnt(7)
    s_bitcmp1_b64 s[14:15], 49
    s_cbranch_scc0 1
    s_waitcnt vmcnt(5)
    s_cmpk_ge_u32 s8, 1584
    s_cbranch_scc1 .ap_175
    s_waitcnt vmcnt(4)
.ap_175:
    s_add_u32 s63, s69, 270336
    buffer_load_dwordx4 v[228:231], v1, s[44:47], s63 offen nt
    s_and_b32 s56, s64, 0
    s_mul_i32 s56, s56, 18432
    s_mul_i32 s57, s3, 2304
    s_add_u32 s56, s56, s57
    s_add_u32 s56, s56, 0x49000
    buffer_load_dwordx4 v[56:59], v2, s[36:39], s56 offen offset:0 sc1
    buffer_load_dwordx4 v[64:67], v2, s[36:39], s56 offen offset:1024 sc1
    buffer_load_dwordx2 v[72:73], v5, s[36:39], s56 offen offset:0 sc1
    s_memrealtime s[8:9]
    s_waitcnt vmcnt(14)
    s_waitcnt lgkmcnt(0)
    s_sub_u32 s8, s8, s30
    s_cmpk_ge_u32 s8, 1836
    s_cbranch_scc1 .ap_176
    s_waitcnt vmcnt(11)
    s_cmpk_ge_u32 s8, 1736
    s_cbranch_scc1 .ap_176
    s_waitcnt vmcnt(10)
    s_bitcmp1_b64 s[14:15], 50
    s_cbranch_scc0 1
    s_waitcnt vmcnt(8)
    s_cmpk_ge_u32 s8, 1616
    s_cbranch_scc1 .ap_176
    s_waitcnt vmcnt(4)
.ap_176:
    s_add_u32 s63, s69, 278528
    buffer_load_dwordx4 v[232:235], v1, s[44:47], s63 offen nt
    s_memrealtime s[8:9]
    s_waitcnt vmcnt(14)
    s_waitcnt lgkmcnt(0)
    s_sub_u32 s8, s8, s30
    s_cmpk_ge_u32 s8, 1868
    s_cbranch_scc1 .ap_177
    s_waitcnt vmcnt(11)
    s_cmpk_ge_u32 s8, 1768
    s_cbranch_scc1 .ap_177
    s_waitcnt vmcnt(10)
    s_bitcmp1_b64 s[14:15], 51
    s_cbranch_scc0 1
    s_waitcnt vmcnt(5)
    s_cmpk_ge_u32 s8, 1648
    s_cbranch_scc1 .ap_177
    s_waitcnt vmcnt(4)
.ap_177:
    s_add_u32 s63, s69, 286720
    buffer_load_dwordx4 v[236:239], v1, s[44:47], s63 offen nt
    s_memrealtime s[8:9]
    s_waitcnt vmcnt(14)
    s_waitcnt lgkmcnt(0)
    s_sub_u32 s8, s8, s30
    s_cmpk_ge_u32 s8, 1900
    s_cbranch_scc1 .ap_178
    s_waitcnt vmcnt(11)
    s_cmpk_ge_u32 s8, 1800
    s_cbranch_scc1 .ap_178
    s_waitcnt vmcnt(10)
    s_bitcmp1_b64 s[14:15], 52
    s_cbranch_scc0 1
    s_waitcnt vmcnt(5)
    s_cmpk_ge_u32 s8, 1680
    s_cbranch_scc1 .ap_178
    s_waitcnt vmcnt(1)
.ap_178:
    s_add_u32 s63, s69, 294912
    buffer_load_dwordx4 v[240:243], v1, s[44:47], s63 offen nt
    s_memrealtime s[8:9]
    s_waitcnt vmcnt(14)
    s_waitcnt lgkmcnt(0)
    s_sub_u32 s8, s8, s30
    s_cmpk_ge_u32 s8, 1932
    s_cbranch_scc1 .ap_179
    s_waitcnt vmcnt(11)
    s_cmpk_ge_u32 s8, 1832
    s_cbranch_scc1 .ap_179
    s_waitcnt vmcnt(7)
    s_bitcmp1_b64 s[14:15], 53
    s_cbranch_scc0 1
    s_waitcnt vmcnt(2)
    s_cmpk_ge_u32 s8, 1712
    s_cbranch_scc1 .ap_179
    s_waitcnt vmcnt(1)
.ap_179:
    s_add_u32 s63, s69, 303104
    buffer_load_dwordx4 v[244:247], v1, s[44:47], s63 offen nt
    s_memrealtime s[8:9]
    s_waitcnt vmcnt(14)
    s_waitcnt lgkmcnt(0)
    s_sub_u32 s8, s8, s30
    s_cmpk_ge_u32 s8, 1964
    s_cbranch_scc1 .ap_180
    s_waitcnt vmcnt(8)
    s_cmpk_ge_u32 s8, 1864
    s_cbranch_scc1 .ap_180
    s_waitcnt vmcnt(7)
    s_bitcmp1_b64 s[14:15], 54
    s_cbranch_scc0 1
    s_waitcnt vmcnt(2)
    s_cmpk_ge_u32 s8, 1744
    s_cbranch_scc1 .ap_180
    s_waitcnt vmcnt(1)
.ap_180:
    s_add_u32 s63, s69, 311296
    buffer_load_dwordx4 v[248:251], v1, s[44:47], s63 offen nt
    s_memrealtime s[8:9]
    s_waitcnt vmcnt(14)
    s_waitcnt lgkmcnt(0)
    s_sub_u32 s8, s8, s30
    s_cmpk_ge_u32 s8, 1996
    s_cbranch_scc1 .ap_181
    s_waitcnt vmcnt(8)
    s_cmpk_ge_u32 s8, 1896
    s_cbranch_scc1 .ap_181
    s_waitcnt vmcnt(4)
    s_bitcmp1_b64 s[14:15], 55
    s_cbranch_scc0 1
    s_waitcnt vmcnt(2)
    s_cmpk_ge_u32 s8, 1776
    s_cbranch_scc1 .ap_181
    s_waitcnt vmcnt(1)
.ap_181:
    s_add_u32 s63, s69, 319488
    buffer_load_dwordx4 v[252:255], v1, s[44:47], s63 offen nt
    s_memrealtime s[8:9]
    s_waitcnt vmcnt(14)
    s_waitcnt lgkmcnt(0)
    s_sub_u32 s8, s8, s30
    s_cmpk_ge_u32 s8, 2028
    s_cbranch_scc1 .ap_182
    s_waitcnt vmcnt(5)
    s_cmpk_ge_u32 s8, 1928
    s_cbranch_scc1 .ap_182
    s_waitcnt vmcnt(4)
    s_bitcmp1_b64 s[14:15], 56
    s_cbranch_scc0 1
    s_waitcnt vmcnt(2)
    s_cmpk_ge_u32 s8, 1808
    s_cbranch_scc1 .ap_182
    s_waitcnt vmcnt(1)
.ap_182:
    s_add_u32 s63, s69, 393216
    buffer_load_dwordx4 v[36:39], v1, s[44:47], s63 offen nt
    s_memrealtime s[8:9]
    s_waitcnt vmcnt(11)
    s_waitcnt lgkmcnt(0)
    s_sub_u32 s8, s8, s30
    s_cmpk_ge_u32 s8, 2060
    s_cbranch_scc1 .ap_183
    s_waitcnt vmcnt(5)
    s_cmpk_ge_u32 s8, 1960
    s_cbranch_scc1 .ap_183
    s_waitcnt vmcnt(4)
    s_bitcmp1_b64 s[14:15], 57
    s_cbranch_scc0 1
    s_waitcnt vmcnt(2)
    s_cmpk_ge_u32 s8, 1840
    s_cbranch_scc1 .ap_183
    s_waitcnt vmcnt(1)
.ap_183:
    s_add_u32 s63, s69, 401408
    buffer_load_dwordx4 v[44:47], v1, s[44:47], s63 offen nt
    s_and_b32 s0, s0, 0xffffff80
    s_sub_u32 s0, s0, 1024
    buffer_load_dword v28, v4, s[36:39], s0 offen sc1
    buffer_load_dwordx4 v[24:27], v9, s[36:39], s59 offen offset:0 sc1
    s_memrealtime s[8:9]
    s_waitcnt vmcnt(9)
    s_waitcnt lgkmcnt(0)
    s_sub_u32 s8, s8, s30
    s_cmpk_ge_u32 s8, 2092
    s_cbranch_scc1 .ap_184
    s_waitcnt vmcnt(6)
    s_cmpk_ge_u32 s8, 1992
    s_cbranch_scc1 .ap_184
    s_waitcnt vmcnt(5)
    s_bitcmp1_b64 s[14:15], 58
    s_cbranch_scc0 1
    s_waitcnt vmcnt(3)
    s_cmpk_ge_u32 s8, 1872
    s_cbranch_scc1 .ap_184
    s_waitcnt vmcnt(2)
.ap_184:
    s_add_u32 s63, s69, 409600
    buffer_load_dwordx4 v[52:55], v1, s[44:47], s63 offen nt
    s_memrealtime s[8:9]
    s_waitcnt vmcnt(9)
    s_waitcnt lgkmcnt(0)
    s_sub_u32 s8, s8, s30
    s_cmpk_ge_u32 s8, 2124
    s_cbranch_scc1 .ap_185
    s_waitcnt vmcnt(6)
    s_cmpk_ge_u32 s8, 2024
    s_cbranch_scc1 .ap_185
    s_waitcnt vmcnt(5)
    s_bitcmp1_b64 s[14:15], 59
    s_cbranch_scc0 1
    s_waitcnt vmcnt(3)
    s_cmpk_ge_u32 s8, 1904
    s_cbranch_scc1 .ap_185
    s_waitcnt vmcnt(1)
.ap_185:
    s_add_u32 s63, s69, 417792
    buffer_load_dwordx4 v[60:63], v1, s[44:47], s63 offen nt
    s_memrealtime s[8:9]
    s_waitcnt vmcnt(9)
    s_waitcnt lgkmcnt(0)
    s_sub_u32 s8, s8, s30
    s_cmpk_ge_u32 s8, 2156
    s_cbranch_scc1 .ap_186
    s_waitcnt vmcnt(6)
    s_cmpk_ge_u32 s8, 2056
    s_cbranch_scc1 .ap_186
    s_waitcnt vmcnt(5)
    s_bitcmp1_b64 s[14:15], 60
    s_cbranch_scc0 1
    s_waitcnt vmcnt(2)
    s_branch .Lsk_b1_4
.Lst_b1_4:
    s_branch .Lrt_b1_4
.Lsk_b1_4:
    s_cmpk_ge_u32 s8, 1936
    s_cbranch_scc1 .ap_186
    s_waitcnt vmcnt(1)
.ap_186:
    s_add_u32 s63, s69, 425984
    buffer_load_dwordx4 v[68:71], v1, s[44:47], s63 offen nt
    s_memrealtime s[8:9]
    s_waitcnt vmcnt(9)
    s_waitcnt lgkmcnt(0)
    s_sub_u32 s8, s8, s30
    s_cmpk_ge_u32 s8, 2188
    s_cbranch_scc1 .ap_187
    s_waitcnt vmcnt(6)
    s_cmpk_ge_u32 s8, 2088
    s_cbranch_scc1 .ap_187
    s_waitcnt vmcnt(5)
    s_bitcmp1_b64 s[14:15], 61
    s_cbranch_scc0 1
    s_waitcnt vmcnt(2)
    s_cmpk_ge_u32 s8, 1968
    s_cbranch_scc1 .ap_187
    s_waitcnt vmcnt(1)
.ap_187:
    s_add_u32 s63, s69, 434176
    buffer_load_dwordx4 v[76:79], v1, s[44:47], s63 offen nt
    s_memrealtime s[8:9]
    s_waitcnt vmcnt(9)
    s_waitcnt lgkmcnt(0)
    s_sub_u32 s8, s8, s30
    s_cmpk_ge_u32 s8, 2220
    s_cbranch_scc1 .ap_188
    s_waitcnt vmcnt(6)
    s_cmpk_ge_u32 s8, 2120
    s_cbranch_scc1 .ap_188
    s_waitcnt vmcnt(4)
    s_bitcmp1_b64 s[14:15], 62
    s_cbranch_scc0 1
    s_waitcnt vmcnt(2)
    s_cmpk_ge_u32 s8, 2000
    s_cbranch_scc1 .ap_188
    s_waitcnt vmcnt(1)
.ap_188:
    s_add_u32 s63, s69, 442368
    buffer_load_dwordx4 v[84:87], v1, s[44:47], s63 offen nt
    s_memrealtime s[8:9]
    s_waitcnt vmcnt(9)
    s_waitcnt lgkmcnt(0)
    s_sub_u32 s8, s8, s30
    s_cmpk_ge_u32 s8, 2252
    s_cbranch_scc1 .ap_189
    s_waitcnt vmcnt(5)
    s_cmpk_ge_u32 s8, 2152
    s_cbranch_scc1 .ap_189
    s_waitcnt vmcnt(4)
    s_bitcmp1_b64 s[14:15], 63
    s_cbranch_scc0 1
    s_waitcnt vmcnt(2)
    s_cmpk_ge_u32 s8, 2032
    s_cbranch_scc1 .ap_189
    s_waitcnt vmcnt(1)
.ap_189:
    s_add_u32 s63, s69, 450560
    buffer_load_dwordx4 v[92:95], v1, s[44:47], s63 offen nt
    s_setprio 0
    s_waitcnt vmcnt(6)
    s_branch .gpc_191
.gp_190:
    buffer_load_dwordx4 v[24:27], v9, s[36:39], s59 offen offset:0 sc1
    s_waitcnt vmcnt(0)
.gpc_191:
    v_cmp_eq_u32 vcc, s34, v26
    s_cmp_eq_u64 vcc, -1
    s_nop 3
    s_cbranch_scc1 .gpd_192
    s_sub_u32 s35, s35, 1
    s_cbranch_scc1 .Lexit
    s_sleep 1
    s_branch .gp_190
.gpd_192:
    v_cmp_eq_u32 vcc, s1, v28
    s_cmp_eq_u64 vcc, -1
    s_cselect_b32 s0, 0x800000, 0
    v_mov_b32 v16, v24
    s_nop 1
    v_max_f32_dpp v16, v16, v16 row_ror:4 row_mask:0xf bank_mask:0xf
    v_sub_f32 v17, v24, v16
    v_sub_f32 v18, v14, v16
    v_mul_f32 v17, 0x3fb8aa3b, v17
    v_mul_f32 v18, 0x3fb8aa3b, v18
    v_exp_f32 v17, v17
    v_exp_f32 v18, v18
    v_mul_f32 v17, v17, v25
    s_nop 1
    v_add_f32_dpp v17, v17, v17 row_ror:4 row_mask:0xf bank_mask:0xf
    v_rcp_f32 v19, v17
    s_nop 0
    v_fma_f32 v15, -v17, v19, 1.0
    v_fma_f32 v19, v15, v19, v19
    v_mul_f32 v18, v18, v19
    v_mul_f32 v10, v10, v18
    v_mul_f32 v11, v11, v18
    v_mul_f32 v12, v12, v18
    v_mul_f32 v13, v13, v18
    v_mov_b32_dpp v112, v10 quad_perm:[2,3,0,1] row_mask:0xf bank_mask:0xf
    v_mov_b32_dpp v113, v11 quad_perm:[2,3,0,1] row_mask:0xf bank_mask:0xf
    v_mov_b32_dpp v114, v12 quad_perm:[2,3,0,1] row_mask:0xf bank_mask:0xf
    v_mov_b32_dpp v115, v13 quad_perm:[2,3,0,1] row_mask:0xf bank_mask:0xf
    v_cvt_pk_bf16_f32 v96, v10, v112
    v_cvt_pk_bf16_f32 v100, v11, v113
    v_cvt_pk_bf16_f32 v104, v12, v114
    v_cvt_pk_bf16_f32 v108, v13, v115
    v_mov_b32_dpp v97, v96 row_ror:12 row_mask:0xf bank_mask:0xf
    v_mov_b32_dpp v101, v100 row_ror:12 row_mask:0xf bank_mask:0xf
    v_mov_b32_dpp v105, v104 row_ror:12 row_mask:0xf bank_mask:0xf
    v_mov_b32_dpp v109, v108 row_ror:12 row_mask:0xf bank_mask:0xf
    v_mov_b32_dpp v98, v96 row_ror:8 row_mask:0xf bank_mask:0xf
    v_mov_b32_dpp v102, v100 row_ror:8 row_mask:0xf bank_mask:0xf
    v_mov_b32_dpp v106, v104 row_ror:8 row_mask:0xf bank_mask:0xf
    v_mov_b32_dpp v110, v108 row_ror:8 row_mask:0xf bank_mask:0xf
    v_mov_b32_dpp v99, v96 row_ror:4 row_mask:0xf bank_mask:0xf
    v_mov_b32_dpp v103, v100 row_ror:4 row_mask:0xf bank_mask:0xf
    v_mov_b32_dpp v107, v104 row_ror:4 row_mask:0xf bank_mask:0xf
    v_mov_b32_dpp v111, v108 row_ror:4 row_mask:0xf bank_mask:0xf
    s_lshl_b32 s60, s3, 10
    s_add_u32 s60, s60, 147456
    v_lshlrev_b32 v10, 5, v0
    v_add_u32 v10, s60, v10
    v_perm_b32 v112, v164, v160, s94
    v_perm_b32 v113, v172, v168, s94
    v_perm_b32 v114, v180, v176, s94
    v_perm_b32 v115, v188, v184, s94
    s_nop 1
    v_mfma_f32_16x16x32_bf16 v[128:131], v[96:99], v[112:115], 0
    v_perm_b32 v116, v164, v160, s95
    v_perm_b32 v117, v172, v168, s95
    v_perm_b32 v118, v180, v176, s95
    v_perm_b32 v119, v188, v184, s95
    s_nop 1
    v_mfma_f32_16x16x32_bf16 v[132:135], v[96:99], v[116:119], 0
    v_perm_b32 v120, v165, v161, s94
    v_perm_b32 v121, v173, v169, s94
    v_perm_b32 v122, v181, v177, s94
    v_perm_b32 v123, v189, v185, s94
    s_nop 1
    v_mfma_f32_16x16x32_bf16 v[136:139], v[96:99], v[120:123], 0
    v_perm_b32 v124, v165, v161, s95
    v_perm_b32 v125, v173, v169, s95
    v_perm_b32 v126, v181, v177, s95
    v_perm_b32 v127, v189, v185, s95
    s_nop 1
    v_mfma_f32_16x16x32_bf16 v[140:143], v[96:99], v[124:127], 0
    v_perm_b32 v112, v166, v162, s94
    v_perm_b32 v113, v174, v170, s94
    v_perm_b32 v114, v182, v178, s94
    v_perm_b32 v115, v190, v186, s94
    s_nop 1
    v_mfma_f32_16x16x32_bf16 v[144:147], v[96:99], v[112:115], 0
    v_perm_b32 v116, v166, v162, s95
    v_perm_b32 v117, v174, v170, s95
    v_perm_b32 v118, v182, v178, s95
    v_perm_b32 v119, v190, v186, s95
    s_nop 1
    v_mfma_f32_16x16x32_bf16 v[148:151], v[96:99], v[116:119], 0
    v_perm_b32 v120, v167, v163, s94
    v_perm_b32 v121, v175, v171, s94
    v_perm_b32 v122, v183, v179, s94
    v_perm_b32 v123, v191, v187, s94
    s_nop 1
    v_mfma_f32_16x16x32_bf16 v[152:155], v[96:99], v[120:123], 0
    v_perm_b32 v124, v167, v163, s95
    v_perm_b32 v125, v175, v171, s95
    v_perm_b32 v126, v183, v179, s95
    v_perm_b32 v127, v191, v187, s95
    s_nop 1
    v_mfma_f32_16x16x32_bf16 v[156:159], v[96:99], v[124:127], 0
    v_perm_b32 v112, v196, v192, s94
    v_perm_b32 v113, v204, v200, s94
    v_perm_b32 v114, v212, v208, s94
    v_perm_b32 v115, v220, v216, s94
    s_nop 1
    v_mfma_f32_16x16x32_bf16 v[128:131], v[100:103], v[112:115], v[128:131]
    v_perm_b32 v116, v196, v192, s95
    v_perm_b32 v117, v204, v200, s95
    v_perm_b32 v118, v212, v208, s95
    v_perm_b32 v119, v220, v216, s95
    s_nop 1
    v_mfma_f32_16x16x32_bf16 v[132:135], v[100:103], v[116:119], v[132:135]
    s_branch .Lsk_b1_5
.Lst_b1_5:
    s_branch .Lrt_b1_5
.Lsk_b1_5:
    v_perm_b32 v120, v197, v193, s94
    v_perm_b32 v121, v205, v201, s94
    v_perm_b32 v122, v213, v209, s94
    v_perm_b32 v123, v221, v217, s94
    s_nop 1
    v_mfma_f32_16x16x32_bf16 v[136:139], v[100:103], v[120:123], v[136:139]
    v_perm_b32 v124, v197, v193, s95
    v_perm_b32 v125, v205, v201, s95
    v_perm_b32 v126, v213, v209, s95
    v_perm_b32 v127, v221, v217, s95
    s_nop 1
    v_mfma_f32_16x16x32_bf16 v[140:143], v[100:103], v[124:127], v[140:143]
    v_perm_b32 v112, v198, v194, s94
    v_perm_b32 v113, v206, v202, s94
    v_perm_b32 v114, v214, v210, s94
    v_perm_b32 v115, v222, v218, s94
    s_nop 1
    v_mfma_f32_16x16x32_bf16 v[144:147], v[100:103], v[112:115], v[144:147]
    v_perm_b32 v116, v198, v194, s95
    v_perm_b32 v117, v206, v202, s95
    v_perm_b32 v118, v214, v210, s95
    v_perm_b32 v119, v222, v218, s95
    s_nop 1
    v_mfma_f32_16x16x32_bf16 v[148:151], v[100:103], v[116:119], v[148:151]
    v_perm_b32 v120, v199, v195, s94
    v_perm_b32 v121, v207, v203, s94
    v_perm_b32 v122, v215, v211, s94
    v_perm_b32 v123, v223, v219, s94
    s_nop 1
    v_mfma_f32_16x16x32_bf16 v[152:155], v[100:103], v[120:123], v[152:155]
    v_perm_b32 v124, v199, v195, s95
    v_perm_b32 v125, v207, v203, s95
    v_perm_b32 v126, v215, v211, s95
    v_perm_b32 v127, v223, v219, s95
    s_nop 1
    v_mfma_f32_16x16x32_bf16 v[156:159], v[100:103], v[124:127], v[156:159]
    v_perm_b32 v112, v228, v224, s94
    v_perm_b32 v113, v236, v232, s94
    v_perm_b32 v114, v244, v240, s94
    v_perm_b32 v115, v252, v248, s94
    s_nop 1
    v_mfma_f32_16x16x32_bf16 v[128:131], v[104:107], v[112:115], v[128:131]
    v_perm_b32 v116, v228, v224, s95
    v_perm_b32 v117, v236, v232, s95
    v_perm_b32 v118, v244, v240, s95
    v_perm_b32 v119, v252, v248, s95
    s_nop 1
    v_mfma_f32_16x16x32_bf16 v[132:135], v[104:107], v[116:119], v[132:135]
    v_perm_b32 v120, v229, v225, s94
    v_perm_b32 v121, v237, v233, s94
    v_perm_b32 v122, v245, v241, s94
    v_perm_b32 v123, v253, v249, s94
    s_nop 1
    v_mfma_f32_16x16x32_bf16 v[136:139], v[104:107], v[120:123], v[136:139]
    v_perm_b32 v124, v229, v225, s95
    v_perm_b32 v125, v237, v233, s95
    v_perm_b32 v126, v245, v241, s95
    v_perm_b32 v127, v253, v249, s95
    s_nop 1
    v_mfma_f32_16x16x32_bf16 v[140:143], v[104:107], v[124:127], v[140:143]
    v_perm_b32 v112, v230, v226, s94
    v_perm_b32 v113, v238, v234, s94
    v_perm_b32 v114, v246, v242, s94
    v_perm_b32 v115, v254, v250, s94
    s_nop 1
    v_mfma_f32_16x16x32_bf16 v[144:147], v[104:107], v[112:115], v[144:147]
    v_perm_b32 v116, v230, v226, s95
    v_perm_b32 v117, v238, v234, s95
    v_perm_b32 v118, v246, v242, s95
    v_perm_b32 v119, v254, v250, s95
    s_nop 1
    v_mfma_f32_16x16x32_bf16 v[148:151], v[104:107], v[116:119], v[148:151]
    v_perm_b32 v120, v231, v227, s94
    v_perm_b32 v121, v239, v235, s94
    v_perm_b32 v122, v247, v243, s94
    v_perm_b32 v123, v255, v251, s94
    s_nop 1
    v_mfma_f32_16x16x32_bf16 v[152:155], v[104:107], v[120:123], v[152:155]
    v_perm_b32 v124, v231, v227, s95
    v_perm_b32 v125, v239, v235, s95
    v_perm_b32 v126, v247, v243, s95
    v_perm_b32 v127, v255, v251, s95
    s_nop 1
    v_mfma_f32_16x16x32_bf16 v[156:159], v[104:107], v[124:127], v[156:159]
    s_waitcnt vmcnt(0)
    s_add_u32 m0, s101, 90112
    s_add_u32 s56, s100, 1179648
    buffer_load_dwordx4 v6, s[52:55], s56 offen nt lds
    s_add_u32 m0, s101, 98304
    s_add_u32 s56, s100, 1769472
    buffer_load_dwordx4 v6, s[52:55], s56 offen nt lds
    s_add_u32 m0, s101, 106496
    s_add_u32 s56, s100, 2359296
    buffer_load_dwordx4 v6, s[52:55], s56 offen nt lds
    s_add_u32 m0, s101, 114688
    s_add_u32 s56, s100, 2949120
    buffer_load_dwordx4 v6, s[52:55], s56 offen nt lds
    s_add_u32 m0, s101, 122880
    s_add_u32 s56, s100, 3538944
    buffer_load_dwordx4 v6, s[52:55], s56 offen nt lds
    s_add_u32 m0, s101, 131072
    s_add_u32 s56, s100, 4128768
    buffer_load_dwordx4 v6, s[52:55], s56 offen nt lds
    s_add_u32 m0, s101, 139264
    s_add_u32 s56, s100, 4718592
    buffer_load_dwordx4 v6, s[52:55], s56 offen nt lds
    v_perm_b32 v112, v44, v36, s94
    v_perm_b32 v113, v60, v52, s94
    v_perm_b32 v114, v76, v68, s94
    v_perm_b32 v115, v92, v84, s94
    s_nop 1
    v_mfma_f32_16x16x32_bf16 v[128:131], v[108:111], v[112:115], v[128:131]
    v_perm_b32 v116, v44, v36, s95
    v_perm_b32 v117, v60, v52, s95
    v_perm_b32 v118, v76, v68, s95
    v_perm_b32 v119, v92, v84, s95
    s_nop 1
    v_mfma_f32_16x16x32_bf16 v[132:135], v[108:111], v[116:119], v[132:135]
    v_perm_b32 v120, v45, v37, s94
    v_perm_b32 v121, v61, v53, s94
    v_perm_b32 v122, v77, v69, s94
    v_perm_b32 v123, v93, v85, s94
    s_nop 1
    v_mfma_f32_16x16x32_bf16 v[136:139], v[108:111], v[120:123], v[136:139]
    v_perm_b32 v124, v45, v37, s95
    v_perm_b32 v125, v61, v53, s95
    v_perm_b32 v126, v77, v69, s95
    v_perm_b32 v127, v93, v85, s95
    s_nop 1
    v_mfma_f32_16x16x32_bf16 v[140:143], v[108:111], v[124:127], v[140:143]
    v_perm_b32 v112, v46, v38, s94
    v_perm_b32 v113, v62, v54, s94
    v_perm_b32 v114, v78, v70, s94
    v_perm_b32 v115, v94, v86, s94
    s_nop 1
    v_mfma_f32_16x16x32_bf16 v[144:147], v[108:111], v[112:115], v[144:147]
    v_perm_b32 v116, v46, v38, s95
    v_perm_b32 v117, v62, v54, s95
    v_perm_b32 v118, v78, v70, s95
    v_perm_b32 v119, v94, v86, s95
    s_nop 1
    v_mfma_f32_16x16x32_bf16 v[148:151], v[108:111], v[116:119], v[148:151]
    v_perm_b32 v120, v47, v39, s94
    v_perm_b32 v121, v63, v55, s94
    v_perm_b32 v122, v79, v71, s94
    s_branch .Lsk_b1_6
.Lst_b1_6:
    s_branch .Lrt_b1_6
.Lsk_b1_6:
    v_perm_b32 v123, v95, v87, s94
    s_nop 1
    v_mfma_f32_16x16x32_bf16 v[152:155], v[108:111], v[120:123], v[152:155]
    v_perm_b32 v124, v47, v39, s95
    v_perm_b32 v125, v63, v55, s95
    v_perm_b32 v126, v79, v71, s95
    v_perm_b32 v127, v95, v87, s95
    s_nop 1
    v_mfma_f32_16x16x32_bf16 v[156:159], v[108:111], v[124:127], v[156:159]
    s_mov_b64 exec, 0xffff
    ds_write2_b32 v10, v128, v129 offset0:0 offset1:128
    ds_write2_b32 v10, v132, v133 offset0:1 offset1:129
    ds_write2_b32 v10, v136, v137 offset0:2 offset1:130
    ds_write2_b32 v10, v140, v141 offset0:3 offset1:131
    ds_write2_b32 v10, v144, v145 offset0:4 offset1:132
    ds_write2_b32 v10, v148, v149 offset0:5 offset1:133
    ds_write2_b32 v10, v152, v153 offset0:6 offset1:134
    ds_write2_b32 v10, v156, v157 offset0:7 offset1:135
    s_mov_b64 exec, -1
    s_waitcnt lgkmcnt(0)
    s_barrier
    s_cmp_lg_u32 s3, 7
    s_cbranch_scc1 .opub_193
    v_add_u32 v10, 147456, v2
    ds_read_b128 v[196:199], v10 offset:0
    ds_read_b128 v[200:203], v10 offset:1024
    ds_read_b128 v[204:207], v10 offset:2048
    ds_read_b128 v[208:211], v10 offset:3072
    ds_read_b128 v[212:215], v10 offset:4096
    ds_read_b128 v[216:219], v10 offset:5120
    ds_read_b128 v[220:223], v10 offset:6144
    ds_read_b128 v[224:227], v10 offset:7168
    v_lshrrev_b32 v11, 5, v0
    v_lshlrev_b32 v11, 13, v11
    v_and_b32 v12, 31, v0
    v_lshl_add_u32 v11, v12, 4, v11
    s_lshl4_add_u32 s56, s67, s66
    s_lshl1_add_u32 s56, s56, s68
    s_lshl_b32 s56, s56, 9
    s_add_u32 s56, s56, 0xa0000
    s_mov_b32 s60, 0x07060503
    s_mov_b32 s61, 0x07060502
    s_mov_b32 s62, 0x07060501
    v_mov_b32 v15, s34
    s_waitcnt lgkmcnt(6)
    v_pk_add_f32 v[196:197], v[196:197], v[200:201]
    v_pk_add_f32 v[198:199], v[198:199], v[202:203]
    s_waitcnt lgkmcnt(5)
    v_pk_add_f32 v[196:197], v[196:197], v[204:205]
    v_pk_add_f32 v[198:199], v[198:199], v[206:207]
    s_waitcnt lgkmcnt(4)
    v_pk_add_f32 v[196:197], v[196:197], v[208:209]
    v_pk_add_f32 v[198:199], v[198:199], v[210:211]
    s_waitcnt lgkmcnt(3)
    v_pk_add_f32 v[196:197], v[196:197], v[212:213]
    v_pk_add_f32 v[198:199], v[198:199], v[214:215]
    s_waitcnt lgkmcnt(2)
    v_pk_add_f32 v[196:197], v[196:197], v[216:217]
    v_pk_add_f32 v[198:199], v[198:199], v[218:219]
    s_waitcnt lgkmcnt(1)
    v_pk_add_f32 v[196:197], v[196:197], v[220:221]
    v_pk_add_f32 v[198:199], v[198:199], v[222:223]
    s_waitcnt lgkmcnt(0)
    v_pk_add_f32 v[196:197], v[196:197], v[224:225]
    v_pk_add_f32 v[198:199], v[198:199], v[226:227]
    v_perm_b32 v12, v196, v199, s60
    v_perm_b32 v13, v197, v199, s61
    v_perm_b32 v14, v198, v199, s62
    s_add_u32 s57, s56, 0x800000
    buffer_store_dwordx4 v[12:15], v11, s[36:39], s57 offen
    buffer_store_dwordx4 v[12:15], v11, s[36:39], s56 offen sc1
.opub_193:
    s_mov_b32 s61, s101
    v_lshrrev_b32 v25, 4, v0
    v_bfe_u32 v26, v0, 1, 1
    v_lshl_add_u32 v25, v25, 1, v26
    v_bfe_u32 v26, v0, 2, 2
    v_lshl_add_u32 v19, v25, 3, v26
    v_lshlrev_b32 v19, 7, v19
    v_and_b32 v25, 3, v25
    v_lshrrev_b32 v26, 1, v26
    v_lshl_add_u32 v25, v25, 1, v26
    v_xor_b32 v25, s3, v25
    v_lshl_add_u32 v19, v25, 4, v19
    v_and_b32 v25, 1, v0
    v_lshl_add_u32 v19, v25, 3, v19
    v_add_u32 v20, 32768, v19
    ds_read_b64_tr_b16 v[160:161], v19 offset:0
    ds_read_b64_tr_b16 v[162:163], v19 offset:512
    ds_read_b64_tr_b16 v[164:165], v19 offset:8192
    ds_read_b64_tr_b16 v[166:167], v19 offset:8704
    ds_read_b64_tr_b16 v[168:169], v19 offset:16384
    ds_read_b64_tr_b16 v[170:171], v19 offset:16896
    ds_read_b64_tr_b16 v[172:173], v19 offset:24576
    ds_read_b64_tr_b16 v[174:175], v19 offset:25088
    ds_read_b64_tr_b16 v[176:177], v20 offset:0
    ds_read_b64_tr_b16 v[178:179], v20 offset:512
    ds_read_b64_tr_b16 v[180:181], v20 offset:8192
    ds_read_b64_tr_b16 v[182:183], v20 offset:8704
    ds_read_b64_tr_b16 v[184:185], v20 offset:16384
    ds_read_b64_tr_b16 v[186:187], v20 offset:16896
    ds_read_b64_tr_b16 v[188:189], v20 offset:24576
    ds_read_b64_tr_b16 v[190:191], v20 offset:25088
    ds_read_b64_tr_b16 v[192:193], v20 offset:32768
    ds_read_b64_tr_b16 v[194:195], v20 offset:33280
    v_add_u32 v19, 73728, v19
    v_add_u32 v20, 73728, v20
    s_mov_b32 s48, s22
    s_and_b32 s49, s23, 0xffff
    s_mov_b32 s50, 0x510000
    s_mov_b32 s51, 0x00020000
    s_mul_i32 s69, s99, 73728
    s_mul_i32 s56, s3, 9216
    s_add_u32 s69, s69, s56
    v_bfe_u32 v25, v0, 4, 1
    s_and_b32 s56, s3, 1
    s_lshl_b32 s56, s56, 2
    v_lshl_or_b32 v25, v25, 1, s56
    v_and_b32 v26, 7, v0
    v_xor_b32 v25, v25, v26
    v_lshrrev_b32 v26, 3, v0
    v_mul_u32_u24 v26, 1152, v26
    s_branch .Lsk_b1_7
.Lst_b1_7:
    s_branch .Lrt_b1_7
.Lsk_b1_7:
    v_lshl_add_u32 v24, v25, 4, v26
    s_and_b32 s58, s64, 0
    s_mul_i32 s58, s58, 18432
    s_mul_i32 s59, s3, 2304
    s_add_u32 s58, s58, s59
    s_add_u32 s62, s58, 0x37000
    s_add_u32 s63, s58, 0x49000
    s_mul_i32 s101, s64, 18432
    s_add_u32 s101, s101, s59
    s_add_u32 s101, s101, 0x170000
    s_waitcnt lgkmcnt(0)
    s_barrier
    s_add_u32 m0, s61, 0
    s_nop 0
    buffer_load_dwordx4 v24, s[48:51], s69 offen offset:0 nt lds
    s_add_u32 m0, s61, 8064
    s_nop 0
    buffer_load_dwordx4 v24, s[48:51], s69 offen offset:128 nt lds
    s_add_u32 m0, s61, 16128
    s_nop 0
    buffer_load_dwordx4 v24, s[48:51], s69 offen offset:256 nt lds
    s_add_u32 m0, s61, 24192
    s_nop 0
    buffer_load_dwordx4 v24, s[48:51], s69 offen offset:384 nt lds
    s_add_u32 m0, s61, 32256
    s_nop 0
    buffer_load_dwordx4 v24, s[48:51], s69 offen offset:512 nt lds
    s_add_u32 m0, s61, 40320
    s_nop 0
    buffer_load_dwordx4 v24, s[48:51], s69 offen offset:640 nt lds
    s_add_u32 m0, s61, 48384
    s_nop 0
    buffer_load_dwordx4 v24, s[48:51], s69 offen offset:768 nt lds
    s_add_u32 m0, s61, 56448
    s_nop 0
    buffer_load_dwordx4 v24, s[48:51], s69 offen offset:896 nt lds
    s_add_u32 m0, s61, 64512
    s_nop 0
    buffer_load_dwordx4 v24, s[48:51], s69 offen offset:1024 nt lds
    v_bfe_u32 v16, v0, 1, 3
    v_mul_u32_u24 v16, 1312, v16
    v_lshrrev_b32 v25, 4, v0
    v_lshl_add_u32 v16, v25, 5, v16
    v_and_b32 v25, 1, v0
    v_lshl_add_u32 v16, v25, 4, v16
    v_add_u32 v16, 147456, v16
    s_mul_i32 s56, s3, 1312
    s_add_u32 s56, s56, 147456
    v_add_u32 v17, s56, v3
    v_add_u32 v18, s56, v4
    v_bfe_u32 v21, v0, 1, 3
    v_mul_u32_u24 v21, 144, v21
    v_bfe_u32 v25, v0, 4, 1
    v_lshl_add_u32 v21, v25, 3, v21
    v_lshrrev_b32 v25, 5, v0
    v_lshl_add_u32 v21, v25, 2, v21
    v_and_b32 v25, 1, v0
    v_lshl_add_u32 v21, v25, 1, v21
    s_lshl_b32 s56, s3, 4
    s_add_u32 s56, s56, 157952
    v_add_u32 v21, s56, v21
    v_and_b32 v22, 15, v0
    v_lshlrev_b32 v22, 3, v22
    s_mul_i32 s56, s3, 144
    s_add_u32 s56, s56, 157952
    v_add_u32 v22, s56, v22
    s_mov_b32 s56, 157952
    v_bfe_u32 v22, v0, 1, 3
    v_mul_u32_u24 v22, 144, v22
    v_and_b32 v25, 48, v0
    v_add3_u32 v22, v22, v25, s56
    v_bfe_u32 v23, v0, 1, 3
    v_mul_u32_u24 v23, 9216, v23
    v_and_b32 v25, 1, v0
    v_lshl_add_u32 v23, v25, 4, v23
    v_and_b32 v25, 48, v0
    v_lshl_add_u32 v23, v25, 1, v23
    v_lshrrev_b32 v25, 4, v0
    v_bfe_u32 v26, v0, 2, 2
    v_lshl_add_u32 v28, v25, 3, v26
    v_lshlrev_b32 v28, 7, v28
    v_and_b32 v25, 1, v25
    v_lshrrev_b32 v26, 1, v26
    v_lshl_add_u32 v25, v25, 1, v26
    s_and_b32 s56, s3, 1
    s_lshl_b32 s56, s56, 1
    v_xor_b32 v25, s56, v25
    v_and_b32 v26, 3, v0
    v_lshl_add_u32 v28, v26, 3, v28
    s_lshr_b32 s56, s3, 1
    s_lshl_b32 s56, s56, 13
    v_add_u32 v28, s56, v28
    v_xor_b32 v26, 1, v25
    v_lshl_add_u32 v29, v26, 5, v28
    v_lshl_add_u32 v28, v25, 5, v28
    v_add_u32 v30, 0x10000, v28
    v_add_u32 v31, 0x10000, v29
    s_mul_i32 s59, s3, 73728
    s_lshl_b32 s56, s99, 7
    s_add_u32 s59, s59, s56
    s_add_u32 s59, s59, 0x1a0000
    s_add_u32 s99, s59, 589824
    s_add_u32 s100, s59, 1179648
    s_branch .gpc_195
.gp_194:
    buffer_load_dwordx4 v[32:35], v2, s[36:39], s62 offen offset:0 sc1
    buffer_load_dwordx4 v[40:43], v2, s[36:39], s62 offen offset:1024 sc1
    buffer_load_dwordx2 v[48:49], v5, s[36:39], s62 offen offset:0 sc1
    buffer_load_dwordx4 v[56:59], v2, s[36:39], s63 offen offset:0 sc1
    buffer_load_dwordx4 v[64:67], v2, s[36:39], s63 offen offset:1024 sc1
    buffer_load_dwordx2 v[72:73], v5, s[36:39], s63 offen offset:0 sc1
    s_waitcnt vmcnt(0)
.gpc_195:
    v_min_u32 v25, v33, v35
    v_max_u32 v26, v33, v35
    v_min3_u32 v25, v25, v41, v43
    v_max3_u32 v26, v26, v41, v43
    v_min3_u32 v25, v25, v49, v57
    v_max3_u32 v26, v26, v49, v57
    v_min3_u32 v25, v25, v59, v65
    v_max3_u32 v26, v26, v59, v65
    v_min3_u32 v25, v25, v67, v73
    v_max3_u32 v26, v26, v67, v73
    v_cmp_eq_u32 vcc, s34, v25
    v_cmp_eq_u32 s[56:57], s34, v26
    s_and_b64 vcc, vcc, s[56:57]
    s_cmp_eq_u64 vcc, -1
    s_nop 2
    s_cbranch_scc1 .gpd_196
    s_sub_u32 s35, s35, 1
    s_cbranch_scc1 .Lexit
    s_sleep 2
    s_branch .gp_194
.gpd_196:
    v_lshlrev_b32 v206, 16, v32
    v_and_b32 v207, 0xffff0000, v32
    v_lshlrev_b32 v216, 16, v56
    v_and_b32 v217, 0xffff0000, v56
    v_lshlrev_b32 v208, 16, v34
    v_and_b32 v209, 0xffff0000, v34
    v_lshlrev_b32 v218, 16, v58
    v_and_b32 v219, 0xffff0000, v58
    v_lshlrev_b32 v210, 16, v40
    v_and_b32 v211, 0xffff0000, v40
    v_lshlrev_b32 v220, 16, v64
    v_and_b32 v221, 0xffff0000, v64
    v_lshlrev_b32 v212, 16, v42
    v_and_b32 v213, 0xffff0000, v42
    v_lshlrev_b32 v222, 16, v66
    v_and_b32 v223, 0xffff0000, v66
    v_lshlrev_b32 v214, 16, v48
    v_and_b32 v215, 0xffff0000, v48
    v_lshlrev_b32 v224, 16, v72
    v_and_b32 v225, 0xffff0000, v72
    s_waitcnt vmcnt(9)
    s_barrier
    ds_read_b64_tr_b16 v[68:69], v19 offset:0
    ds_read_b64_tr_b16 v[70:71], v19 offset:512
    ds_read_b64_tr_b16 v[72:73], v19 offset:8192
    ds_read_b64_tr_b16 v[74:75], v19 offset:8704
    ds_read_b64_tr_b16 v[76:77], v19 offset:16384
    ds_read_b64_tr_b16 v[78:79], v19 offset:16896
    ds_read_b64_tr_b16 v[80:81], v19 offset:24576
    ds_read_b64_tr_b16 v[82:83], v19 offset:25088
    ds_read_b64_tr_b16 v[84:85], v20 offset:0
    ds_read_b64_tr_b16 v[86:87], v20 offset:512
    ds_read_b64_tr_b16 v[88:89], v20 offset:8192
    ds_read_b64_tr_b16 v[90:91], v20 offset:8704
    ds_read_b64_tr_b16 v[92:93], v20 offset:16384
    ds_read_b64_tr_b16 v[94:95], v20 offset:16896
    ds_read_b64_tr_b16 v[96:97], v20 offset:24576
    ds_read_b64_tr_b16 v[98:99], v20 offset:25088
    s_branch .Lsk_b2_0
.Lst_b2_0:
    s_branch .Lrt_b2_0
.Lsk_b2_0:
    ds_read_b64_tr_b16 v[100:101], v20 offset:32768
    ds_read_b64_tr_b16 v[102:103], v20 offset:33280
    s_waitcnt vmcnt(0)
    s_barrier
    ds_read_b64_tr_b16 v[104:105], v28 offset:0
    ds_read_b64_tr_b16 v[106:107], v28 offset:512
    ds_read_b64_tr_b16 v[108:109], v29 offset:0
    ds_read_b64_tr_b16 v[110:111], v29 offset:512
    ds_read_b64_tr_b16 v[112:113], v28 offset:4096
    ds_read_b64_tr_b16 v[114:115], v28 offset:4608
    ds_read_b64_tr_b16 v[116:117], v29 offset:4096
    ds_read_b64_tr_b16 v[118:119], v29 offset:4608
    ds_read_b64_tr_b16 v[120:121], v28 offset:32768
    ds_read_b64_tr_b16 v[122:123], v28 offset:33280
    ds_read_b64_tr_b16 v[124:125], v29 offset:32768
    ds_read_b64_tr_b16 v[126:127], v29 offset:33280
    ds_read_b64_tr_b16 v[128:129], v28 offset:36864
    ds_read_b64_tr_b16 v[130:131], v28 offset:37376
    ds_read_b64_tr_b16 v[132:133], v29 offset:36864
    ds_read_b64_tr_b16 v[134:135], v29 offset:37376
    s_cmp_ge_u32 s3, 2
    s_cbranch_scc1 .Lbc_nodn3
    ds_read_b64_tr_b16 v[136:137], v30 offset:0
    ds_read_b64_tr_b16 v[138:139], v30 offset:512
    ds_read_b64_tr_b16 v[140:141], v31 offset:0
    ds_read_b64_tr_b16 v[142:143], v31 offset:512
    ds_read_b64_tr_b16 v[144:145], v30 offset:4096
    ds_read_b64_tr_b16 v[146:147], v30 offset:4608
    ds_read_b64_tr_b16 v[148:149], v31 offset:4096
    ds_read_b64_tr_b16 v[150:151], v31 offset:4608
.Lbc_nodn3:
    s_mov_b32 s69, 0
.gp_197:
    s_add_u32 s69, s69, 1
    s_and_b32 s56, s69, 0x41
    s_cmp_lg_u32 s56, 0x41
    s_cselect_b32 s56, s0, 0
    s_add_u32 s58, s101, s56
    buffer_load_dwordx4 v[196:199], v2, s[36:39], s58 offen offset:0 sc1
    buffer_load_dwordx4 v[200:203], v2, s[36:39], s58 offen offset:1024 sc1
    buffer_load_dwordx2 v[204:205], v5, s[36:39], s58 offen offset:0 sc1
    s_waitcnt vmcnt(0)
    v_min3_u32 v25, v197, v199, v201
    v_max3_u32 v26, v197, v199, v201
    v_min3_u32 v25, v25, v203, v205
    v_max3_u32 v26, v26, v203, v205
    v_cmp_eq_u32 vcc, s34, v25
    v_cmp_eq_u32 s[56:57], s34, v26
    s_and_b64 vcc, vcc, s[56:57]
    s_cmp_eq_u64 vcc, -1
    s_nop 2
    s_cbranch_scc1 .gpd_198
    s_sub_u32 s35, s35, 1
    s_cbranch_scc1 .Lexit
    s_branch .gp_197
.gpd_198:
    s_mov_b32 s56, 0x3f803f80
    v_dot2_f32_bf16 v236, v196, s56, 0
    v_dot2_f32_bf16 v237, v196, v196, 0
    v_dot2_f32_bf16 v236, v198, s56, v236
    v_dot2_f32_bf16 v237, v198, v198, v237
    v_dot2_f32_bf16 v236, v200, s56, v236
    v_dot2_f32_bf16 v237, v200, v200, v237
    v_dot2_f32_bf16 v236, v202, s56, v236
    v_dot2_f32_bf16 v237, v202, v202, v237
    s_mov_b64 exec, 0xffffffff
    v_dot2_f32_bf16 v236, v204, s56, v236
    v_dot2_f32_bf16 v237, v204, v204, v237
    s_mov_b64 exec, -1
    s_nop 1
    v_permlane32_swap_b32 v236, v237
    v_add_f32 v236, v236, v237
    v_mov_b32 v238, v236
    s_nop 1
    v_permlane16_swap_b32 v238, v236
    v_add_f32 v236, v238, v236
    v_lshlrev_b32 v226, 16, v196
    v_and_b32 v227, 0xffff0000, v196
    v_add_f32_dpp v236, v236, v236 row_ror:8 row_mask:0xf bank_mask:0xf
    v_lshlrev_b32 v228, 16, v198
    v_and_b32 v229, 0xffff0000, v198
    v_add_f32_dpp v236, v236, v236 row_ror:4 row_mask:0xf bank_mask:0xf
    v_lshlrev_b32 v230, 16, v200
    v_and_b32 v231, 0xffff0000, v200
    v_add_f32_dpp v236, v236, v236 quad_perm:[2,3,0,1] row_mask:0xf bank_mask:0xf
    v_lshlrev_b32 v232, 16, v202
    v_and_b32 v233, 0xffff0000, v202
    v_add_f32_dpp v236, v236, v236 quad_perm:[1,0,3,2] row_mask:0xf bank_mask:0xf
    v_mul_f32 v236, 0x3ae38e39, v236
    v_lshlrev_b32 v234, 16, v204
    v_and_b32 v235, 0xffff0000, v204
    v_readlane_b32 s56, v236, 0
    v_readlane_b32 s57, v236, 32
    s_nop 0
    v_mov_b32 v236, s56
    v_fma_f32 v237, -v236, v236, s57
    v_max_f32 v237, 0, v237
    v_cvt_pk_bf16_f32 v238, -v236, v237
    v_and_b32 v239, 0xffff0000, v238
    v_add_f32 v239, 0x3727c5ac, v239
    v_lshlrev_b32 v236, 16, v238
    v_cvt_pk_bf16_f32 v239, v239, v239
    v_lshlrev_b32 v239, 16, v239
    v_sqrt_f32 v239, v239
    v_mov_b32 v237, v236
    v_cvt_pk_bf16_f32 v239, v239, v239
    v_lshlrev_b32 v239, 16, v239
    v_rcp_f32 v238, v239
    v_rcp_f32 v239, v239
    v_pk_add_f32 v[226:227], v[226:227], v[236:237]
    v_pk_add_f32 v[228:229], v[228:229], v[236:237]
    v_pk_add_f32 v[230:231], v[230:231], v[236:237]
    v_pk_add_f32 v[232:233], v[232:233], v[236:237]
    v_pk_add_f32 v[234:235], v[234:235], v[236:237]
    v_cvt_pk_bf16_f32 v226, v226, v227
    v_and_b32 v227, 0xffff0000, v226
    v_lshlrev_b32 v226, 16, v226
    v_cvt_pk_bf16_f32 v228, v228, v229
    v_and_b32 v229, 0xffff0000, v228
    v_lshlrev_b32 v228, 16, v228
    v_cvt_pk_bf16_f32 v230, v230, v231
    v_and_b32 v231, 0xffff0000, v230
    v_lshlrev_b32 v230, 16, v230
    v_cvt_pk_bf16_f32 v232, v232, v233
    v_and_b32 v233, 0xffff0000, v232
    v_lshlrev_b32 v232, 16, v232
    v_cvt_pk_bf16_f32 v234, v234, v235
    v_and_b32 v235, 0xffff0000, v234
    v_lshlrev_b32 v234, 16, v234
    v_pk_mul_f32 v[226:227], v[226:227], v[238:239]
    v_pk_mul_f32 v[228:229], v[228:229], v[238:239]
    v_pk_mul_f32 v[230:231], v[230:231], v[238:239]
    v_pk_mul_f32 v[232:233], v[232:233], v[238:239]
    v_pk_mul_f32 v[234:235], v[234:235], v[238:239]
    v_cvt_pk_bf16_f32 v226, v226, v227
    v_and_b32 v227, 0xffff0000, v226
    v_lshlrev_b32 v226, 16, v226
    v_cvt_pk_bf16_f32 v228, v228, v229
    v_and_b32 v229, 0xffff0000, v228
    v_lshlrev_b32 v228, 16, v228
    v_cvt_pk_bf16_f32 v230, v230, v231
    v_and_b32 v231, 0xffff0000, v230
    v_lshlrev_b32 v230, 16, v230
    v_cvt_pk_bf16_f32 v232, v232, v233
    v_and_b32 v233, 0xffff0000, v232
    v_lshlrev_b32 v232, 16, v232
    v_cvt_pk_bf16_f32 v234, v234, v235
    v_and_b32 v235, 0xffff0000, v234
    v_lshlrev_b32 v234, 16, v234
    v_pk_mul_f32 v[226:227], v[226:227], v[216:217]
    v_pk_mul_f32 v[228:229], v[228:229], v[218:219]
    v_pk_mul_f32 v[230:231], v[230:231], v[220:221]
    v_pk_mul_f32 v[232:233], v[232:233], v[222:223]
    v_pk_mul_f32 v[234:235], v[234:235], v[224:225]
    v_cvt_pk_bf16_f32 v226, v226, v227
    v_and_b32 v227, 0xffff0000, v226
    v_lshlrev_b32 v226, 16, v226
    v_cvt_pk_bf16_f32 v228, v228, v229
    v_and_b32 v229, 0xffff0000, v228
    v_lshlrev_b32 v228, 16, v228
    v_cvt_pk_bf16_f32 v230, v230, v231
    v_and_b32 v231, 0xffff0000, v230
    v_lshlrev_b32 v230, 16, v230
    v_cvt_pk_bf16_f32 v232, v232, v233
    s_branch .Lsk_b2_1
.Lst_b2_1:
    s_branch .Lrt_b2_1
.Lsk_b2_1:
    v_and_b32 v233, 0xffff0000, v232
    v_lshlrev_b32 v232, 16, v232
    v_cvt_pk_bf16_f32 v234, v234, v235
    v_and_b32 v235, 0xffff0000, v234
    v_lshlrev_b32 v234, 16, v234
    v_pk_add_f32 v[226:227], v[226:227], v[206:207]
    v_pk_add_f32 v[228:229], v[228:229], v[208:209]
    v_pk_add_f32 v[230:231], v[230:231], v[210:211]
    v_pk_add_f32 v[232:233], v[232:233], v[212:213]
    v_pk_add_f32 v[234:235], v[234:235], v[214:215]
    v_cvt_pk_bf16_f32 v242, v226, v227
    v_cvt_pk_bf16_f32 v243, v228, v229
    v_cvt_pk_bf16_f32 v244, v230, v231
    v_cvt_pk_bf16_f32 v245, v232, v233
    v_cvt_pk_bf16_f32 v246, v234, v235
    ds_write_b64 v17, v[242:243] offset:0
    ds_write_b64 v17, v[244:245] offset:512
    ds_write_b32 v18, v246 offset:0
    s_waitcnt lgkmcnt(0)
    s_barrier
    ds_read_b128 v[32:35], v16 offset:0
    ds_read_b128 v[36:39], v16 offset:128
    ds_read_b128 v[40:43], v16 offset:256
    ds_read_b128 v[44:47], v16 offset:384
    ds_read_b128 v[48:51], v16 offset:512
    ds_read_b128 v[52:55], v16 offset:640
    ds_read_b128 v[56:59], v16 offset:768
    ds_read_b128 v[60:63], v16 offset:896
    ds_read_b128 v[64:67], v16 offset:1024
    s_waitcnt lgkmcnt(8)
    v_mfma_f32_16x16x32_bf16 v[152:155], v[160:163], v[32:35], 0
    v_mfma_f32_16x16x32_bf16 v[156:159], v[68:71], v[32:35], 0
    s_waitcnt lgkmcnt(7)
    v_mfma_f32_16x16x32_bf16 v[152:155], v[164:167], v[36:39], v[152:155]
    v_mfma_f32_16x16x32_bf16 v[156:159], v[72:75], v[36:39], v[156:159]
    s_waitcnt lgkmcnt(6)
    v_mfma_f32_16x16x32_bf16 v[152:155], v[168:171], v[40:43], v[152:155]
    v_mfma_f32_16x16x32_bf16 v[156:159], v[76:79], v[40:43], v[156:159]
    s_waitcnt lgkmcnt(5)
    v_mfma_f32_16x16x32_bf16 v[152:155], v[172:175], v[44:47], v[152:155]
    v_mfma_f32_16x16x32_bf16 v[156:159], v[80:83], v[44:47], v[156:159]
    s_waitcnt lgkmcnt(4)
    v_mfma_f32_16x16x32_bf16 v[152:155], v[176:179], v[48:51], v[152:155]
    v_mfma_f32_16x16x32_bf16 v[156:159], v[84:87], v[48:51], v[156:159]
    s_waitcnt lgkmcnt(3)
    v_mfma_f32_16x16x32_bf16 v[152:155], v[180:183], v[52:55], v[152:155]
    v_mfma_f32_16x16x32_bf16 v[156:159], v[88:91], v[52:55], v[156:159]
    s_waitcnt lgkmcnt(2)
    v_mfma_f32_16x16x32_bf16 v[152:155], v[184:187], v[56:59], v[152:155]
    v_mfma_f32_16x16x32_bf16 v[156:159], v[92:95], v[56:59], v[156:159]
    s_waitcnt lgkmcnt(1)
    v_mfma_f32_16x16x32_bf16 v[152:155], v[188:191], v[60:63], v[152:155]
    v_mfma_f32_16x16x32_bf16 v[156:159], v[96:99], v[60:63], v[156:159]
    s_waitcnt lgkmcnt(0)
    v_mfma_f32_16x16x32_bf16 v[152:155], v[192:195], v[64:67], v[152:155]
    v_mfma_f32_16x16x32_bf16 v[156:159], v[100:103], v[64:67], v[156:159]
    s_nop 6
    v_permlane32_swap_b32 v152, v154
    v_permlane32_swap_b32 v153, v155
    v_permlane32_swap_b32 v156, v158
    v_permlane32_swap_b32 v157, v159
    v_cndmask_b32 v153, v153, v154, s[96:97]
    v_cndmask_b32 v152, v152, v155, s[96:97]
    v_cndmask_b32 v157, v157, v158, s[96:97]
    v_cndmask_b32 v156, v156, v159, s[96:97]
    v_add_f32_dpp v12, v153, v152 quad_perm:[1,0,3,2] row_mask:0xf bank_mask:0xf
    s_nop 0
    v_add_f32_dpp v13, v157, v156 quad_perm:[1,0,3,2] row_mask:0xf bank_mask:0xf
    v_cvt_pk_bf16_f32 v12, v12, v13
    v_and_b32 v14, 0xffff0000, v12
    v_lshlrev_b32 v12, 16, v12
    v_max_f32 v12, 0xc2ae0000, v12
    v_min_f32 v27, 0x43000000, v12
    v_mul_f32 v25, 0xbfb8aa3b, v27
    v_fma_f32 v26, v27, s98, -v25
    v_fmac_f32 v26, 0xb2a57060, v27
    v_exp_f32 v25, v25
    v_mul_f32 v26, 0x3f317218, v26
    v_fmac_f32 v25, v25, v26
    v_add_f32 v25, 1.0, v25
    v_rcp_f32 v26, v25
    s_nop 0
    v_mul_f32 v27, v12, v26
    v_fma_f32 v25, -v27, v25, v12
    v_fma_f32 v12, v25, v26, v27
    v_cvt_pk_bf16_f32 v12, v12, v12
    v_lshlrev_b32 v12, 16, v12
    v_mul_f32 v12, v12, v14
    v_cvt_pk_bf16_f32 v12, v12, v12
    ds_write_b16 v21, v12
    s_mov_b32 s60, 0x07060503
    s_mov_b32 s61, 0x07060502
    s_mov_b32 s62, 0x07060501
    s_mov_b32 vcc_lo, 0xaaaaaaaa
    s_mov_b32 vcc_hi, 0xaaaaaaaa
    v_mov_b32 v59, s34
    v_mov_b32 v63, s34
    v_mov_b32 v67, s34
    s_cmp_ge_u32 s3, 2
    s_waitcnt lgkmcnt(0)
    s_barrier
    ds_read_b128 v[8:11], v22
    ds_read_b128 v[12:15], v22 offset:64
    s_waitcnt lgkmcnt(1)
    v_mfma_f32_16x16x32_bf16 v[32:35], v[104:107], v[8:11], 0
    v_mfma_f32_16x16x32_bf16 v[36:39], v[108:111], v[8:11], 0
    s_waitcnt lgkmcnt(0)
    v_mfma_f32_16x16x32_bf16 v[32:35], v[112:115], v[12:15], v[32:35]
    v_mfma_f32_16x16x32_bf16 v[36:39], v[116:119], v[12:15], v[36:39]
    v_mfma_f32_16x16x32_bf16 v[40:43], v[120:123], v[8:11], 0
    v_mfma_f32_16x16x32_bf16 v[44:47], v[124:127], v[8:11], 0
    v_mfma_f32_16x16x32_bf16 v[40:43], v[128:131], v[12:15], v[40:43]
    v_mfma_f32_16x16x32_bf16 v[44:47], v[132:135], v[12:15], v[44:47]
    s_cbranch_scc0 .Lbc_three
    s_nop 3
    v_cndmask_b32 v32, v32, v36, vcc
    v_cndmask_b32 v33, v33, v37, vcc
    v_cndmask_b32 v34, v34, v38, vcc
    v_cndmask_b32 v35, v35, v39, vcc
    v_perm_b32 v56, v32, v35, s60
    v_perm_b32 v57, v33, v35, s61
    v_perm_b32 v58, v34, v35, s62
    buffer_store_dwordx4 v[56:59], v23, s[36:39], s59 offen sc1
    v_cndmask_b32 v40, v40, v44, vcc
    v_cndmask_b32 v41, v41, v45, vcc
    v_cndmask_b32 v42, v42, v46, vcc
    v_cndmask_b32 v43, v43, v47, vcc
    v_perm_b32 v60, v40, v43, s60
    v_perm_b32 v61, v41, v43, s61
    v_perm_b32 v62, v42, v43, s62
    buffer_store_dwordx4 v[60:63], v23, s[36:39], s99 offen sc1
    s_nop 1
    s_branch .Lexit
.Lbc_three:
    v_mfma_f32_16x16x32_bf16 v[48:51], v[136:139], v[8:11], 0
    v_mfma_f32_16x16x32_bf16 v[52:55], v[140:143], v[8:11], 0
    v_mfma_f32_16x16x32_bf16 v[48:51], v[144:147], v[12:15], v[48:51]
    v_mfma_f32_16x16x32_bf16 v[52:55], v[148:151], v[12:15], v[52:55]
    v_cndmask_b32 v32, v32, v36, vcc
    v_cndmask_b32 v33, v33, v37, vcc
    v_cndmask_b32 v34, v34, v38, vcc
    v_cndmask_b32 v35, v35, v39, vcc
    v_perm_b32 v56, v32, v35, s60
    v_perm_b32 v57, v33, v35, s61
    v_perm_b32 v58, v34, v35, s62
    buffer_store_dwordx4 v[56:59], v23, s[36:39], s59 offen sc1
    v_cndmask_b32 v40, v40, v44, vcc
    v_cndmask_b32 v41, v41, v45, vcc
    v_cndmask_b32 v42, v42, v46, vcc
    v_cndmask_b32 v43, v43, v47, vcc
    v_perm_b32 v60, v40, v43, s60
    v_perm_b32 v61, v41, v43, s61
    v_perm_b32 v62, v42, v43, s62
    buffer_store_dwordx4 v[60:63], v23, s[36:39], s99 offen sc1
    v_cndmask_b32 v48, v48, v52, vcc
    v_cndmask_b32 v49, v49, v53, vcc
    v_cndmask_b32 v50, v50, v54, vcc
    v_cndmask_b32 v51, v51, v55, vcc
    v_perm_b32 v64, v48, v51, s60
    v_perm_b32 v65, v49, v51, s61
    v_perm_b32 v66, v50, v51, s62
    buffer_store_dwordx4 v[64:67], v23, s[36:39], s100 offen sc1
.Lexit:
.Lend:
s_endpgm
.section .rodata,"a"
.p2align 6
.amdhsa_kernel adaLN_cond__sliding_block_cached__moe_arch_mod__decode_kernel
  .amdhsa_next_free_vgpr 256
  .amdhsa_next_free_sgpr 102
  .amdhsa_accum_offset 256
  .amdhsa_group_segment_fixed_size 0
  .amdhsa_kernarg_size 120
  .amdhsa_user_sgpr_count 2
  .amdhsa_user_sgpr_kernarg_segment_ptr 1
  .amdhsa_system_sgpr_workgroup_id_x 1
.end_amdhsa_kernel
```

```asm
; @launch grid=(256,1,1) block=(512,1,1) lds=159360
.amdgcn_target "amdgcn-amd-amdhsa--gfx950"
.text
.p2align 12
.globl adaLN_cond__sliding_block_cached__moe_arch_mod__decode_kernel
.p2align 8
.type adaLN_cond__sliding_block_cached__moe_arch_mod__decode_kernel,@function
adaLN_cond__sliding_block_cached__moe_arch_mod__decode_kernel:
    s_cmp_ge_u32 s2, 256
    s_cbranch_scc1 .Lend
    s_load_dwordx16 s[4:19], s[0:1], 0
    s_load_dwordx8 s[20:27], s[0:1], 64
    s_load_dwordx4 s[28:31], s[0:1], 96
    s_load_dwordx2 s[32:33], s[0:1], 112
    s_memrealtime s[70:71]
    v_lshrrev_b32 v1, 6, v0
    v_and_b32 v0, 63, v0
    v_readfirstlane_b32 s3, v1
    s_cmp_lt_u32 s3, 4
    s_nop 3
    s_cbranch_scc1 .Ltw_done
    s_cmp_lt_u32 s2, 72
    s_cbranch_scc1 .Ltw_m
    s_cmp_lt_u32 s2, 144
    s_cbranch_scc1 .Ltw_b
    s_cmp_lt_u32 s2, 208
    s_cbranch_scc1 .Ltw_q
    s_cmp_eq_u32 s3, 4
    s_cbranch_scc1 .Lst_a0_0
    s_cmp_eq_u32 s3, 5
    s_cbranch_scc1 .Lst_a0_1
.Lrt_a0_0:
.Lrt_a0_1:
    s_branch .Ltw_done
.Ltw_m:
    s_cmp_eq_u32 s3, 4
    s_cbranch_scc1 .Lst_m0_0
    s_cmp_eq_u32 s3, 5
    s_cbranch_scc1 .Lst_m0_1
.Lrt_m0_1:
    s_cmp_eq_u32 s3, 6
    s_cbranch_scc1 .Lst_m0_2
.Lrt_m0_2:
    s_cmp_eq_u32 s3, 7
    s_cbranch_scc1 .Lst_m0_3
    s_cmp_eq_u32 s3, 5
    s_cbranch_scc1 .Lst_m0_4
    s_cmp_eq_u32 s3, 6
    s_cbranch_scc1 .Lst_m0_5
.Lrt_m0_0:
.Lrt_m0_3:
.Lrt_m0_4:
.Lrt_m0_5:
    s_branch .Ltw_done
.Ltw_b:
    s_cmp_eq_u32 s3, 4
    s_cbranch_scc1 .Lst_b0_0
    s_cmp_eq_u32 s3, 5
    s_cbranch_scc1 .Lst_b0_1
    s_cmp_eq_u32 s3, 6
    s_cbranch_scc1 .Lst_b0_2
    s_cmp_eq_u32 s3, 7
    s_cbranch_scc1 .Lst_b0_3
.Lrt_b0_0:
.Lrt_b0_1:
.Lrt_b0_2:
.Lrt_b0_3:
    s_branch .Ltw_done
.Ltw_q:
    s_cmp_eq_u32 s3, 4
    s_cbranch_scc1 .Lst_q0_0
    s_cmp_eq_u32 s3, 5
    s_cbranch_scc1 .Lst_q0_1
    s_cmp_eq_u32 s3, 6
    s_cbranch_scc1 .Lst_q0_2
    s_cmp_eq_u32 s3, 7
    s_cbranch_scc1 .Lst_q0_3
.Lrt_q0_0:
.Lrt_q0_1:
.Lrt_q0_2:
.Lrt_q0_3:
.Ltw_done:
    s_mov_b32 s35, 0x3ffff
    s_mov_b32 s98, 0xbfb8aa3b
    s_mov_b32 s94, 0x05040100
    s_mov_b32 s95, 0x07060302
    s_mov_b32 s96, 0xaaaaaaaa
    s_mov_b32 s97, 0xaaaaaaaa
    s_and_b32 s64, s2, 7
    s_lshr_b32 s65, s2, 3
    s_mov_b32 s58, 0x2554433
    s_mov_b32 s59, 0x2877661
    s_cmp_ge_u32 s65, 16
    s_cselect_b32 s58, 0xbb1aa998, s58
    s_cselect_b32 s59, 0xffeeddcc, s59
    s_lshl_b32 s57, s65, 2
    s_lshr_b64 s[58:59], s[58:59], s57
    s_lshl1_add_u32 s59, s64, 1
    s_mul_i32 s58, s58, s59
    s_add_u32 s58, s58, s64
    s_add_u32 s58, s58, s59
    s_and_b32 s66, s58, 7
    s_bfe_u32 s67, s58, 0x10003
    s_lshl1_add_u32 s67, s64, s67
    s_lshr_b32 s68, 0xaab5d42a, s65
    s_and_b32 s68, s68, 1
    s_movk_i32 s60, 0x7651
    s_cselect_b32 s60, 0x4320, s60
    s_lshl4_add_u32 s69, s66, s67
    s_lshl_b32 s69, s69, 21
    s_cmp_eq_u32 s64, 7
    s_cselect_b32 s58, 0x4040, 0
    s_or_b32 s58, s58, 0x208180
    s_bitcmp1_b32 s58, s65
    s_cselect_b32 s60, s60, 0x3210
    s_and_b32 s57, s3, 1
    s_and_b32 s59, s3, 6
    s_cmpk_eq_u32 s60, 0x3210
    s_cselect_b32 s57, s68, s57
    s_cselect_b32 s59, s3, s59
    s_lshl_b32 s57, s57, 16
    s_lshl_b32 s59, s59, 10
    s_add_u32 s69, s69, s57
    s_add_u32 s69, s69, s59
    s_add_u32 s69, s69, 0x180000
    v_bfe_u32 v1, v0, 2, 2
    v_lshlrev_b32 v1, 2, v1
    v_bfe_u32 v1, s60, v1, 4
    v_lshrrev_b32 v2, 4, v0
    v_lshl_add_u32 v1, v1, 2, v2
    v_and_b32 v2, 3, v0
    v_lshl_add_u32 v1, v1, 2, v2
    v_lshlrev_b32 v1, 4, v1
    v_lshlrev_b32 v2, 4, v0
    v_lshlrev_b32 v3, 3, v0
    v_and_b32 v4, 31, v0
    v_lshlrev_b32 v4, 2, v4
    v_add_u32 v4, 1024, v4
    v_lshlrev_b32 v5, 1, v4
    s_waitcnt lgkmcnt(0)
    s_load_dword s34, s[32:33], 0
    s_mov_b32 s40, s6
    s_and_b32 s41, s7, 0xffff
    s_mov_b32 s42, 0x10000000
    s_mov_b32 s43, 0x00020000
    s_mov_b32 s6, s60
    s_add_u32 s63, s69, 0
    buffer_load_dwordx4 v[32:35], v1, s[40:43], s63 offen nt
    s_add_u32 s63, s69, 8192
    buffer_load_dwordx4 v[36:39], v1, s[40:43], s63 offen nt
    s_add_u32 s63, s69, 16384
    buffer_load_dwordx4 v[64:67], v1, s[40:43], s63 offen nt
    s_add_u32 s63, s69, 24576
    buffer_load_dwordx4 v[68:71], v1, s[40:43], s63 offen nt
.Lnokpre:
    s_mov_b32 s44, s8
    s_and_b32 s45, s9, 0xffff
    s_mov_b32 s46, 0x10000000
    s_mov_b32 s47, 0x00020000
    s_cmp_eq_u32 s3, 0
    s_cselect_b64 exec, 1, 0
    buffer_load_dword v255, v2, s[44:47], s69 offen nt
    s_mov_b64 exec, -1
    s_mov_b32 s36, s32
    s_and_b32 s37, s33, 0xffff
    s_mov_b32 s38, 0x40000000
    s_mov_b32 s39, 0x00020000
    s_lshl3_add_u32 s56, s3, s2
    s_cmp_lt_u32 s56, 8
    s_cbranch_scc0 .Let_no
    s_lshl2_add_u32 s56, s2, 0x4a1000
    v_lshlrev_b32 v6, 8, v0
    v_mov_b32 v7, s70
    s_mov_b64 exec, 3
    buffer_store_dword v7, v6, s[36:39], s56 offen sc1
    s_mov_b64 exec, -1
.Let_no:
    v_mov_b32 v6, 159232
    v_mov_b32 v7, 0
    ds_write_b32 v6, v7
    s_waitcnt lgkmcnt(0)
    s_barrier
    s_cmp_lt_u32 s3, 4
    s_cbranch_scc1 1
    s_setprio 1
    s_cmp_lt_u32 s65, 9
    s_cbranch_scc1 .Lm
    s_cmp_lt_u32 s65, 18
    s_cbranch_scc1 .Lbc
    s_sub_u32 s65, s65, 18
    s_cmp_ge_u32 s65, 8
    s_cbranch_scc1 .La_early
    s_cmp_eq_u32 s65, 3
    s_mov_b32 s14, 0xb55aab55
    s_cselect_b32 s14, 0x8421084, s14
    s_mov_b32 s15, 0x5aab55aa
    s_cselect_b32 s15, 0x42108421, s15
    s_add_u32 s30, s70, 0
    s_mov_b32 s31, s70
    v_bfe_u32 v16, v0, 1, 3
    v_mul_u32_u24 v16, 1312, v16
    v_lshrrev_b32 v12, 4, v0
    v_lshl_add_u32 v16, v12, 5, v16
    v_and_b32 v12, 1, v0
    v_lshl_add_u32 v16, v12, 4, v16
    v_add_u32 v16, 147456, v16
    s_mul_i32 s56, s3, 1312
    s_add_u32 s56, s56, 147456
    v_add_u32 v17, s56, v3
    v_add_u32 v18, s56, v4
    v_lshrrev_b32 v12, 4, v0
    v_bfe_u32 v13, v0, 1, 1
    v_lshl_add_u32 v12, v12, 1, v13
    v_bfe_u32 v13, v0, 2, 2
    v_lshl_add_u32 v20, v12, 3, v13
    v_lshlrev_b32 v20, 7, v20
    v_and_b32 v12, 3, v12
    v_lshrrev_b32 v13, 1, v13
    v_lshl_add_u32 v12, v12, 1, v13
    v_xor_b32 v12, s3, v12
    v_lshl_add_u32 v20, v12, 4, v20
    v_and_b32 v12, 1, v0
    v_lshl_add_u32 v20, v12, 3, v20
    v_bfe_u32 v23, v0, 1, 3
    v_mul_u32_u24 v23, 144, v23
    v_bfe_u32 v12, v0, 4, 1
    v_lshl_add_u32 v23, v12, 3, v23
    s_branch .Lsk_q0_0
.Lst_q0_0:
    s_branch .Lrt_q0_0
.Lsk_q0_0:
    v_lshrrev_b32 v12, 5, v0
    v_lshl_add_u32 v23, v12, 2, v23
    v_and_b32 v12, 1, v0
    v_lshl_add_u32 v23, v12, 1, v23
    s_lshl_b32 s56, s3, 4
    s_add_u32 s56, s56, 157952
    v_add_u32 v23, s56, v23
    v_and_b32 v24, 15, v0
    v_lshlrev_b32 v24, 3, v24
    s_mul_i32 s56, s3, 144
    s_add_u32 s56, s56, 157952
    v_add_u32 v24, s56, v24
    v_add_u32 v21, 32768, v20
    s_lshl_b32 s100, s3, 10
    s_mul_i32 s58, s3, 1152
    s_mov_b32 s52, s4
    s_and_b32 s53, s5, 0xffff
    s_mov_b32 s54, 0x2400
    s_mov_b32 s55, 0x00020000
    buffer_load_dwordx2 v[246:247], v3, s[52:55], s58 offen
    buffer_load_dwordx2 v[248:249], v3, s[52:55], s58 offen offset:512
    buffer_load_dword v250, v4, s[52:55], s58 offen
    s_mov_b32 s48, s10
    s_and_b32 s49, s11, 0xffff
    s_mov_b32 s50, 0x480000
    s_mov_b32 s51, 0x00020000
    v_bfe_u32 v12, v0, 4, 1
    s_and_b32 s56, s3, 3
    s_lshl_b32 s56, s56, 1
    v_or_b32 v12, s56, v12
    v_and_b32 v19, 7, v0
    v_xor_b32 v12, v12, v19
    v_lshrrev_b32 v19, 3, v0
    v_mul_u32_u24 v19, 8192, v19
    v_lshl_add_u32 v19, v12, 4, v19
    s_lshl3_add_u32 s101, s64, s65
    s_lshl_b32 s57, s3, 16
    s_lshl_b32 s59, s101, 7
    s_add_u32 s57, s57, s59
    s_mov_b32 s99, s57
    s_add_u32 m0, s100, 0
    s_add_u32 s56, s99, 0
    buffer_load_dwordx4 v19, s[48:51], s56 offen nt lds
    s_add_u32 s63, s69, 32768
    buffer_load_dwordx4 v[96:99], v1, s[40:43], s63 offen nt
    s_waitcnt lgkmcnt(0)
    s_add_u32 s34, s34, 1
    s_getreg_b32 s1, hwreg(HW_REG_XCC_ID)
    s_lshl_b32 s1, s1, 24
    s_add_u32 s1, s1, s34
    s_lshr_b32 s0, s2, 3
    s_lshl_b32 s63, s64, 8
    s_add_u32 s0, s0, s63
    s_lshl2_add_u32 s0, s0, 0x480000
    v_mov_b32 v30, s1
    s_cmp_eq_u32 s3, 0
    s_cselect_b64 exec, 1, 0
    buffer_store_dword v30, v2, s[36:39], s0 offen sc1
    s_mov_b64 exec, -1
    s_and_b32 s58, s101, 1
    s_lshl_b32 s101, s101, 8
    s_lshl_b32 s58, s58, 7
    s_sub_u32 s101, s101, s58
    s_lshl_b32 s58, s3, 14
    s_add_u32 s101, s101, s58
    s_add_u32 s101, s101, 0x70000
    s_and_b32 s58, s64, 1
    s_mul_i32 s58, s58, 18432
    s_mul_i32 s59, s3, 2304
    s_add_u32 s58, s58, s59
    s_add_u32 s58, s58, 0x1000
    s_add_u32 s59, s58, 73728
    s_waitcnt vmcnt(5)
    s_add_u32 m0, s100, 8192
    s_add_u32 s56, s99, 524288
    buffer_load_dwordx4 v19, s[48:51], s56 offen nt lds
    s_waitcnt vmcnt(5)
    s_add_u32 s63, s69, 40960
    buffer_load_dwordx4 v[100:103], v1, s[40:43], s63 offen nt
    s_waitcnt vmcnt(5)
    s_add_u32 m0, s100, 16384
    s_add_u32 s56, s99, 1048576
    buffer_load_dwordx4 v19, s[48:51], s56 offen nt lds
    s_waitcnt vmcnt(5)
    s_add_u32 s63, s69, 49152
    buffer_load_dwordx4 v[128:131], v1, s[40:43], s63 offen nt
    v_lshlrev_b32 v236, 16, v246
    v_and_b32 v237, 0xffff0000, v246
    v_lshlrev_b32 v238, 16, v247
    v_and_b32 v239, 0xffff0000, v247
    v_lshlrev_b32 v240, 16, v248
    v_and_b32 v241, 0xffff0000, v248
    v_lshlrev_b32 v242, 16, v249
    v_and_b32 v243, 0xffff0000, v249
    v_lshlrev_b32 v244, 16, v250
    v_and_b32 v245, 0xffff0000, v250
    s_mov_b32 s56, 0x3f803f80
    v_dot2_f32_bf16 v10, v246, s56, 0
    v_dot2_f32_bf16 v11, v246, v246, 0
    v_dot2_f32_bf16 v10, v247, s56, v10
    v_dot2_f32_bf16 v11, v247, v247, v11
    v_dot2_f32_bf16 v10, v248, s56, v10
    v_dot2_f32_bf16 v11, v248, v248, v11
    v_dot2_f32_bf16 v10, v249, s56, v10
    v_dot2_f32_bf16 v11, v249, v249, v11
    s_mov_b64 exec, 0xffffffff
    v_dot2_f32_bf16 v10, v250, s56, v10
    v_dot2_f32_bf16 v11, v250, v250, v11
    s_mov_b64 exec, -1
    s_nop 1
    v_permlane32_swap_b32 v10, v11
    v_add_f32 v10, v10, v11
    v_mov_b32 v12, v10
    s_nop 1
    v_permlane16_swap_b32 v12, v10
    v_add_f32 v10, v12, v10
    s_nop 1
    v_add_f32_dpp v10, v10, v10 row_ror:8 row_mask:0xf bank_mask:0xf
    s_nop 1
    v_add_f32_dpp v10, v10, v10 row_ror:4 row_mask:0xf bank_mask:0xf
    s_nop 1
    v_add_f32_dpp v10, v10, v10 quad_perm:[2,3,0,1] row_mask:0xf bank_mask:0xf
    s_nop 1
    v_add_f32_dpp v10, v10, v10 quad_perm:[1,0,3,2] row_mask:0xf bank_mask:0xf
    v_mul_f32 v10, 0x3ae38e39, v10
    s_nop 0
    v_readlane_b32 s56, v10, 0
    v_readlane_b32 s57, v10, 32
    s_nop 0
    v_mov_b32 v10, s56
    v_fma_f32 v11, -v10, v10, s57
    v_max_f32 v11, 0, v11
    v_cvt_pk_bf16_f32 v12, -v10, v11
    v_and_b32 v13, 0xffff0000, v12
    v_add_f32 v13, 0x3727c5ac, v13
    v_lshlrev_b32 v10, 16, v12
    v_cvt_pk_bf16_f32 v13, v13, v13
    v_lshlrev_b32 v13, 16, v13
    v_sqrt_f32 v13, v13
    v_mov_b32 v11, v10
    v_cvt_pk_bf16_f32 v13, v13, v13
    v_lshlrev_b32 v13, 16, v13
    v_rcp_f32 v12, v13
    v_rcp_f32 v13, v13
    v_pk_add_f32 v[236:237], v[236:237], v[10:11]
    v_pk_add_f32 v[238:239], v[238:239], v[10:11]
    v_pk_add_f32 v[240:241], v[240:241], v[10:11]
    v_pk_add_f32 v[242:243], v[242:243], v[10:11]
    v_pk_add_f32 v[244:245], v[244:245], v[10:11]
    v_cvt_pk_bf16_f32 v236, v236, v237
    v_and_b32 v237, 0xffff0000, v236
    v_lshlrev_b32 v236, 16, v236
    v_cvt_pk_bf16_f32 v238, v238, v239
    v_and_b32 v239, 0xffff0000, v238
    v_lshlrev_b32 v238, 16, v238
    v_cvt_pk_bf16_f32 v240, v240, v241
    v_and_b32 v241, 0xffff0000, v240
    v_lshlrev_b32 v240, 16, v240
    v_cvt_pk_bf16_f32 v242, v242, v243
    v_and_b32 v243, 0xffff0000, v242
    v_lshlrev_b32 v242, 16, v242
    v_cvt_pk_bf16_f32 v244, v244, v245
    v_and_b32 v245, 0xffff0000, v244
    v_lshlrev_b32 v244, 16, v244
    v_pk_mul_f32 v[236:237], v[236:237], v[12:13]
    v_pk_mul_f32 v[238:239], v[238:239], v[12:13]
    v_pk_mul_f32 v[240:241], v[240:241], v[12:13]
    v_pk_mul_f32 v[242:243], v[242:243], v[12:13]
    v_pk_mul_f32 v[244:245], v[244:245], v[12:13]
    v_cvt_pk_bf16_f32 v236, v236, v237
    v_and_b32 v237, 0xffff0000, v236
    v_lshlrev_b32 v236, 16, v236
    v_cvt_pk_bf16_f32 v238, v238, v239
    v_and_b32 v239, 0xffff0000, v238
    v_lshlrev_b32 v238, 16, v238
    v_cvt_pk_bf16_f32 v240, v240, v241
    v_and_b32 v241, 0xffff0000, v240
    v_lshlrev_b32 v240, 16, v240
    v_cvt_pk_bf16_f32 v242, v242, v243
    v_and_b32 v243, 0xffff0000, v242
    v_lshlrev_b32 v242, 16, v242
    v_cvt_pk_bf16_f32 v244, v244, v245
    v_and_b32 v245, 0xffff0000, v244
    v_lshlrev_b32 v244, 16, v244
    s_branch .Lsk_q0_1
.Lst_q0_1:
    s_branch .Lrt_q0_1
.Lsk_q0_1:
    s_waitcnt vmcnt(5)
    s_add_u32 m0, s100, 24576
    s_add_u32 s56, s99, 1572864
    buffer_load_dwordx4 v19, s[48:51], s56 offen nt lds
    s_waitcnt vmcnt(4)
    s_add_u32 s63, s69, 57344
    buffer_load_dwordx4 v[132:135], v1, s[40:43], s63 offen nt
    s_waitcnt vmcnt(4)
    s_add_u32 m0, s100, 32768
    s_add_u32 s56, s99, 2097152
    buffer_load_dwordx4 v19, s[48:51], s56 offen nt lds
    s_waitcnt vmcnt(4)
    s_add_u32 s63, s69, 131072
    buffer_load_dwordx4 v[40:43], v1, s[40:43], s63 offen nt
    s_waitcnt vmcnt(4)
    s_add_u32 m0, s100, 40960
    s_add_u32 s56, s99, 2621440
    buffer_load_dwordx4 v19, s[48:51], s56 offen nt lds
    s_waitcnt vmcnt(4)
    s_add_u32 s63, s69, 139264
    buffer_load_dwordx4 v[44:47], v1, s[40:43], s63 offen nt
    s_waitcnt vmcnt(4)
    s_add_u32 m0, s100, 49152
    s_add_u32 s56, s99, 3145728
    buffer_load_dwordx4 v19, s[48:51], s56 offen nt lds
    s_waitcnt vmcnt(4)
    s_add_u32 s63, s69, 147456
    buffer_load_dwordx4 v[72:75], v1, s[40:43], s63 offen nt
    s_waitcnt vmcnt(4)
    s_add_u32 m0, s100, 57344
    s_add_u32 s56, s99, 3670016
    buffer_load_dwordx4 v19, s[48:51], s56 offen nt lds
    s_waitcnt vmcnt(4)
    s_add_u32 s63, s69, 155648
    buffer_load_dwordx4 v[76:79], v1, s[40:43], s63 offen nt
    s_waitcnt vmcnt(4)
    s_add_u32 m0, s100, 65536
    s_add_u32 s56, s99, 4194304
    buffer_load_dwordx4 v19, s[48:51], s56 offen nt lds
    s_waitcnt vmcnt(4)
    s_add_u32 s63, s69, 163840
    buffer_load_dwordx4 v[104:107], v1, s[40:43], s63 offen nt
    s_waitcnt vmcnt(4)
    s_add_u32 s63, s69, 172032
    buffer_load_dwordx4 v[108:111], v1, s[40:43], s63 offen nt
    s_waitcnt vmcnt(4)
    s_add_u32 s63, s69, 180224
    buffer_load_dwordx4 v[136:139], v1, s[40:43], s63 offen nt
    s_waitcnt vmcnt(4)
    s_add_u32 s63, s69, 188416
    buffer_load_dwordx4 v[140:143], v1, s[40:43], s63 offen nt
    s_waitcnt vmcnt(4)
    s_add_u32 s63, s69, 262144
    buffer_load_dwordx4 v[48:51], v1, s[40:43], s63 offen nt
    s_waitcnt vmcnt(4)
    s_add_u32 s63, s69, 270336
    buffer_load_dwordx4 v[52:55], v1, s[40:43], s63 offen nt
    buffer_load_dwordx4 v[196:199], v2, s[36:39], s58 offen offset:0 sc1
    buffer_load_dwordx4 v[200:203], v2, s[36:39], s58 offen offset:1024 sc1
    buffer_load_dwordx2 v[204:205], v5, s[36:39], s58 offen offset:0 sc1
    buffer_load_dwordx4 v[206:209], v2, s[36:39], s59 offen offset:0 sc1
    buffer_load_dwordx4 v[210:213], v2, s[36:39], s59 offen offset:1024 sc1
    buffer_load_dwordx2 v[214:215], v5, s[36:39], s59 offen offset:0 sc1
    s_add_u32 s63, s69, 278528
    buffer_load_dwordx4 v[80:83], v1, s[40:43], s63 offen nt
    s_add_u32 s63, s69, 286720
    buffer_load_dwordx4 v[84:87], v1, s[40:43], s63 offen nt
    s_add_u32 s63, s69, 294912
    buffer_load_dwordx4 v[112:115], v1, s[40:43], s63 offen nt
    s_barrier
    ds_read_b64_tr_b16 v[160:161], v20 offset:0
    ds_read_b64_tr_b16 v[162:163], v20 offset:512
    ds_read_b64_tr_b16 v[164:165], v20 offset:8192
    ds_read_b64_tr_b16 v[166:167], v20 offset:8704
    ds_read_b64_tr_b16 v[168:169], v20 offset:16384
    ds_read_b64_tr_b16 v[170:171], v20 offset:16896
    ds_read_b64_tr_b16 v[172:173], v20 offset:24576
    ds_read_b64_tr_b16 v[174:175], v20 offset:25088
    ds_read_b64_tr_b16 v[176:177], v21 offset:0
    ds_read_b64_tr_b16 v[178:179], v21 offset:512
    ds_read_b64_tr_b16 v[180:181], v21 offset:8192
    ds_read_b64_tr_b16 v[182:183], v21 offset:8704
    ds_read_b64_tr_b16 v[184:185], v21 offset:16384
    ds_read_b64_tr_b16 v[186:187], v21 offset:16896
    ds_read_b64_tr_b16 v[188:189], v21 offset:24576
    ds_read_b64_tr_b16 v[190:191], v21 offset:25088
    ds_read_b64_tr_b16 v[192:193], v21 offset:32768
    ds_read_b64_tr_b16 v[194:195], v21 offset:33280
    s_add_u32 s63, s69, 303104
    buffer_load_dwordx4 v[116:119], v1, s[40:43], s63 offen nt
    s_waitcnt vmcnt(4)
    s_branch .gpc_2
.gp_1:
    buffer_load_dwordx4 v[196:199], v2, s[36:39], s58 offen offset:0 sc1
    buffer_load_dwordx4 v[200:203], v2, s[36:39], s58 offen offset:1024 sc1
    buffer_load_dwordx2 v[204:205], v5, s[36:39], s58 offen offset:0 sc1
    buffer_load_dwordx4 v[206:209], v2, s[36:39], s59 offen offset:0 sc1
    buffer_load_dwordx4 v[210:213], v2, s[36:39], s59 offen offset:1024 sc1
    buffer_load_dwordx2 v[214:215], v5, s[36:39], s59 offen offset:0 sc1
    s_waitcnt vmcnt(0)
.gpc_2:
    v_min_u32 v10, v197, v199
    v_max_u32 v11, v197, v199
    v_min3_u32 v10, v10, v201, v203
    v_max3_u32 v11, v11, v201, v203
    v_min3_u32 v10, v10, v205, v207
    v_max3_u32 v11, v11, v205, v207
    v_min3_u32 v10, v10, v209, v211
    v_max3_u32 v11, v11, v209, v211
    v_min3_u32 v10, v10, v213, v215
    v_max3_u32 v11, v11, v213, v215
    v_cmp_eq_u32 vcc, s34, v10
    v_cmp_eq_u32 s[56:57], s34, v11
    s_and_b64 vcc, vcc, s[56:57]
    s_cmp_eq_u64 vcc, -1
    s_nop 2
    s_cbranch_scc1 .gpd_3
    s_sub_u32 s35, s35, 1
    s_cbranch_scc1 .Lexit
    s_branch .gp_1
.gpd_3:
    s_add_u32 s63, s69, 311296
    buffer_load_dwordx4 v[144:147], v1, s[40:43], s63 offen nt
    v_and_b32 v207, 0xffff0000, v206
    v_lshlrev_b32 v206, 16, v206
    v_and_b32 v209, 0xffff0000, v208
    v_lshlrev_b32 v208, 16, v208
    v_and_b32 v211, 0xffff0000, v210
    v_lshlrev_b32 v210, 16, v210
    v_and_b32 v213, 0xffff0000, v212
    v_lshlrev_b32 v212, 16, v212
    v_and_b32 v215, 0xffff0000, v214
    v_lshlrev_b32 v214, 16, v214
    v_and_b32 v197, 0xffff0000, v196
    v_lshlrev_b32 v196, 16, v196
    v_and_b32 v199, 0xffff0000, v198
    v_lshlrev_b32 v198, 16, v198
    v_and_b32 v201, 0xffff0000, v200
    v_lshlrev_b32 v200, 16, v200
    v_and_b32 v203, 0xffff0000, v202
    v_lshlrev_b32 v202, 16, v202
    v_and_b32 v205, 0xffff0000, v204
    v_lshlrev_b32 v204, 16, v204
    v_pk_mul_f32 v[236:237], v[236:237], v[206:207]
    v_pk_mul_f32 v[238:239], v[238:239], v[208:209]
    v_pk_mul_f32 v[240:241], v[240:241], v[210:211]
    v_pk_mul_f32 v[242:243], v[242:243], v[212:213]
    v_pk_mul_f32 v[244:245], v[244:245], v[214:215]
    v_cvt_pk_bf16_f32 v236, v236, v237
    v_and_b32 v237, 0xffff0000, v236
    v_lshlrev_b32 v236, 16, v236
    v_cvt_pk_bf16_f32 v238, v238, v239
    v_and_b32 v239, 0xffff0000, v238
    s_branch .Lsk_q0_2
.Lst_q0_2:
    s_branch .Lrt_q0_2
.Lsk_q0_2:
    v_lshlrev_b32 v238, 16, v238
    v_cvt_pk_bf16_f32 v240, v240, v241
    v_and_b32 v241, 0xffff0000, v240
    v_lshlrev_b32 v240, 16, v240
    v_cvt_pk_bf16_f32 v242, v242, v243
    v_and_b32 v243, 0xffff0000, v242
    v_lshlrev_b32 v242, 16, v242
    v_cvt_pk_bf16_f32 v244, v244, v245
    s_branch .Lsk_q0_3
.Lst_q0_3:
    s_branch .Lrt_q0_3
.Lsk_q0_3:
    v_and_b32 v245, 0xffff0000, v244
    v_lshlrev_b32 v244, 16, v244
    v_pk_add_f32 v[236:237], v[236:237], v[196:197]
    v_pk_add_f32 v[238:239], v[238:239], v[198:199]
    v_pk_add_f32 v[240:241], v[240:241], v[200:201]
    v_pk_add_f32 v[242:243], v[242:243], v[202:203]
    v_pk_add_f32 v[244:245], v[244:245], v[204:205]
    v_cvt_pk_bf16_f32 v246, v236, v237
    v_cvt_pk_bf16_f32 v247, v238, v239
    v_cvt_pk_bf16_f32 v248, v240, v241
    v_cvt_pk_bf16_f32 v249, v242, v243
    v_cvt_pk_bf16_f32 v250, v244, v245
    ds_write_b64 v17, v[246:247] offset:0
    ds_write_b64 v17, v[248:249] offset:512
    ds_write_b32 v18, v250 offset:0
    s_add_u32 s63, s69, 319488
    buffer_load_dwordx4 v[148:151], v1, s[40:43], s63 offen nt
    s_waitcnt lgkmcnt(0)
    s_barrier
    s_add_u32 s63, s69, 393216
    buffer_load_dwordx4 v[56:59], v1, s[40:43], s63 offen nt
    ds_read_b128 v[196:199], v16 offset:0
    ds_read_b128 v[200:203], v16 offset:128
    ds_read_b128 v[204:207], v16 offset:256
    ds_read_b128 v[208:211], v16 offset:384
    ds_read_b128 v[212:215], v16 offset:512
    ds_read_b128 v[216:219], v16 offset:640
    ds_read_b128 v[220:223], v16 offset:768
    ds_read_b128 v[224:227], v16 offset:896
    ds_read_b128 v[228:231], v16 offset:1024
    s_waitcnt lgkmcnt(8)
    v_mfma_f32_16x16x32_bf16 v[232:235], v[160:163], v[196:199], 0
    s_waitcnt lgkmcnt(7)
    v_mfma_f32_16x16x32_bf16 v[232:235], v[164:167], v[200:203], v[232:235]
    s_waitcnt lgkmcnt(6)
    v_mfma_f32_16x16x32_bf16 v[232:235], v[168:171], v[204:207], v[232:235]
    s_waitcnt lgkmcnt(5)
    v_mfma_f32_16x16x32_bf16 v[232:235], v[172:175], v[208:211], v[232:235]
    s_waitcnt lgkmcnt(4)
    v_mfma_f32_16x16x32_bf16 v[232:235], v[176:179], v[212:215], v[232:235]
    s_waitcnt lgkmcnt(3)
    v_mfma_f32_16x16x32_bf16 v[232:235], v[180:183], v[216:219], v[232:235]
    s_waitcnt lgkmcnt(2)
    v_mfma_f32_16x16x32_bf16 v[232:235], v[184:187], v[220:223], v[232:235]
    s_waitcnt lgkmcnt(1)
    v_mfma_f32_16x16x32_bf16 v[232:235], v[188:191], v[224:227], v[232:235]
    s_waitcnt lgkmcnt(0)
    v_mfma_f32_16x16x32_bf16 v[232:235], v[192:195], v[228:231], v[232:235]
    s_nop 7
    v_permlane32_swap_b32 v232, v234
    v_permlane32_swap_b32 v233, v235
    v_cndmask_b32 v233, v233, v234, s[96:97]
    v_cndmask_b32 v232, v232, v235, s[96:97]
    s_nop 1
    v_add_f32_dpp v236, v233, v232 quad_perm:[1,0,3,2] row_mask:0xf bank_mask:0xf
    v_and_b32 v12, 1, v0
    v_lshlrev_b32 v12, 8, v12
    v_bfe_u32 v13, v0, 1, 3
    v_lshl_add_u32 v12, v13, 4, v12
    v_cvt_pk_bf16_f32 v236, v236, v236
    ds_write_b16 v23, v236
    v_mov_b32 v243, s34
    s_waitcnt lgkmcnt(0)
    s_barrier
    ds_read2_b32 v[244:245], v24 offset1:1
    v_mov_b32 v241, s34
    s_waitcnt lgkmcnt(0)
    v_mov_b32 v240, v244
    v_mov_b32 v242, v245
    s_mov_b64 exec, 0xffff
    buffer_store_dwordx4 v[240:243], v12, s[36:39], s101 offen sc1
    s_mov_b64 exec, -1
    s_mov_b64 s[18:19], 0
    v_mov_b32 v6, 0
    s_waitcnt vmcnt(3)
    s_bitcmp1_b64 s[14:15], 25
    s_cbranch_scc0 1
    s_waitcnt vmcnt(2)
    s_add_u32 s63, s69, 401408
    buffer_load_dwordx4 v[60:63], v1, s[40:43], s63 offen nt
    s_branch .Ln_att
.La_early:
    s_branch .Lsk_a0_0
.Lst_a0_0:
    s_branch .Lrt_a0_0
.Lsk_a0_0:
    s_mov_b32 s14, 0x6ddb76dd
    s_mov_b32 s15, 0xdb76ddb7
    s_add_u32 s30, s70, -70
    s_mov_b32 s31, s70
    s_cmp_ge_u32 s65, 11
    s_cselect_b32 s99, 1, 0
    s_mul_i32 s57, s99, 3
    s_sub_u32 s100, s65, s57
    s_sub_u32 s100, s100, 8
    s_lshl1_add_u32 s99, s64, s99
    s_mov_b32 s48, s12
    s_and_b32 s49, s13, 0xffff
    s_mov_b32 s50, 0x480000
    s_mov_b32 s51, 0x00020000
    v_bfe_u32 v12, v0, 4, 1
    s_and_b32 s56, s3, 1
    s_lshl_b32 s56, s56, 2
    v_lshl_or_b32 v12, v12, 1, s56
    v_and_b32 v13, 7, v0
    v_xor_b32 v12, v12, v13
    v_lshrrev_b32 v13, 3, v0
    v_mul_u32_u24 v13, 1152, v13
    v_lshl_add_u32 v6, v12, 4, v13
    s_mul_i32 s101, s99, 294912
    s_mul_i32 s56, s100, 384
    s_add_u32 s101, s101, s56
    s_mul_i32 s56, s3, 9216
    s_add_u32 s101, s101, s56
    s_lshl_b32 s57, s3, 10
    s_waitcnt vmcnt(4)
    s_add_u32 m0, s57, 0
    s_add_u32 s56, s101, 0
    buffer_load_dwordx4 v6, s[48:51], s56 offen nt lds
    s_waitcnt vmcnt(4)
    s_add_u32 m0, s57, 32768
    s_add_u32 s56, s101, 128
    buffer_load_dwordx4 v6, s[48:51], s56 offen nt lds
    s_waitcnt vmcnt(4)
    s_bitcmp1_b64 s[14:15], 4
    s_cbranch_scc0 1
    s_waitcnt vmcnt(3)
    s_add_u32 s63, s69, 32768
    buffer_load_dwordx4 v[96:99], v1, s[40:43], s63 offen nt
    s_waitcnt vmcnt(4)
    s_bitcmp1_b64 s[14:15], 5
    s_cbranch_scc0 1
    s_waitcnt vmcnt(2)
    s_add_u32 s63, s69, 40960
    buffer_load_dwordx4 v[100:103], v1, s[40:43], s63 offen nt
    s_waitcnt vmcnt(3)
    s_add_u32 m0, s57, 65536
    s_add_u32 s56, s101, 256
    buffer_load_dwordx4 v6, s[48:51], s56 offen nt lds
    s_waitcnt vmcnt(3)
    s_bitcmp1_b64 s[14:15], 6
    s_cbranch_scc0 1
    s_waitcnt vmcnt(2)
    s_add_u32 s63, s69, 49152
    buffer_load_dwordx4 v[128:131], v1, s[40:43], s63 offen nt
    s_waitcnt vmcnt(3)
    s_bitcmp1_b64 s[14:15], 7
    s_cbranch_scc0 1
    s_waitcnt vmcnt(2)
    s_add_u32 s63, s69, 57344
    buffer_load_dwordx4 v[132:135], v1, s[40:43], s63 offen nt
    s_waitcnt vmcnt(3)
    s_add_u32 m0, s57, 8192
    s_add_u32 s56, s101, 73728
    buffer_load_dwordx4 v6, s[48:51], s56 offen nt lds
    s_waitcnt vmcnt(3)
    s_bitcmp1_b64 s[14:15], 8
    s_cbranch_scc0 1
    s_waitcnt vmcnt(2)
    s_add_u32 s63, s69, 131072
    buffer_load_dwordx4 v[40:43], v1, s[40:43], s63 offen nt
    s_waitcnt vmcnt(3)
    s_bitcmp1_b64 s[14:15], 9
    s_cbranch_scc0 1
    s_waitcnt vmcnt(2)
    s_add_u32 s63, s69, 139264
    buffer_load_dwordx4 v[44:47], v1, s[40:43], s63 offen nt
    s_waitcnt vmcnt(3)
    s_add_u32 m0, s57, 40960
    s_add_u32 s56, s101, 73856
    buffer_load_dwordx4 v6, s[48:51], s56 offen nt lds
    s_waitcnt vmcnt(3)
    s_bitcmp1_b64 s[14:15], 10
    s_cbranch_scc0 1
    s_waitcnt vmcnt(2)
    s_add_u32 s63, s69, 147456
    buffer_load_dwordx4 v[72:75], v1, s[40:43], s63 offen nt
    s_waitcnt vmcnt(3)
    s_bitcmp1_b64 s[14:15], 11
    s_cbranch_scc0 1
    s_waitcnt vmcnt(2)
    s_add_u32 s63, s69, 155648
    buffer_load_dwordx4 v[76:79], v1, s[40:43], s63 offen nt
    s_waitcnt vmcnt(3)
    s_add_u32 m0, s57, 73728
    s_add_u32 s56, s101, 73984
    buffer_load_dwordx4 v6, s[48:51], s56 offen nt lds
    s_waitcnt vmcnt(3)
    s_waitcnt lgkmcnt(0)
    s_add_u32 s34, s34, 1
    s_getreg_b32 s1, hwreg(HW_REG_XCC_ID)
    s_lshl_b32 s1, s1, 24
    s_add_u32 s1, s1, s34
    s_lshr_b32 s0, s2, 3
    s_lshl_b32 s63, s64, 8
    s_add_u32 s0, s0, s63
    s_lshl2_add_u32 s0, s0, 0x480000
    v_mov_b32 v30, s1
    s_cmp_eq_u32 s3, 0
    s_cselect_b64 exec, 1, 0
    buffer_store_dword v30, v2, s[36:39], s0 offen sc1
    s_mov_b64 exec, -1
    s_bitcmp1_b64 s[14:15], 12
    s_cbranch_scc0 1
    s_waitcnt vmcnt(3)
    s_add_u32 s63, s69, 163840
    buffer_load_dwordx4 v[104:107], v1, s[40:43], s63 offen nt
    s_waitcnt vmcnt(4)
    s_bitcmp1_b64 s[14:15], 13
    s_cbranch_scc0 1
    s_waitcnt vmcnt(3)
    s_add_u32 s63, s69, 172032
    buffer_load_dwordx4 v[108:111], v1, s[40:43], s63 offen nt
    s_waitcnt vmcnt(4)
    s_add_u32 m0, s57, 16384
    s_add_u32 s56, s101, 147456
    buffer_load_dwordx4 v6, s[48:51], s56 offen nt lds
    s_waitcnt vmcnt(4)
    s_bitcmp1_b64 s[14:15], 14
    s_cbranch_scc0 1
    s_waitcnt vmcnt(2)
    s_add_u32 s63, s69, 180224
    buffer_load_dwordx4 v[136:139], v1, s[40:43], s63 offen nt
    s_waitcnt vmcnt(3)
    s_bitcmp1_b64 s[14:15], 15
    s_cbranch_scc0 1
    s_waitcnt vmcnt(2)
    s_add_u32 s63, s69, 188416
    buffer_load_dwordx4 v[140:143], v1, s[40:43], s63 offen nt
    s_waitcnt vmcnt(3)
    s_add_u32 m0, s57, 49152
    s_add_u32 s56, s101, 147584
    buffer_load_dwordx4 v6, s[48:51], s56 offen nt lds
    s_waitcnt vmcnt(3)
    s_bitcmp1_b64 s[14:15], 16
    s_cbranch_scc0 1
    s_waitcnt vmcnt(2)
    s_add_u32 s63, s69, 262144
    buffer_load_dwordx4 v[48:51], v1, s[40:43], s63 offen nt
    s_waitcnt vmcnt(3)
    s_bitcmp1_b64 s[14:15], 17
    s_cbranch_scc0 1
    s_waitcnt vmcnt(2)
    s_add_u32 s63, s69, 270336
    buffer_load_dwordx4 v[52:55], v1, s[40:43], s63 offen nt
    s_waitcnt vmcnt(3)
    s_add_u32 m0, s57, 81920
    s_add_u32 s56, s101, 147712
    buffer_load_dwordx4 v6, s[48:51], s56 offen nt lds
    s_waitcnt vmcnt(3)
    s_bitcmp1_b64 s[14:15], 18
    s_cbranch_scc0 1
    s_waitcnt vmcnt(2)
    s_add_u32 s63, s69, 278528
    buffer_load_dwordx4 v[80:83], v1, s[40:43], s63 offen nt
    s_waitcnt vmcnt(3)
    s_bitcmp1_b64 s[14:15], 19
    s_cbranch_scc0 1
    s_waitcnt vmcnt(2)
    s_add_u32 s63, s69, 286720
    buffer_load_dwordx4 v[84:87], v1, s[40:43], s63 offen nt
    s_waitcnt vmcnt(3)
    s_bitcmp1_b64 s[14:15], 20
    s_cbranch_scc0 1
    s_waitcnt vmcnt(2)
    s_add_u32 s63, s69, 294912
    buffer_load_dwordx4 v[112:115], v1, s[40:43], s63 offen nt
    s_waitcnt vmcnt(3)
    s_bitcmp1_b64 s[14:15], 21
    s_cbranch_scc0 1
    s_waitcnt vmcnt(2)
    s_add_u32 s63, s69, 303104
    buffer_load_dwordx4 v[116:119], v1, s[40:43], s63 offen nt
    s_waitcnt vmcnt(3)
    s_bitcmp1_b64 s[14:15], 22
    s_cbranch_scc0 1
    s_waitcnt vmcnt(2)
    s_add_u32 s63, s69, 311296
    buffer_load_dwordx4 v[144:147], v1, s[40:43], s63 offen nt
    s_branch .Lsk_a0_1
.Lst_a0_1:
    s_branch .Lrt_a0_1
.Lsk_a0_1:
    s_waitcnt vmcnt(3)
    s_bitcmp1_b64 s[14:15], 23
    s_cbranch_scc0 1
    s_waitcnt vmcnt(2)
    s_add_u32 s63, s69, 319488
    buffer_load_dwordx4 v[148:151], v1, s[40:43], s63 offen nt
    s_waitcnt vmcnt(3)
    s_bitcmp1_b64 s[14:15], 24
    s_cbranch_scc0 1
    s_waitcnt vmcnt(2)
    s_add_u32 s63, s69, 393216
    buffer_load_dwordx4 v[56:59], v1, s[40:43], s63 offen nt
    s_waitcnt vmcnt(3)
    s_bitcmp1_b64 s[14:15], 25
    s_cbranch_scc0 1
    s_waitcnt vmcnt(2)
    s_add_u32 s63, s69, 401408
    buffer_load_dwordx4 v[60:63], v1, s[40:43], s63 offen nt
    s_mov_b64 s[18:19], -1
.Ln_att:
    v_and_b32 v8, 1, v0
    v_lshlrev_b32 v8, 8, v8
    v_and_b32 v9, 0x3c, v0
    v_lshl_add_u32 v9, v9, 2, v8
    v_add_u32 v7, v9, v8
    v_and_b32 v9, 0x3c, v0
    v_lshrrev_b32 v8, 4, v8
    v_and_b32 v9, 4, v0
    v_lshl_add_u32 v9, v9, 3, v8
    s_lshl_b32 s58, s66, 14
    s_lshl_b32 s59, s67, 10
    s_add_u32 s58, s58, s59
    s_add_u32 s58, s58, 0x70000
    s_lshl4_add_u32 s59, s66, s67
    s_lshl_b32 s59, s59, 7
    s_add_u32 s59, s59, 0x430000
    s_memrealtime s[8:9]
    s_waitcnt vmcnt(8)
    s_waitcnt lgkmcnt(0)
    s_sub_u32 s8, s8, s30
    s_cmpk_ge_u32 s8, 1211
    s_cbranch_scc1 .ap_4
    s_waitcnt vmcnt(5)
    s_cmpk_ge_u32 s8, 1111
    s_cbranch_scc1 .ap_4
    s_waitcnt vmcnt(3)
    s_bitcmp1_b64 s[14:15], 26
    s_cbranch_scc0 1
    s_waitcnt vmcnt(2)
    s_cmpk_ge_u32 s8, 991
    s_cbranch_scc1 .ap_4
    s_waitcnt vmcnt(1)
.ap_4:
    s_add_u32 s63, s69, 409600
    buffer_load_dwordx4 v[88:91], v1, s[40:43], s63 offen nt
    v_and_b32 v157, 7, v0
    v_lshlrev_b32 v157, 2, v157
    s_mov_b32 s63, 0x4a1000
    buffer_load_dword v156, v157, s[36:39], s63 offen
    s_cmp_eq_u32 s3, 0
    s_cbranch_scc1 .Lst_n1_0
.Lrt_n1_0:
    s_cmp_eq_u32 s3, 1
    s_cbranch_scc1 .Lst_n1_1
    s_cmp_eq_u32 s3, 2
    s_cbranch_scc1 .Lst_n1_2
    s_cmp_eq_u32 s3, 3
    s_cbranch_scc1 .Lst_n1_3
    s_cmp_eq_u32 s3, 4
    s_cbranch_scc1 .Lst_n1_4
    s_cmp_eq_u32 s3, 5
    s_cbranch_scc1 .Lst_n1_5
    s_cmp_eq_u32 s3, 6
    s_cbranch_scc1 .Lst_n1_6
    s_cmp_eq_u32 s3, 7
    s_cbranch_scc1 .Lst_n1_7
    s_cmp_eq_u32 s3, 0
    s_cbranch_scc1 .Lrt_n1_8
.Lrt_n1_1:
.Lrt_n1_2:
.Lrt_n1_3:
.Lrt_n1_4:
.Lrt_n1_5:
.Lrt_n1_6:
.Lrt_n1_7:
.Lrt_n1_8:
    s_memrealtime s[8:9]
    s_waitcnt vmcnt(9)
    s_waitcnt lgkmcnt(0)
    s_sub_u32 s8, s8, s30
    s_cmpk_ge_u32 s8, 1238
    s_cbranch_scc1 .ap_5
    s_waitcnt vmcnt(6)
    s_cmpk_ge_u32 s8, 1138
    s_cbranch_scc1 .ap_5
    s_waitcnt vmcnt(4)
    s_bitcmp1_b64 s[14:15], 27
    s_cbranch_scc0 1
    s_waitcnt vmcnt(3)
    s_cmpk_ge_u32 s8, 1018
    s_cbranch_scc1 .ap_5
    s_waitcnt vmcnt(2)
.ap_5:
    s_add_u32 s63, s69, 417792
    buffer_load_dwordx4 v[92:95], v1, s[40:43], s63 offen nt
    s_memrealtime s[8:9]
    s_waitcnt vmcnt(9)
    s_waitcnt lgkmcnt(0)
    s_sub_u32 s8, s8, s30
    s_cmpk_ge_u32 s8, 1265
    s_cbranch_scc1 .ap_6
    s_waitcnt vmcnt(6)
    s_cmpk_ge_u32 s8, 1165
    s_cbranch_scc1 .ap_6
    s_waitcnt vmcnt(4)
    s_bitcmp1_b64 s[14:15], 28
    s_cbranch_scc0 1
    s_waitcnt vmcnt(3)
    s_cmpk_ge_u32 s8, 1045
    s_cbranch_scc1 .ap_6
    s_waitcnt vmcnt(2)
.ap_6:
    s_add_u32 s63, s69, 425984
    buffer_load_dwordx4 v[120:123], v1, s[40:43], s63 offen nt
    s_memrealtime s[8:9]
    s_waitcnt vmcnt(9)
    s_waitcnt lgkmcnt(0)
    s_sub_u32 s8, s8, s30
    s_cmpk_ge_u32 s8, 1292
    s_cbranch_scc1 .ap_7
    s_waitcnt vmcnt(6)
    s_cmpk_ge_u32 s8, 1192
    s_cbranch_scc1 .ap_7
    s_waitcnt vmcnt(4)
    s_bitcmp1_b64 s[14:15], 29
    s_cbranch_scc0 1
    s_waitcnt vmcnt(3)
    s_cmpk_ge_u32 s8, 1072
    s_cbranch_scc1 .ap_7
    s_waitcnt vmcnt(1)
.ap_7:
    s_add_u32 s63, s69, 434176
    buffer_load_dwordx4 v[124:127], v1, s[40:43], s63 offen nt
    s_memrealtime s[8:9]
    s_waitcnt vmcnt(9)
    s_waitcnt lgkmcnt(0)
    s_sub_u32 s8, s8, s30
    s_cmpk_ge_u32 s8, 1320
    s_cbranch_scc1 .ap_8
    s_waitcnt vmcnt(6)
    s_cmpk_ge_u32 s8, 1220
    s_cbranch_scc1 .ap_8
    s_waitcnt vmcnt(4)
    s_bitcmp1_b64 s[14:15], 30
    s_cbranch_scc0 1
    s_waitcnt vmcnt(2)
    s_cmpk_ge_u32 s8, 1100
    s_cbranch_scc1 .ap_8
    s_waitcnt vmcnt(1)
.ap_8:
    s_add_u32 s63, s69, 442368
    buffer_load_dwordx4 v[152:155], v1, s[40:43], s63 offen nt
    s_waitcnt vmcnt(4)
    s_sub_u32 s63, s70, 300
    v_subrev_u32 v156, s63, v156
    v_mov_b32 v157, 600
    v_cmp_lt_u32 s[8:9], v156, v157
    v_add_u32_dpp v156, v156, v156 quad_perm:[1,0,3,2] row_mask:0xf bank_mask:0xf
    s_nop 1
    v_add_u32_dpp v156, v156, v156 quad_perm:[2,3,0,1] row_mask:0xf bank_mask:0xf
    s_nop 1
    v_add_u32_dpp v156, v156, v156 row_ror:4 row_mask:0xf bank_mask:0xf
    s_nop 0
    v_readfirstlane_b32 s63, v156
    s_cmp_eq_u64 s[8:9], -1
    s_nop 3
    s_cbranch_scc0 .et_9
    s_lshr_b32 s63, s63, 3
    s_sub_u32 s63, s63, 300
    s_add_u32 s30, s30, s63
    s_add_u32 s31, s31, s63
.et_9:
    s_memrealtime s[8:9]
    s_waitcnt lgkmcnt(0)
    s_sub_u32 s8, s8, s30
    s_cmpk_ge_u32 s8, 1347
    s_cbranch_scc1 .ap_10
    s_waitcnt vmcnt(4)
    s_cmpk_ge_u32 s8, 1247
    s_cbranch_scc1 .ap_10
    s_waitcnt vmcnt(3)
    s_bitcmp1_b64 s[14:15], 31
    s_cbranch_scc0 1
    s_waitcnt vmcnt(2)
    s_cmpk_ge_u32 s8, 1127
    s_cbranch_scc1 .ap_10
    s_waitcnt vmcnt(1)
.ap_10:
    s_add_u32 s63, s69, 450560
    buffer_load_dwordx4 v[156:159], v1, s[40:43], s63 offen nt
    s_memrealtime s[8:9]
    s_waitcnt lgkmcnt(0)
    s_sub_u32 s8, s8, s30
    s_cmpk_ge_u32 s8, 1374
    s_cbranch_scc1 .ap_11
    s_waitcnt vmcnt(5)
    s_cmpk_ge_u32 s8, 1274
    s_cbranch_scc1 .ap_11
    s_waitcnt vmcnt(3)
    s_bitcmp1_b64 s[14:15], 32
    s_cbranch_scc0 1
    s_waitcnt vmcnt(2)
    s_cmpk_ge_u32 s8, 1154
    s_cbranch_scc1 .ap_11
    s_waitcnt vmcnt(1)
.ap_11:
    v_bfe_u32 v1, v0, 4, 2
    v_and_b32 v10, 0xf0, v2
    v_lshlrev_b32 v1, 2, v1
    v_bfe_u32 v1, s6, v1, 4
    v_lshl_add_u32 v1, v1, 8, v10
    s_add_u32 s63, s69, 0
    buffer_load_dwordx4 v[160:163], v1, s[44:47], s63 offen nt
    s_memrealtime s[8:9]
    s_waitcnt lgkmcnt(0)
    s_sub_u32 s8, s8, s30
    s_cmpk_ge_u32 s8, 1401
    s_cbranch_scc1 .ap_12
    s_waitcnt vmcnt(5)
    s_cmpk_ge_u32 s8, 1301
    s_cbranch_scc1 .ap_12
    s_waitcnt vmcnt(3)
    s_bitcmp1_b64 s[14:15], 33
    s_cbranch_scc0 1
    s_waitcnt vmcnt(2)
    s_cmpk_ge_u32 s8, 1181
    s_cbranch_scc1 .ap_12
    s_waitcnt vmcnt(1)
.ap_12:
    s_add_u32 s63, s69, 8192
    buffer_load_dwordx4 v[164:167], v1, s[44:47], s63 offen nt
    s_memrealtime s[8:9]
    s_waitcnt lgkmcnt(0)
    s_sub_u32 s8, s8, s30
    s_cmpk_ge_u32 s8, 1428
    s_cbranch_scc1 .ap_13
    s_waitcnt vmcnt(5)
    s_cmpk_ge_u32 s8, 1328
    s_cbranch_scc1 .ap_13
    s_waitcnt vmcnt(3)
    s_bitcmp1_b64 s[14:15], 34
    s_cbranch_scc0 1
    s_waitcnt vmcnt(2)
    s_cmpk_ge_u32 s8, 1208
    s_cbranch_scc1 .ap_13
    s_branch .Lsk_n1_0
.Lst_n1_0:
    s_branch .Lrt_n1_0
.Lsk_n1_0:
    s_waitcnt vmcnt(1)
.ap_13:
    s_add_u32 s63, s69, 16384
    buffer_load_dwordx4 v[168:171], v1, s[44:47], s63 offen nt
    s_memrealtime s[8:9]
    s_waitcnt lgkmcnt(0)
    s_sub_u32 s8, s8, s30
    s_cmpk_ge_u32 s8, 1456
    s_cbranch_scc1 .ap_14
    s_waitcnt vmcnt(5)
    s_cmpk_ge_u32 s8, 1356
    s_cbranch_scc1 .ap_14
    s_waitcnt vmcnt(3)
    s_bitcmp1_b64 s[14:15], 35
    s_cbranch_scc0 1
    s_waitcnt vmcnt(2)
    s_cmpk_ge_u32 s8, 1236
    s_cbranch_scc1 .ap_14
    s_waitcnt vmcnt(1)
.ap_14:
    s_add_u32 s63, s69, 24576
    buffer_load_dwordx4 v[172:175], v1, s[44:47], s63 offen nt
    buffer_load_dwordx4 v[16:19], v7, s[36:39], s58 offen offset:0 sc1
    buffer_load_dwordx4 v[20:23], v7, s[36:39], s58 offen offset:256 sc1
    s_memrealtime s[8:9]
    s_waitcnt vmcnt(8)
    s_waitcnt lgkmcnt(0)
    s_sub_u32 s8, s8, s30
    s_cmpk_ge_u32 s8, 1486
    s_cbranch_scc1 .ap_15
    s_waitcnt vmcnt(5)
    s_cmpk_ge_u32 s8, 1386
    s_cbranch_scc1 .ap_15
    s_waitcnt vmcnt(3)
    s_bitcmp1_b64 s[14:15], 36
    s_cbranch_scc0 1
    s_waitcnt vmcnt(2)
    s_cmpk_ge_u32 s8, 1266
    s_cbranch_scc1 .ap_15
    s_waitcnt vmcnt(1)
.ap_15:
    s_add_u32 s63, s69, 32768
    buffer_load_dwordx4 v[176:179], v1, s[44:47], s63 offen nt
    s_memrealtime s[8:9]
    s_waitcnt vmcnt(8)
    s_waitcnt lgkmcnt(0)
    s_sub_u32 s8, s8, s30
    s_cmpk_ge_u32 s8, 1516
    s_cbranch_scc1 .ap_16
    s_waitcnt vmcnt(5)
    s_cmpk_ge_u32 s8, 1416
    s_cbranch_scc1 .ap_16
    s_waitcnt vmcnt(3)
    s_bitcmp1_b64 s[14:15], 37
    s_cbranch_scc0 1
    s_waitcnt vmcnt(2)
    s_cmpk_ge_u32 s8, 1296
    s_cbranch_scc1 .ap_16
    s_waitcnt vmcnt(1)
.ap_16:
    s_add_u32 s63, s69, 40960
    buffer_load_dwordx4 v[180:183], v1, s[44:47], s63 offen nt
    s_memrealtime s[8:9]
    s_waitcnt vmcnt(8)
    s_waitcnt lgkmcnt(0)
    s_sub_u32 s8, s8, s30
    s_cmpk_ge_u32 s8, 1546
    s_cbranch_scc1 .ap_17
    s_waitcnt vmcnt(5)
    s_cmpk_ge_u32 s8, 1446
    s_cbranch_scc1 .ap_17
    s_waitcnt vmcnt(3)
    s_bitcmp1_b64 s[14:15], 38
    s_cbranch_scc0 1
    s_waitcnt vmcnt(2)
    s_cmpk_ge_u32 s8, 1326
    s_cbranch_scc1 .ap_17
    s_waitcnt vmcnt(1)
.ap_17:
    s_add_u32 s63, s69, 49152
    buffer_load_dwordx4 v[184:187], v1, s[44:47], s63 offen nt
    s_waitcnt vmcnt(3)
    s_branch .gpc_19
.gp_18:
    buffer_load_dwordx4 v[16:19], v7, s[36:39], s58 offen offset:0 sc1
    buffer_load_dwordx4 v[20:23], v7, s[36:39], s58 offen offset:256 sc1
    s_waitcnt vmcnt(0)
.gpc_19:
    v_min_u32 v10, v17, v19
    v_max_u32 v11, v17, v19
    v_min3_u32 v10, v10, v21, v23
    v_max3_u32 v11, v11, v21, v23
    v_cmp_eq_u32 vcc, s34, v10
    v_cmp_eq_u32 s[56:57], s34, v11
    s_and_b64 vcc, vcc, s[56:57]
    s_cmp_eq_u64 vcc, -1
    s_nop 2
    s_cbranch_scc1 .gpd_20
    s_sub_u32 s35, s35, 1
    s_cbranch_scc1 .Lexit
    s_sleep 1
    s_branch .gp_18
.gpd_20:
    s_mov_b32 vcc_lo, 0xcccccccc
    s_mov_b32 vcc_hi, 0xcccccccc
    v_cndmask_b32_e64 v24, v16, 0, vcc
    v_cndmask_b32_e64 v25, v18, 0, vcc
    v_cndmask_b32_e64 v26, v20, 0, vcc
    v_cndmask_b32_e64 v27, v22, 0, vcc
    v_cndmask_b32_e32 v28, 0, v16, vcc
    v_cndmask_b32_e32 v29, 0, v18, vcc
    v_cndmask_b32_e32 v30, 0, v20, vcc
    v_cndmask_b32_e32 v31, 0, v22, vcc
    v_mfma_f32_16x16x32_bf16 v[16:19], v[32:35], v[24:27], 0
    v_mfma_f32_16x16x32_bf16 v[32:35], v[40:43], v[24:27], 0
    v_mfma_f32_16x16x32_bf16 v[16:19], v[36:39], v[28:31], v[16:19]
    v_mfma_f32_16x16x32_bf16 v[40:43], v[48:51], v[24:27], 0
    v_mfma_f32_16x16x32_bf16 v[32:35], v[44:47], v[28:31], v[32:35]
    v_mfma_f32_16x16x32_bf16 v[48:51], v[56:59], v[24:27], 0
    v_mfma_f32_16x16x32_bf16 v[40:43], v[52:55], v[28:31], v[40:43]
    v_mfma_f32_16x16x32_bf16 v[56:59], v[64:67], v[24:27], 0
    v_mfma_f32_16x16x32_bf16 v[48:51], v[60:63], v[28:31], v[48:51]
    s_nop 1
    v_add_f32_dpp v10, v17, v16 row_ror:12 row_mask:0xf bank_mask:0x1
    s_memrealtime s[8:9]
    s_waitcnt lgkmcnt(0)
    s_sub_u32 s8, s8, s30
    s_cmpk_ge_u32 s8, 1576
    s_nop 0
    s_cbranch_scc1 .ap_21
    s_waitcnt vmcnt(3)
    s_cmpk_ge_u32 s8, 1476
    s_cbranch_scc1 .ap_21
    s_waitcnt vmcnt(3)
    s_bitcmp1_b64 s[14:15], 39
    s_cbranch_scc0 1
    s_waitcnt vmcnt(2)
    s_cmpk_ge_u32 s8, 1356
    s_cbranch_scc1 .ap_21
    s_waitcnt vmcnt(1)
.ap_21:
    s_add_u32 s63, s69, 57344
    buffer_load_dwordx4 v[188:191], v1, s[44:47], s63 offen nt
    v_mfma_f32_16x16x32_bf16 v[64:67], v[72:75], v[24:27], 0
    v_mfma_f32_16x16x32_bf16 v[56:59], v[68:71], v[28:31], v[56:59]
    v_add_f32_dpp v11, v33, v32 row_ror:12 row_mask:0xf bank_mask:0x1
    v_add_f32_dpp v10, v18, v10 row_ror:8 row_mask:0xf bank_mask:0x1
    v_mfma_f32_16x16x32_bf16 v[72:75], v[80:83], v[24:27], 0
    v_mfma_f32_16x16x32_bf16 v[64:67], v[76:79], v[28:31], v[64:67]
    v_add_f32_dpp v12, v41, v40 row_ror:12 row_mask:0xf bank_mask:0x1
    v_add_f32_dpp v11, v34, v11 row_ror:8 row_mask:0xf bank_mask:0x1
    v_add_f32_dpp v10, v19, v10 row_ror:4 row_mask:0xf bank_mask:0x1
    v_mfma_f32_16x16x32_bf16 v[80:83], v[88:91], v[24:27], 0
    v_mfma_f32_16x16x32_bf16 v[72:75], v[84:87], v[28:31], v[72:75]
    v_add_f32_dpp v13, v49, v48 row_ror:12 row_mask:0xf bank_mask:0x1
    v_add_f32_dpp v12, v42, v12 row_ror:8 row_mask:0xf bank_mask:0x1
    v_add_f32_dpp v11, v35, v11 row_ror:4 row_mask:0xf bank_mask:0x1
    v_mfma_f32_16x16x32_bf16 v[88:91], v[96:99], v[24:27], 0
    v_mfma_f32_16x16x32_bf16 v[80:83], v[92:95], v[28:31], v[80:83]
    v_add_f32_dpp v10, v58, v57 row_ror:12 row_mask:0xf bank_mask:0x2
    v_add_f32_dpp v13, v50, v13 row_ror:8 row_mask:0xf bank_mask:0x1
    v_add_f32_dpp v12, v43, v12 row_ror:4 row_mask:0xf bank_mask:0x1
    s_memrealtime s[8:9]
    s_waitcnt lgkmcnt(0)
    s_sub_u32 s8, s8, s30
    s_cmpk_ge_u32 s8, 1606
    s_nop 0
    s_cbranch_scc1 .ap_22
    s_waitcnt vmcnt(4)
    s_cmpk_ge_u32 s8, 1506
    s_cbranch_scc1 .ap_22
    s_waitcnt vmcnt(3)
    s_bitcmp1_b64 s[14:15], 40
    s_cbranch_scc0 1
    s_waitcnt vmcnt(2)
    s_cmpk_ge_u32 s8, 1386
    s_cbranch_scc1 .ap_22
    s_waitcnt vmcnt(1)
.ap_22:
    s_add_u32 s63, s69, 131072
    buffer_load_dwordx4 v[192:195], v1, s[44:47], s63 offen nt
    v_mfma_f32_16x16x32_bf16 v[96:99], v[104:107], v[24:27], 0
    v_mfma_f32_16x16x32_bf16 v[88:91], v[100:103], v[28:31], v[88:91]
    v_add_f32_dpp v11, v66, v65 row_ror:12 row_mask:0xf bank_mask:0x2
    v_add_f32_dpp v10, v59, v10 row_ror:8 row_mask:0xf bank_mask:0x2
    v_add_f32_dpp v13, v51, v13 row_ror:4 row_mask:0xf bank_mask:0x1
    v_mfma_f32_16x16x32_bf16 v[104:107], v[112:115], v[24:27], 0
    v_mfma_f32_16x16x32_bf16 v[96:99], v[108:111], v[28:31], v[96:99]
    v_add_f32_dpp v12, v74, v73 row_ror:12 row_mask:0xf bank_mask:0x2
    v_add_f32_dpp v11, v67, v11 row_ror:8 row_mask:0xf bank_mask:0x2
    v_add_f32_dpp v10, v56, v10 row_ror:4 row_mask:0xf bank_mask:0x2
    v_mfma_f32_16x16x32_bf16 v[112:115], v[120:123], v[24:27], 0
    v_mfma_f32_16x16x32_bf16 v[104:107], v[116:119], v[28:31], v[104:107]
    v_add_f32_dpp v13, v82, v81 row_ror:12 row_mask:0xf bank_mask:0x2
    v_add_f32_dpp v12, v75, v12 row_ror:8 row_mask:0xf bank_mask:0x2
    v_add_f32_dpp v11, v64, v11 row_ror:4 row_mask:0xf bank_mask:0x2
    v_mfma_f32_16x16x32_bf16 v[120:123], v[128:131], v[24:27], 0
    v_mfma_f32_16x16x32_bf16 v[112:115], v[124:127], v[28:31], v[112:115]
    v_add_f32_dpp v10, v91, v90 row_ror:12 row_mask:0xf bank_mask:0x4
    v_add_f32_dpp v13, v83, v13 row_ror:8 row_mask:0xf bank_mask:0x2
    v_add_f32_dpp v12, v72, v12 row_ror:4 row_mask:0xf bank_mask:0x2
    s_branch .Lsk_n1_1
.Lst_n1_1:
    s_branch .Lrt_n1_1
.Lsk_n1_1:
    s_memrealtime s[8:9]
    s_waitcnt lgkmcnt(0)
    s_sub_u32 s8, s8, s30
    s_cmpk_ge_u32 s8, 1636
    s_nop 0
    s_cbranch_scc1 .ap_23
    s_waitcnt vmcnt(5)
    s_cmpk_ge_u32 s8, 1536
    s_cbranch_scc1 .ap_23
    s_waitcnt vmcnt(3)
    s_bitcmp1_b64 s[14:15], 41
    s_cbranch_scc0 1
    s_waitcnt vmcnt(2)
    s_cmpk_ge_u32 s8, 1416
    s_cbranch_scc1 .ap_23
    s_waitcnt vmcnt(1)
.ap_23:
    s_add_u32 s63, s69, 139264
    buffer_load_dwordx4 v[196:199], v1, s[44:47], s63 offen nt
    v_mfma_f32_16x16x32_bf16 v[128:131], v[136:139], v[24:27], 0
    v_mfma_f32_16x16x32_bf16 v[120:123], v[132:135], v[28:31], v[120:123]
    v_add_f32_dpp v11, v99, v98 row_ror:12 row_mask:0xf bank_mask:0x4
    v_add_f32_dpp v10, v88, v10 row_ror:8 row_mask:0xf bank_mask:0x4
    v_add_f32_dpp v13, v80, v13 row_ror:4 row_mask:0xf bank_mask:0x2
    v_mfma_f32_16x16x32_bf16 v[136:139], v[144:147], v[24:27], 0
    v_mfma_f32_16x16x32_bf16 v[128:131], v[140:143], v[28:31], v[128:131]
    v_add_f32_dpp v12, v107, v106 row_ror:12 row_mask:0xf bank_mask:0x4
    v_add_f32_dpp v11, v96, v11 row_ror:8 row_mask:0xf bank_mask:0x4
    v_add_f32_dpp v10, v89, v10 row_ror:4 row_mask:0xf bank_mask:0x4
    v_mfma_f32_16x16x32_bf16 v[144:147], v[152:155], v[24:27], 0
    v_mfma_f32_16x16x32_bf16 v[136:139], v[148:151], v[28:31], v[136:139]
    v_add_f32_dpp v13, v115, v114 row_ror:12 row_mask:0xf bank_mask:0x4
    v_add_f32_dpp v12, v104, v12 row_ror:8 row_mask:0xf bank_mask:0x4
    v_add_f32_dpp v11, v97, v11 row_ror:4 row_mask:0xf bank_mask:0x4
    v_mfma_f32_16x16x32_bf16 v[144:147], v[156:159], v[28:31], v[144:147]
    v_add_f32_dpp v10, v120, v123 row_ror:12 row_mask:0xf bank_mask:0x8
    v_add_f32_dpp v13, v112, v13 row_ror:8 row_mask:0xf bank_mask:0x4
    v_add_f32_dpp v12, v105, v12 row_ror:4 row_mask:0xf bank_mask:0x4
    s_branch .Lsk_n1_2
.Lst_n1_2:
    s_branch .Lrt_n1_2
.Lsk_n1_2:
    s_memrealtime s[8:9]
    s_waitcnt lgkmcnt(0)
    s_sub_u32 s8, s8, s30
    s_cmpk_ge_u32 s8, 1666
    s_nop 0
    s_cbranch_scc1 .ap_24
    s_waitcnt vmcnt(5)
    s_cmpk_ge_u32 s8, 1566
    s_cbranch_scc1 .ap_24
    s_waitcnt vmcnt(3)
    s_bitcmp1_b64 s[14:15], 42
    s_cbranch_scc0 1
    s_waitcnt vmcnt(2)
    s_cmpk_ge_u32 s8, 1446
    s_cbranch_scc1 .ap_24
    s_waitcnt vmcnt(1)
.ap_24:
    s_add_u32 s63, s69, 147456
    buffer_load_dwordx4 v[200:203], v1, s[44:47], s63 offen nt
    v_add_f32_dpp v11, v128, v131 row_ror:12 row_mask:0xf bank_mask:0x8
    v_add_f32_dpp v10, v121, v10 row_ror:8 row_mask:0xf bank_mask:0x8
    v_add_f32_dpp v13, v113, v13 row_ror:4 row_mask:0xf bank_mask:0x4
    v_add_f32_dpp v12, v136, v139 row_ror:12 row_mask:0xf bank_mask:0x8
    v_add_f32_dpp v11, v129, v11 row_ror:8 row_mask:0xf bank_mask:0x8
    v_add_f32_dpp v10, v122, v10 row_ror:4 row_mask:0xf bank_mask:0x8
    v_add_f32_dpp v13, v144, v147 row_ror:12 row_mask:0xf bank_mask:0x8
    v_add_f32_dpp v12, v137, v12 row_ror:8 row_mask:0xf bank_mask:0x8
    v_add_f32_dpp v11, v130, v11 row_ror:4 row_mask:0xf bank_mask:0x8
    v_add_f32_dpp v13, v145, v13 row_ror:8 row_mask:0xf bank_mask:0x8
    v_add_f32_dpp v12, v138, v12 row_ror:4 row_mask:0xf bank_mask:0x8
    s_memrealtime s[8:9]
    s_waitcnt lgkmcnt(0)
    s_sub_u32 s8, s8, s30
    s_cmpk_ge_u32 s8, 1696
    s_cbranch_scc1 .ap_25
    s_waitcnt vmcnt(5)
    s_cmpk_ge_u32 s8, 1596
    s_cbranch_scc1 .ap_25
    s_waitcnt vmcnt(3)
    s_bitcmp1_b64 s[14:15], 43
    s_cbranch_scc0 1
    s_waitcnt vmcnt(2)
    s_cmpk_ge_u32 s8, 1476
    s_cbranch_scc1 .ap_25
    s_waitcnt vmcnt(1)
.ap_25:
    s_add_u32 s63, s69, 155648
    buffer_load_dwordx4 v[204:207], v1, s[44:47], s63 offen nt
    v_add_f32_dpp v13, v146, v13 row_ror:4 row_mask:0xf bank_mask:0x8
    s_mov_b32 s60, 0x3db504f3
    s_mov_b32 s61, 0x3db504f3
    v_cvt_pk_bf16_f32 v10, v10, v11
    v_and_b32 v11, 0xffff0000, v10
    v_lshlrev_b32 v10, 16, v10
    v_cvt_pk_bf16_f32 v12, v12, v13
    v_and_b32 v13, 0xffff0000, v12
    v_lshlrev_b32 v12, 16, v12
    v_pk_mul_f32 v[10:11], v[10:11], s[60:61]
    v_pk_mul_f32 v[12:13], v[12:13], s[60:61]
    v_cvt_pk_bf16_f32 v10, v10, v11
    v_and_b32 v11, 0xffff0000, v10
    v_lshlrev_b32 v10, 16, v10
    v_cvt_pk_bf16_f32 v12, v12, v13
    v_and_b32 v13, 0xffff0000, v12
    v_lshlrev_b32 v12, 16, v12
    v_max_f32 v14, v10, v11
    v_max3_f32 v14, v14, v12, v13
    s_mov_b32 s60, 0x3fb8aa3b
    v_mov_b32 v22, s34
    v_mov_b32 v23, s34
    v_max_f32_dpp v14, v14, v14 quad_perm:[2,3,0,1] row_mask:0xf bank_mask:0xf
    s_nop 1
    v_max_f32_dpp v14, v14, v14 row_ror:4 row_mask:0xf bank_mask:0xf
    s_nop 1
    v_max_f32_dpp v14, v14, v14 row_ror:8 row_mask:0xf bank_mask:0xf
    v_mov_b32 v15, v14
    s_nop 1
    v_permlane16_swap_b32 v15, v14
    v_max_f32 v14, v15, v14
    v_mov_b32 v15, v14
    s_nop 1
    v_permlane32_swap_b32 v15, v14
    v_max_f32 v14, v15, v14
    v_mul_f32 v15, 0xbfb8aa3b, v14
    v_fma_f32 v10, v10, s60, v15
    v_fma_f32 v11, v11, s60, v15
    v_fma_f32 v12, v12, s60, v15
    v_fma_f32 v13, v13, s60, v15
    v_exp_f32 v10, v10
    v_exp_f32 v11, v11
    v_exp_f32 v12, v12
    v_exp_f32 v13, v13
    v_mov_b32 v20, v14
    v_pk_add_f32 v[16:17], v[10:11], v[12:13]
    v_add_f32 v21, v16, v17
    s_lshl_b32 s60, s68, 5
    s_lshl_b32 s61, s3, 4
    s_add_u32 s61, s61, 159104
    v_add_u32 v16, s61, v3
    v_mov_b32 v17, 159232
    v_mov_b32 v18, 1
    s_add_u32 s60, s60, s59
    v_add_f32_dpp v21, v21, v21 quad_perm:[2,3,0,1] row_mask:0xf bank_mask:0xf
    s_nop 1
    v_add_f32_dpp v21, v21, v21 row_ror:4 row_mask:0xf bank_mask:0xf
    s_nop 1
    v_add_f32_dpp v21, v21, v21 row_ror:8 row_mask:0xf bank_mask:0xf
    v_mov_b32 v15, v21
    s_nop 1
    v_permlane16_swap_b32 v15, v21
    v_add_f32 v21, v15, v21
    v_mov_b32 v15, v21
    s_nop 1
    v_permlane32_swap_b32 v15, v21
    v_add_f32 v21, v15, v21
    s_mov_b64 exec, 3
    ds_write_b64 v16, v[20:21]
    s_mov_b64 exec, 1
    ds_add_rtn_u32 v18, v17, v18
    s_mov_b64 exec, -1
    v_and_b32 v16, 0x78, v3
    v_or_b32 v16, 159104, v16
    s_waitcnt lgkmcnt(0)
    v_readfirstlane_b32 s61, v18
    s_cmp_eq_u32 s61, 7
    s_nop 3
    s_cbranch_scc0 .mlc_26
    ds_read_b64 v[18:19], v16
    s_waitcnt lgkmcnt(0)
    v_mov_b32 v20, v18
    s_nop 1
    v_max_f32_dpp v20, v20, v20 quad_perm:[2,3,0,1] row_mask:0xf bank_mask:0xf
    s_nop 1
    v_max_f32_dpp v20, v20, v20 row_ror:4 row_mask:0xf bank_mask:0xf
    s_nop 1
    v_max_f32_dpp v20, v20, v20 row_ror:8 row_mask:0xf bank_mask:0xf
    v_sub_f32 v18, v18, v20
    v_mul_f32 v18, 0x3fb8aa3b, v18
    v_exp_f32 v18, v18
    s_nop 0
    v_mul_f32 v21, v18, v19
    s_nop 1
    v_add_f32_dpp v21, v21, v21 quad_perm:[2,3,0,1] row_mask:0xf bank_mask:0xf
    s_nop 1
    v_add_f32_dpp v21, v21, v21 row_ror:4 row_mask:0xf bank_mask:0xf
    s_nop 1
    v_add_f32_dpp v21, v21, v21 row_ror:8 row_mask:0xf bank_mask:0xf
    s_mov_b64 exec, 3
    buffer_store_dwordx4 v[20:23], v2, s[36:39], s60 offen sc1
    s_mov_b64 exec, -1
.mlc_26:
    s_memrealtime s[8:9]
    s_waitcnt lgkmcnt(0)
    s_sub_u32 s8, s8, s30
    s_cmpk_ge_u32 s8, 1726
    s_cbranch_scc1 .ap_27
    s_waitcnt vmcnt(5)
    s_cmpk_ge_u32 s8, 1626
    s_cbranch_scc1 .ap_27
    s_waitcnt vmcnt(3)
    s_bitcmp1_b64 s[14:15], 44
    s_cbranch_scc0 1
    s_waitcnt vmcnt(2)
    s_cmpk_ge_u32 s8, 1506
    s_cbranch_scc1 .ap_27
    s_waitcnt vmcnt(1)
.ap_27:
    s_add_u32 s63, s69, 163840
    buffer_load_dwordx4 v[208:211], v1, s[44:47], s63 offen nt
    s_memrealtime s[8:9]
    s_waitcnt vmcnt(8)
    s_waitcnt lgkmcnt(0)
    s_sub_u32 s8, s8, s30
    s_cmpk_ge_u32 s8, 1756
    s_cbranch_scc1 .ap_28
    s_waitcnt vmcnt(5)
    s_cmpk_ge_u32 s8, 1656
    s_cbranch_scc1 .ap_28
    s_waitcnt vmcnt(3)
    s_bitcmp1_b64 s[14:15], 45
    s_cbranch_scc0 1
    s_waitcnt vmcnt(2)
    s_cmpk_ge_u32 s8, 1536
    s_cbranch_scc1 .ap_28
    s_waitcnt vmcnt(1)
.ap_28:
    s_add_u32 s63, s69, 172032
    buffer_load_dwordx4 v[212:215], v1, s[44:47], s63 offen nt
    s_memrealtime s[8:9]
    s_waitcnt vmcnt(8)
    s_waitcnt lgkmcnt(0)
    s_sub_u32 s8, s8, s30
    s_cmpk_ge_u32 s8, 1788
    s_cbranch_scc1 .ap_29
    s_waitcnt vmcnt(5)
    s_cmpk_ge_u32 s8, 1688
    s_cbranch_scc1 .ap_29
    s_waitcnt vmcnt(3)
    s_bitcmp1_b64 s[14:15], 46
    s_cbranch_scc0 1
    s_waitcnt vmcnt(2)
    s_cmpk_ge_u32 s8, 1568
    s_cbranch_scc1 .ap_29
    s_waitcnt vmcnt(1)
.ap_29:
    s_add_u32 s63, s69, 180224
    buffer_load_dwordx4 v[216:219], v1, s[44:47], s63 offen nt
    s_branch .Lsk_n1_3
.Lst_n1_3:
    s_branch .Lrt_n1_3
.Lsk_n1_3:
    s_memrealtime s[8:9]
    s_waitcnt vmcnt(8)
    s_waitcnt lgkmcnt(0)
    s_sub_u32 s8, s8, s30
    s_cmpk_ge_u32 s8, 1820
    s_cbranch_scc1 .ap_30
    s_waitcnt vmcnt(5)
    s_cmpk_ge_u32 s8, 1720
    s_cbranch_scc1 .ap_30
    s_waitcnt vmcnt(3)
    s_bitcmp1_b64 s[14:15], 47
    s_cbranch_scc0 1
    s_waitcnt vmcnt(2)
    s_cmpk_ge_u32 s8, 1600
    s_cbranch_scc1 .ap_30
    s_waitcnt vmcnt(1)
.ap_30:
    s_add_u32 s63, s69, 188416
    buffer_load_dwordx4 v[220:223], v1, s[44:47], s63 offen nt
    s_memrealtime s[8:9]
    s_waitcnt vmcnt(8)
    s_waitcnt lgkmcnt(0)
    s_sub_u32 s8, s8, s30
    s_cmpk_ge_u32 s8, 1852
    s_cbranch_scc1 .ap_31
    s_waitcnt vmcnt(5)
    s_cmpk_ge_u32 s8, 1752
    s_cbranch_scc1 .ap_31
    s_waitcnt vmcnt(3)
    s_bitcmp1_b64 s[14:15], 48
    s_cbranch_scc0 1
    s_waitcnt vmcnt(2)
    s_cmpk_ge_u32 s8, 1632
    s_cbranch_scc1 .ap_31
    s_waitcnt vmcnt(1)
.ap_31:
    s_add_u32 s63, s69, 262144
    buffer_load_dwordx4 v[224:227], v1, s[44:47], s63 offen nt
    s_memrealtime s[8:9]
    s_waitcnt vmcnt(8)
    s_waitcnt lgkmcnt(0)
    s_sub_u32 s8, s8, s30
    s_cmpk_ge_u32 s8, 1884
    s_cbranch_scc1 .ap_32
    s_waitcnt vmcnt(5)
    s_cmpk_ge_u32 s8, 1784
    s_cbranch_scc1 .ap_32
    s_waitcnt vmcnt(3)
    s_bitcmp1_b64 s[14:15], 49
    s_cbranch_scc0 1
    s_waitcnt vmcnt(2)
    s_cmpk_ge_u32 s8, 1664
    s_cbranch_scc1 .ap_32
    s_waitcnt vmcnt(1)
.ap_32:
    s_add_u32 s63, s69, 270336
    buffer_load_dwordx4 v[228:231], v1, s[44:47], s63 offen nt
    s_memrealtime s[8:9]
    s_waitcnt vmcnt(8)
    s_waitcnt lgkmcnt(0)
    s_sub_u32 s8, s8, s30
    s_cmpk_ge_u32 s8, 1916
    s_cbranch_scc1 .ap_33
    s_waitcnt vmcnt(5)
    s_cmpk_ge_u32 s8, 1816
    s_cbranch_scc1 .ap_33
    s_waitcnt vmcnt(3)
    s_bitcmp1_b64 s[14:15], 50
    s_cbranch_scc0 1
    s_waitcnt vmcnt(2)
    s_cmpk_ge_u32 s8, 1696
    s_cbranch_scc1 .ap_33
    s_waitcnt vmcnt(1)
.ap_33:
    s_add_u32 s63, s69, 278528
    buffer_load_dwordx4 v[232:235], v1, s[44:47], s63 offen nt
    s_memrealtime s[8:9]
    s_waitcnt vmcnt(8)
    s_waitcnt lgkmcnt(0)
    s_sub_u32 s8, s8, s30
    s_cmpk_ge_u32 s8, 1948
    s_cbranch_scc1 .ap_34
    s_waitcnt vmcnt(5)
    s_cmpk_ge_u32 s8, 1848
    s_cbranch_scc1 .ap_34
    s_waitcnt vmcnt(3)
    s_bitcmp1_b64 s[14:15], 51
    s_cbranch_scc0 1
    s_waitcnt vmcnt(2)
    s_cmpk_ge_u32 s8, 1728
    s_cbranch_scc1 .ap_34
    s_waitcnt vmcnt(1)
.ap_34:
    s_add_u32 s63, s69, 286720
    buffer_load_dwordx4 v[236:239], v1, s[44:47], s63 offen nt
    s_memrealtime s[8:9]
    s_waitcnt vmcnt(8)
    s_waitcnt lgkmcnt(0)
    s_sub_u32 s8, s8, s30
    s_cmpk_ge_u32 s8, 1980
    s_cbranch_scc1 .ap_35
    s_waitcnt vmcnt(5)
    s_cmpk_ge_u32 s8, 1880
    s_cbranch_scc1 .ap_35
    s_waitcnt vmcnt(3)
    s_bitcmp1_b64 s[14:15], 52
    s_cbranch_scc0 1
    s_waitcnt vmcnt(2)
    s_cmpk_ge_u32 s8, 1760
    s_cbranch_scc1 .ap_35
    s_waitcnt vmcnt(1)
.ap_35:
    s_add_u32 s63, s69, 294912
    buffer_load_dwordx4 v[240:243], v1, s[44:47], s63 offen nt
    s_memrealtime s[8:9]
    s_waitcnt vmcnt(8)
    s_waitcnt lgkmcnt(0)
    s_sub_u32 s8, s8, s30
    s_cmpk_ge_u32 s8, 2012
    s_cbranch_scc1 .ap_36
    s_waitcnt vmcnt(5)
    s_cmpk_ge_u32 s8, 1912
    s_cbranch_scc1 .ap_36
    s_waitcnt vmcnt(3)
    s_bitcmp1_b64 s[14:15], 53
    s_cbranch_scc0 1
    s_waitcnt vmcnt(2)
    s_cmpk_ge_u32 s8, 1792
    s_cbranch_scc1 .ap_36
    s_waitcnt vmcnt(1)
.ap_36:
    s_add_u32 s63, s69, 303104
    buffer_load_dwordx4 v[244:247], v1, s[44:47], s63 offen nt
    s_and_b32 s0, s0, 0xffffff80
    s_sub_u32 s0, s0, 1024
    buffer_load_dword v28, v4, s[36:39], s0 offen sc1
    buffer_load_dwordx4 v[24:27], v9, s[36:39], s59 offen offset:0 sc1
    s_memrealtime s[8:9]
    s_waitcnt vmcnt(9)
    s_waitcnt lgkmcnt(0)
    s_sub_u32 s8, s8, s30
    s_cmpk_ge_u32 s8, 2044
    s_cbranch_scc1 .ap_37
    s_waitcnt vmcnt(6)
    s_cmpk_ge_u32 s8, 1944
    s_cbranch_scc1 .ap_37
    s_waitcnt vmcnt(4)
    s_bitcmp1_b64 s[14:15], 54
    s_cbranch_scc0 1
    s_waitcnt vmcnt(3)
    s_cmpk_ge_u32 s8, 1824
    s_cbranch_scc1 .ap_37
    s_waitcnt vmcnt(2)
.ap_37:
    s_add_u32 s63, s69, 311296
    buffer_load_dwordx4 v[248:251], v1, s[44:47], s63 offen nt
    s_memrealtime s[8:9]
    s_waitcnt vmcnt(9)
    s_waitcnt lgkmcnt(0)
    s_sub_u32 s8, s8, s30
    s_cmpk_ge_u32 s8, 2076
    s_cbranch_scc1 .ap_38
    s_waitcnt vmcnt(6)
    s_cmpk_ge_u32 s8, 1976
    s_cbranch_scc1 .ap_38
    s_waitcnt vmcnt(4)
    s_bitcmp1_b64 s[14:15], 55
    s_cbranch_scc0 1
    s_waitcnt vmcnt(3)
    s_cmpk_ge_u32 s8, 1856
    s_cbranch_scc1 .ap_38
    s_waitcnt vmcnt(1)
.ap_38:
    s_add_u32 s63, s69, 319488
    buffer_load_dwordx4 v[252:255], v1, s[44:47], s63 offen nt
    s_memrealtime s[8:9]
    s_waitcnt vmcnt(9)
    s_waitcnt lgkmcnt(0)
    s_sub_u32 s8, s8, s30
    s_cmpk_ge_u32 s8, 2108
    s_cbranch_scc1 .ap_39
    s_waitcnt vmcnt(6)
    s_cmpk_ge_u32 s8, 2008
    s_cbranch_scc1 .ap_39
    s_waitcnt vmcnt(4)
    s_bitcmp1_b64 s[14:15], 56
    s_cbranch_scc0 1
    s_waitcnt vmcnt(2)
    s_cmpk_ge_u32 s8, 1888
    s_cbranch_scc1 .ap_39
    s_waitcnt vmcnt(1)
.ap_39:
    s_add_u32 s63, s69, 393216
    buffer_load_dwordx4 v[36:39], v1, s[44:47], s63 offen nt
    s_memrealtime s[8:9]
    s_waitcnt vmcnt(9)
    s_waitcnt lgkmcnt(0)
    s_sub_u32 s8, s8, s30
    s_cmpk_ge_u32 s8, 2140
    s_cbranch_scc1 .ap_40
    s_waitcnt vmcnt(6)
    s_cmpk_ge_u32 s8, 2040
    s_cbranch_scc1 .ap_40
    s_waitcnt vmcnt(3)
    s_bitcmp1_b64 s[14:15], 57
    s_cbranch_scc0 1
    s_waitcnt vmcnt(2)
    s_cmpk_ge_u32 s8, 1920
    s_cbranch_scc1 .ap_40
    s_waitcnt vmcnt(1)
.ap_40:
    s_add_u32 s63, s69, 401408
    buffer_load_dwordx4 v[44:47], v1, s[44:47], s63 offen nt
    s_memrealtime s[8:9]
    s_waitcnt vmcnt(9)
    s_waitcnt lgkmcnt(0)
    s_sub_u32 s8, s8, s30
    s_cmpk_ge_u32 s8, 2172
    s_cbranch_scc1 .ap_41
    s_waitcnt vmcnt(6)
    s_cmpk_ge_u32 s8, 2072
    s_cbranch_scc1 .ap_41
    s_waitcnt vmcnt(3)
    s_bitcmp1_b64 s[14:15], 58
    s_cbranch_scc0 1
    s_waitcnt vmcnt(2)
    s_cmpk_ge_u32 s8, 1952
    s_cbranch_scc1 .ap_41
    s_waitcnt vmcnt(1)
.ap_41:
    s_add_u32 s63, s69, 409600
    buffer_load_dwordx4 v[52:55], v1, s[44:47], s63 offen nt
    s_waitcnt vmcnt(5)
    s_branch .gpc_43
.gp_42:
    buffer_load_dwordx4 v[24:27], v9, s[36:39], s59 offen offset:0 sc1
    s_waitcnt vmcnt(0)
.gpc_43:
    v_cmp_eq_u32 vcc, s34, v26
    s_cmp_eq_u64 vcc, -1
    s_nop 3
    s_cbranch_scc1 .gpd_44
    s_sub_u32 s35, s35, 1
    s_branch .Lsk_n1_4
.Lst_n1_4:
    s_branch .Lrt_n1_4
.Lsk_n1_4:
    s_cbranch_scc1 .Lexit
    s_sleep 1
    s_branch .gp_42
.gpd_44:
    v_cmp_eq_u32 vcc, s1, v28
    s_cmp_eq_u64 vcc, -1
    s_cselect_b32 s0, 0x800000, 0
    v_mov_b32 v16, v24
    s_nop 1
    v_max_f32_dpp v16, v16, v16 row_ror:4 row_mask:0xf bank_mask:0xf
    v_sub_f32 v17, v24, v16
    v_sub_f32 v18, v14, v16
    v_mul_f32 v17, 0x3fb8aa3b, v17
    v_mul_f32 v18, 0x3fb8aa3b, v18
    v_exp_f32 v17, v17
    v_exp_f32 v18, v18
    v_mul_f32 v17, v17, v25
    s_nop 1
    v_add_f32_dpp v17, v17, v17 row_ror:4 row_mask:0xf bank_mask:0xf
    v_rcp_f32 v19, v17
    s_nop 0
    v_fma_f32 v15, -v17, v19, 1.0
    v_fma_f32 v19, v15, v19, v19
    v_mul_f32 v18, v18, v19
    v_mul_f32 v10, v10, v18
    v_mul_f32 v11, v11, v18
    v_mul_f32 v12, v12, v18
    v_mul_f32 v13, v13, v18
    v_mov_b32_dpp v112, v10 quad_perm:[2,3,0,1] row_mask:0xf bank_mask:0xf
    v_mov_b32_dpp v113, v11 quad_perm:[2,3,0,1] row_mask:0xf bank_mask:0xf
    v_mov_b32_dpp v114, v12 quad_perm:[2,3,0,1] row_mask:0xf bank_mask:0xf
    v_mov_b32_dpp v115, v13 quad_perm:[2,3,0,1] row_mask:0xf bank_mask:0xf
    v_cvt_pk_bf16_f32 v96, v10, v112
    v_cvt_pk_bf16_f32 v100, v11, v113
    v_cvt_pk_bf16_f32 v104, v12, v114
    v_cvt_pk_bf16_f32 v108, v13, v115
    v_mov_b32_dpp v97, v96 row_ror:12 row_mask:0xf bank_mask:0xf
    v_mov_b32_dpp v101, v100 row_ror:12 row_mask:0xf bank_mask:0xf
    v_mov_b32_dpp v105, v104 row_ror:12 row_mask:0xf bank_mask:0xf
    v_mov_b32_dpp v109, v108 row_ror:12 row_mask:0xf bank_mask:0xf
    v_mov_b32_dpp v98, v96 row_ror:8 row_mask:0xf bank_mask:0xf
    v_mov_b32_dpp v102, v100 row_ror:8 row_mask:0xf bank_mask:0xf
    v_mov_b32_dpp v106, v104 row_ror:8 row_mask:0xf bank_mask:0xf
    v_mov_b32_dpp v110, v108 row_ror:8 row_mask:0xf bank_mask:0xf
    v_mov_b32_dpp v99, v96 row_ror:4 row_mask:0xf bank_mask:0xf
    v_mov_b32_dpp v103, v100 row_ror:4 row_mask:0xf bank_mask:0xf
    v_mov_b32_dpp v107, v104 row_ror:4 row_mask:0xf bank_mask:0xf
    v_mov_b32_dpp v111, v108 row_ror:4 row_mask:0xf bank_mask:0xf
    s_lshl_b32 s60, s3, 10
    s_add_u32 s60, s60, 147456
    v_lshlrev_b32 v10, 5, v0
    v_add_u32 v10, s60, v10
    s_memrealtime s[8:9]
    s_waitcnt lgkmcnt(0)
    s_sub_u32 s8, s8, s30
    s_cmpk_ge_u32 s8, 2204
    s_cbranch_scc1 .ap_45
    s_waitcnt vmcnt(5)
    s_cmpk_ge_u32 s8, 2104
    s_cbranch_scc1 .ap_45
    s_waitcnt vmcnt(3)
    s_bitcmp1_b64 s[14:15], 59
    s_cbranch_scc0 1
    s_waitcnt vmcnt(2)
    s_cmpk_ge_u32 s8, 1984
    s_cbranch_scc1 .ap_45
    s_waitcnt vmcnt(1)
.ap_45:
    s_add_u32 s63, s69, 417792
    buffer_load_dwordx4 v[60:63], v1, s[44:47], s63 offen nt
    v_perm_b32 v112, v164, v160, s94
    v_perm_b32 v113, v172, v168, s94
    v_perm_b32 v114, v180, v176, s94
    v_perm_b32 v115, v188, v184, s94
    s_nop 1
    v_mfma_f32_16x16x32_bf16 v[128:131], v[96:99], v[112:115], 0
    v_perm_b32 v116, v164, v160, s95
    v_perm_b32 v117, v172, v168, s95
    v_perm_b32 v118, v180, v176, s95
    v_perm_b32 v119, v188, v184, s95
    s_nop 1
    v_mfma_f32_16x16x32_bf16 v[132:135], v[96:99], v[116:119], 0
    v_perm_b32 v120, v165, v161, s94
    v_perm_b32 v121, v173, v169, s94
    v_perm_b32 v122, v181, v177, s94
    v_perm_b32 v123, v189, v185, s94
    s_nop 1
    v_mfma_f32_16x16x32_bf16 v[136:139], v[96:99], v[120:123], 0
    v_perm_b32 v124, v165, v161, s95
    v_perm_b32 v125, v173, v169, s95
    v_perm_b32 v126, v181, v177, s95
    v_perm_b32 v127, v189, v185, s95
    s_nop 1
    v_mfma_f32_16x16x32_bf16 v[140:143], v[96:99], v[124:127], 0
    v_perm_b32 v112, v166, v162, s94
    v_perm_b32 v113, v174, v170, s94
    v_perm_b32 v114, v182, v178, s94
    v_perm_b32 v115, v190, v186, s94
    s_nop 1
    v_mfma_f32_16x16x32_bf16 v[144:147], v[96:99], v[112:115], 0
    v_perm_b32 v116, v166, v162, s95
    v_perm_b32 v117, v174, v170, s95
    v_perm_b32 v118, v182, v178, s95
    v_perm_b32 v119, v190, v186, s95
    s_nop 1
    v_mfma_f32_16x16x32_bf16 v[148:151], v[96:99], v[116:119], 0
    v_perm_b32 v120, v167, v163, s94
    v_perm_b32 v121, v175, v171, s94
    v_perm_b32 v122, v183, v179, s94
    v_perm_b32 v123, v191, v187, s94
    s_nop 1
    v_mfma_f32_16x16x32_bf16 v[152:155], v[96:99], v[120:123], 0
    v_perm_b32 v124, v167, v163, s95
    v_perm_b32 v125, v175, v171, s95
    v_perm_b32 v126, v183, v179, s95
    v_perm_b32 v127, v191, v187, s95
    s_nop 1
    v_mfma_f32_16x16x32_bf16 v[156:159], v[96:99], v[124:127], 0
    s_memrealtime s[8:9]
    s_waitcnt lgkmcnt(0)
    s_sub_u32 s8, s8, s30
    s_cmpk_ge_u32 s8, 2236
    s_nop 3
    s_cbranch_scc1 .ap_46
    s_waitcnt vmcnt(5)
    s_cmpk_ge_u32 s8, 2136
    s_cbranch_scc1 .ap_46
    s_waitcnt vmcnt(3)
    s_bitcmp1_b64 s[14:15], 60
    s_cbranch_scc0 1
    s_waitcnt vmcnt(2)
    s_cmpk_ge_u32 s8, 2016
    s_cbranch_scc1 .ap_46
    s_waitcnt vmcnt(1)
.ap_46:
    s_add_u32 s63, s69, 425984
    buffer_load_dwordx4 v[68:71], v1, s[44:47], s63 offen nt
    v_perm_b32 v112, v196, v192, s94
    v_perm_b32 v113, v204, v200, s94
    v_perm_b32 v114, v212, v208, s94
    v_perm_b32 v115, v220, v216, s94
    s_nop 1
    v_mfma_f32_16x16x32_bf16 v[128:131], v[100:103], v[112:115], v[128:131]
    v_perm_b32 v116, v196, v192, s95
    v_perm_b32 v117, v204, v200, s95
    v_perm_b32 v118, v212, v208, s95
    v_perm_b32 v119, v220, v216, s95
    s_nop 1
    v_mfma_f32_16x16x32_bf16 v[132:135], v[100:103], v[116:119], v[132:135]
    v_perm_b32 v120, v197, v193, s94
    v_perm_b32 v121, v205, v201, s94
    v_perm_b32 v122, v213, v209, s94
    v_perm_b32 v123, v221, v217, s94
    s_nop 1
    v_mfma_f32_16x16x32_bf16 v[136:139], v[100:103], v[120:123], v[136:139]
    v_perm_b32 v124, v197, v193, s95
    v_perm_b32 v125, v205, v201, s95
    v_perm_b32 v126, v213, v209, s95
    v_perm_b32 v127, v221, v217, s95
    s_nop 1
    v_mfma_f32_16x16x32_bf16 v[140:143], v[100:103], v[124:127], v[140:143]
    v_perm_b32 v112, v198, v194, s94
    v_perm_b32 v113, v206, v202, s94
    v_perm_b32 v114, v214, v210, s94
    v_perm_b32 v115, v222, v218, s94
    s_nop 1
    v_mfma_f32_16x16x32_bf16 v[144:147], v[100:103], v[112:115], v[144:147]
    v_perm_b32 v116, v198, v194, s95
    v_perm_b32 v117, v206, v202, s95
    v_perm_b32 v118, v214, v210, s95
    v_perm_b32 v119, v222, v218, s95
    s_branch .Lsk_n1_5
.Lst_n1_5:
    s_branch .Lrt_n1_5
.Lsk_n1_5:
    s_nop 1
    v_mfma_f32_16x16x32_bf16 v[148:151], v[100:103], v[116:119], v[148:151]
    v_perm_b32 v120, v199, v195, s94
    v_perm_b32 v121, v207, v203, s94
    v_perm_b32 v122, v215, v211, s94
    v_perm_b32 v123, v223, v219, s94
    s_nop 1
    v_mfma_f32_16x16x32_bf16 v[152:155], v[100:103], v[120:123], v[152:155]
    v_perm_b32 v124, v199, v195, s95
    v_perm_b32 v125, v207, v203, s95
    v_perm_b32 v126, v215, v211, s95
    v_perm_b32 v127, v223, v219, s95
    s_nop 1
    v_mfma_f32_16x16x32_bf16 v[156:159], v[100:103], v[124:127], v[156:159]
    s_memrealtime s[8:9]
    s_waitcnt lgkmcnt(0)
    s_sub_u32 s8, s8, s30
    s_cmpk_ge_u32 s8, 2268
    s_nop 3
    s_cbranch_scc1 .ap_47
    s_waitcnt vmcnt(5)
    s_cmpk_ge_u32 s8, 2168
    s_cbranch_scc1 .ap_47
    s_waitcnt vmcnt(3)
    s_bitcmp1_b64 s[14:15], 61
    s_cbranch_scc0 1
    s_waitcnt vmcnt(2)
    s_cmpk_ge_u32 s8, 2048
    s_cbranch_scc1 .ap_47
    s_waitcnt vmcnt(1)
.ap_47:
    s_add_u32 s63, s69, 434176
    buffer_load_dwordx4 v[76:79], v1, s[44:47], s63 offen nt
    s_waitcnt vmcnt(6)
    v_perm_b32 v112, v228, v224, s94
    v_perm_b32 v113, v236, v232, s94
    v_perm_b32 v114, v244, v240, s94
    v_perm_b32 v115, v252, v248, s94
    s_nop 1
    v_mfma_f32_16x16x32_bf16 v[128:131], v[104:107], v[112:115], v[128:131]
    v_perm_b32 v116, v228, v224, s95
    v_perm_b32 v117, v236, v232, s95
    v_perm_b32 v118, v244, v240, s95
    v_perm_b32 v119, v252, v248, s95
    s_nop 1
    v_mfma_f32_16x16x32_bf16 v[132:135], v[104:107], v[116:119], v[132:135]
    v_perm_b32 v120, v229, v225, s94
    v_perm_b32 v121, v237, v233, s94
    v_perm_b32 v122, v245, v241, s94
    v_perm_b32 v123, v253, v249, s94
    s_nop 1
    v_mfma_f32_16x16x32_bf16 v[136:139], v[104:107], v[120:123], v[136:139]
    v_perm_b32 v124, v229, v225, s95
    v_perm_b32 v125, v237, v233, s95
    v_perm_b32 v126, v245, v241, s95
    v_perm_b32 v127, v253, v249, s95
    s_nop 1
    v_mfma_f32_16x16x32_bf16 v[140:143], v[104:107], v[124:127], v[140:143]
    v_perm_b32 v112, v230, v226, s94
    v_perm_b32 v113, v238, v234, s94
    v_perm_b32 v114, v246, v242, s94
    v_perm_b32 v115, v254, v250, s94
    s_nop 1
    v_mfma_f32_16x16x32_bf16 v[144:147], v[104:107], v[112:115], v[144:147]
    v_perm_b32 v116, v230, v226, s95
    v_perm_b32 v117, v238, v234, s95
    v_perm_b32 v118, v246, v242, s95
    v_perm_b32 v119, v254, v250, s95
    s_nop 1
    v_mfma_f32_16x16x32_bf16 v[148:151], v[104:107], v[116:119], v[148:151]
    v_perm_b32 v120, v231, v227, s94
    v_perm_b32 v121, v239, v235, s94
    v_perm_b32 v122, v247, v243, s94
    v_perm_b32 v123, v255, v251, s94
    s_nop 1
    v_mfma_f32_16x16x32_bf16 v[152:155], v[104:107], v[120:123], v[152:155]
    v_perm_b32 v124, v231, v227, s95
    v_perm_b32 v125, v239, v235, s95
    v_perm_b32 v126, v247, v243, s95
    v_perm_b32 v127, v255, v251, s95
    s_nop 1
    v_mfma_f32_16x16x32_bf16 v[156:159], v[104:107], v[124:127], v[156:159]
    s_memrealtime s[8:9]
    s_waitcnt lgkmcnt(0)
    s_sub_u32 s8, s8, s30
    s_cmpk_ge_u32 s8, 2300
    s_nop 3
    s_cbranch_scc1 .ap_48
    s_waitcnt vmcnt(5)
    s_cmpk_ge_u32 s8, 2200
    s_cbranch_scc1 .ap_48
    s_waitcnt vmcnt(3)
    s_bitcmp1_b64 s[14:15], 62
    s_cbranch_scc0 1
    s_waitcnt vmcnt(2)
    s_cmpk_ge_u32 s8, 2080
    s_cbranch_scc1 .ap_48
    s_waitcnt vmcnt(1)
.ap_48:
    s_add_u32 s63, s69, 442368
    buffer_load_dwordx4 v[84:87], v1, s[44:47], s63 offen nt
    s_memrealtime s[8:9]
    s_waitcnt lgkmcnt(0)
    s_sub_u32 s8, s8, s30
    s_cmpk_ge_u32 s8, 2332
    s_cbranch_scc1 .ap_49
    s_waitcnt vmcnt(5)
    s_cmpk_ge_u32 s8, 2232
    s_cbranch_scc1 .ap_49
    s_waitcnt vmcnt(3)
    s_bitcmp1_b64 s[14:15], 63
    s_cbranch_scc0 1
    s_waitcnt vmcnt(2)
    s_cmpk_ge_u32 s8, 2112
    s_cbranch_scc1 .ap_49
    s_waitcnt vmcnt(1)
.ap_49:
    s_add_u32 s63, s69, 450560
    buffer_load_dwordx4 v[92:95], v1, s[44:47], s63 offen nt
    s_setprio 0
    s_waitcnt vmcnt(6)
    v_perm_b32 v160, v44, v36, s94
    v_perm_b32 v164, v44, v36, s95
    v_perm_b32 v168, v45, v37, s94
    v_perm_b32 v172, v45, v37, s95
    v_perm_b32 v176, v46, v38, s94
    v_perm_b32 v180, v46, v38, s95
    v_perm_b32 v184, v47, v39, s94
    v_perm_b32 v188, v47, v39, s95
    s_waitcnt vmcnt(4)
    v_perm_b32 v161, v60, v52, s94
    v_perm_b32 v165, v60, v52, s95
    v_perm_b32 v169, v61, v53, s94
    v_perm_b32 v173, v61, v53, s95
    v_perm_b32 v177, v62, v54, s94
    v_perm_b32 v181, v62, v54, s95
    v_perm_b32 v185, v63, v55, s94
    v_perm_b32 v189, v63, v55, s95
    s_branch .Lsk_n1_6
.Lst_n1_6:
    s_branch .Lrt_n1_6
.Lsk_n1_6:
    s_waitcnt vmcnt(2)
    v_perm_b32 v162, v76, v68, s94
    v_perm_b32 v166, v76, v68, s95
    v_perm_b32 v170, v77, v69, s94
    v_perm_b32 v174, v77, v69, s95
    v_perm_b32 v178, v78, v70, s94
    v_perm_b32 v182, v78, v70, s95
    v_perm_b32 v186, v79, v71, s94
    v_perm_b32 v190, v79, v71, s95
    s_waitcnt vmcnt(0)
    s_cmp_lt_u32 s65, 8
    s_cbranch_scc1 .wol_50
    s_lshl_b32 s56, s3, 10
    s_add_u32 m0, s56, 24576
    s_add_u32 s56, s101, 221184
    s_mov_b64 exec, s[18:19]
    buffer_load_dwordx4 v6, s[48:51], s56 offen nt lds
    s_mov_b64 exec, -1
    s_lshl_b32 s56, s3, 10
    s_add_u32 m0, s56, 57344
    s_add_u32 s56, s101, 221312
    s_mov_b64 exec, s[18:19]
    buffer_load_dwordx4 v6, s[48:51], s56 offen nt lds
    s_mov_b64 exec, -1
    s_lshl_b32 s56, s3, 10
    s_add_u32 m0, s56, 90112
    s_add_u32 s56, s101, 221440
    s_mov_b64 exec, s[18:19]
    buffer_load_dwordx4 v6, s[48:51], s56 offen nt lds
    s_mov_b64 exec, -1
.wol_50:
    v_perm_b32 v163, v92, v84, s94
    v_perm_b32 v167, v92, v84, s95
    v_perm_b32 v171, v93, v85, s94
    v_mfma_f32_16x16x32_bf16 v[128:131], v[108:111], v[160:163], v[128:131]
    v_perm_b32 v175, v93, v85, s95
    v_mfma_f32_16x16x32_bf16 v[132:135], v[108:111], v[164:167], v[132:135]
    v_perm_b32 v179, v94, v86, s94
    v_mfma_f32_16x16x32_bf16 v[136:139], v[108:111], v[168:171], v[136:139]
    v_perm_b32 v183, v94, v86, s95
    v_mfma_f32_16x16x32_bf16 v[140:143], v[108:111], v[172:175], v[140:143]
    v_perm_b32 v187, v95, v87, s94
    v_mfma_f32_16x16x32_bf16 v[144:147], v[108:111], v[176:179], v[144:147]
    v_perm_b32 v191, v95, v87, s95
    v_mfma_f32_16x16x32_bf16 v[148:151], v[108:111], v[180:183], v[148:151]
    v_mfma_f32_16x16x32_bf16 v[152:155], v[108:111], v[184:187], v[152:155]
    v_mfma_f32_16x16x32_bf16 v[156:159], v[108:111], v[188:191], v[156:159]
    s_mov_b64 exec, 0xffff
    ds_write2_b32 v10, v128, v129 offset0:0 offset1:128
    ds_write2_b32 v10, v132, v133 offset0:1 offset1:129
    ds_write2_b32 v10, v136, v137 offset0:2 offset1:130
    ds_write2_b32 v10, v140, v141 offset0:3 offset1:131
    ds_write2_b32 v10, v144, v145 offset0:4 offset1:132
    ds_write2_b32 v10, v148, v149 offset0:5 offset1:133
    ds_write2_b32 v10, v152, v153 offset0:6 offset1:134
    ds_write2_b32 v10, v156, v157 offset0:7 offset1:135
    s_mov_b64 exec, -1
    s_waitcnt lgkmcnt(0)
    s_barrier
    s_cmp_lg_u32 s3, 7
    s_cbranch_scc1 .opub_51
    v_add_u32 v10, 147456, v2
    ds_read_b128 v[196:199], v10 offset:0
    ds_read_b128 v[200:203], v10 offset:1024
    ds_read_b128 v[204:207], v10 offset:2048
    ds_read_b128 v[208:211], v10 offset:3072
    ds_read_b128 v[212:215], v10 offset:4096
    ds_read_b128 v[216:219], v10 offset:5120
    ds_read_b128 v[220:223], v10 offset:6144
    ds_read_b128 v[224:227], v10 offset:7168
    v_lshrrev_b32 v11, 5, v0
    v_lshlrev_b32 v11, 13, v11
    v_and_b32 v12, 31, v0
    v_lshl_add_u32 v11, v12, 4, v11
    s_lshl4_add_u32 s56, s67, s66
    s_lshl1_add_u32 s56, s56, s68
    s_lshl_b32 s56, s56, 9
    s_add_u32 s56, s56, 0xa0000
    s_mov_b32 s60, 0x07060503
    s_mov_b32 s61, 0x07060502
    s_mov_b32 s62, 0x07060501
    v_mov_b32 v15, s34
    s_waitcnt lgkmcnt(6)
    v_pk_add_f32 v[196:197], v[196:197], v[200:201]
    v_pk_add_f32 v[198:199], v[198:199], v[202:203]
    s_waitcnt lgkmcnt(5)
    v_pk_add_f32 v[196:197], v[196:197], v[204:205]
    v_pk_add_f32 v[198:199], v[198:199], v[206:207]
    s_waitcnt lgkmcnt(4)
    v_pk_add_f32 v[196:197], v[196:197], v[208:209]
    v_pk_add_f32 v[198:199], v[198:199], v[210:211]
    s_waitcnt lgkmcnt(3)
    v_pk_add_f32 v[196:197], v[196:197], v[212:213]
    v_pk_add_f32 v[198:199], v[198:199], v[214:215]
    s_waitcnt lgkmcnt(2)
    v_pk_add_f32 v[196:197], v[196:197], v[216:217]
    v_pk_add_f32 v[198:199], v[198:199], v[218:219]
    s_waitcnt lgkmcnt(1)
    v_pk_add_f32 v[196:197], v[196:197], v[220:221]
    v_pk_add_f32 v[198:199], v[198:199], v[222:223]
    s_waitcnt lgkmcnt(0)
    v_pk_add_f32 v[196:197], v[196:197], v[224:225]
    v_pk_add_f32 v[198:199], v[198:199], v[226:227]
    v_perm_b32 v12, v196, v199, s60
    v_perm_b32 v13, v197, v199, s61
    v_perm_b32 v14, v198, v199, s62
    s_add_u32 s57, s56, 0x800000
    buffer_store_dwordx4 v[12:15], v11, s[36:39], s57 offen
    buffer_store_dwordx4 v[12:15], v11, s[36:39], s56 offen sc1
.opub_51:
    s_cmp_lt_u32 s65, 8
    s_nop 0
    s_cbranch_scc1 .Lexit
    v_and_b32 v6, 31, v0
    v_lshlrev_b32 v6, 3, v6
    v_lshrrev_b32 v7, 5, v0
    v_lshl_add_u32 v6, v7, 2, v6
    s_mul_i32 s56, s3, 528
    s_add_u32 s56, s56, 131072
    v_add_u32 v6, s56, v6
    s_lshl4_add_u32 s101, s99, s3
    s_lshl_b32 s101, s101, 10
    s_add_u32 s101, s101, 0xa0000
    v_add_u32 v5, 8192, v2
    s_cmp_ge_u32 s3, 6
    s_nop 0
    s_cbranch_scc1 .La_w67
    v_lshrrev_b32 v16, 4, v0
    v_bfe_u32 v17, v0, 2, 2
    v_lshl_add_u32 v7, v16, 3, v17
    v_lshlrev_b32 v7, 7, v7
    v_and_b32 v16, 1, v16
    v_lshrrev_b32 v17, 1, v17
    v_lshl_add_u32 v16, v16, 1, v17
    s_and_b32 s56, s3, 1
    s_lshl_b32 s56, s56, 1
    v_xor_b32 v16, s56, v16
    v_and_b32 v17, 3, v0
    v_lshl_add_u32 v7, v17, 3, v7
    s_lshr_b32 s56, s3, 1
    s_lshl_b32 s56, s56, 15
    v_add_u32 v7, s56, v7
    v_xor_b32 v17, 1, v16
    v_lshl_add_u32 v8, v17, 5, v7
    v_lshl_add_u32 v7, v16, 5, v7
    ds_read_b64_tr_b16 v[32:33], v7 offset:0
    ds_read_b64_tr_b16 v[34:35], v7 offset:512
    ds_read_b64_tr_b16 v[64:65], v8 offset:0
    ds_read_b64_tr_b16 v[66:67], v8 offset:512
    ds_read_b64_tr_b16 v[36:37], v7 offset:4096
    ds_read_b64_tr_b16 v[38:39], v7 offset:4608
    ds_read_b64_tr_b16 v[68:69], v8 offset:4096
    ds_read_b64_tr_b16 v[70:71], v8 offset:4608
    ds_read_b64_tr_b16 v[40:41], v7 offset:8192
    ds_read_b64_tr_b16 v[42:43], v7 offset:8704
    ds_read_b64_tr_b16 v[72:73], v8 offset:8192
    ds_read_b64_tr_b16 v[74:75], v8 offset:8704
    ds_read_b64_tr_b16 v[44:45], v7 offset:12288
    ds_read_b64_tr_b16 v[46:47], v7 offset:12800
    ds_read_b64_tr_b16 v[76:77], v8 offset:12288
    ds_read_b64_tr_b16 v[78:79], v8 offset:12800
    ds_read_b64_tr_b16 v[48:49], v7 offset:16384
    s_branch .Lsk_n1_7
.Lst_n1_7:
    s_branch .Lrt_n1_7
.Lsk_n1_7:
    ds_read_b64_tr_b16 v[50:51], v7 offset:16896
    ds_read_b64_tr_b16 v[80:81], v8 offset:16384
    ds_read_b64_tr_b16 v[82:83], v8 offset:16896
    ds_read_b64_tr_b16 v[52:53], v7 offset:20480
    ds_read_b64_tr_b16 v[54:55], v7 offset:20992
    ds_read_b64_tr_b16 v[84:85], v8 offset:20480
    ds_read_b64_tr_b16 v[86:87], v8 offset:20992
    s_mov_b32 s56, 131072
    v_bfe_u32 v9, v0, 1, 3
    v_mul_u32_u24 v9, 528, v9
    v_and_b32 v16, 48, v0
    v_add3_u32 v9, v9, v16, s56
    v_bfe_u32 v10, v0, 1, 3
    v_mul_u32_u24 v10, 36864, v10
    v_and_b32 v16, 1, v0
    v_lshl_add_u32 v10, v16, 4, v10
    v_and_b32 v16, 48, v0
    v_lshl_add_u32 v10, v16, 1, v10
    s_mul_i32 s59, s100, 3
    s_lshr_b32 s56, s3, 1
    s_add_u32 s59, s59, s56
    s_lshl4_add_u32 s59, s59, s99
    s_and_b32 s56, s3, 1
    s_lshl1_add_u32 s59, s59, s56
    s_lshl_b32 s59, s59, 7
    s_add_u32 s59, s59, 0xe0000
    v_mov_b32 v139, s34
    s_waitcnt vmcnt(0)
    s_barrier
    ds_read_b64_tr_b16 v[56:57], v7 offset:24576
    ds_read_b64_tr_b16 v[58:59], v7 offset:25088
    ds_read_b64_tr_b16 v[88:89], v8 offset:24576
    ds_read_b64_tr_b16 v[90:91], v8 offset:25088
    ds_read_b64_tr_b16 v[60:61], v7 offset:28672
    ds_read_b64_tr_b16 v[62:63], v7 offset:29184
    ds_read_b64_tr_b16 v[92:93], v8 offset:28672
    ds_read_b64_tr_b16 v[94:95], v8 offset:29184
    s_branch .La_poll
.La_w67:
    s_cmp_eq_u32 s3, 7
    s_cbranch_scc0 2
    s_waitcnt vmcnt(2)
    s_branch 1
    s_waitcnt vmcnt(0)
    s_barrier
.La_poll:
    s_mov_b32 s60, 0x04000c0c
    s_mov_b32 s61, 0x0706000c
    s_mov_b32 s69, 0
.gp_52:
    s_add_u32 s69, s69, 1
    s_and_b32 s56, s69, 0x41
    s_cmp_lg_u32 s56, 0x41
    s_cselect_b32 s56, s0, 0
    s_add_u32 s58, s101, s56
    buffer_load_dwordx4 v[16:19], v2, s[36:39], s58 offen offset:0 sc1
    buffer_load_dwordx4 v[20:23], v5, s[36:39], s58 offen offset:0 sc1
    s_waitcnt vmcnt(0)
    v_cmp_eq_u32 vcc, s34, v19
    v_cmp_eq_u32 s[56:57], s34, v23
    s_and_b64 vcc, vcc, s[56:57]
    s_cmp_eq_u64 vcc, -1
    s_nop 2
    s_cbranch_scc1 .gpd_53
    s_sub_u32 s35, s35, 1
    s_cbranch_scc1 .Lexit
    s_branch .gp_52
.gpd_53:
    v_perm_b32 v19, v16, v17, s60
    v_perm_b32 v19, v19, v18, s61
    v_perm_b32 v23, v20, v21, s60
    v_perm_b32 v23, v23, v22, s61
    v_permlane32_swap_b32 v16, v18
    v_permlane32_swap_b32 v17, v19
    v_permlane32_swap_b32 v20, v22
    v_permlane32_swap_b32 v21, v23
    v_pk_add_f32 v[16:17], v[16:17], v[18:19]
    v_pk_add_f32 v[20:21], v[20:21], v[22:23]
    v_cvt_pk_bf16_f32 v16, v16, v17
    v_cvt_pk_bf16_f32 v20, v20, v21
    ds_write2_b32 v6, v16, v20 offset1:64
    s_mov_b32 s60, 0x07060503
    s_mov_b32 s61, 0x07060502
    s_mov_b32 s62, 0x07060501
    s_mov_b32 vcc_lo, 0xaaaaaaaa
    s_mov_b32 vcc_hi, 0xaaaaaaaa
    s_waitcnt lgkmcnt(0)
    s_barrier
    s_cmp_ge_u32 s3, 6
    s_cbranch_scc1 .Lexit
    ds_read_b128 v[96:99], v9 offset:0
    ds_read_b128 v[100:103], v9 offset:64
    ds_read_b128 v[104:107], v9 offset:128
    ds_read_b128 v[108:111], v9 offset:192
    ds_read_b128 v[112:115], v9 offset:256
    ds_read_b128 v[116:119], v9 offset:320
    ds_read_b128 v[120:123], v9 offset:384
    ds_read_b128 v[124:127], v9 offset:448
    s_waitcnt lgkmcnt(7)
    v_mfma_f32_16x16x32_bf16 v[128:131], v[32:35], v[96:99], 0
    v_mfma_f32_16x16x32_bf16 v[132:135], v[64:67], v[96:99], 0
    s_waitcnt lgkmcnt(6)
    v_mfma_f32_16x16x32_bf16 v[128:131], v[36:39], v[100:103], v[128:131]
    v_mfma_f32_16x16x32_bf16 v[132:135], v[68:71], v[100:103], v[132:135]
    s_waitcnt lgkmcnt(5)
    v_mfma_f32_16x16x32_bf16 v[128:131], v[40:43], v[104:107], v[128:131]
    v_mfma_f32_16x16x32_bf16 v[132:135], v[72:75], v[104:107], v[132:135]
    s_waitcnt lgkmcnt(4)
    v_mfma_f32_16x16x32_bf16 v[128:131], v[44:47], v[108:111], v[128:131]
    v_mfma_f32_16x16x32_bf16 v[132:135], v[76:79], v[108:111], v[132:135]
    s_waitcnt lgkmcnt(3)
    v_mfma_f32_16x16x32_bf16 v[128:131], v[48:51], v[112:115], v[128:131]
    v_mfma_f32_16x16x32_bf16 v[132:135], v[80:83], v[112:115], v[132:135]
    s_waitcnt lgkmcnt(2)
    v_mfma_f32_16x16x32_bf16 v[128:131], v[52:55], v[116:119], v[128:131]
    v_mfma_f32_16x16x32_bf16 v[132:135], v[84:87], v[116:119], v[132:135]
    s_waitcnt lgkmcnt(1)
    v_mfma_f32_16x16x32_bf16 v[128:131], v[56:59], v[120:123], v[128:131]
    v_mfma_f32_16x16x32_bf16 v[132:135], v[88:91], v[120:123], v[132:135]
    s_waitcnt lgkmcnt(0)
    v_mfma_f32_16x16x32_bf16 v[128:131], v[60:63], v[124:127], v[128:131]
    v_mfma_f32_16x16x32_bf16 v[132:135], v[92:95], v[124:127], v[132:135]
    s_nop 7
    v_cndmask_b32 v128, v128, v132, vcc
    v_cndmask_b32 v129, v129, v133, vcc
    v_cndmask_b32 v130, v130, v134, vcc
    v_cndmask_b32 v131, v131, v135, vcc
    v_perm_b32 v136, v128, v131, s60
    v_perm_b32 v137, v129, v131, s61
    v_perm_b32 v138, v130, v131, s62
    buffer_store_dwordx4 v[136:139], v10, s[36:39], s59 offen sc1
    s_nop 1
    s_branch .Lexit
.Lm:
    s_branch .Lsk_m0_0
.Lst_m0_0:
    s_branch .Lrt_m0_0
.Lsk_m0_0:
    s_cmp_lt_u32 s2, 54
    s_mov_b32 s14, 0xfdff7fdf
    s_cselect_b32 s14, 0x6b5ad6b5, s14
    s_mov_b32 s15, 0xff7fdff7
    s_cselect_b32 s15, 0x5ad6b5ad, s15
    s_add_u32 s30, s70, 0
    s_mov_b32 s31, s70
    v_bfe_u32 v16, v0, 1, 3
    v_mul_u32_u24 v16, 1312, v16
    v_lshrrev_b32 v12, 4, v0
    v_lshl_add_u32 v16, v12, 5, v16
    v_and_b32 v12, 1, v0
    v_lshl_add_u32 v16, v12, 4, v16
    v_add_u32 v16, 147456, v16
    s_mul_i32 s56, s3, 1312
    s_add_u32 s56, s56, 147456
    v_add_u32 v17, s56, v3
    v_add_u32 v18, s56, v4
    v_lshrrev_b32 v12, 4, v0
    v_bfe_u32 v13, v0, 1, 1
    v_lshl_add_u32 v12, v12, 1, v13
    v_bfe_u32 v13, v0, 2, 2
    v_lshl_add_u32 v20, v12, 3, v13
    v_lshlrev_b32 v20, 7, v20
    v_and_b32 v12, 3, v12
    v_lshrrev_b32 v13, 1, v13
    v_lshl_add_u32 v12, v12, 1, v13
    v_xor_b32 v12, s3, v12
    v_lshl_add_u32 v20, v12, 4, v20
    v_and_b32 v12, 1, v0
    v_lshl_add_u32 v20, v12, 3, v20
    v_bfe_u32 v23, v0, 1, 3
    v_mul_u32_u24 v23, 144, v23
    v_bfe_u32 v12, v0, 4, 1
    v_lshl_add_u32 v23, v12, 3, v23
    v_lshrrev_b32 v12, 5, v0
    v_lshl_add_u32 v23, v12, 2, v23
    v_and_b32 v12, 1, v0
    v_lshl_add_u32 v23, v12, 1, v23
    s_lshl_b32 s56, s3, 4
    s_add_u32 s56, s56, 157952
    v_add_u32 v23, s56, v23
    v_and_b32 v24, 15, v0
    v_lshlrev_b32 v24, 3, v24
    s_mul_i32 s56, s3, 144
    s_add_u32 s56, s56, 157952
    v_add_u32 v24, s56, v24
    v_add_u32 v21, 32768, v20
    s_lshl_b32 s100, s3, 10
    s_mov_b32 s99, s2
    s_cmp_ge_u32 s99, 18
    s_cbranch_scc1 .Lm_rel
    s_mul_i32 s58, s3, 1152
    s_mov_b32 s52, s24
    s_and_b32 s53, s25, 0xffff
    s_mov_b32 s54, 0x2400
    s_mov_b32 s55, 0x00020000
    buffer_load_dwordx2 v[246:247], v3, s[52:55], s58 offen
    buffer_load_dwordx2 v[248:249], v3, s[52:55], s58 offen offset:512
    buffer_load_dword v250, v4, s[52:55], s58 offen
    s_mov_b32 s48, s26
    s_and_b32 s49, s27, 0xffff
    s_mov_b32 s50, 0x3cc000
    s_mov_b32 s51, 0x00020000
    v_bfe_u32 v12, v0, 4, 1
    s_and_b32 s56, s3, 3
    s_lshl_b32 s56, s56, 1
    v_or_b32 v12, s56, v12
    v_and_b32 v19, 7, v0
    v_xor_b32 v12, v12, v19
    v_lshrrev_b32 v19, 3, v0
    v_mul_u32_u24 v19, 6912, v19
    v_lshl_add_u32 v19, v12, 4, v19
    s_mul_i32 s57, s3, 55296
    s_lshl_b32 s59, s99, 7
    s_add_u32 s57, s57, s59
    s_add_u32 m0, s100, 0
    s_add_u32 s56, s57, 0
    buffer_load_dwordx4 v19, s[48:51], s56 offen nt lds
    s_add_u32 m0, s100, 8192
    s_add_u32 s56, s57, 442368
    buffer_load_dwordx4 v19, s[48:51], s56 offen nt lds
    s_add_u32 m0, s100, 16384
    s_add_u32 s56, s57, 884736
    buffer_load_dwordx4 v19, s[48:51], s56 offen nt lds
    s_add_u32 m0, s100, 24576
    s_add_u32 s56, s57, 1327104
    buffer_load_dwordx4 v19, s[48:51], s56 offen nt lds
    s_add_u32 m0, s100, 32768
    s_add_u32 s56, s57, 1769472
    buffer_load_dwordx4 v19, s[48:51], s56 offen nt lds
    s_add_u32 m0, s100, 40960
    s_add_u32 s56, s57, 2211840
    buffer_load_dwordx4 v19, s[48:51], s56 offen nt lds
    s_add_u32 m0, s100, 49152
    s_add_u32 s56, s57, 2654208
    buffer_load_dwordx4 v19, s[48:51], s56 offen nt lds
    s_add_u32 m0, s100, 57344
    s_add_u32 s56, s57, 3096576
    buffer_load_dwordx4 v19, s[48:51], s56 offen nt lds
    s_add_u32 m0, s100, 65536
    s_add_u32 s56, s57, 3538944
    buffer_load_dwordx4 v19, s[48:51], s56 offen nt lds
    s_waitcnt lgkmcnt(0)
    s_add_u32 s34, s34, 1
    s_getreg_b32 s1, hwreg(HW_REG_XCC_ID)
    s_lshl_b32 s1, s1, 24
    s_add_u32 s1, s1, s34
    s_lshr_b32 s0, s2, 3
    s_lshl_b32 s63, s64, 8
    s_add_u32 s0, s0, s63
    s_lshl2_add_u32 s0, s0, 0x480000
    v_mov_b32 v30, s1
    s_cmp_eq_u32 s3, 0
    s_cselect_b64 exec, 1, 0
    buffer_store_dword v30, v2, s[36:39], s0 offen sc1
    s_mov_b64 exec, -1
    v_lshrrev_b32 v12, 4, v0
    v_mul_u32_u24 v12, 18432, v12
    v_and_b32 v13, 15, v0
    v_lshl_add_u32 v22, v13, 4, v12
    s_mul_i32 s57, s99, 57
    s_lshr_b32 s57, s57, 9
    s_mul_i32 s58, s57, 9
    s_sub_u32 s58, s99, s58
    s_mul_i32 s59, s57, 73728
    s_lshl_b32 s58, s58, 8
    s_add_u32 s59, s59, s58
    s_mul_i32 s58, s3, 2304
    s_add_u32 s59, s59, s58
    s_add_u32 s59, s59, 0x1000
    s_mov_b32 s58, 0
    s_cmp_eq_u32 s57, 1
    s_cselect_b32 s58, 1.0, s58
    s_cmp_eq_u32 s57, 4
    s_cselect_b32 s58, 1.0, s58
    s_waitcnt vmcnt(10)
    v_lshlrev_b32 v236, 16, v246
    v_and_b32 v237, 0xffff0000, v246
    v_max_f32 v236, 0xc2ae0000, v236
    v_min_f32 v242, 0x43000000, v236
    v_mul_f32 v238, 0xbfb8aa3b, v242
    v_fma_f32 v240, v242, s98, -v238
    v_fmac_f32 v240, 0xb2a57060, v242
    v_exp_f32 v238, v238
    v_mul_f32 v240, 0x3f317218, v240
    v_fmac_f32 v238, v238, v240
    v_add_f32 v238, 1.0, v238
    v_rcp_f32 v240, v238
    s_nop 0
    v_mul_f32 v242, v236, v240
    v_fma_f32 v238, -v242, v238, v236
    v_fma_f32 v236, v238, v240, v242
    v_max_f32 v237, 0xc2ae0000, v237
    v_min_f32 v243, 0x43000000, v237
    v_mul_f32 v239, 0xbfb8aa3b, v243
    v_fma_f32 v241, v243, s98, -v239
    v_fmac_f32 v241, 0xb2a57060, v243
    v_exp_f32 v239, v239
    v_mul_f32 v241, 0x3f317218, v241
    v_fmac_f32 v239, v239, v241
    v_add_f32 v239, 1.0, v239
    v_rcp_f32 v241, v239
    s_nop 0
    v_mul_f32 v243, v237, v241
    v_fma_f32 v239, -v243, v239, v237
    v_fma_f32 v237, v239, v241, v243
    s_branch .Lsk_m0_1
.Lst_m0_1:
    s_branch .Lrt_m0_1
.Lsk_m0_1:
    v_cvt_pk_bf16_f32 v246, v236, v237
    v_lshlrev_b32 v236, 16, v247
    v_and_b32 v237, 0xffff0000, v247
    v_max_f32 v236, 0xc2ae0000, v236
    v_min_f32 v242, 0x43000000, v236
    v_mul_f32 v238, 0xbfb8aa3b, v242
    v_fma_f32 v240, v242, s98, -v238
    v_fmac_f32 v240, 0xb2a57060, v242
    v_exp_f32 v238, v238
    v_mul_f32 v240, 0x3f317218, v240
    v_fmac_f32 v238, v238, v240
    v_add_f32 v238, 1.0, v238
    v_rcp_f32 v240, v238
    s_nop 0
    v_mul_f32 v242, v236, v240
    v_fma_f32 v238, -v242, v238, v236
    v_fma_f32 v236, v238, v240, v242
    v_max_f32 v237, 0xc2ae0000, v237
    v_min_f32 v243, 0x43000000, v237
    v_mul_f32 v239, 0xbfb8aa3b, v243
    v_fma_f32 v241, v243, s98, -v239
    v_fmac_f32 v241, 0xb2a57060, v243
    v_exp_f32 v239, v239
    v_mul_f32 v241, 0x3f317218, v241
    v_fmac_f32 v239, v239, v241
    v_add_f32 v239, 1.0, v239
    v_rcp_f32 v241, v239
    s_nop 0
    v_mul_f32 v243, v237, v241
    v_fma_f32 v239, -v243, v239, v237
    v_fma_f32 v237, v239, v241, v243
    v_cvt_pk_bf16_f32 v247, v236, v237
    v_lshlrev_b32 v236, 16, v248
    v_and_b32 v237, 0xffff0000, v248
    v_max_f32 v236, 0xc2ae0000, v236
    v_min_f32 v242, 0x43000000, v236
    v_mul_f32 v238, 0xbfb8aa3b, v242
    v_fma_f32 v240, v242, s98, -v238
    v_fmac_f32 v240, 0xb2a57060, v242
    v_exp_f32 v238, v238
    v_mul_f32 v240, 0x3f317218, v240
    v_fmac_f32 v238, v238, v240
    v_add_f32 v238, 1.0, v238
    v_rcp_f32 v240, v238
    s_nop 0
    v_mul_f32 v242, v236, v240
    v_fma_f32 v238, -v242, v238, v236
    v_fma_f32 v236, v238, v240, v242
    v_max_f32 v237, 0xc2ae0000, v237
    v_min_f32 v243, 0x43000000, v237
    v_mul_f32 v239, 0xbfb8aa3b, v243
    v_fma_f32 v241, v243, s98, -v239
    v_fmac_f32 v241, 0xb2a57060, v243
    v_exp_f32 v239, v239
    v_mul_f32 v241, 0x3f317218, v241
    v_fmac_f32 v239, v239, v241
    v_add_f32 v239, 1.0, v239
    v_rcp_f32 v241, v239
    s_nop 0
    v_mul_f32 v243, v237, v241
    v_fma_f32 v239, -v243, v239, v237
    v_fma_f32 v237, v239, v241, v243
    v_cvt_pk_bf16_f32 v248, v236, v237
    v_lshlrev_b32 v236, 16, v249
    v_and_b32 v237, 0xffff0000, v249
    v_max_f32 v236, 0xc2ae0000, v236
    v_min_f32 v242, 0x43000000, v236
    v_mul_f32 v238, 0xbfb8aa3b, v242
    v_fma_f32 v240, v242, s98, -v238
    v_fmac_f32 v240, 0xb2a57060, v242
    v_exp_f32 v238, v238
    v_mul_f32 v240, 0x3f317218, v240
    v_fmac_f32 v238, v238, v240
    v_add_f32 v238, 1.0, v238
    v_rcp_f32 v240, v238
    s_nop 0
    v_mul_f32 v242, v236, v240
    v_fma_f32 v238, -v242, v238, v236
    v_fma_f32 v236, v238, v240, v242
    v_max_f32 v237, 0xc2ae0000, v237
    v_min_f32 v243, 0x43000000, v237
    v_mul_f32 v239, 0xbfb8aa3b, v243
    v_fma_f32 v241, v243, s98, -v239
    v_fmac_f32 v241, 0xb2a57060, v243
    v_exp_f32 v239, v239
    v_mul_f32 v241, 0x3f317218, v241
    v_fmac_f32 v239, v239, v241
    v_add_f32 v239, 1.0, v239
    v_rcp_f32 v241, v239
    s_nop 0
    v_mul_f32 v243, v237, v241
    v_fma_f32 v239, -v243, v239, v237
    v_fma_f32 v237, v239, v241, v243
    v_cvt_pk_bf16_f32 v249, v236, v237
    v_lshlrev_b32 v236, 16, v250
    v_and_b32 v237, 0xffff0000, v250
    v_max_f32 v236, 0xc2ae0000, v236
    v_min_f32 v242, 0x43000000, v236
    v_mul_f32 v238, 0xbfb8aa3b, v242
    v_fma_f32 v240, v242, s98, -v238
    v_fmac_f32 v240, 0xb2a57060, v242
    v_exp_f32 v238, v238
    v_mul_f32 v240, 0x3f317218, v240
    v_fmac_f32 v238, v238, v240
    v_add_f32 v238, 1.0, v238
    v_rcp_f32 v240, v238
    s_nop 0
    v_mul_f32 v242, v236, v240
    v_fma_f32 v238, -v242, v238, v236
    v_fma_f32 v236, v238, v240, v242
    v_max_f32 v237, 0xc2ae0000, v237
    v_min_f32 v243, 0x43000000, v237
    v_mul_f32 v239, 0xbfb8aa3b, v243
    v_fma_f32 v241, v243, s98, -v239
    v_fmac_f32 v241, 0xb2a57060, v243
    v_exp_f32 v239, v239
    v_mul_f32 v241, 0x3f317218, v241
    v_fmac_f32 v239, v239, v241
    v_add_f32 v239, 1.0, v239
    v_rcp_f32 v241, v239
    s_nop 0
    v_mul_f32 v243, v237, v241
    v_fma_f32 v239, -v243, v239, v237
    v_fma_f32 v237, v239, v241, v243
    v_cvt_pk_bf16_f32 v250, v236, v237
    ds_write_b64 v17, v[246:247] offset:0
    ds_write_b64 v17, v[248:249] offset:512
    ds_write_b32 v18, v250 offset:0
    s_waitcnt vmcnt(1)
    s_waitcnt lgkmcnt(0)
    s_barrier
    ds_read_b64_tr_b16 v[160:161], v20 offset:0
    ds_read_b64_tr_b16 v[162:163], v20 offset:512
    ds_read_b64_tr_b16 v[164:165], v20 offset:8192
    ds_read_b64_tr_b16 v[166:167], v20 offset:8704
    ds_read_b64_tr_b16 v[168:169], v20 offset:16384
    ds_read_b64_tr_b16 v[170:171], v20 offset:16896
    ds_read_b64_tr_b16 v[172:173], v20 offset:24576
    ds_read_b64_tr_b16 v[174:175], v20 offset:25088
    ds_read_b64_tr_b16 v[176:177], v21 offset:0
    ds_read_b64_tr_b16 v[178:179], v21 offset:512
    ds_read_b64_tr_b16 v[180:181], v21 offset:8192
    ds_read_b64_tr_b16 v[182:183], v21 offset:8704
    ds_read_b64_tr_b16 v[184:185], v21 offset:16384
    ds_read_b64_tr_b16 v[186:187], v21 offset:16896
    ds_read_b64_tr_b16 v[188:189], v21 offset:24576
    ds_read_b64_tr_b16 v[190:191], v21 offset:25088
    ds_read_b64_tr_b16 v[192:193], v21 offset:32768
    ds_read_b64_tr_b16 v[194:195], v21 offset:33280
    ds_read_b128 v[196:199], v16 offset:0
    ds_read_b128 v[200:203], v16 offset:128
    ds_read_b128 v[204:207], v16 offset:256
    ds_read_b128 v[208:211], v16 offset:384
    ds_read_b128 v[212:215], v16 offset:512
    ds_read_b128 v[216:219], v16 offset:640
    ds_read_b128 v[220:223], v16 offset:768
    ds_read_b128 v[224:227], v16 offset:896
    ds_read_b128 v[228:231], v16 offset:1024
    s_waitcnt lgkmcnt(8)
    v_mfma_f32_16x16x32_bf16 v[232:235], v[160:163], v[196:199], 0
    s_waitcnt lgkmcnt(7)
    v_mfma_f32_16x16x32_bf16 v[232:235], v[164:167], v[200:203], v[232:235]
    s_waitcnt lgkmcnt(6)
    v_mfma_f32_16x16x32_bf16 v[232:235], v[168:171], v[204:207], v[232:235]
    s_branch .Lsk_m0_2
.Lst_m0_2:
    s_branch .Lrt_m0_2
.Lsk_m0_2:
    s_waitcnt lgkmcnt(5)
    v_mfma_f32_16x16x32_bf16 v[232:235], v[172:175], v[208:211], v[232:235]
    s_waitcnt lgkmcnt(4)
    v_mfma_f32_16x16x32_bf16 v[232:235], v[176:179], v[212:215], v[232:235]
    s_waitcnt lgkmcnt(3)
    v_mfma_f32_16x16x32_bf16 v[232:235], v[180:183], v[216:219], v[232:235]
    s_waitcnt lgkmcnt(2)
    v_mfma_f32_16x16x32_bf16 v[232:235], v[184:187], v[220:223], v[232:235]
    s_waitcnt lgkmcnt(1)
    v_mfma_f32_16x16x32_bf16 v[232:235], v[188:191], v[224:227], v[232:235]
    s_branch .Lsk_m0_3
.Lst_m0_3:
    s_branch .Lrt_m0_3
.Lsk_m0_3:
    s_waitcnt lgkmcnt(0)
    v_mfma_f32_16x16x32_bf16 v[232:235], v[192:195], v[228:231], v[232:235]
    s_nop 7
    v_permlane32_swap_b32 v232, v234
    v_permlane32_swap_b32 v233, v235
    v_cndmask_b32 v233, v233, v234, s[96:97]
    v_cndmask_b32 v232, v232, v235, s[96:97]
    s_nop 1
    v_add_f32_dpp v236, v233, v232 quad_perm:[1,0,3,2] row_mask:0xf bank_mask:0xf
    v_cvt_pk_bf16_f32 v236, v236, v236
    v_lshlrev_b32 v236, 16, v236
    v_add_f32 v236, s58, v236
    v_cvt_pk_bf16_f32 v236, v236, v236
    ds_write_b16 v23, v236
    v_mov_b32 v243, s34
    s_waitcnt lgkmcnt(0)
    s_barrier
    ds_read2_b32 v[244:245], v24 offset1:1
    v_mov_b32 v241, s34
    s_waitcnt lgkmcnt(0)
    v_mov_b32 v240, v244
    v_mov_b32 v242, v245
    s_bfm_b64 exec, 32, 0
    buffer_store_dwordx4 v[240:243], v22, s[36:39], s59 offen sc1
    s_mov_b64 exec, -1
    s_add_u32 s63, s69, 32768
    buffer_load_dwordx4 v[96:99], v1, s[40:43], s63 offen nt
    s_add_u32 s63, s69, 40960
    buffer_load_dwordx4 v[100:103], v1, s[40:43], s63 offen nt
    s_add_u32 s63, s69, 49152
    buffer_load_dwordx4 v[128:131], v1, s[40:43], s63 offen nt
    s_add_u32 s63, s69, 57344
    buffer_load_dwordx4 v[132:135], v1, s[40:43], s63 offen nt
    s_waitcnt vmcnt(3)
    s_add_u32 s63, s69, 131072
    buffer_load_dwordx4 v[40:43], v1, s[40:43], s63 offen nt
    s_waitcnt vmcnt(3)
    s_add_u32 s63, s69, 139264
    buffer_load_dwordx4 v[44:47], v1, s[40:43], s63 offen nt
    s_waitcnt vmcnt(3)
    s_add_u32 s63, s69, 147456
    buffer_load_dwordx4 v[72:75], v1, s[40:43], s63 offen nt
    s_waitcnt vmcnt(3)
    s_add_u32 s63, s69, 155648
    buffer_load_dwordx4 v[76:79], v1, s[40:43], s63 offen nt
    s_waitcnt vmcnt(3)
    s_add_u32 s63, s69, 163840
    buffer_load_dwordx4 v[104:107], v1, s[40:43], s63 offen nt
    s_waitcnt vmcnt(3)
    s_add_u32 s63, s69, 172032
    buffer_load_dwordx4 v[108:111], v1, s[40:43], s63 offen nt
    s_waitcnt vmcnt(3)
    s_add_u32 s63, s69, 180224
    buffer_load_dwordx4 v[136:139], v1, s[40:43], s63 offen nt
    s_waitcnt vmcnt(3)
    s_add_u32 s63, s69, 188416
    buffer_load_dwordx4 v[140:143], v1, s[40:43], s63 offen nt
    s_waitcnt vmcnt(3)
    s_add_u32 s63, s69, 262144
    buffer_load_dwordx4 v[48:51], v1, s[40:43], s63 offen nt
    s_waitcnt vmcnt(3)
    s_add_u32 s63, s69, 270336
    buffer_load_dwordx4 v[52:55], v1, s[40:43], s63 offen nt
    s_branch .Le_done
.Lm_rel:
    s_waitcnt vmcnt(4)
    s_bitcmp1_b64 s[14:15], 4
    s_cbranch_scc0 1
    s_waitcnt vmcnt(3)
    s_add_u32 s63, s69, 32768
    buffer_load_dwordx4 v[96:99], v1, s[40:43], s63 offen nt
    s_waitcnt vmcnt(4)
    s_bitcmp1_b64 s[14:15], 5
    s_cbranch_scc0 1
    s_waitcnt vmcnt(3)
    s_add_u32 s63, s69, 40960
    buffer_load_dwordx4 v[100:103], v1, s[40:43], s63 offen nt
    s_waitcnt vmcnt(4)
    s_bitcmp1_b64 s[14:15], 6
    s_cbranch_scc0 1
    s_waitcnt vmcnt(3)
    s_add_u32 s63, s69, 49152
    buffer_load_dwordx4 v[128:131], v1, s[40:43], s63 offen nt
    s_waitcnt vmcnt(4)
    s_bitcmp1_b64 s[14:15], 7
    s_cbranch_scc0 1
    s_waitcnt vmcnt(2)
    s_add_u32 s63, s69, 57344
    buffer_load_dwordx4 v[132:135], v1, s[40:43], s63 offen nt
    s_waitcnt vmcnt(3)
    s_bitcmp1_b64 s[14:15], 8
    s_cbranch_scc0 1
    s_waitcnt vmcnt(2)
    s_add_u32 s63, s69, 131072
    buffer_load_dwordx4 v[40:43], v1, s[40:43], s63 offen nt
    s_waitcnt vmcnt(3)
    s_bitcmp1_b64 s[14:15], 9
    s_cbranch_scc0 1
    s_waitcnt vmcnt(2)
    s_add_u32 s63, s69, 139264
    buffer_load_dwordx4 v[44:47], v1, s[40:43], s63 offen nt
    s_waitcnt lgkmcnt(0)
    s_add_u32 s34, s34, 1
    s_getreg_b32 s1, hwreg(HW_REG_XCC_ID)
    s_lshl_b32 s1, s1, 24
    s_add_u32 s1, s1, s34
    s_lshr_b32 s0, s2, 3
    s_lshl_b32 s63, s64, 8
    s_add_u32 s0, s0, s63
    s_lshl2_add_u32 s0, s0, 0x480000
    v_mov_b32 v30, s1
    s_cmp_eq_u32 s3, 0
    s_cselect_b64 exec, 1, 0
    buffer_store_dword v30, v2, s[36:39], s0 offen sc1
    s_mov_b64 exec, -1
    s_cmp_lt_u32 s99, 54
    s_cbranch_scc1 .Lmr_part
    s_waitcnt vmcnt(4)
    s_bitcmp1_b64 s[14:15], 10
    s_cbranch_scc0 1
    s_waitcnt vmcnt(3)
    s_add_u32 s63, s69, 147456
    buffer_load_dwordx4 v[72:75], v1, s[40:43], s63 offen nt
    s_waitcnt vmcnt(4)
    s_bitcmp1_b64 s[14:15], 11
    s_cbranch_scc0 1
    s_waitcnt vmcnt(3)
    s_add_u32 s63, s69, 155648
    buffer_load_dwordx4 v[76:79], v1, s[40:43], s63 offen nt
    s_waitcnt vmcnt(4)
    s_bitcmp1_b64 s[14:15], 12
    s_cbranch_scc0 1
    s_waitcnt vmcnt(3)
    s_add_u32 s63, s69, 163840
    buffer_load_dwordx4 v[104:107], v1, s[40:43], s63 offen nt
    s_waitcnt vmcnt(4)
    s_bitcmp1_b64 s[14:15], 13
    s_cbranch_scc0 1
    s_waitcnt vmcnt(2)
    s_add_u32 s63, s69, 172032
    buffer_load_dwordx4 v[108:111], v1, s[40:43], s63 offen nt
    s_waitcnt vmcnt(3)
    s_bitcmp1_b64 s[14:15], 14
    s_cbranch_scc0 1
    s_waitcnt vmcnt(2)
    s_add_u32 s63, s69, 180224
    buffer_load_dwordx4 v[136:139], v1, s[40:43], s63 offen nt
    s_waitcnt vmcnt(3)
    s_bitcmp1_b64 s[14:15], 15
    s_cbranch_scc0 1
    s_waitcnt vmcnt(2)
    s_add_u32 s63, s69, 188416
    buffer_load_dwordx4 v[140:143], v1, s[40:43], s63 offen nt
    s_waitcnt vmcnt(3)
    s_bitcmp1_b64 s[14:15], 16
    s_cbranch_scc0 1
    s_waitcnt vmcnt(2)
    s_add_u32 s63, s69, 262144
    buffer_load_dwordx4 v[48:51], v1, s[40:43], s63 offen nt
    s_waitcnt vmcnt(3)
    s_bitcmp1_b64 s[14:15], 17
    s_cbranch_scc0 1
    s_waitcnt vmcnt(2)
    s_add_u32 s63, s69, 270336
    buffer_load_dwordx4 v[52:55], v1, s[40:43], s63 offen nt
    s_branch .Le_done
.Lmr_part:
    s_mul_i32 s58, s3, 1152
    s_mov_b32 s52, s24
    s_and_b32 s53, s25, 0xffff
    s_mov_b32 s54, 0x2400
    s_mov_b32 s55, 0x00020000
    buffer_load_dwordx2 v[246:247], v3, s[52:55], s58 offen
    buffer_load_dwordx2 v[248:249], v3, s[52:55], s58 offen offset:512
    buffer_load_dword v250, v4, s[52:55], s58 offen
    s_mov_b32 s48, s26
    s_and_b32 s49, s27, 0xffff
    s_mov_b32 s50, 0x3cc000
    s_mov_b32 s51, 0x00020000
    v_bfe_u32 v12, v0, 4, 1
    s_and_b32 s56, s3, 3
    s_lshl_b32 s56, s56, 1
    v_or_b32 v12, s56, v12
    v_and_b32 v19, 7, v0
    v_xor_b32 v12, v12, v19
    v_lshrrev_b32 v19, 3, v0
    v_mul_u32_u24 v19, 6912, v19
    v_lshl_add_u32 v19, v12, 4, v19
    s_mul_i32 s57, s3, 55296
    s_lshl_b32 s59, s99, 7
    s_branch .Lsk_m0_4
.Lst_m0_4:
    s_branch .Lrt_m0_4
.Lsk_m0_4:
    s_add_u32 s57, s57, s59
    s_add_u32 m0, s100, 0
    s_add_u32 s56, s57, 0
    buffer_load_dwordx4 v19, s[48:51], s56 offen nt lds
    s_add_u32 m0, s100, 8192
    s_add_u32 s56, s57, 442368
    buffer_load_dwordx4 v19, s[48:51], s56 offen nt lds
    s_add_u32 m0, s100, 16384
    s_add_u32 s56, s57, 884736
    buffer_load_dwordx4 v19, s[48:51], s56 offen nt lds
    s_add_u32 m0, s100, 24576
    s_add_u32 s56, s57, 1327104
    buffer_load_dwordx4 v19, s[48:51], s56 offen nt lds
    s_add_u32 m0, s100, 32768
    s_add_u32 s56, s57, 1769472
    buffer_load_dwordx4 v19, s[48:51], s56 offen nt lds
    s_add_u32 m0, s100, 40960
    s_add_u32 s56, s57, 2211840
    buffer_load_dwordx4 v19, s[48:51], s56 offen nt lds
    s_add_u32 m0, s100, 49152
    s_add_u32 s56, s57, 2654208
    buffer_load_dwordx4 v19, s[48:51], s56 offen nt lds
    s_add_u32 m0, s100, 57344
    s_add_u32 s56, s57, 3096576
    buffer_load_dwordx4 v19, s[48:51], s56 offen nt lds
    s_add_u32 m0, s100, 65536
    s_add_u32 s56, s57, 3538944
    buffer_load_dwordx4 v19, s[48:51], s56 offen nt lds
    v_lshrrev_b32 v12, 4, v0
    v_mul_u32_u24 v12, 18432, v12
    v_and_b32 v13, 15, v0
    v_lshl_add_u32 v22, v13, 4, v12
    s_mul_i32 s57, s99, 57
    s_lshr_b32 s57, s57, 9
    s_mul_i32 s58, s57, 9
    s_sub_u32 s58, s99, s58
    s_mul_i32 s59, s57, 73728
    s_lshl_b32 s58, s58, 8
    s_add_u32 s59, s59, s58
    s_mul_i32 s58, s3, 2304
    s_add_u32 s59, s59, s58
    s_add_u32 s59, s59, 0x1000
    s_mov_b32 s58, 0
    s_cmp_eq_u32 s57, 1
    s_cselect_b32 s58, 1.0, s58
    s_cmp_eq_u32 s57, 4
    s_cselect_b32 s58, 1.0, s58
    s_waitcnt vmcnt(9)
    v_lshlrev_b32 v236, 16, v246
    v_and_b32 v237, 0xffff0000, v246
    v_max_f32 v236, 0xc2ae0000, v236
    v_min_f32 v242, 0x43000000, v236
    v_mul_f32 v238, 0xbfb8aa3b, v242
    v_fma_f32 v240, v242, s98, -v238
    v_fmac_f32 v240, 0xb2a57060, v242
    v_exp_f32 v238, v238
    v_mul_f32 v240, 0x3f317218, v240
    v_fmac_f32 v238, v238, v240
    v_add_f32 v238, 1.0, v238
    v_rcp_f32 v240, v238
    s_nop 0
    v_mul_f32 v242, v236, v240
    v_fma_f32 v238, -v242, v238, v236
    v_fma_f32 v236, v238, v240, v242
    v_max_f32 v237, 0xc2ae0000, v237
    v_min_f32 v243, 0x43000000, v237
    v_mul_f32 v239, 0xbfb8aa3b, v243
    v_fma_f32 v241, v243, s98, -v239
    v_fmac_f32 v241, 0xb2a57060, v243
    v_exp_f32 v239, v239
    v_mul_f32 v241, 0x3f317218, v241
    v_fmac_f32 v239, v239, v241
    v_add_f32 v239, 1.0, v239
    v_rcp_f32 v241, v239
    s_nop 0
    v_mul_f32 v243, v237, v241
    v_fma_f32 v239, -v243, v239, v237
    v_fma_f32 v237, v239, v241, v243
    v_cvt_pk_bf16_f32 v246, v236, v237
    v_lshlrev_b32 v236, 16, v247
    v_and_b32 v237, 0xffff0000, v247
    v_max_f32 v236, 0xc2ae0000, v236
    v_min_f32 v242, 0x43000000, v236
    v_mul_f32 v238, 0xbfb8aa3b, v242
    v_fma_f32 v240, v242, s98, -v238
    v_fmac_f32 v240, 0xb2a57060, v242
    v_exp_f32 v238, v238
    v_mul_f32 v240, 0x3f317218, v240
    v_fmac_f32 v238, v238, v240
    v_add_f32 v238, 1.0, v238
    v_rcp_f32 v240, v238
    s_nop 0
    v_mul_f32 v242, v236, v240
    v_fma_f32 v238, -v242, v238, v236
    v_fma_f32 v236, v238, v240, v242
    v_max_f32 v237, 0xc2ae0000, v237
    v_min_f32 v243, 0x43000000, v237
    v_mul_f32 v239, 0xbfb8aa3b, v243
    v_fma_f32 v241, v243, s98, -v239
    v_fmac_f32 v241, 0xb2a57060, v243
    v_exp_f32 v239, v239
    v_mul_f32 v241, 0x3f317218, v241
    v_fmac_f32 v239, v239, v241
    v_add_f32 v239, 1.0, v239
    v_rcp_f32 v241, v239
    s_nop 0
    v_mul_f32 v243, v237, v241
    v_fma_f32 v239, -v243, v239, v237
    v_fma_f32 v237, v239, v241, v243
    v_cvt_pk_bf16_f32 v247, v236, v237
    v_lshlrev_b32 v236, 16, v248
    v_and_b32 v237, 0xffff0000, v248
    v_max_f32 v236, 0xc2ae0000, v236
    v_min_f32 v242, 0x43000000, v236
    v_mul_f32 v238, 0xbfb8aa3b, v242
    v_fma_f32 v240, v242, s98, -v238
    v_fmac_f32 v240, 0xb2a57060, v242
    v_exp_f32 v238, v238
    v_mul_f32 v240, 0x3f317218, v240
    v_fmac_f32 v238, v238, v240
    v_add_f32 v238, 1.0, v238
    v_rcp_f32 v240, v238
    s_nop 0
    v_mul_f32 v242, v236, v240
    v_fma_f32 v238, -v242, v238, v236
    v_fma_f32 v236, v238, v240, v242
    v_max_f32 v237, 0xc2ae0000, v237
    v_min_f32 v243, 0x43000000, v237
    v_mul_f32 v239, 0xbfb8aa3b, v243
    v_fma_f32 v241, v243, s98, -v239
    v_fmac_f32 v241, 0xb2a57060, v243
    v_exp_f32 v239, v239
    v_mul_f32 v241, 0x3f317218, v241
    v_fmac_f32 v239, v239, v241
    v_add_f32 v239, 1.0, v239
    v_rcp_f32 v241, v239
    s_nop 0
    v_mul_f32 v243, v237, v241
    v_fma_f32 v239, -v243, v239, v237
    v_fma_f32 v237, v239, v241, v243
    v_cvt_pk_bf16_f32 v248, v236, v237
    v_lshlrev_b32 v236, 16, v249
    v_and_b32 v237, 0xffff0000, v249
    v_max_f32 v236, 0xc2ae0000, v236
    v_min_f32 v242, 0x43000000, v236
    v_mul_f32 v238, 0xbfb8aa3b, v242
    v_fma_f32 v240, v242, s98, -v238
    v_fmac_f32 v240, 0xb2a57060, v242
    v_exp_f32 v238, v238
    v_mul_f32 v240, 0x3f317218, v240
    v_fmac_f32 v238, v238, v240
    v_add_f32 v238, 1.0, v238
    v_rcp_f32 v240, v238
    s_nop 0
    v_mul_f32 v242, v236, v240
    v_fma_f32 v238, -v242, v238, v236
    v_fma_f32 v236, v238, v240, v242
    v_max_f32 v237, 0xc2ae0000, v237
    v_min_f32 v243, 0x43000000, v237
    v_mul_f32 v239, 0xbfb8aa3b, v243
    v_fma_f32 v241, v243, s98, -v239
    v_fmac_f32 v241, 0xb2a57060, v243
    v_exp_f32 v239, v239
    v_mul_f32 v241, 0x3f317218, v241
    v_fmac_f32 v239, v239, v241
    v_add_f32 v239, 1.0, v239
    v_rcp_f32 v241, v239
    s_nop 0
    v_mul_f32 v243, v237, v241
    v_fma_f32 v239, -v243, v239, v237
    s_branch .Lsk_m0_5
.Lst_m0_5:
    s_branch .Lrt_m0_5
.Lsk_m0_5:
    v_fma_f32 v237, v239, v241, v243
    v_cvt_pk_bf16_f32 v249, v236, v237
    v_lshlrev_b32 v236, 16, v250
    v_and_b32 v237, 0xffff0000, v250
    v_max_f32 v236, 0xc2ae0000, v236
    v_min_f32 v242, 0x43000000, v236
    v_mul_f32 v238, 0xbfb8aa3b, v242
    v_fma_f32 v240, v242, s98, -v238
    v_fmac_f32 v240, 0xb2a57060, v242
    v_exp_f32 v238, v238
    v_mul_f32 v240, 0x3f317218, v240
    v_fmac_f32 v238, v238, v240
    v_add_f32 v238, 1.0, v238
    v_rcp_f32 v240, v238
    s_nop 0
    v_mul_f32 v242, v236, v240
    v_fma_f32 v238, -v242, v238, v236
    v_fma_f32 v236, v238, v240, v242
    v_max_f32 v237, 0xc2ae0000, v237
    v_min_f32 v243, 0x43000000, v237
    v_mul_f32 v239, 0xbfb8aa3b, v243
    v_fma_f32 v241, v243, s98, -v239
    v_fmac_f32 v241, 0xb2a57060, v243
    v_exp_f32 v239, v239
    v_mul_f32 v241, 0x3f317218, v241
    v_fmac_f32 v239, v239, v241
    v_add_f32 v239, 1.0, v239
    v_rcp_f32 v241, v239
    s_nop 0
    v_mul_f32 v243, v237, v241
    v_fma_f32 v239, -v243, v239, v237
    v_fma_f32 v237, v239, v241, v243
    v_cvt_pk_bf16_f32 v250, v236, v237
    ds_write_b64 v17, v[246:247] offset:0
    ds_write_b64 v17, v[248:249] offset:512
    ds_write_b32 v18, v250 offset:0
    s_waitcnt vmcnt(3)
    s_add_u32 s63, s69, 147456
    buffer_load_dwordx4 v[72:75], v1, s[40:43], s63 offen nt
    s_waitcnt vmcnt(3)
    s_add_u32 s63, s69, 155648
    buffer_load_dwordx4 v[76:79], v1, s[40:43], s63 offen nt
    s_waitcnt vmcnt(3)
    s_add_u32 s63, s69, 163840
    buffer_load_dwordx4 v[104:107], v1, s[40:43], s63 offen nt
    s_waitcnt vmcnt(3)
    s_add_u32 s63, s69, 172032
    buffer_load_dwordx4 v[108:111], v1, s[40:43], s63 offen nt
    s_waitcnt vmcnt(3)
    s_add_u32 s63, s69, 180224
    buffer_load_dwordx4 v[136:139], v1, s[40:43], s63 offen nt
    s_waitcnt vmcnt(3)
    s_add_u32 s63, s69, 188416
    buffer_load_dwordx4 v[140:143], v1, s[40:43], s63 offen nt
    s_waitcnt vmcnt(3)
    s_add_u32 s63, s69, 262144
    buffer_load_dwordx4 v[48:51], v1, s[40:43], s63 offen nt
    s_waitcnt vmcnt(3)
    s_add_u32 s63, s69, 270336
    buffer_load_dwordx4 v[52:55], v1, s[40:43], s63 offen nt
    s_waitcnt lgkmcnt(0)
    s_barrier
    ds_read_b64_tr_b16 v[160:161], v20 offset:0
    ds_read_b64_tr_b16 v[162:163], v20 offset:512
    ds_read_b64_tr_b16 v[164:165], v20 offset:8192
    ds_read_b64_tr_b16 v[166:167], v20 offset:8704
    ds_read_b64_tr_b16 v[168:169], v20 offset:16384
    ds_read_b64_tr_b16 v[170:171], v20 offset:16896
    ds_read_b64_tr_b16 v[172:173], v20 offset:24576
    ds_read_b64_tr_b16 v[174:175], v20 offset:25088
    ds_read_b64_tr_b16 v[176:177], v21 offset:0
    ds_read_b64_tr_b16 v[178:179], v21 offset:512
    ds_read_b64_tr_b16 v[180:181], v21 offset:8192
    ds_read_b64_tr_b16 v[182:183], v21 offset:8704
    ds_read_b64_tr_b16 v[184:185], v21 offset:16384
    ds_read_b64_tr_b16 v[186:187], v21 offset:16896
    ds_read_b64_tr_b16 v[188:189], v21 offset:24576
    ds_read_b64_tr_b16 v[190:191], v21 offset:25088
    ds_read_b64_tr_b16 v[192:193], v21 offset:32768
    ds_read_b64_tr_b16 v[194:195], v21 offset:33280
    ds_read_b128 v[196:199], v16 offset:0
    ds_read_b128 v[200:203], v16 offset:128
    ds_read_b128 v[204:207], v16 offset:256
    ds_read_b128 v[208:211], v16 offset:384
    ds_read_b128 v[212:215], v16 offset:512
    ds_read_b128 v[216:219], v16 offset:640
    ds_read_b128 v[220:223], v16 offset:768
    ds_read_b128 v[224:227], v16 offset:896
    ds_read_b128 v[228:231], v16 offset:1024
    s_waitcnt lgkmcnt(8)
    v_mfma_f32_16x16x32_bf16 v[232:235], v[160:163], v[196:199], 0
    s_waitcnt lgkmcnt(7)
    v_mfma_f32_16x16x32_bf16 v[232:235], v[164:167], v[200:203], v[232:235]
    s_waitcnt lgkmcnt(6)
    v_mfma_f32_16x16x32_bf16 v[232:235], v[168:171], v[204:207], v[232:235]
    s_waitcnt lgkmcnt(5)
    v_mfma_f32_16x16x32_bf16 v[232:235], v[172:175], v[208:211], v[232:235]
    s_waitcnt lgkmcnt(4)
    v_mfma_f32_16x16x32_bf16 v[232:235], v[176:179], v[212:215], v[232:235]
    s_waitcnt lgkmcnt(3)
    v_mfma_f32_16x16x32_bf16 v[232:235], v[180:183], v[216:219], v[232:235]
    s_waitcnt lgkmcnt(2)
    v_mfma_f32_16x16x32_bf16 v[232:235], v[184:187], v[220:223], v[232:235]
    s_waitcnt lgkmcnt(1)
    v_mfma_f32_16x16x32_bf16 v[232:235], v[188:191], v[224:227], v[232:235]
    s_waitcnt lgkmcnt(0)
    v_mfma_f32_16x16x32_bf16 v[232:235], v[192:195], v[228:231], v[232:235]
    s_nop 7
    v_permlane32_swap_b32 v232, v234
    v_permlane32_swap_b32 v233, v235
    v_cndmask_b32 v233, v233, v234, s[96:97]
    v_cndmask_b32 v232, v232, v235, s[96:97]
    s_nop 1
    v_add_f32_dpp v236, v233, v232 quad_perm:[1,0,3,2] row_mask:0xf bank_mask:0xf
    v_cvt_pk_bf16_f32 v236, v236, v236
    v_lshlrev_b32 v236, 16, v236
    v_add_f32 v236, s58, v236
    v_cvt_pk_bf16_f32 v236, v236, v236
    ds_write_b16 v23, v236
    v_mov_b32 v243, s34
    s_waitcnt lgkmcnt(0)
    s_barrier
    ds_read2_b32 v[244:245], v24 offset1:1
    v_mov_b32 v241, s34
    s_waitcnt lgkmcnt(0)
    v_mov_b32 v240, v244
    v_mov_b32 v242, v245
    s_bfm_b64 exec, 16, 0
    buffer_store_dwordx4 v[240:243], v22, s[36:39], s59 offen sc1
    s_mov_b64 exec, -1
.Le_done:
    v_and_b32 v8, 1, v0
    v_lshlrev_b32 v8, 8, v8
    v_and_b32 v9, 0x3c, v0
    v_lshl_add_u32 v9, v9, 2, v8
    v_add_u32 v7, v9, v8
    v_and_b32 v9, 0x3c, v0
    v_lshrrev_b32 v8, 4, v8
    v_and_b32 v9, 4, v0
    v_lshl_add_u32 v9, v9, 3, v8
    s_lshl_b32 s58, s66, 14
    s_lshl_b32 s59, s67, 10
    s_add_u32 s58, s58, s59
    s_add_u32 s58, s58, 0x70000
    s_lshl4_add_u32 s59, s66, s67
    s_lshl_b32 s59, s59, 7
    s_add_u32 s59, s59, 0x430000
    s_waitcnt vmcnt(3)
    s_bitcmp1_b64 s[14:15], 18
    s_cbranch_scc0 1
    s_waitcnt vmcnt(2)
    s_add_u32 s63, s69, 278528
    buffer_load_dwordx4 v[80:83], v1, s[40:43], s63 offen nt
    v_and_b32 v157, 7, v0
    v_lshlrev_b32 v157, 2, v157
    s_mov_b32 s63, 0x4a1000
    buffer_load_dword v156, v157, s[36:39], s63 offen
    s_cmp_eq_u32 s3, 0
    s_cbranch_scc1 .Lst_m1_0
    s_cmp_eq_u32 s3, 1
    s_cbranch_scc1 .Lst_m1_1
    s_cmp_eq_u32 s3, 2
    s_cbranch_scc1 .Lst_m1_2
    s_cmp_eq_u32 s3, 3
    s_cbranch_scc1 .Lst_m1_3
    s_cmp_eq_u32 s3, 4
    s_cbranch_scc1 .Lst_m1_4
    s_cmp_eq_u32 s3, 5
    s_cbranch_scc1 .Lst_m1_5
    s_cmp_eq_u32 s3, 6
    s_cbranch_scc1 .Lst_m1_6
    s_cmp_eq_u32 s3, 7
    s_cbranch_scc1 .Lst_m1_7
.Lrt_m1_0:
.Lrt_m1_1:
.Lrt_m1_2:
.Lrt_m1_3:
.Lrt_m1_4:
.Lrt_m1_5:
.Lrt_m1_6:
.Lrt_m1_7:
    s_memrealtime s[8:9]
    s_waitcnt lgkmcnt(0)
    s_sub_u32 s8, s8, s30
    s_cmpk_ge_u32 s8, 912
    s_cbranch_scc1 .ap_54
    s_waitcnt vmcnt(5)
    s_cmpk_ge_u32 s8, 812
    s_cbranch_scc1 .ap_54
    s_waitcnt vmcnt(4)
    s_bitcmp1_b64 s[14:15], 19
    s_cbranch_scc0 1
    s_waitcnt vmcnt(3)
    s_cmpk_ge_u32 s8, 692
    s_cbranch_scc1 .ap_54
    s_waitcnt vmcnt(2)
.ap_54:
    s_add_u32 s63, s69, 286720
    buffer_load_dwordx4 v[84:87], v1, s[40:43], s63 offen nt
    s_memrealtime s[8:9]
    s_waitcnt lgkmcnt(0)
    s_sub_u32 s8, s8, s30
    s_cmpk_ge_u32 s8, 957
    s_cbranch_scc1 .ap_55
    s_waitcnt vmcnt(6)
    s_cmpk_ge_u32 s8, 857
    s_cbranch_scc1 .ap_55
    s_waitcnt vmcnt(4)
    s_bitcmp1_b64 s[14:15], 20
    s_cbranch_scc0 1
    s_waitcnt vmcnt(3)
    s_cmpk_ge_u32 s8, 737
    s_cbranch_scc1 .ap_55
    s_waitcnt vmcnt(2)
.ap_55:
    s_add_u32 s63, s69, 294912
    buffer_load_dwordx4 v[112:115], v1, s[40:43], s63 offen nt
    s_memrealtime s[8:9]
    s_waitcnt lgkmcnt(0)
    s_sub_u32 s8, s8, s30
    s_cmpk_ge_u32 s8, 1002
    s_cbranch_scc1 .ap_56
    s_waitcnt vmcnt(6)
    s_cmpk_ge_u32 s8, 902
    s_cbranch_scc1 .ap_56
    s_waitcnt vmcnt(4)
    s_bitcmp1_b64 s[14:15], 21
    s_cbranch_scc0 1
    s_waitcnt vmcnt(3)
    s_cmpk_ge_u32 s8, 782
    s_cbranch_scc1 .ap_56
    s_waitcnt vmcnt(1)
.ap_56:
    s_add_u32 s63, s69, 303104
    buffer_load_dwordx4 v[116:119], v1, s[40:43], s63 offen nt
    s_memrealtime s[8:9]
    s_waitcnt lgkmcnt(0)
    s_sub_u32 s8, s8, s30
    s_cmpk_ge_u32 s8, 1048
    s_cbranch_scc1 .ap_57
    s_waitcnt vmcnt(6)
    s_cmpk_ge_u32 s8, 948
    s_cbranch_scc1 .ap_57
    s_waitcnt vmcnt(4)
    s_bitcmp1_b64 s[14:15], 22
    s_cbranch_scc0 1
    s_waitcnt vmcnt(2)
    s_cmpk_ge_u32 s8, 828
    s_cbranch_scc1 .ap_57
    s_waitcnt vmcnt(1)
.ap_57:
    s_add_u32 s63, s69, 311296
    buffer_load_dwordx4 v[144:147], v1, s[40:43], s63 offen nt
    s_waitcnt vmcnt(4)
    s_sub_u32 s63, s70, 300
    v_subrev_u32 v156, s63, v156
    v_mov_b32 v157, 600
    v_cmp_lt_u32 s[8:9], v156, v157
    v_add_u32_dpp v156, v156, v156 quad_perm:[1,0,3,2] row_mask:0xf bank_mask:0xf
    s_nop 1
    v_add_u32_dpp v156, v156, v156 quad_perm:[2,3,0,1] row_mask:0xf bank_mask:0xf
    s_nop 1
    v_add_u32_dpp v156, v156, v156 row_ror:4 row_mask:0xf bank_mask:0xf
    s_nop 0
    v_readfirstlane_b32 s63, v156
    s_cmp_eq_u64 s[8:9], -1
    s_nop 3
    s_cbranch_scc0 .et_58
    s_lshr_b32 s63, s63, 3
    s_sub_u32 s63, s63, 300
    s_add_u32 s30, s30, s63
    s_add_u32 s31, s31, s63
.et_58:
    s_memrealtime s[8:9]
    s_waitcnt lgkmcnt(0)
    s_sub_u32 s8, s8, s30
    s_cmpk_ge_u32 s8, 1093
    s_cbranch_scc1 .ap_59
    s_waitcnt vmcnt(4)
    s_cmpk_ge_u32 s8, 993
    s_cbranch_scc1 .ap_59
    s_waitcnt vmcnt(3)
    s_bitcmp1_b64 s[14:15], 23
    s_cbranch_scc0 1
    s_waitcnt vmcnt(2)
    s_cmpk_ge_u32 s8, 873
    s_cbranch_scc1 .ap_59
    s_waitcnt vmcnt(1)
.ap_59:
    s_add_u32 s63, s69, 319488
    buffer_load_dwordx4 v[148:151], v1, s[40:43], s63 offen nt
    s_memrealtime s[8:9]
    s_waitcnt lgkmcnt(0)
    s_sub_u32 s8, s8, s30
    s_cmpk_ge_u32 s8, 1138
    s_cbranch_scc1 .ap_60
    s_waitcnt vmcnt(5)
    s_cmpk_ge_u32 s8, 1038
    s_cbranch_scc1 .ap_60
    s_waitcnt vmcnt(3)
    s_bitcmp1_b64 s[14:15], 24
    s_cbranch_scc0 1
    s_waitcnt vmcnt(2)
    s_cmpk_ge_u32 s8, 918
    s_cbranch_scc1 .ap_60
    s_waitcnt vmcnt(1)
.ap_60:
    s_add_u32 s63, s69, 393216
    buffer_load_dwordx4 v[56:59], v1, s[40:43], s63 offen nt
    s_memrealtime s[8:9]
    s_waitcnt lgkmcnt(0)
    s_sub_u32 s8, s8, s30
    s_cmpk_ge_u32 s8, 1184
    s_cbranch_scc1 .ap_61
    s_waitcnt vmcnt(5)
    s_cmpk_ge_u32 s8, 1084
    s_cbranch_scc1 .ap_61
    s_waitcnt vmcnt(3)
    s_bitcmp1_b64 s[14:15], 25
    s_cbranch_scc0 1
    s_waitcnt vmcnt(2)
    s_cmpk_ge_u32 s8, 964
    s_cbranch_scc1 .ap_61
    s_waitcnt vmcnt(1)
.ap_61:
    s_add_u32 s63, s69, 401408
    buffer_load_dwordx4 v[60:63], v1, s[40:43], s63 offen nt
    s_memrealtime s[8:9]
    s_waitcnt lgkmcnt(0)
    s_sub_u32 s8, s8, s30
    s_cmpk_ge_u32 s8, 1211
    s_cbranch_scc1 .ap_62
    s_waitcnt vmcnt(5)
    s_cmpk_ge_u32 s8, 1111
    s_cbranch_scc1 .ap_62
    s_waitcnt vmcnt(3)
    s_bitcmp1_b64 s[14:15], 26
    s_cbranch_scc0 1
    s_waitcnt vmcnt(2)
    s_cmpk_ge_u32 s8, 991
    s_cbranch_scc1 .ap_62
    s_waitcnt vmcnt(1)
.ap_62:
    s_add_u32 s63, s69, 409600
    buffer_load_dwordx4 v[88:91], v1, s[40:43], s63 offen nt
    s_memrealtime s[8:9]
    s_waitcnt lgkmcnt(0)
    s_sub_u32 s8, s8, s30
    s_cmpk_ge_u32 s8, 1238
    s_cbranch_scc1 .ap_63
    s_waitcnt vmcnt(5)
    s_cmpk_ge_u32 s8, 1138
    s_cbranch_scc1 .ap_63
    s_waitcnt vmcnt(3)
    s_bitcmp1_b64 s[14:15], 27
    s_cbranch_scc0 1
    s_waitcnt vmcnt(2)
    s_cmpk_ge_u32 s8, 1018
    s_cbranch_scc1 .ap_63
    s_waitcnt vmcnt(1)
.ap_63:
    s_add_u32 s63, s69, 417792
    buffer_load_dwordx4 v[92:95], v1, s[40:43], s63 offen nt
    s_memrealtime s[8:9]
    s_waitcnt vmcnt(8)
    s_waitcnt lgkmcnt(0)
    s_sub_u32 s8, s8, s30
    s_cmpk_ge_u32 s8, 1265
    s_cbranch_scc1 .ap_64
    s_waitcnt vmcnt(5)
    s_cmpk_ge_u32 s8, 1165
    s_cbranch_scc1 .ap_64
    s_branch .Lsk_m1_0
.Lst_m1_0:
    s_branch .Lrt_m1_0
.Lsk_m1_0:
    s_waitcnt vmcnt(3)
    s_bitcmp1_b64 s[14:15], 28
    s_cbranch_scc0 1
    s_waitcnt vmcnt(2)
    s_cmpk_ge_u32 s8, 1045
    s_cbranch_scc1 .ap_64
    s_waitcnt vmcnt(1)
.ap_64:
    s_add_u32 s63, s69, 425984
    buffer_load_dwordx4 v[120:123], v1, s[40:43], s63 offen nt
    s_memrealtime s[8:9]
    s_waitcnt vmcnt(8)
    s_waitcnt lgkmcnt(0)
    s_sub_u32 s8, s8, s30
    s_cmpk_ge_u32 s8, 1292
    s_cbranch_scc1 .ap_65
    s_waitcnt vmcnt(5)
    s_cmpk_ge_u32 s8, 1192
    s_cbranch_scc1 .ap_65
    s_waitcnt vmcnt(3)
    s_bitcmp1_b64 s[14:15], 29
    s_cbranch_scc0 1
    s_waitcnt vmcnt(2)
    s_cmpk_ge_u32 s8, 1072
    s_cbranch_scc1 .ap_65
    s_waitcnt vmcnt(1)
.ap_65:
    s_add_u32 s63, s69, 434176
    buffer_load_dwordx4 v[124:127], v1, s[40:43], s63 offen nt
    s_memrealtime s[8:9]
    s_waitcnt vmcnt(8)
    s_waitcnt lgkmcnt(0)
    s_sub_u32 s8, s8, s30
    s_cmpk_ge_u32 s8, 1320
    s_cbranch_scc1 .ap_66
    s_waitcnt vmcnt(5)
    s_cmpk_ge_u32 s8, 1220
    s_cbranch_scc1 .ap_66
    s_waitcnt vmcnt(3)
    s_bitcmp1_b64 s[14:15], 30
    s_cbranch_scc0 1
    s_waitcnt vmcnt(2)
    s_cmpk_ge_u32 s8, 1100
    s_cbranch_scc1 .ap_66
    s_waitcnt vmcnt(1)
.ap_66:
    s_add_u32 s63, s69, 442368
    buffer_load_dwordx4 v[152:155], v1, s[40:43], s63 offen nt
    s_memrealtime s[8:9]
    s_waitcnt vmcnt(8)
    s_waitcnt lgkmcnt(0)
    s_sub_u32 s8, s8, s30
    s_cmpk_ge_u32 s8, 1347
    s_cbranch_scc1 .ap_67
    s_waitcnt vmcnt(5)
    s_cmpk_ge_u32 s8, 1247
    s_cbranch_scc1 .ap_67
    s_waitcnt vmcnt(3)
    s_bitcmp1_b64 s[14:15], 31
    s_cbranch_scc0 1
    s_waitcnt vmcnt(2)
    s_cmpk_ge_u32 s8, 1127
    s_cbranch_scc1 .ap_67
    s_waitcnt vmcnt(1)
.ap_67:
    s_add_u32 s63, s69, 450560
    buffer_load_dwordx4 v[156:159], v1, s[40:43], s63 offen nt
    s_memrealtime s[8:9]
    s_waitcnt vmcnt(8)
    s_waitcnt lgkmcnt(0)
    s_sub_u32 s8, s8, s30
    s_cmpk_ge_u32 s8, 1374
    s_cbranch_scc1 .ap_68
    s_waitcnt vmcnt(5)
    s_cmpk_ge_u32 s8, 1274
    s_cbranch_scc1 .ap_68
    s_waitcnt vmcnt(3)
    s_bitcmp1_b64 s[14:15], 32
    s_cbranch_scc0 1
    s_waitcnt vmcnt(2)
    s_cmpk_ge_u32 s8, 1154
    s_cbranch_scc1 .ap_68
    s_waitcnt vmcnt(1)
.ap_68:
    v_bfe_u32 v1, v0, 4, 2
    v_and_b32 v10, 0xf0, v2
    v_lshlrev_b32 v1, 2, v1
    v_bfe_u32 v1, s6, v1, 4
    v_lshl_add_u32 v1, v1, 8, v10
    s_add_u32 s63, s69, 0
    buffer_load_dwordx4 v[160:163], v1, s[44:47], s63 offen nt
    s_memrealtime s[8:9]
    s_waitcnt vmcnt(8)
    s_waitcnt lgkmcnt(0)
    s_sub_u32 s8, s8, s30
    s_cmpk_ge_u32 s8, 1401
    s_cbranch_scc1 .ap_69
    s_waitcnt vmcnt(5)
    s_cmpk_ge_u32 s8, 1301
    s_cbranch_scc1 .ap_69
    s_waitcnt vmcnt(3)
    s_bitcmp1_b64 s[14:15], 33
    s_cbranch_scc0 1
    s_waitcnt vmcnt(2)
    s_cmpk_ge_u32 s8, 1181
    s_cbranch_scc1 .ap_69
    s_waitcnt vmcnt(1)
.ap_69:
    s_add_u32 s63, s69, 8192
    buffer_load_dwordx4 v[164:167], v1, s[44:47], s63 offen nt
    s_memrealtime s[8:9]
    s_waitcnt vmcnt(8)
    s_waitcnt lgkmcnt(0)
    s_sub_u32 s8, s8, s30
    s_cmpk_ge_u32 s8, 1428
    s_cbranch_scc1 .ap_70
    s_waitcnt vmcnt(5)
    s_cmpk_ge_u32 s8, 1328
    s_cbranch_scc1 .ap_70
    s_waitcnt vmcnt(3)
    s_bitcmp1_b64 s[14:15], 34
    s_cbranch_scc0 1
    s_waitcnt vmcnt(2)
    s_cmpk_ge_u32 s8, 1208
    s_cbranch_scc1 .ap_70
    s_waitcnt vmcnt(1)
.ap_70:
    s_add_u32 s63, s69, 16384
    buffer_load_dwordx4 v[168:171], v1, s[44:47], s63 offen nt
    s_memrealtime s[8:9]
    s_waitcnt vmcnt(8)
    s_waitcnt lgkmcnt(0)
    s_sub_u32 s8, s8, s30
    s_cmpk_ge_u32 s8, 1456
    s_cbranch_scc1 .ap_71
    s_waitcnt vmcnt(5)
    s_cmpk_ge_u32 s8, 1356
    s_cbranch_scc1 .ap_71
    s_waitcnt vmcnt(3)
    s_bitcmp1_b64 s[14:15], 35
    s_cbranch_scc0 1
    s_waitcnt vmcnt(2)
    s_cmpk_ge_u32 s8, 1236
    s_cbranch_scc1 .ap_71
    s_waitcnt vmcnt(1)
.ap_71:
    s_add_u32 s63, s69, 24576
    buffer_load_dwordx4 v[172:175], v1, s[44:47], s63 offen nt
    buffer_load_dwordx4 v[16:19], v7, s[36:39], s58 offen offset:0 sc1
    buffer_load_dwordx4 v[20:23], v7, s[36:39], s58 offen offset:256 sc1
    s_memrealtime s[8:9]
    s_waitcnt vmcnt(8)
    s_waitcnt lgkmcnt(0)
    s_sub_u32 s8, s8, s30
    s_cmpk_ge_u32 s8, 1486
    s_cbranch_scc1 .ap_72
    s_waitcnt vmcnt(5)
    s_cmpk_ge_u32 s8, 1386
    s_cbranch_scc1 .ap_72
    s_waitcnt vmcnt(3)
    s_bitcmp1_b64 s[14:15], 36
    s_cbranch_scc0 1
    s_waitcnt vmcnt(2)
    s_cmpk_ge_u32 s8, 1266
    s_cbranch_scc1 .ap_72
    s_waitcnt vmcnt(1)
.ap_72:
    s_add_u32 s63, s69, 32768
    buffer_load_dwordx4 v[176:179], v1, s[44:47], s63 offen nt
    s_memrealtime s[8:9]
    s_waitcnt vmcnt(8)
    s_waitcnt lgkmcnt(0)
    s_sub_u32 s8, s8, s30
    s_cmpk_ge_u32 s8, 1516
    s_cbranch_scc1 .ap_73
    s_waitcnt vmcnt(5)
    s_cmpk_ge_u32 s8, 1416
    s_cbranch_scc1 .ap_73
    s_waitcnt vmcnt(3)
    s_bitcmp1_b64 s[14:15], 37
    s_cbranch_scc0 1
    s_waitcnt vmcnt(2)
    s_cmpk_ge_u32 s8, 1296
    s_cbranch_scc1 .ap_73
    s_waitcnt vmcnt(1)
.ap_73:
    s_add_u32 s63, s69, 40960
    buffer_load_dwordx4 v[180:183], v1, s[44:47], s63 offen nt
    s_memrealtime s[8:9]
    s_waitcnt vmcnt(8)
    s_waitcnt lgkmcnt(0)
    s_sub_u32 s8, s8, s30
    s_cmpk_ge_u32 s8, 1546
    s_cbranch_scc1 .ap_74
    s_waitcnt vmcnt(5)
    s_cmpk_ge_u32 s8, 1446
    s_cbranch_scc1 .ap_74
    s_waitcnt vmcnt(3)
    s_bitcmp1_b64 s[14:15], 38
    s_cbranch_scc0 1
    s_waitcnt vmcnt(2)
    s_cmpk_ge_u32 s8, 1326
    s_cbranch_scc1 .ap_74
    s_waitcnt vmcnt(1)
.ap_74:
    s_add_u32 s63, s69, 49152
    buffer_load_dwordx4 v[184:187], v1, s[44:47], s63 offen nt
    s_waitcnt vmcnt(3)
    s_branch .gpc_76
.gp_75:
    buffer_load_dwordx4 v[16:19], v7, s[36:39], s58 offen offset:0 sc1
    buffer_load_dwordx4 v[20:23], v7, s[36:39], s58 offen offset:256 sc1
    s_waitcnt vmcnt(0)
.gpc_76:
    v_min_u32 v10, v17, v19
    v_max_u32 v11, v17, v19
    v_min3_u32 v10, v10, v21, v23
    v_max3_u32 v11, v11, v21, v23
    v_cmp_eq_u32 vcc, s34, v10
    v_cmp_eq_u32 s[56:57], s34, v11
    s_and_b64 vcc, vcc, s[56:57]
    s_cmp_eq_u64 vcc, -1
    s_nop 2
    s_cbranch_scc1 .gpd_77
    s_sub_u32 s35, s35, 1
    s_cbranch_scc1 .Lexit
    s_sleep 1
    s_branch .gp_75
.gpd_77:
    s_mov_b32 vcc_lo, 0xcccccccc
    s_mov_b32 vcc_hi, 0xcccccccc
    v_cndmask_b32_e64 v24, v16, 0, vcc
    v_cndmask_b32_e64 v25, v18, 0, vcc
    v_cndmask_b32_e64 v26, v20, 0, vcc
    v_cndmask_b32_e64 v27, v22, 0, vcc
    s_branch .Lsk_m1_1
.Lst_m1_1:
    s_branch .Lrt_m1_1
.Lsk_m1_1:
    v_cndmask_b32_e32 v28, 0, v16, vcc
    v_cndmask_b32_e32 v29, 0, v18, vcc
    v_cndmask_b32_e32 v30, 0, v20, vcc
    v_cndmask_b32_e32 v31, 0, v22, vcc
    v_mfma_f32_16x16x32_bf16 v[16:19], v[32:35], v[24:27], 0
    v_mfma_f32_16x16x32_bf16 v[32:35], v[40:43], v[24:27], 0
    v_mfma_f32_16x16x32_bf16 v[16:19], v[36:39], v[28:31], v[16:19]
    v_mfma_f32_16x16x32_bf16 v[40:43], v[48:51], v[24:27], 0
    v_mfma_f32_16x16x32_bf16 v[32:35], v[44:47], v[28:31], v[32:35]
    v_mfma_f32_16x16x32_bf16 v[48:51], v[56:59], v[24:27], 0
    v_mfma_f32_16x16x32_bf16 v[40:43], v[52:55], v[28:31], v[40:43]
    v_mfma_f32_16x16x32_bf16 v[56:59], v[64:67], v[24:27], 0
    v_mfma_f32_16x16x32_bf16 v[48:51], v[60:63], v[28:31], v[48:51]
    s_nop 1
    v_add_f32_dpp v10, v17, v16 row_ror:12 row_mask:0xf bank_mask:0x1
    s_memrealtime s[8:9]
    s_waitcnt lgkmcnt(0)
    s_sub_u32 s8, s8, s30
    s_cmpk_ge_u32 s8, 1576
    s_nop 0
    s_cbranch_scc1 .ap_78
    s_waitcnt vmcnt(3)
    s_cmpk_ge_u32 s8, 1476
    s_cbranch_scc1 .ap_78
    s_waitcnt vmcnt(3)
    s_bitcmp1_b64 s[14:15], 39
    s_cbranch_scc0 1
    s_waitcnt vmcnt(2)
    s_cmpk_ge_u32 s8, 1356
    s_cbranch_scc1 .ap_78
    s_waitcnt vmcnt(1)
.ap_78:
    s_add_u32 s63, s69, 57344
    buffer_load_dwordx4 v[188:191], v1, s[44:47], s63 offen nt
    v_mfma_f32_16x16x32_bf16 v[64:67], v[72:75], v[24:27], 0
    v_mfma_f32_16x16x32_bf16 v[56:59], v[68:71], v[28:31], v[56:59]
    v_add_f32_dpp v11, v33, v32 row_ror:12 row_mask:0xf bank_mask:0x1
    v_add_f32_dpp v10, v18, v10 row_ror:8 row_mask:0xf bank_mask:0x1
    v_mfma_f32_16x16x32_bf16 v[72:75], v[80:83], v[24:27], 0
    v_mfma_f32_16x16x32_bf16 v[64:67], v[76:79], v[28:31], v[64:67]
    v_add_f32_dpp v12, v41, v40 row_ror:12 row_mask:0xf bank_mask:0x1
    v_add_f32_dpp v11, v34, v11 row_ror:8 row_mask:0xf bank_mask:0x1
    v_add_f32_dpp v10, v19, v10 row_ror:4 row_mask:0xf bank_mask:0x1
    v_mfma_f32_16x16x32_bf16 v[80:83], v[88:91], v[24:27], 0
    v_mfma_f32_16x16x32_bf16 v[72:75], v[84:87], v[28:31], v[72:75]
    v_add_f32_dpp v13, v49, v48 row_ror:12 row_mask:0xf bank_mask:0x1
    v_add_f32_dpp v12, v42, v12 row_ror:8 row_mask:0xf bank_mask:0x1
    v_add_f32_dpp v11, v35, v11 row_ror:4 row_mask:0xf bank_mask:0x1
    v_mfma_f32_16x16x32_bf16 v[88:91], v[96:99], v[24:27], 0
    v_mfma_f32_16x16x32_bf16 v[80:83], v[92:95], v[28:31], v[80:83]
    v_add_f32_dpp v10, v58, v57 row_ror:12 row_mask:0xf bank_mask:0x2
    v_add_f32_dpp v13, v50, v13 row_ror:8 row_mask:0xf bank_mask:0x1
    v_add_f32_dpp v12, v43, v12 row_ror:4 row_mask:0xf bank_mask:0x1
    s_memrealtime s[8:9]
    s_waitcnt lgkmcnt(0)
    s_sub_u32 s8, s8, s30
    s_cmpk_ge_u32 s8, 1606
    s_nop 0
    s_cbranch_scc1 .ap_79
    s_waitcnt vmcnt(4)
    s_cmpk_ge_u32 s8, 1506
    s_cbranch_scc1 .ap_79
    s_waitcnt vmcnt(3)
    s_bitcmp1_b64 s[14:15], 40
    s_cbranch_scc0 1
    s_waitcnt vmcnt(2)
    s_cmpk_ge_u32 s8, 1386
    s_cbranch_scc1 .ap_79
    s_waitcnt vmcnt(1)
.ap_79:
    s_add_u32 s63, s69, 131072
    buffer_load_dwordx4 v[192:195], v1, s[44:47], s63 offen nt
    v_mfma_f32_16x16x32_bf16 v[96:99], v[104:107], v[24:27], 0
    v_mfma_f32_16x16x32_bf16 v[88:91], v[100:103], v[28:31], v[88:91]
    v_add_f32_dpp v11, v66, v65 row_ror:12 row_mask:0xf bank_mask:0x2
    v_add_f32_dpp v10, v59, v10 row_ror:8 row_mask:0xf bank_mask:0x2
    v_add_f32_dpp v13, v51, v13 row_ror:4 row_mask:0xf bank_mask:0x1
    v_mfma_f32_16x16x32_bf16 v[104:107], v[112:115], v[24:27], 0
    v_mfma_f32_16x16x32_bf16 v[96:99], v[108:111], v[28:31], v[96:99]
    v_add_f32_dpp v12, v74, v73 row_ror:12 row_mask:0xf bank_mask:0x2
    v_add_f32_dpp v11, v67, v11 row_ror:8 row_mask:0xf bank_mask:0x2
    v_add_f32_dpp v10, v56, v10 row_ror:4 row_mask:0xf bank_mask:0x2
    v_mfma_f32_16x16x32_bf16 v[112:115], v[120:123], v[24:27], 0
    v_mfma_f32_16x16x32_bf16 v[104:107], v[116:119], v[28:31], v[104:107]
    v_add_f32_dpp v13, v82, v81 row_ror:12 row_mask:0xf bank_mask:0x2
    v_add_f32_dpp v12, v75, v12 row_ror:8 row_mask:0xf bank_mask:0x2
    v_add_f32_dpp v11, v64, v11 row_ror:4 row_mask:0xf bank_mask:0x2
    v_mfma_f32_16x16x32_bf16 v[120:123], v[128:131], v[24:27], 0
    v_mfma_f32_16x16x32_bf16 v[112:115], v[124:127], v[28:31], v[112:115]
    v_add_f32_dpp v10, v91, v90 row_ror:12 row_mask:0xf bank_mask:0x4
    v_add_f32_dpp v13, v83, v13 row_ror:8 row_mask:0xf bank_mask:0x2
    v_add_f32_dpp v12, v72, v12 row_ror:4 row_mask:0xf bank_mask:0x2
    s_memrealtime s[8:9]
    s_waitcnt lgkmcnt(0)
    s_sub_u32 s8, s8, s30
    s_cmpk_ge_u32 s8, 1636
    s_nop 0
    s_cbranch_scc1 .ap_80
    s_waitcnt vmcnt(5)
    s_cmpk_ge_u32 s8, 1536
    s_cbranch_scc1 .ap_80
    s_waitcnt vmcnt(3)
    s_bitcmp1_b64 s[14:15], 41
    s_cbranch_scc0 1
    s_waitcnt vmcnt(2)
    s_cmpk_ge_u32 s8, 1416
    s_cbranch_scc1 .ap_80
    s_waitcnt vmcnt(1)
.ap_80:
    s_add_u32 s63, s69, 139264
    buffer_load_dwordx4 v[196:199], v1, s[44:47], s63 offen nt
    v_mfma_f32_16x16x32_bf16 v[128:131], v[136:139], v[24:27], 0
    v_mfma_f32_16x16x32_bf16 v[120:123], v[132:135], v[28:31], v[120:123]
    v_add_f32_dpp v11, v99, v98 row_ror:12 row_mask:0xf bank_mask:0x4
    v_add_f32_dpp v10, v88, v10 row_ror:8 row_mask:0xf bank_mask:0x4
    v_add_f32_dpp v13, v80, v13 row_ror:4 row_mask:0xf bank_mask:0x2
    v_mfma_f32_16x16x32_bf16 v[136:139], v[144:147], v[24:27], 0
    v_mfma_f32_16x16x32_bf16 v[128:131], v[140:143], v[28:31], v[128:131]
    v_add_f32_dpp v12, v107, v106 row_ror:12 row_mask:0xf bank_mask:0x4
    v_add_f32_dpp v11, v96, v11 row_ror:8 row_mask:0xf bank_mask:0x4
    v_add_f32_dpp v10, v89, v10 row_ror:4 row_mask:0xf bank_mask:0x4
    v_mfma_f32_16x16x32_bf16 v[144:147], v[152:155], v[24:27], 0
    v_mfma_f32_16x16x32_bf16 v[136:139], v[148:151], v[28:31], v[136:139]
    v_add_f32_dpp v13, v115, v114 row_ror:12 row_mask:0xf bank_mask:0x4
    v_add_f32_dpp v12, v104, v12 row_ror:8 row_mask:0xf bank_mask:0x4
    v_add_f32_dpp v11, v97, v11 row_ror:4 row_mask:0xf bank_mask:0x4
    v_mfma_f32_16x16x32_bf16 v[144:147], v[156:159], v[28:31], v[144:147]
    v_add_f32_dpp v10, v120, v123 row_ror:12 row_mask:0xf bank_mask:0x8
    v_add_f32_dpp v13, v112, v13 row_ror:8 row_mask:0xf bank_mask:0x4
    v_add_f32_dpp v12, v105, v12 row_ror:4 row_mask:0xf bank_mask:0x4
    s_memrealtime s[8:9]
    s_waitcnt lgkmcnt(0)
    s_sub_u32 s8, s8, s30
    s_cmpk_ge_u32 s8, 1666
    s_nop 0
    s_cbranch_scc1 .ap_81
    s_waitcnt vmcnt(5)
    s_cmpk_ge_u32 s8, 1566
    s_cbranch_scc1 .ap_81
    s_waitcnt vmcnt(3)
    s_bitcmp1_b64 s[14:15], 42
    s_cbranch_scc0 1
    s_waitcnt vmcnt(2)
    s_cmpk_ge_u32 s8, 1446
    s_cbranch_scc1 .ap_81
    s_waitcnt vmcnt(1)
.ap_81:
    s_add_u32 s63, s69, 147456
    buffer_load_dwordx4 v[200:203], v1, s[44:47], s63 offen nt
    v_add_f32_dpp v11, v128, v131 row_ror:12 row_mask:0xf bank_mask:0x8
    v_add_f32_dpp v10, v121, v10 row_ror:8 row_mask:0xf bank_mask:0x8
    v_add_f32_dpp v13, v113, v13 row_ror:4 row_mask:0xf bank_mask:0x4
    v_add_f32_dpp v12, v136, v139 row_ror:12 row_mask:0xf bank_mask:0x8
    v_add_f32_dpp v11, v129, v11 row_ror:8 row_mask:0xf bank_mask:0x8
    v_add_f32_dpp v10, v122, v10 row_ror:4 row_mask:0xf bank_mask:0x8
    v_add_f32_dpp v13, v144, v147 row_ror:12 row_mask:0xf bank_mask:0x8
    v_add_f32_dpp v12, v137, v12 row_ror:8 row_mask:0xf bank_mask:0x8
    v_add_f32_dpp v11, v130, v11 row_ror:4 row_mask:0xf bank_mask:0x8
    v_add_f32_dpp v13, v145, v13 row_ror:8 row_mask:0xf bank_mask:0x8
    v_add_f32_dpp v12, v138, v12 row_ror:4 row_mask:0xf bank_mask:0x8
    s_memrealtime s[8:9]
    s_waitcnt lgkmcnt(0)
    s_sub_u32 s8, s8, s30
    s_cmpk_ge_u32 s8, 1696
    s_cbranch_scc1 .ap_82
    s_waitcnt vmcnt(5)
    s_cmpk_ge_u32 s8, 1596
    s_cbranch_scc1 .ap_82
    s_waitcnt vmcnt(3)
    s_bitcmp1_b64 s[14:15], 43
    s_cbranch_scc0 1
    s_waitcnt vmcnt(2)
    s_cmpk_ge_u32 s8, 1476
    s_cbranch_scc1 .ap_82
    s_waitcnt vmcnt(1)
.ap_82:
    s_add_u32 s63, s69, 155648
    buffer_load_dwordx4 v[204:207], v1, s[44:47], s63 offen nt
    v_add_f32_dpp v13, v146, v13 row_ror:4 row_mask:0xf bank_mask:0x8
    s_mov_b32 s60, 0x3db504f3
    s_branch .Lsk_m1_2
.Lst_m1_2:
    s_branch .Lrt_m1_2
.Lsk_m1_2:
    s_mov_b32 s61, 0x3db504f3
    v_cvt_pk_bf16_f32 v10, v10, v11
    v_and_b32 v11, 0xffff0000, v10
    v_lshlrev_b32 v10, 16, v10
    v_cvt_pk_bf16_f32 v12, v12, v13
    v_and_b32 v13, 0xffff0000, v12
    v_lshlrev_b32 v12, 16, v12
    v_pk_mul_f32 v[10:11], v[10:11], s[60:61]
    v_pk_mul_f32 v[12:13], v[12:13], s[60:61]
    v_cvt_pk_bf16_f32 v10, v10, v11
    v_and_b32 v11, 0xffff0000, v10
    v_lshlrev_b32 v10, 16, v10
    v_cvt_pk_bf16_f32 v12, v12, v13
    v_and_b32 v13, 0xffff0000, v12
    v_lshlrev_b32 v12, 16, v12
    v_max_f32 v14, v10, v11
    v_max3_f32 v14, v14, v12, v13
    s_mov_b32 s60, 0x3fb8aa3b
    v_mov_b32 v22, s34
    v_mov_b32 v23, s34
    v_max_f32_dpp v14, v14, v14 quad_perm:[2,3,0,1] row_mask:0xf bank_mask:0xf
    s_nop 1
    v_max_f32_dpp v14, v14, v14 row_ror:4 row_mask:0xf bank_mask:0xf
    s_nop 1
    v_max_f32_dpp v14, v14, v14 row_ror:8 row_mask:0xf bank_mask:0xf
    v_mov_b32 v15, v14
    s_nop 1
    v_permlane16_swap_b32 v15, v14
    v_max_f32 v14, v15, v14
    v_mov_b32 v15, v14
    s_nop 1
    v_permlane32_swap_b32 v15, v14
    v_max_f32 v14, v15, v14
    v_mul_f32 v15, 0xbfb8aa3b, v14
    v_fma_f32 v10, v10, s60, v15
    v_fma_f32 v11, v11, s60, v15
    v_fma_f32 v12, v12, s60, v15
    v_fma_f32 v13, v13, s60, v15
    v_exp_f32 v10, v10
    v_exp_f32 v11, v11
    v_exp_f32 v12, v12
    v_exp_f32 v13, v13
    v_mov_b32 v20, v14
    v_pk_add_f32 v[16:17], v[10:11], v[12:13]
    v_add_f32 v21, v16, v17
    s_lshl_b32 s60, s68, 5
    s_lshl_b32 s61, s3, 4
    s_add_u32 s61, s61, 159104
    v_add_u32 v16, s61, v3
    v_mov_b32 v17, 159232
    v_mov_b32 v18, 1
    s_add_u32 s60, s60, s59
    v_add_f32_dpp v21, v21, v21 quad_perm:[2,3,0,1] row_mask:0xf bank_mask:0xf
    s_nop 1
    v_add_f32_dpp v21, v21, v21 row_ror:4 row_mask:0xf bank_mask:0xf
    s_nop 1
    v_add_f32_dpp v21, v21, v21 row_ror:8 row_mask:0xf bank_mask:0xf
    v_mov_b32 v15, v21
    s_nop 1
    v_permlane16_swap_b32 v15, v21
    v_add_f32 v21, v15, v21
    v_mov_b32 v15, v21
    s_nop 1
    v_permlane32_swap_b32 v15, v21
    v_add_f32 v21, v15, v21
    s_mov_b64 exec, 3
    ds_write_b64 v16, v[20:21]
    s_mov_b64 exec, 1
    ds_add_rtn_u32 v18, v17, v18
    s_mov_b64 exec, -1
    v_and_b32 v16, 0x78, v3
    v_or_b32 v16, 159104, v16
    s_waitcnt lgkmcnt(0)
    v_readfirstlane_b32 s61, v18
    s_cmp_eq_u32 s61, 7
    s_nop 3
    s_cbranch_scc0 .mlc_83
    ds_read_b64 v[18:19], v16
    s_waitcnt lgkmcnt(0)
    v_mov_b32 v20, v18
    s_nop 1
    v_max_f32_dpp v20, v20, v20 quad_perm:[2,3,0,1] row_mask:0xf bank_mask:0xf
    s_nop 1
    v_max_f32_dpp v20, v20, v20 row_ror:4 row_mask:0xf bank_mask:0xf
    s_nop 1
    v_max_f32_dpp v20, v20, v20 row_ror:8 row_mask:0xf bank_mask:0xf
    v_sub_f32 v18, v18, v20
    v_mul_f32 v18, 0x3fb8aa3b, v18
    v_exp_f32 v18, v18
    s_nop 0
    v_mul_f32 v21, v18, v19
    s_nop 1
    v_add_f32_dpp v21, v21, v21 quad_perm:[2,3,0,1] row_mask:0xf bank_mask:0xf
    s_nop 1
    v_add_f32_dpp v21, v21, v21 row_ror:4 row_mask:0xf bank_mask:0xf
    s_nop 1
    v_add_f32_dpp v21, v21, v21 row_ror:8 row_mask:0xf bank_mask:0xf
    s_mov_b64 exec, 3
    buffer_store_dwordx4 v[20:23], v2, s[36:39], s60 offen sc1
    s_mov_b64 exec, -1
.mlc_83:
    s_memrealtime s[8:9]
    s_waitcnt lgkmcnt(0)
    s_sub_u32 s8, s8, s30
    s_cmpk_ge_u32 s8, 1726
    s_cbranch_scc1 .ap_84
    s_waitcnt vmcnt(5)
    s_cmpk_ge_u32 s8, 1626
    s_cbranch_scc1 .ap_84
    s_waitcnt vmcnt(3)
    s_bitcmp1_b64 s[14:15], 44
    s_cbranch_scc0 1
    s_waitcnt vmcnt(2)
    s_cmpk_ge_u32 s8, 1506
    s_cbranch_scc1 .ap_84
    s_waitcnt vmcnt(1)
.ap_84:
    s_add_u32 s63, s69, 163840
    buffer_load_dwordx4 v[208:211], v1, s[44:47], s63 offen nt
    s_cmp_eq_u32 s3, 0
    s_cbranch_scc1 .Lst_m2_0
    s_cmp_eq_u32 s3, 1
    s_cbranch_scc1 .Lst_m2_1
    s_cmp_eq_u32 s3, 2
    s_cbranch_scc1 .Lrt_m2_2
    s_cmp_eq_u32 s3, 3
    s_cbranch_scc1 .Lrt_m2_3
.Lrt_m2_0:
.Lrt_m2_1:
.Lrt_m2_2:
.Lrt_m2_3:
    v_and_b32 v16, 8, v0
    v_and_b32 v17, 1, v0
    v_lshl_add_u32 v16, v17, 2, v16
    v_bfe_u32 v17, v0, 1, 2
    v_add_u32 v16, v16, v17
    v_lshrrev_b32 v17, 4, v0
    v_lshl_add_u32 v16, v16, 2, v17
    v_lshlrev_b32 v7, 1, v16
    v_and_b32 v8, 62, v16
    v_lshlrev_b32 v8, 2, v8
    s_mul_i32 s100, s3, 1152
    s_lshl_b32 s56, s65, 7
    s_add_u32 s100, s100, s56
    s_mov_b32 s52, s4
    s_and_b32 s53, s5, 0xffff
    s_mov_b32 s54, 0x2400
    s_mov_b32 s55, 0x00020000
    buffer_load_ushort v40, v7, s[52:55], s100 offen
    s_lshr_b32 s56, s64, 1
    s_and_b32 s57, s3, 3
    s_cmp_lg_u32 s56, s57
    s_cselect_b64 exec, 0, -1
    s_mov_b32 s48, s16
    s_and_b32 s49, s17, 0xffff
    s_mov_b32 s50, 0x480
    s_mov_b32 s51, 0x00020000
    buffer_load_dwordx2 v[48:49], v3, s[48:51], 0 offen
    buffer_load_dwordx2 v[50:51], v3, s[48:51], 0 offen offset:512
    buffer_load_dword v34, v4, s[48:51], 0 offen
    s_mov_b32 s48, s28
    s_and_b32 s49, s29, 0xffff
    s_mov_b32 s50, 0x2400
    s_mov_b32 s51, 0x00020000
    buffer_load_ushort v39, v7, s[48:51], s100 offen nt
    s_mov_b64 exec, -1
    s_memrealtime s[8:9]
    s_waitcnt vmcnt(13)
    s_waitcnt lgkmcnt(0)
    s_sub_u32 s8, s8, s30
    s_cmpk_ge_u32 s8, 1756
    s_cbranch_scc1 .ap_85
    s_waitcnt vmcnt(10)
    s_cmpk_ge_u32 s8, 1656
    s_cbranch_scc1 .ap_85
    s_waitcnt vmcnt(8)
    s_bitcmp1_b64 s[14:15], 45
    s_cbranch_scc0 1
    s_waitcnt vmcnt(7)
    s_cmpk_ge_u32 s8, 1536
    s_cbranch_scc1 .ap_85
    s_waitcnt vmcnt(6)
.ap_85:
    s_add_u32 s63, s69, 172032
    buffer_load_dwordx4 v[212:215], v1, s[44:47], s63 offen nt
    s_memrealtime s[8:9]
    s_waitcnt vmcnt(13)
    s_waitcnt lgkmcnt(0)
    s_sub_u32 s8, s8, s30
    s_cmpk_ge_u32 s8, 1788
    s_cbranch_scc1 .ap_86
    s_waitcnt vmcnt(10)
    s_cmpk_ge_u32 s8, 1688
    s_cbranch_scc1 .ap_86
    s_waitcnt vmcnt(8)
    s_bitcmp1_b64 s[14:15], 46
    s_cbranch_scc0 1
    s_waitcnt vmcnt(7)
    s_cmpk_ge_u32 s8, 1568
    s_cbranch_scc1 .ap_86
    s_waitcnt vmcnt(6)
.ap_86:
    s_add_u32 s63, s69, 180224
    buffer_load_dwordx4 v[216:219], v1, s[44:47], s63 offen nt
    s_memrealtime s[8:9]
    s_waitcnt vmcnt(13)
    s_waitcnt lgkmcnt(0)
    s_sub_u32 s8, s8, s30
    s_cmpk_ge_u32 s8, 1820
    s_cbranch_scc1 .ap_87
    s_branch .Lsk_m1_3
.Lst_m1_3:
    s_branch .Lrt_m1_3
.Lsk_m1_3:
    s_waitcnt vmcnt(10)
    s_cmpk_ge_u32 s8, 1720
    s_cbranch_scc1 .ap_87
    s_waitcnt vmcnt(8)
    s_bitcmp1_b64 s[14:15], 47
    s_cbranch_scc0 1
    s_waitcnt vmcnt(7)
    s_cmpk_ge_u32 s8, 1600
    s_cbranch_scc1 .ap_87
    s_waitcnt vmcnt(1)
.ap_87:
    s_add_u32 s63, s69, 188416
    buffer_load_dwordx4 v[220:223], v1, s[44:47], s63 offen nt
    s_memrealtime s[8:9]
    s_waitcnt vmcnt(13)
    s_waitcnt lgkmcnt(0)
    s_sub_u32 s8, s8, s30
    s_cmpk_ge_u32 s8, 1852
    s_cbranch_scc1 .ap_88
    s_waitcnt vmcnt(10)
    s_cmpk_ge_u32 s8, 1752
    s_cbranch_scc1 .ap_88
    s_waitcnt vmcnt(8)
    s_bitcmp1_b64 s[14:15], 48
    s_cbranch_scc0 1
    s_waitcnt vmcnt(2)
    s_cmpk_ge_u32 s8, 1632
    s_cbranch_scc1 .ap_88
    s_waitcnt vmcnt(1)
.ap_88:
    s_add_u32 s63, s69, 262144
    buffer_load_dwordx4 v[224:227], v1, s[44:47], s63 offen nt
    s_memrealtime s[8:9]
    s_waitcnt vmcnt(13)
    s_waitcnt lgkmcnt(0)
    s_sub_u32 s8, s8, s30
    s_cmpk_ge_u32 s8, 1884
    s_cbranch_scc1 .ap_89
    s_waitcnt vmcnt(10)
    s_cmpk_ge_u32 s8, 1784
    s_cbranch_scc1 .ap_89
    s_waitcnt vmcnt(3)
    s_bitcmp1_b64 s[14:15], 49
    s_cbranch_scc0 1
    s_waitcnt vmcnt(2)
    s_cmpk_ge_u32 s8, 1664
    s_cbranch_scc1 .ap_89
    s_waitcnt vmcnt(1)
.ap_89:
    s_add_u32 s63, s69, 270336
    buffer_load_dwordx4 v[228:231], v1, s[44:47], s63 offen nt
    s_memrealtime s[8:9]
    s_waitcnt vmcnt(13)
    s_waitcnt lgkmcnt(0)
    s_sub_u32 s8, s8, s30
    s_cmpk_ge_u32 s8, 1916
    s_cbranch_scc1 .ap_90
    s_waitcnt vmcnt(10)
    s_cmpk_ge_u32 s8, 1816
    s_cbranch_scc1 .ap_90
    s_waitcnt vmcnt(3)
    s_bitcmp1_b64 s[14:15], 50
    s_cbranch_scc0 1
    s_waitcnt vmcnt(2)
    s_cmpk_ge_u32 s8, 1696
    s_cbranch_scc1 .ap_90
    s_waitcnt vmcnt(1)
.ap_90:
    s_add_u32 s63, s69, 278528
    buffer_load_dwordx4 v[232:235], v1, s[44:47], s63 offen nt
    s_memrealtime s[8:9]
    s_waitcnt vmcnt(13)
    s_waitcnt lgkmcnt(0)
    s_sub_u32 s8, s8, s30
    s_cmpk_ge_u32 s8, 1948
    s_cbranch_scc1 .ap_91
    s_waitcnt vmcnt(5)
    s_cmpk_ge_u32 s8, 1848
    s_cbranch_scc1 .ap_91
    s_waitcnt vmcnt(3)
    s_bitcmp1_b64 s[14:15], 51
    s_cbranch_scc0 1
    s_waitcnt vmcnt(2)
    s_cmpk_ge_u32 s8, 1728
    s_cbranch_scc1 .ap_91
    s_waitcnt vmcnt(1)
.ap_91:
    s_add_u32 s63, s69, 286720
    buffer_load_dwordx4 v[236:239], v1, s[44:47], s63 offen nt
    s_memrealtime s[8:9]
    s_waitcnt vmcnt(13)
    s_waitcnt lgkmcnt(0)
    s_sub_u32 s8, s8, s30
    s_cmpk_ge_u32 s8, 1980
    s_cbranch_scc1 .ap_92
    s_waitcnt vmcnt(5)
    s_cmpk_ge_u32 s8, 1880
    s_cbranch_scc1 .ap_92
    s_waitcnt vmcnt(3)
    s_bitcmp1_b64 s[14:15], 52
    s_cbranch_scc0 1
    s_waitcnt vmcnt(2)
    s_cmpk_ge_u32 s8, 1760
    s_cbranch_scc1 .ap_92
    s_waitcnt vmcnt(1)
.ap_92:
    s_add_u32 s63, s69, 294912
    buffer_load_dwordx4 v[240:243], v1, s[44:47], s63 offen nt
    s_memrealtime s[8:9]
    s_waitcnt vmcnt(13)
    s_waitcnt lgkmcnt(0)
    s_sub_u32 s8, s8, s30
    s_cmpk_ge_u32 s8, 2012
    s_cbranch_scc1 .ap_93
    s_waitcnt vmcnt(5)
    s_cmpk_ge_u32 s8, 1912
    s_cbranch_scc1 .ap_93
    s_waitcnt vmcnt(3)
    s_bitcmp1_b64 s[14:15], 53
    s_cbranch_scc0 1
    s_waitcnt vmcnt(2)
    s_cmpk_ge_u32 s8, 1792
    s_cbranch_scc1 .ap_93
    s_waitcnt vmcnt(1)
.ap_93:
    s_add_u32 s63, s69, 303104
    buffer_load_dwordx4 v[244:247], v1, s[44:47], s63 offen nt
    s_and_b32 s0, s0, 0xffffff80
    s_sub_u32 s0, s0, 1024
    buffer_load_dword v28, v4, s[36:39], s0 offen sc1
    buffer_load_dwordx4 v[24:27], v9, s[36:39], s59 offen offset:0 sc1
    s_memrealtime s[8:9]
    s_waitcnt vmcnt(9)
    s_waitcnt lgkmcnt(0)
    s_sub_u32 s8, s8, s30
    s_cmpk_ge_u32 s8, 2044
    s_cbranch_scc1 .ap_94
    s_waitcnt vmcnt(6)
    s_cmpk_ge_u32 s8, 1944
    s_cbranch_scc1 .ap_94
    s_waitcnt vmcnt(4)
    s_bitcmp1_b64 s[14:15], 54
    s_cbranch_scc0 1
    s_waitcnt vmcnt(3)
    s_cmpk_ge_u32 s8, 1824
    s_cbranch_scc1 .ap_94
    s_waitcnt vmcnt(2)
.ap_94:
    s_add_u32 s63, s69, 311296
    buffer_load_dwordx4 v[248:251], v1, s[44:47], s63 offen nt
    s_memrealtime s[8:9]
    s_waitcnt vmcnt(9)
    s_waitcnt lgkmcnt(0)
    s_sub_u32 s8, s8, s30
    s_cmpk_ge_u32 s8, 2076
    s_cbranch_scc1 .ap_95
    s_waitcnt vmcnt(6)
    s_cmpk_ge_u32 s8, 1976
    s_cbranch_scc1 .ap_95
    s_waitcnt vmcnt(4)
    s_bitcmp1_b64 s[14:15], 55
    s_cbranch_scc0 1
    s_waitcnt vmcnt(3)
    s_cmpk_ge_u32 s8, 1856
    s_cbranch_scc1 .ap_95
    s_waitcnt vmcnt(1)
.ap_95:
    s_add_u32 s63, s69, 319488
    buffer_load_dwordx4 v[252:255], v1, s[44:47], s63 offen nt
    s_memrealtime s[8:9]
    s_waitcnt vmcnt(9)
    s_waitcnt lgkmcnt(0)
    s_sub_u32 s8, s8, s30
    s_cmpk_ge_u32 s8, 2108
    s_cbranch_scc1 .ap_96
    s_waitcnt vmcnt(6)
    s_cmpk_ge_u32 s8, 2008
    s_cbranch_scc1 .ap_96
    s_waitcnt vmcnt(4)
    s_bitcmp1_b64 s[14:15], 56
    s_cbranch_scc0 1
    s_waitcnt vmcnt(2)
    s_cmpk_ge_u32 s8, 1888
    s_cbranch_scc1 .ap_96
    s_branch .Lsk_m1_4
.Lst_m1_4:
    s_branch .Lrt_m1_4
.Lsk_m1_4:
    s_waitcnt vmcnt(1)
.ap_96:
    s_add_u32 s63, s69, 393216
    buffer_load_dwordx4 v[36:39], v1, s[44:47], s63 offen nt
    s_memrealtime s[8:9]
    s_waitcnt vmcnt(9)
    s_waitcnt lgkmcnt(0)
    s_sub_u32 s8, s8, s30
    s_cmpk_ge_u32 s8, 2140
    s_cbranch_scc1 .ap_97
    s_waitcnt vmcnt(6)
    s_cmpk_ge_u32 s8, 2040
    s_cbranch_scc1 .ap_97
    s_waitcnt vmcnt(3)
    s_bitcmp1_b64 s[14:15], 57
    s_cbranch_scc0 1
    s_waitcnt vmcnt(2)
    s_cmpk_ge_u32 s8, 1920
    s_cbranch_scc1 .ap_97
    s_waitcnt vmcnt(1)
.ap_97:
    s_add_u32 s63, s69, 401408
    buffer_load_dwordx4 v[44:47], v1, s[44:47], s63 offen nt
    s_memrealtime s[8:9]
    s_waitcnt vmcnt(9)
    s_waitcnt lgkmcnt(0)
    s_sub_u32 s8, s8, s30
    s_cmpk_ge_u32 s8, 2172
    s_cbranch_scc1 .ap_98
    s_waitcnt vmcnt(6)
    s_cmpk_ge_u32 s8, 2072
    s_cbranch_scc1 .ap_98
    s_waitcnt vmcnt(3)
    s_bitcmp1_b64 s[14:15], 58
    s_cbranch_scc0 1
    s_waitcnt vmcnt(2)
    s_cmpk_ge_u32 s8, 1952
    s_cbranch_scc1 .ap_98
    s_waitcnt vmcnt(1)
.ap_98:
    s_add_u32 s63, s69, 409600
    buffer_load_dwordx4 v[52:55], v1, s[44:47], s63 offen nt
    s_waitcnt vmcnt(5)
    s_branch .gpc_100
.gp_99:
    buffer_load_dwordx4 v[24:27], v9, s[36:39], s59 offen offset:0 sc1
    s_waitcnt vmcnt(0)
.gpc_100:
    v_cmp_eq_u32 vcc, s34, v26
    s_cmp_eq_u64 vcc, -1
    s_nop 3
    s_cbranch_scc1 .gpd_101
    s_sub_u32 s35, s35, 1
    s_cbranch_scc1 .Lexit
    s_sleep 1
    s_branch .gp_99
.gpd_101:
    v_cmp_eq_u32 vcc, s1, v28
    s_cmp_eq_u64 vcc, -1
    s_cselect_b32 s0, 0x800000, 0
    v_mov_b32 v16, v24
    s_nop 1
    v_max_f32_dpp v16, v16, v16 row_ror:4 row_mask:0xf bank_mask:0xf
    v_sub_f32 v17, v24, v16
    v_sub_f32 v18, v14, v16
    v_mul_f32 v17, 0x3fb8aa3b, v17
    v_mul_f32 v18, 0x3fb8aa3b, v18
    v_exp_f32 v17, v17
    v_exp_f32 v18, v18
    v_mul_f32 v17, v17, v25
    s_nop 1
    v_add_f32_dpp v17, v17, v17 row_ror:4 row_mask:0xf bank_mask:0xf
    v_rcp_f32 v19, v17
    s_nop 0
    v_fma_f32 v15, -v17, v19, 1.0
    v_fma_f32 v19, v15, v19, v19
    v_mul_f32 v18, v18, v19
    v_mul_f32 v10, v10, v18
    v_mul_f32 v11, v11, v18
    v_mul_f32 v12, v12, v18
    v_mul_f32 v13, v13, v18
    v_mov_b32_dpp v112, v10 quad_perm:[2,3,0,1] row_mask:0xf bank_mask:0xf
    v_mov_b32_dpp v113, v11 quad_perm:[2,3,0,1] row_mask:0xf bank_mask:0xf
    v_mov_b32_dpp v114, v12 quad_perm:[2,3,0,1] row_mask:0xf bank_mask:0xf
    v_mov_b32_dpp v115, v13 quad_perm:[2,3,0,1] row_mask:0xf bank_mask:0xf
    v_cvt_pk_bf16_f32 v96, v10, v112
    v_cvt_pk_bf16_f32 v100, v11, v113
    v_cvt_pk_bf16_f32 v104, v12, v114
    v_cvt_pk_bf16_f32 v108, v13, v115
    v_mov_b32_dpp v97, v96 row_ror:12 row_mask:0xf bank_mask:0xf
    v_mov_b32_dpp v101, v100 row_ror:12 row_mask:0xf bank_mask:0xf
    v_mov_b32_dpp v105, v104 row_ror:12 row_mask:0xf bank_mask:0xf
    v_mov_b32_dpp v109, v108 row_ror:12 row_mask:0xf bank_mask:0xf
    v_mov_b32_dpp v98, v96 row_ror:8 row_mask:0xf bank_mask:0xf
    v_mov_b32_dpp v102, v100 row_ror:8 row_mask:0xf bank_mask:0xf
    v_mov_b32_dpp v106, v104 row_ror:8 row_mask:0xf bank_mask:0xf
    v_mov_b32_dpp v110, v108 row_ror:8 row_mask:0xf bank_mask:0xf
    v_mov_b32_dpp v99, v96 row_ror:4 row_mask:0xf bank_mask:0xf
    v_mov_b32_dpp v103, v100 row_ror:4 row_mask:0xf bank_mask:0xf
    v_mov_b32_dpp v107, v104 row_ror:4 row_mask:0xf bank_mask:0xf
    v_mov_b32_dpp v111, v108 row_ror:4 row_mask:0xf bank_mask:0xf
    s_lshl_b32 s60, s3, 10
    s_add_u32 s60, s60, 147456
    v_lshlrev_b32 v10, 5, v0
    v_add_u32 v10, s60, v10
    s_memrealtime s[8:9]
    s_waitcnt lgkmcnt(0)
    s_sub_u32 s8, s8, s30
    s_cmpk_ge_u32 s8, 2204
    s_cbranch_scc1 .ap_102
    s_waitcnt vmcnt(5)
    s_cmpk_ge_u32 s8, 2104
    s_cbranch_scc1 .ap_102
    s_waitcnt vmcnt(3)
    s_bitcmp1_b64 s[14:15], 59
    s_cbranch_scc0 1
    s_waitcnt vmcnt(2)
    s_cmpk_ge_u32 s8, 1984
    s_cbranch_scc1 .ap_102
    s_waitcnt vmcnt(1)
.ap_102:
    s_add_u32 s63, s69, 417792
    buffer_load_dwordx4 v[60:63], v1, s[44:47], s63 offen nt
    v_perm_b32 v112, v164, v160, s94
    v_perm_b32 v113, v172, v168, s94
    v_perm_b32 v114, v180, v176, s94
    v_perm_b32 v115, v188, v184, s94
    s_nop 1
    v_mfma_f32_16x16x32_bf16 v[128:131], v[96:99], v[112:115], 0
    v_perm_b32 v116, v164, v160, s95
    v_perm_b32 v117, v172, v168, s95
    v_perm_b32 v118, v180, v176, s95
    v_perm_b32 v119, v188, v184, s95
    s_nop 1
    v_mfma_f32_16x16x32_bf16 v[132:135], v[96:99], v[116:119], 0
    v_perm_b32 v120, v165, v161, s94
    v_perm_b32 v121, v173, v169, s94
    v_perm_b32 v122, v181, v177, s94
    v_perm_b32 v123, v189, v185, s94
    s_nop 1
    v_mfma_f32_16x16x32_bf16 v[136:139], v[96:99], v[120:123], 0
    v_perm_b32 v124, v165, v161, s95
    v_perm_b32 v125, v173, v169, s95
    v_perm_b32 v126, v181, v177, s95
    v_perm_b32 v127, v189, v185, s95
    s_nop 1
    v_mfma_f32_16x16x32_bf16 v[140:143], v[96:99], v[124:127], 0
    v_perm_b32 v112, v166, v162, s94
    v_perm_b32 v113, v174, v170, s94
    v_perm_b32 v114, v182, v178, s94
    v_perm_b32 v115, v190, v186, s94
    s_nop 1
    v_mfma_f32_16x16x32_bf16 v[144:147], v[96:99], v[112:115], 0
    v_perm_b32 v116, v166, v162, s95
    v_perm_b32 v117, v174, v170, s95
    v_perm_b32 v118, v182, v178, s95
    v_perm_b32 v119, v190, v186, s95
    s_nop 1
    v_mfma_f32_16x16x32_bf16 v[148:151], v[96:99], v[116:119], 0
    v_perm_b32 v120, v167, v163, s94
    v_perm_b32 v121, v175, v171, s94
    v_perm_b32 v122, v183, v179, s94
    v_perm_b32 v123, v191, v187, s94
    s_nop 1
    v_mfma_f32_16x16x32_bf16 v[152:155], v[96:99], v[120:123], 0
    v_perm_b32 v124, v167, v163, s95
    v_perm_b32 v125, v175, v171, s95
    v_perm_b32 v126, v183, v179, s95
    v_perm_b32 v127, v191, v187, s95
    s_nop 1
    v_mfma_f32_16x16x32_bf16 v[156:159], v[96:99], v[124:127], 0
    s_memrealtime s[8:9]
    s_waitcnt lgkmcnt(0)
    s_sub_u32 s8, s8, s30
    s_cmpk_ge_u32 s8, 2236
    s_nop 3
    s_cbranch_scc1 .ap_103
    s_waitcnt vmcnt(5)
    s_cmpk_ge_u32 s8, 2136
    s_cbranch_scc1 .ap_103
    s_waitcnt vmcnt(3)
    s_bitcmp1_b64 s[14:15], 60
    s_cbranch_scc0 1
    s_waitcnt vmcnt(2)
    s_cmpk_ge_u32 s8, 2016
    s_cbranch_scc1 .ap_103
    s_waitcnt vmcnt(1)
.ap_103:
    s_add_u32 s63, s69, 425984
    buffer_load_dwordx4 v[68:71], v1, s[44:47], s63 offen nt
    v_perm_b32 v112, v196, v192, s94
    v_perm_b32 v113, v204, v200, s94
    s_branch .Lsk_m1_5
.Lst_m1_5:
    s_branch .Lrt_m1_5
.Lsk_m1_5:
    v_perm_b32 v114, v212, v208, s94
    v_perm_b32 v115, v220, v216, s94
    s_nop 1
    v_mfma_f32_16x16x32_bf16 v[128:131], v[100:103], v[112:115], v[128:131]
    v_perm_b32 v116, v196, v192, s95
    v_perm_b32 v117, v204, v200, s95
    v_perm_b32 v118, v212, v208, s95
    v_perm_b32 v119, v220, v216, s95
    s_nop 1
    v_mfma_f32_16x16x32_bf16 v[132:135], v[100:103], v[116:119], v[132:135]
    v_perm_b32 v120, v197, v193, s94
    v_perm_b32 v121, v205, v201, s94
    v_perm_b32 v122, v213, v209, s94
    v_perm_b32 v123, v221, v217, s94
    s_nop 1
    v_mfma_f32_16x16x32_bf16 v[136:139], v[100:103], v[120:123], v[136:139]
    v_perm_b32 v124, v197, v193, s95
    v_perm_b32 v125, v205, v201, s95
    v_perm_b32 v126, v213, v209, s95
    v_perm_b32 v127, v221, v217, s95
    s_nop 1
    v_mfma_f32_16x16x32_bf16 v[140:143], v[100:103], v[124:127], v[140:143]
    v_perm_b32 v112, v198, v194, s94
    v_perm_b32 v113, v206, v202, s94
    v_perm_b32 v114, v214, v210, s94
    v_perm_b32 v115, v222, v218, s94
    s_nop 1
    v_mfma_f32_16x16x32_bf16 v[144:147], v[100:103], v[112:115], v[144:147]
    v_perm_b32 v116, v198, v194, s95
    v_perm_b32 v117, v206, v202, s95
    v_perm_b32 v118, v214, v210, s95
    v_perm_b32 v119, v222, v218, s95
    s_nop 1
    v_mfma_f32_16x16x32_bf16 v[148:151], v[100:103], v[116:119], v[148:151]
    v_perm_b32 v120, v199, v195, s94
    v_perm_b32 v121, v207, v203, s94
    v_perm_b32 v122, v215, v211, s94
    v_perm_b32 v123, v223, v219, s94
    s_nop 1
    v_mfma_f32_16x16x32_bf16 v[152:155], v[100:103], v[120:123], v[152:155]
    v_perm_b32 v124, v199, v195, s95
    v_perm_b32 v125, v207, v203, s95
    v_perm_b32 v126, v215, v211, s95
    v_perm_b32 v127, v223, v219, s95
    s_nop 1
    v_mfma_f32_16x16x32_bf16 v[156:159], v[100:103], v[124:127], v[156:159]
    s_memrealtime s[8:9]
    s_waitcnt lgkmcnt(0)
    s_sub_u32 s8, s8, s30
    s_cmpk_ge_u32 s8, 2268
    s_nop 3
    s_cbranch_scc1 .ap_104
    s_waitcnt vmcnt(5)
    s_cmpk_ge_u32 s8, 2168
    s_cbranch_scc1 .ap_104
    s_waitcnt vmcnt(3)
    s_bitcmp1_b64 s[14:15], 61
    s_cbranch_scc0 1
    s_waitcnt vmcnt(2)
    s_cmpk_ge_u32 s8, 2048
    s_cbranch_scc1 .ap_104
    s_waitcnt vmcnt(1)
.ap_104:
    s_add_u32 s63, s69, 434176
    buffer_load_dwordx4 v[76:79], v1, s[44:47], s63 offen nt
    s_waitcnt vmcnt(6)
    v_perm_b32 v112, v228, v224, s94
    v_perm_b32 v113, v236, v232, s94
    v_perm_b32 v114, v244, v240, s94
    v_perm_b32 v115, v252, v248, s94
    s_nop 1
    v_mfma_f32_16x16x32_bf16 v[128:131], v[104:107], v[112:115], v[128:131]
    v_perm_b32 v116, v228, v224, s95
    v_perm_b32 v117, v236, v232, s95
    v_perm_b32 v118, v244, v240, s95
    v_perm_b32 v119, v252, v248, s95
    s_nop 1
    v_mfma_f32_16x16x32_bf16 v[132:135], v[104:107], v[116:119], v[132:135]
    v_perm_b32 v120, v229, v225, s94
    v_perm_b32 v121, v237, v233, s94
    v_perm_b32 v122, v245, v241, s94
    v_perm_b32 v123, v253, v249, s94
    s_nop 1
    v_mfma_f32_16x16x32_bf16 v[136:139], v[104:107], v[120:123], v[136:139]
    v_perm_b32 v124, v229, v225, s95
    v_perm_b32 v125, v237, v233, s95
    v_perm_b32 v126, v245, v241, s95
    v_perm_b32 v127, v253, v249, s95
    s_nop 1
    v_mfma_f32_16x16x32_bf16 v[140:143], v[104:107], v[124:127], v[140:143]
    v_perm_b32 v112, v230, v226, s94
    v_perm_b32 v113, v238, v234, s94
    v_perm_b32 v114, v246, v242, s94
    v_perm_b32 v115, v254, v250, s94
    s_nop 1
    v_mfma_f32_16x16x32_bf16 v[144:147], v[104:107], v[112:115], v[144:147]
    v_perm_b32 v116, v230, v226, s95
    v_perm_b32 v117, v238, v234, s95
    v_perm_b32 v118, v246, v242, s95
    v_perm_b32 v119, v254, v250, s95
    s_nop 1
    v_mfma_f32_16x16x32_bf16 v[148:151], v[104:107], v[116:119], v[148:151]
    v_perm_b32 v120, v231, v227, s94
    v_perm_b32 v121, v239, v235, s94
    v_perm_b32 v122, v247, v243, s94
    v_perm_b32 v123, v255, v251, s94
    s_nop 1
    v_mfma_f32_16x16x32_bf16 v[152:155], v[104:107], v[120:123], v[152:155]
    v_perm_b32 v124, v231, v227, s95
    v_perm_b32 v125, v239, v235, s95
    v_perm_b32 v126, v247, v243, s95
    v_perm_b32 v127, v255, v251, s95
    s_nop 1
    v_mfma_f32_16x16x32_bf16 v[156:159], v[104:107], v[124:127], v[156:159]
    s_memrealtime s[8:9]
    s_waitcnt lgkmcnt(0)
    s_sub_u32 s8, s8, s30
    s_cmpk_ge_u32 s8, 2300
    s_nop 3
    s_cbranch_scc1 .ap_105
    s_waitcnt vmcnt(5)
    s_cmpk_ge_u32 s8, 2200
    s_cbranch_scc1 .ap_105
    s_waitcnt vmcnt(3)
    s_bitcmp1_b64 s[14:15], 62
    s_cbranch_scc0 1
    s_waitcnt vmcnt(2)
    s_cmpk_ge_u32 s8, 2080
    s_cbranch_scc1 .ap_105
    s_waitcnt vmcnt(1)
.ap_105:
    s_add_u32 s63, s69, 442368
    buffer_load_dwordx4 v[84:87], v1, s[44:47], s63 offen nt
    s_memrealtime s[8:9]
    s_waitcnt lgkmcnt(0)
    s_sub_u32 s8, s8, s30
    s_cmpk_ge_u32 s8, 2332
    s_cbranch_scc1 .ap_106
    s_waitcnt vmcnt(5)
    s_cmpk_ge_u32 s8, 2232
    s_cbranch_scc1 .ap_106
    s_waitcnt vmcnt(3)
    s_bitcmp1_b64 s[14:15], 63
    s_cbranch_scc0 1
    s_waitcnt vmcnt(2)
    s_cmpk_ge_u32 s8, 2112
    s_cbranch_scc1 .ap_106
    s_waitcnt vmcnt(1)
.ap_106:
    s_add_u32 s63, s69, 450560
    buffer_load_dwordx4 v[92:95], v1, s[44:47], s63 offen nt
    s_setprio 0
    s_waitcnt vmcnt(6)
    v_perm_b32 v160, v44, v36, s94
    v_perm_b32 v164, v44, v36, s95
    v_perm_b32 v168, v45, v37, s94
    v_perm_b32 v172, v45, v37, s95
    v_perm_b32 v176, v46, v38, s94
    v_perm_b32 v180, v46, v38, s95
    v_perm_b32 v184, v47, v39, s94
    v_perm_b32 v188, v47, v39, s95
    s_waitcnt vmcnt(4)
    v_perm_b32 v161, v60, v52, s94
    v_perm_b32 v165, v60, v52, s95
    v_perm_b32 v169, v61, v53, s94
    v_perm_b32 v173, v61, v53, s95
    v_perm_b32 v177, v62, v54, s94
    v_perm_b32 v181, v62, v54, s95
    v_perm_b32 v185, v63, v55, s94
    v_perm_b32 v189, v63, v55, s95
    s_branch .Lsk_m1_6
.Lst_m1_6:
    s_branch .Lrt_m1_6
.Lsk_m1_6:
    s_waitcnt vmcnt(2)
    v_perm_b32 v162, v76, v68, s94
    v_perm_b32 v166, v76, v68, s95
    v_perm_b32 v170, v77, v69, s94
    v_perm_b32 v174, v77, v69, s95
    v_perm_b32 v178, v78, v70, s94
    v_perm_b32 v182, v78, v70, s95
    v_perm_b32 v186, v79, v71, s94
    v_perm_b32 v190, v79, v71, s95
    s_waitcnt vmcnt(0)
    v_perm_b32 v163, v92, v84, s94
    v_perm_b32 v167, v92, v84, s95
    v_perm_b32 v171, v93, v85, s94
    v_mfma_f32_16x16x32_bf16 v[128:131], v[108:111], v[160:163], v[128:131]
    v_perm_b32 v175, v93, v85, s95
    v_mfma_f32_16x16x32_bf16 v[132:135], v[108:111], v[164:167], v[132:135]
    v_perm_b32 v179, v94, v86, s94
    v_mfma_f32_16x16x32_bf16 v[136:139], v[108:111], v[168:171], v[136:139]
    v_perm_b32 v183, v94, v86, s95
    v_mfma_f32_16x16x32_bf16 v[140:143], v[108:111], v[172:175], v[140:143]
    v_perm_b32 v187, v95, v87, s94
    v_mfma_f32_16x16x32_bf16 v[144:147], v[108:111], v[176:179], v[144:147]
    v_perm_b32 v191, v95, v87, s95
    v_mfma_f32_16x16x32_bf16 v[148:151], v[108:111], v[180:183], v[148:151]
    v_mfma_f32_16x16x32_bf16 v[152:155], v[108:111], v[184:187], v[152:155]
    v_mfma_f32_16x16x32_bf16 v[156:159], v[108:111], v[188:191], v[156:159]
    s_mov_b64 exec, 0xffff
    ds_write2_b32 v10, v128, v129 offset0:0 offset1:128
    ds_write2_b32 v10, v132, v133 offset0:1 offset1:129
    ds_write2_b32 v10, v136, v137 offset0:2 offset1:130
    ds_write2_b32 v10, v140, v141 offset0:3 offset1:131
    ds_write2_b32 v10, v144, v145 offset0:4 offset1:132
    ds_write2_b32 v10, v148, v149 offset0:5 offset1:133
    ds_write2_b32 v10, v152, v153 offset0:6 offset1:134
    ds_write2_b32 v10, v156, v157 offset0:7 offset1:135
    s_mov_b64 exec, -1
    s_waitcnt lgkmcnt(0)
    s_barrier
    s_cmp_lg_u32 s3, 7
    s_cbranch_scc1 .opub_107
    v_add_u32 v10, 147456, v2
    ds_read_b128 v[196:199], v10 offset:0
    ds_read_b128 v[200:203], v10 offset:1024
    ds_read_b128 v[204:207], v10 offset:2048
    ds_read_b128 v[208:211], v10 offset:3072
    ds_read_b128 v[212:215], v10 offset:4096
    ds_read_b128 v[216:219], v10 offset:5120
    ds_read_b128 v[220:223], v10 offset:6144
    ds_read_b128 v[224:227], v10 offset:7168
    v_lshrrev_b32 v11, 5, v0
    v_lshlrev_b32 v11, 13, v11
    v_and_b32 v12, 31, v0
    v_lshl_add_u32 v11, v12, 4, v11
    s_lshl4_add_u32 s56, s67, s66
    s_lshl1_add_u32 s56, s56, s68
    s_lshl_b32 s56, s56, 9
    s_add_u32 s56, s56, 0xa0000
    s_mov_b32 s60, 0x07060503
    s_mov_b32 s61, 0x07060502
    s_mov_b32 s62, 0x07060501
    v_mov_b32 v15, s34
    s_waitcnt lgkmcnt(6)
    v_pk_add_f32 v[196:197], v[196:197], v[200:201]
    v_pk_add_f32 v[198:199], v[198:199], v[202:203]
    s_waitcnt lgkmcnt(5)
    v_pk_add_f32 v[196:197], v[196:197], v[204:205]
    v_pk_add_f32 v[198:199], v[198:199], v[206:207]
    s_waitcnt lgkmcnt(4)
    v_pk_add_f32 v[196:197], v[196:197], v[208:209]
    v_pk_add_f32 v[198:199], v[198:199], v[210:211]
    s_waitcnt lgkmcnt(3)
    v_pk_add_f32 v[196:197], v[196:197], v[212:213]
    v_pk_add_f32 v[198:199], v[198:199], v[214:215]
    s_waitcnt lgkmcnt(2)
    v_pk_add_f32 v[196:197], v[196:197], v[216:217]
    v_pk_add_f32 v[198:199], v[198:199], v[218:219]
    s_waitcnt lgkmcnt(1)
    v_pk_add_f32 v[196:197], v[196:197], v[220:221]
    v_pk_add_f32 v[198:199], v[198:199], v[222:223]
    s_waitcnt lgkmcnt(0)
    v_pk_add_f32 v[196:197], v[196:197], v[224:225]
    v_pk_add_f32 v[198:199], v[198:199], v[226:227]
    v_perm_b32 v12, v196, v199, s60
    v_perm_b32 v13, v197, v199, s61
    v_perm_b32 v14, v198, v199, s62
    s_add_u32 s57, s56, 0x800000
    buffer_store_dwordx4 v[12:15], v11, s[36:39], s57 offen
    buffer_store_dwordx4 v[12:15], v11, s[36:39], s56 offen sc1
.opub_107:
    s_and_b32 s58, s64, 0
    s_mul_i32 s58, s58, 18432
    s_mul_i32 s59, s3, 2304
    s_add_u32 s58, s58, s59
    s_add_u32 s62, s58, 0x37000
    s_add_u32 s63, s58, 0x49000
    s_mul_i32 s101, s64, 18432
    s_add_u32 s101, s101, s59
    s_add_u32 s101, s101, 0x170000
    v_and_b32 v16, 8, v0
    v_and_b32 v17, 1, v0
    v_lshl_add_u32 v16, v17, 2, v16
    v_bfe_u32 v17, v0, 1, 2
    v_add_u32 v16, v16, v17
    v_lshlrev_b32 v9, 4, v16
    s_lshl_b32 s56, s65, 8
    s_add_u32 s58, s58, s56
    s_add_u32 s58, s58, 0x25000
    s_add_u32 s99, s101, s56
    s_lshr_b32 s56, s64, 1
    s_and_b32 s57, s3, 3
    s_cmp_lg_u32 s56, s57
    s_cbranch_scc1 .Lr_ga
    s_add_u32 s59, s58, 73728
    s_add_u32 s60, s58, 147456
    s_add_u32 s61, s58, 221184
.gp_108:
    buffer_load_dwordx4 v[56:59], v2, s[36:39], s62 offen offset:0 sc1
    buffer_load_dwordx4 v[60:63], v2, s[36:39], s62 offen offset:1024 sc1
    buffer_load_dwordx2 v[64:65], v5, s[36:39], s62 offen offset:0 sc1
    buffer_load_dwordx4 v[66:69], v2, s[36:39], s63 offen offset:0 sc1
    buffer_load_dwordx4 v[70:73], v2, s[36:39], s63 offen offset:1024 sc1
    buffer_load_dwordx2 v[74:75], v5, s[36:39], s63 offen offset:0 sc1
    buffer_load_dwordx2 v[76:77], v8, s[36:39], s59 offen offset:0 sc1
    buffer_load_dwordx2 v[78:79], v8, s[36:39], s60 offen offset:0 sc1
    buffer_load_dwordx2 v[80:81], v8, s[36:39], s61 offen offset:0 sc1
    buffer_load_dwordx2 v[42:43], v8, s[36:39], s58 offen offset:0 sc1
    s_waitcnt vmcnt(0)
.gpc_109:
    v_min_u32 v24, v57, v59
    v_max_u32 v25, v57, v59
    v_min3_u32 v24, v24, v61, v63
    v_max3_u32 v25, v25, v61, v63
    v_min3_u32 v24, v24, v65, v67
    v_max3_u32 v25, v25, v65, v67
    v_min3_u32 v24, v24, v69, v71
    v_max3_u32 v25, v25, v69, v71
    v_min3_u32 v24, v24, v73, v75
    v_max3_u32 v25, v25, v73, v75
    v_min3_u32 v24, v24, v77, v79
    v_max3_u32 v25, v25, v77, v79
    v_min3_u32 v24, v24, v81, v43
    v_max3_u32 v25, v25, v81, v43
    v_cmp_eq_u32 vcc, s34, v24
    v_cmp_eq_u32 s[56:57], s34, v25
    s_and_b64 vcc, vcc, s[56:57]
    s_cmp_eq_u64 vcc, -1
    s_nop 2
    s_cbranch_scc1 .gpd_110
    s_sub_u32 s35, s35, 1
    s_cbranch_scc1 .Lexit
    s_sleep 2
    s_branch .gp_108
.gpd_110:
    v_and_b32 v57, 0xffff0000, v56
    v_lshlrev_b32 v56, 16, v56
    v_and_b32 v67, 0xffff0000, v66
    v_lshlrev_b32 v66, 16, v66
    v_and_b32 v59, 0xffff0000, v58
    v_lshlrev_b32 v58, 16, v58
    v_and_b32 v69, 0xffff0000, v68
    v_lshlrev_b32 v68, 16, v68
    v_and_b32 v61, 0xffff0000, v60
    v_lshlrev_b32 v60, 16, v60
    v_and_b32 v71, 0xffff0000, v70
    v_lshlrev_b32 v70, 16, v70
    v_and_b32 v63, 0xffff0000, v62
    s_branch .Lsk_m1_7
.Lst_m1_7:
    s_branch .Lrt_m1_7
.Lsk_m1_7:
    v_lshlrev_b32 v62, 16, v62
    v_and_b32 v73, 0xffff0000, v72
    v_lshlrev_b32 v72, 16, v72
    v_and_b32 v65, 0xffff0000, v64
    v_lshlrev_b32 v64, 16, v64
    v_and_b32 v75, 0xffff0000, v74
    v_lshlrev_b32 v74, 16, v74
    v_lshlrev_b32 v77, 16, v76
    v_and_b32 v76, 0xffff0000, v76
    s_mov_b32 vcc_lo, 0xffff0000
    s_mov_b32 vcc_hi, 0xffff0000
    v_cndmask_b32 v77, v77, v76, vcc
    v_lshlrev_b32 v79, 16, v78
    v_and_b32 v78, 0xffff0000, v78
    s_mov_b32 vcc_lo, 0xffff0000
    s_mov_b32 vcc_hi, 0xffff0000
    v_cndmask_b32 v79, v79, v78, vcc
    v_lshlrev_b32 v81, 16, v80
    v_and_b32 v80, 0xffff0000, v80
    s_mov_b32 vcc_lo, 0xffff0000
    s_mov_b32 vcc_hi, 0xffff0000
    v_cndmask_b32 v81, v81, v80, vcc
    s_nop 1
    s_branch .Lr_ga2
.Lr_ga:
.gp_111:
    buffer_load_dwordx2 v[42:43], v8, s[36:39], s58 offen offset:0 sc1
    s_waitcnt vmcnt(0)
.gpc_112:
    v_cmp_eq_u32 vcc, s34, v43
    s_cmp_eq_u64 vcc, -1
    s_nop 3
    s_cbranch_scc1 .gpd_113
    s_sub_u32 s35, s35, 1
    s_cbranch_scc1 .Lexit
    s_sleep 2
    s_branch .gp_111
.gpd_113:
.Lr_ga2:
    v_lshlrev_b32 v40, 16, v40
    v_lshlrev_b32 v41, 16, v42
    v_and_b32 v42, 0xffff0000, v42
    s_mov_b32 vcc_lo, 0xffff0000
    s_mov_b32 vcc_hi, 0xffff0000
    v_cndmask_b32 v41, v41, v42, vcc
    s_mul_i32 s59, s3, 9
    s_add_u32 s59, s59, s65
    s_lshl_b32 s59, s59, 12
    s_add_u32 s59, s59, 0xe0000
    s_mov_b32 s60, 0x04000c0c
    s_mov_b32 s61, 0x0706000c
    v_mov_b32 v45, s34
    v_mov_b32 v47, s34
.gp_114:
    buffer_load_dwordx4 v[16:19], v2, s[36:39], s59 offen offset:0 sc1
    buffer_load_dwordx4 v[20:23], v2, s[36:39], s59 offen offset:1024 sc1
    buffer_load_dwordx4 v[24:27], v2, s[36:39], s59 offen offset:2048 sc1
    buffer_load_dwordx4 v[28:31], v2, s[36:39], s59 offen offset:3072 sc1
    s_waitcnt vmcnt(0)
.gpc_115:
    v_min_u32 v32, v19, v23
    v_max_u32 v33, v19, v23
    v_min3_u32 v32, v32, v27, v31
    v_max3_u32 v33, v33, v27, v31
    v_cmp_eq_u32 vcc, s34, v32
    v_cmp_eq_u32 s[56:57], s34, v33
    s_and_b64 vcc, vcc, s[56:57]
    s_cmp_eq_u64 vcc, -1
    s_nop 2
    s_cbranch_scc1 .gpd_116
    s_sub_u32 s35, s35, 1
    s_cbranch_scc1 .Lexit
    s_branch .gp_114
.gpd_116:
    v_perm_b32 v19, v16, v17, s60
    v_perm_b32 v19, v19, v18, s61
    v_perm_b32 v23, v20, v21, s60
    v_perm_b32 v23, v23, v22, s61
    v_perm_b32 v27, v24, v25, s60
    v_perm_b32 v27, v27, v26, s61
    v_perm_b32 v31, v28, v29, s60
    v_perm_b32 v31, v31, v30, s61
    v_pk_add_f32 v[16:17], v[16:17], v[20:21]
    v_pk_add_f32 v[18:19], v[18:19], v[22:23]
    v_pk_add_f32 v[24:25], v[24:25], v[28:29]
    v_pk_add_f32 v[26:27], v[26:27], v[30:31]
    v_pk_add_f32 v[16:17], v[16:17], v[24:25]
    v_pk_add_f32 v[18:19], v[18:19], v[26:27]
    s_nop 1
    v_permlane32_swap_b32 v16, v18
    v_permlane32_swap_b32 v17, v19
    v_pk_add_f32 v[16:17], v[16:17], v[18:19]
    s_nop 1
    v_permlane16_swap_b32 v16, v17
    v_add_f32 v16, v16, v17
    v_cvt_pk_bf16_f32 v16, v16, v16
    v_lshlrev_b32 v16, 16, v16
    v_mul_f32 v16, v16, v41
    v_cvt_pk_bf16_f32 v16, v16, v16
    v_lshlrev_b32 v16, 16, v16
    v_add_f32 v17, v16, v40
    v_add_f32 v16, v16, v40
    v_mov_b32 v40, v16
    s_nop 0
    v_permlane16_swap_b32 v16, v17
    v_cvt_pk_bf16_f32 v44, v16, v17
    v_cvt_pk_bf16_f32 v46, v16, v17
    s_nop 1
    v_permlane32_swap_b32 v44, v46
    s_mov_b64 exec, 0xffff
    s_add_u32 s57, s99, 0x800000
    buffer_store_dwordx4 v[44:47], v9, s[36:39], s57 offen
    buffer_store_dwordx4 v[44:47], v9, s[36:39], s99 offen sc1
    s_mov_b64 exec, -1
    s_lshr_b32 s56, s64, 1
    s_and_b32 s57, s3, 3
    s_cmp_lg_u32 s56, s57
    s_cbranch_scc1 .Lexit
    v_cvt_pk_bf16_f32 v40, v40, v40
    v_lshlrev_b32 v40, 16, v40
    s_mov_b32 s69, 0
.gp_117:
    s_add_u32 s69, s69, 1
    s_and_b32 s56, s69, 0x41
    s_cmp_lg_u32 s56, 0x41
    s_cselect_b32 s56, s0, 0
    s_add_u32 s58, s101, s56
    buffer_load_dwordx4 v[84:87], v2, s[36:39], s58 offen offset:0 sc1
    buffer_load_dwordx4 v[88:91], v2, s[36:39], s58 offen offset:1024 sc1
    buffer_load_dwordx2 v[92:93], v5, s[36:39], s58 offen offset:0 sc1
    s_waitcnt vmcnt(0)
    v_min3_u32 v24, v85, v87, v89
    v_max3_u32 v25, v85, v87, v89
    v_min3_u32 v24, v24, v91, v93
    v_max3_u32 v25, v25, v91, v93
    v_cmp_eq_u32 vcc, s34, v24
    v_cmp_eq_u32 s[56:57], s34, v25
    s_and_b64 vcc, vcc, s[56:57]
    s_cmp_eq_u64 vcc, -1
    s_nop 2
    s_cbranch_scc1 .gpd_118
    s_sub_u32 s35, s35, 1
    s_cbranch_scc1 .Lexit
    s_sleep 1
    s_branch .gp_117
.gpd_118:
    s_mov_b32 s56, 0x3f803f80
    v_dot2_f32_bf16 v104, v84, s56, 0
    v_dot2_f32_bf16 v105, v84, v84, 0
    v_dot2_f32_bf16 v104, v86, s56, v104
    v_dot2_f32_bf16 v105, v86, v86, v105
    s_branch .Lsk_m2_0
.Lst_m2_0:
    s_branch .Lrt_m2_0
.Lsk_m2_0:
    v_dot2_f32_bf16 v104, v88, s56, v104
    v_dot2_f32_bf16 v105, v88, v88, v105
    v_dot2_f32_bf16 v104, v90, s56, v104
    v_dot2_f32_bf16 v105, v90, v90, v105
    s_mov_b64 exec, 0xffffffff
    v_dot2_f32_bf16 v104, v92, s56, v104
    v_dot2_f32_bf16 v105, v92, v92, v105
    s_mov_b64 exec, -1
    s_nop 1
    v_permlane32_swap_b32 v104, v105
    v_add_f32 v104, v104, v105
    v_mov_b32 v106, v104
    s_nop 1
    v_permlane16_swap_b32 v106, v104
    v_add_f32 v104, v106, v104
    v_lshlrev_b32 v94, 16, v84
    v_and_b32 v95, 0xffff0000, v84
    v_add_f32_dpp v104, v104, v104 row_ror:8 row_mask:0xf bank_mask:0xf
    v_lshlrev_b32 v96, 16, v86
    v_and_b32 v97, 0xffff0000, v86
    v_add_f32_dpp v104, v104, v104 row_ror:4 row_mask:0xf bank_mask:0xf
    v_lshlrev_b32 v98, 16, v88
    v_and_b32 v99, 0xffff0000, v88
    v_add_f32_dpp v104, v104, v104 quad_perm:[2,3,0,1] row_mask:0xf bank_mask:0xf
    v_lshlrev_b32 v100, 16, v90
    v_and_b32 v101, 0xffff0000, v90
    v_add_f32_dpp v104, v104, v104 quad_perm:[1,0,3,2] row_mask:0xf bank_mask:0xf
    v_mul_f32 v104, 0x3ae38e39, v104
    v_lshlrev_b32 v102, 16, v92
    v_and_b32 v103, 0xffff0000, v92
    v_readlane_b32 s56, v104, 0
    v_readlane_b32 s57, v104, 32
    s_nop 0
    v_mov_b32 v104, s56
    v_fma_f32 v105, -v104, v104, s57
    v_max_f32 v105, 0, v105
    v_cvt_pk_bf16_f32 v106, -v104, v105
    v_and_b32 v107, 0xffff0000, v106
    v_add_f32 v107, 0x3727c5ac, v107
    v_lshlrev_b32 v104, 16, v106
    v_cvt_pk_bf16_f32 v107, v107, v107
    v_lshlrev_b32 v107, 16, v107
    v_sqrt_f32 v107, v107
    v_mov_b32 v105, v104
    v_cvt_pk_bf16_f32 v107, v107, v107
    v_lshlrev_b32 v107, 16, v107
    v_rcp_f32 v106, v107
    v_rcp_f32 v107, v107
    v_pk_add_f32 v[94:95], v[94:95], v[104:105]
    v_pk_add_f32 v[96:97], v[96:97], v[104:105]
    v_pk_add_f32 v[98:99], v[98:99], v[104:105]
    v_pk_add_f32 v[100:101], v[100:101], v[104:105]
    v_pk_add_f32 v[102:103], v[102:103], v[104:105]
    v_cvt_pk_bf16_f32 v94, v94, v95
    v_and_b32 v95, 0xffff0000, v94
    v_lshlrev_b32 v94, 16, v94
    v_cvt_pk_bf16_f32 v96, v96, v97
    v_and_b32 v97, 0xffff0000, v96
    v_lshlrev_b32 v96, 16, v96
    v_cvt_pk_bf16_f32 v98, v98, v99
    v_and_b32 v99, 0xffff0000, v98
    v_lshlrev_b32 v98, 16, v98
    v_cvt_pk_bf16_f32 v100, v100, v101
    v_and_b32 v101, 0xffff0000, v100
    v_lshlrev_b32 v100, 16, v100
    v_cvt_pk_bf16_f32 v102, v102, v103
    v_and_b32 v103, 0xffff0000, v102
    v_lshlrev_b32 v102, 16, v102
    v_pk_mul_f32 v[94:95], v[94:95], v[106:107]
    v_pk_mul_f32 v[96:97], v[96:97], v[106:107]
    v_pk_mul_f32 v[98:99], v[98:99], v[106:107]
    v_pk_mul_f32 v[100:101], v[100:101], v[106:107]
    v_pk_mul_f32 v[102:103], v[102:103], v[106:107]
    v_cvt_pk_bf16_f32 v94, v94, v95
    v_and_b32 v95, 0xffff0000, v94
    v_lshlrev_b32 v94, 16, v94
    v_cvt_pk_bf16_f32 v96, v96, v97
    v_and_b32 v97, 0xffff0000, v96
    v_lshlrev_b32 v96, 16, v96
    v_cvt_pk_bf16_f32 v98, v98, v99
    v_and_b32 v99, 0xffff0000, v98
    v_lshlrev_b32 v98, 16, v98
    v_cvt_pk_bf16_f32 v100, v100, v101
    v_and_b32 v101, 0xffff0000, v100
    v_lshlrev_b32 v100, 16, v100
    v_cvt_pk_bf16_f32 v102, v102, v103
    v_and_b32 v103, 0xffff0000, v102
    v_lshlrev_b32 v102, 16, v102
    v_pk_mul_f32 v[94:95], v[94:95], v[66:67]
    v_pk_mul_f32 v[96:97], v[96:97], v[68:69]
    v_pk_mul_f32 v[98:99], v[98:99], v[70:71]
    v_pk_mul_f32 v[100:101], v[100:101], v[72:73]
    v_pk_mul_f32 v[102:103], v[102:103], v[74:75]
    v_cvt_pk_bf16_f32 v94, v94, v95
    v_and_b32 v95, 0xffff0000, v94
    v_lshlrev_b32 v94, 16, v94
    v_cvt_pk_bf16_f32 v96, v96, v97
    v_and_b32 v97, 0xffff0000, v96
    v_lshlrev_b32 v96, 16, v96
    v_cvt_pk_bf16_f32 v98, v98, v99
    v_and_b32 v99, 0xffff0000, v98
    v_lshlrev_b32 v98, 16, v98
    v_cvt_pk_bf16_f32 v100, v100, v101
    v_and_b32 v101, 0xffff0000, v100
    v_lshlrev_b32 v100, 16, v100
    v_cvt_pk_bf16_f32 v102, v102, v103
    v_and_b32 v103, 0xffff0000, v102
    v_lshlrev_b32 v102, 16, v102
    v_pk_add_f32 v[94:95], v[94:95], v[56:57]
    v_pk_add_f32 v[96:97], v[96:97], v[58:59]
    v_pk_add_f32 v[98:99], v[98:99], v[60:61]
    v_pk_add_f32 v[100:101], v[100:101], v[62:63]
    v_pk_add_f32 v[102:103], v[102:103], v[64:65]
    v_cvt_pk_bf16_f32 v110, v94, v95
    v_cvt_pk_bf16_f32 v111, v96, v97
    v_cvt_pk_bf16_f32 v112, v98, v99
    v_cvt_pk_bf16_f32 v113, v100, v101
    v_cvt_pk_bf16_f32 v114, v102, v103
    v_dot2_f32_bf16 v14, v110, v48, 0
    v_dot2_f32_bf16 v14, v111, v49, v14
    v_dot2_f32_bf16 v14, v112, v50, v14
    v_dot2_f32_bf16 v14, v113, v51, v14
    s_mov_b64 exec, 0xffffffff
    v_dot2_f32_bf16 v14, v114, v34, v14
    s_mov_b64 exec, -1
    s_nop 1
    v_mov_b32 v15, v14
    s_nop 1
    v_permlane32_swap_b32 v15, v14
    v_add_f32 v14, v15, v14
    v_mov_b32 v15, v14
    s_nop 1
    v_permlane16_swap_b32 v15, v14
    v_add_f32 v14, v15, v14
    s_nop 1
    v_add_f32_dpp v14, v14, v14 row_ror:8 row_mask:0xf bank_mask:0xf
    s_nop 1
    v_add_f32_dpp v14, v14, v14 row_ror:4 row_mask:0xf bank_mask:0xf
    s_nop 1
    v_add_f32_dpp v14, v14, v14 quad_perm:[2,3,0,1] row_mask:0xf bank_mask:0xf
    s_nop 1
    v_add_f32_dpp v14, v14, v14 quad_perm:[1,0,3,2] row_mask:0xf bank_mask:0xf
    v_cvt_pk_bf16_f32 v14, v14, v14
    v_lshlrev_b32 v14, 16, v14
    v_max_f32 v14, 0xc2ae0000, v14
    v_min_f32 v14, 0x43000000, v14
    v_mul_f32 v15, 0xbfb8aa3b, v14
    v_fma_f32 v16, v14, s98, -v15
    v_fmac_f32 v16, 0xb2a57060, v14
    v_exp_f32 v15, v15
    v_mul_f32 v16, 0x3f317218, v16
    v_fmac_f32 v15, v15, v16
    v_add_f32 v15, 1.0, v15
    v_rcp_f32 v16, v15
    s_nop 0
    v_fma_f32 v15, -v15, v16, 1.0
    v_fma_f32 v14, v15, v16, v16
    v_cvt_pk_bf16_f32 v14, v14, v14
    v_lshlrev_b32 v14, 16, v14
    v_add_f32 v41, v40, v104
    v_cvt_pk_bf16_f32 v41, v41, v41
    v_lshlrev_b32 v41, 16, v41
    v_mul_f32 v41, v41, v106
    v_cvt_pk_bf16_f32 v41, v41, v41
    v_lshlrev_b32 v41, 16, v41
    v_mul_f32 v41, v41, v79
    v_cvt_pk_bf16_f32 v41, v41, v41
    s_branch .Lsk_m2_1
.Lst_m2_1:
    s_branch .Lrt_m2_1
.Lsk_m2_1:
    v_lshlrev_b32 v41, 16, v41
    v_add_f32 v41, v41, v77
    v_cvt_pk_bf16_f32 v41, v41, v41
    v_lshlrev_b32 v41, 16, v41
    s_and_b32 s62, s64, 1
    s_lshl1_add_u32 s58, s65, s62
    s_lshl3_add_u32 s58, s58, s3
    s_mul_i32 s58, s58, 9216
    s_add_u32 s58, s58, 0x1a0000
    s_add_u32 s59, s58, 4096
    s_add_u32 s63, s58, 8192
    s_cmp_eq_u32 s62, 0
    s_mov_b32 s56, 0x00ff00ff
    s_cselect_b32 s62, s56, 0xff00ff00
    s_mov_b32 s60, 0x04000c0c
    s_mov_b32 s61, 0x0706000c
    s_mov_b32 s48, s28
    s_and_b32 s49, s29, 0xffff
    s_mov_b32 s50, 0x2400
    s_mov_b32 s51, 0x00020000
.gp_119:
    buffer_load_dwordx4 v[120:123], v2, s[36:39], s58 offen offset:0 sc1
    buffer_load_dwordx4 v[124:127], v2, s[36:39], s58 offen offset:1024 sc1
    buffer_load_dwordx4 v[128:131], v2, s[36:39], s58 offen offset:2048 sc1
    buffer_load_dwordx4 v[132:135], v2, s[36:39], s58 offen offset:3072 sc1
    buffer_load_dwordx4 v[136:139], v2, s[36:39], s59 offen offset:0 sc1
    buffer_load_dwordx4 v[140:143], v2, s[36:39], s59 offen offset:1024 sc1
    buffer_load_dwordx4 v[144:147], v2, s[36:39], s59 offen offset:2048 sc1
    buffer_load_dwordx4 v[148:151], v2, s[36:39], s59 offen offset:3072 sc1
    buffer_load_dwordx4 v[152:155], v2, s[36:39], s63 offen offset:0 sc1
    s_waitcnt vmcnt(0)
.gpc_120:
    v_min3_u32 v24, v123, v127, v131
    v_max3_u32 v25, v123, v127, v131
    v_min3_u32 v24, v24, v135, v139
    v_max3_u32 v25, v25, v135, v139
    v_min3_u32 v24, v24, v143, v147
    v_max3_u32 v25, v25, v143, v147
    v_min3_u32 v24, v24, v151, v155
    v_max3_u32 v25, v25, v151, v155
    v_cmp_eq_u32 vcc, s34, v24
    v_cmp_eq_u32 s[56:57], s34, v25
    s_and_b64 vcc, vcc, s[56:57]
    s_cmp_eq_u64 vcc, -1
    s_nop 2
    s_cbranch_scc1 .gpd_121
    s_sub_u32 s35, s35, 1
    s_cbranch_scc1 .Lexit
    s_branch .gp_119
.gpd_121:
    v_perm_b32 v123, v120, v121, s60
    v_perm_b32 v123, v123, v122, s61
    v_perm_b32 v127, v124, v125, s60
    v_perm_b32 v127, v127, v126, s61
    v_perm_b32 v131, v128, v129, s60
    v_perm_b32 v131, v131, v130, s61
    v_perm_b32 v135, v132, v133, s60
    v_perm_b32 v135, v135, v134, s61
    v_perm_b32 v139, v136, v137, s60
    v_perm_b32 v139, v139, v138, s61
    v_perm_b32 v143, v140, v141, s60
    v_perm_b32 v143, v143, v142, s61
    v_perm_b32 v147, v144, v145, s60
    v_perm_b32 v147, v147, v146, s61
    v_perm_b32 v151, v148, v149, s60
    v_perm_b32 v151, v151, v150, s61
    v_perm_b32 v155, v152, v153, s60
    v_perm_b32 v155, v155, v154, s61
    v_pk_add_f32 v[120:121], v[120:121], v[124:125]
    v_pk_add_f32 v[122:123], v[122:123], v[126:127]
    v_pk_add_f32 v[128:129], v[128:129], v[132:133]
    v_pk_add_f32 v[130:131], v[130:131], v[134:135]
    v_pk_add_f32 v[136:137], v[136:137], v[140:141]
    v_pk_add_f32 v[138:139], v[138:139], v[142:143]
    v_pk_add_f32 v[144:145], v[144:145], v[148:149]
    v_pk_add_f32 v[146:147], v[146:147], v[150:151]
    v_pk_add_f32 v[120:121], v[120:121], v[128:129]
    v_pk_add_f32 v[122:123], v[122:123], v[130:131]
    v_pk_add_f32 v[136:137], v[136:137], v[144:145]
    v_pk_add_f32 v[138:139], v[138:139], v[146:147]
    v_pk_add_f32 v[120:121], v[120:121], v[136:137]
    v_pk_add_f32 v[122:123], v[122:123], v[138:139]
    v_pk_add_f32 v[120:121], v[120:121], v[152:153]
    v_pk_add_f32 v[122:123], v[122:123], v[154:155]
    s_nop 1
    v_permlane32_swap_b32 v120, v122
    v_permlane32_swap_b32 v121, v123
    v_pk_add_f32 v[120:121], v[120:121], v[122:123]
    s_nop 1
    v_permlane16_swap_b32 v120, v121
    v_add_f32 v120, v120, v121
    s_nop 1
    v_add_f32_dpp v120, v120, v120 row_ror:8 row_mask:0xf bank_mask:0xf
    v_cvt_pk_bf16_f32 v120, v120, v120
    v_lshlrev_b32 v120, 16, v120
    v_mul_f32 v120, v120, v14
    v_cvt_pk_bf16_f32 v120, v120, v120
    v_lshlrev_b32 v120, 16, v120
    v_add_f32 v120, v120, v41
    v_cvt_pk_bf16_f32 v120, v120, v120
    v_lshlrev_b32 v120, 16, v120
    v_mul_f32 v120, v120, v81
    v_cvt_pk_bf16_f32 v120, v120, v120
    v_lshlrev_b32 v120, 16, v120
    v_add_f32 v120, v120, v40
    v_cvt_pk_bf16_f32 v120, v120, v120
    s_mov_b32 exec_lo, s62
    s_mov_b32 exec_hi, s62
    buffer_store_short v120, v7, s[48:51], s100 offen
    s_mov_b64 exec, -1
    s_or_b32 s56, s2, s3
    s_cmp_lg_u32 s56, 0
    s_cbranch_scc1 .Lexit
    v_mov_b32 v13, s34
    v_mov_b32 v12, 0
    s_mov_b64 exec, 1
    buffer_store_dword v13, v12, s[36:39], 0 offen
    s_mov_b64 exec, -1
    s_branch .Lexit
.Lbc:
    s_branch .Lsk_b0_0
.Lst_b0_0:
    s_branch .Lrt_b0_0
.Lsk_b0_0:
    s_sub_u32 s56, s65, 9
    s_mov_b32 s57, 0x63054210
    s_cmp_eq_u32 s65, 14
    s_cselect_b32 s56, s64, s56
    s_cselect_b32 s57, 0x37654210, s57
    s_cselect_b32 s99, 8, s64
    s_lshl_b32 s56, s56, 2
    s_lshr_b32 s56, s57, s56
    s_and_b32 s56, s56, 7
    s_cmp_eq_u32 s65, 17
    s_cselect_b32 s56, 7, s56
    s_lshl3_add_u32 s99, s99, s56
    s_and_b32 s56, s99, 7
    s_cmp_eq_u32 s56, 3
    s_mov_b32 s14, 0xb5b5b5b5
    s_cselect_b32 s14, 0x0, s14
    s_mov_b32 s15, 0xd6d6b6b6
    s_cselect_b32 s15, 0x0, s15
    s_cselect_b32 s30, -50, 0
    s_add_u32 s30, s30, 0
    s_add_u32 s30, s30, s70
    s_mov_b32 s31, s70
    s_mov_b32 s48, s18
    s_and_b32 s49, s19, 0xffff
    s_mov_b32 s50, 0x510000
    s_mov_b32 s51, 0x00020000
    s_mov_b32 s52, s20
    s_and_b32 s53, s21, 0xffff
    s_mov_b32 s54, 0x510000
    s_mov_b32 s55, 0x00020000
    v_bfe_u32 v12, v0, 4, 1
    s_and_b32 s56, s3, 3
    s_lshl_b32 s56, s56, 1
    v_or_b32 v12, s56, v12
    v_and_b32 v6, 7, v0
    v_xor_b32 v12, v12, v6
    v_lshrrev_b32 v6, 3, v0
    v_mul_u32_u24 v6, 9216, v6
    v_lshl_add_u32 v6, v12, 4, v6
    s_mul_i32 s100, s3, 73728
    s_lshl_b32 s56, s99, 7
    s_add_u32 s100, s100, s56
    s_lshl_b32 s101, s3, 10
    s_waitcnt lgkmcnt(0)
    s_add_u32 s34, s34, 1
    s_getreg_b32 s1, hwreg(HW_REG_XCC_ID)
    s_lshl_b32 s1, s1, 24
    s_add_u32 s1, s1, s34
    s_lshr_b32 s0, s2, 3
    s_lshl_b32 s63, s64, 8
    s_add_u32 s0, s0, s63
    s_lshl2_add_u32 s0, s0, 0x480000
    v_mov_b32 v30, s1
    s_cmp_eq_u32 s3, 0
    s_cselect_b64 exec, 1, 0
    buffer_store_dword v30, v2, s[36:39], s0 offen sc1
    s_mov_b64 exec, -1
    v_and_b32 v8, 1, v0
    v_lshlrev_b32 v8, 8, v8
    v_and_b32 v9, 0x3c, v0
    v_lshl_add_u32 v9, v9, 2, v8
    v_add_u32 v7, v9, v8
    v_and_b32 v9, 0x3c, v0
    v_lshrrev_b32 v8, 4, v8
    v_and_b32 v9, 4, v0
    v_lshl_add_u32 v9, v9, 3, v8
    s_lshl_b32 s58, s66, 14
    s_lshl_b32 s59, s67, 10
    s_add_u32 s58, s58, s59
    s_add_u32 s58, s58, 0x70000
    s_lshl4_add_u32 s59, s66, s67
    s_lshl_b32 s59, s59, 7
    s_add_u32 s59, s59, 0x430000
    s_bitcmp1_b64 s[14:15], 4
    s_cbranch_scc0 1
    s_waitcnt vmcnt(4)
    s_add_u32 s63, s69, 32768
    buffer_load_dwordx4 v[96:99], v1, s[40:43], s63 offen nt
    s_waitcnt vmcnt(6)
    s_add_u32 m0, s101, 0
    s_add_u32 s56, s100, 0
    buffer_load_dwordx4 v6, s[48:51], s56 offen nt lds
    s_waitcnt vmcnt(6)
    s_bitcmp1_b64 s[14:15], 5
    s_cbranch_scc0 1
    s_waitcnt vmcnt(4)
    s_add_u32 s63, s69, 40960
    buffer_load_dwordx4 v[100:103], v1, s[40:43], s63 offen nt
    s_waitcnt vmcnt(6)
    s_bitcmp1_b64 s[14:15], 6
    s_cbranch_scc0 1
    s_waitcnt vmcnt(2)
    s_add_u32 s63, s69, 49152
    buffer_load_dwordx4 v[128:131], v1, s[40:43], s63 offen nt
    s_cmp_eq_u32 s3, 0
    s_cbranch_scc1 .Lst_b1_0
    s_cmp_eq_u32 s3, 1
    s_cbranch_scc1 .Lst_b1_1
    s_cmp_eq_u32 s3, 2
    s_cbranch_scc1 .Lst_b1_2
    s_cmp_eq_u32 s3, 3
    s_cbranch_scc1 .Lst_b1_3
    s_cmp_eq_u32 s3, 4
    s_cbranch_scc1 .Lst_b1_4
    s_cmp_eq_u32 s3, 5
    s_cbranch_scc1 .Lst_b1_5
    s_cmp_eq_u32 s3, 6
    s_cbranch_scc1 .Lst_b1_6
    s_cmp_eq_u32 s3, 7
    s_cbranch_scc1 .Lst_b1_7
.Lrt_b1_0:
.Lrt_b1_1:
.Lrt_b1_2:
.Lrt_b1_3:
.Lrt_b1_4:
.Lrt_b1_5:
.Lrt_b1_6:
.Lrt_b1_7:
    s_waitcnt vmcnt(6)
    s_add_u32 m0, s101, 8192
    s_add_u32 s56, s100, 589824
    buffer_load_dwordx4 v6, s[48:51], s56 offen nt lds
    s_waitcnt vmcnt(4)
    s_bitcmp1_b64 s[14:15], 7
    s_cbranch_scc0 1
    s_waitcnt vmcnt(2)
    s_add_u32 s63, s69, 57344
    buffer_load_dwordx4 v[132:135], v1, s[40:43], s63 offen nt
    s_waitcnt vmcnt(4)
    s_bitcmp1_b64 s[14:15], 8
    s_cbranch_scc0 1
    s_waitcnt vmcnt(2)
    s_add_u32 s63, s69, 131072
    buffer_load_dwordx4 v[40:43], v1, s[40:43], s63 offen nt
    s_memrealtime s[8:9]
    s_waitcnt lgkmcnt(0)
    s_sub_u32 s8, s8, s30
    s_cmpk_ge_u32 s8, 437
    s_cbranch_scc1 .ap_122
    s_waitcnt vmcnt(5)
    s_cmpk_ge_u32 s8, 337
    s_cbranch_scc1 .ap_122
    s_waitcnt vmcnt(4)
    s_bitcmp1_b64 s[14:15], 9
    s_cbranch_scc0 1
    s_waitcnt vmcnt(2)
    s_cmpk_ge_u32 s8, 217
    s_cbranch_scc1 .ap_122
    s_waitcnt vmcnt(1)
.ap_122:
    s_add_u32 s63, s69, 139264
    buffer_load_dwordx4 v[44:47], v1, s[40:43], s63 offen nt
    s_memrealtime s[8:9]
    s_waitcnt lgkmcnt(0)
    s_sub_u32 s8, s8, s30
    s_cmpk_ge_u32 s8, 471
    s_cbranch_scc1 .ap_123
    s_waitcnt vmcnt(5)
    s_cmpk_ge_u32 s8, 371
    s_cbranch_scc1 .ap_123
    s_waitcnt vmcnt(4)
    s_bitcmp1_b64 s[14:15], 10
    s_cbranch_scc0 1
    s_waitcnt vmcnt(2)
    s_cmpk_ge_u32 s8, 251
    s_cbranch_scc1 .ap_123
    s_waitcnt vmcnt(1)
.ap_123:
    s_add_u32 s63, s69, 147456
    buffer_load_dwordx4 v[72:75], v1, s[40:43], s63 offen nt
    s_memrealtime s[8:9]
    s_waitcnt lgkmcnt(0)
    s_sub_u32 s8, s8, s30
    s_cmpk_ge_u32 s8, 505
    s_cbranch_scc1 .ap_124
    s_waitcnt vmcnt(5)
    s_cmpk_ge_u32 s8, 405
    s_cbranch_scc1 .ap_124
    s_waitcnt vmcnt(4)
    s_cmpk_ge_u32 s8, 285
    s_cbranch_scc1 .ap_124
    s_waitcnt vmcnt(1)
.ap_124:
    s_add_u32 m0, s101, 16384
    s_add_u32 s56, s100, 1179648
    buffer_load_dwordx4 v6, s[48:51], s56 offen nt lds
    s_memrealtime s[8:9]
    s_waitcnt lgkmcnt(0)
    s_sub_u32 s8, s8, s30
    s_cmpk_ge_u32 s8, 505
    s_cbranch_scc1 .ap_125
    s_waitcnt vmcnt(5)
    s_cmpk_ge_u32 s8, 405
    s_cbranch_scc1 .ap_125
    s_waitcnt vmcnt(4)
    s_bitcmp1_b64 s[14:15], 11
    s_cbranch_scc0 1
    s_waitcnt vmcnt(2)
    s_cmpk_ge_u32 s8, 285
    s_cbranch_scc1 .ap_125
    s_waitcnt vmcnt(1)
.ap_125:
    s_add_u32 s63, s69, 155648
    buffer_load_dwordx4 v[76:79], v1, s[40:43], s63 offen nt
    s_memrealtime s[8:9]
    s_waitcnt vmcnt(8)
    s_waitcnt lgkmcnt(0)
    s_sub_u32 s8, s8, s30
    s_cmpk_ge_u32 s8, 539
    s_cbranch_scc1 .ap_126
    s_waitcnt vmcnt(5)
    s_cmpk_ge_u32 s8, 439
    s_cbranch_scc1 .ap_126
    s_waitcnt vmcnt(4)
    s_bitcmp1_b64 s[14:15], 12
    s_cbranch_scc0 1
    s_waitcnt vmcnt(2)
    s_cmpk_ge_u32 s8, 319
    s_cbranch_scc1 .ap_126
    s_waitcnt vmcnt(1)
.ap_126:
    s_add_u32 s63, s69, 163840
    buffer_load_dwordx4 v[104:107], v1, s[40:43], s63 offen nt
    v_and_b32 v157, 7, v0
    v_lshlrev_b32 v157, 2, v157
    s_mov_b32 s63, 0x4a1100
    buffer_load_dword v156, v157, s[36:39], s63 offen
    s_memrealtime s[8:9]
    s_waitcnt vmcnt(9)
    s_branch .Lsk_b0_1
.Lst_b0_1:
    s_branch .Lrt_b0_1
.Lsk_b0_1:
    s_waitcnt lgkmcnt(0)
    s_sub_u32 s8, s8, s30
    s_cmpk_ge_u32 s8, 573
    s_cbranch_scc1 .ap_127
    s_waitcnt vmcnt(6)
    s_cmpk_ge_u32 s8, 473
    s_cbranch_scc1 .ap_127
    s_waitcnt vmcnt(5)
    s_bitcmp1_b64 s[14:15], 13
    s_cbranch_scc0 1
    s_waitcnt vmcnt(3)
    s_cmpk_ge_u32 s8, 353
    s_cbranch_scc1 .ap_127
    s_waitcnt vmcnt(2)
.ap_127:
    s_add_u32 s63, s69, 172032
    buffer_load_dwordx4 v[108:111], v1, s[40:43], s63 offen nt
    s_memrealtime s[8:9]
    s_waitcnt vmcnt(9)
    s_waitcnt lgkmcnt(0)
    s_sub_u32 s8, s8, s30
    s_cmpk_ge_u32 s8, 607
    s_cbranch_scc1 .ap_128
    s_waitcnt vmcnt(6)
    s_cmpk_ge_u32 s8, 507
    s_cbranch_scc1 .ap_128
    s_waitcnt vmcnt(5)
    s_bitcmp1_b64 s[14:15], 14
    s_cbranch_scc0 1
    s_waitcnt vmcnt(3)
    s_cmpk_ge_u32 s8, 387
    s_cbranch_scc1 .ap_128
    s_waitcnt vmcnt(2)
.ap_128:
    s_add_u32 s63, s69, 180224
    buffer_load_dwordx4 v[136:139], v1, s[40:43], s63 offen nt
    s_memrealtime s[8:9]
    s_waitcnt vmcnt(9)
    s_waitcnt lgkmcnt(0)
    s_sub_u32 s8, s8, s30
    s_cmpk_ge_u32 s8, 641
    s_cbranch_scc1 .ap_129
    s_waitcnt vmcnt(6)
    s_cmpk_ge_u32 s8, 541
    s_cbranch_scc1 .ap_129
    s_waitcnt vmcnt(5)
    s_cmpk_ge_u32 s8, 421
    s_cbranch_scc1 .ap_129
    s_waitcnt vmcnt(1)
.ap_129:
    s_add_u32 m0, s101, 24576
    s_add_u32 s56, s100, 1769472
    buffer_load_dwordx4 v6, s[48:51], s56 offen nt lds
    s_memrealtime s[8:9]
    s_waitcnt vmcnt(9)
    s_waitcnt lgkmcnt(0)
    s_sub_u32 s8, s8, s30
    s_cmpk_ge_u32 s8, 641
    s_cbranch_scc1 .ap_130
    s_waitcnt vmcnt(6)
    s_cmpk_ge_u32 s8, 541
    s_cbranch_scc1 .ap_130
    s_waitcnt vmcnt(5)
    s_bitcmp1_b64 s[14:15], 15
    s_cbranch_scc0 1
    s_waitcnt vmcnt(2)
    s_cmpk_ge_u32 s8, 421
    s_cbranch_scc1 .ap_130
    s_waitcnt vmcnt(1)
.ap_130:
    s_add_u32 s63, s69, 188416
    buffer_load_dwordx4 v[140:143], v1, s[40:43], s63 offen nt
    s_memrealtime s[8:9]
    s_waitcnt vmcnt(9)
    s_waitcnt lgkmcnt(0)
    s_sub_u32 s8, s8, s30
    s_cmpk_ge_u32 s8, 675
    s_cbranch_scc1 .ap_131
    s_waitcnt vmcnt(6)
    s_cmpk_ge_u32 s8, 575
    s_cbranch_scc1 .ap_131
    s_waitcnt vmcnt(5)
    s_bitcmp1_b64 s[14:15], 16
    s_cbranch_scc0 1
    s_waitcnt vmcnt(2)
    s_cmpk_ge_u32 s8, 455
    s_cbranch_scc1 .ap_131
    s_waitcnt vmcnt(1)
.ap_131:
    s_add_u32 s63, s69, 262144
    buffer_load_dwordx4 v[48:51], v1, s[40:43], s63 offen nt
    s_waitcnt vmcnt(5)
    s_sub_u32 s63, s70, 300
    v_subrev_u32 v156, s63, v156
    v_mov_b32 v157, 600
    v_cmp_lt_u32 s[8:9], v156, v157
    v_add_u32_dpp v156, v156, v156 quad_perm:[1,0,3,2] row_mask:0xf bank_mask:0xf
    s_nop 1
    v_add_u32_dpp v156, v156, v156 quad_perm:[2,3,0,1] row_mask:0xf bank_mask:0xf
    s_nop 1
    v_add_u32_dpp v156, v156, v156 row_ror:4 row_mask:0xf bank_mask:0xf
    s_nop 0
    v_readfirstlane_b32 s63, v156
    s_cmp_eq_u64 s[8:9], -1
    s_nop 3
    s_cbranch_scc0 .et_132
    s_lshr_b32 s63, s63, 3
    s_sub_u32 s63, s63, 300
    s_add_u32 s30, s30, s63
    s_add_u32 s31, s31, s63
.et_132:
    s_memrealtime s[8:9]
    s_waitcnt lgkmcnt(0)
    s_sub_u32 s8, s8, s30
    s_cmpk_ge_u32 s8, 709
    s_cbranch_scc1 .ap_133
    s_waitcnt vmcnt(5)
    s_cmpk_ge_u32 s8, 609
    s_cbranch_scc1 .ap_133
    s_waitcnt vmcnt(4)
    s_bitcmp1_b64 s[14:15], 17
    s_cbranch_scc0 1
    s_waitcnt vmcnt(2)
    s_cmpk_ge_u32 s8, 489
    s_cbranch_scc1 .ap_133
    s_waitcnt vmcnt(1)
.ap_133:
    s_add_u32 s63, s69, 270336
    buffer_load_dwordx4 v[52:55], v1, s[40:43], s63 offen nt
    s_memrealtime s[8:9]
    s_waitcnt lgkmcnt(0)
    s_sub_u32 s8, s8, s30
    s_cmpk_ge_u32 s8, 744
    s_cbranch_scc1 .ap_134
    s_waitcnt vmcnt(5)
    s_cmpk_ge_u32 s8, 644
    s_cbranch_scc1 .ap_134
    s_waitcnt vmcnt(4)
    s_bitcmp1_b64 s[14:15], 18
    s_cbranch_scc0 1
    s_waitcnt vmcnt(2)
    s_cmpk_ge_u32 s8, 524
    s_cbranch_scc1 .ap_134
    s_waitcnt vmcnt(1)
.ap_134:
    s_add_u32 s63, s69, 278528
    buffer_load_dwordx4 v[80:83], v1, s[40:43], s63 offen nt
    s_memrealtime s[8:9]
    s_waitcnt lgkmcnt(0)
    s_sub_u32 s8, s8, s30
    s_cmpk_ge_u32 s8, 779
    s_cbranch_scc1 .ap_135
    s_waitcnt vmcnt(5)
    s_cmpk_ge_u32 s8, 679
    s_cbranch_scc1 .ap_135
    s_waitcnt vmcnt(4)
    s_cmpk_ge_u32 s8, 559
    s_cbranch_scc1 .ap_135
    s_waitcnt vmcnt(1)
.ap_135:
    s_add_u32 m0, s101, 32768
    s_add_u32 s56, s100, 2359296
    buffer_load_dwordx4 v6, s[48:51], s56 offen nt lds
    s_memrealtime s[8:9]
    s_waitcnt lgkmcnt(0)
    s_sub_u32 s8, s8, s30
    s_cmpk_ge_u32 s8, 779
    s_cbranch_scc1 .ap_136
    s_waitcnt vmcnt(5)
    s_cmpk_ge_u32 s8, 679
    s_cbranch_scc1 .ap_136
    s_waitcnt vmcnt(4)
    s_bitcmp1_b64 s[14:15], 19
    s_cbranch_scc0 1
    s_waitcnt vmcnt(2)
    s_cmpk_ge_u32 s8, 559
    s_cbranch_scc1 .ap_136
    s_waitcnt vmcnt(1)
.ap_136:
    s_add_u32 s63, s69, 286720
    buffer_load_dwordx4 v[84:87], v1, s[40:43], s63 offen nt
    s_memrealtime s[8:9]
    s_waitcnt vmcnt(8)
    s_waitcnt lgkmcnt(0)
    s_sub_u32 s8, s8, s30
    s_cmpk_ge_u32 s8, 814
    s_cbranch_scc1 .ap_137
    s_waitcnt vmcnt(5)
    s_cmpk_ge_u32 s8, 714
    s_cbranch_scc1 .ap_137
    s_waitcnt vmcnt(4)
    s_bitcmp1_b64 s[14:15], 20
    s_cbranch_scc0 1
    s_waitcnt vmcnt(2)
    s_cmpk_ge_u32 s8, 594
    s_cbranch_scc1 .ap_137
    s_waitcnt vmcnt(1)
.ap_137:
    s_add_u32 s63, s69, 294912
    buffer_load_dwordx4 v[112:115], v1, s[40:43], s63 offen nt
    s_memrealtime s[8:9]
    s_waitcnt vmcnt(8)
    s_waitcnt lgkmcnt(0)
    s_sub_u32 s8, s8, s30
    s_cmpk_ge_u32 s8, 849
    s_cbranch_scc1 .ap_138
    s_waitcnt vmcnt(5)
    s_cmpk_ge_u32 s8, 749
    s_cbranch_scc1 .ap_138
    s_waitcnt vmcnt(4)
    s_bitcmp1_b64 s[14:15], 21
    s_cbranch_scc0 1
    s_waitcnt vmcnt(2)
    s_cmpk_ge_u32 s8, 629
    s_cbranch_scc1 .ap_138
    s_waitcnt vmcnt(1)
.ap_138:
    s_add_u32 s63, s69, 303104
    buffer_load_dwordx4 v[116:119], v1, s[40:43], s63 offen nt
    s_memrealtime s[8:9]
    s_waitcnt vmcnt(8)
    s_waitcnt lgkmcnt(0)
    s_sub_u32 s8, s8, s30
    s_cmpk_ge_u32 s8, 884
    s_cbranch_scc1 .ap_139
    s_waitcnt vmcnt(5)
    s_cmpk_ge_u32 s8, 784
    s_cbranch_scc1 .ap_139
    s_waitcnt vmcnt(4)
    s_bitcmp1_b64 s[14:15], 22
    s_cbranch_scc0 1
    s_waitcnt vmcnt(2)
    s_cmpk_ge_u32 s8, 664
    s_cbranch_scc1 .ap_139
    s_waitcnt vmcnt(1)
.ap_139:
    s_add_u32 s63, s69, 311296
    buffer_load_dwordx4 v[144:147], v1, s[40:43], s63 offen nt
    s_memrealtime s[8:9]
    s_branch .Lsk_b0_2
.Lst_b0_2:
    s_branch .Lrt_b0_2
.Lsk_b0_2:
    s_waitcnt vmcnt(8)
    s_waitcnt lgkmcnt(0)
    s_sub_u32 s8, s8, s30
    s_cmpk_ge_u32 s8, 919
    s_cbranch_scc1 .ap_140
    s_waitcnt vmcnt(5)
    s_cmpk_ge_u32 s8, 819
    s_cbranch_scc1 .ap_140
    s_waitcnt vmcnt(4)
    s_cmpk_ge_u32 s8, 699
    s_cbranch_scc1 .ap_140
    s_waitcnt vmcnt(1)
.ap_140:
    s_add_u32 m0, s101, 40960
    s_add_u32 s56, s100, 2949120
    buffer_load_dwordx4 v6, s[48:51], s56 offen nt lds
    s_branch .Lsk_b0_3
.Lst_b0_3:
    s_branch .Lrt_b0_3
.Lsk_b0_3:
    s_memrealtime s[8:9]
    s_waitcnt vmcnt(8)
    s_waitcnt lgkmcnt(0)
    s_sub_u32 s8, s8, s30
    s_cmpk_ge_u32 s8, 919
    s_cbranch_scc1 .ap_141
    s_waitcnt vmcnt(5)
    s_cmpk_ge_u32 s8, 819
    s_cbranch_scc1 .ap_141
    s_waitcnt vmcnt(4)
    s_bitcmp1_b64 s[14:15], 23
    s_cbranch_scc0 1
    s_waitcnt vmcnt(2)
    s_cmpk_ge_u32 s8, 699
    s_cbranch_scc1 .ap_141
    s_waitcnt vmcnt(1)
.ap_141:
    s_add_u32 s63, s69, 319488
    buffer_load_dwordx4 v[148:151], v1, s[40:43], s63 offen nt
    s_memrealtime s[8:9]
    s_waitcnt vmcnt(8)
    s_waitcnt lgkmcnt(0)
    s_sub_u32 s8, s8, s30
    s_cmpk_ge_u32 s8, 954
    s_cbranch_scc1 .ap_142
    s_waitcnt vmcnt(5)
    s_cmpk_ge_u32 s8, 854
    s_cbranch_scc1 .ap_142
    s_waitcnt vmcnt(4)
    s_bitcmp1_b64 s[14:15], 24
    s_cbranch_scc0 1
    s_waitcnt vmcnt(2)
    s_cmpk_ge_u32 s8, 734
    s_cbranch_scc1 .ap_142
    s_waitcnt vmcnt(1)
.ap_142:
    s_add_u32 s63, s69, 393216
    buffer_load_dwordx4 v[56:59], v1, s[40:43], s63 offen nt
    s_memrealtime s[8:9]
    s_waitcnt vmcnt(8)
    s_waitcnt lgkmcnt(0)
    s_sub_u32 s8, s8, s30
    s_cmpk_ge_u32 s8, 990
    s_cbranch_scc1 .ap_143
    s_waitcnt vmcnt(5)
    s_cmpk_ge_u32 s8, 890
    s_cbranch_scc1 .ap_143
    s_waitcnt vmcnt(4)
    s_bitcmp1_b64 s[14:15], 25
    s_cbranch_scc0 1
    s_waitcnt vmcnt(2)
    s_cmpk_ge_u32 s8, 770
    s_cbranch_scc1 .ap_143
    s_waitcnt vmcnt(1)
.ap_143:
    s_add_u32 s63, s69, 401408
    buffer_load_dwordx4 v[60:63], v1, s[40:43], s63 offen nt
    s_memrealtime s[8:9]
    s_waitcnt vmcnt(8)
    s_waitcnt lgkmcnt(0)
    s_sub_u32 s8, s8, s30
    s_cmpk_ge_u32 s8, 1028
    s_cbranch_scc1 .ap_144
    s_waitcnt vmcnt(5)
    s_cmpk_ge_u32 s8, 928
    s_cbranch_scc1 .ap_144
    s_waitcnt vmcnt(4)
    s_bitcmp1_b64 s[14:15], 26
    s_cbranch_scc0 1
    s_waitcnt vmcnt(2)
    s_cmpk_ge_u32 s8, 808
    s_cbranch_scc1 .ap_144
    s_waitcnt vmcnt(1)
.ap_144:
    s_add_u32 s63, s69, 409600
    buffer_load_dwordx4 v[88:91], v1, s[40:43], s63 offen nt
    s_memrealtime s[8:9]
    s_waitcnt vmcnt(8)
    s_waitcnt lgkmcnt(0)
    s_sub_u32 s8, s8, s30
    s_cmpk_ge_u32 s8, 1067
    s_cbranch_scc1 .ap_145
    s_waitcnt vmcnt(5)
    s_cmpk_ge_u32 s8, 967
    s_cbranch_scc1 .ap_145
    s_waitcnt vmcnt(4)
    s_cmpk_ge_u32 s8, 847
    s_cbranch_scc1 .ap_145
    s_waitcnt vmcnt(1)
.ap_145:
    s_add_u32 m0, s101, 49152
    s_add_u32 s56, s100, 3538944
    buffer_load_dwordx4 v6, s[48:51], s56 offen nt lds
    s_memrealtime s[8:9]
    s_waitcnt vmcnt(8)
    s_waitcnt lgkmcnt(0)
    s_sub_u32 s8, s8, s30
    s_cmpk_ge_u32 s8, 1067
    s_cbranch_scc1 .ap_146
    s_waitcnt vmcnt(5)
    s_cmpk_ge_u32 s8, 967
    s_cbranch_scc1 .ap_146
    s_waitcnt vmcnt(4)
    s_bitcmp1_b64 s[14:15], 27
    s_cbranch_scc0 1
    s_waitcnt vmcnt(2)
    s_cmpk_ge_u32 s8, 847
    s_cbranch_scc1 .ap_146
    s_waitcnt vmcnt(1)
.ap_146:
    s_add_u32 s63, s69, 417792
    buffer_load_dwordx4 v[92:95], v1, s[40:43], s63 offen nt
    s_memrealtime s[8:9]
    s_waitcnt vmcnt(8)
    s_waitcnt lgkmcnt(0)
    s_sub_u32 s8, s8, s30
    s_cmpk_ge_u32 s8, 1106
    s_cbranch_scc1 .ap_147
    s_waitcnt vmcnt(5)
    s_cmpk_ge_u32 s8, 1006
    s_cbranch_scc1 .ap_147
    s_waitcnt vmcnt(4)
    s_bitcmp1_b64 s[14:15], 28
    s_cbranch_scc0 1
    s_waitcnt vmcnt(2)
    s_cmpk_ge_u32 s8, 886
    s_cbranch_scc1 .ap_147
    s_waitcnt vmcnt(1)
.ap_147:
    s_add_u32 s63, s69, 425984
    buffer_load_dwordx4 v[120:123], v1, s[40:43], s63 offen nt
    s_memrealtime s[8:9]
    s_waitcnt vmcnt(8)
    s_waitcnt lgkmcnt(0)
    s_sub_u32 s8, s8, s30
    s_cmpk_ge_u32 s8, 1145
    s_cbranch_scc1 .ap_148
    s_waitcnt vmcnt(5)
    s_cmpk_ge_u32 s8, 1045
    s_cbranch_scc1 .ap_148
    s_waitcnt vmcnt(4)
    s_bitcmp1_b64 s[14:15], 29
    s_cbranch_scc0 1
    s_waitcnt vmcnt(2)
    s_cmpk_ge_u32 s8, 925
    s_cbranch_scc1 .ap_148
    s_waitcnt vmcnt(1)
.ap_148:
    s_add_u32 s63, s69, 434176
    buffer_load_dwordx4 v[124:127], v1, s[40:43], s63 offen nt
    s_memrealtime s[8:9]
    s_waitcnt vmcnt(8)
    s_waitcnt lgkmcnt(0)
    s_sub_u32 s8, s8, s30
    s_cmpk_ge_u32 s8, 1184
    s_cbranch_scc1 .ap_149
    s_waitcnt vmcnt(5)
    s_cmpk_ge_u32 s8, 1084
    s_cbranch_scc1 .ap_149
    s_waitcnt vmcnt(4)
    s_bitcmp1_b64 s[14:15], 30
    s_cbranch_scc0 1
    s_waitcnt vmcnt(2)
    s_cmpk_ge_u32 s8, 964
    s_cbranch_scc1 .ap_149
    s_waitcnt vmcnt(1)
.ap_149:
    s_add_u32 s63, s69, 442368
    buffer_load_dwordx4 v[152:155], v1, s[40:43], s63 offen nt
    s_memrealtime s[8:9]
    s_waitcnt vmcnt(8)
    s_waitcnt lgkmcnt(0)
    s_sub_u32 s8, s8, s30
    s_cmpk_ge_u32 s8, 1223
    s_cbranch_scc1 .ap_150
    s_waitcnt vmcnt(5)
    s_cmpk_ge_u32 s8, 1123
    s_cbranch_scc1 .ap_150
    s_waitcnt vmcnt(4)
    s_cmpk_ge_u32 s8, 1003
    s_cbranch_scc1 .ap_150
    s_waitcnt vmcnt(1)
.ap_150:
    s_add_u32 m0, s101, 57344
    s_add_u32 s56, s100, 4128768
    buffer_load_dwordx4 v6, s[48:51], s56 offen nt lds
    s_memrealtime s[8:9]
    s_waitcnt vmcnt(8)
    s_waitcnt lgkmcnt(0)
    s_sub_u32 s8, s8, s30
    s_cmpk_ge_u32 s8, 1223
    s_cbranch_scc1 .ap_151
    s_waitcnt vmcnt(5)
    s_cmpk_ge_u32 s8, 1123
    s_cbranch_scc1 .ap_151
    s_waitcnt vmcnt(4)
    s_bitcmp1_b64 s[14:15], 31
    s_cbranch_scc0 1
    s_waitcnt vmcnt(2)
    s_cmpk_ge_u32 s8, 1003
    s_cbranch_scc1 .ap_151
    s_waitcnt vmcnt(1)
.ap_151:
    s_add_u32 s63, s69, 450560
    buffer_load_dwordx4 v[156:159], v1, s[40:43], s63 offen nt
    s_memrealtime s[8:9]
    s_waitcnt vmcnt(8)
    s_waitcnt lgkmcnt(0)
    s_sub_u32 s8, s8, s30
    s_cmpk_ge_u32 s8, 1262
    s_cbranch_scc1 .ap_152
    s_waitcnt vmcnt(5)
    s_cmpk_ge_u32 s8, 1162
    s_cbranch_scc1 .ap_152
    s_waitcnt vmcnt(4)
    s_bitcmp1_b64 s[14:15], 32
    s_cbranch_scc0 1
    s_waitcnt vmcnt(2)
    s_cmpk_ge_u32 s8, 1042
    s_cbranch_scc1 .ap_152
    s_waitcnt vmcnt(1)
.ap_152:
    v_bfe_u32 v1, v0, 4, 2
    v_and_b32 v10, 0xf0, v2
    v_lshlrev_b32 v1, 2, v1
    v_bfe_u32 v1, s6, v1, 4
    v_lshl_add_u32 v1, v1, 8, v10
    s_add_u32 s63, s69, 0
    buffer_load_dwordx4 v[160:163], v1, s[44:47], s63 offen nt
    s_memrealtime s[8:9]
    s_waitcnt vmcnt(8)
    s_waitcnt lgkmcnt(0)
    s_sub_u32 s8, s8, s30
    s_cmpk_ge_u32 s8, 1298
    s_cbranch_scc1 .ap_153
    s_branch .Lsk_b1_0
.Lst_b1_0:
    s_branch .Lrt_b1_0
.Lsk_b1_0:
    s_waitcnt vmcnt(5)
    s_cmpk_ge_u32 s8, 1198
    s_cbranch_scc1 .ap_153
    s_waitcnt vmcnt(4)
    s_bitcmp1_b64 s[14:15], 33
    s_cbranch_scc0 1
    s_waitcnt vmcnt(2)
    s_cmpk_ge_u32 s8, 1078
    s_cbranch_scc1 .ap_153
    s_waitcnt vmcnt(1)
.ap_153:
    s_add_u32 s63, s69, 8192
    buffer_load_dwordx4 v[164:167], v1, s[44:47], s63 offen nt
    s_memrealtime s[8:9]
    s_waitcnt vmcnt(8)
    s_waitcnt lgkmcnt(0)
    s_sub_u32 s8, s8, s30
    s_cmpk_ge_u32 s8, 1335
    s_cbranch_scc1 .ap_154
    s_waitcnt vmcnt(5)
    s_cmpk_ge_u32 s8, 1235
    s_cbranch_scc1 .ap_154
    s_waitcnt vmcnt(4)
    s_bitcmp1_b64 s[14:15], 34
    s_cbranch_scc0 1
    s_waitcnt vmcnt(2)
    s_cmpk_ge_u32 s8, 1115
    s_cbranch_scc1 .ap_154
    s_waitcnt vmcnt(1)
.ap_154:
    s_add_u32 s63, s69, 16384
    buffer_load_dwordx4 v[168:171], v1, s[44:47], s63 offen nt
    s_memrealtime s[8:9]
    s_waitcnt vmcnt(8)
    s_waitcnt lgkmcnt(0)
    s_sub_u32 s8, s8, s30
    s_cmpk_ge_u32 s8, 1371
    s_cbranch_scc1 .ap_155
    s_waitcnt vmcnt(5)
    s_cmpk_ge_u32 s8, 1271
    s_cbranch_scc1 .ap_155
    s_waitcnt vmcnt(4)
    s_cmpk_ge_u32 s8, 1151
    s_cbranch_scc1 .ap_155
    s_waitcnt vmcnt(1)
.ap_155:
    s_add_u32 m0, s101, 65536
    s_add_u32 s56, s100, 4718592
    buffer_load_dwordx4 v6, s[48:51], s56 offen nt lds
    s_memrealtime s[8:9]
    s_waitcnt vmcnt(8)
    s_waitcnt lgkmcnt(0)
    s_sub_u32 s8, s8, s30
    s_cmpk_ge_u32 s8, 1371
    s_cbranch_scc1 .ap_156
    s_waitcnt vmcnt(5)
    s_cmpk_ge_u32 s8, 1271
    s_cbranch_scc1 .ap_156
    s_waitcnt vmcnt(4)
    s_bitcmp1_b64 s[14:15], 35
    s_cbranch_scc0 1
    s_waitcnt vmcnt(2)
    s_cmpk_ge_u32 s8, 1151
    s_cbranch_scc1 .ap_156
    s_waitcnt vmcnt(1)
.ap_156:
    s_add_u32 s63, s69, 24576
    buffer_load_dwordx4 v[172:175], v1, s[44:47], s63 offen nt
    s_memrealtime s[8:9]
    s_waitcnt vmcnt(8)
    s_waitcnt lgkmcnt(0)
    s_sub_u32 s8, s8, s30
    s_cmpk_ge_u32 s8, 1408
    s_cbranch_scc1 .ap_157
    s_waitcnt vmcnt(5)
    s_cmpk_ge_u32 s8, 1308
    s_cbranch_scc1 .ap_157
    s_waitcnt vmcnt(4)
    s_bitcmp1_b64 s[14:15], 36
    s_cbranch_scc0 1
    s_waitcnt vmcnt(2)
    s_cmpk_ge_u32 s8, 1188
    s_cbranch_scc1 .ap_157
    s_waitcnt vmcnt(1)
.ap_157:
    s_add_u32 s63, s69, 32768
    buffer_load_dwordx4 v[176:179], v1, s[44:47], s63 offen nt
    buffer_load_dwordx4 v[16:19], v7, s[36:39], s58 offen offset:0 sc1
    buffer_load_dwordx4 v[20:23], v7, s[36:39], s58 offen offset:256 sc1
    s_memrealtime s[8:9]
    s_waitcnt vmcnt(8)
    s_waitcnt lgkmcnt(0)
    s_sub_u32 s8, s8, s30
    s_cmpk_ge_u32 s8, 1444
    s_cbranch_scc1 .ap_158
    s_waitcnt vmcnt(5)
    s_cmpk_ge_u32 s8, 1344
    s_cbranch_scc1 .ap_158
    s_waitcnt vmcnt(4)
    s_bitcmp1_b64 s[14:15], 37
    s_cbranch_scc0 1
    s_waitcnt vmcnt(2)
    s_cmpk_ge_u32 s8, 1224
    s_cbranch_scc1 .ap_158
    s_waitcnt vmcnt(1)
.ap_158:
    s_add_u32 s63, s69, 40960
    buffer_load_dwordx4 v[180:183], v1, s[44:47], s63 offen nt
    s_memrealtime s[8:9]
    s_waitcnt vmcnt(8)
    s_waitcnt lgkmcnt(0)
    s_sub_u32 s8, s8, s30
    s_cmpk_ge_u32 s8, 1481
    s_cbranch_scc1 .ap_159
    s_waitcnt vmcnt(5)
    s_cmpk_ge_u32 s8, 1381
    s_cbranch_scc1 .ap_159
    s_waitcnt vmcnt(4)
    s_bitcmp1_b64 s[14:15], 38
    s_cbranch_scc0 1
    s_waitcnt vmcnt(2)
    s_cmpk_ge_u32 s8, 1261
    s_cbranch_scc1 .ap_159
    s_waitcnt vmcnt(1)
.ap_159:
    s_add_u32 s63, s69, 49152
    buffer_load_dwordx4 v[184:187], v1, s[44:47], s63 offen nt
    s_memrealtime s[8:9]
    s_waitcnt vmcnt(8)
    s_waitcnt lgkmcnt(0)
    s_sub_u32 s8, s8, s30
    s_cmpk_ge_u32 s8, 1517
    s_cbranch_scc1 .ap_160
    s_waitcnt vmcnt(5)
    s_cmpk_ge_u32 s8, 1417
    s_cbranch_scc1 .ap_160
    s_waitcnt vmcnt(4)
    s_cmpk_ge_u32 s8, 1297
    s_cbranch_scc1 .ap_160
    s_waitcnt vmcnt(1)
.ap_160:
    s_add_u32 m0, s101, 73728
    s_add_u32 s56, s100, 0
    buffer_load_dwordx4 v6, s[52:55], s56 offen nt lds
    s_memrealtime s[8:9]
    s_waitcnt vmcnt(8)
    s_waitcnt lgkmcnt(0)
    s_sub_u32 s8, s8, s30
    s_cmpk_ge_u32 s8, 1517
    s_cbranch_scc1 .ap_161
    s_waitcnt vmcnt(5)
    s_cmpk_ge_u32 s8, 1417
    s_cbranch_scc1 .ap_161
    s_waitcnt vmcnt(4)
    s_bitcmp1_b64 s[14:15], 39
    s_cbranch_scc0 1
    s_waitcnt vmcnt(2)
    s_cmpk_ge_u32 s8, 1297
    s_cbranch_scc1 .ap_161
    s_waitcnt vmcnt(1)
.ap_161:
    s_add_u32 s63, s69, 57344
    buffer_load_dwordx4 v[188:191], v1, s[44:47], s63 offen nt
    s_memrealtime s[8:9]
    s_waitcnt vmcnt(8)
    s_waitcnt lgkmcnt(0)
    s_sub_u32 s8, s8, s30
    s_cmpk_ge_u32 s8, 1554
    s_cbranch_scc1 .ap_162
    s_waitcnt vmcnt(5)
    s_cmpk_ge_u32 s8, 1454
    s_cbranch_scc1 .ap_162
    s_waitcnt vmcnt(4)
    s_bitcmp1_b64 s[14:15], 40
    s_cbranch_scc0 1
    s_waitcnt vmcnt(2)
    s_cmpk_ge_u32 s8, 1334
    s_cbranch_scc1 .ap_162
    s_waitcnt vmcnt(1)
.ap_162:
    s_add_u32 s63, s69, 131072
    buffer_load_dwordx4 v[192:195], v1, s[44:47], s63 offen nt
    s_waitcnt vmcnt(5)
    s_branch .gpc_164
.gp_163:
    buffer_load_dwordx4 v[16:19], v7, s[36:39], s58 offen offset:0 sc1
    buffer_load_dwordx4 v[20:23], v7, s[36:39], s58 offen offset:256 sc1
    s_waitcnt vmcnt(0)
.gpc_164:
    v_min_u32 v10, v17, v19
    v_max_u32 v11, v17, v19
    v_min3_u32 v10, v10, v21, v23
    v_max3_u32 v11, v11, v21, v23
    v_cmp_eq_u32 vcc, s34, v10
    v_cmp_eq_u32 s[56:57], s34, v11
    s_and_b64 vcc, vcc, s[56:57]
    s_cmp_eq_u64 vcc, -1
    s_nop 2
    s_cbranch_scc1 .gpd_165
    s_sub_u32 s35, s35, 1
    s_cbranch_scc1 .Lexit
    s_sleep 1
    s_branch .gp_163
.gpd_165:
    s_mov_b32 vcc_lo, 0xcccccccc
    s_mov_b32 vcc_hi, 0xcccccccc
    v_cndmask_b32_e64 v24, v16, 0, vcc
    v_cndmask_b32_e64 v25, v18, 0, vcc
    v_cndmask_b32_e64 v26, v20, 0, vcc
    v_cndmask_b32_e64 v27, v22, 0, vcc
    v_cndmask_b32_e32 v28, 0, v16, vcc
    v_cndmask_b32_e32 v29, 0, v18, vcc
    v_cndmask_b32_e32 v30, 0, v20, vcc
    v_cndmask_b32_e32 v31, 0, v22, vcc
    v_mfma_f32_16x16x32_bf16 v[16:19], v[32:35], v[24:27], 0
    v_mfma_f32_16x16x32_bf16 v[32:35], v[40:43], v[24:27], 0
    v_mfma_f32_16x16x32_bf16 v[16:19], v[36:39], v[28:31], v[16:19]
    v_mfma_f32_16x16x32_bf16 v[40:43], v[48:51], v[24:27], 0
    v_mfma_f32_16x16x32_bf16 v[32:35], v[44:47], v[28:31], v[32:35]
    v_mfma_f32_16x16x32_bf16 v[48:51], v[56:59], v[24:27], 0
    v_mfma_f32_16x16x32_bf16 v[40:43], v[52:55], v[28:31], v[40:43]
    v_mfma_f32_16x16x32_bf16 v[56:59], v[64:67], v[24:27], 0
    v_mfma_f32_16x16x32_bf16 v[48:51], v[60:63], v[28:31], v[48:51]
    s_nop 1
    v_add_f32_dpp v10, v17, v16 row_ror:12 row_mask:0xf bank_mask:0x1
    s_memrealtime s[8:9]
    s_waitcnt lgkmcnt(0)
    s_sub_u32 s8, s8, s30
    s_cmpk_ge_u32 s8, 1591
    s_nop 0
    s_cbranch_scc1 .ap_166
    s_branch .Lsk_b1_1
.Lst_b1_1:
    s_branch .Lrt_b1_1
.Lsk_b1_1:
    s_waitcnt vmcnt(5)
    s_cmpk_ge_u32 s8, 1491
    s_cbranch_scc1 .ap_166
    s_waitcnt vmcnt(4)
    s_bitcmp1_b64 s[14:15], 41
    s_cbranch_scc0 1
    s_waitcnt vmcnt(2)
    s_cmpk_ge_u32 s8, 1371
    s_cbranch_scc1 .ap_166
    s_waitcnt vmcnt(1)
.ap_166:
    s_add_u32 s63, s69, 139264
    buffer_load_dwordx4 v[196:199], v1, s[44:47], s63 offen nt
    v_mfma_f32_16x16x32_bf16 v[64:67], v[72:75], v[24:27], 0
    v_mfma_f32_16x16x32_bf16 v[56:59], v[68:71], v[28:31], v[56:59]
    v_add_f32_dpp v11, v33, v32 row_ror:12 row_mask:0xf bank_mask:0x1
    v_add_f32_dpp v10, v18, v10 row_ror:8 row_mask:0xf bank_mask:0x1
    v_mfma_f32_16x16x32_bf16 v[72:75], v[80:83], v[24:27], 0
    v_mfma_f32_16x16x32_bf16 v[64:67], v[76:79], v[28:31], v[64:67]
    v_add_f32_dpp v12, v41, v40 row_ror:12 row_mask:0xf bank_mask:0x1
    v_add_f32_dpp v11, v34, v11 row_ror:8 row_mask:0xf bank_mask:0x1
    v_add_f32_dpp v10, v19, v10 row_ror:4 row_mask:0xf bank_mask:0x1
    v_mfma_f32_16x16x32_bf16 v[80:83], v[88:91], v[24:27], 0
    v_mfma_f32_16x16x32_bf16 v[72:75], v[84:87], v[28:31], v[72:75]
    v_add_f32_dpp v13, v49, v48 row_ror:12 row_mask:0xf bank_mask:0x1
    v_add_f32_dpp v12, v42, v12 row_ror:8 row_mask:0xf bank_mask:0x1
    v_add_f32_dpp v11, v35, v11 row_ror:4 row_mask:0xf bank_mask:0x1
    v_mfma_f32_16x16x32_bf16 v[88:91], v[96:99], v[24:27], 0
    v_mfma_f32_16x16x32_bf16 v[80:83], v[92:95], v[28:31], v[80:83]
    v_add_f32_dpp v10, v58, v57 row_ror:12 row_mask:0xf bank_mask:0x2
    v_add_f32_dpp v13, v50, v13 row_ror:8 row_mask:0xf bank_mask:0x1
    v_add_f32_dpp v12, v43, v12 row_ror:4 row_mask:0xf bank_mask:0x1
    s_memrealtime s[8:9]
    s_waitcnt lgkmcnt(0)
    s_sub_u32 s8, s8, s30
    s_cmpk_ge_u32 s8, 1602
    s_nop 0
    s_cbranch_scc1 .ap_167
    s_waitcnt vmcnt(5)
    s_cmpk_ge_u32 s8, 1502
    s_cbranch_scc1 .ap_167
    s_waitcnt vmcnt(4)
    s_bitcmp1_b64 s[14:15], 42
    s_cbranch_scc0 1
    s_waitcnt vmcnt(2)
    s_cmpk_ge_u32 s8, 1382
    s_cbranch_scc1 .ap_167
    s_waitcnt vmcnt(1)
.ap_167:
    s_add_u32 s63, s69, 147456
    buffer_load_dwordx4 v[200:203], v1, s[44:47], s63 offen nt
    s_memrealtime s[8:9]
    s_waitcnt lgkmcnt(0)
    s_sub_u32 s8, s8, s30
    s_cmpk_ge_u32 s8, 1613
    s_cbranch_scc1 .ap_168
    s_waitcnt vmcnt(5)
    s_cmpk_ge_u32 s8, 1513
    s_cbranch_scc1 .ap_168
    s_waitcnt vmcnt(4)
    s_cmpk_ge_u32 s8, 1393
    s_cbranch_scc1 .ap_168
    s_waitcnt vmcnt(1)
.ap_168:
    s_add_u32 m0, s101, 81920
    s_add_u32 s56, s100, 589824
    buffer_load_dwordx4 v6, s[52:55], s56 offen nt lds
    v_mfma_f32_16x16x32_bf16 v[96:99], v[104:107], v[24:27], 0
    v_mfma_f32_16x16x32_bf16 v[88:91], v[100:103], v[28:31], v[88:91]
    v_add_f32_dpp v11, v66, v65 row_ror:12 row_mask:0xf bank_mask:0x2
    v_add_f32_dpp v10, v59, v10 row_ror:8 row_mask:0xf bank_mask:0x2
    v_add_f32_dpp v13, v51, v13 row_ror:4 row_mask:0xf bank_mask:0x1
    v_mfma_f32_16x16x32_bf16 v[104:107], v[112:115], v[24:27], 0
    v_mfma_f32_16x16x32_bf16 v[96:99], v[108:111], v[28:31], v[96:99]
    v_add_f32_dpp v12, v74, v73 row_ror:12 row_mask:0xf bank_mask:0x2
    v_add_f32_dpp v11, v67, v11 row_ror:8 row_mask:0xf bank_mask:0x2
    v_add_f32_dpp v10, v56, v10 row_ror:4 row_mask:0xf bank_mask:0x2
    v_mfma_f32_16x16x32_bf16 v[112:115], v[120:123], v[24:27], 0
    v_mfma_f32_16x16x32_bf16 v[104:107], v[116:119], v[28:31], v[104:107]
    v_add_f32_dpp v13, v82, v81 row_ror:12 row_mask:0xf bank_mask:0x2
    v_add_f32_dpp v12, v75, v12 row_ror:8 row_mask:0xf bank_mask:0x2
    v_add_f32_dpp v11, v64, v11 row_ror:4 row_mask:0xf bank_mask:0x2
    v_mfma_f32_16x16x32_bf16 v[120:123], v[128:131], v[24:27], 0
    v_mfma_f32_16x16x32_bf16 v[112:115], v[124:127], v[28:31], v[112:115]
    v_add_f32_dpp v10, v91, v90 row_ror:12 row_mask:0xf bank_mask:0x4
    v_add_f32_dpp v13, v83, v13 row_ror:8 row_mask:0xf bank_mask:0x2
    v_add_f32_dpp v12, v72, v12 row_ror:4 row_mask:0xf bank_mask:0x2
    s_memrealtime s[8:9]
    s_waitcnt lgkmcnt(0)
    s_sub_u32 s8, s8, s30
    s_cmpk_ge_u32 s8, 1613
    s_nop 0
    s_cbranch_scc1 .ap_169
    s_waitcnt vmcnt(5)
    s_cmpk_ge_u32 s8, 1513
    s_cbranch_scc1 .ap_169
    s_waitcnt vmcnt(4)
    s_bitcmp1_b64 s[14:15], 43
    s_cbranch_scc0 1
    s_waitcnt vmcnt(2)
    s_cmpk_ge_u32 s8, 1393
    s_cbranch_scc1 .ap_169
    s_waitcnt vmcnt(1)
.ap_169:
    s_add_u32 s63, s69, 155648
    buffer_load_dwordx4 v[204:207], v1, s[44:47], s63 offen nt
    v_mfma_f32_16x16x32_bf16 v[128:131], v[136:139], v[24:27], 0
    v_mfma_f32_16x16x32_bf16 v[120:123], v[132:135], v[28:31], v[120:123]
    v_add_f32_dpp v11, v99, v98 row_ror:12 row_mask:0xf bank_mask:0x4
    v_add_f32_dpp v10, v88, v10 row_ror:8 row_mask:0xf bank_mask:0x4
    v_add_f32_dpp v13, v80, v13 row_ror:4 row_mask:0xf bank_mask:0x2
    v_mfma_f32_16x16x32_bf16 v[136:139], v[144:147], v[24:27], 0
    v_mfma_f32_16x16x32_bf16 v[128:131], v[140:143], v[28:31], v[128:131]
    v_add_f32_dpp v12, v107, v106 row_ror:12 row_mask:0xf bank_mask:0x4
    v_add_f32_dpp v11, v96, v11 row_ror:8 row_mask:0xf bank_mask:0x4
    v_add_f32_dpp v10, v89, v10 row_ror:4 row_mask:0xf bank_mask:0x4
    v_mfma_f32_16x16x32_bf16 v[144:147], v[152:155], v[24:27], 0
    v_mfma_f32_16x16x32_bf16 v[136:139], v[148:151], v[28:31], v[136:139]
    v_add_f32_dpp v13, v115, v114 row_ror:12 row_mask:0xf bank_mask:0x4
    v_add_f32_dpp v12, v104, v12 row_ror:8 row_mask:0xf bank_mask:0x4
    v_add_f32_dpp v11, v97, v11 row_ror:4 row_mask:0xf bank_mask:0x4
    v_mfma_f32_16x16x32_bf16 v[144:147], v[156:159], v[28:31], v[144:147]
    v_add_f32_dpp v10, v120, v123 row_ror:12 row_mask:0xf bank_mask:0x8
    v_add_f32_dpp v13, v112, v13 row_ror:8 row_mask:0xf bank_mask:0x4
    v_add_f32_dpp v12, v105, v12 row_ror:4 row_mask:0xf bank_mask:0x4
    s_memrealtime s[8:9]
    s_waitcnt vmcnt(8)
    s_waitcnt lgkmcnt(0)
    s_sub_u32 s8, s8, s30
    s_cmpk_ge_u32 s8, 1624
    s_cbranch_scc1 .ap_170
    s_waitcnt vmcnt(5)
    s_cmpk_ge_u32 s8, 1524
    s_cbranch_scc1 .ap_170
    s_waitcnt vmcnt(4)
    s_bitcmp1_b64 s[14:15], 44
    s_cbranch_scc0 1
    s_waitcnt vmcnt(2)
    s_cmpk_ge_u32 s8, 1404
    s_cbranch_scc1 .ap_170
    s_waitcnt vmcnt(1)
.ap_170:
    s_add_u32 s63, s69, 163840
    buffer_load_dwordx4 v[208:211], v1, s[44:47], s63 offen nt
    s_cmp_eq_u32 s3, 0
    s_cbranch_scc1 .Lst_b2_0
    s_cmp_eq_u32 s3, 1
    s_cbranch_scc1 .Lst_b2_1
    s_cmp_eq_u32 s3, 2
    s_cbranch_scc1 .Lst_b2_2
    s_cmp_eq_u32 s3, 3
    s_cbranch_scc1 .Lst_b2_3
.Lrt_b2_0:
.Lrt_b2_1:
.Lrt_b2_2:
.Lrt_b2_3:
    v_add_f32_dpp v11, v128, v131 row_ror:12 row_mask:0xf bank_mask:0x8
    v_add_f32_dpp v10, v121, v10 row_ror:8 row_mask:0xf bank_mask:0x8
    v_add_f32_dpp v13, v113, v13 row_ror:4 row_mask:0xf bank_mask:0x4
    v_add_f32_dpp v12, v136, v139 row_ror:12 row_mask:0xf bank_mask:0x8
    v_add_f32_dpp v11, v129, v11 row_ror:8 row_mask:0xf bank_mask:0x8
    v_add_f32_dpp v10, v122, v10 row_ror:4 row_mask:0xf bank_mask:0x8
    v_add_f32_dpp v13, v144, v147 row_ror:12 row_mask:0xf bank_mask:0x8
    v_add_f32_dpp v12, v137, v12 row_ror:8 row_mask:0xf bank_mask:0x8
    v_add_f32_dpp v11, v130, v11 row_ror:4 row_mask:0xf bank_mask:0x8
    v_add_f32_dpp v13, v145, v13 row_ror:8 row_mask:0xf bank_mask:0x8
    v_add_f32_dpp v12, v138, v12 row_ror:4 row_mask:0xf bank_mask:0x8
    s_memrealtime s[8:9]
    s_waitcnt vmcnt(8)
    s_waitcnt lgkmcnt(0)
    s_sub_u32 s8, s8, s30
    s_cmpk_ge_u32 s8, 1636
    s_cbranch_scc1 .ap_171
    s_waitcnt vmcnt(5)
    s_cmpk_ge_u32 s8, 1536
    s_cbranch_scc1 .ap_171
    s_waitcnt vmcnt(4)
    s_bitcmp1_b64 s[14:15], 45
    s_cbranch_scc0 1
    s_waitcnt vmcnt(2)
    s_cmpk_ge_u32 s8, 1416
    s_cbranch_scc1 .ap_171
    s_waitcnt vmcnt(1)
.ap_171:
    s_add_u32 s63, s69, 172032
    buffer_load_dwordx4 v[212:215], v1, s[44:47], s63 offen nt
    v_add_f32_dpp v13, v146, v13 row_ror:4 row_mask:0xf bank_mask:0x8
    s_mov_b32 s60, 0x3db504f3
    s_mov_b32 s61, 0x3db504f3
    s_branch .Lsk_b1_2
.Lst_b1_2:
    s_branch .Lrt_b1_2
.Lsk_b1_2:
    v_cvt_pk_bf16_f32 v10, v10, v11
    v_and_b32 v11, 0xffff0000, v10
    v_lshlrev_b32 v10, 16, v10
    v_cvt_pk_bf16_f32 v12, v12, v13
    v_and_b32 v13, 0xffff0000, v12
    v_lshlrev_b32 v12, 16, v12
    v_pk_mul_f32 v[10:11], v[10:11], s[60:61]
    v_pk_mul_f32 v[12:13], v[12:13], s[60:61]
    v_cvt_pk_bf16_f32 v10, v10, v11
    v_and_b32 v11, 0xffff0000, v10
    v_lshlrev_b32 v10, 16, v10
    v_cvt_pk_bf16_f32 v12, v12, v13
    v_and_b32 v13, 0xffff0000, v12
    v_lshlrev_b32 v12, 16, v12
    v_max_f32 v14, v10, v11
    v_max3_f32 v14, v14, v12, v13
    s_mov_b32 s60, 0x3fb8aa3b
    v_mov_b32 v22, s34
    v_mov_b32 v23, s34
    v_max_f32_dpp v14, v14, v14 quad_perm:[2,3,0,1] row_mask:0xf bank_mask:0xf
    s_nop 1
    v_max_f32_dpp v14, v14, v14 row_ror:4 row_mask:0xf bank_mask:0xf
    s_nop 1
    v_max_f32_dpp v14, v14, v14 row_ror:8 row_mask:0xf bank_mask:0xf
    v_mov_b32 v15, v14
    s_nop 1
    v_permlane16_swap_b32 v15, v14
    v_max_f32 v14, v15, v14
    v_mov_b32 v15, v14
    s_nop 1
    v_permlane32_swap_b32 v15, v14
    v_max_f32 v14, v15, v14
    v_mul_f32 v15, 0xbfb8aa3b, v14
    v_fma_f32 v10, v10, s60, v15
    v_fma_f32 v11, v11, s60, v15
    v_fma_f32 v12, v12, s60, v15
    v_fma_f32 v13, v13, s60, v15
    v_exp_f32 v10, v10
    v_exp_f32 v11, v11
    v_exp_f32 v12, v12
    v_exp_f32 v13, v13
    v_mov_b32 v20, v14
    v_pk_add_f32 v[16:17], v[10:11], v[12:13]
    v_add_f32 v21, v16, v17
    s_lshl_b32 s60, s68, 5
    s_lshl_b32 s61, s3, 4
    s_add_u32 s61, s61, 159104
    v_add_u32 v16, s61, v3
    v_mov_b32 v17, 159232
    v_mov_b32 v18, 1
    s_add_u32 s60, s60, s59
    v_add_f32_dpp v21, v21, v21 quad_perm:[2,3,0,1] row_mask:0xf bank_mask:0xf
    s_nop 1
    v_add_f32_dpp v21, v21, v21 row_ror:4 row_mask:0xf bank_mask:0xf
    s_nop 1
    v_add_f32_dpp v21, v21, v21 row_ror:8 row_mask:0xf bank_mask:0xf
    v_mov_b32 v15, v21
    s_nop 1
    v_permlane16_swap_b32 v15, v21
    v_add_f32 v21, v15, v21
    v_mov_b32 v15, v21
    s_nop 1
    v_permlane32_swap_b32 v15, v21
    v_add_f32 v21, v15, v21
    s_mov_b64 exec, 3
    ds_write_b64 v16, v[20:21]
    s_mov_b64 exec, 1
    ds_add_rtn_u32 v18, v17, v18
    s_mov_b64 exec, -1
    v_and_b32 v16, 0x78, v3
    v_or_b32 v16, 159104, v16
    s_waitcnt lgkmcnt(0)
    v_readfirstlane_b32 s61, v18
    s_cmp_eq_u32 s61, 7
    s_nop 3
    s_cbranch_scc0 .mlc_172
    ds_read_b64 v[18:19], v16
    s_waitcnt lgkmcnt(0)
    v_mov_b32 v20, v18
    s_nop 1
    v_max_f32_dpp v20, v20, v20 quad_perm:[2,3,0,1] row_mask:0xf bank_mask:0xf
    s_nop 1
    v_max_f32_dpp v20, v20, v20 row_ror:4 row_mask:0xf bank_mask:0xf
    s_nop 1
    v_max_f32_dpp v20, v20, v20 row_ror:8 row_mask:0xf bank_mask:0xf
    v_sub_f32 v18, v18, v20
    v_mul_f32 v18, 0x3fb8aa3b, v18
    v_exp_f32 v18, v18
    s_nop 0
    v_mul_f32 v21, v18, v19
    s_nop 1
    v_add_f32_dpp v21, v21, v21 quad_perm:[2,3,0,1] row_mask:0xf bank_mask:0xf
    s_nop 1
    v_add_f32_dpp v21, v21, v21 row_ror:4 row_mask:0xf bank_mask:0xf
    s_nop 1
    v_add_f32_dpp v21, v21, v21 row_ror:8 row_mask:0xf bank_mask:0xf
    s_mov_b64 exec, 3
    buffer_store_dwordx4 v[20:23], v2, s[36:39], s60 offen sc1
    s_mov_b64 exec, -1
.mlc_172:
    s_memrealtime s[8:9]
    s_waitcnt vmcnt(8)
    s_waitcnt lgkmcnt(0)
    s_sub_u32 s8, s8, s30
    s_cmpk_ge_u32 s8, 1668
    s_cbranch_scc1 .ap_173
    s_waitcnt vmcnt(5)
    s_cmpk_ge_u32 s8, 1568
    s_cbranch_scc1 .ap_173
    s_waitcnt vmcnt(4)
    s_bitcmp1_b64 s[14:15], 46
    s_cbranch_scc0 1
    s_waitcnt vmcnt(2)
    s_cmpk_ge_u32 s8, 1448
    s_cbranch_scc1 .ap_173
    s_waitcnt vmcnt(1)
.ap_173:
    s_add_u32 s63, s69, 180224
    buffer_load_dwordx4 v[216:219], v1, s[44:47], s63 offen nt
    s_memrealtime s[8:9]
    s_waitcnt vmcnt(8)
    s_waitcnt lgkmcnt(0)
    s_sub_u32 s8, s8, s30
    s_cmpk_ge_u32 s8, 1700
    s_cbranch_scc1 .ap_174
    s_waitcnt vmcnt(5)
    s_cmpk_ge_u32 s8, 1600
    s_cbranch_scc1 .ap_174
    s_waitcnt vmcnt(4)
    s_bitcmp1_b64 s[14:15], 47
    s_cbranch_scc0 1
    s_waitcnt vmcnt(2)
    s_cmpk_ge_u32 s8, 1480
    s_cbranch_scc1 .ap_174
    s_waitcnt vmcnt(1)
.ap_174:
    s_add_u32 s63, s69, 188416
    buffer_load_dwordx4 v[220:223], v1, s[44:47], s63 offen nt
    s_and_b32 s56, s64, 0
    s_mul_i32 s56, s56, 18432
    s_mul_i32 s57, s3, 2304
    s_add_u32 s56, s56, s57
    s_add_u32 s56, s56, 0x37000
    buffer_load_dwordx4 v[32:35], v2, s[36:39], s56 offen offset:0 sc1
    buffer_load_dwordx4 v[40:43], v2, s[36:39], s56 offen offset:1024 sc1
    buffer_load_dwordx2 v[48:49], v5, s[36:39], s56 offen offset:0 sc1
    s_memrealtime s[8:9]
    s_waitcnt vmcnt(11)
    s_waitcnt lgkmcnt(0)
    s_sub_u32 s8, s8, s30
    s_cmpk_ge_u32 s8, 1732
    s_cbranch_scc1 .ap_175
    s_waitcnt vmcnt(8)
    s_cmpk_ge_u32 s8, 1632
    s_cbranch_scc1 .ap_175
    s_waitcnt vmcnt(7)
    s_bitcmp1_b64 s[14:15], 48
    s_cbranch_scc0 1
    s_waitcnt vmcnt(5)
    s_cmpk_ge_u32 s8, 1512
    s_cbranch_scc1 .ap_175
    s_branch .Lsk_b1_3
.Lst_b1_3:
    s_branch .Lrt_b1_3
.Lsk_b1_3:
    s_waitcnt vmcnt(4)
.ap_175:
    s_add_u32 s63, s69, 262144
    buffer_load_dwordx4 v[224:227], v1, s[44:47], s63 offen nt
    s_memrealtime s[8:9]
    s_waitcnt vmcnt(11)
    s_waitcnt lgkmcnt(0)
    s_sub_u32 s8, s8, s30
    s_cmpk_ge_u32 s8, 1764
    s_cbranch_scc1 .ap_176
    s_waitcnt vmcnt(8)
    s_cmpk_ge_u32 s8, 1664
    s_cbranch_scc1 .ap_176
    s_waitcnt vmcnt(7)
    s_bitcmp1_b64 s[14:15], 49
    s_cbranch_scc0 1
    s_waitcnt vmcnt(5)
    s_cmpk_ge_u32 s8, 1544
    s_cbranch_scc1 .ap_176
    s_waitcnt vmcnt(4)
.ap_176:
    s_add_u32 s63, s69, 270336
    buffer_load_dwordx4 v[228:231], v1, s[44:47], s63 offen nt
    s_and_b32 s56, s64, 0
    s_mul_i32 s56, s56, 18432
    s_mul_i32 s57, s3, 2304
    s_add_u32 s56, s56, s57
    s_add_u32 s56, s56, 0x49000
    buffer_load_dwordx4 v[56:59], v2, s[36:39], s56 offen offset:0 sc1
    buffer_load_dwordx4 v[64:67], v2, s[36:39], s56 offen offset:1024 sc1
    buffer_load_dwordx2 v[72:73], v5, s[36:39], s56 offen offset:0 sc1
    s_memrealtime s[8:9]
    s_waitcnt vmcnt(14)
    s_waitcnt lgkmcnt(0)
    s_sub_u32 s8, s8, s30
    s_cmpk_ge_u32 s8, 1796
    s_cbranch_scc1 .ap_177
    s_waitcnt vmcnt(11)
    s_cmpk_ge_u32 s8, 1696
    s_cbranch_scc1 .ap_177
    s_waitcnt vmcnt(10)
    s_bitcmp1_b64 s[14:15], 50
    s_cbranch_scc0 1
    s_waitcnt vmcnt(8)
    s_cmpk_ge_u32 s8, 1576
    s_cbranch_scc1 .ap_177
    s_waitcnt vmcnt(4)
.ap_177:
    s_add_u32 s63, s69, 278528
    buffer_load_dwordx4 v[232:235], v1, s[44:47], s63 offen nt
    s_memrealtime s[8:9]
    s_waitcnt vmcnt(14)
    s_waitcnt lgkmcnt(0)
    s_sub_u32 s8, s8, s30
    s_cmpk_ge_u32 s8, 1828
    s_cbranch_scc1 .ap_178
    s_waitcnt vmcnt(11)
    s_cmpk_ge_u32 s8, 1728
    s_cbranch_scc1 .ap_178
    s_waitcnt vmcnt(10)
    s_bitcmp1_b64 s[14:15], 51
    s_cbranch_scc0 1
    s_waitcnt vmcnt(5)
    s_cmpk_ge_u32 s8, 1608
    s_cbranch_scc1 .ap_178
    s_waitcnt vmcnt(4)
.ap_178:
    s_add_u32 s63, s69, 286720
    buffer_load_dwordx4 v[236:239], v1, s[44:47], s63 offen nt
    s_memrealtime s[8:9]
    s_waitcnt vmcnt(14)
    s_waitcnt lgkmcnt(0)
    s_sub_u32 s8, s8, s30
    s_cmpk_ge_u32 s8, 1860
    s_cbranch_scc1 .ap_179
    s_waitcnt vmcnt(11)
    s_cmpk_ge_u32 s8, 1760
    s_cbranch_scc1 .ap_179
    s_waitcnt vmcnt(10)
    s_bitcmp1_b64 s[14:15], 52
    s_cbranch_scc0 1
    s_waitcnt vmcnt(5)
    s_cmpk_ge_u32 s8, 1640
    s_cbranch_scc1 .ap_179
    s_waitcnt vmcnt(1)
.ap_179:
    s_add_u32 s63, s69, 294912
    buffer_load_dwordx4 v[240:243], v1, s[44:47], s63 offen nt
    s_memrealtime s[8:9]
    s_waitcnt vmcnt(14)
    s_waitcnt lgkmcnt(0)
    s_sub_u32 s8, s8, s30
    s_cmpk_ge_u32 s8, 1892
    s_cbranch_scc1 .ap_180
    s_waitcnt vmcnt(11)
    s_cmpk_ge_u32 s8, 1792
    s_cbranch_scc1 .ap_180
    s_waitcnt vmcnt(7)
    s_bitcmp1_b64 s[14:15], 53
    s_cbranch_scc0 1
    s_waitcnt vmcnt(2)
    s_cmpk_ge_u32 s8, 1672
    s_cbranch_scc1 .ap_180
    s_waitcnt vmcnt(1)
.ap_180:
    s_add_u32 s63, s69, 303104
    buffer_load_dwordx4 v[244:247], v1, s[44:47], s63 offen nt
    s_and_b32 s0, s0, 0xffffff80
    s_sub_u32 s0, s0, 1024
    buffer_load_dword v28, v4, s[36:39], s0 offen sc1
    buffer_load_dwordx4 v[24:27], v9, s[36:39], s59 offen offset:0 sc1
    s_memrealtime s[8:9]
    s_waitcnt vmcnt(15)
    s_waitcnt lgkmcnt(0)
    s_sub_u32 s8, s8, s30
    s_cmpk_ge_u32 s8, 1924
    s_cbranch_scc1 .ap_181
    s_waitcnt vmcnt(9)
    s_cmpk_ge_u32 s8, 1824
    s_cbranch_scc1 .ap_181
    s_waitcnt vmcnt(5)
    s_bitcmp1_b64 s[14:15], 54
    s_cbranch_scc0 1
    s_waitcnt vmcnt(3)
    s_cmpk_ge_u32 s8, 1704
    s_cbranch_scc1 .ap_181
    s_waitcnt vmcnt(2)
.ap_181:
    s_add_u32 s63, s69, 311296
    buffer_load_dwordx4 v[248:251], v1, s[44:47], s63 offen nt
    s_memrealtime s[8:9]
    s_waitcnt vmcnt(15)
    s_waitcnt lgkmcnt(0)
    s_sub_u32 s8, s8, s30
    s_cmpk_ge_u32 s8, 1956
    s_cbranch_scc1 .ap_182
    s_waitcnt vmcnt(6)
    s_cmpk_ge_u32 s8, 1856
    s_cbranch_scc1 .ap_182
    s_waitcnt vmcnt(5)
    s_bitcmp1_b64 s[14:15], 55
    s_cbranch_scc0 1
    s_waitcnt vmcnt(3)
    s_cmpk_ge_u32 s8, 1736
    s_cbranch_scc1 .ap_182
    s_waitcnt vmcnt(1)
.ap_182:
    s_add_u32 s63, s69, 319488
    buffer_load_dwordx4 v[252:255], v1, s[44:47], s63 offen nt
    s_memrealtime s[8:9]
    s_waitcnt vmcnt(12)
    s_waitcnt lgkmcnt(0)
    s_sub_u32 s8, s8, s30
    s_cmpk_ge_u32 s8, 1988
    s_cbranch_scc1 .ap_183
    s_waitcnt vmcnt(6)
    s_cmpk_ge_u32 s8, 1888
    s_cbranch_scc1 .ap_183
    s_waitcnt vmcnt(5)
    s_bitcmp1_b64 s[14:15], 56
    s_cbranch_scc0 1
    s_waitcnt vmcnt(2)
    s_cmpk_ge_u32 s8, 1768
    s_cbranch_scc1 .ap_183
    s_waitcnt vmcnt(1)
.ap_183:
    s_add_u32 s63, s69, 393216
    buffer_load_dwordx4 v[36:39], v1, s[44:47], s63 offen nt
    s_memrealtime s[8:9]
    s_waitcnt vmcnt(12)
    s_waitcnt lgkmcnt(0)
    s_sub_u32 s8, s8, s30
    s_cmpk_ge_u32 s8, 2020
    s_cbranch_scc1 .ap_184
    s_waitcnt vmcnt(6)
    s_cmpk_ge_u32 s8, 1920
    s_cbranch_scc1 .ap_184
    s_waitcnt vmcnt(5)
    s_bitcmp1_b64 s[14:15], 57
    s_cbranch_scc0 1
    s_waitcnt vmcnt(2)
    s_cmpk_ge_u32 s8, 1800
    s_cbranch_scc1 .ap_184
    s_waitcnt vmcnt(1)
.ap_184:
    s_add_u32 s63, s69, 401408
    buffer_load_dwordx4 v[44:47], v1, s[44:47], s63 offen nt
    s_memrealtime s[8:9]
    s_waitcnt vmcnt(9)
    s_waitcnt lgkmcnt(0)
    s_sub_u32 s8, s8, s30
    s_cmpk_ge_u32 s8, 2052
    s_cbranch_scc1 .ap_185
    s_waitcnt vmcnt(6)
    s_cmpk_ge_u32 s8, 1952
    s_cbranch_scc1 .ap_185
    s_waitcnt vmcnt(4)
    s_bitcmp1_b64 s[14:15], 58
    s_cbranch_scc0 1
    s_waitcnt vmcnt(2)
    s_cmpk_ge_u32 s8, 1832
    s_cbranch_scc1 .ap_185
    s_waitcnt vmcnt(1)
.ap_185:
    s_add_u32 s63, s69, 409600
    buffer_load_dwordx4 v[52:55], v1, s[44:47], s63 offen nt
    s_waitcnt vmcnt(5)
    s_branch .gpc_187
.gp_186:
    buffer_load_dwordx4 v[24:27], v9, s[36:39], s59 offen offset:0 sc1
    s_waitcnt vmcnt(0)
.gpc_187:
    v_cmp_eq_u32 vcc, s34, v26
    s_cmp_eq_u64 vcc, -1
    s_nop 3
    s_cbranch_scc1 .gpd_188
    s_sub_u32 s35, s35, 1
    s_cbranch_scc1 .Lexit
    s_sleep 1
    s_branch .gp_186
.gpd_188:
    v_cmp_eq_u32 vcc, s1, v28
    s_cmp_eq_u64 vcc, -1
    s_cselect_b32 s0, 0x800000, 0
    v_mov_b32 v16, v24
    s_nop 1
    v_max_f32_dpp v16, v16, v16 row_ror:4 row_mask:0xf bank_mask:0xf
    v_sub_f32 v17, v24, v16
    v_sub_f32 v18, v14, v16
    v_mul_f32 v17, 0x3fb8aa3b, v17
    v_mul_f32 v18, 0x3fb8aa3b, v18
    v_exp_f32 v17, v17
    s_branch .Lsk_b1_4
.Lst_b1_4:
    s_branch .Lrt_b1_4
.Lsk_b1_4:
    v_exp_f32 v18, v18
    v_mul_f32 v17, v17, v25
    s_nop 1
    v_add_f32_dpp v17, v17, v17 row_ror:4 row_mask:0xf bank_mask:0xf
    v_rcp_f32 v19, v17
    s_nop 0
    v_fma_f32 v15, -v17, v19, 1.0
    v_fma_f32 v19, v15, v19, v19
    v_mul_f32 v18, v18, v19
    v_mul_f32 v10, v10, v18
    v_mul_f32 v11, v11, v18
    v_mul_f32 v12, v12, v18
    v_mul_f32 v13, v13, v18
    v_mov_b32_dpp v112, v10 quad_perm:[2,3,0,1] row_mask:0xf bank_mask:0xf
    v_mov_b32_dpp v113, v11 quad_perm:[2,3,0,1] row_mask:0xf bank_mask:0xf
    v_mov_b32_dpp v114, v12 quad_perm:[2,3,0,1] row_mask:0xf bank_mask:0xf
    v_mov_b32_dpp v115, v13 quad_perm:[2,3,0,1] row_mask:0xf bank_mask:0xf
    v_cvt_pk_bf16_f32 v96, v10, v112
    v_cvt_pk_bf16_f32 v100, v11, v113
    v_cvt_pk_bf16_f32 v104, v12, v114
    v_cvt_pk_bf16_f32 v108, v13, v115
    v_mov_b32_dpp v97, v96 row_ror:12 row_mask:0xf bank_mask:0xf
    v_mov_b32_dpp v101, v100 row_ror:12 row_mask:0xf bank_mask:0xf
    v_mov_b32_dpp v105, v104 row_ror:12 row_mask:0xf bank_mask:0xf
    v_mov_b32_dpp v109, v108 row_ror:12 row_mask:0xf bank_mask:0xf
    v_mov_b32_dpp v98, v96 row_ror:8 row_mask:0xf bank_mask:0xf
    v_mov_b32_dpp v102, v100 row_ror:8 row_mask:0xf bank_mask:0xf
    v_mov_b32_dpp v106, v104 row_ror:8 row_mask:0xf bank_mask:0xf
    v_mov_b32_dpp v110, v108 row_ror:8 row_mask:0xf bank_mask:0xf
    v_mov_b32_dpp v99, v96 row_ror:4 row_mask:0xf bank_mask:0xf
    v_mov_b32_dpp v103, v100 row_ror:4 row_mask:0xf bank_mask:0xf
    v_mov_b32_dpp v107, v104 row_ror:4 row_mask:0xf bank_mask:0xf
    v_mov_b32_dpp v111, v108 row_ror:4 row_mask:0xf bank_mask:0xf
    s_lshl_b32 s60, s3, 10
    s_add_u32 s60, s60, 147456
    v_lshlrev_b32 v10, 5, v0
    v_add_u32 v10, s60, v10
    s_memrealtime s[8:9]
    s_waitcnt lgkmcnt(0)
    s_sub_u32 s8, s8, s30
    s_cmpk_ge_u32 s8, 2084
    s_cbranch_scc1 .ap_189
    s_waitcnt vmcnt(5)
    s_cmpk_ge_u32 s8, 1984
    s_cbranch_scc1 .ap_189
    s_waitcnt vmcnt(4)
    s_bitcmp1_b64 s[14:15], 59
    s_cbranch_scc0 1
    s_waitcnt vmcnt(2)
    s_cmpk_ge_u32 s8, 1864
    s_cbranch_scc1 .ap_189
    s_waitcnt vmcnt(1)
.ap_189:
    s_add_u32 s63, s69, 417792
    buffer_load_dwordx4 v[60:63], v1, s[44:47], s63 offen nt
    v_perm_b32 v112, v164, v160, s94
    v_perm_b32 v113, v172, v168, s94
    v_perm_b32 v114, v180, v176, s94
    v_perm_b32 v115, v188, v184, s94
    s_nop 1
    v_mfma_f32_16x16x32_bf16 v[128:131], v[96:99], v[112:115], 0
    v_perm_b32 v116, v164, v160, s95
    v_perm_b32 v117, v172, v168, s95
    v_perm_b32 v118, v180, v176, s95
    v_perm_b32 v119, v188, v184, s95
    s_nop 1
    v_mfma_f32_16x16x32_bf16 v[132:135], v[96:99], v[116:119], 0
    v_perm_b32 v120, v165, v161, s94
    v_perm_b32 v121, v173, v169, s94
    v_perm_b32 v122, v181, v177, s94
    v_perm_b32 v123, v189, v185, s94
    s_nop 1
    v_mfma_f32_16x16x32_bf16 v[136:139], v[96:99], v[120:123], 0
    v_perm_b32 v124, v165, v161, s95
    v_perm_b32 v125, v173, v169, s95
    v_perm_b32 v126, v181, v177, s95
    v_perm_b32 v127, v189, v185, s95
    s_nop 1
    v_mfma_f32_16x16x32_bf16 v[140:143], v[96:99], v[124:127], 0
    v_perm_b32 v112, v166, v162, s94
    v_perm_b32 v113, v174, v170, s94
    v_perm_b32 v114, v182, v178, s94
    v_perm_b32 v115, v190, v186, s94
    s_nop 1
    v_mfma_f32_16x16x32_bf16 v[144:147], v[96:99], v[112:115], 0
    v_perm_b32 v116, v166, v162, s95
    v_perm_b32 v117, v174, v170, s95
    v_perm_b32 v118, v182, v178, s95
    v_perm_b32 v119, v190, v186, s95
    s_nop 1
    v_mfma_f32_16x16x32_bf16 v[148:151], v[96:99], v[116:119], 0
    v_perm_b32 v120, v167, v163, s94
    v_perm_b32 v121, v175, v171, s94
    v_perm_b32 v122, v183, v179, s94
    v_perm_b32 v123, v191, v187, s94
    s_nop 1
    v_mfma_f32_16x16x32_bf16 v[152:155], v[96:99], v[120:123], 0
    v_perm_b32 v124, v167, v163, s95
    v_perm_b32 v125, v175, v171, s95
    v_perm_b32 v126, v183, v179, s95
    v_perm_b32 v127, v191, v187, s95
    s_nop 1
    v_mfma_f32_16x16x32_bf16 v[156:159], v[96:99], v[124:127], 0
    s_memrealtime s[8:9]
    s_waitcnt lgkmcnt(0)
    s_sub_u32 s8, s8, s30
    s_cmpk_ge_u32 s8, 2116
    s_nop 3
    s_cbranch_scc1 .ap_190
    s_waitcnt vmcnt(5)
    s_cmpk_ge_u32 s8, 2016
    s_cbranch_scc1 .ap_190
    s_waitcnt vmcnt(4)
    s_bitcmp1_b64 s[14:15], 60
    s_cbranch_scc0 1
    s_waitcnt vmcnt(2)
    s_cmpk_ge_u32 s8, 1896
    s_cbranch_scc1 .ap_190
    s_waitcnt vmcnt(1)
.ap_190:
    s_add_u32 s63, s69, 425984
    buffer_load_dwordx4 v[68:71], v1, s[44:47], s63 offen nt
    v_perm_b32 v112, v196, v192, s94
    v_perm_b32 v113, v204, v200, s94
    v_perm_b32 v114, v212, v208, s94
    v_perm_b32 v115, v220, v216, s94
    s_nop 1
    v_mfma_f32_16x16x32_bf16 v[128:131], v[100:103], v[112:115], v[128:131]
    v_perm_b32 v116, v196, v192, s95
    v_perm_b32 v117, v204, v200, s95
    v_perm_b32 v118, v212, v208, s95
    v_perm_b32 v119, v220, v216, s95
    s_nop 1
    v_mfma_f32_16x16x32_bf16 v[132:135], v[100:103], v[116:119], v[132:135]
    v_perm_b32 v120, v197, v193, s94
    v_perm_b32 v121, v205, v201, s94
    v_perm_b32 v122, v213, v209, s94
    v_perm_b32 v123, v221, v217, s94
    s_nop 1
    v_mfma_f32_16x16x32_bf16 v[136:139], v[100:103], v[120:123], v[136:139]
    v_perm_b32 v124, v197, v193, s95
    v_perm_b32 v125, v205, v201, s95
    v_perm_b32 v126, v213, v209, s95
    v_perm_b32 v127, v221, v217, s95
    s_nop 1
    v_mfma_f32_16x16x32_bf16 v[140:143], v[100:103], v[124:127], v[140:143]
    v_perm_b32 v112, v198, v194, s94
    v_perm_b32 v113, v206, v202, s94
    v_perm_b32 v114, v214, v210, s94
    v_perm_b32 v115, v222, v218, s94
    s_nop 1
    v_mfma_f32_16x16x32_bf16 v[144:147], v[100:103], v[112:115], v[144:147]
    v_perm_b32 v116, v198, v194, s95
    v_perm_b32 v117, v206, v202, s95
    v_perm_b32 v118, v214, v210, s95
    v_perm_b32 v119, v222, v218, s95
    s_nop 1
    v_mfma_f32_16x16x32_bf16 v[148:151], v[100:103], v[116:119], v[148:151]
    v_perm_b32 v120, v199, v195, s94
    v_perm_b32 v121, v207, v203, s94
    v_perm_b32 v122, v215, v211, s94
    v_perm_b32 v123, v223, v219, s94
    s_nop 1
    v_mfma_f32_16x16x32_bf16 v[152:155], v[100:103], v[120:123], v[152:155]
    v_perm_b32 v124, v199, v195, s95
    v_perm_b32 v125, v207, v203, s95
    v_perm_b32 v126, v215, v211, s95
    v_perm_b32 v127, v223, v219, s95
    s_nop 1
    v_mfma_f32_16x16x32_bf16 v[156:159], v[100:103], v[124:127], v[156:159]
    s_branch .Lsk_b1_5
.Lst_b1_5:
    s_branch .Lrt_b1_5
.Lsk_b1_5:
    s_memrealtime s[8:9]
    s_waitcnt lgkmcnt(0)
    s_sub_u32 s8, s8, s30
    s_cmpk_ge_u32 s8, 2148
    s_nop 3
    s_cbranch_scc1 .ap_191
    s_waitcnt vmcnt(5)
    s_cmpk_ge_u32 s8, 2048
    s_cbranch_scc1 .ap_191
    s_waitcnt vmcnt(4)
    s_bitcmp1_b64 s[14:15], 61
    s_cbranch_scc0 1
    s_waitcnt vmcnt(2)
    s_cmpk_ge_u32 s8, 1928
    s_cbranch_scc1 .ap_191
    s_waitcnt vmcnt(1)
.ap_191:
    s_add_u32 s63, s69, 434176
    buffer_load_dwordx4 v[76:79], v1, s[44:47], s63 offen nt
    s_waitcnt vmcnt(6)
    v_perm_b32 v112, v228, v224, s94
    v_perm_b32 v113, v236, v232, s94
    v_perm_b32 v114, v244, v240, s94
    v_perm_b32 v115, v252, v248, s94
    s_nop 1
    v_mfma_f32_16x16x32_bf16 v[128:131], v[104:107], v[112:115], v[128:131]
    v_perm_b32 v116, v228, v224, s95
    v_perm_b32 v117, v236, v232, s95
    v_perm_b32 v118, v244, v240, s95
    v_perm_b32 v119, v252, v248, s95
    s_nop 1
    v_mfma_f32_16x16x32_bf16 v[132:135], v[104:107], v[116:119], v[132:135]
    v_perm_b32 v120, v229, v225, s94
    v_perm_b32 v121, v237, v233, s94
    v_perm_b32 v122, v245, v241, s94
    v_perm_b32 v123, v253, v249, s94
    s_nop 1
    v_mfma_f32_16x16x32_bf16 v[136:139], v[104:107], v[120:123], v[136:139]
    v_perm_b32 v124, v229, v225, s95
    v_perm_b32 v125, v237, v233, s95
    v_perm_b32 v126, v245, v241, s95
    v_perm_b32 v127, v253, v249, s95
    s_nop 1
    v_mfma_f32_16x16x32_bf16 v[140:143], v[104:107], v[124:127], v[140:143]
    v_perm_b32 v112, v230, v226, s94
    v_perm_b32 v113, v238, v234, s94
    v_perm_b32 v114, v246, v242, s94
    v_perm_b32 v115, v254, v250, s94
    s_nop 1
    v_mfma_f32_16x16x32_bf16 v[144:147], v[104:107], v[112:115], v[144:147]
    v_perm_b32 v116, v230, v226, s95
    v_perm_b32 v117, v238, v234, s95
    v_perm_b32 v118, v246, v242, s95
    v_perm_b32 v119, v254, v250, s95
    s_nop 1
    v_mfma_f32_16x16x32_bf16 v[148:151], v[104:107], v[116:119], v[148:151]
    v_perm_b32 v120, v231, v227, s94
    v_perm_b32 v121, v239, v235, s94
    v_perm_b32 v122, v247, v243, s94
    v_perm_b32 v123, v255, v251, s94
    s_nop 1
    v_mfma_f32_16x16x32_bf16 v[152:155], v[104:107], v[120:123], v[152:155]
    v_perm_b32 v124, v231, v227, s95
    v_perm_b32 v125, v239, v235, s95
    v_perm_b32 v126, v247, v243, s95
    v_perm_b32 v127, v255, v251, s95
    s_nop 1
    v_mfma_f32_16x16x32_bf16 v[156:159], v[104:107], v[124:127], v[156:159]
    s_memrealtime s[8:9]
    s_waitcnt lgkmcnt(0)
    s_sub_u32 s8, s8, s30
    s_cmpk_ge_u32 s8, 2180
    s_nop 3
    s_cbranch_scc1 .ap_192
    s_waitcnt vmcnt(5)
    s_cmpk_ge_u32 s8, 2080
    s_cbranch_scc1 .ap_192
    s_waitcnt vmcnt(4)
    s_bitcmp1_b64 s[14:15], 62
    s_cbranch_scc0 1
    s_waitcnt vmcnt(2)
    s_cmpk_ge_u32 s8, 1960
    s_cbranch_scc1 .ap_192
    s_waitcnt vmcnt(1)
.ap_192:
    s_add_u32 s63, s69, 442368
    buffer_load_dwordx4 v[84:87], v1, s[44:47], s63 offen nt
    s_memrealtime s[8:9]
    s_waitcnt lgkmcnt(0)
    s_sub_u32 s8, s8, s30
    s_cmpk_ge_u32 s8, 2212
    s_cbranch_scc1 .ap_193
    s_waitcnt vmcnt(5)
    s_cmpk_ge_u32 s8, 2112
    s_cbranch_scc1 .ap_193
    s_waitcnt vmcnt(4)
    s_bitcmp1_b64 s[14:15], 63
    s_cbranch_scc0 1
    s_waitcnt vmcnt(2)
    s_cmpk_ge_u32 s8, 1992
    s_cbranch_scc1 .ap_193
    s_waitcnt vmcnt(1)
.ap_193:
    s_add_u32 s63, s69, 450560
    buffer_load_dwordx4 v[92:95], v1, s[44:47], s63 offen nt
    s_setprio 0
    s_waitcnt vmcnt(6)
    v_perm_b32 v160, v44, v36, s94
    v_perm_b32 v164, v44, v36, s95
    v_perm_b32 v168, v45, v37, s94
    v_perm_b32 v172, v45, v37, s95
    v_perm_b32 v176, v46, v38, s94
    v_perm_b32 v180, v46, v38, s95
    v_perm_b32 v184, v47, v39, s94
    v_perm_b32 v188, v47, v39, s95
    s_waitcnt vmcnt(4)
    v_perm_b32 v161, v60, v52, s94
    v_perm_b32 v165, v60, v52, s95
    v_perm_b32 v169, v61, v53, s94
    v_perm_b32 v173, v61, v53, s95
    v_perm_b32 v177, v62, v54, s94
    v_perm_b32 v181, v62, v54, s95
    v_perm_b32 v185, v63, v55, s94
    v_perm_b32 v189, v63, v55, s95
    s_waitcnt vmcnt(2)
    v_perm_b32 v162, v76, v68, s94
    v_perm_b32 v166, v76, v68, s95
    v_perm_b32 v170, v77, v69, s94
    v_perm_b32 v174, v77, v69, s95
    v_perm_b32 v178, v78, v70, s94
    v_perm_b32 v182, v78, v70, s95
    v_perm_b32 v186, v79, v71, s94
    v_perm_b32 v190, v79, v71, s95
    s_branch .Lsk_b1_6
    .fill 59, 4, 0xbf800000
.Lst_b1_6:
    s_branch .Lrt_b1_6
.Lsk_b1_6:
    s_waitcnt vmcnt(0)
    s_add_u32 m0, s101, 90112
    s_add_u32 s56, s100, 1179648
    buffer_load_dwordx4 v6, s[52:55], s56 offen nt lds
    s_add_u32 m0, s101, 98304
    s_add_u32 s56, s100, 1769472
    buffer_load_dwordx4 v6, s[52:55], s56 offen nt lds
    s_add_u32 m0, s101, 106496
    s_add_u32 s56, s100, 2359296
    buffer_load_dwordx4 v6, s[52:55], s56 offen nt lds
    s_add_u32 m0, s101, 114688
    s_add_u32 s56, s100, 2949120
    buffer_load_dwordx4 v6, s[52:55], s56 offen nt lds
    v_perm_b32 v163, v92, v84, s94
    v_perm_b32 v167, v92, v84, s95
    v_perm_b32 v171, v93, v85, s94
    v_mfma_f32_16x16x32_bf16 v[128:131], v[108:111], v[160:163], v[128:131]
    v_perm_b32 v175, v93, v85, s95
    v_mfma_f32_16x16x32_bf16 v[132:135], v[108:111], v[164:167], v[132:135]
    v_perm_b32 v179, v94, v86, s94
    v_mfma_f32_16x16x32_bf16 v[136:139], v[108:111], v[168:171], v[136:139]
    v_perm_b32 v183, v94, v86, s95
    v_mfma_f32_16x16x32_bf16 v[140:143], v[108:111], v[172:175], v[140:143]
    v_perm_b32 v187, v95, v87, s94
    v_mfma_f32_16x16x32_bf16 v[144:147], v[108:111], v[176:179], v[144:147]
    v_perm_b32 v191, v95, v87, s95
    v_mfma_f32_16x16x32_bf16 v[148:151], v[108:111], v[180:183], v[148:151]
    v_mfma_f32_16x16x32_bf16 v[152:155], v[108:111], v[184:187], v[152:155]
    v_mfma_f32_16x16x32_bf16 v[156:159], v[108:111], v[188:191], v[156:159]
    s_mov_b64 exec, 0xffff
    ds_write2_b32 v10, v128, v129 offset0:0 offset1:128
    ds_write2_b32 v10, v132, v133 offset0:1 offset1:129
    ds_write2_b32 v10, v136, v137 offset0:2 offset1:130
    ds_write2_b32 v10, v140, v141 offset0:3 offset1:131
    ds_write2_b32 v10, v144, v145 offset0:4 offset1:132
    ds_write2_b32 v10, v148, v149 offset0:5 offset1:133
    ds_write2_b32 v10, v152, v153 offset0:6 offset1:134
    ds_write2_b32 v10, v156, v157 offset0:7 offset1:135
    s_mov_b64 exec, -1
    s_waitcnt lgkmcnt(0)
    s_barrier
    s_cmp_lg_u32 s3, 7
    s_cbranch_scc1 .opub_194
    v_add_u32 v10, 147456, v2
    ds_read_b128 v[196:199], v10 offset:0
    ds_read_b128 v[200:203], v10 offset:1024
    ds_read_b128 v[204:207], v10 offset:2048
    ds_read_b128 v[208:211], v10 offset:3072
    ds_read_b128 v[212:215], v10 offset:4096
    ds_read_b128 v[216:219], v10 offset:5120
    ds_read_b128 v[220:223], v10 offset:6144
    ds_read_b128 v[224:227], v10 offset:7168
    v_lshrrev_b32 v11, 5, v0
    v_lshlrev_b32 v11, 13, v11
    v_and_b32 v12, 31, v0
    v_lshl_add_u32 v11, v12, 4, v11
    s_lshl4_add_u32 s56, s67, s66
    s_lshl1_add_u32 s56, s56, s68
    s_lshl_b32 s56, s56, 9
    s_add_u32 s56, s56, 0xa0000
    s_mov_b32 s60, 0x07060503
    s_mov_b32 s61, 0x07060502
    s_mov_b32 s62, 0x07060501
    v_mov_b32 v15, s34
    s_waitcnt lgkmcnt(6)
    v_pk_add_f32 v[196:197], v[196:197], v[200:201]
    v_pk_add_f32 v[198:199], v[198:199], v[202:203]
    s_waitcnt lgkmcnt(5)
    v_pk_add_f32 v[196:197], v[196:197], v[204:205]
    v_pk_add_f32 v[198:199], v[198:199], v[206:207]
    s_waitcnt lgkmcnt(4)
    v_pk_add_f32 v[196:197], v[196:197], v[208:209]
    v_pk_add_f32 v[198:199], v[198:199], v[210:211]
    s_waitcnt lgkmcnt(3)
    v_pk_add_f32 v[196:197], v[196:197], v[212:213]
    v_pk_add_f32 v[198:199], v[198:199], v[214:215]
    s_waitcnt lgkmcnt(2)
    v_pk_add_f32 v[196:197], v[196:197], v[216:217]
    v_pk_add_f32 v[198:199], v[198:199], v[218:219]
    s_waitcnt lgkmcnt(1)
    v_pk_add_f32 v[196:197], v[196:197], v[220:221]
    v_pk_add_f32 v[198:199], v[198:199], v[222:223]
    s_waitcnt lgkmcnt(0)
    v_pk_add_f32 v[196:197], v[196:197], v[224:225]
    v_pk_add_f32 v[198:199], v[198:199], v[226:227]
    v_perm_b32 v12, v196, v199, s60
    v_perm_b32 v13, v197, v199, s61
    v_perm_b32 v14, v198, v199, s62
    s_add_u32 s57, s56, 0x800000
    buffer_store_dwordx4 v[12:15], v11, s[36:39], s57 offen
    buffer_store_dwordx4 v[12:15], v11, s[36:39], s56 offen sc1
.opub_194:
    s_mov_b32 s61, s101
    v_lshrrev_b32 v25, 4, v0
    v_bfe_u32 v26, v0, 1, 1
    v_lshl_add_u32 v25, v25, 1, v26
    v_bfe_u32 v26, v0, 2, 2
    v_lshl_add_u32 v19, v25, 3, v26
    v_lshlrev_b32 v19, 7, v19
    v_and_b32 v25, 3, v25
    v_lshrrev_b32 v26, 1, v26
    v_lshl_add_u32 v25, v25, 1, v26
    v_xor_b32 v25, s3, v25
    v_lshl_add_u32 v19, v25, 4, v19
    v_and_b32 v25, 1, v0
    v_lshl_add_u32 v19, v25, 3, v19
    v_add_u32 v20, 32768, v19
    ds_read_b64_tr_b16 v[160:161], v19 offset:0
    ds_read_b64_tr_b16 v[162:163], v19 offset:512
    ds_read_b64_tr_b16 v[164:165], v19 offset:8192
    ds_read_b64_tr_b16 v[166:167], v19 offset:8704
    ds_read_b64_tr_b16 v[168:169], v19 offset:16384
    ds_read_b64_tr_b16 v[170:171], v19 offset:16896
    ds_read_b64_tr_b16 v[172:173], v19 offset:24576
    ds_read_b64_tr_b16 v[174:175], v19 offset:25088
    ds_read_b64_tr_b16 v[176:177], v20 offset:0
    ds_read_b64_tr_b16 v[178:179], v20 offset:512
    ds_read_b64_tr_b16 v[180:181], v20 offset:8192
    s_branch .Lsk_b1_7
.Lst_b1_7:
    s_branch .Lrt_b1_7
.Lsk_b1_7:
    ds_read_b64_tr_b16 v[182:183], v20 offset:8704
    ds_read_b64_tr_b16 v[184:185], v20 offset:16384
    ds_read_b64_tr_b16 v[186:187], v20 offset:16896
    ds_read_b64_tr_b16 v[188:189], v20 offset:24576
    ds_read_b64_tr_b16 v[190:191], v20 offset:25088
    ds_read_b64_tr_b16 v[192:193], v20 offset:32768
    ds_read_b64_tr_b16 v[194:195], v20 offset:33280
    v_add_u32 v19, 73728, v19
    v_add_u32 v20, 73728, v20
    s_mov_b32 s48, s22
    s_and_b32 s49, s23, 0xffff
    s_mov_b32 s50, 0x510000
    s_mov_b32 s51, 0x00020000
    s_mul_i32 s69, s99, 73728
    s_mul_i32 s56, s3, 9216
    s_add_u32 s69, s69, s56
    v_bfe_u32 v25, v0, 4, 1
    s_and_b32 s56, s3, 1
    s_lshl_b32 s56, s56, 2
    v_lshl_or_b32 v25, v25, 1, s56
    v_and_b32 v26, 7, v0
    v_xor_b32 v25, v25, v26
    v_lshrrev_b32 v26, 3, v0
    v_mul_u32_u24 v26, 1152, v26
    v_lshl_add_u32 v24, v25, 4, v26
    s_and_b32 s58, s64, 0
    s_mul_i32 s58, s58, 18432
    s_mul_i32 s59, s3, 2304
    s_add_u32 s58, s58, s59
    s_add_u32 s62, s58, 0x37000
    s_add_u32 s63, s58, 0x49000
    s_mul_i32 s101, s64, 18432
    s_add_u32 s101, s101, s59
    s_add_u32 s101, s101, 0x170000
    s_waitcnt lgkmcnt(0)
    s_barrier
    s_add_u32 m0, s61, 122880
    s_add_u32 s56, s100, 3538944
    buffer_load_dwordx4 v6, s[52:55], s56 offen nt lds
    s_add_u32 m0, s61, 131072
    s_add_u32 s56, s100, 4128768
    buffer_load_dwordx4 v6, s[52:55], s56 offen nt lds
    s_add_u32 m0, s61, 139264
    s_add_u32 s56, s100, 4718592
    buffer_load_dwordx4 v6, s[52:55], s56 offen nt lds
    s_add_u32 m0, s61, 0
    s_nop 0
    buffer_load_dwordx4 v24, s[48:51], s69 offen offset:0 nt lds
    s_add_u32 m0, s61, 8064
    s_nop 0
    buffer_load_dwordx4 v24, s[48:51], s69 offen offset:128 nt lds
    s_add_u32 m0, s61, 16128
    s_nop 0
    buffer_load_dwordx4 v24, s[48:51], s69 offen offset:256 nt lds
    s_add_u32 m0, s61, 24192
    s_nop 0
    buffer_load_dwordx4 v24, s[48:51], s69 offen offset:384 nt lds
    s_add_u32 m0, s61, 32256
    s_nop 0
    buffer_load_dwordx4 v24, s[48:51], s69 offen offset:512 nt lds
    s_add_u32 m0, s61, 40320
    s_nop 0
    buffer_load_dwordx4 v24, s[48:51], s69 offen offset:640 nt lds
    s_add_u32 m0, s61, 48384
    s_nop 0
    buffer_load_dwordx4 v24, s[48:51], s69 offen offset:768 nt lds
    s_add_u32 m0, s61, 56448
    s_nop 0
    buffer_load_dwordx4 v24, s[48:51], s69 offen offset:896 nt lds
    s_add_u32 m0, s61, 64512
    s_nop 0
    buffer_load_dwordx4 v24, s[48:51], s69 offen offset:1024 nt lds
    v_bfe_u32 v16, v0, 1, 3
    v_mul_u32_u24 v16, 1312, v16
    v_lshrrev_b32 v25, 4, v0
    v_lshl_add_u32 v16, v25, 5, v16
    v_and_b32 v25, 1, v0
    v_lshl_add_u32 v16, v25, 4, v16
    v_add_u32 v16, 147456, v16
    s_mul_i32 s56, s3, 1312
    s_add_u32 s56, s56, 147456
    v_add_u32 v17, s56, v3
    v_add_u32 v18, s56, v4
    v_bfe_u32 v21, v0, 1, 3
    v_mul_u32_u24 v21, 144, v21
    v_bfe_u32 v25, v0, 4, 1
    v_lshl_add_u32 v21, v25, 3, v21
    v_lshrrev_b32 v25, 5, v0
    v_lshl_add_u32 v21, v25, 2, v21
    v_and_b32 v25, 1, v0
    v_lshl_add_u32 v21, v25, 1, v21
    s_lshl_b32 s56, s3, 4
    s_add_u32 s56, s56, 157952
    v_add_u32 v21, s56, v21
    v_and_b32 v22, 15, v0
    v_lshlrev_b32 v22, 3, v22
    s_mul_i32 s56, s3, 144
    s_add_u32 s56, s56, 157952
    v_add_u32 v22, s56, v22
    s_mov_b32 s56, 157952
    v_bfe_u32 v22, v0, 1, 3
    v_mul_u32_u24 v22, 144, v22
    v_and_b32 v25, 48, v0
    v_add3_u32 v22, v22, v25, s56
    v_bfe_u32 v23, v0, 1, 3
    v_mul_u32_u24 v23, 9216, v23
    v_and_b32 v25, 1, v0
    v_lshl_add_u32 v23, v25, 4, v23
    v_and_b32 v25, 48, v0
    v_lshl_add_u32 v23, v25, 1, v23
    v_lshrrev_b32 v25, 4, v0
    v_bfe_u32 v26, v0, 2, 2
    v_lshl_add_u32 v28, v25, 3, v26
    v_lshlrev_b32 v28, 7, v28
    v_and_b32 v25, 1, v25
    v_lshrrev_b32 v26, 1, v26
    v_lshl_add_u32 v25, v25, 1, v26
    s_and_b32 s56, s3, 1
    s_lshl_b32 s56, s56, 1
    v_xor_b32 v25, s56, v25
    v_and_b32 v26, 3, v0
    v_lshl_add_u32 v28, v26, 3, v28
    s_lshr_b32 s56, s3, 1
    s_lshl_b32 s56, s56, 13
    v_add_u32 v28, s56, v28
    v_xor_b32 v26, 1, v25
    v_lshl_add_u32 v29, v26, 5, v28
    v_lshl_add_u32 v28, v25, 5, v28
    v_add_u32 v30, 0x10000, v28
    v_add_u32 v31, 0x10000, v29
    s_mul_i32 s59, s3, 73728
    s_lshl_b32 s56, s99, 7
    s_add_u32 s59, s59, s56
    s_add_u32 s59, s59, 0x1a0000
    s_add_u32 s99, s59, 589824
    s_add_u32 s100, s59, 1179648
    s_branch .gpc_196
.gp_195:
    buffer_load_dwordx4 v[32:35], v2, s[36:39], s62 offen offset:0 sc1
    buffer_load_dwordx4 v[40:43], v2, s[36:39], s62 offen offset:1024 sc1
    buffer_load_dwordx2 v[48:49], v5, s[36:39], s62 offen offset:0 sc1
    buffer_load_dwordx4 v[56:59], v2, s[36:39], s63 offen offset:0 sc1
    buffer_load_dwordx4 v[64:67], v2, s[36:39], s63 offen offset:1024 sc1
    buffer_load_dwordx2 v[72:73], v5, s[36:39], s63 offen offset:0 sc1
    s_waitcnt vmcnt(0)
.gpc_196:
    v_min_u32 v25, v33, v35
    v_max_u32 v26, v33, v35
    v_min3_u32 v25, v25, v41, v43
    v_max3_u32 v26, v26, v41, v43
    v_min3_u32 v25, v25, v49, v57
    v_max3_u32 v26, v26, v49, v57
    v_min3_u32 v25, v25, v59, v65
    v_max3_u32 v26, v26, v59, v65
    v_min3_u32 v25, v25, v67, v73
    v_max3_u32 v26, v26, v67, v73
    v_cmp_eq_u32 vcc, s34, v25
    v_cmp_eq_u32 s[56:57], s34, v26
    s_and_b64 vcc, vcc, s[56:57]
    s_cmp_eq_u64 vcc, -1
    s_nop 2
    s_cbranch_scc1 .gpd_197
    s_sub_u32 s35, s35, 1
    s_cbranch_scc1 .Lexit
    s_sleep 2
    s_branch .gp_195
.gpd_197:
    v_lshlrev_b32 v206, 16, v32
    v_and_b32 v207, 0xffff0000, v32
    v_lshlrev_b32 v216, 16, v56
    s_branch .Lsk_b2_0
.Lst_b2_0:
    s_branch .Lrt_b2_0
.Lsk_b2_0:
    v_and_b32 v217, 0xffff0000, v56
    v_lshlrev_b32 v208, 16, v34
    v_and_b32 v209, 0xffff0000, v34
    v_lshlrev_b32 v218, 16, v58
    v_and_b32 v219, 0xffff0000, v58
    v_lshlrev_b32 v210, 16, v40
    v_and_b32 v211, 0xffff0000, v40
    v_lshlrev_b32 v220, 16, v64
    v_and_b32 v221, 0xffff0000, v64
    v_lshlrev_b32 v212, 16, v42
    v_and_b32 v213, 0xffff0000, v42
    v_lshlrev_b32 v222, 16, v66
    v_and_b32 v223, 0xffff0000, v66
    v_lshlrev_b32 v214, 16, v48
    v_and_b32 v215, 0xffff0000, v48
    v_lshlrev_b32 v224, 16, v72
    v_and_b32 v225, 0xffff0000, v72
    s_waitcnt vmcnt(9)
    s_barrier
    ds_read_b64_tr_b16 v[68:69], v19 offset:0
    ds_read_b64_tr_b16 v[70:71], v19 offset:512
    ds_read_b64_tr_b16 v[72:73], v19 offset:8192
    ds_read_b64_tr_b16 v[74:75], v19 offset:8704
    ds_read_b64_tr_b16 v[76:77], v19 offset:16384
    ds_read_b64_tr_b16 v[78:79], v19 offset:16896
    ds_read_b64_tr_b16 v[80:81], v19 offset:24576
    ds_read_b64_tr_b16 v[82:83], v19 offset:25088
    ds_read_b64_tr_b16 v[84:85], v20 offset:0
    ds_read_b64_tr_b16 v[86:87], v20 offset:512
    ds_read_b64_tr_b16 v[88:89], v20 offset:8192
    ds_read_b64_tr_b16 v[90:91], v20 offset:8704
    ds_read_b64_tr_b16 v[92:93], v20 offset:16384
    ds_read_b64_tr_b16 v[94:95], v20 offset:16896
    ds_read_b64_tr_b16 v[96:97], v20 offset:24576
    ds_read_b64_tr_b16 v[98:99], v20 offset:25088
    ds_read_b64_tr_b16 v[100:101], v20 offset:32768
    ds_read_b64_tr_b16 v[102:103], v20 offset:33280
    s_waitcnt vmcnt(0)
    s_barrier
    ds_read_b64_tr_b16 v[104:105], v28 offset:0
    ds_read_b64_tr_b16 v[106:107], v28 offset:512
    ds_read_b64_tr_b16 v[108:109], v29 offset:0
    ds_read_b64_tr_b16 v[110:111], v29 offset:512
    ds_read_b64_tr_b16 v[112:113], v28 offset:4096
    ds_read_b64_tr_b16 v[114:115], v28 offset:4608
    ds_read_b64_tr_b16 v[116:117], v29 offset:4096
    ds_read_b64_tr_b16 v[118:119], v29 offset:4608
    ds_read_b64_tr_b16 v[120:121], v28 offset:32768
    ds_read_b64_tr_b16 v[122:123], v28 offset:33280
    ds_read_b64_tr_b16 v[124:125], v29 offset:32768
    ds_read_b64_tr_b16 v[126:127], v29 offset:33280
    ds_read_b64_tr_b16 v[128:129], v28 offset:36864
    ds_read_b64_tr_b16 v[130:131], v28 offset:37376
    ds_read_b64_tr_b16 v[132:133], v29 offset:36864
    ds_read_b64_tr_b16 v[134:135], v29 offset:37376
    s_cmp_ge_u32 s3, 2
    s_cbranch_scc1 .Lbc_nodn3
    ds_read_b64_tr_b16 v[136:137], v30 offset:0
    ds_read_b64_tr_b16 v[138:139], v30 offset:512
    ds_read_b64_tr_b16 v[140:141], v31 offset:0
    ds_read_b64_tr_b16 v[142:143], v31 offset:512
    ds_read_b64_tr_b16 v[144:145], v30 offset:4096
    ds_read_b64_tr_b16 v[146:147], v30 offset:4608
    ds_read_b64_tr_b16 v[148:149], v31 offset:4096
    ds_read_b64_tr_b16 v[150:151], v31 offset:4608
.Lbc_nodn3:
    s_branch .Lsk_b2_1
    .fill 154, 4, 0xbf800000
.Lst_b2_1:
    s_branch .Lrt_b2_1
.Lsk_b2_1:
    s_mov_b32 s69, 0
.gp_198:
    s_add_u32 s69, s69, 1
    s_and_b32 s56, s69, 0x41
    s_cmp_lg_u32 s56, 0x41
    s_cselect_b32 s56, s0, 0
    s_add_u32 s58, s101, s56
    buffer_load_dwordx4 v[196:199], v2, s[36:39], s58 offen offset:0 sc1
    buffer_load_dwordx4 v[200:203], v2, s[36:39], s58 offen offset:1024 sc1
    buffer_load_dwordx2 v[204:205], v5, s[36:39], s58 offen offset:0 sc1
    s_waitcnt vmcnt(0)
    v_min3_u32 v25, v197, v199, v201
    v_max3_u32 v26, v197, v199, v201
    v_min3_u32 v25, v25, v203, v205
    v_max3_u32 v26, v26, v203, v205
    v_cmp_eq_u32 vcc, s34, v25
    v_cmp_eq_u32 s[56:57], s34, v26
    s_and_b64 vcc, vcc, s[56:57]
    s_cmp_eq_u64 vcc, -1
    s_nop 2
    s_cbranch_scc1 .gpd_199
    s_sub_u32 s35, s35, 1
    s_cbranch_scc1 .Lexit
    s_branch .gp_198
.gpd_199:
    s_mov_b32 s56, 0x3f803f80
    v_dot2_f32_bf16 v236, v196, s56, 0
    v_dot2_f32_bf16 v237, v196, v196, 0
    v_dot2_f32_bf16 v236, v198, s56, v236
    v_dot2_f32_bf16 v237, v198, v198, v237
    v_dot2_f32_bf16 v236, v200, s56, v236
    v_dot2_f32_bf16 v237, v200, v200, v237
    v_dot2_f32_bf16 v236, v202, s56, v236
    v_dot2_f32_bf16 v237, v202, v202, v237
    s_mov_b64 exec, 0xffffffff
    v_dot2_f32_bf16 v236, v204, s56, v236
    v_dot2_f32_bf16 v237, v204, v204, v237
    s_mov_b64 exec, -1
    s_nop 1
    v_permlane32_swap_b32 v236, v237
    v_add_f32 v236, v236, v237
    v_mov_b32 v238, v236
    s_nop 1
    v_permlane16_swap_b32 v238, v236
    v_add_f32 v236, v238, v236
    v_lshlrev_b32 v226, 16, v196
    v_and_b32 v227, 0xffff0000, v196
    v_add_f32_dpp v236, v236, v236 row_ror:8 row_mask:0xf bank_mask:0xf
    v_lshlrev_b32 v228, 16, v198
    v_and_b32 v229, 0xffff0000, v198
    v_add_f32_dpp v236, v236, v236 row_ror:4 row_mask:0xf bank_mask:0xf
    v_lshlrev_b32 v230, 16, v200
    v_and_b32 v231, 0xffff0000, v200
    v_add_f32_dpp v236, v236, v236 quad_perm:[2,3,0,1] row_mask:0xf bank_mask:0xf
    v_lshlrev_b32 v232, 16, v202
    v_and_b32 v233, 0xffff0000, v202
    v_add_f32_dpp v236, v236, v236 quad_perm:[1,0,3,2] row_mask:0xf bank_mask:0xf
    v_mul_f32 v236, 0x3ae38e39, v236
    v_lshlrev_b32 v234, 16, v204
    v_and_b32 v235, 0xffff0000, v204
    v_readlane_b32 s56, v236, 0
    v_readlane_b32 s57, v236, 32
    s_nop 0
    v_mov_b32 v236, s56
    v_fma_f32 v237, -v236, v236, s57
    v_max_f32 v237, 0, v237
    v_cvt_pk_bf16_f32 v238, -v236, v237
    v_and_b32 v239, 0xffff0000, v238
    v_add_f32 v239, 0x3727c5ac, v239
    v_lshlrev_b32 v236, 16, v238
    v_cvt_pk_bf16_f32 v239, v239, v239
    v_lshlrev_b32 v239, 16, v239
    v_sqrt_f32 v239, v239
    v_mov_b32 v237, v236
    v_cvt_pk_bf16_f32 v239, v239, v239
    v_lshlrev_b32 v239, 16, v239
    v_rcp_f32 v238, v239
    v_rcp_f32 v239, v239
    v_pk_add_f32 v[226:227], v[226:227], v[236:237]
    v_pk_add_f32 v[228:229], v[228:229], v[236:237]
    v_pk_add_f32 v[230:231], v[230:231], v[236:237]
    v_pk_add_f32 v[232:233], v[232:233], v[236:237]
    v_pk_add_f32 v[234:235], v[234:235], v[236:237]
    v_cvt_pk_bf16_f32 v226, v226, v227
    v_and_b32 v227, 0xffff0000, v226
    v_lshlrev_b32 v226, 16, v226
    v_cvt_pk_bf16_f32 v228, v228, v229
    v_and_b32 v229, 0xffff0000, v228
    v_lshlrev_b32 v228, 16, v228
    v_cvt_pk_bf16_f32 v230, v230, v231
    v_and_b32 v231, 0xffff0000, v230
    v_lshlrev_b32 v230, 16, v230
    v_cvt_pk_bf16_f32 v232, v232, v233
    v_and_b32 v233, 0xffff0000, v232
    v_lshlrev_b32 v232, 16, v232
    v_cvt_pk_bf16_f32 v234, v234, v235
    v_and_b32 v235, 0xffff0000, v234
    v_lshlrev_b32 v234, 16, v234
    v_pk_mul_f32 v[226:227], v[226:227], v[238:239]
    v_pk_mul_f32 v[228:229], v[228:229], v[238:239]
    v_pk_mul_f32 v[230:231], v[230:231], v[238:239]
    v_pk_mul_f32 v[232:233], v[232:233], v[238:239]
    v_pk_mul_f32 v[234:235], v[234:235], v[238:239]
    v_cvt_pk_bf16_f32 v226, v226, v227
    v_and_b32 v227, 0xffff0000, v226
    v_lshlrev_b32 v226, 16, v226
    v_cvt_pk_bf16_f32 v228, v228, v229
    v_and_b32 v229, 0xffff0000, v228
    v_lshlrev_b32 v228, 16, v228
    v_cvt_pk_bf16_f32 v230, v230, v231
    v_and_b32 v231, 0xffff0000, v230
    v_lshlrev_b32 v230, 16, v230
    v_cvt_pk_bf16_f32 v232, v232, v233
    v_and_b32 v233, 0xffff0000, v232
    v_lshlrev_b32 v232, 16, v232
    v_cvt_pk_bf16_f32 v234, v234, v235
    v_and_b32 v235, 0xffff0000, v234
    v_lshlrev_b32 v234, 16, v234
    v_pk_mul_f32 v[226:227], v[226:227], v[216:217]
    v_pk_mul_f32 v[228:229], v[228:229], v[218:219]
    v_pk_mul_f32 v[230:231], v[230:231], v[220:221]
    v_pk_mul_f32 v[232:233], v[232:233], v[222:223]
    v_pk_mul_f32 v[234:235], v[234:235], v[224:225]
    v_cvt_pk_bf16_f32 v226, v226, v227
    v_and_b32 v227, 0xffff0000, v226
    v_lshlrev_b32 v226, 16, v226
    v_cvt_pk_bf16_f32 v228, v228, v229
    v_and_b32 v229, 0xffff0000, v228
    v_lshlrev_b32 v228, 16, v228
    v_cvt_pk_bf16_f32 v230, v230, v231
    v_and_b32 v231, 0xffff0000, v230
    v_lshlrev_b32 v230, 16, v230
    v_cvt_pk_bf16_f32 v232, v232, v233
    v_and_b32 v233, 0xffff0000, v232
    v_lshlrev_b32 v232, 16, v232
    v_cvt_pk_bf16_f32 v234, v234, v235
    v_and_b32 v235, 0xffff0000, v234
    v_lshlrev_b32 v234, 16, v234
    v_pk_add_f32 v[226:227], v[226:227], v[206:207]
    v_pk_add_f32 v[228:229], v[228:229], v[208:209]
    v_pk_add_f32 v[230:231], v[230:231], v[210:211]
    v_pk_add_f32 v[232:233], v[232:233], v[212:213]
    v_pk_add_f32 v[234:235], v[234:235], v[214:215]
    v_cvt_pk_bf16_f32 v242, v226, v227
    v_cvt_pk_bf16_f32 v243, v228, v229
    v_cvt_pk_bf16_f32 v244, v230, v231
    v_cvt_pk_bf16_f32 v245, v232, v233
    v_cvt_pk_bf16_f32 v246, v234, v235
    ds_write_b64 v17, v[242:243] offset:0
    ds_write_b64 v17, v[244:245] offset:512
    ds_write_b32 v18, v246 offset:0
    s_branch .Lsk_b2_2
    .fill 23, 4, 0xbf800000
.Lst_b2_2:
    s_branch .Lrt_b2_2
.Lsk_b2_2:
    s_waitcnt lgkmcnt(0)
    s_barrier
    ds_read_b128 v[32:35], v16 offset:0
    ds_read_b128 v[36:39], v16 offset:128
    ds_read_b128 v[40:43], v16 offset:256
    ds_read_b128 v[44:47], v16 offset:384
    ds_read_b128 v[48:51], v16 offset:512
    ds_read_b128 v[52:55], v16 offset:640
    ds_read_b128 v[56:59], v16 offset:768
    ds_read_b128 v[60:63], v16 offset:896
    ds_read_b128 v[64:67], v16 offset:1024
    s_waitcnt lgkmcnt(8)
    v_mfma_f32_16x16x32_bf16 v[152:155], v[160:163], v[32:35], 0
    v_mfma_f32_16x16x32_bf16 v[156:159], v[68:71], v[32:35], 0
    s_waitcnt lgkmcnt(7)
    v_mfma_f32_16x16x32_bf16 v[152:155], v[164:167], v[36:39], v[152:155]
    v_mfma_f32_16x16x32_bf16 v[156:159], v[72:75], v[36:39], v[156:159]
    s_waitcnt lgkmcnt(6)
    v_mfma_f32_16x16x32_bf16 v[152:155], v[168:171], v[40:43], v[152:155]
    v_mfma_f32_16x16x32_bf16 v[156:159], v[76:79], v[40:43], v[156:159]
    s_waitcnt lgkmcnt(5)
    v_mfma_f32_16x16x32_bf16 v[152:155], v[172:175], v[44:47], v[152:155]
    v_mfma_f32_16x16x32_bf16 v[156:159], v[80:83], v[44:47], v[156:159]
    s_waitcnt lgkmcnt(4)
    v_mfma_f32_16x16x32_bf16 v[152:155], v[176:179], v[48:51], v[152:155]
    v_mfma_f32_16x16x32_bf16 v[156:159], v[84:87], v[48:51], v[156:159]
    s_waitcnt lgkmcnt(3)
    v_mfma_f32_16x16x32_bf16 v[152:155], v[180:183], v[52:55], v[152:155]
    v_mfma_f32_16x16x32_bf16 v[156:159], v[88:91], v[52:55], v[156:159]
    s_waitcnt lgkmcnt(2)
    v_mfma_f32_16x16x32_bf16 v[152:155], v[184:187], v[56:59], v[152:155]
    v_mfma_f32_16x16x32_bf16 v[156:159], v[92:95], v[56:59], v[156:159]
    s_waitcnt lgkmcnt(1)
    v_mfma_f32_16x16x32_bf16 v[152:155], v[188:191], v[60:63], v[152:155]
    v_mfma_f32_16x16x32_bf16 v[156:159], v[96:99], v[60:63], v[156:159]
    s_waitcnt lgkmcnt(0)
    v_mfma_f32_16x16x32_bf16 v[152:155], v[192:195], v[64:67], v[152:155]
    v_mfma_f32_16x16x32_bf16 v[156:159], v[100:103], v[64:67], v[156:159]
    s_nop 6
    v_permlane32_swap_b32 v152, v154
    v_permlane32_swap_b32 v153, v155
    v_permlane32_swap_b32 v156, v158
    v_permlane32_swap_b32 v157, v159
    v_cndmask_b32 v153, v153, v154, s[96:97]
    v_cndmask_b32 v152, v152, v155, s[96:97]
    v_cndmask_b32 v157, v157, v158, s[96:97]
    v_cndmask_b32 v156, v156, v159, s[96:97]
    v_add_f32_dpp v12, v153, v152 quad_perm:[1,0,3,2] row_mask:0xf bank_mask:0xf
    s_nop 0
    v_add_f32_dpp v13, v157, v156 quad_perm:[1,0,3,2] row_mask:0xf bank_mask:0xf
    v_cvt_pk_bf16_f32 v12, v12, v13
    v_and_b32 v14, 0xffff0000, v12
    v_lshlrev_b32 v12, 16, v12
    v_max_f32 v12, 0xc2ae0000, v12
    v_min_f32 v27, 0x43000000, v12
    v_mul_f32 v25, 0xbfb8aa3b, v27
    v_fma_f32 v26, v27, s98, -v25
    v_fmac_f32 v26, 0xb2a57060, v27
    v_exp_f32 v25, v25
    v_mul_f32 v26, 0x3f317218, v26
    v_fmac_f32 v25, v25, v26
    v_add_f32 v25, 1.0, v25
    v_rcp_f32 v26, v25
    s_nop 0
    v_mul_f32 v27, v12, v26
    v_fma_f32 v25, -v27, v25, v12
    v_fma_f32 v12, v25, v26, v27
    v_cvt_pk_bf16_f32 v12, v12, v12
    v_lshlrev_b32 v12, 16, v12
    v_mul_f32 v12, v12, v14
    v_cvt_pk_bf16_f32 v12, v12, v12
    ds_write_b16 v21, v12
    s_mov_b32 s60, 0x07060503
    s_mov_b32 s61, 0x07060502
    s_mov_b32 s62, 0x07060501
    s_mov_b32 vcc_lo, 0xaaaaaaaa
    s_mov_b32 vcc_hi, 0xaaaaaaaa
    v_mov_b32 v59, s34
    v_mov_b32 v63, s34
    v_mov_b32 v67, s34
    s_branch .Lsk_b2_3
    .fill 75, 4, 0xbf800000
.Lst_b2_3:
    s_branch .Lrt_b2_3
.Lsk_b2_3:
    s_cmp_ge_u32 s3, 2
    s_waitcnt lgkmcnt(0)
    s_barrier
    ds_read_b128 v[8:11], v22
    ds_read_b128 v[12:15], v22 offset:64
    s_waitcnt lgkmcnt(1)
    v_mfma_f32_16x16x32_bf16 v[32:35], v[104:107], v[8:11], 0
    v_mfma_f32_16x16x32_bf16 v[36:39], v[108:111], v[8:11], 0
    s_waitcnt lgkmcnt(0)
    v_mfma_f32_16x16x32_bf16 v[32:35], v[112:115], v[12:15], v[32:35]
    v_mfma_f32_16x16x32_bf16 v[36:39], v[116:119], v[12:15], v[36:39]
    v_mfma_f32_16x16x32_bf16 v[40:43], v[120:123], v[8:11], 0
    v_mfma_f32_16x16x32_bf16 v[44:47], v[124:127], v[8:11], 0
    v_mfma_f32_16x16x32_bf16 v[40:43], v[128:131], v[12:15], v[40:43]
    v_mfma_f32_16x16x32_bf16 v[44:47], v[132:135], v[12:15], v[44:47]
    s_cbranch_scc0 .Lbc_three
    s_nop 3
    v_cndmask_b32 v32, v32, v36, vcc
    v_cndmask_b32 v33, v33, v37, vcc
    v_cndmask_b32 v34, v34, v38, vcc
    v_cndmask_b32 v35, v35, v39, vcc
    v_perm_b32 v56, v32, v35, s60
    v_perm_b32 v57, v33, v35, s61
    v_perm_b32 v58, v34, v35, s62
    buffer_store_dwordx4 v[56:59], v23, s[36:39], s59 offen sc1
    v_cndmask_b32 v40, v40, v44, vcc
    v_cndmask_b32 v41, v41, v45, vcc
    v_cndmask_b32 v42, v42, v46, vcc
    v_cndmask_b32 v43, v43, v47, vcc
    v_perm_b32 v60, v40, v43, s60
    v_perm_b32 v61, v41, v43, s61
    v_perm_b32 v62, v42, v43, s62
    buffer_store_dwordx4 v[60:63], v23, s[36:39], s99 offen sc1
    s_nop 1
    s_branch .Lexit
.Lbc_three:
    v_mfma_f32_16x16x32_bf16 v[48:51], v[136:139], v[8:11], 0
    v_mfma_f32_16x16x32_bf16 v[52:55], v[140:143], v[8:11], 0
    v_mfma_f32_16x16x32_bf16 v[48:51], v[144:147], v[12:15], v[48:51]
    v_mfma_f32_16x16x32_bf16 v[52:55], v[148:151], v[12:15], v[52:55]
    v_cndmask_b32 v32, v32, v36, vcc
    v_cndmask_b32 v33, v33, v37, vcc
    v_cndmask_b32 v34, v34, v38, vcc
    v_cndmask_b32 v35, v35, v39, vcc
    v_perm_b32 v56, v32, v35, s60
    v_perm_b32 v57, v33, v35, s61
    v_perm_b32 v58, v34, v35, s62
    buffer_store_dwordx4 v[56:59], v23, s[36:39], s59 offen sc1
    v_cndmask_b32 v40, v40, v44, vcc
    v_cndmask_b32 v41, v41, v45, vcc
    v_cndmask_b32 v42, v42, v46, vcc
    v_cndmask_b32 v43, v43, v47, vcc
    v_perm_b32 v60, v40, v43, s60
    v_perm_b32 v61, v41, v43, s61
    v_perm_b32 v62, v42, v43, s62
    buffer_store_dwordx4 v[60:63], v23, s[36:39], s99 offen sc1
    v_cndmask_b32 v48, v48, v52, vcc
    v_cndmask_b32 v49, v49, v53, vcc
    v_cndmask_b32 v50, v50, v54, vcc
    v_cndmask_b32 v51, v51, v55, vcc
    v_perm_b32 v64, v48, v51, s60
    v_perm_b32 v65, v49, v51, s61
    v_perm_b32 v66, v50, v51, s62
    buffer_store_dwordx4 v[64:67], v23, s[36:39], s100 offen sc1
.Lexit:
.Lend:
s_endpgm
.section .rodata,"a"
.p2align 6
.amdhsa_kernel adaLN_cond__sliding_block_cached__moe_arch_mod__decode_kernel
  .amdhsa_next_free_vgpr 256
  .amdhsa_next_free_sgpr 102
  .amdhsa_accum_offset 256
  .amdhsa_group_segment_fixed_size 0
  .amdhsa_kernarg_size 120
  .amdhsa_user_sgpr_count 2
  .amdhsa_user_sgpr_kernarg_segment_ptr 1
  .amdhsa_system_sgpr_workgroup_id_x 1
.end_amdhsa_kernel
```

```asm
; @launch grid=(256,1,1) block=(512,1,1) lds=159360
.amdgcn_target "amdgcn-amd-amdhsa--gfx950"
.text
.p2align 12
.globl adaLN_cond__sliding_block_cached__moe_arch_mod__decode_kernel
.p2align 8
.type adaLN_cond__sliding_block_cached__moe_arch_mod__decode_kernel,@function
adaLN_cond__sliding_block_cached__moe_arch_mod__decode_kernel:
    s_cmp_ge_u32 s2, 256
    s_cbranch_scc1 .Lend
    s_load_dwordx16 s[4:19], s[0:1], 0
    s_load_dwordx8 s[20:27], s[0:1], 64
    s_load_dwordx4 s[28:31], s[0:1], 96
    s_load_dwordx2 s[32:33], s[0:1], 112
    s_memrealtime s[70:71]
    v_lshrrev_b32 v1, 6, v0
    v_and_b32 v0, 63, v0
    v_readfirstlane_b32 s3, v1
    s_cmp_lt_u32 s3, 4
    s_nop 3
    s_cbranch_scc1 .Ltw_done
    s_cmp_lt_u32 s2, 72
    s_cbranch_scc1 .Ltw_m
    s_cmp_lt_u32 s2, 144
    s_cbranch_scc1 .Ltw_b
    s_cmp_lt_u32 s2, 208
    s_cbranch_scc1 .Ltw_q
    s_cmp_eq_u32 s3, 4
    s_cbranch_scc1 .Lst_a0_0
    s_cmp_eq_u32 s3, 5
    s_cbranch_scc1 .Lst_a0_1
.Lrt_a0_0:
.Lrt_a0_1:
    s_branch .Ltw_done
.Ltw_m:
    s_cmp_eq_u32 s3, 4
    s_cbranch_scc1 .Lst_m0_0
    s_cmp_eq_u32 s3, 5
    s_cbranch_scc1 .Lst_m0_1
.Lrt_m0_1:
    s_cmp_eq_u32 s3, 6
    s_cbranch_scc1 .Lst_m0_2
.Lrt_m0_2:
    s_cmp_eq_u32 s3, 7
    s_cbranch_scc1 .Lst_m0_3
    s_cmp_eq_u32 s3, 5
    s_cbranch_scc1 .Lst_m0_4
    s_cmp_eq_u32 s3, 6
    s_cbranch_scc1 .Lrt_m0_5
.Lrt_m0_0:
.Lrt_m0_3:
.Lrt_m0_4:
.Lrt_m0_5:
    s_branch .Ltw_done
.Ltw_b:
    s_cmp_eq_u32 s3, 4
    s_cbranch_scc1 .Lst_b0_0
    s_cmp_eq_u32 s3, 5
    s_cbranch_scc1 .Lst_b0_1
    s_cmp_eq_u32 s3, 6
    s_cbranch_scc1 .Lst_b0_2
    s_cmp_eq_u32 s3, 7
    s_cbranch_scc1 .Lst_b0_3
.Lrt_b0_0:
.Lrt_b0_1:
.Lrt_b0_2:
.Lrt_b0_3:
    s_branch .Ltw_done
.Ltw_q:
    s_cmp_eq_u32 s3, 4
    s_cbranch_scc1 .Lst_q0_0
    s_cmp_eq_u32 s3, 5
    s_cbranch_scc1 .Lst_q0_1
    s_cmp_eq_u32 s3, 6
    s_cbranch_scc1 .Lst_q0_2
    s_cmp_eq_u32 s3, 7
    s_cbranch_scc1 .Lst_q0_3
.Lrt_q0_0:
.Lrt_q0_1:
.Lrt_q0_2:
.Lrt_q0_3:
.Ltw_done:
    s_mov_b32 s35, 0x3ffff
    s_mov_b32 s98, 0xbfb8aa3b
    s_mov_b32 s94, 0x05040100
    s_mov_b32 s95, 0x07060302
    s_mov_b32 s96, 0xaaaaaaaa
    s_mov_b32 s97, 0xaaaaaaaa
    s_and_b32 s64, s2, 7
    s_lshr_b32 s65, s2, 3
    s_mov_b32 s58, 0x2554433
    s_mov_b32 s59, 0x2877661
    s_cmp_ge_u32 s65, 16
    s_cselect_b32 s58, 0xbb1aa998, s58
    s_cselect_b32 s59, 0xffeeddcc, s59
    s_lshl_b32 s57, s65, 2
    s_lshr_b64 s[58:59], s[58:59], s57
    s_lshl1_add_u32 s59, s64, 1
    s_mul_i32 s58, s58, s59
    s_add_u32 s58, s58, s64
    s_add_u32 s58, s58, s59
    s_and_b32 s66, s58, 7
    s_bfe_u32 s67, s58, 0x10003
    s_lshl1_add_u32 s67, s64, s67
    s_lshr_b32 s68, 0xaab5d42a, s65
    s_and_b32 s68, s68, 1
    s_movk_i32 s60, 0x7651
    s_cselect_b32 s60, 0x4320, s60
    s_lshl4_add_u32 s69, s66, s67
    s_lshl_b32 s69, s69, 21
    s_cmp_eq_u32 s64, 7
    s_cselect_b32 s58, 0x4040, 0
    s_or_b32 s58, s58, 0x208180
    s_bitcmp1_b32 s58, s65
    s_cselect_b32 s60, s60, 0x3210
    s_and_b32 s57, s3, 1
    s_and_b32 s59, s3, 6
    s_cmpk_eq_u32 s60, 0x3210
    s_cselect_b32 s57, s68, s57
    s_cselect_b32 s59, s3, s59
    s_lshl_b32 s57, s57, 16
    s_lshl_b32 s59, s59, 10
    s_add_u32 s69, s69, s57
    s_add_u32 s69, s69, s59
    s_add_u32 s69, s69, 0x180000
    v_bfe_u32 v1, v0, 2, 2
    v_lshlrev_b32 v1, 2, v1
    v_bfe_u32 v1, s60, v1, 4
    v_lshrrev_b32 v2, 4, v0
    v_lshl_add_u32 v1, v1, 2, v2
    v_and_b32 v2, 3, v0
    v_lshl_add_u32 v1, v1, 2, v2
    v_lshlrev_b32 v1, 4, v1
    v_lshlrev_b32 v2, 4, v0
    v_lshlrev_b32 v3, 3, v0
    v_and_b32 v4, 31, v0
    v_lshlrev_b32 v4, 2, v4
    v_add_u32 v4, 1024, v4
    v_lshlrev_b32 v5, 1, v4
    s_waitcnt lgkmcnt(0)
    s_load_dword s34, s[32:33], 0
    s_mov_b32 s40, s6
    s_and_b32 s41, s7, 0xffff
    s_mov_b32 s42, 0x10000000
    s_mov_b32 s43, 0x00020000
    s_mov_b32 s6, s60
    s_add_u32 s63, s69, 0
    buffer_load_dwordx4 v[32:35], v1, s[40:43], s63 offen nt
    s_add_u32 s63, s69, 8192
    buffer_load_dwordx4 v[36:39], v1, s[40:43], s63 offen nt
    s_add_u32 s63, s69, 16384
    buffer_load_dwordx4 v[64:67], v1, s[40:43], s63 offen nt
    s_add_u32 s63, s69, 24576
    buffer_load_dwordx4 v[68:71], v1, s[40:43], s63 offen nt
.Lnokpre:
    s_mov_b32 s44, s8
    s_and_b32 s45, s9, 0xffff
    s_mov_b32 s46, 0x10000000
    s_mov_b32 s47, 0x00020000
    s_cmp_eq_u32 s3, 0
    s_cselect_b64 exec, 1, 0
    buffer_load_dword v255, v2, s[44:47], s69 offen nt
    s_mov_b64 exec, -1
    s_mov_b32 s36, s32
    s_and_b32 s37, s33, 0xffff
    s_mov_b32 s38, 0x40000000
    s_mov_b32 s39, 0x00020000
    s_lshl3_add_u32 s56, s3, s2
    s_cmp_lt_u32 s56, 8
    s_cbranch_scc0 .Let_no
    s_lshl2_add_u32 s56, s2, 0x4a1000
    v_lshlrev_b32 v6, 8, v0
    v_mov_b32 v7, s70
    s_mov_b64 exec, 3
    buffer_store_dword v7, v6, s[36:39], s56 offen sc1
    s_mov_b64 exec, -1
.Let_no:
    v_mov_b32 v6, 159232
    v_mov_b32 v7, 0
    ds_write_b32 v6, v7
    s_waitcnt lgkmcnt(0)
    s_barrier
    s_cmp_lt_u32 s3, 4
    s_cbranch_scc1 1
    s_setprio 1
    s_cmp_lt_u32 s65, 9
    s_cbranch_scc1 .Lm
    s_cmp_lt_u32 s65, 18
    s_cbranch_scc1 .Lbc
    s_sub_u32 s65, s65, 18
    s_cmp_ge_u32 s65, 8
    s_cbranch_scc1 .La_early
    s_cmp_eq_u32 s65, 3
    s_mov_b32 s14, 0xb55aab55
    s_cselect_b32 s14, 0x8421084, s14
    s_mov_b32 s15, 0x5aab55aa
    s_cselect_b32 s15, 0x42108421, s15
    s_add_u32 s30, s70, 0
    s_mov_b32 s31, s70
    v_bfe_u32 v16, v0, 1, 3
    v_mul_u32_u24 v16, 1312, v16
    v_lshrrev_b32 v12, 4, v0
    v_lshl_add_u32 v16, v12, 5, v16
    v_and_b32 v12, 1, v0
    v_lshl_add_u32 v16, v12, 4, v16
    v_add_u32 v16, 147456, v16
    s_mul_i32 s56, s3, 1312
    s_add_u32 s56, s56, 147456
    v_add_u32 v17, s56, v3
    v_add_u32 v18, s56, v4
    v_lshrrev_b32 v12, 4, v0
    v_bfe_u32 v13, v0, 1, 1
    v_lshl_add_u32 v12, v12, 1, v13
    v_bfe_u32 v13, v0, 2, 2
    v_lshl_add_u32 v20, v12, 3, v13
    v_lshlrev_b32 v20, 7, v20
    v_and_b32 v12, 3, v12
    v_lshrrev_b32 v13, 1, v13
    v_lshl_add_u32 v12, v12, 1, v13
    v_xor_b32 v12, s3, v12
    v_lshl_add_u32 v20, v12, 4, v20
    v_and_b32 v12, 1, v0
    v_lshl_add_u32 v20, v12, 3, v20
    v_bfe_u32 v23, v0, 1, 3
    v_mul_u32_u24 v23, 144, v23
    v_bfe_u32 v12, v0, 4, 1
    v_lshl_add_u32 v23, v12, 3, v23
    s_branch .Lsk_q0_0
.Lst_q0_0:
    s_branch .Lrt_q0_0
.Lsk_q0_0:
    v_lshrrev_b32 v12, 5, v0
    v_lshl_add_u32 v23, v12, 2, v23
    v_and_b32 v12, 1, v0
    v_lshl_add_u32 v23, v12, 1, v23
    s_lshl_b32 s56, s3, 4
    s_add_u32 s56, s56, 157952
    v_add_u32 v23, s56, v23
    v_and_b32 v24, 15, v0
    v_lshlrev_b32 v24, 3, v24
    s_mul_i32 s56, s3, 144
    s_add_u32 s56, s56, 157952
    v_add_u32 v24, s56, v24
    v_add_u32 v21, 32768, v20
    s_lshl_b32 s100, s3, 10
    s_mul_i32 s58, s3, 1152
    s_mov_b32 s52, s4
    s_and_b32 s53, s5, 0xffff
    s_mov_b32 s54, 0x2400
    s_mov_b32 s55, 0x00020000
    buffer_load_dwordx2 v[246:247], v3, s[52:55], s58 offen
    buffer_load_dwordx2 v[248:249], v3, s[52:55], s58 offen offset:512
    buffer_load_dword v250, v4, s[52:55], s58 offen
    s_mov_b32 s48, s10
    s_and_b32 s49, s11, 0xffff
    s_mov_b32 s50, 0x480000
    s_mov_b32 s51, 0x00020000
    v_bfe_u32 v12, v0, 4, 1
    s_and_b32 s56, s3, 3
    s_lshl_b32 s56, s56, 1
    v_or_b32 v12, s56, v12
    v_and_b32 v19, 7, v0
    v_xor_b32 v12, v12, v19
    v_lshrrev_b32 v19, 3, v0
    v_mul_u32_u24 v19, 8192, v19
    v_lshl_add_u32 v19, v12, 4, v19
    s_lshl3_add_u32 s101, s64, s65
    s_lshl_b32 s57, s3, 16
    s_lshl_b32 s59, s101, 7
    s_add_u32 s57, s57, s59
    s_mov_b32 s99, s57
    s_add_u32 m0, s100, 0
    s_add_u32 s56, s99, 0
    buffer_load_dwordx4 v19, s[48:51], s56 offen nt lds
    s_add_u32 s63, s69, 32768
    buffer_load_dwordx4 v[96:99], v1, s[40:43], s63 offen nt
    s_waitcnt lgkmcnt(0)
    s_add_u32 s34, s34, 1
    s_getreg_b32 s1, hwreg(HW_REG_XCC_ID)
    s_lshl_b32 s1, s1, 24
    s_add_u32 s1, s1, s34
    s_lshr_b32 s0, s2, 3
    s_lshl_b32 s63, s64, 8
    s_add_u32 s0, s0, s63
    s_lshl2_add_u32 s0, s0, 0x480000
    v_mov_b32 v30, s1
    s_cmp_eq_u32 s3, 0
    s_cselect_b64 exec, 1, 0
    buffer_store_dword v30, v2, s[36:39], s0 offen sc1
    s_mov_b64 exec, -1
    s_and_b32 s58, s101, 1
    s_lshl_b32 s101, s101, 8
    s_lshl_b32 s58, s58, 7
    s_sub_u32 s101, s101, s58
    s_lshl_b32 s58, s3, 14
    s_add_u32 s101, s101, s58
    s_add_u32 s101, s101, 0x70000
    s_and_b32 s58, s64, 1
    s_mul_i32 s58, s58, 18432
    s_mul_i32 s59, s3, 2304
    s_add_u32 s58, s58, s59
    s_add_u32 s58, s58, 0x1000
    s_add_u32 s59, s58, 73728
    s_waitcnt vmcnt(5)
    s_add_u32 m0, s100, 8192
    s_add_u32 s56, s99, 524288
    buffer_load_dwordx4 v19, s[48:51], s56 offen nt lds
    s_waitcnt vmcnt(5)
    s_add_u32 s63, s69, 40960
    buffer_load_dwordx4 v[100:103], v1, s[40:43], s63 offen nt
    s_waitcnt vmcnt(5)
    s_add_u32 m0, s100, 16384
    s_add_u32 s56, s99, 1048576
    buffer_load_dwordx4 v19, s[48:51], s56 offen nt lds
    s_waitcnt vmcnt(5)
    s_add_u32 s63, s69, 49152
    buffer_load_dwordx4 v[128:131], v1, s[40:43], s63 offen nt
    v_lshlrev_b32 v236, 16, v246
    v_and_b32 v237, 0xffff0000, v246
    v_lshlrev_b32 v238, 16, v247
    v_and_b32 v239, 0xffff0000, v247
    v_lshlrev_b32 v240, 16, v248
    v_and_b32 v241, 0xffff0000, v248
    v_lshlrev_b32 v242, 16, v249
    v_and_b32 v243, 0xffff0000, v249
    v_lshlrev_b32 v244, 16, v250
    v_and_b32 v245, 0xffff0000, v250
    s_mov_b32 s56, 0x3f803f80
    v_dot2_f32_bf16 v10, v246, s56, 0
    v_dot2_f32_bf16 v11, v246, v246, 0
    v_dot2_f32_bf16 v10, v247, s56, v10
    v_dot2_f32_bf16 v11, v247, v247, v11
    v_dot2_f32_bf16 v10, v248, s56, v10
    v_dot2_f32_bf16 v11, v248, v248, v11
    v_dot2_f32_bf16 v10, v249, s56, v10
    v_dot2_f32_bf16 v11, v249, v249, v11
    s_mov_b64 exec, 0xffffffff
    v_dot2_f32_bf16 v10, v250, s56, v10
    v_dot2_f32_bf16 v11, v250, v250, v11
    s_mov_b64 exec, -1
    s_nop 1
    v_permlane32_swap_b32 v10, v11
    v_add_f32 v10, v10, v11
    v_mov_b32 v12, v10
    s_nop 1
    v_permlane16_swap_b32 v12, v10
    v_add_f32 v10, v12, v10
    s_nop 1
    v_add_f32_dpp v10, v10, v10 row_ror:8 row_mask:0xf bank_mask:0xf
    s_nop 1
    v_add_f32_dpp v10, v10, v10 row_ror:4 row_mask:0xf bank_mask:0xf
    s_nop 1
    v_add_f32_dpp v10, v10, v10 quad_perm:[2,3,0,1] row_mask:0xf bank_mask:0xf
    s_nop 1
    v_add_f32_dpp v10, v10, v10 quad_perm:[1,0,3,2] row_mask:0xf bank_mask:0xf
    v_mul_f32 v10, 0x3ae38e39, v10
    s_nop 0
    v_readlane_b32 s56, v10, 0
    v_readlane_b32 s57, v10, 32
    s_nop 0
    v_mov_b32 v10, s56
    v_fma_f32 v11, -v10, v10, s57
    v_max_f32 v11, 0, v11
    v_cvt_pk_bf16_f32 v12, -v10, v11
    v_and_b32 v13, 0xffff0000, v12
    v_add_f32 v13, 0x3727c5ac, v13
    v_lshlrev_b32 v10, 16, v12
    v_cvt_pk_bf16_f32 v13, v13, v13
    v_lshlrev_b32 v13, 16, v13
    v_sqrt_f32 v13, v13
    v_mov_b32 v11, v10
    v_cvt_pk_bf16_f32 v13, v13, v13
    v_lshlrev_b32 v13, 16, v13
    v_rcp_f32 v12, v13
    v_rcp_f32 v13, v13
    v_pk_add_f32 v[236:237], v[236:237], v[10:11]
    v_pk_add_f32 v[238:239], v[238:239], v[10:11]
    v_pk_add_f32 v[240:241], v[240:241], v[10:11]
    v_pk_add_f32 v[242:243], v[242:243], v[10:11]
    v_pk_add_f32 v[244:245], v[244:245], v[10:11]
    v_cvt_pk_bf16_f32 v236, v236, v237
    v_and_b32 v237, 0xffff0000, v236
    v_lshlrev_b32 v236, 16, v236
    v_cvt_pk_bf16_f32 v238, v238, v239
    v_and_b32 v239, 0xffff0000, v238
    v_lshlrev_b32 v238, 16, v238
    v_cvt_pk_bf16_f32 v240, v240, v241
    v_and_b32 v241, 0xffff0000, v240
    v_lshlrev_b32 v240, 16, v240
    v_cvt_pk_bf16_f32 v242, v242, v243
    v_and_b32 v243, 0xffff0000, v242
    v_lshlrev_b32 v242, 16, v242
    v_cvt_pk_bf16_f32 v244, v244, v245
    v_and_b32 v245, 0xffff0000, v244
    v_lshlrev_b32 v244, 16, v244
    v_pk_mul_f32 v[236:237], v[236:237], v[12:13]
    v_pk_mul_f32 v[238:239], v[238:239], v[12:13]
    v_pk_mul_f32 v[240:241], v[240:241], v[12:13]
    v_pk_mul_f32 v[242:243], v[242:243], v[12:13]
    v_pk_mul_f32 v[244:245], v[244:245], v[12:13]
    v_cvt_pk_bf16_f32 v236, v236, v237
    v_and_b32 v237, 0xffff0000, v236
    v_lshlrev_b32 v236, 16, v236
    v_cvt_pk_bf16_f32 v238, v238, v239
    v_and_b32 v239, 0xffff0000, v238
    v_lshlrev_b32 v238, 16, v238
    v_cvt_pk_bf16_f32 v240, v240, v241
    v_and_b32 v241, 0xffff0000, v240
    v_lshlrev_b32 v240, 16, v240
    v_cvt_pk_bf16_f32 v242, v242, v243
    v_and_b32 v243, 0xffff0000, v242
    v_lshlrev_b32 v242, 16, v242
    v_cvt_pk_bf16_f32 v244, v244, v245
    v_and_b32 v245, 0xffff0000, v244
    v_lshlrev_b32 v244, 16, v244
    s_branch .Lsk_q0_1
.Lst_q0_1:
    s_branch .Lrt_q0_1
.Lsk_q0_1:
    s_waitcnt vmcnt(5)
    s_add_u32 m0, s100, 24576
    s_add_u32 s56, s99, 1572864
    buffer_load_dwordx4 v19, s[48:51], s56 offen nt lds
    s_waitcnt vmcnt(4)
    s_add_u32 s63, s69, 57344
    buffer_load_dwordx4 v[132:135], v1, s[40:43], s63 offen nt
    s_waitcnt vmcnt(4)
    s_add_u32 m0, s100, 32768
    s_add_u32 s56, s99, 2097152
    buffer_load_dwordx4 v19, s[48:51], s56 offen nt lds
    s_waitcnt vmcnt(4)
    s_add_u32 s63, s69, 131072
    buffer_load_dwordx4 v[40:43], v1, s[40:43], s63 offen nt
    s_waitcnt vmcnt(4)
    s_add_u32 m0, s100, 40960
    s_add_u32 s56, s99, 2621440
    buffer_load_dwordx4 v19, s[48:51], s56 offen nt lds
    s_waitcnt vmcnt(4)
    s_add_u32 s63, s69, 139264
    buffer_load_dwordx4 v[44:47], v1, s[40:43], s63 offen nt
    s_waitcnt vmcnt(4)
    s_add_u32 m0, s100, 49152
    s_add_u32 s56, s99, 3145728
    buffer_load_dwordx4 v19, s[48:51], s56 offen nt lds
    s_waitcnt vmcnt(4)
    s_add_u32 s63, s69, 147456
    buffer_load_dwordx4 v[72:75], v1, s[40:43], s63 offen nt
    s_waitcnt vmcnt(4)
    s_add_u32 m0, s100, 57344
    s_add_u32 s56, s99, 3670016
    buffer_load_dwordx4 v19, s[48:51], s56 offen nt lds
    s_waitcnt vmcnt(4)
    s_add_u32 s63, s69, 155648
    buffer_load_dwordx4 v[76:79], v1, s[40:43], s63 offen nt
    s_waitcnt vmcnt(4)
    s_add_u32 m0, s100, 65536
    s_add_u32 s56, s99, 4194304
    buffer_load_dwordx4 v19, s[48:51], s56 offen nt lds
    s_waitcnt vmcnt(4)
    s_add_u32 s63, s69, 163840
    buffer_load_dwordx4 v[104:107], v1, s[40:43], s63 offen nt
    s_waitcnt vmcnt(4)
    s_add_u32 s63, s69, 172032
    buffer_load_dwordx4 v[108:111], v1, s[40:43], s63 offen nt
    s_waitcnt vmcnt(4)
    s_add_u32 s63, s69, 180224
    buffer_load_dwordx4 v[136:139], v1, s[40:43], s63 offen nt
    s_waitcnt vmcnt(4)
    s_add_u32 s63, s69, 188416
    buffer_load_dwordx4 v[140:143], v1, s[40:43], s63 offen nt
    s_waitcnt vmcnt(4)
    s_add_u32 s63, s69, 262144
    buffer_load_dwordx4 v[48:51], v1, s[40:43], s63 offen nt
    s_waitcnt vmcnt(4)
    s_add_u32 s63, s69, 270336
    buffer_load_dwordx4 v[52:55], v1, s[40:43], s63 offen nt
    buffer_load_dwordx4 v[196:199], v2, s[36:39], s58 offen offset:0 sc1
    buffer_load_dwordx4 v[200:203], v2, s[36:39], s58 offen offset:1024 sc1
    buffer_load_dwordx2 v[204:205], v5, s[36:39], s58 offen offset:0 sc1
    buffer_load_dwordx4 v[206:209], v2, s[36:39], s59 offen offset:0 sc1
    buffer_load_dwordx4 v[210:213], v2, s[36:39], s59 offen offset:1024 sc1
    buffer_load_dwordx2 v[214:215], v5, s[36:39], s59 offen offset:0 sc1
    s_add_u32 s63, s69, 278528
    buffer_load_dwordx4 v[80:83], v1, s[40:43], s63 offen nt
    s_add_u32 s63, s69, 286720
    buffer_load_dwordx4 v[84:87], v1, s[40:43], s63 offen nt
    s_add_u32 s63, s69, 294912
    buffer_load_dwordx4 v[112:115], v1, s[40:43], s63 offen nt
    s_barrier
    ds_read_b64_tr_b16 v[160:161], v20 offset:0
    ds_read_b64_tr_b16 v[162:163], v20 offset:512
    ds_read_b64_tr_b16 v[164:165], v20 offset:8192
    ds_read_b64_tr_b16 v[166:167], v20 offset:8704
    ds_read_b64_tr_b16 v[168:169], v20 offset:16384
    ds_read_b64_tr_b16 v[170:171], v20 offset:16896
    ds_read_b64_tr_b16 v[172:173], v20 offset:24576
    ds_read_b64_tr_b16 v[174:175], v20 offset:25088
    ds_read_b64_tr_b16 v[176:177], v21 offset:0
    ds_read_b64_tr_b16 v[178:179], v21 offset:512
    ds_read_b64_tr_b16 v[180:181], v21 offset:8192
    ds_read_b64_tr_b16 v[182:183], v21 offset:8704
    ds_read_b64_tr_b16 v[184:185], v21 offset:16384
    ds_read_b64_tr_b16 v[186:187], v21 offset:16896
    ds_read_b64_tr_b16 v[188:189], v21 offset:24576
    ds_read_b64_tr_b16 v[190:191], v21 offset:25088
    ds_read_b64_tr_b16 v[192:193], v21 offset:32768
    ds_read_b64_tr_b16 v[194:195], v21 offset:33280
    s_add_u32 s63, s69, 303104
    buffer_load_dwordx4 v[116:119], v1, s[40:43], s63 offen nt
    s_waitcnt vmcnt(4)
    s_branch .gpc_2
.gp_1:
    buffer_load_dwordx4 v[196:199], v2, s[36:39], s58 offen offset:0 sc1
    buffer_load_dwordx4 v[200:203], v2, s[36:39], s58 offen offset:1024 sc1
    buffer_load_dwordx2 v[204:205], v5, s[36:39], s58 offen offset:0 sc1
    buffer_load_dwordx4 v[206:209], v2, s[36:39], s59 offen offset:0 sc1
    buffer_load_dwordx4 v[210:213], v2, s[36:39], s59 offen offset:1024 sc1
    buffer_load_dwordx2 v[214:215], v5, s[36:39], s59 offen offset:0 sc1
    s_waitcnt vmcnt(0)
.gpc_2:
    v_min_u32 v10, v197, v199
    v_max_u32 v11, v197, v199
    v_min3_u32 v10, v10, v201, v203
    v_max3_u32 v11, v11, v201, v203
    v_min3_u32 v10, v10, v205, v207
    v_max3_u32 v11, v11, v205, v207
    v_min3_u32 v10, v10, v209, v211
    v_max3_u32 v11, v11, v209, v211
    v_min3_u32 v10, v10, v213, v215
    v_max3_u32 v11, v11, v213, v215
    v_cmp_eq_u32 vcc, s34, v10
    v_cmp_eq_u32 s[56:57], s34, v11
    s_and_b64 vcc, vcc, s[56:57]
    s_cmp_eq_u64 vcc, -1
    s_nop 2
    s_cbranch_scc1 .gpd_3
    s_sub_u32 s35, s35, 1
    s_cbranch_scc1 .Lexit
    s_branch .gp_1
.gpd_3:
    s_add_u32 s63, s69, 311296
    buffer_load_dwordx4 v[144:147], v1, s[40:43], s63 offen nt
    v_and_b32 v207, 0xffff0000, v206
    v_lshlrev_b32 v206, 16, v206
    v_and_b32 v209, 0xffff0000, v208
    v_lshlrev_b32 v208, 16, v208
    v_and_b32 v211, 0xffff0000, v210
    v_lshlrev_b32 v210, 16, v210
    v_and_b32 v213, 0xffff0000, v212
    v_lshlrev_b32 v212, 16, v212
    v_and_b32 v215, 0xffff0000, v214
    v_lshlrev_b32 v214, 16, v214
    v_and_b32 v197, 0xffff0000, v196
    v_lshlrev_b32 v196, 16, v196
    v_and_b32 v199, 0xffff0000, v198
    v_lshlrev_b32 v198, 16, v198
    v_and_b32 v201, 0xffff0000, v200
    v_lshlrev_b32 v200, 16, v200
    v_and_b32 v203, 0xffff0000, v202
    v_lshlrev_b32 v202, 16, v202
    v_and_b32 v205, 0xffff0000, v204
    v_lshlrev_b32 v204, 16, v204
    v_pk_mul_f32 v[236:237], v[236:237], v[206:207]
    v_pk_mul_f32 v[238:239], v[238:239], v[208:209]
    v_pk_mul_f32 v[240:241], v[240:241], v[210:211]
    v_pk_mul_f32 v[242:243], v[242:243], v[212:213]
    v_pk_mul_f32 v[244:245], v[244:245], v[214:215]
    v_cvt_pk_bf16_f32 v236, v236, v237
    v_and_b32 v237, 0xffff0000, v236
    v_lshlrev_b32 v236, 16, v236
    v_cvt_pk_bf16_f32 v238, v238, v239
    v_and_b32 v239, 0xffff0000, v238
    s_branch .Lsk_q0_2
.Lst_q0_2:
    s_branch .Lrt_q0_2
.Lsk_q0_2:
    v_lshlrev_b32 v238, 16, v238
    v_cvt_pk_bf16_f32 v240, v240, v241
    v_and_b32 v241, 0xffff0000, v240
    v_lshlrev_b32 v240, 16, v240
    v_cvt_pk_bf16_f32 v242, v242, v243
    v_and_b32 v243, 0xffff0000, v242
    v_lshlrev_b32 v242, 16, v242
    v_cvt_pk_bf16_f32 v244, v244, v245
    s_branch .Lsk_q0_3
.Lst_q0_3:
    s_branch .Lrt_q0_3
.Lsk_q0_3:
    v_and_b32 v245, 0xffff0000, v244
    v_lshlrev_b32 v244, 16, v244
    v_pk_add_f32 v[236:237], v[236:237], v[196:197]
    v_pk_add_f32 v[238:239], v[238:239], v[198:199]
    v_pk_add_f32 v[240:241], v[240:241], v[200:201]
    v_pk_add_f32 v[242:243], v[242:243], v[202:203]
    v_pk_add_f32 v[244:245], v[244:245], v[204:205]
    v_cvt_pk_bf16_f32 v246, v236, v237
    v_cvt_pk_bf16_f32 v247, v238, v239
    v_cvt_pk_bf16_f32 v248, v240, v241
    v_cvt_pk_bf16_f32 v249, v242, v243
    v_cvt_pk_bf16_f32 v250, v244, v245
    ds_write_b64 v17, v[246:247] offset:0
    ds_write_b64 v17, v[248:249] offset:512
    ds_write_b32 v18, v250 offset:0
    s_add_u32 s63, s69, 319488
    buffer_load_dwordx4 v[148:151], v1, s[40:43], s63 offen nt
    s_waitcnt lgkmcnt(0)
    s_barrier
    s_add_u32 s63, s69, 393216
    buffer_load_dwordx4 v[56:59], v1, s[40:43], s63 offen nt
    ds_read_b128 v[196:199], v16 offset:0
    ds_read_b128 v[200:203], v16 offset:128
    ds_read_b128 v[204:207], v16 offset:256
    ds_read_b128 v[208:211], v16 offset:384
    ds_read_b128 v[212:215], v16 offset:512
    ds_read_b128 v[216:219], v16 offset:640
    ds_read_b128 v[220:223], v16 offset:768
    ds_read_b128 v[224:227], v16 offset:896
    ds_read_b128 v[228:231], v16 offset:1024
    s_waitcnt lgkmcnt(8)
    v_mfma_f32_16x16x32_bf16 v[232:235], v[160:163], v[196:199], 0
    s_waitcnt lgkmcnt(7)
    v_mfma_f32_16x16x32_bf16 v[232:235], v[164:167], v[200:203], v[232:235]
    s_waitcnt lgkmcnt(6)
    v_mfma_f32_16x16x32_bf16 v[232:235], v[168:171], v[204:207], v[232:235]
    s_waitcnt lgkmcnt(5)
    v_mfma_f32_16x16x32_bf16 v[232:235], v[172:175], v[208:211], v[232:235]
    s_waitcnt lgkmcnt(4)
    v_mfma_f32_16x16x32_bf16 v[232:235], v[176:179], v[212:215], v[232:235]
    s_waitcnt lgkmcnt(3)
    v_mfma_f32_16x16x32_bf16 v[232:235], v[180:183], v[216:219], v[232:235]
    s_waitcnt lgkmcnt(2)
    v_mfma_f32_16x16x32_bf16 v[232:235], v[184:187], v[220:223], v[232:235]
    s_waitcnt lgkmcnt(1)
    v_mfma_f32_16x16x32_bf16 v[232:235], v[188:191], v[224:227], v[232:235]
    s_waitcnt lgkmcnt(0)
    v_mfma_f32_16x16x32_bf16 v[232:235], v[192:195], v[228:231], v[232:235]
    s_nop 7
    v_permlane32_swap_b32 v232, v234
    v_permlane32_swap_b32 v233, v235
    v_cndmask_b32 v233, v233, v234, s[96:97]
    v_cndmask_b32 v232, v232, v235, s[96:97]
    s_nop 1
    v_add_f32_dpp v236, v233, v232 quad_perm:[1,0,3,2] row_mask:0xf bank_mask:0xf
    v_and_b32 v12, 1, v0
    v_lshlrev_b32 v12, 8, v12
    v_bfe_u32 v13, v0, 1, 3
    v_lshl_add_u32 v12, v13, 4, v12
    v_cvt_pk_bf16_f32 v236, v236, v236
    ds_write_b16 v23, v236
    v_mov_b32 v243, s34
    s_waitcnt lgkmcnt(0)
    s_barrier
    ds_read2_b32 v[244:245], v24 offset1:1
    v_mov_b32 v241, s34
    s_waitcnt lgkmcnt(0)
    v_mov_b32 v240, v244
    v_mov_b32 v242, v245
    s_mov_b64 exec, 0xffff
    buffer_store_dwordx4 v[240:243], v12, s[36:39], s101 offen sc1
    s_mov_b64 exec, -1
    s_mov_b64 s[18:19], 0
    v_mov_b32 v6, 0
    s_waitcnt vmcnt(3)
    s_bitcmp1_b64 s[14:15], 25
    s_cbranch_scc0 1
    s_waitcnt vmcnt(2)
    s_add_u32 s63, s69, 401408
    buffer_load_dwordx4 v[60:63], v1, s[40:43], s63 offen nt
    s_branch .Ln_att
.La_early:
    s_branch .Lsk_a0_0
.Lst_a0_0:
    s_branch .Lrt_a0_0
.Lsk_a0_0:
    s_mov_b32 s14, 0x6ddb76dd
    s_mov_b32 s15, 0xdb76ddb7
    s_add_u32 s30, s70, -70
    s_mov_b32 s31, s70
    s_cmp_ge_u32 s65, 11
    s_cselect_b32 s99, 1, 0
    s_mul_i32 s57, s99, 3
    s_sub_u32 s100, s65, s57
    s_sub_u32 s100, s100, 8
    s_lshl1_add_u32 s99, s64, s99
    s_mov_b32 s48, s12
    s_and_b32 s49, s13, 0xffff
    s_mov_b32 s50, 0x480000
    s_mov_b32 s51, 0x00020000
    v_bfe_u32 v12, v0, 4, 1
    s_and_b32 s56, s3, 1
    s_lshl_b32 s56, s56, 2
    v_lshl_or_b32 v12, v12, 1, s56
    v_and_b32 v13, 7, v0
    v_xor_b32 v12, v12, v13
    v_lshrrev_b32 v13, 3, v0
    v_mul_u32_u24 v13, 1152, v13
    v_lshl_add_u32 v6, v12, 4, v13
    s_mul_i32 s101, s99, 294912
    s_mul_i32 s56, s100, 384
    s_add_u32 s101, s101, s56
    s_mul_i32 s56, s3, 9216
    s_add_u32 s101, s101, s56
    s_lshl_b32 s57, s3, 10
    s_waitcnt vmcnt(4)
    s_add_u32 m0, s57, 0
    s_add_u32 s56, s101, 0
    buffer_load_dwordx4 v6, s[48:51], s56 offen nt lds
    s_waitcnt vmcnt(4)
    s_add_u32 m0, s57, 32768
    s_add_u32 s56, s101, 128
    buffer_load_dwordx4 v6, s[48:51], s56 offen nt lds
    s_waitcnt vmcnt(4)
    s_bitcmp1_b64 s[14:15], 4
    s_cbranch_scc0 1
    s_waitcnt vmcnt(3)
    s_add_u32 s63, s69, 32768
    buffer_load_dwordx4 v[96:99], v1, s[40:43], s63 offen nt
    s_waitcnt vmcnt(4)
    s_bitcmp1_b64 s[14:15], 5
    s_cbranch_scc0 1
    s_waitcnt vmcnt(2)
    s_add_u32 s63, s69, 40960
    buffer_load_dwordx4 v[100:103], v1, s[40:43], s63 offen nt
    s_waitcnt vmcnt(3)
    s_add_u32 m0, s57, 65536
    s_add_u32 s56, s101, 256
    buffer_load_dwordx4 v6, s[48:51], s56 offen nt lds
    s_waitcnt vmcnt(3)
    s_bitcmp1_b64 s[14:15], 6
    s_cbranch_scc0 1
    s_waitcnt vmcnt(2)
    s_add_u32 s63, s69, 49152
    buffer_load_dwordx4 v[128:131], v1, s[40:43], s63 offen nt
    s_waitcnt vmcnt(3)
    s_bitcmp1_b64 s[14:15], 7
    s_cbranch_scc0 1
    s_waitcnt vmcnt(2)
    s_add_u32 s63, s69, 57344
    buffer_load_dwordx4 v[132:135], v1, s[40:43], s63 offen nt
    s_waitcnt vmcnt(3)
    s_add_u32 m0, s57, 8192
    s_add_u32 s56, s101, 73728
    buffer_load_dwordx4 v6, s[48:51], s56 offen nt lds
    s_waitcnt vmcnt(3)
    s_bitcmp1_b64 s[14:15], 8
    s_cbranch_scc0 1
    s_waitcnt vmcnt(2)
    s_add_u32 s63, s69, 131072
    buffer_load_dwordx4 v[40:43], v1, s[40:43], s63 offen nt
    s_waitcnt vmcnt(3)
    s_bitcmp1_b64 s[14:15], 9
    s_cbranch_scc0 1
    s_waitcnt vmcnt(2)
    s_add_u32 s63, s69, 139264
    buffer_load_dwordx4 v[44:47], v1, s[40:43], s63 offen nt
    s_waitcnt vmcnt(3)
    s_add_u32 m0, s57, 40960
    s_add_u32 s56, s101, 73856
    buffer_load_dwordx4 v6, s[48:51], s56 offen nt lds
    s_waitcnt vmcnt(3)
    s_bitcmp1_b64 s[14:15], 10
    s_cbranch_scc0 1
    s_waitcnt vmcnt(2)
    s_add_u32 s63, s69, 147456
    buffer_load_dwordx4 v[72:75], v1, s[40:43], s63 offen nt
    s_waitcnt vmcnt(3)
    s_bitcmp1_b64 s[14:15], 11
    s_cbranch_scc0 1
    s_waitcnt vmcnt(2)
    s_add_u32 s63, s69, 155648
    buffer_load_dwordx4 v[76:79], v1, s[40:43], s63 offen nt
    s_waitcnt vmcnt(3)
    s_add_u32 m0, s57, 73728
    s_add_u32 s56, s101, 73984
    buffer_load_dwordx4 v6, s[48:51], s56 offen nt lds
    s_waitcnt vmcnt(3)
    s_waitcnt lgkmcnt(0)
    s_add_u32 s34, s34, 1
    s_getreg_b32 s1, hwreg(HW_REG_XCC_ID)
    s_lshl_b32 s1, s1, 24
    s_add_u32 s1, s1, s34
    s_lshr_b32 s0, s2, 3
    s_lshl_b32 s63, s64, 8
    s_add_u32 s0, s0, s63
    s_lshl2_add_u32 s0, s0, 0x480000
    v_mov_b32 v30, s1
    s_cmp_eq_u32 s3, 0
    s_cselect_b64 exec, 1, 0
    buffer_store_dword v30, v2, s[36:39], s0 offen sc1
    s_mov_b64 exec, -1
    s_bitcmp1_b64 s[14:15], 12
    s_cbranch_scc0 1
    s_waitcnt vmcnt(3)
    s_add_u32 s63, s69, 163840
    buffer_load_dwordx4 v[104:107], v1, s[40:43], s63 offen nt
    s_waitcnt vmcnt(4)
    s_bitcmp1_b64 s[14:15], 13
    s_cbranch_scc0 1
    s_waitcnt vmcnt(3)
    s_add_u32 s63, s69, 172032
    buffer_load_dwordx4 v[108:111], v1, s[40:43], s63 offen nt
    s_waitcnt vmcnt(4)
    s_add_u32 m0, s57, 16384
    s_add_u32 s56, s101, 147456
    buffer_load_dwordx4 v6, s[48:51], s56 offen nt lds
    s_waitcnt vmcnt(4)
    s_bitcmp1_b64 s[14:15], 14
    s_cbranch_scc0 1
    s_waitcnt vmcnt(2)
    s_add_u32 s63, s69, 180224
    buffer_load_dwordx4 v[136:139], v1, s[40:43], s63 offen nt
    s_waitcnt vmcnt(3)
    s_bitcmp1_b64 s[14:15], 15
    s_cbranch_scc0 1
    s_waitcnt vmcnt(2)
    s_add_u32 s63, s69, 188416
    buffer_load_dwordx4 v[140:143], v1, s[40:43], s63 offen nt
    s_waitcnt vmcnt(3)
    s_add_u32 m0, s57, 49152
    s_add_u32 s56, s101, 147584
    buffer_load_dwordx4 v6, s[48:51], s56 offen nt lds
    s_waitcnt vmcnt(3)
    s_bitcmp1_b64 s[14:15], 16
    s_cbranch_scc0 1
    s_waitcnt vmcnt(2)
    s_add_u32 s63, s69, 262144
    buffer_load_dwordx4 v[48:51], v1, s[40:43], s63 offen nt
    s_waitcnt vmcnt(3)
    s_bitcmp1_b64 s[14:15], 17
    s_cbranch_scc0 1
    s_waitcnt vmcnt(2)
    s_add_u32 s63, s69, 270336
    buffer_load_dwordx4 v[52:55], v1, s[40:43], s63 offen nt
    s_waitcnt vmcnt(3)
    s_add_u32 m0, s57, 81920
    s_add_u32 s56, s101, 147712
    buffer_load_dwordx4 v6, s[48:51], s56 offen nt lds
    s_waitcnt vmcnt(3)
    s_bitcmp1_b64 s[14:15], 18
    s_cbranch_scc0 1
    s_waitcnt vmcnt(2)
    s_add_u32 s63, s69, 278528
    buffer_load_dwordx4 v[80:83], v1, s[40:43], s63 offen nt
    s_waitcnt vmcnt(3)
    s_bitcmp1_b64 s[14:15], 19
    s_cbranch_scc0 1
    s_waitcnt vmcnt(2)
    s_add_u32 s63, s69, 286720
    buffer_load_dwordx4 v[84:87], v1, s[40:43], s63 offen nt
    s_waitcnt vmcnt(3)
    s_bitcmp1_b64 s[14:15], 20
    s_cbranch_scc0 1
    s_waitcnt vmcnt(2)
    s_add_u32 s63, s69, 294912
    buffer_load_dwordx4 v[112:115], v1, s[40:43], s63 offen nt
    s_waitcnt vmcnt(3)
    s_bitcmp1_b64 s[14:15], 21
    s_cbranch_scc0 1
    s_waitcnt vmcnt(2)
    s_add_u32 s63, s69, 303104
    buffer_load_dwordx4 v[116:119], v1, s[40:43], s63 offen nt
    s_waitcnt vmcnt(3)
    s_bitcmp1_b64 s[14:15], 22
    s_cbranch_scc0 1
    s_waitcnt vmcnt(2)
    s_add_u32 s63, s69, 311296
    buffer_load_dwordx4 v[144:147], v1, s[40:43], s63 offen nt
    s_branch .Lsk_a0_1
.Lst_a0_1:
    s_branch .Lrt_a0_1
.Lsk_a0_1:
    s_waitcnt vmcnt(3)
    s_bitcmp1_b64 s[14:15], 23
    s_cbranch_scc0 1
    s_waitcnt vmcnt(2)
    s_add_u32 s63, s69, 319488
    buffer_load_dwordx4 v[148:151], v1, s[40:43], s63 offen nt
    s_waitcnt vmcnt(3)
    s_bitcmp1_b64 s[14:15], 24
    s_cbranch_scc0 1
    s_waitcnt vmcnt(2)
    s_add_u32 s63, s69, 393216
    buffer_load_dwordx4 v[56:59], v1, s[40:43], s63 offen nt
    s_waitcnt vmcnt(3)
    s_bitcmp1_b64 s[14:15], 25
    s_cbranch_scc0 1
    s_waitcnt vmcnt(2)
    s_add_u32 s63, s69, 401408
    buffer_load_dwordx4 v[60:63], v1, s[40:43], s63 offen nt
    s_mov_b64 s[18:19], -1
.Ln_att:
    v_and_b32 v8, 1, v0
    v_lshlrev_b32 v8, 8, v8
    v_and_b32 v9, 0x3c, v0
    v_lshl_add_u32 v9, v9, 2, v8
    v_add_u32 v7, v9, v8
    v_and_b32 v9, 0x3c, v0
    v_lshrrev_b32 v8, 4, v8
    v_and_b32 v9, 4, v0
    v_lshl_add_u32 v9, v9, 3, v8
    s_lshl_b32 s58, s66, 14
    s_lshl_b32 s59, s67, 10
    s_add_u32 s58, s58, s59
    s_add_u32 s58, s58, 0x70000
    s_lshl4_add_u32 s59, s66, s67
    s_lshl_b32 s59, s59, 7
    s_add_u32 s59, s59, 0x430000
    s_memrealtime s[8:9]
    s_waitcnt vmcnt(8)
    s_waitcnt lgkmcnt(0)
    s_sub_u32 s8, s8, s30
    s_cmpk_ge_u32 s8, 1211
    s_cbranch_scc1 .ap_4
    s_waitcnt vmcnt(5)
    s_cmpk_ge_u32 s8, 1111
    s_cbranch_scc1 .ap_4
    s_waitcnt vmcnt(3)
    s_bitcmp1_b64 s[14:15], 26
    s_cbranch_scc0 1
    s_waitcnt vmcnt(2)
    s_cmpk_ge_u32 s8, 991
    s_cbranch_scc1 .ap_4
    s_waitcnt vmcnt(1)
.ap_4:
    s_add_u32 s63, s69, 409600
    buffer_load_dwordx4 v[88:91], v1, s[40:43], s63 offen nt
    v_and_b32 v157, 7, v0
    v_lshlrev_b32 v157, 2, v157
    s_mov_b32 s63, 0x4a1000
    buffer_load_dword v156, v157, s[36:39], s63 offen
    s_cmp_eq_u32 s3, 0
    s_cbranch_scc1 .Lst_n1_0
.Lrt_n1_0:
    s_cmp_eq_u32 s3, 1
    s_cbranch_scc1 .Lst_n1_1
    s_cmp_eq_u32 s3, 2
    s_cbranch_scc1 .Lst_n1_2
    s_cmp_eq_u32 s3, 3
    s_cbranch_scc1 .Lst_n1_3
    s_cmp_eq_u32 s3, 4
    s_cbranch_scc1 .Lst_n1_4
    s_cmp_eq_u32 s3, 5
    s_cbranch_scc1 .Lst_n1_5
    s_cmp_eq_u32 s3, 6
    s_cbranch_scc1 .Lst_n1_6
    s_cmp_eq_u32 s3, 7
    s_cbranch_scc1 .Lst_n1_7
    s_cmp_eq_u32 s3, 0
    s_cbranch_scc1 .Lrt_n1_8
.Lrt_n1_1:
.Lrt_n1_2:
.Lrt_n1_3:
.Lrt_n1_4:
.Lrt_n1_5:
.Lrt_n1_6:
.Lrt_n1_7:
.Lrt_n1_8:
    s_memrealtime s[8:9]
    s_waitcnt vmcnt(9)
    s_waitcnt lgkmcnt(0)
    s_sub_u32 s8, s8, s30
    s_cmpk_ge_u32 s8, 1238
    s_cbranch_scc1 .ap_5
    s_waitcnt vmcnt(6)
    s_cmpk_ge_u32 s8, 1138
    s_cbranch_scc1 .ap_5
    s_waitcnt vmcnt(4)
    s_bitcmp1_b64 s[14:15], 27
    s_cbranch_scc0 1
    s_waitcnt vmcnt(3)
    s_cmpk_ge_u32 s8, 1018
    s_cbranch_scc1 .ap_5
    s_waitcnt vmcnt(2)
.ap_5:
    s_add_u32 s63, s69, 417792
    buffer_load_dwordx4 v[92:95], v1, s[40:43], s63 offen nt
    s_memrealtime s[8:9]
    s_waitcnt vmcnt(9)
    s_waitcnt lgkmcnt(0)
    s_sub_u32 s8, s8, s30
    s_cmpk_ge_u32 s8, 1265
    s_cbranch_scc1 .ap_6
    s_waitcnt vmcnt(6)
    s_cmpk_ge_u32 s8, 1165
    s_cbranch_scc1 .ap_6
    s_waitcnt vmcnt(4)
    s_bitcmp1_b64 s[14:15], 28
    s_cbranch_scc0 1
    s_waitcnt vmcnt(3)
    s_cmpk_ge_u32 s8, 1045
    s_cbranch_scc1 .ap_6
    s_waitcnt vmcnt(2)
.ap_6:
    s_add_u32 s63, s69, 425984
    buffer_load_dwordx4 v[120:123], v1, s[40:43], s63 offen nt
    s_memrealtime s[8:9]
    s_waitcnt vmcnt(9)
    s_waitcnt lgkmcnt(0)
    s_sub_u32 s8, s8, s30
    s_cmpk_ge_u32 s8, 1292
    s_cbranch_scc1 .ap_7
    s_waitcnt vmcnt(6)
    s_cmpk_ge_u32 s8, 1192
    s_cbranch_scc1 .ap_7
    s_waitcnt vmcnt(4)
    s_bitcmp1_b64 s[14:15], 29
    s_cbranch_scc0 1
    s_waitcnt vmcnt(3)
    s_cmpk_ge_u32 s8, 1072
    s_cbranch_scc1 .ap_7
    s_waitcnt vmcnt(1)
.ap_7:
    s_add_u32 s63, s69, 434176
    buffer_load_dwordx4 v[124:127], v1, s[40:43], s63 offen nt
    s_memrealtime s[8:9]
    s_waitcnt vmcnt(9)
    s_waitcnt lgkmcnt(0)
    s_sub_u32 s8, s8, s30
    s_cmpk_ge_u32 s8, 1320
    s_cbranch_scc1 .ap_8
    s_waitcnt vmcnt(6)
    s_cmpk_ge_u32 s8, 1220
    s_cbranch_scc1 .ap_8
    s_waitcnt vmcnt(4)
    s_bitcmp1_b64 s[14:15], 30
    s_cbranch_scc0 1
    s_waitcnt vmcnt(2)
    s_cmpk_ge_u32 s8, 1100
    s_cbranch_scc1 .ap_8
    s_waitcnt vmcnt(1)
.ap_8:
    s_add_u32 s63, s69, 442368
    buffer_load_dwordx4 v[152:155], v1, s[40:43], s63 offen nt
    s_waitcnt vmcnt(4)
    s_sub_u32 s63, s70, 300
    v_subrev_u32 v156, s63, v156
    v_mov_b32 v157, 600
    v_cmp_lt_u32 s[8:9], v156, v157
    v_add_u32_dpp v156, v156, v156 quad_perm:[1,0,3,2] row_mask:0xf bank_mask:0xf
    s_nop 1
    v_add_u32_dpp v156, v156, v156 quad_perm:[2,3,0,1] row_mask:0xf bank_mask:0xf
    s_nop 1
    v_add_u32_dpp v156, v156, v156 row_ror:4 row_mask:0xf bank_mask:0xf
    s_nop 0
    v_readfirstlane_b32 s63, v156
    s_cmp_eq_u64 s[8:9], -1
    s_nop 3
    s_cbranch_scc0 .et_9
    s_lshr_b32 s63, s63, 3
    s_sub_u32 s63, s63, 300
    s_add_u32 s30, s30, s63
    s_add_u32 s31, s31, s63
.et_9:
    s_memrealtime s[8:9]
    s_waitcnt lgkmcnt(0)
    s_sub_u32 s8, s8, s30
    s_cmpk_ge_u32 s8, 1347
    s_cbranch_scc1 .ap_10
    s_waitcnt vmcnt(4)
    s_cmpk_ge_u32 s8, 1247
    s_cbranch_scc1 .ap_10
    s_waitcnt vmcnt(3)
    s_bitcmp1_b64 s[14:15], 31
    s_cbranch_scc0 1
    s_waitcnt vmcnt(2)
    s_cmpk_ge_u32 s8, 1127
    s_cbranch_scc1 .ap_10
    s_waitcnt vmcnt(1)
.ap_10:
    s_add_u32 s63, s69, 450560
    buffer_load_dwordx4 v[156:159], v1, s[40:43], s63 offen nt
    s_memrealtime s[8:9]
    s_waitcnt lgkmcnt(0)
    s_sub_u32 s8, s8, s30
    s_cmpk_ge_u32 s8, 1374
    s_cbranch_scc1 .ap_11
    s_waitcnt vmcnt(5)
    s_cmpk_ge_u32 s8, 1274
    s_cbranch_scc1 .ap_11
    s_waitcnt vmcnt(3)
    s_bitcmp1_b64 s[14:15], 32
    s_cbranch_scc0 1
    s_waitcnt vmcnt(2)
    s_cmpk_ge_u32 s8, 1154
    s_cbranch_scc1 .ap_11
    s_waitcnt vmcnt(1)
.ap_11:
    v_bfe_u32 v1, v0, 4, 2
    v_and_b32 v10, 0xf0, v2
    v_lshlrev_b32 v1, 2, v1
    v_bfe_u32 v1, s6, v1, 4
    v_lshl_add_u32 v1, v1, 8, v10
    s_add_u32 s63, s69, 0
    buffer_load_dwordx4 v[160:163], v1, s[44:47], s63 offen nt
    s_memrealtime s[8:9]
    s_waitcnt lgkmcnt(0)
    s_sub_u32 s8, s8, s30
    s_cmpk_ge_u32 s8, 1401
    s_cbranch_scc1 .ap_12
    s_waitcnt vmcnt(5)
    s_cmpk_ge_u32 s8, 1301
    s_cbranch_scc1 .ap_12
    s_waitcnt vmcnt(3)
    s_bitcmp1_b64 s[14:15], 33
    s_cbranch_scc0 1
    s_waitcnt vmcnt(2)
    s_cmpk_ge_u32 s8, 1181
    s_cbranch_scc1 .ap_12
    s_waitcnt vmcnt(1)
.ap_12:
    s_add_u32 s63, s69, 8192
    buffer_load_dwordx4 v[164:167], v1, s[44:47], s63 offen nt
    s_memrealtime s[8:9]
    s_waitcnt lgkmcnt(0)
    s_sub_u32 s8, s8, s30
    s_cmpk_ge_u32 s8, 1428
    s_cbranch_scc1 .ap_13
    s_waitcnt vmcnt(5)
    s_cmpk_ge_u32 s8, 1328
    s_cbranch_scc1 .ap_13
    s_waitcnt vmcnt(3)
    s_bitcmp1_b64 s[14:15], 34
    s_cbranch_scc0 1
    s_waitcnt vmcnt(2)
    s_cmpk_ge_u32 s8, 1208
    s_cbranch_scc1 .ap_13
    s_branch .Lsk_n1_0
.Lst_n1_0:
    s_branch .Lrt_n1_0
.Lsk_n1_0:
    s_waitcnt vmcnt(1)
.ap_13:
    s_add_u32 s63, s69, 16384
    buffer_load_dwordx4 v[168:171], v1, s[44:47], s63 offen nt
    s_memrealtime s[8:9]
    s_waitcnt lgkmcnt(0)
    s_sub_u32 s8, s8, s30
    s_cmpk_ge_u32 s8, 1456
    s_cbranch_scc1 .ap_14
    s_waitcnt vmcnt(5)
    s_cmpk_ge_u32 s8, 1356
    s_cbranch_scc1 .ap_14
    s_waitcnt vmcnt(3)
    s_bitcmp1_b64 s[14:15], 35
    s_cbranch_scc0 1
    s_waitcnt vmcnt(2)
    s_cmpk_ge_u32 s8, 1236
    s_cbranch_scc1 .ap_14
    s_waitcnt vmcnt(1)
.ap_14:
    s_add_u32 s63, s69, 24576
    buffer_load_dwordx4 v[172:175], v1, s[44:47], s63 offen nt
    buffer_load_dwordx4 v[16:19], v7, s[36:39], s58 offen offset:0 sc1
    buffer_load_dwordx4 v[20:23], v7, s[36:39], s58 offen offset:256 sc1
    s_memrealtime s[8:9]
    s_waitcnt vmcnt(8)
    s_waitcnt lgkmcnt(0)
    s_sub_u32 s8, s8, s30
    s_cmpk_ge_u32 s8, 1486
    s_cbranch_scc1 .ap_15
    s_waitcnt vmcnt(5)
    s_cmpk_ge_u32 s8, 1386
    s_cbranch_scc1 .ap_15
    s_waitcnt vmcnt(3)
    s_bitcmp1_b64 s[14:15], 36
    s_cbranch_scc0 1
    s_waitcnt vmcnt(2)
    s_cmpk_ge_u32 s8, 1266
    s_cbranch_scc1 .ap_15
    s_waitcnt vmcnt(1)
.ap_15:
    s_add_u32 s63, s69, 32768
    buffer_load_dwordx4 v[176:179], v1, s[44:47], s63 offen nt
    s_memrealtime s[8:9]
    s_waitcnt vmcnt(8)
    s_waitcnt lgkmcnt(0)
    s_sub_u32 s8, s8, s30
    s_cmpk_ge_u32 s8, 1516
    s_cbranch_scc1 .ap_16
    s_waitcnt vmcnt(5)
    s_cmpk_ge_u32 s8, 1416
    s_cbranch_scc1 .ap_16
    s_waitcnt vmcnt(3)
    s_bitcmp1_b64 s[14:15], 37
    s_cbranch_scc0 1
    s_waitcnt vmcnt(2)
    s_cmpk_ge_u32 s8, 1296
    s_cbranch_scc1 .ap_16
    s_waitcnt vmcnt(1)
.ap_16:
    s_add_u32 s63, s69, 40960
    buffer_load_dwordx4 v[180:183], v1, s[44:47], s63 offen nt
    s_memrealtime s[8:9]
    s_waitcnt vmcnt(8)
    s_waitcnt lgkmcnt(0)
    s_sub_u32 s8, s8, s30
    s_cmpk_ge_u32 s8, 1546
    s_cbranch_scc1 .ap_17
    s_waitcnt vmcnt(5)
    s_cmpk_ge_u32 s8, 1446
    s_cbranch_scc1 .ap_17
    s_waitcnt vmcnt(3)
    s_bitcmp1_b64 s[14:15], 38
    s_cbranch_scc0 1
    s_waitcnt vmcnt(2)
    s_cmpk_ge_u32 s8, 1326
    s_cbranch_scc1 .ap_17
    s_waitcnt vmcnt(1)
.ap_17:
    s_add_u32 s63, s69, 49152
    buffer_load_dwordx4 v[184:187], v1, s[44:47], s63 offen nt
    s_waitcnt vmcnt(3)
    s_branch .gpc_19
.gp_18:
    buffer_load_dwordx4 v[16:19], v7, s[36:39], s58 offen offset:0 sc1
    buffer_load_dwordx4 v[20:23], v7, s[36:39], s58 offen offset:256 sc1
    s_waitcnt vmcnt(0)
.gpc_19:
    v_min_u32 v10, v17, v19
    v_max_u32 v11, v17, v19
    v_min3_u32 v10, v10, v21, v23
    v_max3_u32 v11, v11, v21, v23
    v_cmp_eq_u32 vcc, s34, v10
    v_cmp_eq_u32 s[56:57], s34, v11
    s_and_b64 vcc, vcc, s[56:57]
    s_cmp_eq_u64 vcc, -1
    s_nop 2
    s_cbranch_scc1 .gpd_20
    s_sub_u32 s35, s35, 1
    s_cbranch_scc1 .Lexit
    s_sleep 1
    s_branch .gp_18
.gpd_20:
    s_mov_b32 vcc_lo, 0xcccccccc
    s_mov_b32 vcc_hi, 0xcccccccc
    v_cndmask_b32_e64 v24, v16, 0, vcc
    v_cndmask_b32_e64 v25, v18, 0, vcc
    v_cndmask_b32_e64 v26, v20, 0, vcc
    v_cndmask_b32_e64 v27, v22, 0, vcc
    v_cndmask_b32_e32 v28, 0, v16, vcc
    v_cndmask_b32_e32 v29, 0, v18, vcc
    v_cndmask_b32_e32 v30, 0, v20, vcc
    v_cndmask_b32_e32 v31, 0, v22, vcc
    v_mfma_f32_16x16x32_bf16 v[16:19], v[32:35], v[24:27], 0
    v_mfma_f32_16x16x32_bf16 v[32:35], v[40:43], v[24:27], 0
    v_mfma_f32_16x16x32_bf16 v[16:19], v[36:39], v[28:31], v[16:19]
    v_mfma_f32_16x16x32_bf16 v[40:43], v[48:51], v[24:27], 0
    v_mfma_f32_16x16x32_bf16 v[32:35], v[44:47], v[28:31], v[32:35]
    v_mfma_f32_16x16x32_bf16 v[48:51], v[56:59], v[24:27], 0
    v_mfma_f32_16x16x32_bf16 v[40:43], v[52:55], v[28:31], v[40:43]
    v_mfma_f32_16x16x32_bf16 v[56:59], v[64:67], v[24:27], 0
    v_mfma_f32_16x16x32_bf16 v[48:51], v[60:63], v[28:31], v[48:51]
    s_nop 1
    v_add_f32_dpp v10, v17, v16 row_ror:12 row_mask:0xf bank_mask:0x1
    s_memrealtime s[8:9]
    s_waitcnt lgkmcnt(0)
    s_sub_u32 s8, s8, s30
    s_cmpk_ge_u32 s8, 1576
    s_nop 0
    s_cbranch_scc1 .ap_21
    s_waitcnt vmcnt(3)
    s_cmpk_ge_u32 s8, 1476
    s_cbranch_scc1 .ap_21
    s_waitcnt vmcnt(3)
    s_bitcmp1_b64 s[14:15], 39
    s_cbranch_scc0 1
    s_waitcnt vmcnt(2)
    s_cmpk_ge_u32 s8, 1356
    s_cbranch_scc1 .ap_21
    s_waitcnt vmcnt(1)
.ap_21:
    s_add_u32 s63, s69, 57344
    buffer_load_dwordx4 v[188:191], v1, s[44:47], s63 offen nt
    v_mfma_f32_16x16x32_bf16 v[64:67], v[72:75], v[24:27], 0
    v_mfma_f32_16x16x32_bf16 v[56:59], v[68:71], v[28:31], v[56:59]
    v_add_f32_dpp v11, v33, v32 row_ror:12 row_mask:0xf bank_mask:0x1
    v_add_f32_dpp v10, v18, v10 row_ror:8 row_mask:0xf bank_mask:0x1
    v_mfma_f32_16x16x32_bf16 v[72:75], v[80:83], v[24:27], 0
    v_mfma_f32_16x16x32_bf16 v[64:67], v[76:79], v[28:31], v[64:67]
    v_add_f32_dpp v12, v41, v40 row_ror:12 row_mask:0xf bank_mask:0x1
    v_add_f32_dpp v11, v34, v11 row_ror:8 row_mask:0xf bank_mask:0x1
    v_add_f32_dpp v10, v19, v10 row_ror:4 row_mask:0xf bank_mask:0x1
    v_mfma_f32_16x16x32_bf16 v[80:83], v[88:91], v[24:27], 0
    v_mfma_f32_16x16x32_bf16 v[72:75], v[84:87], v[28:31], v[72:75]
    v_add_f32_dpp v13, v49, v48 row_ror:12 row_mask:0xf bank_mask:0x1
    v_add_f32_dpp v12, v42, v12 row_ror:8 row_mask:0xf bank_mask:0x1
    v_add_f32_dpp v11, v35, v11 row_ror:4 row_mask:0xf bank_mask:0x1
    v_mfma_f32_16x16x32_bf16 v[88:91], v[96:99], v[24:27], 0
    v_mfma_f32_16x16x32_bf16 v[80:83], v[92:95], v[28:31], v[80:83]
    v_add_f32_dpp v10, v58, v57 row_ror:12 row_mask:0xf bank_mask:0x2
    v_add_f32_dpp v13, v50, v13 row_ror:8 row_mask:0xf bank_mask:0x1
    v_add_f32_dpp v12, v43, v12 row_ror:4 row_mask:0xf bank_mask:0x1
    s_memrealtime s[8:9]
    s_waitcnt lgkmcnt(0)
    s_sub_u32 s8, s8, s30
    s_cmpk_ge_u32 s8, 1606
    s_nop 0
    s_cbranch_scc1 .ap_22
    s_waitcnt vmcnt(4)
    s_cmpk_ge_u32 s8, 1506
    s_cbranch_scc1 .ap_22
    s_waitcnt vmcnt(3)
    s_bitcmp1_b64 s[14:15], 40
    s_cbranch_scc0 1
    s_waitcnt vmcnt(2)
    s_cmpk_ge_u32 s8, 1386
    s_cbranch_scc1 .ap_22
    s_waitcnt vmcnt(1)
.ap_22:
    s_add_u32 s63, s69, 131072
    buffer_load_dwordx4 v[192:195], v1, s[44:47], s63 offen nt
    v_mfma_f32_16x16x32_bf16 v[96:99], v[104:107], v[24:27], 0
    v_mfma_f32_16x16x32_bf16 v[88:91], v[100:103], v[28:31], v[88:91]
    v_add_f32_dpp v11, v66, v65 row_ror:12 row_mask:0xf bank_mask:0x2
    v_add_f32_dpp v10, v59, v10 row_ror:8 row_mask:0xf bank_mask:0x2
    v_add_f32_dpp v13, v51, v13 row_ror:4 row_mask:0xf bank_mask:0x1
    v_mfma_f32_16x16x32_bf16 v[104:107], v[112:115], v[24:27], 0
    v_mfma_f32_16x16x32_bf16 v[96:99], v[108:111], v[28:31], v[96:99]
    v_add_f32_dpp v12, v74, v73 row_ror:12 row_mask:0xf bank_mask:0x2
    v_add_f32_dpp v11, v67, v11 row_ror:8 row_mask:0xf bank_mask:0x2
    v_add_f32_dpp v10, v56, v10 row_ror:4 row_mask:0xf bank_mask:0x2
    v_mfma_f32_16x16x32_bf16 v[112:115], v[120:123], v[24:27], 0
    v_mfma_f32_16x16x32_bf16 v[104:107], v[116:119], v[28:31], v[104:107]
    v_add_f32_dpp v13, v82, v81 row_ror:12 row_mask:0xf bank_mask:0x2
    v_add_f32_dpp v12, v75, v12 row_ror:8 row_mask:0xf bank_mask:0x2
    v_add_f32_dpp v11, v64, v11 row_ror:4 row_mask:0xf bank_mask:0x2
    v_mfma_f32_16x16x32_bf16 v[120:123], v[128:131], v[24:27], 0
    v_mfma_f32_16x16x32_bf16 v[112:115], v[124:127], v[28:31], v[112:115]
    v_add_f32_dpp v10, v91, v90 row_ror:12 row_mask:0xf bank_mask:0x4
    v_add_f32_dpp v13, v83, v13 row_ror:8 row_mask:0xf bank_mask:0x2
    v_add_f32_dpp v12, v72, v12 row_ror:4 row_mask:0xf bank_mask:0x2
    s_branch .Lsk_n1_1
.Lst_n1_1:
    s_branch .Lrt_n1_1
.Lsk_n1_1:
    s_memrealtime s[8:9]
    s_waitcnt lgkmcnt(0)
    s_sub_u32 s8, s8, s30
    s_cmpk_ge_u32 s8, 1636
    s_nop 0
    s_cbranch_scc1 .ap_23
    s_waitcnt vmcnt(5)
    s_cmpk_ge_u32 s8, 1536
    s_cbranch_scc1 .ap_23
    s_waitcnt vmcnt(3)
    s_bitcmp1_b64 s[14:15], 41
    s_cbranch_scc0 1
    s_waitcnt vmcnt(2)
    s_cmpk_ge_u32 s8, 1416
    s_cbranch_scc1 .ap_23
    s_waitcnt vmcnt(1)
.ap_23:
    s_add_u32 s63, s69, 139264
    buffer_load_dwordx4 v[196:199], v1, s[44:47], s63 offen nt
    v_mfma_f32_16x16x32_bf16 v[128:131], v[136:139], v[24:27], 0
    v_mfma_f32_16x16x32_bf16 v[120:123], v[132:135], v[28:31], v[120:123]
    v_add_f32_dpp v11, v99, v98 row_ror:12 row_mask:0xf bank_mask:0x4
    v_add_f32_dpp v10, v88, v10 row_ror:8 row_mask:0xf bank_mask:0x4
    v_add_f32_dpp v13, v80, v13 row_ror:4 row_mask:0xf bank_mask:0x2
    v_mfma_f32_16x16x32_bf16 v[136:139], v[144:147], v[24:27], 0
    v_mfma_f32_16x16x32_bf16 v[128:131], v[140:143], v[28:31], v[128:131]
    v_add_f32_dpp v12, v107, v106 row_ror:12 row_mask:0xf bank_mask:0x4
    v_add_f32_dpp v11, v96, v11 row_ror:8 row_mask:0xf bank_mask:0x4
    v_add_f32_dpp v10, v89, v10 row_ror:4 row_mask:0xf bank_mask:0x4
    v_mfma_f32_16x16x32_bf16 v[144:147], v[152:155], v[24:27], 0
    v_mfma_f32_16x16x32_bf16 v[136:139], v[148:151], v[28:31], v[136:139]
    v_add_f32_dpp v13, v115, v114 row_ror:12 row_mask:0xf bank_mask:0x4
    v_add_f32_dpp v12, v104, v12 row_ror:8 row_mask:0xf bank_mask:0x4
    v_add_f32_dpp v11, v97, v11 row_ror:4 row_mask:0xf bank_mask:0x4
    v_mfma_f32_16x16x32_bf16 v[144:147], v[156:159], v[28:31], v[144:147]
    v_add_f32_dpp v10, v120, v123 row_ror:12 row_mask:0xf bank_mask:0x8
    v_add_f32_dpp v13, v112, v13 row_ror:8 row_mask:0xf bank_mask:0x4
    v_add_f32_dpp v12, v105, v12 row_ror:4 row_mask:0xf bank_mask:0x4
    s_branch .Lsk_n1_2
.Lst_n1_2:
    s_branch .Lrt_n1_2
.Lsk_n1_2:
    s_memrealtime s[8:9]
    s_waitcnt lgkmcnt(0)
    s_sub_u32 s8, s8, s30
    s_cmpk_ge_u32 s8, 1666
    s_nop 0
    s_cbranch_scc1 .ap_24
    s_waitcnt vmcnt(5)
    s_cmpk_ge_u32 s8, 1566
    s_cbranch_scc1 .ap_24
    s_waitcnt vmcnt(3)
    s_bitcmp1_b64 s[14:15], 42
    s_cbranch_scc0 1
    s_waitcnt vmcnt(2)
    s_cmpk_ge_u32 s8, 1446
    s_cbranch_scc1 .ap_24
    s_waitcnt vmcnt(1)
.ap_24:
    s_add_u32 s63, s69, 147456
    buffer_load_dwordx4 v[200:203], v1, s[44:47], s63 offen nt
    v_add_f32_dpp v11, v128, v131 row_ror:12 row_mask:0xf bank_mask:0x8
    v_add_f32_dpp v10, v121, v10 row_ror:8 row_mask:0xf bank_mask:0x8
    v_add_f32_dpp v13, v113, v13 row_ror:4 row_mask:0xf bank_mask:0x4
    v_add_f32_dpp v12, v136, v139 row_ror:12 row_mask:0xf bank_mask:0x8
    v_add_f32_dpp v11, v129, v11 row_ror:8 row_mask:0xf bank_mask:0x8
    v_add_f32_dpp v10, v122, v10 row_ror:4 row_mask:0xf bank_mask:0x8
    v_add_f32_dpp v13, v144, v147 row_ror:12 row_mask:0xf bank_mask:0x8
    v_add_f32_dpp v12, v137, v12 row_ror:8 row_mask:0xf bank_mask:0x8
    v_add_f32_dpp v11, v130, v11 row_ror:4 row_mask:0xf bank_mask:0x8
    v_add_f32_dpp v13, v145, v13 row_ror:8 row_mask:0xf bank_mask:0x8
    v_add_f32_dpp v12, v138, v12 row_ror:4 row_mask:0xf bank_mask:0x8
    s_memrealtime s[8:9]
    s_waitcnt lgkmcnt(0)
    s_sub_u32 s8, s8, s30
    s_cmpk_ge_u32 s8, 1696
    s_cbranch_scc1 .ap_25
    s_waitcnt vmcnt(5)
    s_cmpk_ge_u32 s8, 1596
    s_cbranch_scc1 .ap_25
    s_waitcnt vmcnt(3)
    s_bitcmp1_b64 s[14:15], 43
    s_cbranch_scc0 1
    s_waitcnt vmcnt(2)
    s_cmpk_ge_u32 s8, 1476
    s_cbranch_scc1 .ap_25
    s_waitcnt vmcnt(1)
.ap_25:
    s_add_u32 s63, s69, 155648
    buffer_load_dwordx4 v[204:207], v1, s[44:47], s63 offen nt
    v_add_f32_dpp v13, v146, v13 row_ror:4 row_mask:0xf bank_mask:0x8
    s_mov_b32 s60, 0x3db504f3
    s_mov_b32 s61, 0x3db504f3
    v_cvt_pk_bf16_f32 v10, v10, v11
    v_and_b32 v11, 0xffff0000, v10
    v_lshlrev_b32 v10, 16, v10
    v_cvt_pk_bf16_f32 v12, v12, v13
    v_and_b32 v13, 0xffff0000, v12
    v_lshlrev_b32 v12, 16, v12
    v_pk_mul_f32 v[10:11], v[10:11], s[60:61]
    v_pk_mul_f32 v[12:13], v[12:13], s[60:61]
    v_cvt_pk_bf16_f32 v10, v10, v11
    v_and_b32 v11, 0xffff0000, v10
    v_lshlrev_b32 v10, 16, v10
    v_cvt_pk_bf16_f32 v12, v12, v13
    v_and_b32 v13, 0xffff0000, v12
    v_lshlrev_b32 v12, 16, v12
    v_max_f32 v14, v10, v11
    v_max3_f32 v14, v14, v12, v13
    s_mov_b32 s60, 0x3fb8aa3b
    v_mov_b32 v22, s34
    v_mov_b32 v23, s34
    v_max_f32_dpp v14, v14, v14 quad_perm:[2,3,0,1] row_mask:0xf bank_mask:0xf
    s_nop 1
    v_max_f32_dpp v14, v14, v14 row_ror:4 row_mask:0xf bank_mask:0xf
    s_nop 1
    v_max_f32_dpp v14, v14, v14 row_ror:8 row_mask:0xf bank_mask:0xf
    v_mov_b32 v15, v14
    s_nop 1
    v_permlane16_swap_b32 v15, v14
    v_max_f32 v14, v15, v14
    v_mov_b32 v15, v14
    s_nop 1
    v_permlane32_swap_b32 v15, v14
    v_max_f32 v14, v15, v14
    v_mul_f32 v15, 0xbfb8aa3b, v14
    v_fma_f32 v10, v10, s60, v15
    v_fma_f32 v11, v11, s60, v15
    v_fma_f32 v12, v12, s60, v15
    v_fma_f32 v13, v13, s60, v15
    v_exp_f32 v10, v10
    v_exp_f32 v11, v11
    v_exp_f32 v12, v12
    v_exp_f32 v13, v13
    v_mov_b32 v20, v14
    v_pk_add_f32 v[16:17], v[10:11], v[12:13]
    v_add_f32 v21, v16, v17
    s_lshl_b32 s60, s68, 5
    s_lshl_b32 s61, s3, 4
    s_add_u32 s61, s61, 159104
    v_add_u32 v16, s61, v3
    v_mov_b32 v17, 159232
    v_mov_b32 v18, 1
    s_add_u32 s60, s60, s59
    v_add_f32_dpp v21, v21, v21 quad_perm:[2,3,0,1] row_mask:0xf bank_mask:0xf
    s_nop 1
    v_add_f32_dpp v21, v21, v21 row_ror:4 row_mask:0xf bank_mask:0xf
    s_nop 1
    v_add_f32_dpp v21, v21, v21 row_ror:8 row_mask:0xf bank_mask:0xf
    v_mov_b32 v15, v21
    s_nop 1
    v_permlane16_swap_b32 v15, v21
    v_add_f32 v21, v15, v21
    v_mov_b32 v15, v21
    s_nop 1
    v_permlane32_swap_b32 v15, v21
    v_add_f32 v21, v15, v21
    s_mov_b64 exec, 3
    ds_write_b64 v16, v[20:21]
    s_mov_b64 exec, 1
    ds_add_rtn_u32 v18, v17, v18
    s_mov_b64 exec, -1
    v_and_b32 v16, 0x78, v3
    v_or_b32 v16, 159104, v16
    s_waitcnt lgkmcnt(0)
    v_readfirstlane_b32 s61, v18
    s_cmp_eq_u32 s61, 7
    s_nop 3
    s_cbranch_scc0 .mlc_26
    ds_read_b64 v[18:19], v16
    s_waitcnt lgkmcnt(0)
    v_mov_b32 v20, v18
    s_nop 1
    v_max_f32_dpp v20, v20, v20 quad_perm:[2,3,0,1] row_mask:0xf bank_mask:0xf
    s_nop 1
    v_max_f32_dpp v20, v20, v20 row_ror:4 row_mask:0xf bank_mask:0xf
    s_nop 1
    v_max_f32_dpp v20, v20, v20 row_ror:8 row_mask:0xf bank_mask:0xf
    v_sub_f32 v18, v18, v20
    v_mul_f32 v18, 0x3fb8aa3b, v18
    v_exp_f32 v18, v18
    s_nop 0
    v_mul_f32 v21, v18, v19
    s_nop 1
    v_add_f32_dpp v21, v21, v21 quad_perm:[2,3,0,1] row_mask:0xf bank_mask:0xf
    s_nop 1
    v_add_f32_dpp v21, v21, v21 row_ror:4 row_mask:0xf bank_mask:0xf
    s_nop 1
    v_add_f32_dpp v21, v21, v21 row_ror:8 row_mask:0xf bank_mask:0xf
    s_mov_b64 exec, 3
    buffer_store_dwordx4 v[20:23], v2, s[36:39], s60 offen sc1
    s_mov_b64 exec, -1
.mlc_26:
    s_memrealtime s[8:9]
    s_waitcnt lgkmcnt(0)
    s_sub_u32 s8, s8, s30
    s_cmpk_ge_u32 s8, 1726
    s_cbranch_scc1 .ap_27
    s_waitcnt vmcnt(5)
    s_cmpk_ge_u32 s8, 1626
    s_cbranch_scc1 .ap_27
    s_waitcnt vmcnt(3)
    s_bitcmp1_b64 s[14:15], 44
    s_cbranch_scc0 1
    s_waitcnt vmcnt(2)
    s_cmpk_ge_u32 s8, 1506
    s_cbranch_scc1 .ap_27
    s_waitcnt vmcnt(1)
.ap_27:
    s_add_u32 s63, s69, 163840
    buffer_load_dwordx4 v[208:211], v1, s[44:47], s63 offen nt
    s_memrealtime s[8:9]
    s_waitcnt vmcnt(8)
    s_waitcnt lgkmcnt(0)
    s_sub_u32 s8, s8, s30
    s_cmpk_ge_u32 s8, 1756
    s_cbranch_scc1 .ap_28
    s_waitcnt vmcnt(5)
    s_cmpk_ge_u32 s8, 1656
    s_cbranch_scc1 .ap_28
    s_waitcnt vmcnt(3)
    s_bitcmp1_b64 s[14:15], 45
    s_cbranch_scc0 1
    s_waitcnt vmcnt(2)
    s_cmpk_ge_u32 s8, 1536
    s_cbranch_scc1 .ap_28
    s_waitcnt vmcnt(1)
.ap_28:
    s_add_u32 s63, s69, 172032
    buffer_load_dwordx4 v[212:215], v1, s[44:47], s63 offen nt
    s_memrealtime s[8:9]
    s_waitcnt vmcnt(8)
    s_waitcnt lgkmcnt(0)
    s_sub_u32 s8, s8, s30
    s_cmpk_ge_u32 s8, 1788
    s_cbranch_scc1 .ap_29
    s_waitcnt vmcnt(5)
    s_cmpk_ge_u32 s8, 1688
    s_cbranch_scc1 .ap_29
    s_waitcnt vmcnt(3)
    s_bitcmp1_b64 s[14:15], 46
    s_cbranch_scc0 1
    s_waitcnt vmcnt(2)
    s_cmpk_ge_u32 s8, 1568
    s_cbranch_scc1 .ap_29
    s_waitcnt vmcnt(1)
.ap_29:
    s_add_u32 s63, s69, 180224
    buffer_load_dwordx4 v[216:219], v1, s[44:47], s63 offen nt
    s_branch .Lsk_n1_3
.Lst_n1_3:
    s_branch .Lrt_n1_3
.Lsk_n1_3:
    s_memrealtime s[8:9]
    s_waitcnt vmcnt(8)
    s_waitcnt lgkmcnt(0)
    s_sub_u32 s8, s8, s30
    s_cmpk_ge_u32 s8, 1820
    s_cbranch_scc1 .ap_30
    s_waitcnt vmcnt(5)
    s_cmpk_ge_u32 s8, 1720
    s_cbranch_scc1 .ap_30
    s_waitcnt vmcnt(3)
    s_bitcmp1_b64 s[14:15], 47
    s_cbranch_scc0 1
    s_waitcnt vmcnt(2)
    s_cmpk_ge_u32 s8, 1600
    s_cbranch_scc1 .ap_30
    s_waitcnt vmcnt(1)
.ap_30:
    s_add_u32 s63, s69, 188416
    buffer_load_dwordx4 v[220:223], v1, s[44:47], s63 offen nt
    s_memrealtime s[8:9]
    s_waitcnt vmcnt(8)
    s_waitcnt lgkmcnt(0)
    s_sub_u32 s8, s8, s30
    s_cmpk_ge_u32 s8, 1852
    s_cbranch_scc1 .ap_31
    s_waitcnt vmcnt(5)
    s_cmpk_ge_u32 s8, 1752
    s_cbranch_scc1 .ap_31
    s_waitcnt vmcnt(3)
    s_bitcmp1_b64 s[14:15], 48
    s_cbranch_scc0 1
    s_waitcnt vmcnt(2)
    s_cmpk_ge_u32 s8, 1632
    s_cbranch_scc1 .ap_31
    s_waitcnt vmcnt(1)
.ap_31:
    s_add_u32 s63, s69, 262144
    buffer_load_dwordx4 v[224:227], v1, s[44:47], s63 offen nt
    s_memrealtime s[8:9]
    s_waitcnt vmcnt(8)
    s_waitcnt lgkmcnt(0)
    s_sub_u32 s8, s8, s30
    s_cmpk_ge_u32 s8, 1884
    s_cbranch_scc1 .ap_32
    s_waitcnt vmcnt(5)
    s_cmpk_ge_u32 s8, 1784
    s_cbranch_scc1 .ap_32
    s_waitcnt vmcnt(3)
    s_bitcmp1_b64 s[14:15], 49
    s_cbranch_scc0 1
    s_waitcnt vmcnt(2)
    s_cmpk_ge_u32 s8, 1664
    s_cbranch_scc1 .ap_32
    s_waitcnt vmcnt(1)
.ap_32:
    s_add_u32 s63, s69, 270336
    buffer_load_dwordx4 v[228:231], v1, s[44:47], s63 offen nt
    s_memrealtime s[8:9]
    s_waitcnt vmcnt(8)
    s_waitcnt lgkmcnt(0)
    s_sub_u32 s8, s8, s30
    s_cmpk_ge_u32 s8, 1916
    s_cbranch_scc1 .ap_33
    s_waitcnt vmcnt(5)
    s_cmpk_ge_u32 s8, 1816
    s_cbranch_scc1 .ap_33
    s_waitcnt vmcnt(3)
    s_bitcmp1_b64 s[14:15], 50
    s_cbranch_scc0 1
    s_waitcnt vmcnt(2)
    s_cmpk_ge_u32 s8, 1696
    s_cbranch_scc1 .ap_33
    s_waitcnt vmcnt(1)
.ap_33:
    s_add_u32 s63, s69, 278528
    buffer_load_dwordx4 v[232:235], v1, s[44:47], s63 offen nt
    s_memrealtime s[8:9]
    s_waitcnt vmcnt(8)
    s_waitcnt lgkmcnt(0)
    s_sub_u32 s8, s8, s30
    s_cmpk_ge_u32 s8, 1948
    s_cbranch_scc1 .ap_34
    s_waitcnt vmcnt(5)
    s_cmpk_ge_u32 s8, 1848
    s_cbranch_scc1 .ap_34
    s_waitcnt vmcnt(3)
    s_bitcmp1_b64 s[14:15], 51
    s_cbranch_scc0 1
    s_waitcnt vmcnt(2)
    s_cmpk_ge_u32 s8, 1728
    s_cbranch_scc1 .ap_34
    s_waitcnt vmcnt(1)
.ap_34:
    s_add_u32 s63, s69, 286720
    buffer_load_dwordx4 v[236:239], v1, s[44:47], s63 offen nt
    s_memrealtime s[8:9]
    s_waitcnt vmcnt(8)
    s_waitcnt lgkmcnt(0)
    s_sub_u32 s8, s8, s30
    s_cmpk_ge_u32 s8, 1980
    s_cbranch_scc1 .ap_35
    s_waitcnt vmcnt(5)
    s_cmpk_ge_u32 s8, 1880
    s_cbranch_scc1 .ap_35
    s_waitcnt vmcnt(3)
    s_bitcmp1_b64 s[14:15], 52
    s_cbranch_scc0 1
    s_waitcnt vmcnt(2)
    s_cmpk_ge_u32 s8, 1760
    s_cbranch_scc1 .ap_35
    s_waitcnt vmcnt(1)
.ap_35:
    s_add_u32 s63, s69, 294912
    buffer_load_dwordx4 v[240:243], v1, s[44:47], s63 offen nt
    s_memrealtime s[8:9]
    s_waitcnt vmcnt(8)
    s_waitcnt lgkmcnt(0)
    s_sub_u32 s8, s8, s30
    s_cmpk_ge_u32 s8, 2012
    s_cbranch_scc1 .ap_36
    s_waitcnt vmcnt(5)
    s_cmpk_ge_u32 s8, 1912
    s_cbranch_scc1 .ap_36
    s_waitcnt vmcnt(3)
    s_bitcmp1_b64 s[14:15], 53
    s_cbranch_scc0 1
    s_waitcnt vmcnt(2)
    s_cmpk_ge_u32 s8, 1792
    s_cbranch_scc1 .ap_36
    s_waitcnt vmcnt(1)
.ap_36:
    s_add_u32 s63, s69, 303104
    buffer_load_dwordx4 v[244:247], v1, s[44:47], s63 offen nt
    s_and_b32 s0, s0, 0xffffff80
    s_sub_u32 s0, s0, 1024
    buffer_load_dword v28, v4, s[36:39], s0 offen sc1
    buffer_load_dwordx4 v[24:27], v9, s[36:39], s59 offen offset:0 sc1
    s_memrealtime s[8:9]
    s_waitcnt vmcnt(9)
    s_waitcnt lgkmcnt(0)
    s_sub_u32 s8, s8, s30
    s_cmpk_ge_u32 s8, 2044
    s_cbranch_scc1 .ap_37
    s_waitcnt vmcnt(6)
    s_cmpk_ge_u32 s8, 1944
    s_cbranch_scc1 .ap_37
    s_waitcnt vmcnt(4)
    s_bitcmp1_b64 s[14:15], 54
    s_cbranch_scc0 1
    s_waitcnt vmcnt(3)
    s_cmpk_ge_u32 s8, 1824
    s_cbranch_scc1 .ap_37
    s_waitcnt vmcnt(2)
.ap_37:
    s_add_u32 s63, s69, 311296
    buffer_load_dwordx4 v[248:251], v1, s[44:47], s63 offen nt
    s_memrealtime s[8:9]
    s_waitcnt vmcnt(9)
    s_waitcnt lgkmcnt(0)
    s_sub_u32 s8, s8, s30
    s_cmpk_ge_u32 s8, 2076
    s_cbranch_scc1 .ap_38
    s_waitcnt vmcnt(6)
    s_cmpk_ge_u32 s8, 1976
    s_cbranch_scc1 .ap_38
    s_waitcnt vmcnt(4)
    s_bitcmp1_b64 s[14:15], 55
    s_cbranch_scc0 1
    s_waitcnt vmcnt(3)
    s_cmpk_ge_u32 s8, 1856
    s_cbranch_scc1 .ap_38
    s_waitcnt vmcnt(1)
.ap_38:
    s_add_u32 s63, s69, 319488
    buffer_load_dwordx4 v[252:255], v1, s[44:47], s63 offen nt
    s_memrealtime s[8:9]
    s_waitcnt vmcnt(9)
    s_waitcnt lgkmcnt(0)
    s_sub_u32 s8, s8, s30
    s_cmpk_ge_u32 s8, 2108
    s_cbranch_scc1 .ap_39
    s_waitcnt vmcnt(6)
    s_cmpk_ge_u32 s8, 2008
    s_cbranch_scc1 .ap_39
    s_waitcnt vmcnt(4)
    s_bitcmp1_b64 s[14:15], 56
    s_cbranch_scc0 1
    s_waitcnt vmcnt(2)
    s_cmpk_ge_u32 s8, 1888
    s_cbranch_scc1 .ap_39
    s_waitcnt vmcnt(1)
.ap_39:
    s_add_u32 s63, s69, 393216
    buffer_load_dwordx4 v[36:39], v1, s[44:47], s63 offen nt
    s_memrealtime s[8:9]
    s_waitcnt vmcnt(9)
    s_waitcnt lgkmcnt(0)
    s_sub_u32 s8, s8, s30
    s_cmpk_ge_u32 s8, 2140
    s_cbranch_scc1 .ap_40
    s_waitcnt vmcnt(6)
    s_cmpk_ge_u32 s8, 2040
    s_cbranch_scc1 .ap_40
    s_waitcnt vmcnt(3)
    s_bitcmp1_b64 s[14:15], 57
    s_cbranch_scc0 1
    s_waitcnt vmcnt(2)
    s_cmpk_ge_u32 s8, 1920
    s_cbranch_scc1 .ap_40
    s_waitcnt vmcnt(1)
.ap_40:
    s_add_u32 s63, s69, 401408
    buffer_load_dwordx4 v[44:47], v1, s[44:47], s63 offen nt
    s_memrealtime s[8:9]
    s_waitcnt vmcnt(9)
    s_waitcnt lgkmcnt(0)
    s_sub_u32 s8, s8, s30
    s_cmpk_ge_u32 s8, 2172
    s_cbranch_scc1 .ap_41
    s_waitcnt vmcnt(6)
    s_cmpk_ge_u32 s8, 2072
    s_cbranch_scc1 .ap_41
    s_waitcnt vmcnt(3)
    s_bitcmp1_b64 s[14:15], 58
    s_cbranch_scc0 1
    s_waitcnt vmcnt(2)
    s_cmpk_ge_u32 s8, 1952
    s_cbranch_scc1 .ap_41
    s_waitcnt vmcnt(1)
.ap_41:
    s_add_u32 s63, s69, 409600
    buffer_load_dwordx4 v[52:55], v1, s[44:47], s63 offen nt
    s_waitcnt vmcnt(5)
    s_branch .gpc_43
.gp_42:
    buffer_load_dwordx4 v[24:27], v9, s[36:39], s59 offen offset:0 sc1
    s_waitcnt vmcnt(0)
.gpc_43:
    v_cmp_eq_u32 vcc, s34, v26
    s_cmp_eq_u64 vcc, -1
    s_nop 3
    s_cbranch_scc1 .gpd_44
    s_sub_u32 s35, s35, 1
    s_branch .Lsk_n1_4
.Lst_n1_4:
    s_branch .Lrt_n1_4
.Lsk_n1_4:
    s_cbranch_scc1 .Lexit
    s_sleep 1
    s_branch .gp_42
.gpd_44:
    v_cmp_eq_u32 vcc, s1, v28
    s_cmp_eq_u64 vcc, -1
    s_cselect_b32 s0, 0x800000, 0
    v_mov_b32 v16, v24
    s_nop 1
    v_max_f32_dpp v16, v16, v16 row_ror:4 row_mask:0xf bank_mask:0xf
    v_sub_f32 v17, v24, v16
    v_sub_f32 v18, v14, v16
    v_mul_f32 v17, 0x3fb8aa3b, v17
    v_mul_f32 v18, 0x3fb8aa3b, v18
    v_exp_f32 v17, v17
    v_exp_f32 v18, v18
    v_mul_f32 v17, v17, v25
    s_nop 1
    v_add_f32_dpp v17, v17, v17 row_ror:4 row_mask:0xf bank_mask:0xf
    v_rcp_f32 v19, v17
    s_nop 0
    v_fma_f32 v15, -v17, v19, 1.0
    v_fma_f32 v19, v15, v19, v19
    v_mul_f32 v18, v18, v19
    v_mul_f32 v10, v10, v18
    v_mul_f32 v11, v11, v18
    v_mul_f32 v12, v12, v18
    v_mul_f32 v13, v13, v18
    v_mov_b32_dpp v112, v10 quad_perm:[2,3,0,1] row_mask:0xf bank_mask:0xf
    v_mov_b32_dpp v113, v11 quad_perm:[2,3,0,1] row_mask:0xf bank_mask:0xf
    v_mov_b32_dpp v114, v12 quad_perm:[2,3,0,1] row_mask:0xf bank_mask:0xf
    v_mov_b32_dpp v115, v13 quad_perm:[2,3,0,1] row_mask:0xf bank_mask:0xf
    v_cvt_pk_bf16_f32 v96, v10, v112
    v_cvt_pk_bf16_f32 v100, v11, v113
    v_cvt_pk_bf16_f32 v104, v12, v114
    v_cvt_pk_bf16_f32 v108, v13, v115
    v_mov_b32_dpp v97, v96 row_ror:12 row_mask:0xf bank_mask:0xf
    v_mov_b32_dpp v101, v100 row_ror:12 row_mask:0xf bank_mask:0xf
    v_mov_b32_dpp v105, v104 row_ror:12 row_mask:0xf bank_mask:0xf
    v_mov_b32_dpp v109, v108 row_ror:12 row_mask:0xf bank_mask:0xf
    v_mov_b32_dpp v98, v96 row_ror:8 row_mask:0xf bank_mask:0xf
    v_mov_b32_dpp v102, v100 row_ror:8 row_mask:0xf bank_mask:0xf
    v_mov_b32_dpp v106, v104 row_ror:8 row_mask:0xf bank_mask:0xf
    v_mov_b32_dpp v110, v108 row_ror:8 row_mask:0xf bank_mask:0xf
    v_mov_b32_dpp v99, v96 row_ror:4 row_mask:0xf bank_mask:0xf
    v_mov_b32_dpp v103, v100 row_ror:4 row_mask:0xf bank_mask:0xf
    v_mov_b32_dpp v107, v104 row_ror:4 row_mask:0xf bank_mask:0xf
    v_mov_b32_dpp v111, v108 row_ror:4 row_mask:0xf bank_mask:0xf
    s_lshl_b32 s60, s3, 10
    s_add_u32 s60, s60, 147456
    v_lshlrev_b32 v10, 5, v0
    v_add_u32 v10, s60, v10
    s_memrealtime s[8:9]
    s_waitcnt lgkmcnt(0)
    s_sub_u32 s8, s8, s30
    s_cmpk_ge_u32 s8, 2204
    s_cbranch_scc1 .ap_45
    s_waitcnt vmcnt(5)
    s_cmpk_ge_u32 s8, 2104
    s_cbranch_scc1 .ap_45
    s_waitcnt vmcnt(3)
    s_bitcmp1_b64 s[14:15], 59
    s_cbranch_scc0 1
    s_waitcnt vmcnt(2)
    s_cmpk_ge_u32 s8, 1984
    s_cbranch_scc1 .ap_45
    s_waitcnt vmcnt(1)
.ap_45:
    s_add_u32 s63, s69, 417792
    buffer_load_dwordx4 v[60:63], v1, s[44:47], s63 offen nt
    v_perm_b32 v112, v164, v160, s94
    v_perm_b32 v113, v172, v168, s94
    v_perm_b32 v114, v180, v176, s94
    v_perm_b32 v115, v188, v184, s94
    s_nop 1
    v_mfma_f32_16x16x32_bf16 v[128:131], v[96:99], v[112:115], 0
    v_perm_b32 v116, v164, v160, s95
    v_perm_b32 v117, v172, v168, s95
    v_perm_b32 v118, v180, v176, s95
    v_perm_b32 v119, v188, v184, s95
    s_nop 1
    v_mfma_f32_16x16x32_bf16 v[132:135], v[96:99], v[116:119], 0
    v_perm_b32 v120, v165, v161, s94
    v_perm_b32 v121, v173, v169, s94
    v_perm_b32 v122, v181, v177, s94
    v_perm_b32 v123, v189, v185, s94
    s_nop 1
    v_mfma_f32_16x16x32_bf16 v[136:139], v[96:99], v[120:123], 0
    v_perm_b32 v124, v165, v161, s95
    v_perm_b32 v125, v173, v169, s95
    v_perm_b32 v126, v181, v177, s95
    v_perm_b32 v127, v189, v185, s95
    s_nop 1
    v_mfma_f32_16x16x32_bf16 v[140:143], v[96:99], v[124:127], 0
    v_perm_b32 v112, v166, v162, s94
    v_perm_b32 v113, v174, v170, s94
    v_perm_b32 v114, v182, v178, s94
    v_perm_b32 v115, v190, v186, s94
    s_nop 1
    v_mfma_f32_16x16x32_bf16 v[144:147], v[96:99], v[112:115], 0
    v_perm_b32 v116, v166, v162, s95
    v_perm_b32 v117, v174, v170, s95
    v_perm_b32 v118, v182, v178, s95
    v_perm_b32 v119, v190, v186, s95
    s_nop 1
    v_mfma_f32_16x16x32_bf16 v[148:151], v[96:99], v[116:119], 0
    v_perm_b32 v120, v167, v163, s94
    v_perm_b32 v121, v175, v171, s94
    v_perm_b32 v122, v183, v179, s94
    v_perm_b32 v123, v191, v187, s94
    s_nop 1
    v_mfma_f32_16x16x32_bf16 v[152:155], v[96:99], v[120:123], 0
    v_perm_b32 v124, v167, v163, s95
    v_perm_b32 v125, v175, v171, s95
    v_perm_b32 v126, v183, v179, s95
    v_perm_b32 v127, v191, v187, s95
    s_nop 1
    v_mfma_f32_16x16x32_bf16 v[156:159], v[96:99], v[124:127], 0
    s_memrealtime s[8:9]
    s_waitcnt lgkmcnt(0)
    s_sub_u32 s8, s8, s30
    s_cmpk_ge_u32 s8, 2236
    s_nop 3
    s_cbranch_scc1 .ap_46
    s_waitcnt vmcnt(5)
    s_cmpk_ge_u32 s8, 2136
    s_cbranch_scc1 .ap_46
    s_waitcnt vmcnt(3)
    s_bitcmp1_b64 s[14:15], 60
    s_cbranch_scc0 1
    s_waitcnt vmcnt(2)
    s_cmpk_ge_u32 s8, 2016
    s_cbranch_scc1 .ap_46
    s_waitcnt vmcnt(1)
.ap_46:
    s_add_u32 s63, s69, 425984
    buffer_load_dwordx4 v[68:71], v1, s[44:47], s63 offen nt
    v_perm_b32 v112, v196, v192, s94
    v_perm_b32 v113, v204, v200, s94
    v_perm_b32 v114, v212, v208, s94
    v_perm_b32 v115, v220, v216, s94
    s_nop 1
    v_mfma_f32_16x16x32_bf16 v[128:131], v[100:103], v[112:115], v[128:131]
    v_perm_b32 v116, v196, v192, s95
    v_perm_b32 v117, v204, v200, s95
    v_perm_b32 v118, v212, v208, s95
    v_perm_b32 v119, v220, v216, s95
    s_nop 1
    v_mfma_f32_16x16x32_bf16 v[132:135], v[100:103], v[116:119], v[132:135]
    v_perm_b32 v120, v197, v193, s94
    v_perm_b32 v121, v205, v201, s94
    v_perm_b32 v122, v213, v209, s94
    v_perm_b32 v123, v221, v217, s94
    s_nop 1
    v_mfma_f32_16x16x32_bf16 v[136:139], v[100:103], v[120:123], v[136:139]
    v_perm_b32 v124, v197, v193, s95
    v_perm_b32 v125, v205, v201, s95
    v_perm_b32 v126, v213, v209, s95
    v_perm_b32 v127, v221, v217, s95
    s_nop 1
    v_mfma_f32_16x16x32_bf16 v[140:143], v[100:103], v[124:127], v[140:143]
    v_perm_b32 v112, v198, v194, s94
    v_perm_b32 v113, v206, v202, s94
    v_perm_b32 v114, v214, v210, s94
    v_perm_b32 v115, v222, v218, s94
    s_nop 1
    v_mfma_f32_16x16x32_bf16 v[144:147], v[100:103], v[112:115], v[144:147]
    v_perm_b32 v116, v198, v194, s95
    v_perm_b32 v117, v206, v202, s95
    v_perm_b32 v118, v214, v210, s95
    v_perm_b32 v119, v222, v218, s95
    s_branch .Lsk_n1_5
.Lst_n1_5:
    s_branch .Lrt_n1_5
.Lsk_n1_5:
    s_nop 1
    v_mfma_f32_16x16x32_bf16 v[148:151], v[100:103], v[116:119], v[148:151]
    v_perm_b32 v120, v199, v195, s94
    v_perm_b32 v121, v207, v203, s94
    v_perm_b32 v122, v215, v211, s94
    v_perm_b32 v123, v223, v219, s94
    s_nop 1
    v_mfma_f32_16x16x32_bf16 v[152:155], v[100:103], v[120:123], v[152:155]
    v_perm_b32 v124, v199, v195, s95
    v_perm_b32 v125, v207, v203, s95
    v_perm_b32 v126, v215, v211, s95
    v_perm_b32 v127, v223, v219, s95
    s_nop 1
    v_mfma_f32_16x16x32_bf16 v[156:159], v[100:103], v[124:127], v[156:159]
    s_memrealtime s[8:9]
    s_waitcnt lgkmcnt(0)
    s_sub_u32 s8, s8, s30
    s_cmpk_ge_u32 s8, 2268
    s_nop 3
    s_cbranch_scc1 .ap_47
    s_waitcnt vmcnt(5)
    s_cmpk_ge_u32 s8, 2168
    s_cbranch_scc1 .ap_47
    s_waitcnt vmcnt(3)
    s_bitcmp1_b64 s[14:15], 61
    s_cbranch_scc0 1
    s_waitcnt vmcnt(2)
    s_cmpk_ge_u32 s8, 2048
    s_cbranch_scc1 .ap_47
    s_waitcnt vmcnt(1)
.ap_47:
    s_add_u32 s63, s69, 434176
    buffer_load_dwordx4 v[76:79], v1, s[44:47], s63 offen nt
    s_waitcnt vmcnt(6)
    v_perm_b32 v112, v228, v224, s94
    v_perm_b32 v113, v236, v232, s94
    v_perm_b32 v114, v244, v240, s94
    v_perm_b32 v115, v252, v248, s94
    s_nop 1
    v_mfma_f32_16x16x32_bf16 v[128:131], v[104:107], v[112:115], v[128:131]
    v_perm_b32 v116, v228, v224, s95
    v_perm_b32 v117, v236, v232, s95
    v_perm_b32 v118, v244, v240, s95
    v_perm_b32 v119, v252, v248, s95
    s_nop 1
    v_mfma_f32_16x16x32_bf16 v[132:135], v[104:107], v[116:119], v[132:135]
    v_perm_b32 v120, v229, v225, s94
    v_perm_b32 v121, v237, v233, s94
    v_perm_b32 v122, v245, v241, s94
    v_perm_b32 v123, v253, v249, s94
    s_nop 1
    v_mfma_f32_16x16x32_bf16 v[136:139], v[104:107], v[120:123], v[136:139]
    v_perm_b32 v124, v229, v225, s95
    v_perm_b32 v125, v237, v233, s95
    v_perm_b32 v126, v245, v241, s95
    v_perm_b32 v127, v253, v249, s95
    s_nop 1
    v_mfma_f32_16x16x32_bf16 v[140:143], v[104:107], v[124:127], v[140:143]
    v_perm_b32 v112, v230, v226, s94
    v_perm_b32 v113, v238, v234, s94
    v_perm_b32 v114, v246, v242, s94
    v_perm_b32 v115, v254, v250, s94
    s_nop 1
    v_mfma_f32_16x16x32_bf16 v[144:147], v[104:107], v[112:115], v[144:147]
    v_perm_b32 v116, v230, v226, s95
    v_perm_b32 v117, v238, v234, s95
    v_perm_b32 v118, v246, v242, s95
    v_perm_b32 v119, v254, v250, s95
    s_nop 1
    v_mfma_f32_16x16x32_bf16 v[148:151], v[104:107], v[116:119], v[148:151]
    v_perm_b32 v120, v231, v227, s94
    v_perm_b32 v121, v239, v235, s94
    v_perm_b32 v122, v247, v243, s94
    v_perm_b32 v123, v255, v251, s94
    s_nop 1
    v_mfma_f32_16x16x32_bf16 v[152:155], v[104:107], v[120:123], v[152:155]
    v_perm_b32 v124, v231, v227, s95
    v_perm_b32 v125, v239, v235, s95
    v_perm_b32 v126, v247, v243, s95
    v_perm_b32 v127, v255, v251, s95
    s_nop 1
    v_mfma_f32_16x16x32_bf16 v[156:159], v[104:107], v[124:127], v[156:159]
    s_memrealtime s[8:9]
    s_waitcnt lgkmcnt(0)
    s_sub_u32 s8, s8, s30
    s_cmpk_ge_u32 s8, 2300
    s_nop 3
    s_cbranch_scc1 .ap_48
    s_waitcnt vmcnt(5)
    s_cmpk_ge_u32 s8, 2200
    s_cbranch_scc1 .ap_48
    s_waitcnt vmcnt(3)
    s_bitcmp1_b64 s[14:15], 62
    s_cbranch_scc0 1
    s_waitcnt vmcnt(2)
    s_cmpk_ge_u32 s8, 2080
    s_cbranch_scc1 .ap_48
    s_waitcnt vmcnt(1)
.ap_48:
    s_add_u32 s63, s69, 442368
    buffer_load_dwordx4 v[84:87], v1, s[44:47], s63 offen nt
    s_memrealtime s[8:9]
    s_waitcnt lgkmcnt(0)
    s_sub_u32 s8, s8, s30
    s_cmpk_ge_u32 s8, 2332
    s_cbranch_scc1 .ap_49
    s_waitcnt vmcnt(5)
    s_cmpk_ge_u32 s8, 2232
    s_cbranch_scc1 .ap_49
    s_waitcnt vmcnt(3)
    s_bitcmp1_b64 s[14:15], 63
    s_cbranch_scc0 1
    s_waitcnt vmcnt(2)
    s_cmpk_ge_u32 s8, 2112
    s_cbranch_scc1 .ap_49
    s_waitcnt vmcnt(1)
.ap_49:
    s_add_u32 s63, s69, 450560
    buffer_load_dwordx4 v[92:95], v1, s[44:47], s63 offen nt
    s_setprio 0
    s_waitcnt vmcnt(6)
    v_perm_b32 v160, v44, v36, s94
    v_perm_b32 v164, v44, v36, s95
    v_perm_b32 v168, v45, v37, s94
    v_perm_b32 v172, v45, v37, s95
    v_perm_b32 v176, v46, v38, s94
    v_perm_b32 v180, v46, v38, s95
    v_perm_b32 v184, v47, v39, s94
    v_perm_b32 v188, v47, v39, s95
    s_waitcnt vmcnt(4)
    v_perm_b32 v161, v60, v52, s94
    v_perm_b32 v165, v60, v52, s95
    v_perm_b32 v169, v61, v53, s94
    v_perm_b32 v173, v61, v53, s95
    v_perm_b32 v177, v62, v54, s94
    v_perm_b32 v181, v62, v54, s95
    v_perm_b32 v185, v63, v55, s94
    v_perm_b32 v189, v63, v55, s95
    s_branch .Lsk_n1_6
.Lst_n1_6:
    s_branch .Lrt_n1_6
.Lsk_n1_6:
    s_waitcnt vmcnt(2)
    v_perm_b32 v162, v76, v68, s94
    v_perm_b32 v166, v76, v68, s95
    v_perm_b32 v170, v77, v69, s94
    v_perm_b32 v174, v77, v69, s95
    v_perm_b32 v178, v78, v70, s94
    v_perm_b32 v182, v78, v70, s95
    v_perm_b32 v186, v79, v71, s94
    v_perm_b32 v190, v79, v71, s95
    s_waitcnt vmcnt(0)
    s_cmp_lt_u32 s65, 8
    s_cbranch_scc1 .wol_50
    s_lshl_b32 s56, s3, 10
    s_add_u32 m0, s56, 24576
    s_add_u32 s56, s101, 221184
    s_mov_b64 exec, s[18:19]
    buffer_load_dwordx4 v6, s[48:51], s56 offen nt lds
    s_mov_b64 exec, -1
    s_lshl_b32 s56, s3, 10
    s_add_u32 m0, s56, 57344
    s_add_u32 s56, s101, 221312
    s_mov_b64 exec, s[18:19]
    buffer_load_dwordx4 v6, s[48:51], s56 offen nt lds
    s_mov_b64 exec, -1
    s_lshl_b32 s56, s3, 10
    s_add_u32 m0, s56, 90112
    s_add_u32 s56, s101, 221440
    s_mov_b64 exec, s[18:19]
    buffer_load_dwordx4 v6, s[48:51], s56 offen nt lds
    s_mov_b64 exec, -1
.wol_50:
    v_perm_b32 v163, v92, v84, s94
    v_perm_b32 v167, v92, v84, s95
    v_perm_b32 v171, v93, v85, s94
    v_mfma_f32_16x16x32_bf16 v[128:131], v[108:111], v[160:163], v[128:131]
    v_perm_b32 v175, v93, v85, s95
    v_mfma_f32_16x16x32_bf16 v[132:135], v[108:111], v[164:167], v[132:135]
    v_perm_b32 v179, v94, v86, s94
    v_mfma_f32_16x16x32_bf16 v[136:139], v[108:111], v[168:171], v[136:139]
    v_perm_b32 v183, v94, v86, s95
    v_mfma_f32_16x16x32_bf16 v[140:143], v[108:111], v[172:175], v[140:143]
    v_perm_b32 v187, v95, v87, s94
    v_mfma_f32_16x16x32_bf16 v[144:147], v[108:111], v[176:179], v[144:147]
    v_perm_b32 v191, v95, v87, s95
    v_mfma_f32_16x16x32_bf16 v[148:151], v[108:111], v[180:183], v[148:151]
    v_mfma_f32_16x16x32_bf16 v[152:155], v[108:111], v[184:187], v[152:155]
    v_mfma_f32_16x16x32_bf16 v[156:159], v[108:111], v[188:191], v[156:159]
    s_mov_b64 exec, 0xffff
    ds_write2_b32 v10, v128, v129 offset0:0 offset1:128
    ds_write2_b32 v10, v132, v133 offset0:1 offset1:129
    ds_write2_b32 v10, v136, v137 offset0:2 offset1:130
    ds_write2_b32 v10, v140, v141 offset0:3 offset1:131
    ds_write2_b32 v10, v144, v145 offset0:4 offset1:132
    ds_write2_b32 v10, v148, v149 offset0:5 offset1:133
    ds_write2_b32 v10, v152, v153 offset0:6 offset1:134
    ds_write2_b32 v10, v156, v157 offset0:7 offset1:135
    s_mov_b64 exec, -1
    s_waitcnt lgkmcnt(0)
    s_barrier
    s_cmp_lg_u32 s3, 7
    s_cbranch_scc1 .opub_51
    v_add_u32 v10, 147456, v2
    ds_read_b128 v[196:199], v10 offset:0
    ds_read_b128 v[200:203], v10 offset:1024
    ds_read_b128 v[204:207], v10 offset:2048
    ds_read_b128 v[208:211], v10 offset:3072
    ds_read_b128 v[212:215], v10 offset:4096
    ds_read_b128 v[216:219], v10 offset:5120
    ds_read_b128 v[220:223], v10 offset:6144
    ds_read_b128 v[224:227], v10 offset:7168
    v_lshrrev_b32 v11, 5, v0
    v_lshlrev_b32 v11, 13, v11
    v_and_b32 v12, 31, v0
    v_lshl_add_u32 v11, v12, 4, v11
    s_lshl4_add_u32 s56, s67, s66
    s_lshl1_add_u32 s56, s56, s68
    s_lshl_b32 s56, s56, 9
    s_add_u32 s56, s56, 0xa0000
    s_mov_b32 s60, 0x07060503
    s_mov_b32 s61, 0x07060502
    s_mov_b32 s62, 0x07060501
    v_mov_b32 v15, s34
    s_waitcnt lgkmcnt(6)
    v_pk_add_f32 v[196:197], v[196:197], v[200:201]
    v_pk_add_f32 v[198:199], v[198:199], v[202:203]
    s_waitcnt lgkmcnt(5)
    v_pk_add_f32 v[196:197], v[196:197], v[204:205]
    v_pk_add_f32 v[198:199], v[198:199], v[206:207]
    s_waitcnt lgkmcnt(4)
    v_pk_add_f32 v[196:197], v[196:197], v[208:209]
    v_pk_add_f32 v[198:199], v[198:199], v[210:211]
    s_waitcnt lgkmcnt(3)
    v_pk_add_f32 v[196:197], v[196:197], v[212:213]
    v_pk_add_f32 v[198:199], v[198:199], v[214:215]
    s_waitcnt lgkmcnt(2)
    v_pk_add_f32 v[196:197], v[196:197], v[216:217]
    v_pk_add_f32 v[198:199], v[198:199], v[218:219]
    s_waitcnt lgkmcnt(1)
    v_pk_add_f32 v[196:197], v[196:197], v[220:221]
    v_pk_add_f32 v[198:199], v[198:199], v[222:223]
    s_waitcnt lgkmcnt(0)
    v_pk_add_f32 v[196:197], v[196:197], v[224:225]
    v_pk_add_f32 v[198:199], v[198:199], v[226:227]
    v_perm_b32 v12, v196, v199, s60
    v_perm_b32 v13, v197, v199, s61
    v_perm_b32 v14, v198, v199, s62
    s_add_u32 s57, s56, 0x800000
    buffer_store_dwordx4 v[12:15], v11, s[36:39], s57 offen
    s_cmp_lg_u32 s0, 0
    s_nop 0
    s_cbranch_scc1 .nosl_52
    buffer_store_dwordx4 v[12:15], v11, s[36:39], s56 offen sc1
.nosl_52:
.opub_51:
    s_cmp_lt_u32 s65, 8
    s_nop 0
    s_cbranch_scc1 .Lexit
    v_and_b32 v6, 31, v0
    v_lshlrev_b32 v6, 3, v6
    v_lshrrev_b32 v7, 5, v0
    v_lshl_add_u32 v6, v7, 2, v6
    s_mul_i32 s56, s3, 528
    s_add_u32 s56, s56, 131072
    v_add_u32 v6, s56, v6
    s_lshl4_add_u32 s101, s99, s3
    s_lshl_b32 s101, s101, 10
    s_add_u32 s101, s101, 0xa0000
    v_add_u32 v5, 8192, v2
    s_cmp_ge_u32 s3, 6
    s_nop 0
    s_cbranch_scc1 .La_w67
    v_lshrrev_b32 v16, 4, v0
    v_bfe_u32 v17, v0, 2, 2
    v_lshl_add_u32 v7, v16, 3, v17
    v_lshlrev_b32 v7, 7, v7
    v_and_b32 v16, 1, v16
    v_lshrrev_b32 v17, 1, v17
    v_lshl_add_u32 v16, v16, 1, v17
    s_and_b32 s56, s3, 1
    s_lshl_b32 s56, s56, 1
    v_xor_b32 v16, s56, v16
    v_and_b32 v17, 3, v0
    v_lshl_add_u32 v7, v17, 3, v7
    s_lshr_b32 s56, s3, 1
    s_lshl_b32 s56, s56, 15
    v_add_u32 v7, s56, v7
    v_xor_b32 v17, 1, v16
    v_lshl_add_u32 v8, v17, 5, v7
    v_lshl_add_u32 v7, v16, 5, v7
    ds_read_b64_tr_b16 v[32:33], v7 offset:0
    ds_read_b64_tr_b16 v[34:35], v7 offset:512
    ds_read_b64_tr_b16 v[64:65], v8 offset:0
    ds_read_b64_tr_b16 v[66:67], v8 offset:512
    ds_read_b64_tr_b16 v[36:37], v7 offset:4096
    ds_read_b64_tr_b16 v[38:39], v7 offset:4608
    ds_read_b64_tr_b16 v[68:69], v8 offset:4096
    ds_read_b64_tr_b16 v[70:71], v8 offset:4608
    ds_read_b64_tr_b16 v[40:41], v7 offset:8192
    ds_read_b64_tr_b16 v[42:43], v7 offset:8704
    ds_read_b64_tr_b16 v[72:73], v8 offset:8192
    ds_read_b64_tr_b16 v[74:75], v8 offset:8704
    ds_read_b64_tr_b16 v[44:45], v7 offset:12288
    ds_read_b64_tr_b16 v[46:47], v7 offset:12800
    ds_read_b64_tr_b16 v[76:77], v8 offset:12288
    ds_read_b64_tr_b16 v[78:79], v8 offset:12800
    s_branch .Lsk_n1_7
.Lst_n1_7:
    s_branch .Lrt_n1_7
.Lsk_n1_7:
    ds_read_b64_tr_b16 v[48:49], v7 offset:16384
    ds_read_b64_tr_b16 v[50:51], v7 offset:16896
    ds_read_b64_tr_b16 v[80:81], v8 offset:16384
    ds_read_b64_tr_b16 v[82:83], v8 offset:16896
    ds_read_b64_tr_b16 v[52:53], v7 offset:20480
    ds_read_b64_tr_b16 v[54:55], v7 offset:20992
    ds_read_b64_tr_b16 v[84:85], v8 offset:20480
    ds_read_b64_tr_b16 v[86:87], v8 offset:20992
    s_mov_b32 s56, 131072
    v_bfe_u32 v9, v0, 1, 3
    v_mul_u32_u24 v9, 528, v9
    v_and_b32 v16, 48, v0
    v_add3_u32 v9, v9, v16, s56
    v_bfe_u32 v10, v0, 1, 3
    v_mul_u32_u24 v10, 36864, v10
    v_and_b32 v16, 1, v0
    v_lshl_add_u32 v10, v16, 4, v10
    v_and_b32 v16, 48, v0
    v_lshl_add_u32 v10, v16, 1, v10
    s_mul_i32 s59, s100, 3
    s_lshr_b32 s56, s3, 1
    s_add_u32 s59, s59, s56
    s_lshl4_add_u32 s59, s59, s99
    s_and_b32 s56, s3, 1
    s_lshl1_add_u32 s59, s59, s56
    s_lshl_b32 s59, s59, 7
    s_add_u32 s59, s59, 0xe0000
    v_mov_b32 v139, s34
    s_waitcnt vmcnt(0)
    s_barrier
    ds_read_b64_tr_b16 v[56:57], v7 offset:24576
    ds_read_b64_tr_b16 v[58:59], v7 offset:25088
    ds_read_b64_tr_b16 v[88:89], v8 offset:24576
    ds_read_b64_tr_b16 v[90:91], v8 offset:25088
    ds_read_b64_tr_b16 v[60:61], v7 offset:28672
    ds_read_b64_tr_b16 v[62:63], v7 offset:29184
    ds_read_b64_tr_b16 v[92:93], v8 offset:28672
    ds_read_b64_tr_b16 v[94:95], v8 offset:29184
    s_branch .La_poll
.La_w67:
    s_cmp_eq_u32 s3, 7
    s_cbranch_scc0 2
    s_waitcnt vmcnt(1)
    s_branch 1
    s_waitcnt vmcnt(0)
    s_barrier
.La_poll:
    s_mov_b32 s60, 0x04000c0c
    s_mov_b32 s61, 0x0706000c
    s_mov_b32 s69, 0
.gp_53:
    s_add_u32 s69, s69, 1
    s_and_b32 s56, s69, 0x41
    s_cmp_lg_u32 s56, 0x41
    s_cselect_b32 s56, 0, 0x800000
    s_xor_b32 s56, s56, s0
    s_add_u32 s58, s101, s56
    buffer_load_dwordx4 v[16:19], v2, s[36:39], s58 offen offset:0 sc1
    buffer_load_dwordx4 v[20:23], v5, s[36:39], s58 offen offset:0 sc1
    s_waitcnt vmcnt(0)
    v_cmp_eq_u32 vcc, s34, v19
    v_cmp_eq_u32 s[56:57], s34, v23
    s_and_b64 vcc, vcc, s[56:57]
    s_cmp_eq_u64 vcc, -1
    s_nop 2
    s_cbranch_scc1 .gpd_54
    s_sub_u32 s35, s35, 1
    s_cbranch_scc1 .Lexit
    s_branch .gp_53
.gpd_54:
    v_perm_b32 v19, v16, v17, s60
    v_perm_b32 v19, v19, v18, s61
    v_perm_b32 v23, v20, v21, s60
    v_perm_b32 v23, v23, v22, s61
    v_permlane32_swap_b32 v16, v18
    v_permlane32_swap_b32 v17, v19
    v_permlane32_swap_b32 v20, v22
    v_permlane32_swap_b32 v21, v23
    v_pk_add_f32 v[16:17], v[16:17], v[18:19]
    v_pk_add_f32 v[20:21], v[20:21], v[22:23]
    v_cvt_pk_bf16_f32 v16, v16, v17
    v_cvt_pk_bf16_f32 v20, v20, v21
    ds_write2_b32 v6, v16, v20 offset1:64
    s_mov_b32 s60, 0x07060503
    s_mov_b32 s61, 0x07060502
    s_mov_b32 s62, 0x07060501
    s_mov_b32 vcc_lo, 0xaaaaaaaa
    s_mov_b32 vcc_hi, 0xaaaaaaaa
    s_waitcnt lgkmcnt(0)
    s_barrier
    s_cmp_ge_u32 s3, 6
    s_cbranch_scc1 .Lexit
    ds_read_b128 v[96:99], v9 offset:0
    ds_read_b128 v[100:103], v9 offset:64
    ds_read_b128 v[104:107], v9 offset:128
    ds_read_b128 v[108:111], v9 offset:192
    ds_read_b128 v[112:115], v9 offset:256
    ds_read_b128 v[116:119], v9 offset:320
    ds_read_b128 v[120:123], v9 offset:384
    ds_read_b128 v[124:127], v9 offset:448
    s_waitcnt lgkmcnt(7)
    v_mfma_f32_16x16x32_bf16 v[128:131], v[32:35], v[96:99], 0
    v_mfma_f32_16x16x32_bf16 v[132:135], v[64:67], v[96:99], 0
    s_waitcnt lgkmcnt(6)
    v_mfma_f32_16x16x32_bf16 v[128:131], v[36:39], v[100:103], v[128:131]
    v_mfma_f32_16x16x32_bf16 v[132:135], v[68:71], v[100:103], v[132:135]
    s_waitcnt lgkmcnt(5)
    v_mfma_f32_16x16x32_bf16 v[128:131], v[40:43], v[104:107], v[128:131]
    v_mfma_f32_16x16x32_bf16 v[132:135], v[72:75], v[104:107], v[132:135]
    s_waitcnt lgkmcnt(4)
    v_mfma_f32_16x16x32_bf16 v[128:131], v[44:47], v[108:111], v[128:131]
    v_mfma_f32_16x16x32_bf16 v[132:135], v[76:79], v[108:111], v[132:135]
    s_waitcnt lgkmcnt(3)
    v_mfma_f32_16x16x32_bf16 v[128:131], v[48:51], v[112:115], v[128:131]
    v_mfma_f32_16x16x32_bf16 v[132:135], v[80:83], v[112:115], v[132:135]
    s_waitcnt lgkmcnt(2)
    v_mfma_f32_16x16x32_bf16 v[128:131], v[52:55], v[116:119], v[128:131]
    v_mfma_f32_16x16x32_bf16 v[132:135], v[84:87], v[116:119], v[132:135]
    s_waitcnt lgkmcnt(1)
    v_mfma_f32_16x16x32_bf16 v[128:131], v[56:59], v[120:123], v[128:131]
    v_mfma_f32_16x16x32_bf16 v[132:135], v[88:91], v[120:123], v[132:135]
    s_waitcnt lgkmcnt(0)
    v_mfma_f32_16x16x32_bf16 v[128:131], v[60:63], v[124:127], v[128:131]
    v_mfma_f32_16x16x32_bf16 v[132:135], v[92:95], v[124:127], v[132:135]
    s_nop 7
    v_cndmask_b32 v128, v128, v132, vcc
    v_cndmask_b32 v129, v129, v133, vcc
    v_cndmask_b32 v130, v130, v134, vcc
    v_cndmask_b32 v131, v131, v135, vcc
    v_perm_b32 v136, v128, v131, s60
    v_perm_b32 v137, v129, v131, s61
    v_perm_b32 v138, v130, v131, s62
    buffer_store_dwordx4 v[136:139], v10, s[36:39], s59 offen sc1
    s_nop 1
    s_branch .Lexit
.Lm:
    s_branch .Lsk_m0_0
.Lst_m0_0:
    s_branch .Lrt_m0_0
.Lsk_m0_0:
    s_cmp_lt_u32 s2, 54
    s_mov_b32 s14, 0xfdff7fdf
    s_cselect_b32 s14, 0x6b5ad6b5, s14
    s_mov_b32 s15, 0xff7fdff7
    s_cselect_b32 s15, 0x5ad6b5ad, s15
    s_add_u32 s30, s70, 0
    s_mov_b32 s31, s70
    v_bfe_u32 v16, v0, 1, 3
    v_mul_u32_u24 v16, 1312, v16
    v_lshrrev_b32 v12, 4, v0
    v_lshl_add_u32 v16, v12, 5, v16
    v_and_b32 v12, 1, v0
    v_lshl_add_u32 v16, v12, 4, v16
    v_add_u32 v16, 147456, v16
    s_mul_i32 s56, s3, 1312
    s_add_u32 s56, s56, 147456
    v_add_u32 v17, s56, v3
    v_add_u32 v18, s56, v4
    v_lshrrev_b32 v12, 4, v0
    v_bfe_u32 v13, v0, 1, 1
    v_lshl_add_u32 v12, v12, 1, v13
    v_bfe_u32 v13, v0, 2, 2
    v_lshl_add_u32 v20, v12, 3, v13
    v_lshlrev_b32 v20, 7, v20
    v_and_b32 v12, 3, v12
    v_lshrrev_b32 v13, 1, v13
    v_lshl_add_u32 v12, v12, 1, v13
    v_xor_b32 v12, s3, v12
    v_lshl_add_u32 v20, v12, 4, v20
    v_and_b32 v12, 1, v0
    v_lshl_add_u32 v20, v12, 3, v20
    v_bfe_u32 v23, v0, 1, 3
    v_mul_u32_u24 v23, 144, v23
    v_bfe_u32 v12, v0, 4, 1
    v_lshl_add_u32 v23, v12, 3, v23
    v_lshrrev_b32 v12, 5, v0
    v_lshl_add_u32 v23, v12, 2, v23
    v_and_b32 v12, 1, v0
    v_lshl_add_u32 v23, v12, 1, v23
    s_lshl_b32 s56, s3, 4
    s_add_u32 s56, s56, 157952
    v_add_u32 v23, s56, v23
    v_and_b32 v24, 15, v0
    v_lshlrev_b32 v24, 3, v24
    s_mul_i32 s56, s3, 144
    s_add_u32 s56, s56, 157952
    v_add_u32 v24, s56, v24
    v_add_u32 v21, 32768, v20
    s_lshl_b32 s100, s3, 10
    s_mov_b32 s99, s2
    s_cmp_ge_u32 s99, 18
    s_cbranch_scc1 .Lm_rel
    s_mul_i32 s58, s3, 1152
    s_mov_b32 s52, s24
    s_and_b32 s53, s25, 0xffff
    s_mov_b32 s54, 0x2400
    s_mov_b32 s55, 0x00020000
    buffer_load_dwordx2 v[246:247], v3, s[52:55], s58 offen
    buffer_load_dwordx2 v[248:249], v3, s[52:55], s58 offen offset:512
    buffer_load_dword v250, v4, s[52:55], s58 offen
    s_mov_b32 s48, s26
    s_and_b32 s49, s27, 0xffff
    s_mov_b32 s50, 0x3cc000
    s_mov_b32 s51, 0x00020000
    v_bfe_u32 v12, v0, 4, 1
    s_and_b32 s56, s3, 3
    s_lshl_b32 s56, s56, 1
    v_or_b32 v12, s56, v12
    v_and_b32 v19, 7, v0
    v_xor_b32 v12, v12, v19
    v_lshrrev_b32 v19, 3, v0
    v_mul_u32_u24 v19, 6912, v19
    v_lshl_add_u32 v19, v12, 4, v19
    s_mul_i32 s57, s3, 55296
    s_lshl_b32 s59, s99, 7
    s_add_u32 s57, s57, s59
    s_add_u32 m0, s100, 0
    s_add_u32 s56, s57, 0
    buffer_load_dwordx4 v19, s[48:51], s56 offen nt lds
    s_add_u32 m0, s100, 8192
    s_add_u32 s56, s57, 442368
    buffer_load_dwordx4 v19, s[48:51], s56 offen nt lds
    s_add_u32 m0, s100, 16384
    s_add_u32 s56, s57, 884736
    buffer_load_dwordx4 v19, s[48:51], s56 offen nt lds
    s_add_u32 m0, s100, 24576
    s_add_u32 s56, s57, 1327104
    buffer_load_dwordx4 v19, s[48:51], s56 offen nt lds
    s_add_u32 m0, s100, 32768
    s_add_u32 s56, s57, 1769472
    buffer_load_dwordx4 v19, s[48:51], s56 offen nt lds
    s_add_u32 m0, s100, 40960
    s_add_u32 s56, s57, 2211840
    buffer_load_dwordx4 v19, s[48:51], s56 offen nt lds
    s_add_u32 m0, s100, 49152
    s_add_u32 s56, s57, 2654208
    buffer_load_dwordx4 v19, s[48:51], s56 offen nt lds
    s_add_u32 m0, s100, 57344
    s_add_u32 s56, s57, 3096576
    buffer_load_dwordx4 v19, s[48:51], s56 offen nt lds
    s_add_u32 m0, s100, 65536
    s_add_u32 s56, s57, 3538944
    buffer_load_dwordx4 v19, s[48:51], s56 offen nt lds
    s_waitcnt lgkmcnt(0)
    s_add_u32 s34, s34, 1
    s_getreg_b32 s1, hwreg(HW_REG_XCC_ID)
    s_lshl_b32 s1, s1, 24
    s_add_u32 s1, s1, s34
    s_lshr_b32 s0, s2, 3
    s_lshl_b32 s63, s64, 8
    s_add_u32 s0, s0, s63
    s_lshl2_add_u32 s0, s0, 0x480000
    v_mov_b32 v30, s1
    s_cmp_eq_u32 s3, 0
    s_cselect_b64 exec, 1, 0
    buffer_store_dword v30, v2, s[36:39], s0 offen sc1
    s_mov_b64 exec, -1
    v_lshrrev_b32 v12, 4, v0
    v_mul_u32_u24 v12, 18432, v12
    v_and_b32 v13, 15, v0
    v_lshl_add_u32 v22, v13, 4, v12
    s_mul_i32 s57, s99, 57
    s_lshr_b32 s57, s57, 9
    s_mul_i32 s58, s57, 9
    s_sub_u32 s58, s99, s58
    s_mul_i32 s59, s57, 73728
    s_lshl_b32 s58, s58, 8
    s_add_u32 s59, s59, s58
    s_mul_i32 s58, s3, 2304
    s_add_u32 s59, s59, s58
    s_add_u32 s59, s59, 0x1000
    s_mov_b32 s58, 0
    s_cmp_eq_u32 s57, 1
    s_cselect_b32 s58, 1.0, s58
    s_cmp_eq_u32 s57, 4
    s_cselect_b32 s58, 1.0, s58
    s_waitcnt vmcnt(10)
    v_lshlrev_b32 v236, 16, v246
    v_and_b32 v237, 0xffff0000, v246
    v_max_f32 v236, 0xc2ae0000, v236
    v_min_f32 v242, 0x43000000, v236
    v_mul_f32 v238, 0xbfb8aa3b, v242
    v_fma_f32 v240, v242, s98, -v238
    v_fmac_f32 v240, 0xb2a57060, v242
    v_exp_f32 v238, v238
    v_mul_f32 v240, 0x3f317218, v240
    v_fmac_f32 v238, v238, v240
    v_add_f32 v238, 1.0, v238
    v_rcp_f32 v240, v238
    s_nop 0
    v_mul_f32 v242, v236, v240
    v_fma_f32 v238, -v242, v238, v236
    v_fma_f32 v236, v238, v240, v242
    v_max_f32 v237, 0xc2ae0000, v237
    v_min_f32 v243, 0x43000000, v237
    v_mul_f32 v239, 0xbfb8aa3b, v243
    v_fma_f32 v241, v243, s98, -v239
    v_fmac_f32 v241, 0xb2a57060, v243
    v_exp_f32 v239, v239
    v_mul_f32 v241, 0x3f317218, v241
    v_fmac_f32 v239, v239, v241
    v_add_f32 v239, 1.0, v239
    v_rcp_f32 v241, v239
    s_nop 0
    v_mul_f32 v243, v237, v241
    v_fma_f32 v239, -v243, v239, v237
    v_fma_f32 v237, v239, v241, v243
    v_cvt_pk_bf16_f32 v246, v236, v237
    v_lshlrev_b32 v236, 16, v247
    v_and_b32 v237, 0xffff0000, v247
    v_max_f32 v236, 0xc2ae0000, v236
    v_min_f32 v242, 0x43000000, v236
    v_mul_f32 v238, 0xbfb8aa3b, v242
    s_branch .Lsk_m0_1
.Lst_m0_1:
    s_branch .Lrt_m0_1
.Lsk_m0_1:
    v_fma_f32 v240, v242, s98, -v238
    v_fmac_f32 v240, 0xb2a57060, v242
    v_exp_f32 v238, v238
    v_mul_f32 v240, 0x3f317218, v240
    v_fmac_f32 v238, v238, v240
    v_add_f32 v238, 1.0, v238
    v_rcp_f32 v240, v238
    s_nop 0
    v_mul_f32 v242, v236, v240
    v_fma_f32 v238, -v242, v238, v236
    v_fma_f32 v236, v238, v240, v242
    v_max_f32 v237, 0xc2ae0000, v237
    v_min_f32 v243, 0x43000000, v237
    v_mul_f32 v239, 0xbfb8aa3b, v243
    v_fma_f32 v241, v243, s98, -v239
    v_fmac_f32 v241, 0xb2a57060, v243
    v_exp_f32 v239, v239
    v_mul_f32 v241, 0x3f317218, v241
    v_fmac_f32 v239, v239, v241
    v_add_f32 v239, 1.0, v239
    v_rcp_f32 v241, v239
    s_nop 0
    v_mul_f32 v243, v237, v241
    v_fma_f32 v239, -v243, v239, v237
    v_fma_f32 v237, v239, v241, v243
    v_cvt_pk_bf16_f32 v247, v236, v237
    v_lshlrev_b32 v236, 16, v248
    v_and_b32 v237, 0xffff0000, v248
    v_max_f32 v236, 0xc2ae0000, v236
    v_min_f32 v242, 0x43000000, v236
    v_mul_f32 v238, 0xbfb8aa3b, v242
    v_fma_f32 v240, v242, s98, -v238
    v_fmac_f32 v240, 0xb2a57060, v242
    v_exp_f32 v238, v238
    v_mul_f32 v240, 0x3f317218, v240
    v_fmac_f32 v238, v238, v240
    v_add_f32 v238, 1.0, v238
    v_rcp_f32 v240, v238
    s_nop 0
    v_mul_f32 v242, v236, v240
    v_fma_f32 v238, -v242, v238, v236
    v_fma_f32 v236, v238, v240, v242
    v_max_f32 v237, 0xc2ae0000, v237
    v_min_f32 v243, 0x43000000, v237
    v_mul_f32 v239, 0xbfb8aa3b, v243
    v_fma_f32 v241, v243, s98, -v239
    v_fmac_f32 v241, 0xb2a57060, v243
    v_exp_f32 v239, v239
    v_mul_f32 v241, 0x3f317218, v241
    v_fmac_f32 v239, v239, v241
    v_add_f32 v239, 1.0, v239
    v_rcp_f32 v241, v239
    s_nop 0
    v_mul_f32 v243, v237, v241
    v_fma_f32 v239, -v243, v239, v237
    v_fma_f32 v237, v239, v241, v243
    v_cvt_pk_bf16_f32 v248, v236, v237
    v_lshlrev_b32 v236, 16, v249
    v_and_b32 v237, 0xffff0000, v249
    v_max_f32 v236, 0xc2ae0000, v236
    v_min_f32 v242, 0x43000000, v236
    v_mul_f32 v238, 0xbfb8aa3b, v242
    v_fma_f32 v240, v242, s98, -v238
    v_fmac_f32 v240, 0xb2a57060, v242
    v_exp_f32 v238, v238
    v_mul_f32 v240, 0x3f317218, v240
    v_fmac_f32 v238, v238, v240
    v_add_f32 v238, 1.0, v238
    v_rcp_f32 v240, v238
    s_nop 0
    v_mul_f32 v242, v236, v240
    v_fma_f32 v238, -v242, v238, v236
    v_fma_f32 v236, v238, v240, v242
    v_max_f32 v237, 0xc2ae0000, v237
    v_min_f32 v243, 0x43000000, v237
    v_mul_f32 v239, 0xbfb8aa3b, v243
    v_fma_f32 v241, v243, s98, -v239
    v_fmac_f32 v241, 0xb2a57060, v243
    v_exp_f32 v239, v239
    v_mul_f32 v241, 0x3f317218, v241
    v_fmac_f32 v239, v239, v241
    v_add_f32 v239, 1.0, v239
    v_rcp_f32 v241, v239
    s_nop 0
    v_mul_f32 v243, v237, v241
    v_fma_f32 v239, -v243, v239, v237
    v_fma_f32 v237, v239, v241, v243
    v_cvt_pk_bf16_f32 v249, v236, v237
    v_lshlrev_b32 v236, 16, v250
    v_and_b32 v237, 0xffff0000, v250
    v_max_f32 v236, 0xc2ae0000, v236
    v_min_f32 v242, 0x43000000, v236
    v_mul_f32 v238, 0xbfb8aa3b, v242
    v_fma_f32 v240, v242, s98, -v238
    v_fmac_f32 v240, 0xb2a57060, v242
    v_exp_f32 v238, v238
    v_mul_f32 v240, 0x3f317218, v240
    v_fmac_f32 v238, v238, v240
    v_add_f32 v238, 1.0, v238
    v_rcp_f32 v240, v238
    s_nop 0
    v_mul_f32 v242, v236, v240
    v_fma_f32 v238, -v242, v238, v236
    v_fma_f32 v236, v238, v240, v242
    v_max_f32 v237, 0xc2ae0000, v237
    v_min_f32 v243, 0x43000000, v237
    v_mul_f32 v239, 0xbfb8aa3b, v243
    v_fma_f32 v241, v243, s98, -v239
    v_fmac_f32 v241, 0xb2a57060, v243
    v_exp_f32 v239, v239
    v_mul_f32 v241, 0x3f317218, v241
    v_fmac_f32 v239, v239, v241
    v_add_f32 v239, 1.0, v239
    v_rcp_f32 v241, v239
    s_nop 0
    v_mul_f32 v243, v237, v241
    v_fma_f32 v239, -v243, v239, v237
    v_fma_f32 v237, v239, v241, v243
    v_cvt_pk_bf16_f32 v250, v236, v237
    ds_write_b64 v17, v[246:247] offset:0
    ds_write_b64 v17, v[248:249] offset:512
    ds_write_b32 v18, v250 offset:0
    s_waitcnt vmcnt(1)
    s_waitcnt lgkmcnt(0)
    s_barrier
    ds_read_b64_tr_b16 v[160:161], v20 offset:0
    ds_read_b64_tr_b16 v[162:163], v20 offset:512
    ds_read_b64_tr_b16 v[164:165], v20 offset:8192
    ds_read_b64_tr_b16 v[166:167], v20 offset:8704
    ds_read_b64_tr_b16 v[168:169], v20 offset:16384
    ds_read_b64_tr_b16 v[170:171], v20 offset:16896
    ds_read_b64_tr_b16 v[172:173], v20 offset:24576
    ds_read_b64_tr_b16 v[174:175], v20 offset:25088
    ds_read_b64_tr_b16 v[176:177], v21 offset:0
    ds_read_b64_tr_b16 v[178:179], v21 offset:512
    ds_read_b64_tr_b16 v[180:181], v21 offset:8192
    ds_read_b64_tr_b16 v[182:183], v21 offset:8704
    ds_read_b64_tr_b16 v[184:185], v21 offset:16384
    ds_read_b64_tr_b16 v[186:187], v21 offset:16896
    ds_read_b64_tr_b16 v[188:189], v21 offset:24576
    ds_read_b64_tr_b16 v[190:191], v21 offset:25088
    ds_read_b64_tr_b16 v[192:193], v21 offset:32768
    ds_read_b64_tr_b16 v[194:195], v21 offset:33280
    ds_read_b128 v[196:199], v16 offset:0
    ds_read_b128 v[200:203], v16 offset:128
    ds_read_b128 v[204:207], v16 offset:256
    ds_read_b128 v[208:211], v16 offset:384
    ds_read_b128 v[212:215], v16 offset:512
    ds_read_b128 v[216:219], v16 offset:640
    ds_read_b128 v[220:223], v16 offset:768
    ds_read_b128 v[224:227], v16 offset:896
    ds_read_b128 v[228:231], v16 offset:1024
    s_waitcnt lgkmcnt(8)
    v_mfma_f32_16x16x32_bf16 v[232:235], v[160:163], v[196:199], 0
    s_waitcnt lgkmcnt(7)
    v_mfma_f32_16x16x32_bf16 v[232:235], v[164:167], v[200:203], v[232:235]
    s_waitcnt lgkmcnt(6)
    v_mfma_f32_16x16x32_bf16 v[232:235], v[168:171], v[204:207], v[232:235]
    s_waitcnt lgkmcnt(5)
    v_mfma_f32_16x16x32_bf16 v[232:235], v[172:175], v[208:211], v[232:235]
    s_waitcnt lgkmcnt(4)
    v_mfma_f32_16x16x32_bf16 v[232:235], v[176:179], v[212:215], v[232:235]
    s_waitcnt lgkmcnt(3)
    v_mfma_f32_16x16x32_bf16 v[232:235], v[180:183], v[216:219], v[232:235]
    s_waitcnt lgkmcnt(2)
    v_mfma_f32_16x16x32_bf16 v[232:235], v[184:187], v[220:223], v[232:235]
    s_branch .Lsk_m0_2
.Lst_m0_2:
    s_branch .Lrt_m0_2
.Lsk_m0_2:
    s_waitcnt lgkmcnt(1)
    v_mfma_f32_16x16x32_bf16 v[232:235], v[188:191], v[224:227], v[232:235]
    s_waitcnt lgkmcnt(0)
    v_mfma_f32_16x16x32_bf16 v[232:235], v[192:195], v[228:231], v[232:235]
    s_nop 7
    v_permlane32_swap_b32 v232, v234
    v_permlane32_swap_b32 v233, v235
    v_cndmask_b32 v233, v233, v234, s[96:97]
    v_cndmask_b32 v232, v232, v235, s[96:97]
    s_nop 1
    v_add_f32_dpp v236, v233, v232 quad_perm:[1,0,3,2] row_mask:0xf bank_mask:0xf
    v_cvt_pk_bf16_f32 v236, v236, v236
    v_lshlrev_b32 v236, 16, v236
    v_add_f32 v236, s58, v236
    v_cvt_pk_bf16_f32 v236, v236, v236
    ds_write_b16 v23, v236
    v_mov_b32 v243, s34
    s_waitcnt lgkmcnt(0)
    s_barrier
    ds_read2_b32 v[244:245], v24 offset1:1
    v_mov_b32 v241, s34
    s_waitcnt lgkmcnt(0)
    v_mov_b32 v240, v244
    v_mov_b32 v242, v245
    s_bfm_b64 exec, 32, 0
    buffer_store_dwordx4 v[240:243], v22, s[36:39], s59 offen sc1
    s_mov_b64 exec, -1
    s_add_u32 s63, s69, 32768
    buffer_load_dwordx4 v[96:99], v1, s[40:43], s63 offen nt
    s_add_u32 s63, s69, 40960
    buffer_load_dwordx4 v[100:103], v1, s[40:43], s63 offen nt
    s_add_u32 s63, s69, 49152
    buffer_load_dwordx4 v[128:131], v1, s[40:43], s63 offen nt
    s_add_u32 s63, s69, 57344
    buffer_load_dwordx4 v[132:135], v1, s[40:43], s63 offen nt
    s_waitcnt vmcnt(3)
    s_add_u32 s63, s69, 131072
    buffer_load_dwordx4 v[40:43], v1, s[40:43], s63 offen nt
    s_waitcnt vmcnt(3)
    s_add_u32 s63, s69, 139264
    buffer_load_dwordx4 v[44:47], v1, s[40:43], s63 offen nt
    s_waitcnt vmcnt(3)
    s_add_u32 s63, s69, 147456
    buffer_load_dwordx4 v[72:75], v1, s[40:43], s63 offen nt
    s_waitcnt vmcnt(3)
    s_add_u32 s63, s69, 155648
    buffer_load_dwordx4 v[76:79], v1, s[40:43], s63 offen nt
    s_waitcnt vmcnt(3)
    s_add_u32 s63, s69, 163840
    buffer_load_dwordx4 v[104:107], v1, s[40:43], s63 offen nt
    s_waitcnt vmcnt(3)
    s_add_u32 s63, s69, 172032
    buffer_load_dwordx4 v[108:111], v1, s[40:43], s63 offen nt
    s_waitcnt vmcnt(3)
    s_add_u32 s63, s69, 180224
    buffer_load_dwordx4 v[136:139], v1, s[40:43], s63 offen nt
    s_waitcnt vmcnt(3)
    s_add_u32 s63, s69, 188416
    buffer_load_dwordx4 v[140:143], v1, s[40:43], s63 offen nt
    s_waitcnt vmcnt(3)
    s_add_u32 s63, s69, 262144
    buffer_load_dwordx4 v[48:51], v1, s[40:43], s63 offen nt
    s_waitcnt vmcnt(3)
    s_add_u32 s63, s69, 270336
    buffer_load_dwordx4 v[52:55], v1, s[40:43], s63 offen nt
    s_branch .Le_done
.Lm_rel:
    s_waitcnt vmcnt(4)
    s_bitcmp1_b64 s[14:15], 4
    s_cbranch_scc0 1
    s_waitcnt vmcnt(3)
    s_add_u32 s63, s69, 32768
    buffer_load_dwordx4 v[96:99], v1, s[40:43], s63 offen nt
    s_waitcnt vmcnt(4)
    s_bitcmp1_b64 s[14:15], 5
    s_cbranch_scc0 1
    s_waitcnt vmcnt(3)
    s_add_u32 s63, s69, 40960
    buffer_load_dwordx4 v[100:103], v1, s[40:43], s63 offen nt
    s_waitcnt vmcnt(4)
    s_bitcmp1_b64 s[14:15], 6
    s_cbranch_scc0 1
    s_waitcnt vmcnt(3)
    s_add_u32 s63, s69, 49152
    buffer_load_dwordx4 v[128:131], v1, s[40:43], s63 offen nt
    s_waitcnt vmcnt(4)
    s_bitcmp1_b64 s[14:15], 7
    s_cbranch_scc0 1
    s_waitcnt vmcnt(2)
    s_add_u32 s63, s69, 57344
    buffer_load_dwordx4 v[132:135], v1, s[40:43], s63 offen nt
    s_waitcnt vmcnt(3)
    s_bitcmp1_b64 s[14:15], 8
    s_cbranch_scc0 1
    s_waitcnt vmcnt(2)
    s_add_u32 s63, s69, 131072
    buffer_load_dwordx4 v[40:43], v1, s[40:43], s63 offen nt
    s_waitcnt vmcnt(3)
    s_bitcmp1_b64 s[14:15], 9
    s_cbranch_scc0 1
    s_waitcnt vmcnt(2)
    s_add_u32 s63, s69, 139264
    buffer_load_dwordx4 v[44:47], v1, s[40:43], s63 offen nt
    s_waitcnt lgkmcnt(0)
    s_add_u32 s34, s34, 1
    s_getreg_b32 s1, hwreg(HW_REG_XCC_ID)
    s_lshl_b32 s1, s1, 24
    s_add_u32 s1, s1, s34
    s_lshr_b32 s0, s2, 3
    s_lshl_b32 s63, s64, 8
    s_add_u32 s0, s0, s63
    s_lshl2_add_u32 s0, s0, 0x480000
    v_mov_b32 v30, s1
    s_cmp_eq_u32 s3, 0
    s_cselect_b64 exec, 1, 0
    buffer_store_dword v30, v2, s[36:39], s0 offen sc1
    s_mov_b64 exec, -1
    s_cmp_lt_u32 s99, 54
    s_cbranch_scc1 .Lmr_part
    s_waitcnt vmcnt(4)
    s_bitcmp1_b64 s[14:15], 10
    s_cbranch_scc0 1
    s_waitcnt vmcnt(3)
    s_add_u32 s63, s69, 147456
    buffer_load_dwordx4 v[72:75], v1, s[40:43], s63 offen nt
    s_waitcnt vmcnt(4)
    s_bitcmp1_b64 s[14:15], 11
    s_cbranch_scc0 1
    s_waitcnt vmcnt(3)
    s_add_u32 s63, s69, 155648
    buffer_load_dwordx4 v[76:79], v1, s[40:43], s63 offen nt
    s_waitcnt vmcnt(4)
    s_bitcmp1_b64 s[14:15], 12
    s_cbranch_scc0 1
    s_waitcnt vmcnt(3)
    s_add_u32 s63, s69, 163840
    buffer_load_dwordx4 v[104:107], v1, s[40:43], s63 offen nt
    s_waitcnt vmcnt(4)
    s_bitcmp1_b64 s[14:15], 13
    s_cbranch_scc0 1
    s_waitcnt vmcnt(2)
    s_add_u32 s63, s69, 172032
    buffer_load_dwordx4 v[108:111], v1, s[40:43], s63 offen nt
    s_waitcnt vmcnt(3)
    s_bitcmp1_b64 s[14:15], 14
    s_cbranch_scc0 1
    s_waitcnt vmcnt(2)
    s_add_u32 s63, s69, 180224
    buffer_load_dwordx4 v[136:139], v1, s[40:43], s63 offen nt
    s_waitcnt vmcnt(3)
    s_bitcmp1_b64 s[14:15], 15
    s_cbranch_scc0 1
    s_waitcnt vmcnt(2)
    s_add_u32 s63, s69, 188416
    buffer_load_dwordx4 v[140:143], v1, s[40:43], s63 offen nt
    s_waitcnt vmcnt(3)
    s_bitcmp1_b64 s[14:15], 16
    s_cbranch_scc0 1
    s_waitcnt vmcnt(2)
    s_add_u32 s63, s69, 262144
    buffer_load_dwordx4 v[48:51], v1, s[40:43], s63 offen nt
    s_waitcnt vmcnt(3)
    s_bitcmp1_b64 s[14:15], 17
    s_cbranch_scc0 1
    s_waitcnt vmcnt(2)
    s_add_u32 s63, s69, 270336
    buffer_load_dwordx4 v[52:55], v1, s[40:43], s63 offen nt
    s_branch .Le_done
.Lmr_part:
    s_mul_i32 s58, s3, 1152
    s_mov_b32 s52, s24
    s_and_b32 s53, s25, 0xffff
    s_mov_b32 s54, 0x2400
    s_mov_b32 s55, 0x00020000
    buffer_load_dwordx2 v[246:247], v3, s[52:55], s58 offen
    buffer_load_dwordx2 v[248:249], v3, s[52:55], s58 offen offset:512
    buffer_load_dword v250, v4, s[52:55], s58 offen
    s_mov_b32 s48, s26
    s_and_b32 s49, s27, 0xffff
    s_mov_b32 s50, 0x3cc000
    s_mov_b32 s51, 0x00020000
    v_bfe_u32 v12, v0, 4, 1
    s_and_b32 s56, s3, 3
    s_lshl_b32 s56, s56, 1
    v_or_b32 v12, s56, v12
    v_and_b32 v19, 7, v0
    v_xor_b32 v12, v12, v19
    v_lshrrev_b32 v19, 3, v0
    v_mul_u32_u24 v19, 6912, v19
    v_lshl_add_u32 v19, v12, 4, v19
    s_branch .Lsk_m0_3
.Lst_m0_3:
    s_branch .Lrt_m0_3
.Lsk_m0_3:
    s_mul_i32 s57, s3, 55296
    s_lshl_b32 s59, s99, 7
    s_add_u32 s57, s57, s59
    s_add_u32 m0, s100, 0
    s_add_u32 s56, s57, 0
    buffer_load_dwordx4 v19, s[48:51], s56 offen nt lds
    s_add_u32 m0, s100, 8192
    s_add_u32 s56, s57, 442368
    buffer_load_dwordx4 v19, s[48:51], s56 offen nt lds
    s_add_u32 m0, s100, 16384
    s_add_u32 s56, s57, 884736
    buffer_load_dwordx4 v19, s[48:51], s56 offen nt lds
    s_add_u32 m0, s100, 24576
    s_add_u32 s56, s57, 1327104
    buffer_load_dwordx4 v19, s[48:51], s56 offen nt lds
    s_add_u32 m0, s100, 32768
    s_add_u32 s56, s57, 1769472
    buffer_load_dwordx4 v19, s[48:51], s56 offen nt lds
    s_add_u32 m0, s100, 40960
    s_add_u32 s56, s57, 2211840
    buffer_load_dwordx4 v19, s[48:51], s56 offen nt lds
    s_add_u32 m0, s100, 49152
    s_add_u32 s56, s57, 2654208
    buffer_load_dwordx4 v19, s[48:51], s56 offen nt lds
    s_add_u32 m0, s100, 57344
    s_add_u32 s56, s57, 3096576
    buffer_load_dwordx4 v19, s[48:51], s56 offen nt lds
    s_add_u32 m0, s100, 65536
    s_add_u32 s56, s57, 3538944
    buffer_load_dwordx4 v19, s[48:51], s56 offen nt lds
    v_lshrrev_b32 v12, 4, v0
    v_mul_u32_u24 v12, 18432, v12
    v_and_b32 v13, 15, v0
    v_lshl_add_u32 v22, v13, 4, v12
    s_mul_i32 s57, s99, 57
    s_lshr_b32 s57, s57, 9
    s_mul_i32 s58, s57, 9
    s_sub_u32 s58, s99, s58
    s_mul_i32 s59, s57, 73728
    s_lshl_b32 s58, s58, 8
    s_add_u32 s59, s59, s58
    s_mul_i32 s58, s3, 2304
    s_add_u32 s59, s59, s58
    s_add_u32 s59, s59, 0x1000
    s_mov_b32 s58, 0
    s_cmp_eq_u32 s57, 1
    s_cselect_b32 s58, 1.0, s58
    s_cmp_eq_u32 s57, 4
    s_cselect_b32 s58, 1.0, s58
    s_waitcnt vmcnt(9)
    v_lshlrev_b32 v236, 16, v246
    v_and_b32 v237, 0xffff0000, v246
    v_max_f32 v236, 0xc2ae0000, v236
    v_min_f32 v242, 0x43000000, v236
    v_mul_f32 v238, 0xbfb8aa3b, v242
    v_fma_f32 v240, v242, s98, -v238
    v_fmac_f32 v240, 0xb2a57060, v242
    v_exp_f32 v238, v238
    v_mul_f32 v240, 0x3f317218, v240
    v_fmac_f32 v238, v238, v240
    v_add_f32 v238, 1.0, v238
    v_rcp_f32 v240, v238
    s_nop 0
    v_mul_f32 v242, v236, v240
    v_fma_f32 v238, -v242, v238, v236
    v_fma_f32 v236, v238, v240, v242
    v_max_f32 v237, 0xc2ae0000, v237
    v_min_f32 v243, 0x43000000, v237
    v_mul_f32 v239, 0xbfb8aa3b, v243
    v_fma_f32 v241, v243, s98, -v239
    v_fmac_f32 v241, 0xb2a57060, v243
    v_exp_f32 v239, v239
    v_mul_f32 v241, 0x3f317218, v241
    v_fmac_f32 v239, v239, v241
    v_add_f32 v239, 1.0, v239
    v_rcp_f32 v241, v239
    s_nop 0
    v_mul_f32 v243, v237, v241
    v_fma_f32 v239, -v243, v239, v237
    v_fma_f32 v237, v239, v241, v243
    v_cvt_pk_bf16_f32 v246, v236, v237
    v_lshlrev_b32 v236, 16, v247
    v_and_b32 v237, 0xffff0000, v247
    v_max_f32 v236, 0xc2ae0000, v236
    v_min_f32 v242, 0x43000000, v236
    v_mul_f32 v238, 0xbfb8aa3b, v242
    v_fma_f32 v240, v242, s98, -v238
    v_fmac_f32 v240, 0xb2a57060, v242
    v_exp_f32 v238, v238
    v_mul_f32 v240, 0x3f317218, v240
    v_fmac_f32 v238, v238, v240
    v_add_f32 v238, 1.0, v238
    v_rcp_f32 v240, v238
    s_nop 0
    v_mul_f32 v242, v236, v240
    v_fma_f32 v238, -v242, v238, v236
    v_fma_f32 v236, v238, v240, v242
    v_max_f32 v237, 0xc2ae0000, v237
    v_min_f32 v243, 0x43000000, v237
    v_mul_f32 v239, 0xbfb8aa3b, v243
    v_fma_f32 v241, v243, s98, -v239
    v_fmac_f32 v241, 0xb2a57060, v243
    v_exp_f32 v239, v239
    v_mul_f32 v241, 0x3f317218, v241
    v_fmac_f32 v239, v239, v241
    v_add_f32 v239, 1.0, v239
    v_rcp_f32 v241, v239
    s_nop 0
    v_mul_f32 v243, v237, v241
    v_fma_f32 v239, -v243, v239, v237
    v_fma_f32 v237, v239, v241, v243
    v_cvt_pk_bf16_f32 v247, v236, v237
    v_lshlrev_b32 v236, 16, v248
    v_and_b32 v237, 0xffff0000, v248
    v_max_f32 v236, 0xc2ae0000, v236
    v_min_f32 v242, 0x43000000, v236
    v_mul_f32 v238, 0xbfb8aa3b, v242
    v_fma_f32 v240, v242, s98, -v238
    v_fmac_f32 v240, 0xb2a57060, v242
    v_exp_f32 v238, v238
    v_mul_f32 v240, 0x3f317218, v240
    v_fmac_f32 v238, v238, v240
    v_add_f32 v238, 1.0, v238
    v_rcp_f32 v240, v238
    s_nop 0
    v_mul_f32 v242, v236, v240
    v_fma_f32 v238, -v242, v238, v236
    v_fma_f32 v236, v238, v240, v242
    v_max_f32 v237, 0xc2ae0000, v237
    v_min_f32 v243, 0x43000000, v237
    v_mul_f32 v239, 0xbfb8aa3b, v243
    v_fma_f32 v241, v243, s98, -v239
    v_fmac_f32 v241, 0xb2a57060, v243
    v_exp_f32 v239, v239
    v_mul_f32 v241, 0x3f317218, v241
    v_fmac_f32 v239, v239, v241
    v_add_f32 v239, 1.0, v239
    v_rcp_f32 v241, v239
    s_nop 0
    v_mul_f32 v243, v237, v241
    v_fma_f32 v239, -v243, v239, v237
    v_fma_f32 v237, v239, v241, v243
    v_cvt_pk_bf16_f32 v248, v236, v237
    v_lshlrev_b32 v236, 16, v249
    v_and_b32 v237, 0xffff0000, v249
    v_max_f32 v236, 0xc2ae0000, v236
    v_min_f32 v242, 0x43000000, v236
    v_mul_f32 v238, 0xbfb8aa3b, v242
    v_fma_f32 v240, v242, s98, -v238
    v_fmac_f32 v240, 0xb2a57060, v242
    v_exp_f32 v238, v238
    v_mul_f32 v240, 0x3f317218, v240
    v_fmac_f32 v238, v238, v240
    v_add_f32 v238, 1.0, v238
    v_rcp_f32 v240, v238
    s_nop 0
    v_mul_f32 v242, v236, v240
    v_fma_f32 v238, -v242, v238, v236
    v_fma_f32 v236, v238, v240, v242
    v_max_f32 v237, 0xc2ae0000, v237
    v_min_f32 v243, 0x43000000, v237
    v_mul_f32 v239, 0xbfb8aa3b, v243
    v_fma_f32 v241, v243, s98, -v239
    v_fmac_f32 v241, 0xb2a57060, v243
    v_exp_f32 v239, v239
    v_mul_f32 v241, 0x3f317218, v241
    v_fmac_f32 v239, v239, v241
    v_add_f32 v239, 1.0, v239
    v_rcp_f32 v241, v239
    s_nop 0
    s_branch .Lsk_m0_4
.Lst_m0_4:
    s_branch .Lrt_m0_4
.Lsk_m0_4:
    v_mul_f32 v243, v237, v241
    v_fma_f32 v239, -v243, v239, v237
    v_fma_f32 v237, v239, v241, v243
    v_cvt_pk_bf16_f32 v249, v236, v237
    v_lshlrev_b32 v236, 16, v250
    v_and_b32 v237, 0xffff0000, v250
    v_max_f32 v236, 0xc2ae0000, v236
    v_min_f32 v242, 0x43000000, v236
    v_mul_f32 v238, 0xbfb8aa3b, v242
    v_fma_f32 v240, v242, s98, -v238
    v_fmac_f32 v240, 0xb2a57060, v242
    v_exp_f32 v238, v238
    v_mul_f32 v240, 0x3f317218, v240
    v_fmac_f32 v238, v238, v240
    v_add_f32 v238, 1.0, v238
    v_rcp_f32 v240, v238
    s_nop 0
    v_mul_f32 v242, v236, v240
    v_fma_f32 v238, -v242, v238, v236
    v_fma_f32 v236, v238, v240, v242
    v_max_f32 v237, 0xc2ae0000, v237
    v_min_f32 v243, 0x43000000, v237
    v_mul_f32 v239, 0xbfb8aa3b, v243
    v_fma_f32 v241, v243, s98, -v239
    v_fmac_f32 v241, 0xb2a57060, v243
    v_exp_f32 v239, v239
    v_mul_f32 v241, 0x3f317218, v241
    v_fmac_f32 v239, v239, v241
    v_add_f32 v239, 1.0, v239
    v_rcp_f32 v241, v239
    s_nop 0
    v_mul_f32 v243, v237, v241
    v_fma_f32 v239, -v243, v239, v237
    v_fma_f32 v237, v239, v241, v243
    v_cvt_pk_bf16_f32 v250, v236, v237
    ds_write_b64 v17, v[246:247] offset:0
    ds_write_b64 v17, v[248:249] offset:512
    ds_write_b32 v18, v250 offset:0
    s_waitcnt vmcnt(3)
    s_add_u32 s63, s69, 147456
    buffer_load_dwordx4 v[72:75], v1, s[40:43], s63 offen nt
    s_waitcnt vmcnt(3)
    s_add_u32 s63, s69, 155648
    buffer_load_dwordx4 v[76:79], v1, s[40:43], s63 offen nt
    s_waitcnt vmcnt(3)
    s_add_u32 s63, s69, 163840
    buffer_load_dwordx4 v[104:107], v1, s[40:43], s63 offen nt
    s_waitcnt vmcnt(3)
    s_add_u32 s63, s69, 172032
    buffer_load_dwordx4 v[108:111], v1, s[40:43], s63 offen nt
    s_waitcnt vmcnt(3)
    s_add_u32 s63, s69, 180224
    buffer_load_dwordx4 v[136:139], v1, s[40:43], s63 offen nt
    s_waitcnt vmcnt(3)
    s_add_u32 s63, s69, 188416
    buffer_load_dwordx4 v[140:143], v1, s[40:43], s63 offen nt
    s_waitcnt vmcnt(3)
    s_add_u32 s63, s69, 262144
    buffer_load_dwordx4 v[48:51], v1, s[40:43], s63 offen nt
    s_waitcnt vmcnt(3)
    s_add_u32 s63, s69, 270336
    buffer_load_dwordx4 v[52:55], v1, s[40:43], s63 offen nt
    s_waitcnt lgkmcnt(0)
    s_barrier
    ds_read_b64_tr_b16 v[160:161], v20 offset:0
    ds_read_b64_tr_b16 v[162:163], v20 offset:512
    ds_read_b64_tr_b16 v[164:165], v20 offset:8192
    ds_read_b64_tr_b16 v[166:167], v20 offset:8704
    ds_read_b64_tr_b16 v[168:169], v20 offset:16384
    ds_read_b64_tr_b16 v[170:171], v20 offset:16896
    ds_read_b64_tr_b16 v[172:173], v20 offset:24576
    ds_read_b64_tr_b16 v[174:175], v20 offset:25088
    ds_read_b64_tr_b16 v[176:177], v21 offset:0
    ds_read_b64_tr_b16 v[178:179], v21 offset:512
    ds_read_b64_tr_b16 v[180:181], v21 offset:8192
    ds_read_b64_tr_b16 v[182:183], v21 offset:8704
    ds_read_b64_tr_b16 v[184:185], v21 offset:16384
    ds_read_b64_tr_b16 v[186:187], v21 offset:16896
    ds_read_b64_tr_b16 v[188:189], v21 offset:24576
    ds_read_b64_tr_b16 v[190:191], v21 offset:25088
    ds_read_b64_tr_b16 v[192:193], v21 offset:32768
    ds_read_b64_tr_b16 v[194:195], v21 offset:33280
    ds_read_b128 v[196:199], v16 offset:0
    ds_read_b128 v[200:203], v16 offset:128
    ds_read_b128 v[204:207], v16 offset:256
    ds_read_b128 v[208:211], v16 offset:384
    ds_read_b128 v[212:215], v16 offset:512
    ds_read_b128 v[216:219], v16 offset:640
    ds_read_b128 v[220:223], v16 offset:768
    ds_read_b128 v[224:227], v16 offset:896
    ds_read_b128 v[228:231], v16 offset:1024
    s_waitcnt lgkmcnt(8)
    v_mfma_f32_16x16x32_bf16 v[232:235], v[160:163], v[196:199], 0
    s_waitcnt lgkmcnt(7)
    v_mfma_f32_16x16x32_bf16 v[232:235], v[164:167], v[200:203], v[232:235]
    s_waitcnt lgkmcnt(6)
    v_mfma_f32_16x16x32_bf16 v[232:235], v[168:171], v[204:207], v[232:235]
    s_waitcnt lgkmcnt(5)
    v_mfma_f32_16x16x32_bf16 v[232:235], v[172:175], v[208:211], v[232:235]
    s_waitcnt lgkmcnt(4)
    v_mfma_f32_16x16x32_bf16 v[232:235], v[176:179], v[212:215], v[232:235]
    s_waitcnt lgkmcnt(3)
    v_mfma_f32_16x16x32_bf16 v[232:235], v[180:183], v[216:219], v[232:235]
    s_waitcnt lgkmcnt(2)
    v_mfma_f32_16x16x32_bf16 v[232:235], v[184:187], v[220:223], v[232:235]
    s_waitcnt lgkmcnt(1)
    v_mfma_f32_16x16x32_bf16 v[232:235], v[188:191], v[224:227], v[232:235]
    s_waitcnt lgkmcnt(0)
    v_mfma_f32_16x16x32_bf16 v[232:235], v[192:195], v[228:231], v[232:235]
    s_nop 7
    v_permlane32_swap_b32 v232, v234
    v_permlane32_swap_b32 v233, v235
    v_cndmask_b32 v233, v233, v234, s[96:97]
    v_cndmask_b32 v232, v232, v235, s[96:97]
    s_nop 1
    v_add_f32_dpp v236, v233, v232 quad_perm:[1,0,3,2] row_mask:0xf bank_mask:0xf
    v_cvt_pk_bf16_f32 v236, v236, v236
    v_lshlrev_b32 v236, 16, v236
    v_add_f32 v236, s58, v236
    v_cvt_pk_bf16_f32 v236, v236, v236
    ds_write_b16 v23, v236
    v_mov_b32 v243, s34
    s_waitcnt lgkmcnt(0)
    s_barrier
    ds_read2_b32 v[244:245], v24 offset1:1
    v_mov_b32 v241, s34
    s_waitcnt lgkmcnt(0)
    v_mov_b32 v240, v244
    v_mov_b32 v242, v245
    s_bfm_b64 exec, 16, 0
    buffer_store_dwordx4 v[240:243], v22, s[36:39], s59 offen sc1
    s_mov_b64 exec, -1
.Le_done:
    v_and_b32 v8, 1, v0
    v_lshlrev_b32 v8, 8, v8
    v_and_b32 v9, 0x3c, v0
    v_lshl_add_u32 v9, v9, 2, v8
    v_add_u32 v7, v9, v8
    v_and_b32 v9, 0x3c, v0
    v_lshrrev_b32 v8, 4, v8
    v_and_b32 v9, 4, v0
    v_lshl_add_u32 v9, v9, 3, v8
    s_lshl_b32 s58, s66, 14
    s_lshl_b32 s59, s67, 10
    s_add_u32 s58, s58, s59
    s_add_u32 s58, s58, 0x70000
    s_lshl4_add_u32 s59, s66, s67
    s_lshl_b32 s59, s59, 7
    s_add_u32 s59, s59, 0x430000
    s_waitcnt vmcnt(3)
    s_bitcmp1_b64 s[14:15], 18
    s_cbranch_scc0 1
    s_waitcnt vmcnt(2)
    s_add_u32 s63, s69, 278528
    buffer_load_dwordx4 v[80:83], v1, s[40:43], s63 offen nt
    v_and_b32 v157, 7, v0
    v_lshlrev_b32 v157, 2, v157
    s_mov_b32 s63, 0x4a1000
    buffer_load_dword v156, v157, s[36:39], s63 offen
    s_cmp_eq_u32 s3, 0
    s_cbranch_scc1 .Lst_m1_0
    s_cmp_eq_u32 s3, 1
    s_cbranch_scc1 .Lst_m1_1
    s_cmp_eq_u32 s3, 2
    s_cbranch_scc1 .Lst_m1_2
    s_cmp_eq_u32 s3, 3
    s_cbranch_scc1 .Lst_m1_3
    s_cmp_eq_u32 s3, 4
    s_cbranch_scc1 .Lst_m1_4
    s_cmp_eq_u32 s3, 5
    s_cbranch_scc1 .Lst_m1_5
    s_cmp_eq_u32 s3, 6
    s_cbranch_scc1 .Lst_m1_6
    s_cmp_eq_u32 s3, 7
    s_cbranch_scc1 .Lst_m1_7
.Lrt_m1_0:
.Lrt_m1_1:
.Lrt_m1_2:
.Lrt_m1_3:
.Lrt_m1_4:
.Lrt_m1_5:
.Lrt_m1_6:
.Lrt_m1_7:
    s_memrealtime s[8:9]
    s_waitcnt lgkmcnt(0)
    s_sub_u32 s8, s8, s30
    s_cmpk_ge_u32 s8, 912
    s_cbranch_scc1 .ap_55
    s_waitcnt vmcnt(5)
    s_cmpk_ge_u32 s8, 812
    s_cbranch_scc1 .ap_55
    s_waitcnt vmcnt(4)
    s_bitcmp1_b64 s[14:15], 19
    s_cbranch_scc0 1
    s_waitcnt vmcnt(3)
    s_cmpk_ge_u32 s8, 692
    s_cbranch_scc1 .ap_55
    s_waitcnt vmcnt(2)
.ap_55:
    s_add_u32 s63, s69, 286720
    buffer_load_dwordx4 v[84:87], v1, s[40:43], s63 offen nt
    s_memrealtime s[8:9]
    s_waitcnt lgkmcnt(0)
    s_sub_u32 s8, s8, s30
    s_cmpk_ge_u32 s8, 957
    s_cbranch_scc1 .ap_56
    s_waitcnt vmcnt(6)
    s_cmpk_ge_u32 s8, 857
    s_cbranch_scc1 .ap_56
    s_waitcnt vmcnt(4)
    s_bitcmp1_b64 s[14:15], 20
    s_cbranch_scc0 1
    s_waitcnt vmcnt(3)
    s_cmpk_ge_u32 s8, 737
    s_cbranch_scc1 .ap_56
    s_waitcnt vmcnt(2)
.ap_56:
    s_add_u32 s63, s69, 294912
    buffer_load_dwordx4 v[112:115], v1, s[40:43], s63 offen nt
    s_memrealtime s[8:9]
    s_waitcnt lgkmcnt(0)
    s_sub_u32 s8, s8, s30
    s_cmpk_ge_u32 s8, 1002
    s_cbranch_scc1 .ap_57
    s_waitcnt vmcnt(6)
    s_cmpk_ge_u32 s8, 902
    s_cbranch_scc1 .ap_57
    s_waitcnt vmcnt(4)
    s_bitcmp1_b64 s[14:15], 21
    s_cbranch_scc0 1
    s_waitcnt vmcnt(3)
    s_cmpk_ge_u32 s8, 782
    s_cbranch_scc1 .ap_57
    s_waitcnt vmcnt(1)
.ap_57:
    s_add_u32 s63, s69, 303104
    buffer_load_dwordx4 v[116:119], v1, s[40:43], s63 offen nt
    s_memrealtime s[8:9]
    s_waitcnt lgkmcnt(0)
    s_sub_u32 s8, s8, s30
    s_cmpk_ge_u32 s8, 1048
    s_cbranch_scc1 .ap_58
    s_waitcnt vmcnt(6)
    s_cmpk_ge_u32 s8, 948
    s_cbranch_scc1 .ap_58
    s_waitcnt vmcnt(4)
    s_bitcmp1_b64 s[14:15], 22
    s_cbranch_scc0 1
    s_waitcnt vmcnt(2)
    s_cmpk_ge_u32 s8, 828
    s_cbranch_scc1 .ap_58
    s_waitcnt vmcnt(1)
.ap_58:
    s_add_u32 s63, s69, 311296
    buffer_load_dwordx4 v[144:147], v1, s[40:43], s63 offen nt
    s_waitcnt vmcnt(4)
    s_sub_u32 s63, s70, 300
    v_subrev_u32 v156, s63, v156
    v_mov_b32 v157, 600
    v_cmp_lt_u32 s[8:9], v156, v157
    v_add_u32_dpp v156, v156, v156 quad_perm:[1,0,3,2] row_mask:0xf bank_mask:0xf
    s_nop 1
    v_add_u32_dpp v156, v156, v156 quad_perm:[2,3,0,1] row_mask:0xf bank_mask:0xf
    s_nop 1
    v_add_u32_dpp v156, v156, v156 row_ror:4 row_mask:0xf bank_mask:0xf
    s_nop 0
    v_readfirstlane_b32 s63, v156
    s_cmp_eq_u64 s[8:9], -1
    s_nop 3
    s_cbranch_scc0 .et_59
    s_lshr_b32 s63, s63, 3
    s_sub_u32 s63, s63, 300
    s_add_u32 s30, s30, s63
    s_add_u32 s31, s31, s63
.et_59:
    s_memrealtime s[8:9]
    s_waitcnt lgkmcnt(0)
    s_sub_u32 s8, s8, s30
    s_cmpk_ge_u32 s8, 1093
    s_cbranch_scc1 .ap_60
    s_waitcnt vmcnt(4)
    s_cmpk_ge_u32 s8, 993
    s_cbranch_scc1 .ap_60
    s_waitcnt vmcnt(3)
    s_bitcmp1_b64 s[14:15], 23
    s_cbranch_scc0 1
    s_waitcnt vmcnt(2)
    s_cmpk_ge_u32 s8, 873
    s_cbranch_scc1 .ap_60
    s_waitcnt vmcnt(1)
.ap_60:
    s_add_u32 s63, s69, 319488
    buffer_load_dwordx4 v[148:151], v1, s[40:43], s63 offen nt
    s_memrealtime s[8:9]
    s_waitcnt lgkmcnt(0)
    s_sub_u32 s8, s8, s30
    s_cmpk_ge_u32 s8, 1138
    s_cbranch_scc1 .ap_61
    s_waitcnt vmcnt(5)
    s_cmpk_ge_u32 s8, 1038
    s_cbranch_scc1 .ap_61
    s_waitcnt vmcnt(3)
    s_bitcmp1_b64 s[14:15], 24
    s_cbranch_scc0 1
    s_waitcnt vmcnt(2)
    s_cmpk_ge_u32 s8, 918
    s_cbranch_scc1 .ap_61
    s_waitcnt vmcnt(1)
.ap_61:
    s_add_u32 s63, s69, 393216
    buffer_load_dwordx4 v[56:59], v1, s[40:43], s63 offen nt
    s_memrealtime s[8:9]
    s_waitcnt lgkmcnt(0)
    s_sub_u32 s8, s8, s30
    s_cmpk_ge_u32 s8, 1184
    s_cbranch_scc1 .ap_62
    s_waitcnt vmcnt(5)
    s_cmpk_ge_u32 s8, 1084
    s_cbranch_scc1 .ap_62
    s_waitcnt vmcnt(3)
    s_bitcmp1_b64 s[14:15], 25
    s_cbranch_scc0 1
    s_waitcnt vmcnt(2)
    s_cmpk_ge_u32 s8, 964
    s_cbranch_scc1 .ap_62
    s_waitcnt vmcnt(1)
.ap_62:
    s_add_u32 s63, s69, 401408
    buffer_load_dwordx4 v[60:63], v1, s[40:43], s63 offen nt
    s_memrealtime s[8:9]
    s_waitcnt lgkmcnt(0)
    s_sub_u32 s8, s8, s30
    s_cmpk_ge_u32 s8, 1211
    s_cbranch_scc1 .ap_63
    s_waitcnt vmcnt(5)
    s_cmpk_ge_u32 s8, 1111
    s_cbranch_scc1 .ap_63
    s_waitcnt vmcnt(3)
    s_bitcmp1_b64 s[14:15], 26
    s_cbranch_scc0 1
    s_waitcnt vmcnt(2)
    s_cmpk_ge_u32 s8, 991
    s_cbranch_scc1 .ap_63
    s_waitcnt vmcnt(1)
.ap_63:
    s_add_u32 s63, s69, 409600
    buffer_load_dwordx4 v[88:91], v1, s[40:43], s63 offen nt
    s_memrealtime s[8:9]
    s_waitcnt lgkmcnt(0)
    s_sub_u32 s8, s8, s30
    s_cmpk_ge_u32 s8, 1238
    s_cbranch_scc1 .ap_64
    s_waitcnt vmcnt(5)
    s_cmpk_ge_u32 s8, 1138
    s_cbranch_scc1 .ap_64
    s_waitcnt vmcnt(3)
    s_bitcmp1_b64 s[14:15], 27
    s_cbranch_scc0 1
    s_waitcnt vmcnt(2)
    s_cmpk_ge_u32 s8, 1018
    s_cbranch_scc1 .ap_64
    s_waitcnt vmcnt(1)
.ap_64:
    s_add_u32 s63, s69, 417792
    buffer_load_dwordx4 v[92:95], v1, s[40:43], s63 offen nt
    s_memrealtime s[8:9]
    s_waitcnt vmcnt(8)
    s_waitcnt lgkmcnt(0)
    s_sub_u32 s8, s8, s30
    s_cmpk_ge_u32 s8, 1265
    s_cbranch_scc1 .ap_65
    s_branch .Lsk_m1_0
.Lst_m1_0:
    s_branch .Lrt_m1_0
.Lsk_m1_0:
    s_waitcnt vmcnt(5)
    s_cmpk_ge_u32 s8, 1165
    s_cbranch_scc1 .ap_65
    s_waitcnt vmcnt(3)
    s_bitcmp1_b64 s[14:15], 28
    s_cbranch_scc0 1
    s_waitcnt vmcnt(2)
    s_cmpk_ge_u32 s8, 1045
    s_cbranch_scc1 .ap_65
    s_waitcnt vmcnt(1)
.ap_65:
    s_add_u32 s63, s69, 425984
    buffer_load_dwordx4 v[120:123], v1, s[40:43], s63 offen nt
    s_memrealtime s[8:9]
    s_waitcnt vmcnt(8)
    s_waitcnt lgkmcnt(0)
    s_sub_u32 s8, s8, s30
    s_cmpk_ge_u32 s8, 1292
    s_cbranch_scc1 .ap_66
    s_waitcnt vmcnt(5)
    s_cmpk_ge_u32 s8, 1192
    s_cbranch_scc1 .ap_66
    s_waitcnt vmcnt(3)
    s_bitcmp1_b64 s[14:15], 29
    s_cbranch_scc0 1
    s_waitcnt vmcnt(2)
    s_cmpk_ge_u32 s8, 1072
    s_cbranch_scc1 .ap_66
    s_waitcnt vmcnt(1)
.ap_66:
    s_add_u32 s63, s69, 434176
    buffer_load_dwordx4 v[124:127], v1, s[40:43], s63 offen nt
    s_memrealtime s[8:9]
    s_waitcnt vmcnt(8)
    s_waitcnt lgkmcnt(0)
    s_sub_u32 s8, s8, s30
    s_cmpk_ge_u32 s8, 1320
    s_cbranch_scc1 .ap_67
    s_waitcnt vmcnt(5)
    s_cmpk_ge_u32 s8, 1220
    s_cbranch_scc1 .ap_67
    s_waitcnt vmcnt(3)
    s_bitcmp1_b64 s[14:15], 30
    s_cbranch_scc0 1
    s_waitcnt vmcnt(2)
    s_cmpk_ge_u32 s8, 1100
    s_cbranch_scc1 .ap_67
    s_waitcnt vmcnt(1)
.ap_67:
    s_add_u32 s63, s69, 442368
    buffer_load_dwordx4 v[152:155], v1, s[40:43], s63 offen nt
    s_memrealtime s[8:9]
    s_waitcnt vmcnt(8)
    s_waitcnt lgkmcnt(0)
    s_sub_u32 s8, s8, s30
    s_cmpk_ge_u32 s8, 1347
    s_cbranch_scc1 .ap_68
    s_waitcnt vmcnt(5)
    s_cmpk_ge_u32 s8, 1247
    s_cbranch_scc1 .ap_68
    s_waitcnt vmcnt(3)
    s_bitcmp1_b64 s[14:15], 31
    s_cbranch_scc0 1
    s_waitcnt vmcnt(2)
    s_cmpk_ge_u32 s8, 1127
    s_cbranch_scc1 .ap_68
    s_waitcnt vmcnt(1)
.ap_68:
    s_add_u32 s63, s69, 450560
    buffer_load_dwordx4 v[156:159], v1, s[40:43], s63 offen nt
    s_memrealtime s[8:9]
    s_waitcnt vmcnt(8)
    s_waitcnt lgkmcnt(0)
    s_sub_u32 s8, s8, s30
    s_cmpk_ge_u32 s8, 1374
    s_cbranch_scc1 .ap_69
    s_waitcnt vmcnt(5)
    s_cmpk_ge_u32 s8, 1274
    s_cbranch_scc1 .ap_69
    s_waitcnt vmcnt(3)
    s_bitcmp1_b64 s[14:15], 32
    s_cbranch_scc0 1
    s_waitcnt vmcnt(2)
    s_cmpk_ge_u32 s8, 1154
    s_cbranch_scc1 .ap_69
    s_waitcnt vmcnt(1)
.ap_69:
    v_bfe_u32 v1, v0, 4, 2
    v_and_b32 v10, 0xf0, v2
    v_lshlrev_b32 v1, 2, v1
    v_bfe_u32 v1, s6, v1, 4
    v_lshl_add_u32 v1, v1, 8, v10
    s_add_u32 s63, s69, 0
    buffer_load_dwordx4 v[160:163], v1, s[44:47], s63 offen nt
    s_memrealtime s[8:9]
    s_waitcnt vmcnt(8)
    s_waitcnt lgkmcnt(0)
    s_sub_u32 s8, s8, s30
    s_cmpk_ge_u32 s8, 1401
    s_cbranch_scc1 .ap_70
    s_waitcnt vmcnt(5)
    s_cmpk_ge_u32 s8, 1301
    s_cbranch_scc1 .ap_70
    s_waitcnt vmcnt(3)
    s_bitcmp1_b64 s[14:15], 33
    s_cbranch_scc0 1
    s_waitcnt vmcnt(2)
    s_cmpk_ge_u32 s8, 1181
    s_cbranch_scc1 .ap_70
    s_waitcnt vmcnt(1)
.ap_70:
    s_add_u32 s63, s69, 8192
    buffer_load_dwordx4 v[164:167], v1, s[44:47], s63 offen nt
    s_memrealtime s[8:9]
    s_waitcnt vmcnt(8)
    s_waitcnt lgkmcnt(0)
    s_sub_u32 s8, s8, s30
    s_cmpk_ge_u32 s8, 1428
    s_cbranch_scc1 .ap_71
    s_waitcnt vmcnt(5)
    s_cmpk_ge_u32 s8, 1328
    s_cbranch_scc1 .ap_71
    s_waitcnt vmcnt(3)
    s_bitcmp1_b64 s[14:15], 34
    s_cbranch_scc0 1
    s_waitcnt vmcnt(2)
    s_cmpk_ge_u32 s8, 1208
    s_cbranch_scc1 .ap_71
    s_waitcnt vmcnt(1)
.ap_71:
    s_add_u32 s63, s69, 16384
    buffer_load_dwordx4 v[168:171], v1, s[44:47], s63 offen nt
    s_memrealtime s[8:9]
    s_waitcnt vmcnt(8)
    s_waitcnt lgkmcnt(0)
    s_sub_u32 s8, s8, s30
    s_cmpk_ge_u32 s8, 1456
    s_cbranch_scc1 .ap_72
    s_waitcnt vmcnt(5)
    s_cmpk_ge_u32 s8, 1356
    s_cbranch_scc1 .ap_72
    s_waitcnt vmcnt(3)
    s_bitcmp1_b64 s[14:15], 35
    s_cbranch_scc0 1
    s_waitcnt vmcnt(2)
    s_cmpk_ge_u32 s8, 1236
    s_cbranch_scc1 .ap_72
    s_waitcnt vmcnt(1)
.ap_72:
    s_add_u32 s63, s69, 24576
    buffer_load_dwordx4 v[172:175], v1, s[44:47], s63 offen nt
    buffer_load_dwordx4 v[16:19], v7, s[36:39], s58 offen offset:0 sc1
    buffer_load_dwordx4 v[20:23], v7, s[36:39], s58 offen offset:256 sc1
    s_memrealtime s[8:9]
    s_waitcnt vmcnt(8)
    s_waitcnt lgkmcnt(0)
    s_sub_u32 s8, s8, s30
    s_cmpk_ge_u32 s8, 1486
    s_cbranch_scc1 .ap_73
    s_waitcnt vmcnt(5)
    s_cmpk_ge_u32 s8, 1386
    s_cbranch_scc1 .ap_73
    s_waitcnt vmcnt(3)
    s_bitcmp1_b64 s[14:15], 36
    s_cbranch_scc0 1
    s_waitcnt vmcnt(2)
    s_cmpk_ge_u32 s8, 1266
    s_cbranch_scc1 .ap_73
    s_waitcnt vmcnt(1)
.ap_73:
    s_add_u32 s63, s69, 32768
    buffer_load_dwordx4 v[176:179], v1, s[44:47], s63 offen nt
    s_memrealtime s[8:9]
    s_waitcnt vmcnt(8)
    s_waitcnt lgkmcnt(0)
    s_sub_u32 s8, s8, s30
    s_cmpk_ge_u32 s8, 1516
    s_cbranch_scc1 .ap_74
    s_waitcnt vmcnt(5)
    s_cmpk_ge_u32 s8, 1416
    s_cbranch_scc1 .ap_74
    s_waitcnt vmcnt(3)
    s_bitcmp1_b64 s[14:15], 37
    s_cbranch_scc0 1
    s_waitcnt vmcnt(2)
    s_cmpk_ge_u32 s8, 1296
    s_cbranch_scc1 .ap_74
    s_waitcnt vmcnt(1)
.ap_74:
    s_add_u32 s63, s69, 40960
    buffer_load_dwordx4 v[180:183], v1, s[44:47], s63 offen nt
    s_memrealtime s[8:9]
    s_waitcnt vmcnt(8)
    s_waitcnt lgkmcnt(0)
    s_sub_u32 s8, s8, s30
    s_cmpk_ge_u32 s8, 1546
    s_cbranch_scc1 .ap_75
    s_waitcnt vmcnt(5)
    s_cmpk_ge_u32 s8, 1446
    s_cbranch_scc1 .ap_75
    s_waitcnt vmcnt(3)
    s_bitcmp1_b64 s[14:15], 38
    s_cbranch_scc0 1
    s_waitcnt vmcnt(2)
    s_cmpk_ge_u32 s8, 1326
    s_cbranch_scc1 .ap_75
    s_waitcnt vmcnt(1)
.ap_75:
    s_add_u32 s63, s69, 49152
    buffer_load_dwordx4 v[184:187], v1, s[44:47], s63 offen nt
    s_waitcnt vmcnt(3)
    s_branch .gpc_77
.gp_76:
    buffer_load_dwordx4 v[16:19], v7, s[36:39], s58 offen offset:0 sc1
    buffer_load_dwordx4 v[20:23], v7, s[36:39], s58 offen offset:256 sc1
    s_waitcnt vmcnt(0)
.gpc_77:
    v_min_u32 v10, v17, v19
    v_max_u32 v11, v17, v19
    v_min3_u32 v10, v10, v21, v23
    v_max3_u32 v11, v11, v21, v23
    v_cmp_eq_u32 vcc, s34, v10
    v_cmp_eq_u32 s[56:57], s34, v11
    s_and_b64 vcc, vcc, s[56:57]
    s_cmp_eq_u64 vcc, -1
    s_nop 2
    s_cbranch_scc1 .gpd_78
    s_sub_u32 s35, s35, 1
    s_cbranch_scc1 .Lexit
    s_sleep 1
    s_branch .gp_76
.gpd_78:
    s_mov_b32 vcc_lo, 0xcccccccc
    s_mov_b32 vcc_hi, 0xcccccccc
    v_cndmask_b32_e64 v24, v16, 0, vcc
    v_cndmask_b32_e64 v25, v18, 0, vcc
    v_cndmask_b32_e64 v26, v20, 0, vcc
    s_branch .Lsk_m1_1
.Lst_m1_1:
    s_branch .Lrt_m1_1
.Lsk_m1_1:
    v_cndmask_b32_e64 v27, v22, 0, vcc
    v_cndmask_b32_e32 v28, 0, v16, vcc
    v_cndmask_b32_e32 v29, 0, v18, vcc
    v_cndmask_b32_e32 v30, 0, v20, vcc
    v_cndmask_b32_e32 v31, 0, v22, vcc
    v_mfma_f32_16x16x32_bf16 v[16:19], v[32:35], v[24:27], 0
    v_mfma_f32_16x16x32_bf16 v[32:35], v[40:43], v[24:27], 0
    v_mfma_f32_16x16x32_bf16 v[16:19], v[36:39], v[28:31], v[16:19]
    v_mfma_f32_16x16x32_bf16 v[40:43], v[48:51], v[24:27], 0
    v_mfma_f32_16x16x32_bf16 v[32:35], v[44:47], v[28:31], v[32:35]
    v_mfma_f32_16x16x32_bf16 v[48:51], v[56:59], v[24:27], 0
    v_mfma_f32_16x16x32_bf16 v[40:43], v[52:55], v[28:31], v[40:43]
    v_mfma_f32_16x16x32_bf16 v[56:59], v[64:67], v[24:27], 0
    v_mfma_f32_16x16x32_bf16 v[48:51], v[60:63], v[28:31], v[48:51]
    s_nop 1
    v_add_f32_dpp v10, v17, v16 row_ror:12 row_mask:0xf bank_mask:0x1
    s_memrealtime s[8:9]
    s_waitcnt lgkmcnt(0)
    s_sub_u32 s8, s8, s30
    s_cmpk_ge_u32 s8, 1576
    s_nop 0
    s_cbranch_scc1 .ap_79
    s_waitcnt vmcnt(3)
    s_cmpk_ge_u32 s8, 1476
    s_cbranch_scc1 .ap_79
    s_waitcnt vmcnt(3)
    s_bitcmp1_b64 s[14:15], 39
    s_cbranch_scc0 1
    s_waitcnt vmcnt(2)
    s_cmpk_ge_u32 s8, 1356
    s_cbranch_scc1 .ap_79
    s_waitcnt vmcnt(1)
.ap_79:
    s_add_u32 s63, s69, 57344
    buffer_load_dwordx4 v[188:191], v1, s[44:47], s63 offen nt
    v_mfma_f32_16x16x32_bf16 v[64:67], v[72:75], v[24:27], 0
    v_mfma_f32_16x16x32_bf16 v[56:59], v[68:71], v[28:31], v[56:59]
    v_add_f32_dpp v11, v33, v32 row_ror:12 row_mask:0xf bank_mask:0x1
    v_add_f32_dpp v10, v18, v10 row_ror:8 row_mask:0xf bank_mask:0x1
    v_mfma_f32_16x16x32_bf16 v[72:75], v[80:83], v[24:27], 0
    v_mfma_f32_16x16x32_bf16 v[64:67], v[76:79], v[28:31], v[64:67]
    v_add_f32_dpp v12, v41, v40 row_ror:12 row_mask:0xf bank_mask:0x1
    v_add_f32_dpp v11, v34, v11 row_ror:8 row_mask:0xf bank_mask:0x1
    v_add_f32_dpp v10, v19, v10 row_ror:4 row_mask:0xf bank_mask:0x1
    v_mfma_f32_16x16x32_bf16 v[80:83], v[88:91], v[24:27], 0
    v_mfma_f32_16x16x32_bf16 v[72:75], v[84:87], v[28:31], v[72:75]
    v_add_f32_dpp v13, v49, v48 row_ror:12 row_mask:0xf bank_mask:0x1
    v_add_f32_dpp v12, v42, v12 row_ror:8 row_mask:0xf bank_mask:0x1
    v_add_f32_dpp v11, v35, v11 row_ror:4 row_mask:0xf bank_mask:0x1
    v_mfma_f32_16x16x32_bf16 v[88:91], v[96:99], v[24:27], 0
    v_mfma_f32_16x16x32_bf16 v[80:83], v[92:95], v[28:31], v[80:83]
    v_add_f32_dpp v10, v58, v57 row_ror:12 row_mask:0xf bank_mask:0x2
    v_add_f32_dpp v13, v50, v13 row_ror:8 row_mask:0xf bank_mask:0x1
    v_add_f32_dpp v12, v43, v12 row_ror:4 row_mask:0xf bank_mask:0x1
    s_memrealtime s[8:9]
    s_waitcnt lgkmcnt(0)
    s_sub_u32 s8, s8, s30
    s_cmpk_ge_u32 s8, 1606
    s_nop 0
    s_cbranch_scc1 .ap_80
    s_waitcnt vmcnt(4)
    s_cmpk_ge_u32 s8, 1506
    s_cbranch_scc1 .ap_80
    s_waitcnt vmcnt(3)
    s_bitcmp1_b64 s[14:15], 40
    s_cbranch_scc0 1
    s_waitcnt vmcnt(2)
    s_cmpk_ge_u32 s8, 1386
    s_cbranch_scc1 .ap_80
    s_waitcnt vmcnt(1)
.ap_80:
    s_add_u32 s63, s69, 131072
    buffer_load_dwordx4 v[192:195], v1, s[44:47], s63 offen nt
    v_mfma_f32_16x16x32_bf16 v[96:99], v[104:107], v[24:27], 0
    v_mfma_f32_16x16x32_bf16 v[88:91], v[100:103], v[28:31], v[88:91]
    v_add_f32_dpp v11, v66, v65 row_ror:12 row_mask:0xf bank_mask:0x2
    v_add_f32_dpp v10, v59, v10 row_ror:8 row_mask:0xf bank_mask:0x2
    v_add_f32_dpp v13, v51, v13 row_ror:4 row_mask:0xf bank_mask:0x1
    v_mfma_f32_16x16x32_bf16 v[104:107], v[112:115], v[24:27], 0
    v_mfma_f32_16x16x32_bf16 v[96:99], v[108:111], v[28:31], v[96:99]
    v_add_f32_dpp v12, v74, v73 row_ror:12 row_mask:0xf bank_mask:0x2
    v_add_f32_dpp v11, v67, v11 row_ror:8 row_mask:0xf bank_mask:0x2
    v_add_f32_dpp v10, v56, v10 row_ror:4 row_mask:0xf bank_mask:0x2
    v_mfma_f32_16x16x32_bf16 v[112:115], v[120:123], v[24:27], 0
    v_mfma_f32_16x16x32_bf16 v[104:107], v[116:119], v[28:31], v[104:107]
    v_add_f32_dpp v13, v82, v81 row_ror:12 row_mask:0xf bank_mask:0x2
    v_add_f32_dpp v12, v75, v12 row_ror:8 row_mask:0xf bank_mask:0x2
    v_add_f32_dpp v11, v64, v11 row_ror:4 row_mask:0xf bank_mask:0x2
    v_mfma_f32_16x16x32_bf16 v[120:123], v[128:131], v[24:27], 0
    v_mfma_f32_16x16x32_bf16 v[112:115], v[124:127], v[28:31], v[112:115]
    v_add_f32_dpp v10, v91, v90 row_ror:12 row_mask:0xf bank_mask:0x4
    v_add_f32_dpp v13, v83, v13 row_ror:8 row_mask:0xf bank_mask:0x2
    v_add_f32_dpp v12, v72, v12 row_ror:4 row_mask:0xf bank_mask:0x2
    s_memrealtime s[8:9]
    s_waitcnt lgkmcnt(0)
    s_sub_u32 s8, s8, s30
    s_cmpk_ge_u32 s8, 1636
    s_nop 0
    s_cbranch_scc1 .ap_81
    s_waitcnt vmcnt(5)
    s_cmpk_ge_u32 s8, 1536
    s_cbranch_scc1 .ap_81
    s_waitcnt vmcnt(3)
    s_bitcmp1_b64 s[14:15], 41
    s_cbranch_scc0 1
    s_waitcnt vmcnt(2)
    s_cmpk_ge_u32 s8, 1416
    s_cbranch_scc1 .ap_81
    s_waitcnt vmcnt(1)
.ap_81:
    s_add_u32 s63, s69, 139264
    buffer_load_dwordx4 v[196:199], v1, s[44:47], s63 offen nt
    v_mfma_f32_16x16x32_bf16 v[128:131], v[136:139], v[24:27], 0
    v_mfma_f32_16x16x32_bf16 v[120:123], v[132:135], v[28:31], v[120:123]
    v_add_f32_dpp v11, v99, v98 row_ror:12 row_mask:0xf bank_mask:0x4
    v_add_f32_dpp v10, v88, v10 row_ror:8 row_mask:0xf bank_mask:0x4
    v_add_f32_dpp v13, v80, v13 row_ror:4 row_mask:0xf bank_mask:0x2
    v_mfma_f32_16x16x32_bf16 v[136:139], v[144:147], v[24:27], 0
    v_mfma_f32_16x16x32_bf16 v[128:131], v[140:143], v[28:31], v[128:131]
    v_add_f32_dpp v12, v107, v106 row_ror:12 row_mask:0xf bank_mask:0x4
    v_add_f32_dpp v11, v96, v11 row_ror:8 row_mask:0xf bank_mask:0x4
    v_add_f32_dpp v10, v89, v10 row_ror:4 row_mask:0xf bank_mask:0x4
    v_mfma_f32_16x16x32_bf16 v[144:147], v[152:155], v[24:27], 0
    v_mfma_f32_16x16x32_bf16 v[136:139], v[148:151], v[28:31], v[136:139]
    v_add_f32_dpp v13, v115, v114 row_ror:12 row_mask:0xf bank_mask:0x4
    v_add_f32_dpp v12, v104, v12 row_ror:8 row_mask:0xf bank_mask:0x4
    v_add_f32_dpp v11, v97, v11 row_ror:4 row_mask:0xf bank_mask:0x4
    v_mfma_f32_16x16x32_bf16 v[144:147], v[156:159], v[28:31], v[144:147]
    v_add_f32_dpp v10, v120, v123 row_ror:12 row_mask:0xf bank_mask:0x8
    v_add_f32_dpp v13, v112, v13 row_ror:8 row_mask:0xf bank_mask:0x4
    v_add_f32_dpp v12, v105, v12 row_ror:4 row_mask:0xf bank_mask:0x4
    s_memrealtime s[8:9]
    s_waitcnt lgkmcnt(0)
    s_sub_u32 s8, s8, s30
    s_cmpk_ge_u32 s8, 1666
    s_nop 0
    s_cbranch_scc1 .ap_82
    s_waitcnt vmcnt(5)
    s_cmpk_ge_u32 s8, 1566
    s_cbranch_scc1 .ap_82
    s_waitcnt vmcnt(3)
    s_bitcmp1_b64 s[14:15], 42
    s_cbranch_scc0 1
    s_waitcnt vmcnt(2)
    s_cmpk_ge_u32 s8, 1446
    s_cbranch_scc1 .ap_82
    s_waitcnt vmcnt(1)
.ap_82:
    s_add_u32 s63, s69, 147456
    buffer_load_dwordx4 v[200:203], v1, s[44:47], s63 offen nt
    v_add_f32_dpp v11, v128, v131 row_ror:12 row_mask:0xf bank_mask:0x8
    v_add_f32_dpp v10, v121, v10 row_ror:8 row_mask:0xf bank_mask:0x8
    v_add_f32_dpp v13, v113, v13 row_ror:4 row_mask:0xf bank_mask:0x4
    v_add_f32_dpp v12, v136, v139 row_ror:12 row_mask:0xf bank_mask:0x8
    v_add_f32_dpp v11, v129, v11 row_ror:8 row_mask:0xf bank_mask:0x8
    v_add_f32_dpp v10, v122, v10 row_ror:4 row_mask:0xf bank_mask:0x8
    v_add_f32_dpp v13, v144, v147 row_ror:12 row_mask:0xf bank_mask:0x8
    v_add_f32_dpp v12, v137, v12 row_ror:8 row_mask:0xf bank_mask:0x8
    v_add_f32_dpp v11, v130, v11 row_ror:4 row_mask:0xf bank_mask:0x8
    v_add_f32_dpp v13, v145, v13 row_ror:8 row_mask:0xf bank_mask:0x8
    v_add_f32_dpp v12, v138, v12 row_ror:4 row_mask:0xf bank_mask:0x8
    s_memrealtime s[8:9]
    s_waitcnt lgkmcnt(0)
    s_sub_u32 s8, s8, s30
    s_cmpk_ge_u32 s8, 1696
    s_cbranch_scc1 .ap_83
    s_waitcnt vmcnt(5)
    s_cmpk_ge_u32 s8, 1596
    s_cbranch_scc1 .ap_83
    s_waitcnt vmcnt(3)
    s_bitcmp1_b64 s[14:15], 43
    s_cbranch_scc0 1
    s_waitcnt vmcnt(2)
    s_cmpk_ge_u32 s8, 1476
    s_cbranch_scc1 .ap_83
    s_waitcnt vmcnt(1)
.ap_83:
    s_add_u32 s63, s69, 155648
    buffer_load_dwordx4 v[204:207], v1, s[44:47], s63 offen nt
    s_branch .Lsk_m1_2
.Lst_m1_2:
    s_branch .Lrt_m1_2
.Lsk_m1_2:
    v_add_f32_dpp v13, v146, v13 row_ror:4 row_mask:0xf bank_mask:0x8
    s_mov_b32 s60, 0x3db504f3
    s_mov_b32 s61, 0x3db504f3
    v_cvt_pk_bf16_f32 v10, v10, v11
    v_and_b32 v11, 0xffff0000, v10
    v_lshlrev_b32 v10, 16, v10
    v_cvt_pk_bf16_f32 v12, v12, v13
    v_and_b32 v13, 0xffff0000, v12
    v_lshlrev_b32 v12, 16, v12
    v_pk_mul_f32 v[10:11], v[10:11], s[60:61]
    v_pk_mul_f32 v[12:13], v[12:13], s[60:61]
    v_cvt_pk_bf16_f32 v10, v10, v11
    v_and_b32 v11, 0xffff0000, v10
    v_lshlrev_b32 v10, 16, v10
    v_cvt_pk_bf16_f32 v12, v12, v13
    v_and_b32 v13, 0xffff0000, v12
    v_lshlrev_b32 v12, 16, v12
    v_max_f32 v14, v10, v11
    v_max3_f32 v14, v14, v12, v13
    s_mov_b32 s60, 0x3fb8aa3b
    v_mov_b32 v22, s34
    v_mov_b32 v23, s34
    v_max_f32_dpp v14, v14, v14 quad_perm:[2,3,0,1] row_mask:0xf bank_mask:0xf
    s_nop 1
    v_max_f32_dpp v14, v14, v14 row_ror:4 row_mask:0xf bank_mask:0xf
    s_nop 1
    v_max_f32_dpp v14, v14, v14 row_ror:8 row_mask:0xf bank_mask:0xf
    v_mov_b32 v15, v14
    s_nop 1
    v_permlane16_swap_b32 v15, v14
    v_max_f32 v14, v15, v14
    v_mov_b32 v15, v14
    s_nop 1
    v_permlane32_swap_b32 v15, v14
    v_max_f32 v14, v15, v14
    v_mul_f32 v15, 0xbfb8aa3b, v14
    v_fma_f32 v10, v10, s60, v15
    v_fma_f32 v11, v11, s60, v15
    v_fma_f32 v12, v12, s60, v15
    v_fma_f32 v13, v13, s60, v15
    v_exp_f32 v10, v10
    v_exp_f32 v11, v11
    v_exp_f32 v12, v12
    v_exp_f32 v13, v13
    v_mov_b32 v20, v14
    v_pk_add_f32 v[16:17], v[10:11], v[12:13]
    v_add_f32 v21, v16, v17
    s_lshl_b32 s60, s68, 5
    s_lshl_b32 s61, s3, 4
    s_add_u32 s61, s61, 159104
    v_add_u32 v16, s61, v3
    v_mov_b32 v17, 159232
    v_mov_b32 v18, 1
    s_add_u32 s60, s60, s59
    v_add_f32_dpp v21, v21, v21 quad_perm:[2,3,0,1] row_mask:0xf bank_mask:0xf
    s_nop 1
    v_add_f32_dpp v21, v21, v21 row_ror:4 row_mask:0xf bank_mask:0xf
    s_nop 1
    v_add_f32_dpp v21, v21, v21 row_ror:8 row_mask:0xf bank_mask:0xf
    v_mov_b32 v15, v21
    s_nop 1
    v_permlane16_swap_b32 v15, v21
    v_add_f32 v21, v15, v21
    v_mov_b32 v15, v21
    s_nop 1
    v_permlane32_swap_b32 v15, v21
    v_add_f32 v21, v15, v21
    s_mov_b64 exec, 3
    ds_write_b64 v16, v[20:21]
    s_mov_b64 exec, 1
    ds_add_rtn_u32 v18, v17, v18
    s_mov_b64 exec, -1
    v_and_b32 v16, 0x78, v3
    v_or_b32 v16, 159104, v16
    s_waitcnt lgkmcnt(0)
    v_readfirstlane_b32 s61, v18
    s_cmp_eq_u32 s61, 7
    s_nop 3
    s_cbranch_scc0 .mlc_84
    ds_read_b64 v[18:19], v16
    s_waitcnt lgkmcnt(0)
    v_mov_b32 v20, v18
    s_nop 1
    v_max_f32_dpp v20, v20, v20 quad_perm:[2,3,0,1] row_mask:0xf bank_mask:0xf
    s_nop 1
    v_max_f32_dpp v20, v20, v20 row_ror:4 row_mask:0xf bank_mask:0xf
    s_nop 1
    v_max_f32_dpp v20, v20, v20 row_ror:8 row_mask:0xf bank_mask:0xf
    v_sub_f32 v18, v18, v20
    v_mul_f32 v18, 0x3fb8aa3b, v18
    v_exp_f32 v18, v18
    s_nop 0
    v_mul_f32 v21, v18, v19
    s_nop 1
    v_add_f32_dpp v21, v21, v21 quad_perm:[2,3,0,1] row_mask:0xf bank_mask:0xf
    s_nop 1
    v_add_f32_dpp v21, v21, v21 row_ror:4 row_mask:0xf bank_mask:0xf
    s_nop 1
    v_add_f32_dpp v21, v21, v21 row_ror:8 row_mask:0xf bank_mask:0xf
    s_mov_b64 exec, 3
    buffer_store_dwordx4 v[20:23], v2, s[36:39], s60 offen sc1
    s_mov_b64 exec, -1
.mlc_84:
    s_memrealtime s[8:9]
    s_waitcnt lgkmcnt(0)
    s_sub_u32 s8, s8, s30
    s_cmpk_ge_u32 s8, 1726
    s_cbranch_scc1 .ap_85
    s_waitcnt vmcnt(5)
    s_cmpk_ge_u32 s8, 1626
    s_cbranch_scc1 .ap_85
    s_waitcnt vmcnt(3)
    s_bitcmp1_b64 s[14:15], 44
    s_cbranch_scc0 1
    s_waitcnt vmcnt(2)
    s_cmpk_ge_u32 s8, 1506
    s_cbranch_scc1 .ap_85
    s_waitcnt vmcnt(1)
.ap_85:
    s_add_u32 s63, s69, 163840
    buffer_load_dwordx4 v[208:211], v1, s[44:47], s63 offen nt
    s_cmp_eq_u32 s3, 0
    s_cbranch_scc1 .Lst_m2_0
    s_cmp_eq_u32 s3, 1
    s_cbranch_scc1 .Lst_m2_1
    s_cmp_eq_u32 s3, 2
    s_cbranch_scc1 .Lrt_m2_2
    s_cmp_eq_u32 s3, 3
    s_cbranch_scc1 .Lrt_m2_3
.Lrt_m2_0:
.Lrt_m2_1:
.Lrt_m2_2:
.Lrt_m2_3:
    v_and_b32 v16, 8, v0
    v_and_b32 v17, 1, v0
    v_lshl_add_u32 v16, v17, 2, v16
    v_bfe_u32 v17, v0, 1, 2
    v_add_u32 v16, v16, v17
    v_lshrrev_b32 v17, 4, v0
    v_lshl_add_u32 v16, v16, 2, v17
    v_lshlrev_b32 v7, 1, v16
    v_and_b32 v8, 62, v16
    v_lshlrev_b32 v8, 2, v8
    s_mul_i32 s100, s3, 1152
    s_lshl_b32 s56, s65, 7
    s_add_u32 s100, s100, s56
    s_mov_b32 s52, s4
    s_and_b32 s53, s5, 0xffff
    s_mov_b32 s54, 0x2400
    s_mov_b32 s55, 0x00020000
    buffer_load_ushort v40, v7, s[52:55], s100 offen
    s_lshr_b32 s56, s64, 1
    s_and_b32 s57, s3, 3
    s_cmp_lg_u32 s56, s57
    s_cselect_b64 exec, 0, -1
    s_mov_b32 s48, s16
    s_and_b32 s49, s17, 0xffff
    s_mov_b32 s50, 0x480
    s_mov_b32 s51, 0x00020000
    buffer_load_dwordx2 v[48:49], v3, s[48:51], 0 offen
    buffer_load_dwordx2 v[50:51], v3, s[48:51], 0 offen offset:512
    buffer_load_dword v34, v4, s[48:51], 0 offen
    s_mov_b32 s48, s28
    s_and_b32 s49, s29, 0xffff
    s_mov_b32 s50, 0x2400
    s_mov_b32 s51, 0x00020000
    buffer_load_ushort v39, v7, s[48:51], s100 offen nt
    s_mov_b64 exec, -1
    s_memrealtime s[8:9]
    s_waitcnt vmcnt(13)
    s_waitcnt lgkmcnt(0)
    s_sub_u32 s8, s8, s30
    s_cmpk_ge_u32 s8, 1756
    s_cbranch_scc1 .ap_86
    s_waitcnt vmcnt(10)
    s_cmpk_ge_u32 s8, 1656
    s_cbranch_scc1 .ap_86
    s_waitcnt vmcnt(8)
    s_bitcmp1_b64 s[14:15], 45
    s_cbranch_scc0 1
    s_waitcnt vmcnt(7)
    s_cmpk_ge_u32 s8, 1536
    s_cbranch_scc1 .ap_86
    s_waitcnt vmcnt(6)
.ap_86:
    s_add_u32 s63, s69, 172032
    buffer_load_dwordx4 v[212:215], v1, s[44:47], s63 offen nt
    s_memrealtime s[8:9]
    s_waitcnt vmcnt(13)
    s_waitcnt lgkmcnt(0)
    s_sub_u32 s8, s8, s30
    s_cmpk_ge_u32 s8, 1788
    s_cbranch_scc1 .ap_87
    s_waitcnt vmcnt(10)
    s_cmpk_ge_u32 s8, 1688
    s_cbranch_scc1 .ap_87
    s_waitcnt vmcnt(8)
    s_bitcmp1_b64 s[14:15], 46
    s_cbranch_scc0 1
    s_waitcnt vmcnt(7)
    s_cmpk_ge_u32 s8, 1568
    s_cbranch_scc1 .ap_87
    s_waitcnt vmcnt(6)
.ap_87:
    s_add_u32 s63, s69, 180224
    buffer_load_dwordx4 v[216:219], v1, s[44:47], s63 offen nt
    s_memrealtime s[8:9]
    s_waitcnt vmcnt(13)
    s_branch .Lsk_m1_3
.Lst_m1_3:
    s_branch .Lrt_m1_3
.Lsk_m1_3:
    s_waitcnt lgkmcnt(0)
    s_sub_u32 s8, s8, s30
    s_cmpk_ge_u32 s8, 1820
    s_cbranch_scc1 .ap_88
    s_waitcnt vmcnt(10)
    s_cmpk_ge_u32 s8, 1720
    s_cbranch_scc1 .ap_88
    s_waitcnt vmcnt(8)
    s_bitcmp1_b64 s[14:15], 47
    s_cbranch_scc0 1
    s_waitcnt vmcnt(7)
    s_cmpk_ge_u32 s8, 1600
    s_cbranch_scc1 .ap_88
    s_waitcnt vmcnt(1)
.ap_88:
    s_add_u32 s63, s69, 188416
    buffer_load_dwordx4 v[220:223], v1, s[44:47], s63 offen nt
    s_memrealtime s[8:9]
    s_waitcnt vmcnt(13)
    s_waitcnt lgkmcnt(0)
    s_sub_u32 s8, s8, s30
    s_cmpk_ge_u32 s8, 1852
    s_cbranch_scc1 .ap_89
    s_waitcnt vmcnt(10)
    s_cmpk_ge_u32 s8, 1752
    s_cbranch_scc1 .ap_89
    s_waitcnt vmcnt(8)
    s_bitcmp1_b64 s[14:15], 48
    s_cbranch_scc0 1
    s_waitcnt vmcnt(2)
    s_cmpk_ge_u32 s8, 1632
    s_cbranch_scc1 .ap_89
    s_waitcnt vmcnt(1)
.ap_89:
    s_add_u32 s63, s69, 262144
    buffer_load_dwordx4 v[224:227], v1, s[44:47], s63 offen nt
    s_memrealtime s[8:9]
    s_waitcnt vmcnt(13)
    s_waitcnt lgkmcnt(0)
    s_sub_u32 s8, s8, s30
    s_cmpk_ge_u32 s8, 1884
    s_cbranch_scc1 .ap_90
    s_waitcnt vmcnt(10)
    s_cmpk_ge_u32 s8, 1784
    s_cbranch_scc1 .ap_90
    s_waitcnt vmcnt(3)
    s_bitcmp1_b64 s[14:15], 49
    s_cbranch_scc0 1
    s_waitcnt vmcnt(2)
    s_cmpk_ge_u32 s8, 1664
    s_cbranch_scc1 .ap_90
    s_waitcnt vmcnt(1)
.ap_90:
    s_add_u32 s63, s69, 270336
    buffer_load_dwordx4 v[228:231], v1, s[44:47], s63 offen nt
    s_memrealtime s[8:9]
    s_waitcnt vmcnt(13)
    s_waitcnt lgkmcnt(0)
    s_sub_u32 s8, s8, s30
    s_cmpk_ge_u32 s8, 1916
    s_cbranch_scc1 .ap_91
    s_waitcnt vmcnt(10)
    s_cmpk_ge_u32 s8, 1816
    s_cbranch_scc1 .ap_91
    s_waitcnt vmcnt(3)
    s_bitcmp1_b64 s[14:15], 50
    s_cbranch_scc0 1
    s_waitcnt vmcnt(2)
    s_cmpk_ge_u32 s8, 1696
    s_cbranch_scc1 .ap_91
    s_waitcnt vmcnt(1)
.ap_91:
    s_add_u32 s63, s69, 278528
    buffer_load_dwordx4 v[232:235], v1, s[44:47], s63 offen nt
    s_memrealtime s[8:9]
    s_waitcnt vmcnt(13)
    s_waitcnt lgkmcnt(0)
    s_sub_u32 s8, s8, s30
    s_cmpk_ge_u32 s8, 1948
    s_cbranch_scc1 .ap_92
    s_waitcnt vmcnt(5)
    s_cmpk_ge_u32 s8, 1848
    s_cbranch_scc1 .ap_92
    s_waitcnt vmcnt(3)
    s_bitcmp1_b64 s[14:15], 51
    s_cbranch_scc0 1
    s_waitcnt vmcnt(2)
    s_cmpk_ge_u32 s8, 1728
    s_cbranch_scc1 .ap_92
    s_waitcnt vmcnt(1)
.ap_92:
    s_add_u32 s63, s69, 286720
    buffer_load_dwordx4 v[236:239], v1, s[44:47], s63 offen nt
    s_memrealtime s[8:9]
    s_waitcnt vmcnt(13)
    s_waitcnt lgkmcnt(0)
    s_sub_u32 s8, s8, s30
    s_cmpk_ge_u32 s8, 1980
    s_cbranch_scc1 .ap_93
    s_waitcnt vmcnt(5)
    s_cmpk_ge_u32 s8, 1880
    s_cbranch_scc1 .ap_93
    s_waitcnt vmcnt(3)
    s_bitcmp1_b64 s[14:15], 52
    s_cbranch_scc0 1
    s_waitcnt vmcnt(2)
    s_cmpk_ge_u32 s8, 1760
    s_cbranch_scc1 .ap_93
    s_waitcnt vmcnt(1)
.ap_93:
    s_add_u32 s63, s69, 294912
    buffer_load_dwordx4 v[240:243], v1, s[44:47], s63 offen nt
    s_memrealtime s[8:9]
    s_waitcnt vmcnt(13)
    s_waitcnt lgkmcnt(0)
    s_sub_u32 s8, s8, s30
    s_cmpk_ge_u32 s8, 2012
    s_cbranch_scc1 .ap_94
    s_waitcnt vmcnt(5)
    s_cmpk_ge_u32 s8, 1912
    s_cbranch_scc1 .ap_94
    s_waitcnt vmcnt(3)
    s_bitcmp1_b64 s[14:15], 53
    s_cbranch_scc0 1
    s_waitcnt vmcnt(2)
    s_cmpk_ge_u32 s8, 1792
    s_cbranch_scc1 .ap_94
    s_waitcnt vmcnt(1)
.ap_94:
    s_add_u32 s63, s69, 303104
    buffer_load_dwordx4 v[244:247], v1, s[44:47], s63 offen nt
    s_and_b32 s0, s0, 0xffffff80
    s_sub_u32 s0, s0, 1024
    buffer_load_dword v28, v4, s[36:39], s0 offen sc1
    buffer_load_dwordx4 v[24:27], v9, s[36:39], s59 offen offset:0 sc1
    s_memrealtime s[8:9]
    s_waitcnt vmcnt(9)
    s_waitcnt lgkmcnt(0)
    s_sub_u32 s8, s8, s30
    s_cmpk_ge_u32 s8, 2044
    s_cbranch_scc1 .ap_95
    s_waitcnt vmcnt(6)
    s_cmpk_ge_u32 s8, 1944
    s_cbranch_scc1 .ap_95
    s_waitcnt vmcnt(4)
    s_bitcmp1_b64 s[14:15], 54
    s_cbranch_scc0 1
    s_waitcnt vmcnt(3)
    s_cmpk_ge_u32 s8, 1824
    s_cbranch_scc1 .ap_95
    s_waitcnt vmcnt(2)
.ap_95:
    s_add_u32 s63, s69, 311296
    buffer_load_dwordx4 v[248:251], v1, s[44:47], s63 offen nt
    s_memrealtime s[8:9]
    s_waitcnt vmcnt(9)
    s_waitcnt lgkmcnt(0)
    s_sub_u32 s8, s8, s30
    s_cmpk_ge_u32 s8, 2076
    s_cbranch_scc1 .ap_96
    s_waitcnt vmcnt(6)
    s_cmpk_ge_u32 s8, 1976
    s_cbranch_scc1 .ap_96
    s_waitcnt vmcnt(4)
    s_bitcmp1_b64 s[14:15], 55
    s_cbranch_scc0 1
    s_waitcnt vmcnt(3)
    s_cmpk_ge_u32 s8, 1856
    s_cbranch_scc1 .ap_96
    s_waitcnt vmcnt(1)
.ap_96:
    s_add_u32 s63, s69, 319488
    buffer_load_dwordx4 v[252:255], v1, s[44:47], s63 offen nt
    s_memrealtime s[8:9]
    s_waitcnt vmcnt(9)
    s_waitcnt lgkmcnt(0)
    s_sub_u32 s8, s8, s30
    s_cmpk_ge_u32 s8, 2108
    s_cbranch_scc1 .ap_97
    s_waitcnt vmcnt(6)
    s_cmpk_ge_u32 s8, 2008
    s_cbranch_scc1 .ap_97
    s_waitcnt vmcnt(4)
    s_bitcmp1_b64 s[14:15], 56
    s_cbranch_scc0 1
    s_waitcnt vmcnt(2)
    s_cmpk_ge_u32 s8, 1888
    s_cbranch_scc1 .ap_97
    s_branch .Lsk_m1_4
.Lst_m1_4:
    s_branch .Lrt_m1_4
.Lsk_m1_4:
    s_waitcnt vmcnt(1)
.ap_97:
    s_add_u32 s63, s69, 393216
    buffer_load_dwordx4 v[36:39], v1, s[44:47], s63 offen nt
    s_memrealtime s[8:9]
    s_waitcnt vmcnt(9)
    s_waitcnt lgkmcnt(0)
    s_sub_u32 s8, s8, s30
    s_cmpk_ge_u32 s8, 2140
    s_cbranch_scc1 .ap_98
    s_waitcnt vmcnt(6)
    s_cmpk_ge_u32 s8, 2040
    s_cbranch_scc1 .ap_98
    s_waitcnt vmcnt(3)
    s_bitcmp1_b64 s[14:15], 57
    s_cbranch_scc0 1
    s_waitcnt vmcnt(2)
    s_cmpk_ge_u32 s8, 1920
    s_cbranch_scc1 .ap_98
    s_waitcnt vmcnt(1)
.ap_98:
    s_add_u32 s63, s69, 401408
    buffer_load_dwordx4 v[44:47], v1, s[44:47], s63 offen nt
    s_memrealtime s[8:9]
    s_waitcnt vmcnt(9)
    s_waitcnt lgkmcnt(0)
    s_sub_u32 s8, s8, s30
    s_cmpk_ge_u32 s8, 2172
    s_cbranch_scc1 .ap_99
    s_waitcnt vmcnt(6)
    s_cmpk_ge_u32 s8, 2072
    s_cbranch_scc1 .ap_99
    s_waitcnt vmcnt(3)
    s_bitcmp1_b64 s[14:15], 58
    s_cbranch_scc0 1
    s_waitcnt vmcnt(2)
    s_cmpk_ge_u32 s8, 1952
    s_cbranch_scc1 .ap_99
    s_waitcnt vmcnt(1)
.ap_99:
    s_add_u32 s63, s69, 409600
    buffer_load_dwordx4 v[52:55], v1, s[44:47], s63 offen nt
    s_waitcnt vmcnt(5)
    s_branch .gpc_101
.gp_100:
    buffer_load_dwordx4 v[24:27], v9, s[36:39], s59 offen offset:0 sc1
    s_waitcnt vmcnt(0)
.gpc_101:
    v_cmp_eq_u32 vcc, s34, v26
    s_cmp_eq_u64 vcc, -1
    s_nop 3
    s_cbranch_scc1 .gpd_102
    s_sub_u32 s35, s35, 1
    s_cbranch_scc1 .Lexit
    s_sleep 1
    s_branch .gp_100
.gpd_102:
    v_cmp_eq_u32 vcc, s1, v28
    s_cmp_eq_u64 vcc, -1
    s_cselect_b32 s0, 0x800000, 0
    v_mov_b32 v16, v24
    s_nop 1
    v_max_f32_dpp v16, v16, v16 row_ror:4 row_mask:0xf bank_mask:0xf
    v_sub_f32 v17, v24, v16
    v_sub_f32 v18, v14, v16
    v_mul_f32 v17, 0x3fb8aa3b, v17
    v_mul_f32 v18, 0x3fb8aa3b, v18
    v_exp_f32 v17, v17
    v_exp_f32 v18, v18
    v_mul_f32 v17, v17, v25
    s_nop 1
    v_add_f32_dpp v17, v17, v17 row_ror:4 row_mask:0xf bank_mask:0xf
    v_rcp_f32 v19, v17
    s_nop 0
    v_fma_f32 v15, -v17, v19, 1.0
    v_fma_f32 v19, v15, v19, v19
    v_mul_f32 v18, v18, v19
    v_mul_f32 v10, v10, v18
    v_mul_f32 v11, v11, v18
    v_mul_f32 v12, v12, v18
    v_mul_f32 v13, v13, v18
    v_mov_b32_dpp v112, v10 quad_perm:[2,3,0,1] row_mask:0xf bank_mask:0xf
    v_mov_b32_dpp v113, v11 quad_perm:[2,3,0,1] row_mask:0xf bank_mask:0xf
    v_mov_b32_dpp v114, v12 quad_perm:[2,3,0,1] row_mask:0xf bank_mask:0xf
    v_mov_b32_dpp v115, v13 quad_perm:[2,3,0,1] row_mask:0xf bank_mask:0xf
    v_cvt_pk_bf16_f32 v96, v10, v112
    v_cvt_pk_bf16_f32 v100, v11, v113
    v_cvt_pk_bf16_f32 v104, v12, v114
    v_cvt_pk_bf16_f32 v108, v13, v115
    v_mov_b32_dpp v97, v96 row_ror:12 row_mask:0xf bank_mask:0xf
    v_mov_b32_dpp v101, v100 row_ror:12 row_mask:0xf bank_mask:0xf
    v_mov_b32_dpp v105, v104 row_ror:12 row_mask:0xf bank_mask:0xf
    v_mov_b32_dpp v109, v108 row_ror:12 row_mask:0xf bank_mask:0xf
    v_mov_b32_dpp v98, v96 row_ror:8 row_mask:0xf bank_mask:0xf
    v_mov_b32_dpp v102, v100 row_ror:8 row_mask:0xf bank_mask:0xf
    v_mov_b32_dpp v106, v104 row_ror:8 row_mask:0xf bank_mask:0xf
    v_mov_b32_dpp v110, v108 row_ror:8 row_mask:0xf bank_mask:0xf
    v_mov_b32_dpp v99, v96 row_ror:4 row_mask:0xf bank_mask:0xf
    v_mov_b32_dpp v103, v100 row_ror:4 row_mask:0xf bank_mask:0xf
    v_mov_b32_dpp v107, v104 row_ror:4 row_mask:0xf bank_mask:0xf
    v_mov_b32_dpp v111, v108 row_ror:4 row_mask:0xf bank_mask:0xf
    s_lshl_b32 s60, s3, 10
    s_add_u32 s60, s60, 147456
    v_lshlrev_b32 v10, 5, v0
    v_add_u32 v10, s60, v10
    s_memrealtime s[8:9]
    s_waitcnt lgkmcnt(0)
    s_sub_u32 s8, s8, s30
    s_cmpk_ge_u32 s8, 2204
    s_cbranch_scc1 .ap_103
    s_waitcnt vmcnt(5)
    s_cmpk_ge_u32 s8, 2104
    s_cbranch_scc1 .ap_103
    s_waitcnt vmcnt(3)
    s_bitcmp1_b64 s[14:15], 59
    s_cbranch_scc0 1
    s_waitcnt vmcnt(2)
    s_cmpk_ge_u32 s8, 1984
    s_cbranch_scc1 .ap_103
    s_waitcnt vmcnt(1)
.ap_103:
    s_add_u32 s63, s69, 417792
    buffer_load_dwordx4 v[60:63], v1, s[44:47], s63 offen nt
    v_perm_b32 v112, v164, v160, s94
    v_perm_b32 v113, v172, v168, s94
    v_perm_b32 v114, v180, v176, s94
    v_perm_b32 v115, v188, v184, s94
    s_nop 1
    v_mfma_f32_16x16x32_bf16 v[128:131], v[96:99], v[112:115], 0
    v_perm_b32 v116, v164, v160, s95
    v_perm_b32 v117, v172, v168, s95
    v_perm_b32 v118, v180, v176, s95
    v_perm_b32 v119, v188, v184, s95
    s_nop 1
    v_mfma_f32_16x16x32_bf16 v[132:135], v[96:99], v[116:119], 0
    v_perm_b32 v120, v165, v161, s94
    v_perm_b32 v121, v173, v169, s94
    v_perm_b32 v122, v181, v177, s94
    v_perm_b32 v123, v189, v185, s94
    s_nop 1
    v_mfma_f32_16x16x32_bf16 v[136:139], v[96:99], v[120:123], 0
    v_perm_b32 v124, v165, v161, s95
    v_perm_b32 v125, v173, v169, s95
    v_perm_b32 v126, v181, v177, s95
    v_perm_b32 v127, v189, v185, s95
    s_nop 1
    v_mfma_f32_16x16x32_bf16 v[140:143], v[96:99], v[124:127], 0
    v_perm_b32 v112, v166, v162, s94
    v_perm_b32 v113, v174, v170, s94
    v_perm_b32 v114, v182, v178, s94
    v_perm_b32 v115, v190, v186, s94
    s_nop 1
    v_mfma_f32_16x16x32_bf16 v[144:147], v[96:99], v[112:115], 0
    v_perm_b32 v116, v166, v162, s95
    v_perm_b32 v117, v174, v170, s95
    v_perm_b32 v118, v182, v178, s95
    v_perm_b32 v119, v190, v186, s95
    s_nop 1
    v_mfma_f32_16x16x32_bf16 v[148:151], v[96:99], v[116:119], 0
    v_perm_b32 v120, v167, v163, s94
    v_perm_b32 v121, v175, v171, s94
    v_perm_b32 v122, v183, v179, s94
    v_perm_b32 v123, v191, v187, s94
    s_nop 1
    v_mfma_f32_16x16x32_bf16 v[152:155], v[96:99], v[120:123], 0
    v_perm_b32 v124, v167, v163, s95
    v_perm_b32 v125, v175, v171, s95
    v_perm_b32 v126, v183, v179, s95
    v_perm_b32 v127, v191, v187, s95
    s_nop 1
    v_mfma_f32_16x16x32_bf16 v[156:159], v[96:99], v[124:127], 0
    s_memrealtime s[8:9]
    s_waitcnt lgkmcnt(0)
    s_sub_u32 s8, s8, s30
    s_cmpk_ge_u32 s8, 2236
    s_nop 3
    s_cbranch_scc1 .ap_104
    s_waitcnt vmcnt(5)
    s_cmpk_ge_u32 s8, 2136
    s_cbranch_scc1 .ap_104
    s_waitcnt vmcnt(3)
    s_bitcmp1_b64 s[14:15], 60
    s_cbranch_scc0 1
    s_waitcnt vmcnt(2)
    s_cmpk_ge_u32 s8, 2016
    s_cbranch_scc1 .ap_104
    s_waitcnt vmcnt(1)
.ap_104:
    s_add_u32 s63, s69, 425984
    buffer_load_dwordx4 v[68:71], v1, s[44:47], s63 offen nt
    v_perm_b32 v112, v196, v192, s94
    s_branch .Lsk_m1_5
.Lst_m1_5:
    s_branch .Lrt_m1_5
.Lsk_m1_5:
    v_perm_b32 v113, v204, v200, s94
    v_perm_b32 v114, v212, v208, s94
    v_perm_b32 v115, v220, v216, s94
    s_nop 1
    v_mfma_f32_16x16x32_bf16 v[128:131], v[100:103], v[112:115], v[128:131]
    v_perm_b32 v116, v196, v192, s95
    v_perm_b32 v117, v204, v200, s95
    v_perm_b32 v118, v212, v208, s95
    v_perm_b32 v119, v220, v216, s95
    s_nop 1
    v_mfma_f32_16x16x32_bf16 v[132:135], v[100:103], v[116:119], v[132:135]
    v_perm_b32 v120, v197, v193, s94
    v_perm_b32 v121, v205, v201, s94
    v_perm_b32 v122, v213, v209, s94
    v_perm_b32 v123, v221, v217, s94
    s_nop 1
    v_mfma_f32_16x16x32_bf16 v[136:139], v[100:103], v[120:123], v[136:139]
    v_perm_b32 v124, v197, v193, s95
    v_perm_b32 v125, v205, v201, s95
    v_perm_b32 v126, v213, v209, s95
    v_perm_b32 v127, v221, v217, s95
    s_nop 1
    v_mfma_f32_16x16x32_bf16 v[140:143], v[100:103], v[124:127], v[140:143]
    v_perm_b32 v112, v198, v194, s94
    v_perm_b32 v113, v206, v202, s94
    v_perm_b32 v114, v214, v210, s94
    v_perm_b32 v115, v222, v218, s94
    s_nop 1
    v_mfma_f32_16x16x32_bf16 v[144:147], v[100:103], v[112:115], v[144:147]
    v_perm_b32 v116, v198, v194, s95
    v_perm_b32 v117, v206, v202, s95
    v_perm_b32 v118, v214, v210, s95
    v_perm_b32 v119, v222, v218, s95
    s_nop 1
    v_mfma_f32_16x16x32_bf16 v[148:151], v[100:103], v[116:119], v[148:151]
    v_perm_b32 v120, v199, v195, s94
    v_perm_b32 v121, v207, v203, s94
    v_perm_b32 v122, v215, v211, s94
    v_perm_b32 v123, v223, v219, s94
    s_nop 1
    v_mfma_f32_16x16x32_bf16 v[152:155], v[100:103], v[120:123], v[152:155]
    v_perm_b32 v124, v199, v195, s95
    v_perm_b32 v125, v207, v203, s95
    v_perm_b32 v126, v215, v211, s95
    v_perm_b32 v127, v223, v219, s95
    s_nop 1
    v_mfma_f32_16x16x32_bf16 v[156:159], v[100:103], v[124:127], v[156:159]
    s_memrealtime s[8:9]
    s_waitcnt lgkmcnt(0)
    s_sub_u32 s8, s8, s30
    s_cmpk_ge_u32 s8, 2268
    s_nop 3
    s_cbranch_scc1 .ap_105
    s_waitcnt vmcnt(5)
    s_cmpk_ge_u32 s8, 2168
    s_cbranch_scc1 .ap_105
    s_waitcnt vmcnt(3)
    s_bitcmp1_b64 s[14:15], 61
    s_cbranch_scc0 1
    s_waitcnt vmcnt(2)
    s_cmpk_ge_u32 s8, 2048
    s_cbranch_scc1 .ap_105
    s_waitcnt vmcnt(1)
.ap_105:
    s_add_u32 s63, s69, 434176
    buffer_load_dwordx4 v[76:79], v1, s[44:47], s63 offen nt
    s_waitcnt vmcnt(6)
    v_perm_b32 v112, v228, v224, s94
    v_perm_b32 v113, v236, v232, s94
    v_perm_b32 v114, v244, v240, s94
    v_perm_b32 v115, v252, v248, s94
    s_nop 1
    v_mfma_f32_16x16x32_bf16 v[128:131], v[104:107], v[112:115], v[128:131]
    v_perm_b32 v116, v228, v224, s95
    v_perm_b32 v117, v236, v232, s95
    v_perm_b32 v118, v244, v240, s95
    v_perm_b32 v119, v252, v248, s95
    s_nop 1
    v_mfma_f32_16x16x32_bf16 v[132:135], v[104:107], v[116:119], v[132:135]
    v_perm_b32 v120, v229, v225, s94
    v_perm_b32 v121, v237, v233, s94
    v_perm_b32 v122, v245, v241, s94
    v_perm_b32 v123, v253, v249, s94
    s_nop 1
    v_mfma_f32_16x16x32_bf16 v[136:139], v[104:107], v[120:123], v[136:139]
    v_perm_b32 v124, v229, v225, s95
    v_perm_b32 v125, v237, v233, s95
    v_perm_b32 v126, v245, v241, s95
    v_perm_b32 v127, v253, v249, s95
    s_nop 1
    v_mfma_f32_16x16x32_bf16 v[140:143], v[104:107], v[124:127], v[140:143]
    v_perm_b32 v112, v230, v226, s94
    v_perm_b32 v113, v238, v234, s94
    v_perm_b32 v114, v246, v242, s94
    v_perm_b32 v115, v254, v250, s94
    s_nop 1
    v_mfma_f32_16x16x32_bf16 v[144:147], v[104:107], v[112:115], v[144:147]
    v_perm_b32 v116, v230, v226, s95
    v_perm_b32 v117, v238, v234, s95
    v_perm_b32 v118, v246, v242, s95
    v_perm_b32 v119, v254, v250, s95
    s_nop 1
    v_mfma_f32_16x16x32_bf16 v[148:151], v[104:107], v[116:119], v[148:151]
    v_perm_b32 v120, v231, v227, s94
    v_perm_b32 v121, v239, v235, s94
    v_perm_b32 v122, v247, v243, s94
    v_perm_b32 v123, v255, v251, s94
    s_nop 1
    v_mfma_f32_16x16x32_bf16 v[152:155], v[104:107], v[120:123], v[152:155]
    v_perm_b32 v124, v231, v227, s95
    v_perm_b32 v125, v239, v235, s95
    v_perm_b32 v126, v247, v243, s95
    v_perm_b32 v127, v255, v251, s95
    s_nop 1
    v_mfma_f32_16x16x32_bf16 v[156:159], v[104:107], v[124:127], v[156:159]
    s_memrealtime s[8:9]
    s_waitcnt lgkmcnt(0)
    s_sub_u32 s8, s8, s30
    s_cmpk_ge_u32 s8, 2300
    s_nop 3
    s_cbranch_scc1 .ap_106
    s_waitcnt vmcnt(5)
    s_cmpk_ge_u32 s8, 2200
    s_cbranch_scc1 .ap_106
    s_waitcnt vmcnt(3)
    s_bitcmp1_b64 s[14:15], 62
    s_cbranch_scc0 1
    s_waitcnt vmcnt(2)
    s_cmpk_ge_u32 s8, 2080
    s_cbranch_scc1 .ap_106
    s_waitcnt vmcnt(1)
.ap_106:
    s_add_u32 s63, s69, 442368
    buffer_load_dwordx4 v[84:87], v1, s[44:47], s63 offen nt
    s_memrealtime s[8:9]
    s_waitcnt lgkmcnt(0)
    s_sub_u32 s8, s8, s30
    s_cmpk_ge_u32 s8, 2332
    s_cbranch_scc1 .ap_107
    s_waitcnt vmcnt(5)
    s_cmpk_ge_u32 s8, 2232
    s_cbranch_scc1 .ap_107
    s_waitcnt vmcnt(3)
    s_bitcmp1_b64 s[14:15], 63
    s_cbranch_scc0 1
    s_waitcnt vmcnt(2)
    s_cmpk_ge_u32 s8, 2112
    s_cbranch_scc1 .ap_107
    s_waitcnt vmcnt(1)
.ap_107:
    s_add_u32 s63, s69, 450560
    buffer_load_dwordx4 v[92:95], v1, s[44:47], s63 offen nt
    s_setprio 0
    s_waitcnt vmcnt(6)
    v_perm_b32 v160, v44, v36, s94
    v_perm_b32 v164, v44, v36, s95
    v_perm_b32 v168, v45, v37, s94
    v_perm_b32 v172, v45, v37, s95
    v_perm_b32 v176, v46, v38, s94
    v_perm_b32 v180, v46, v38, s95
    v_perm_b32 v184, v47, v39, s94
    v_perm_b32 v188, v47, v39, s95
    s_waitcnt vmcnt(4)
    v_perm_b32 v161, v60, v52, s94
    v_perm_b32 v165, v60, v52, s95
    v_perm_b32 v169, v61, v53, s94
    v_perm_b32 v173, v61, v53, s95
    v_perm_b32 v177, v62, v54, s94
    v_perm_b32 v181, v62, v54, s95
    v_perm_b32 v185, v63, v55, s94
    v_perm_b32 v189, v63, v55, s95
    s_branch .Lsk_m1_6
.Lst_m1_6:
    s_branch .Lrt_m1_6
.Lsk_m1_6:
    s_waitcnt vmcnt(2)
    v_perm_b32 v162, v76, v68, s94
    v_perm_b32 v166, v76, v68, s95
    v_perm_b32 v170, v77, v69, s94
    v_perm_b32 v174, v77, v69, s95
    v_perm_b32 v178, v78, v70, s94
    v_perm_b32 v182, v78, v70, s95
    v_perm_b32 v186, v79, v71, s94
    v_perm_b32 v190, v79, v71, s95
    s_waitcnt vmcnt(0)
    v_perm_b32 v163, v92, v84, s94
    v_perm_b32 v167, v92, v84, s95
    v_perm_b32 v171, v93, v85, s94
    v_mfma_f32_16x16x32_bf16 v[128:131], v[108:111], v[160:163], v[128:131]
    v_perm_b32 v175, v93, v85, s95
    v_mfma_f32_16x16x32_bf16 v[132:135], v[108:111], v[164:167], v[132:135]
    v_perm_b32 v179, v94, v86, s94
    v_mfma_f32_16x16x32_bf16 v[136:139], v[108:111], v[168:171], v[136:139]
    v_perm_b32 v183, v94, v86, s95
    v_mfma_f32_16x16x32_bf16 v[140:143], v[108:111], v[172:175], v[140:143]
    v_perm_b32 v187, v95, v87, s94
    v_mfma_f32_16x16x32_bf16 v[144:147], v[108:111], v[176:179], v[144:147]
    v_perm_b32 v191, v95, v87, s95
    v_mfma_f32_16x16x32_bf16 v[148:151], v[108:111], v[180:183], v[148:151]
    v_mfma_f32_16x16x32_bf16 v[152:155], v[108:111], v[184:187], v[152:155]
    v_mfma_f32_16x16x32_bf16 v[156:159], v[108:111], v[188:191], v[156:159]
    s_mov_b64 exec, 0xffff
    ds_write2_b32 v10, v128, v129 offset0:0 offset1:128
    ds_write2_b32 v10, v132, v133 offset0:1 offset1:129
    ds_write2_b32 v10, v136, v137 offset0:2 offset1:130
    ds_write2_b32 v10, v140, v141 offset0:3 offset1:131
    ds_write2_b32 v10, v144, v145 offset0:4 offset1:132
    ds_write2_b32 v10, v148, v149 offset0:5 offset1:133
    ds_write2_b32 v10, v152, v153 offset0:6 offset1:134
    ds_write2_b32 v10, v156, v157 offset0:7 offset1:135
    s_mov_b64 exec, -1
    s_waitcnt lgkmcnt(0)
    s_barrier
    s_cmp_lg_u32 s3, 7
    s_cbranch_scc1 .opub_108
    v_add_u32 v10, 147456, v2
    ds_read_b128 v[196:199], v10 offset:0
    ds_read_b128 v[200:203], v10 offset:1024
    ds_read_b128 v[204:207], v10 offset:2048
    ds_read_b128 v[208:211], v10 offset:3072
    ds_read_b128 v[212:215], v10 offset:4096
    ds_read_b128 v[216:219], v10 offset:5120
    ds_read_b128 v[220:223], v10 offset:6144
    ds_read_b128 v[224:227], v10 offset:7168
    v_lshrrev_b32 v11, 5, v0
    v_lshlrev_b32 v11, 13, v11
    v_and_b32 v12, 31, v0
    v_lshl_add_u32 v11, v12, 4, v11
    s_lshl4_add_u32 s56, s67, s66
    s_lshl1_add_u32 s56, s56, s68
    s_lshl_b32 s56, s56, 9
    s_add_u32 s56, s56, 0xa0000
    s_mov_b32 s60, 0x07060503
    s_mov_b32 s61, 0x07060502
    s_mov_b32 s62, 0x07060501
    v_mov_b32 v15, s34
    s_waitcnt lgkmcnt(6)
    v_pk_add_f32 v[196:197], v[196:197], v[200:201]
    v_pk_add_f32 v[198:199], v[198:199], v[202:203]
    s_waitcnt lgkmcnt(5)
    v_pk_add_f32 v[196:197], v[196:197], v[204:205]
    v_pk_add_f32 v[198:199], v[198:199], v[206:207]
    s_waitcnt lgkmcnt(4)
    v_pk_add_f32 v[196:197], v[196:197], v[208:209]
    v_pk_add_f32 v[198:199], v[198:199], v[210:211]
    s_waitcnt lgkmcnt(3)
    v_pk_add_f32 v[196:197], v[196:197], v[212:213]
    v_pk_add_f32 v[198:199], v[198:199], v[214:215]
    s_waitcnt lgkmcnt(2)
    v_pk_add_f32 v[196:197], v[196:197], v[216:217]
    v_pk_add_f32 v[198:199], v[198:199], v[218:219]
    s_waitcnt lgkmcnt(1)
    v_pk_add_f32 v[196:197], v[196:197], v[220:221]
    v_pk_add_f32 v[198:199], v[198:199], v[222:223]
    s_waitcnt lgkmcnt(0)
    v_pk_add_f32 v[196:197], v[196:197], v[224:225]
    v_pk_add_f32 v[198:199], v[198:199], v[226:227]
    v_perm_b32 v12, v196, v199, s60
    v_perm_b32 v13, v197, v199, s61
    v_perm_b32 v14, v198, v199, s62
    s_add_u32 s57, s56, 0x800000
    buffer_store_dwordx4 v[12:15], v11, s[36:39], s57 offen
    s_cmp_lg_u32 s0, 0
    s_nop 0
    s_cbranch_scc1 .nosl_109
    buffer_store_dwordx4 v[12:15], v11, s[36:39], s56 offen sc1
.nosl_109:
.opub_108:
    s_and_b32 s58, s64, 0
    s_mul_i32 s58, s58, 18432
    s_mul_i32 s59, s3, 2304
    s_add_u32 s58, s58, s59
    s_add_u32 s62, s58, 0x37000
    s_add_u32 s63, s58, 0x49000
    s_mul_i32 s101, s64, 18432
    s_add_u32 s101, s101, s59
    s_add_u32 s101, s101, 0x170000
    v_and_b32 v16, 8, v0
    v_and_b32 v17, 1, v0
    v_lshl_add_u32 v16, v17, 2, v16
    v_bfe_u32 v17, v0, 1, 2
    v_add_u32 v16, v16, v17
    v_lshlrev_b32 v9, 4, v16
    s_lshl_b32 s56, s65, 8
    s_add_u32 s58, s58, s56
    s_add_u32 s58, s58, 0x25000
    s_add_u32 s99, s101, s56
    s_lshr_b32 s56, s64, 1
    s_and_b32 s57, s3, 3
    s_cmp_lg_u32 s56, s57
    s_cbranch_scc1 .Lr_ga
    s_add_u32 s59, s58, 73728
    s_add_u32 s60, s58, 147456
    s_add_u32 s61, s58, 221184
.gp_110:
    buffer_load_dwordx4 v[56:59], v2, s[36:39], s62 offen offset:0 sc1
    buffer_load_dwordx4 v[60:63], v2, s[36:39], s62 offen offset:1024 sc1
    buffer_load_dwordx2 v[64:65], v5, s[36:39], s62 offen offset:0 sc1
    buffer_load_dwordx4 v[66:69], v2, s[36:39], s63 offen offset:0 sc1
    buffer_load_dwordx4 v[70:73], v2, s[36:39], s63 offen offset:1024 sc1
    buffer_load_dwordx2 v[74:75], v5, s[36:39], s63 offen offset:0 sc1
    buffer_load_dwordx2 v[76:77], v8, s[36:39], s59 offen offset:0 sc1
    buffer_load_dwordx2 v[78:79], v8, s[36:39], s60 offen offset:0 sc1
    buffer_load_dwordx2 v[80:81], v8, s[36:39], s61 offen offset:0 sc1
    buffer_load_dwordx2 v[42:43], v8, s[36:39], s58 offen offset:0 sc1
    s_waitcnt vmcnt(0)
.gpc_111:
    v_min_u32 v24, v57, v59
    v_max_u32 v25, v57, v59
    v_min3_u32 v24, v24, v61, v63
    v_max3_u32 v25, v25, v61, v63
    v_min3_u32 v24, v24, v65, v67
    v_max3_u32 v25, v25, v65, v67
    v_min3_u32 v24, v24, v69, v71
    v_max3_u32 v25, v25, v69, v71
    v_min3_u32 v24, v24, v73, v75
    v_max3_u32 v25, v25, v73, v75
    v_min3_u32 v24, v24, v77, v79
    v_max3_u32 v25, v25, v77, v79
    v_min3_u32 v24, v24, v81, v43
    v_max3_u32 v25, v25, v81, v43
    v_cmp_eq_u32 vcc, s34, v24
    v_cmp_eq_u32 s[56:57], s34, v25
    s_and_b64 vcc, vcc, s[56:57]
    s_cmp_eq_u64 vcc, -1
    s_nop 2
    s_cbranch_scc1 .gpd_112
    s_sub_u32 s35, s35, 1
    s_cbranch_scc1 .Lexit
    s_sleep 2
    s_branch .gp_110
.gpd_112:
    v_and_b32 v57, 0xffff0000, v56
    v_lshlrev_b32 v56, 16, v56
    v_and_b32 v67, 0xffff0000, v66
    v_lshlrev_b32 v66, 16, v66
    v_and_b32 v59, 0xffff0000, v58
    v_lshlrev_b32 v58, 16, v58
    v_and_b32 v69, 0xffff0000, v68
    v_lshlrev_b32 v68, 16, v68
    v_and_b32 v61, 0xffff0000, v60
    s_branch .Lsk_m1_7
.Lst_m1_7:
    s_branch .Lrt_m1_7
.Lsk_m1_7:
    v_lshlrev_b32 v60, 16, v60
    v_and_b32 v71, 0xffff0000, v70
    v_lshlrev_b32 v70, 16, v70
    v_and_b32 v63, 0xffff0000, v62
    v_lshlrev_b32 v62, 16, v62
    v_and_b32 v73, 0xffff0000, v72
    v_lshlrev_b32 v72, 16, v72
    v_and_b32 v65, 0xffff0000, v64
    v_lshlrev_b32 v64, 16, v64
    v_and_b32 v75, 0xffff0000, v74
    v_lshlrev_b32 v74, 16, v74
    v_lshlrev_b32 v77, 16, v76
    v_and_b32 v76, 0xffff0000, v76
    s_mov_b32 vcc_lo, 0xffff0000
    s_mov_b32 vcc_hi, 0xffff0000
    v_cndmask_b32 v77, v77, v76, vcc
    v_lshlrev_b32 v79, 16, v78
    v_and_b32 v78, 0xffff0000, v78
    s_mov_b32 vcc_lo, 0xffff0000
    s_mov_b32 vcc_hi, 0xffff0000
    v_cndmask_b32 v79, v79, v78, vcc
    v_lshlrev_b32 v81, 16, v80
    v_and_b32 v80, 0xffff0000, v80
    s_mov_b32 vcc_lo, 0xffff0000
    s_mov_b32 vcc_hi, 0xffff0000
    v_cndmask_b32 v81, v81, v80, vcc
    s_nop 1
    s_branch .Lr_ga2
.Lr_ga:
.gp_113:
    buffer_load_dwordx2 v[42:43], v8, s[36:39], s58 offen offset:0 sc1
    s_waitcnt vmcnt(0)
.gpc_114:
    v_cmp_eq_u32 vcc, s34, v43
    s_cmp_eq_u64 vcc, -1
    s_nop 3
    s_cbranch_scc1 .gpd_115
    s_sub_u32 s35, s35, 1
    s_cbranch_scc1 .Lexit
    s_sleep 2
    s_branch .gp_113
.gpd_115:
.Lr_ga2:
    v_lshlrev_b32 v40, 16, v40
    v_lshlrev_b32 v41, 16, v42
    v_and_b32 v42, 0xffff0000, v42
    s_mov_b32 vcc_lo, 0xffff0000
    s_mov_b32 vcc_hi, 0xffff0000
    v_cndmask_b32 v41, v41, v42, vcc
    s_mul_i32 s59, s3, 9
    s_add_u32 s59, s59, s65
    s_lshl_b32 s59, s59, 12
    s_add_u32 s59, s59, 0xe0000
    s_mov_b32 s60, 0x04000c0c
    s_mov_b32 s61, 0x0706000c
    v_mov_b32 v45, s34
    v_mov_b32 v47, s34
.gp_116:
    buffer_load_dwordx4 v[16:19], v2, s[36:39], s59 offen offset:0 sc1
    buffer_load_dwordx4 v[20:23], v2, s[36:39], s59 offen offset:1024 sc1
    buffer_load_dwordx4 v[24:27], v2, s[36:39], s59 offen offset:2048 sc1
    buffer_load_dwordx4 v[28:31], v2, s[36:39], s59 offen offset:3072 sc1
    s_waitcnt vmcnt(0)
.gpc_117:
    v_min_u32 v32, v19, v23
    v_max_u32 v33, v19, v23
    v_min3_u32 v32, v32, v27, v31
    v_max3_u32 v33, v33, v27, v31
    v_cmp_eq_u32 vcc, s34, v32
    v_cmp_eq_u32 s[56:57], s34, v33
    s_and_b64 vcc, vcc, s[56:57]
    s_cmp_eq_u64 vcc, -1
    s_nop 2
    s_cbranch_scc1 .gpd_118
    s_sub_u32 s35, s35, 1
    s_cbranch_scc1 .Lexit
    s_branch .gp_116
.gpd_118:
    v_perm_b32 v19, v16, v17, s60
    v_perm_b32 v19, v19, v18, s61
    v_perm_b32 v23, v20, v21, s60
    v_perm_b32 v23, v23, v22, s61
    v_perm_b32 v27, v24, v25, s60
    v_perm_b32 v27, v27, v26, s61
    v_perm_b32 v31, v28, v29, s60
    v_perm_b32 v31, v31, v30, s61
    v_pk_add_f32 v[16:17], v[16:17], v[20:21]
    v_pk_add_f32 v[18:19], v[18:19], v[22:23]
    v_pk_add_f32 v[24:25], v[24:25], v[28:29]
    v_pk_add_f32 v[26:27], v[26:27], v[30:31]
    v_pk_add_f32 v[16:17], v[16:17], v[24:25]
    v_pk_add_f32 v[18:19], v[18:19], v[26:27]
    s_nop 1
    v_permlane32_swap_b32 v16, v18
    v_permlane32_swap_b32 v17, v19
    v_pk_add_f32 v[16:17], v[16:17], v[18:19]
    s_nop 1
    v_permlane16_swap_b32 v16, v17
    v_add_f32 v16, v16, v17
    v_cvt_pk_bf16_f32 v16, v16, v16
    v_lshlrev_b32 v16, 16, v16
    v_mul_f32 v16, v16, v41
    v_cvt_pk_bf16_f32 v16, v16, v16
    v_lshlrev_b32 v16, 16, v16
    v_add_f32 v17, v16, v40
    v_add_f32 v16, v16, v40
    v_mov_b32 v40, v16
    s_nop 0
    v_permlane16_swap_b32 v16, v17
    v_cvt_pk_bf16_f32 v44, v16, v17
    v_cvt_pk_bf16_f32 v46, v16, v17
    s_nop 1
    v_permlane32_swap_b32 v44, v46
    s_mov_b64 exec, 0xffff
    s_add_u32 s57, s99, 0x800000
    buffer_store_dwordx4 v[44:47], v9, s[36:39], s57 offen
    s_cmp_lg_u32 s0, 0
    s_nop 0
    s_cbranch_scc1 .nosl_119
    buffer_store_dwordx4 v[44:47], v9, s[36:39], s99 offen sc1
.nosl_119:
    s_mov_b64 exec, -1
    s_lshr_b32 s56, s64, 1
    s_and_b32 s57, s3, 3
    s_cmp_lg_u32 s56, s57
    s_cbranch_scc1 .Lexit
    v_cvt_pk_bf16_f32 v40, v40, v40
    v_lshlrev_b32 v40, 16, v40
    s_mov_b32 s69, 0
.gp_120:
    s_add_u32 s69, s69, 1
    s_and_b32 s56, s69, 0x41
    s_cmp_lg_u32 s56, 0x41
    s_cselect_b32 s56, 0, 0x800000
    s_xor_b32 s56, s56, s0
    s_add_u32 s58, s101, s56
    buffer_load_dwordx4 v[84:87], v2, s[36:39], s58 offen offset:0 sc1
    buffer_load_dwordx4 v[88:91], v2, s[36:39], s58 offen offset:1024 sc1
    buffer_load_dwordx2 v[92:93], v5, s[36:39], s58 offen offset:0 sc1
    s_waitcnt vmcnt(0)
    v_min3_u32 v24, v85, v87, v89
    v_max3_u32 v25, v85, v87, v89
    v_min3_u32 v24, v24, v91, v93
    v_max3_u32 v25, v25, v91, v93
    v_cmp_eq_u32 vcc, s34, v24
    v_cmp_eq_u32 s[56:57], s34, v25
    s_and_b64 vcc, vcc, s[56:57]
    s_cmp_eq_u64 vcc, -1
    s_nop 2
    s_cbranch_scc1 .gpd_121
    s_sub_u32 s35, s35, 1
    s_cbranch_scc1 .Lexit
    s_branch .Lsk_m2_0
.Lst_m2_0:
    s_branch .Lrt_m2_0
.Lsk_m2_0:
    s_sleep 1
    s_branch .gp_120
.gpd_121:
    s_mov_b32 s56, 0x3f803f80
    v_dot2_f32_bf16 v104, v84, s56, 0
    v_dot2_f32_bf16 v105, v84, v84, 0
    v_dot2_f32_bf16 v104, v86, s56, v104
    v_dot2_f32_bf16 v105, v86, v86, v105
    v_dot2_f32_bf16 v104, v88, s56, v104
    v_dot2_f32_bf16 v105, v88, v88, v105
    v_dot2_f32_bf16 v104, v90, s56, v104
    v_dot2_f32_bf16 v105, v90, v90, v105
    s_mov_b64 exec, 0xffffffff
    v_dot2_f32_bf16 v104, v92, s56, v104
    v_dot2_f32_bf16 v105, v92, v92, v105
    s_mov_b64 exec, -1
    s_nop 1
    v_permlane32_swap_b32 v104, v105
    v_add_f32 v104, v104, v105
    v_mov_b32 v106, v104
    s_nop 1
    v_permlane16_swap_b32 v106, v104
    v_add_f32 v104, v106, v104
    v_lshlrev_b32 v94, 16, v84
    v_and_b32 v95, 0xffff0000, v84
    v_add_f32_dpp v104, v104, v104 row_ror:8 row_mask:0xf bank_mask:0xf
    v_lshlrev_b32 v96, 16, v86
    v_and_b32 v97, 0xffff0000, v86
    v_add_f32_dpp v104, v104, v104 row_ror:4 row_mask:0xf bank_mask:0xf
    v_lshlrev_b32 v98, 16, v88
    v_and_b32 v99, 0xffff0000, v88
    v_add_f32_dpp v104, v104, v104 quad_perm:[2,3,0,1] row_mask:0xf bank_mask:0xf
    v_lshlrev_b32 v100, 16, v90
    v_and_b32 v101, 0xffff0000, v90
    v_add_f32_dpp v104, v104, v104 quad_perm:[1,0,3,2] row_mask:0xf bank_mask:0xf
    v_mul_f32 v104, 0x3ae38e39, v104
    v_lshlrev_b32 v102, 16, v92
    v_and_b32 v103, 0xffff0000, v92
    v_readlane_b32 s56, v104, 0
    v_readlane_b32 s57, v104, 32
    s_nop 0
    v_mov_b32 v104, s56
    v_fma_f32 v105, -v104, v104, s57
    v_max_f32 v105, 0, v105
    v_cvt_pk_bf16_f32 v106, -v104, v105
    v_and_b32 v107, 0xffff0000, v106
    v_add_f32 v107, 0x3727c5ac, v107
    v_lshlrev_b32 v104, 16, v106
    v_cvt_pk_bf16_f32 v107, v107, v107
    v_lshlrev_b32 v107, 16, v107
    v_sqrt_f32 v107, v107
    v_mov_b32 v105, v104
    v_cvt_pk_bf16_f32 v107, v107, v107
    v_lshlrev_b32 v107, 16, v107
    v_rcp_f32 v106, v107
    v_rcp_f32 v107, v107
    v_pk_add_f32 v[94:95], v[94:95], v[104:105]
    v_pk_add_f32 v[96:97], v[96:97], v[104:105]
    v_pk_add_f32 v[98:99], v[98:99], v[104:105]
    v_pk_add_f32 v[100:101], v[100:101], v[104:105]
    v_pk_add_f32 v[102:103], v[102:103], v[104:105]
    v_cvt_pk_bf16_f32 v94, v94, v95
    v_and_b32 v95, 0xffff0000, v94
    v_lshlrev_b32 v94, 16, v94
    v_cvt_pk_bf16_f32 v96, v96, v97
    v_and_b32 v97, 0xffff0000, v96
    v_lshlrev_b32 v96, 16, v96
    v_cvt_pk_bf16_f32 v98, v98, v99
    v_and_b32 v99, 0xffff0000, v98
    v_lshlrev_b32 v98, 16, v98
    v_cvt_pk_bf16_f32 v100, v100, v101
    v_and_b32 v101, 0xffff0000, v100
    v_lshlrev_b32 v100, 16, v100
    v_cvt_pk_bf16_f32 v102, v102, v103
    v_and_b32 v103, 0xffff0000, v102
    v_lshlrev_b32 v102, 16, v102
    v_pk_mul_f32 v[94:95], v[94:95], v[106:107]
    v_pk_mul_f32 v[96:97], v[96:97], v[106:107]
    v_pk_mul_f32 v[98:99], v[98:99], v[106:107]
    v_pk_mul_f32 v[100:101], v[100:101], v[106:107]
    v_pk_mul_f32 v[102:103], v[102:103], v[106:107]
    v_cvt_pk_bf16_f32 v94, v94, v95
    v_and_b32 v95, 0xffff0000, v94
    v_lshlrev_b32 v94, 16, v94
    v_cvt_pk_bf16_f32 v96, v96, v97
    v_and_b32 v97, 0xffff0000, v96
    v_lshlrev_b32 v96, 16, v96
    v_cvt_pk_bf16_f32 v98, v98, v99
    v_and_b32 v99, 0xffff0000, v98
    v_lshlrev_b32 v98, 16, v98
    v_cvt_pk_bf16_f32 v100, v100, v101
    v_and_b32 v101, 0xffff0000, v100
    v_lshlrev_b32 v100, 16, v100
    v_cvt_pk_bf16_f32 v102, v102, v103
    v_and_b32 v103, 0xffff0000, v102
    v_lshlrev_b32 v102, 16, v102
    v_pk_mul_f32 v[94:95], v[94:95], v[66:67]
    v_pk_mul_f32 v[96:97], v[96:97], v[68:69]
    v_pk_mul_f32 v[98:99], v[98:99], v[70:71]
    v_pk_mul_f32 v[100:101], v[100:101], v[72:73]
    v_pk_mul_f32 v[102:103], v[102:103], v[74:75]
    v_cvt_pk_bf16_f32 v94, v94, v95
    v_and_b32 v95, 0xffff0000, v94
    v_lshlrev_b32 v94, 16, v94
    v_cvt_pk_bf16_f32 v96, v96, v97
    v_and_b32 v97, 0xffff0000, v96
    v_lshlrev_b32 v96, 16, v96
    v_cvt_pk_bf16_f32 v98, v98, v99
    v_and_b32 v99, 0xffff0000, v98
    v_lshlrev_b32 v98, 16, v98
    v_cvt_pk_bf16_f32 v100, v100, v101
    v_and_b32 v101, 0xffff0000, v100
    v_lshlrev_b32 v100, 16, v100
    v_cvt_pk_bf16_f32 v102, v102, v103
    v_and_b32 v103, 0xffff0000, v102
    v_lshlrev_b32 v102, 16, v102
    v_pk_add_f32 v[94:95], v[94:95], v[56:57]
    v_pk_add_f32 v[96:97], v[96:97], v[58:59]
    v_pk_add_f32 v[98:99], v[98:99], v[60:61]
    v_pk_add_f32 v[100:101], v[100:101], v[62:63]
    v_pk_add_f32 v[102:103], v[102:103], v[64:65]
    v_cvt_pk_bf16_f32 v110, v94, v95
    v_cvt_pk_bf16_f32 v111, v96, v97
    v_cvt_pk_bf16_f32 v112, v98, v99
    v_cvt_pk_bf16_f32 v113, v100, v101
    v_cvt_pk_bf16_f32 v114, v102, v103
    v_dot2_f32_bf16 v14, v110, v48, 0
    v_dot2_f32_bf16 v14, v111, v49, v14
    v_dot2_f32_bf16 v14, v112, v50, v14
    v_dot2_f32_bf16 v14, v113, v51, v14
    s_mov_b64 exec, 0xffffffff
    v_dot2_f32_bf16 v14, v114, v34, v14
    s_mov_b64 exec, -1
    s_nop 1
    v_mov_b32 v15, v14
    s_nop 1
    v_permlane32_swap_b32 v15, v14
    v_add_f32 v14, v15, v14
    v_mov_b32 v15, v14
    s_nop 1
    v_permlane16_swap_b32 v15, v14
    v_add_f32 v14, v15, v14
    s_nop 1
    v_add_f32_dpp v14, v14, v14 row_ror:8 row_mask:0xf bank_mask:0xf
    s_nop 1
    v_add_f32_dpp v14, v14, v14 row_ror:4 row_mask:0xf bank_mask:0xf
    s_nop 1
    v_add_f32_dpp v14, v14, v14 quad_perm:[2,3,0,1] row_mask:0xf bank_mask:0xf
    s_nop 1
    v_add_f32_dpp v14, v14, v14 quad_perm:[1,0,3,2] row_mask:0xf bank_mask:0xf
    v_cvt_pk_bf16_f32 v14, v14, v14
    v_lshlrev_b32 v14, 16, v14
    v_max_f32 v14, 0xc2ae0000, v14
    v_min_f32 v14, 0x43000000, v14
    v_mul_f32 v15, 0xbfb8aa3b, v14
    v_fma_f32 v16, v14, s98, -v15
    v_fmac_f32 v16, 0xb2a57060, v14
    v_exp_f32 v15, v15
    v_mul_f32 v16, 0x3f317218, v16
    v_fmac_f32 v15, v15, v16
    v_add_f32 v15, 1.0, v15
    v_rcp_f32 v16, v15
    s_nop 0
    v_fma_f32 v15, -v15, v16, 1.0
    v_fma_f32 v14, v15, v16, v16
    v_cvt_pk_bf16_f32 v14, v14, v14
    s_branch .Lsk_m2_1
.Lst_m2_1:
    s_branch .Lrt_m2_1
.Lsk_m2_1:
    v_lshlrev_b32 v14, 16, v14
    v_add_f32 v41, v40, v104
    v_cvt_pk_bf16_f32 v41, v41, v41
    v_lshlrev_b32 v41, 16, v41
    v_mul_f32 v41, v41, v106
    v_cvt_pk_bf16_f32 v41, v41, v41
    v_lshlrev_b32 v41, 16, v41
    v_mul_f32 v41, v41, v79
    v_cvt_pk_bf16_f32 v41, v41, v41
    v_lshlrev_b32 v41, 16, v41
    v_add_f32 v41, v41, v77
    v_cvt_pk_bf16_f32 v41, v41, v41
    v_lshlrev_b32 v41, 16, v41
    s_and_b32 s62, s64, 1
    s_lshl1_add_u32 s58, s65, s62
    s_lshl3_add_u32 s58, s58, s3
    s_mul_i32 s58, s58, 9216
    s_add_u32 s58, s58, 0x1a0000
    s_add_u32 s59, s58, 4096
    s_add_u32 s63, s58, 8192
    s_cmp_eq_u32 s62, 0
    s_mov_b32 s56, 0x00ff00ff
    s_cselect_b32 s62, s56, 0xff00ff00
    s_mov_b32 s60, 0x04000c0c
    s_mov_b32 s61, 0x0706000c
    s_mov_b32 s48, s28
    s_and_b32 s49, s29, 0xffff
    s_mov_b32 s50, 0x2400
    s_mov_b32 s51, 0x00020000
.gp_122:
    buffer_load_dwordx4 v[120:123], v2, s[36:39], s58 offen offset:0 sc1
    buffer_load_dwordx4 v[124:127], v2, s[36:39], s58 offen offset:1024 sc1
    buffer_load_dwordx4 v[128:131], v2, s[36:39], s58 offen offset:2048 sc1
    buffer_load_dwordx4 v[132:135], v2, s[36:39], s58 offen offset:3072 sc1
    buffer_load_dwordx4 v[136:139], v2, s[36:39], s59 offen offset:0 sc1
    buffer_load_dwordx4 v[140:143], v2, s[36:39], s59 offen offset:1024 sc1
    buffer_load_dwordx4 v[144:147], v2, s[36:39], s59 offen offset:2048 sc1
    buffer_load_dwordx4 v[148:151], v2, s[36:39], s59 offen offset:3072 sc1
    buffer_load_dwordx4 v[152:155], v2, s[36:39], s63 offen offset:0 sc1
    s_waitcnt vmcnt(0)
.gpc_123:
    v_min3_u32 v24, v123, v127, v131
    v_max3_u32 v25, v123, v127, v131
    v_min3_u32 v24, v24, v135, v139
    v_max3_u32 v25, v25, v135, v139
    v_min3_u32 v24, v24, v143, v147
    v_max3_u32 v25, v25, v143, v147
    v_min3_u32 v24, v24, v151, v155
    v_max3_u32 v25, v25, v151, v155
    v_cmp_eq_u32 vcc, s34, v24
    v_cmp_eq_u32 s[56:57], s34, v25
    s_and_b64 vcc, vcc, s[56:57]
    s_cmp_eq_u64 vcc, -1
    s_nop 2
    s_cbranch_scc1 .gpd_124
    s_sub_u32 s35, s35, 1
    s_cbranch_scc1 .Lexit
    s_branch .gp_122
.gpd_124:
    v_perm_b32 v123, v120, v121, s60
    v_perm_b32 v123, v123, v122, s61
    v_perm_b32 v127, v124, v125, s60
    v_perm_b32 v127, v127, v126, s61
    v_perm_b32 v131, v128, v129, s60
    v_perm_b32 v131, v131, v130, s61
    v_perm_b32 v135, v132, v133, s60
    v_perm_b32 v135, v135, v134, s61
    v_perm_b32 v139, v136, v137, s60
    v_perm_b32 v139, v139, v138, s61
    v_perm_b32 v143, v140, v141, s60
    v_perm_b32 v143, v143, v142, s61
    v_perm_b32 v147, v144, v145, s60
    v_perm_b32 v147, v147, v146, s61
    v_perm_b32 v151, v148, v149, s60
    v_perm_b32 v151, v151, v150, s61
    v_perm_b32 v155, v152, v153, s60
    v_perm_b32 v155, v155, v154, s61
    v_pk_add_f32 v[120:121], v[120:121], v[124:125]
    v_pk_add_f32 v[122:123], v[122:123], v[126:127]
    v_pk_add_f32 v[128:129], v[128:129], v[132:133]
    v_pk_add_f32 v[130:131], v[130:131], v[134:135]
    v_pk_add_f32 v[136:137], v[136:137], v[140:141]
    v_pk_add_f32 v[138:139], v[138:139], v[142:143]
    v_pk_add_f32 v[144:145], v[144:145], v[148:149]
    v_pk_add_f32 v[146:147], v[146:147], v[150:151]
    v_pk_add_f32 v[120:121], v[120:121], v[128:129]
    v_pk_add_f32 v[122:123], v[122:123], v[130:131]
    v_pk_add_f32 v[136:137], v[136:137], v[144:145]
    v_pk_add_f32 v[138:139], v[138:139], v[146:147]
    v_pk_add_f32 v[120:121], v[120:121], v[136:137]
    v_pk_add_f32 v[122:123], v[122:123], v[138:139]
    v_pk_add_f32 v[120:121], v[120:121], v[152:153]
    v_pk_add_f32 v[122:123], v[122:123], v[154:155]
    s_nop 1
    v_permlane32_swap_b32 v120, v122
    v_permlane32_swap_b32 v121, v123
    v_pk_add_f32 v[120:121], v[120:121], v[122:123]
    s_nop 1
    v_permlane16_swap_b32 v120, v121
    v_add_f32 v120, v120, v121
    s_nop 1
    v_add_f32_dpp v120, v120, v120 row_ror:8 row_mask:0xf bank_mask:0xf
    v_cvt_pk_bf16_f32 v120, v120, v120
    v_lshlrev_b32 v120, 16, v120
    v_mul_f32 v120, v120, v14
    v_cvt_pk_bf16_f32 v120, v120, v120
    v_lshlrev_b32 v120, 16, v120
    v_add_f32 v120, v120, v41
    v_cvt_pk_bf16_f32 v120, v120, v120
    v_lshlrev_b32 v120, 16, v120
    v_mul_f32 v120, v120, v81
    v_cvt_pk_bf16_f32 v120, v120, v120
    v_lshlrev_b32 v120, 16, v120
    v_add_f32 v120, v120, v40
    v_cvt_pk_bf16_f32 v120, v120, v120
    s_mov_b32 exec_lo, s62
    s_mov_b32 exec_hi, s62
    buffer_store_short v120, v7, s[48:51], s100 offen
    s_mov_b64 exec, -1
    s_or_b32 s56, s2, s3
    s_cmp_lg_u32 s56, 0
    s_cbranch_scc1 .Lexit
    v_mov_b32 v13, s34
    v_mov_b32 v12, 0
    s_mov_b64 exec, 1
    buffer_store_dword v13, v12, s[36:39], 0 offen
    s_mov_b64 exec, -1
    s_branch .Lexit
.Lbc:
    s_branch .Lsk_b0_0
.Lst_b0_0:
    s_branch .Lrt_b0_0
.Lsk_b0_0:
    s_sub_u32 s56, s65, 9
    s_mov_b32 s57, 0x63054210
    s_cmp_eq_u32 s65, 14
    s_cselect_b32 s56, s64, s56
    s_cselect_b32 s57, 0x37654210, s57
    s_cselect_b32 s99, 8, s64
    s_lshl_b32 s56, s56, 2
    s_lshr_b32 s56, s57, s56
    s_and_b32 s56, s56, 7
    s_cmp_eq_u32 s65, 17
    s_cselect_b32 s56, 7, s56
    s_lshl3_add_u32 s99, s99, s56
    s_and_b32 s56, s99, 7
    s_cmp_eq_u32 s56, 3
    s_mov_b32 s14, 0xb5b5b5b5
    s_cselect_b32 s14, 0x0, s14
    s_mov_b32 s15, 0xd6d6b6b6
    s_cselect_b32 s15, 0x0, s15
    s_cselect_b32 s30, -50, 0
    s_add_u32 s30, s30, 0
    s_add_u32 s30, s30, s70
    s_mov_b32 s31, s70
    s_mov_b32 s48, s18
    s_and_b32 s49, s19, 0xffff
    s_mov_b32 s50, 0x510000
    s_mov_b32 s51, 0x00020000
    s_mov_b32 s52, s20
    s_and_b32 s53, s21, 0xffff
    s_mov_b32 s54, 0x510000
    s_mov_b32 s55, 0x00020000
    v_bfe_u32 v12, v0, 4, 1
    s_and_b32 s56, s3, 3
    s_lshl_b32 s56, s56, 1
    v_or_b32 v12, s56, v12
    v_and_b32 v6, 7, v0
    v_xor_b32 v12, v12, v6
    v_lshrrev_b32 v6, 3, v0
    v_mul_u32_u24 v6, 9216, v6
    v_lshl_add_u32 v6, v12, 4, v6
    s_mul_i32 s100, s3, 73728
    s_lshl_b32 s56, s99, 7
    s_add_u32 s100, s100, s56
    s_lshl_b32 s101, s3, 10
    s_waitcnt lgkmcnt(0)
    s_add_u32 s34, s34, 1
    s_getreg_b32 s1, hwreg(HW_REG_XCC_ID)
    s_lshl_b32 s1, s1, 24
    s_add_u32 s1, s1, s34
    s_lshr_b32 s0, s2, 3
    s_lshl_b32 s63, s64, 8
    s_add_u32 s0, s0, s63
    s_lshl2_add_u32 s0, s0, 0x480000
    v_mov_b32 v30, s1
    s_cmp_eq_u32 s3, 0
    s_cselect_b64 exec, 1, 0
    buffer_store_dword v30, v2, s[36:39], s0 offen sc1
    s_mov_b64 exec, -1
    v_and_b32 v8, 1, v0
    v_lshlrev_b32 v8, 8, v8
    v_and_b32 v9, 0x3c, v0
    v_lshl_add_u32 v9, v9, 2, v8
    v_add_u32 v7, v9, v8
    v_and_b32 v9, 0x3c, v0
    v_lshrrev_b32 v8, 4, v8
    v_and_b32 v9, 4, v0
    v_lshl_add_u32 v9, v9, 3, v8
    s_lshl_b32 s58, s66, 14
    s_lshl_b32 s59, s67, 10
    s_add_u32 s58, s58, s59
    s_add_u32 s58, s58, 0x70000
    s_lshl4_add_u32 s59, s66, s67
    s_lshl_b32 s59, s59, 7
    s_add_u32 s59, s59, 0x430000
    s_bitcmp1_b64 s[14:15], 4
    s_cbranch_scc0 1
    s_waitcnt vmcnt(4)
    s_add_u32 s63, s69, 32768
    buffer_load_dwordx4 v[96:99], v1, s[40:43], s63 offen nt
    s_waitcnt vmcnt(6)
    s_add_u32 m0, s101, 0
    s_add_u32 s56, s100, 0
    buffer_load_dwordx4 v6, s[48:51], s56 offen nt lds
    s_waitcnt vmcnt(6)
    s_bitcmp1_b64 s[14:15], 5
    s_cbranch_scc0 1
    s_waitcnt vmcnt(4)
    s_add_u32 s63, s69, 40960
    buffer_load_dwordx4 v[100:103], v1, s[40:43], s63 offen nt
    s_waitcnt vmcnt(6)
    s_bitcmp1_b64 s[14:15], 6
    s_cbranch_scc0 1
    s_waitcnt vmcnt(2)
    s_add_u32 s63, s69, 49152
    buffer_load_dwordx4 v[128:131], v1, s[40:43], s63 offen nt
    s_cmp_eq_u32 s3, 0
    s_cbranch_scc1 .Lst_b1_0
    s_cmp_eq_u32 s3, 1
    s_cbranch_scc1 .Lst_b1_1
    s_cmp_eq_u32 s3, 2
    s_cbranch_scc1 .Lst_b1_2
    s_cmp_eq_u32 s3, 3
    s_cbranch_scc1 .Lst_b1_3
    s_cmp_eq_u32 s3, 4
    s_cbranch_scc1 .Lst_b1_4
    s_cmp_eq_u32 s3, 5
    s_cbranch_scc1 .Lst_b1_5
    s_cmp_eq_u32 s3, 6
    s_cbranch_scc1 .Lst_b1_6
    s_cmp_eq_u32 s3, 7
    s_cbranch_scc1 .Lst_b1_7
.Lrt_b1_0:
.Lrt_b1_1:
.Lrt_b1_2:
.Lrt_b1_3:
.Lrt_b1_4:
.Lrt_b1_5:
.Lrt_b1_6:
.Lrt_b1_7:
    s_waitcnt vmcnt(6)
    s_add_u32 m0, s101, 8192
    s_add_u32 s56, s100, 589824
    buffer_load_dwordx4 v6, s[48:51], s56 offen nt lds
    s_waitcnt vmcnt(4)
    s_bitcmp1_b64 s[14:15], 7
    s_cbranch_scc0 1
    s_waitcnt vmcnt(2)
    s_add_u32 s63, s69, 57344
    buffer_load_dwordx4 v[132:135], v1, s[40:43], s63 offen nt
    s_waitcnt vmcnt(4)
    s_bitcmp1_b64 s[14:15], 8
    s_cbranch_scc0 1
    s_waitcnt vmcnt(2)
    s_add_u32 s63, s69, 131072
    buffer_load_dwordx4 v[40:43], v1, s[40:43], s63 offen nt
    s_memrealtime s[8:9]
    s_waitcnt lgkmcnt(0)
    s_sub_u32 s8, s8, s30
    s_cmpk_ge_u32 s8, 437
    s_cbranch_scc1 .ap_125
    s_waitcnt vmcnt(5)
    s_cmpk_ge_u32 s8, 337
    s_cbranch_scc1 .ap_125
    s_waitcnt vmcnt(4)
    s_bitcmp1_b64 s[14:15], 9
    s_cbranch_scc0 1
    s_waitcnt vmcnt(2)
    s_cmpk_ge_u32 s8, 217
    s_cbranch_scc1 .ap_125
    s_waitcnt vmcnt(1)
.ap_125:
    s_add_u32 s63, s69, 139264
    buffer_load_dwordx4 v[44:47], v1, s[40:43], s63 offen nt
    s_memrealtime s[8:9]
    s_waitcnt lgkmcnt(0)
    s_sub_u32 s8, s8, s30
    s_cmpk_ge_u32 s8, 471
    s_cbranch_scc1 .ap_126
    s_waitcnt vmcnt(5)
    s_cmpk_ge_u32 s8, 371
    s_cbranch_scc1 .ap_126
    s_waitcnt vmcnt(4)
    s_bitcmp1_b64 s[14:15], 10
    s_cbranch_scc0 1
    s_waitcnt vmcnt(2)
    s_cmpk_ge_u32 s8, 251
    s_cbranch_scc1 .ap_126
    s_waitcnt vmcnt(1)
.ap_126:
    s_add_u32 s63, s69, 147456
    buffer_load_dwordx4 v[72:75], v1, s[40:43], s63 offen nt
    s_memrealtime s[8:9]
    s_waitcnt lgkmcnt(0)
    s_sub_u32 s8, s8, s30
    s_cmpk_ge_u32 s8, 505
    s_cbranch_scc1 .ap_127
    s_waitcnt vmcnt(5)
    s_cmpk_ge_u32 s8, 405
    s_cbranch_scc1 .ap_127
    s_waitcnt vmcnt(4)
    s_cmpk_ge_u32 s8, 285
    s_cbranch_scc1 .ap_127
    s_waitcnt vmcnt(1)
.ap_127:
    s_add_u32 m0, s101, 16384
    s_add_u32 s56, s100, 1179648
    buffer_load_dwordx4 v6, s[48:51], s56 offen nt lds
    s_memrealtime s[8:9]
    s_waitcnt lgkmcnt(0)
    s_sub_u32 s8, s8, s30
    s_cmpk_ge_u32 s8, 505
    s_cbranch_scc1 .ap_128
    s_waitcnt vmcnt(5)
    s_cmpk_ge_u32 s8, 405
    s_cbranch_scc1 .ap_128
    s_waitcnt vmcnt(4)
    s_bitcmp1_b64 s[14:15], 11
    s_cbranch_scc0 1
    s_waitcnt vmcnt(2)
    s_cmpk_ge_u32 s8, 285
    s_cbranch_scc1 .ap_128
    s_waitcnt vmcnt(1)
.ap_128:
    s_add_u32 s63, s69, 155648
    buffer_load_dwordx4 v[76:79], v1, s[40:43], s63 offen nt
    s_memrealtime s[8:9]
    s_waitcnt vmcnt(8)
    s_waitcnt lgkmcnt(0)
    s_sub_u32 s8, s8, s30
    s_cmpk_ge_u32 s8, 539
    s_cbranch_scc1 .ap_129
    s_waitcnt vmcnt(5)
    s_cmpk_ge_u32 s8, 439
    s_cbranch_scc1 .ap_129
    s_waitcnt vmcnt(4)
    s_bitcmp1_b64 s[14:15], 12
    s_cbranch_scc0 1
    s_waitcnt vmcnt(2)
    s_cmpk_ge_u32 s8, 319
    s_cbranch_scc1 .ap_129
    s_waitcnt vmcnt(1)
.ap_129:
    s_add_u32 s63, s69, 163840
    buffer_load_dwordx4 v[104:107], v1, s[40:43], s63 offen nt
    v_and_b32 v157, 7, v0
    v_lshlrev_b32 v157, 2, v157
    s_mov_b32 s63, 0x4a1100
    buffer_load_dword v156, v157, s[36:39], s63 offen
    s_branch .Lsk_b0_1
.Lst_b0_1:
    s_branch .Lrt_b0_1
.Lsk_b0_1:
    s_memrealtime s[8:9]
    s_waitcnt vmcnt(9)
    s_waitcnt lgkmcnt(0)
    s_sub_u32 s8, s8, s30
    s_cmpk_ge_u32 s8, 573
    s_cbranch_scc1 .ap_130
    s_waitcnt vmcnt(6)
    s_cmpk_ge_u32 s8, 473
    s_cbranch_scc1 .ap_130
    s_waitcnt vmcnt(5)
    s_bitcmp1_b64 s[14:15], 13
    s_cbranch_scc0 1
    s_waitcnt vmcnt(3)
    s_cmpk_ge_u32 s8, 353
    s_cbranch_scc1 .ap_130
    s_waitcnt vmcnt(2)
.ap_130:
    s_add_u32 s63, s69, 172032
    buffer_load_dwordx4 v[108:111], v1, s[40:43], s63 offen nt
    s_memrealtime s[8:9]
    s_waitcnt vmcnt(9)
    s_waitcnt lgkmcnt(0)
    s_sub_u32 s8, s8, s30
    s_cmpk_ge_u32 s8, 607
    s_cbranch_scc1 .ap_131
    s_waitcnt vmcnt(6)
    s_cmpk_ge_u32 s8, 507
    s_cbranch_scc1 .ap_131
    s_waitcnt vmcnt(5)
    s_bitcmp1_b64 s[14:15], 14
    s_cbranch_scc0 1
    s_waitcnt vmcnt(3)
    s_cmpk_ge_u32 s8, 387
    s_cbranch_scc1 .ap_131
    s_waitcnt vmcnt(2)
.ap_131:
    s_add_u32 s63, s69, 180224
    buffer_load_dwordx4 v[136:139], v1, s[40:43], s63 offen nt
    s_memrealtime s[8:9]
    s_waitcnt vmcnt(9)
    s_waitcnt lgkmcnt(0)
    s_sub_u32 s8, s8, s30
    s_cmpk_ge_u32 s8, 641
    s_cbranch_scc1 .ap_132
    s_waitcnt vmcnt(6)
    s_cmpk_ge_u32 s8, 541
    s_cbranch_scc1 .ap_132
    s_waitcnt vmcnt(5)
    s_cmpk_ge_u32 s8, 421
    s_cbranch_scc1 .ap_132
    s_waitcnt vmcnt(1)
.ap_132:
    s_add_u32 m0, s101, 24576
    s_add_u32 s56, s100, 1769472
    buffer_load_dwordx4 v6, s[48:51], s56 offen nt lds
    s_memrealtime s[8:9]
    s_waitcnt vmcnt(9)
    s_waitcnt lgkmcnt(0)
    s_sub_u32 s8, s8, s30
    s_cmpk_ge_u32 s8, 641
    s_cbranch_scc1 .ap_133
    s_waitcnt vmcnt(6)
    s_cmpk_ge_u32 s8, 541
    s_cbranch_scc1 .ap_133
    s_waitcnt vmcnt(5)
    s_bitcmp1_b64 s[14:15], 15
    s_cbranch_scc0 1
    s_waitcnt vmcnt(2)
    s_cmpk_ge_u32 s8, 421
    s_cbranch_scc1 .ap_133
    s_waitcnt vmcnt(1)
.ap_133:
    s_add_u32 s63, s69, 188416
    buffer_load_dwordx4 v[140:143], v1, s[40:43], s63 offen nt
    s_memrealtime s[8:9]
    s_waitcnt vmcnt(9)
    s_waitcnt lgkmcnt(0)
    s_sub_u32 s8, s8, s30
    s_cmpk_ge_u32 s8, 675
    s_cbranch_scc1 .ap_134
    s_waitcnt vmcnt(6)
    s_cmpk_ge_u32 s8, 575
    s_cbranch_scc1 .ap_134
    s_waitcnt vmcnt(5)
    s_bitcmp1_b64 s[14:15], 16
    s_cbranch_scc0 1
    s_waitcnt vmcnt(2)
    s_cmpk_ge_u32 s8, 455
    s_cbranch_scc1 .ap_134
    s_waitcnt vmcnt(1)
.ap_134:
    s_add_u32 s63, s69, 262144
    buffer_load_dwordx4 v[48:51], v1, s[40:43], s63 offen nt
    s_waitcnt vmcnt(5)
    s_sub_u32 s63, s70, 300
    v_subrev_u32 v156, s63, v156
    v_mov_b32 v157, 600
    v_cmp_lt_u32 s[8:9], v156, v157
    v_add_u32_dpp v156, v156, v156 quad_perm:[1,0,3,2] row_mask:0xf bank_mask:0xf
    s_nop 1
    v_add_u32_dpp v156, v156, v156 quad_perm:[2,3,0,1] row_mask:0xf bank_mask:0xf
    s_nop 1
    v_add_u32_dpp v156, v156, v156 row_ror:4 row_mask:0xf bank_mask:0xf
    s_nop 0
    v_readfirstlane_b32 s63, v156
    s_cmp_eq_u64 s[8:9], -1
    s_nop 3
    s_cbranch_scc0 .et_135
    s_lshr_b32 s63, s63, 3
    s_sub_u32 s63, s63, 300
    s_add_u32 s30, s30, s63
    s_add_u32 s31, s31, s63
.et_135:
    s_memrealtime s[8:9]
    s_waitcnt lgkmcnt(0)
    s_sub_u32 s8, s8, s30
    s_cmpk_ge_u32 s8, 709
    s_cbranch_scc1 .ap_136
    s_waitcnt vmcnt(5)
    s_cmpk_ge_u32 s8, 609
    s_cbranch_scc1 .ap_136
    s_waitcnt vmcnt(4)
    s_bitcmp1_b64 s[14:15], 17
    s_cbranch_scc0 1
    s_waitcnt vmcnt(2)
    s_cmpk_ge_u32 s8, 489
    s_cbranch_scc1 .ap_136
    s_waitcnt vmcnt(1)
.ap_136:
    s_add_u32 s63, s69, 270336
    buffer_load_dwordx4 v[52:55], v1, s[40:43], s63 offen nt
    s_memrealtime s[8:9]
    s_waitcnt lgkmcnt(0)
    s_sub_u32 s8, s8, s30
    s_cmpk_ge_u32 s8, 744
    s_cbranch_scc1 .ap_137
    s_waitcnt vmcnt(5)
    s_cmpk_ge_u32 s8, 644
    s_cbranch_scc1 .ap_137
    s_waitcnt vmcnt(4)
    s_bitcmp1_b64 s[14:15], 18
    s_cbranch_scc0 1
    s_waitcnt vmcnt(2)
    s_cmpk_ge_u32 s8, 524
    s_cbranch_scc1 .ap_137
    s_waitcnt vmcnt(1)
.ap_137:
    s_add_u32 s63, s69, 278528
    buffer_load_dwordx4 v[80:83], v1, s[40:43], s63 offen nt
    s_memrealtime s[8:9]
    s_waitcnt lgkmcnt(0)
    s_sub_u32 s8, s8, s30
    s_cmpk_ge_u32 s8, 779
    s_cbranch_scc1 .ap_138
    s_waitcnt vmcnt(5)
    s_cmpk_ge_u32 s8, 679
    s_cbranch_scc1 .ap_138
    s_waitcnt vmcnt(4)
    s_cmpk_ge_u32 s8, 559
    s_cbranch_scc1 .ap_138
    s_waitcnt vmcnt(1)
.ap_138:
    s_add_u32 m0, s101, 32768
    s_add_u32 s56, s100, 2359296
    buffer_load_dwordx4 v6, s[48:51], s56 offen nt lds
    s_memrealtime s[8:9]
    s_waitcnt lgkmcnt(0)
    s_sub_u32 s8, s8, s30
    s_cmpk_ge_u32 s8, 779
    s_cbranch_scc1 .ap_139
    s_waitcnt vmcnt(5)
    s_cmpk_ge_u32 s8, 679
    s_cbranch_scc1 .ap_139
    s_waitcnt vmcnt(4)
    s_bitcmp1_b64 s[14:15], 19
    s_cbranch_scc0 1
    s_waitcnt vmcnt(2)
    s_cmpk_ge_u32 s8, 559
    s_cbranch_scc1 .ap_139
    s_waitcnt vmcnt(1)
.ap_139:
    s_add_u32 s63, s69, 286720
    buffer_load_dwordx4 v[84:87], v1, s[40:43], s63 offen nt
    s_memrealtime s[8:9]
    s_waitcnt vmcnt(8)
    s_waitcnt lgkmcnt(0)
    s_sub_u32 s8, s8, s30
    s_cmpk_ge_u32 s8, 814
    s_cbranch_scc1 .ap_140
    s_waitcnt vmcnt(5)
    s_cmpk_ge_u32 s8, 714
    s_cbranch_scc1 .ap_140
    s_waitcnt vmcnt(4)
    s_bitcmp1_b64 s[14:15], 20
    s_cbranch_scc0 1
    s_waitcnt vmcnt(2)
    s_cmpk_ge_u32 s8, 594
    s_cbranch_scc1 .ap_140
    s_waitcnt vmcnt(1)
.ap_140:
    s_add_u32 s63, s69, 294912
    buffer_load_dwordx4 v[112:115], v1, s[40:43], s63 offen nt
    s_memrealtime s[8:9]
    s_waitcnt vmcnt(8)
    s_waitcnt lgkmcnt(0)
    s_sub_u32 s8, s8, s30
    s_cmpk_ge_u32 s8, 849
    s_cbranch_scc1 .ap_141
    s_waitcnt vmcnt(5)
    s_cmpk_ge_u32 s8, 749
    s_cbranch_scc1 .ap_141
    s_waitcnt vmcnt(4)
    s_bitcmp1_b64 s[14:15], 21
    s_cbranch_scc0 1
    s_waitcnt vmcnt(2)
    s_cmpk_ge_u32 s8, 629
    s_cbranch_scc1 .ap_141
    s_waitcnt vmcnt(1)
.ap_141:
    s_add_u32 s63, s69, 303104
    buffer_load_dwordx4 v[116:119], v1, s[40:43], s63 offen nt
    s_memrealtime s[8:9]
    s_waitcnt vmcnt(8)
    s_waitcnt lgkmcnt(0)
    s_sub_u32 s8, s8, s30
    s_cmpk_ge_u32 s8, 884
    s_cbranch_scc1 .ap_142
    s_waitcnt vmcnt(5)
    s_cmpk_ge_u32 s8, 784
    s_cbranch_scc1 .ap_142
    s_waitcnt vmcnt(4)
    s_bitcmp1_b64 s[14:15], 22
    s_cbranch_scc0 1
    s_waitcnt vmcnt(2)
    s_cmpk_ge_u32 s8, 664
    s_cbranch_scc1 .ap_142
    s_branch .Lsk_b0_2
.Lst_b0_2:
    s_branch .Lrt_b0_2
.Lsk_b0_2:
    s_waitcnt vmcnt(1)
.ap_142:
    s_add_u32 s63, s69, 311296
    buffer_load_dwordx4 v[144:147], v1, s[40:43], s63 offen nt
    s_memrealtime s[8:9]
    s_waitcnt vmcnt(8)
    s_waitcnt lgkmcnt(0)
    s_sub_u32 s8, s8, s30
    s_cmpk_ge_u32 s8, 919
    s_cbranch_scc1 .ap_143
    s_branch .Lsk_b0_3
.Lst_b0_3:
    s_branch .Lrt_b0_3
.Lsk_b0_3:
    s_waitcnt vmcnt(5)
    s_cmpk_ge_u32 s8, 819
    s_cbranch_scc1 .ap_143
    s_waitcnt vmcnt(4)
    s_cmpk_ge_u32 s8, 699
    s_cbranch_scc1 .ap_143
    s_waitcnt vmcnt(1)
.ap_143:
    s_add_u32 m0, s101, 40960
    s_add_u32 s56, s100, 2949120
    buffer_load_dwordx4 v6, s[48:51], s56 offen nt lds
    s_memrealtime s[8:9]
    s_waitcnt vmcnt(8)
    s_waitcnt lgkmcnt(0)
    s_sub_u32 s8, s8, s30
    s_cmpk_ge_u32 s8, 919
    s_cbranch_scc1 .ap_144
    s_waitcnt vmcnt(5)
    s_cmpk_ge_u32 s8, 819
    s_cbranch_scc1 .ap_144
    s_waitcnt vmcnt(4)
    s_bitcmp1_b64 s[14:15], 23
    s_cbranch_scc0 1
    s_waitcnt vmcnt(2)
    s_cmpk_ge_u32 s8, 699
    s_cbranch_scc1 .ap_144
    s_waitcnt vmcnt(1)
.ap_144:
    s_add_u32 s63, s69, 319488
    buffer_load_dwordx4 v[148:151], v1, s[40:43], s63 offen nt
    s_memrealtime s[8:9]
    s_waitcnt vmcnt(8)
    s_waitcnt lgkmcnt(0)
    s_sub_u32 s8, s8, s30
    s_cmpk_ge_u32 s8, 954
    s_cbranch_scc1 .ap_145
    s_waitcnt vmcnt(5)
    s_cmpk_ge_u32 s8, 854
    s_cbranch_scc1 .ap_145
    s_waitcnt vmcnt(4)
    s_bitcmp1_b64 s[14:15], 24
    s_cbranch_scc0 1
    s_waitcnt vmcnt(2)
    s_cmpk_ge_u32 s8, 734
    s_cbranch_scc1 .ap_145
    s_waitcnt vmcnt(1)
.ap_145:
    s_add_u32 s63, s69, 393216
    buffer_load_dwordx4 v[56:59], v1, s[40:43], s63 offen nt
    s_memrealtime s[8:9]
    s_waitcnt vmcnt(8)
    s_waitcnt lgkmcnt(0)
    s_sub_u32 s8, s8, s30
    s_cmpk_ge_u32 s8, 990
    s_cbranch_scc1 .ap_146
    s_waitcnt vmcnt(5)
    s_cmpk_ge_u32 s8, 890
    s_cbranch_scc1 .ap_146
    s_waitcnt vmcnt(4)
    s_bitcmp1_b64 s[14:15], 25
    s_cbranch_scc0 1
    s_waitcnt vmcnt(2)
    s_cmpk_ge_u32 s8, 770
    s_cbranch_scc1 .ap_146
    s_waitcnt vmcnt(1)
.ap_146:
    s_add_u32 s63, s69, 401408
    buffer_load_dwordx4 v[60:63], v1, s[40:43], s63 offen nt
    s_memrealtime s[8:9]
    s_waitcnt vmcnt(8)
    s_waitcnt lgkmcnt(0)
    s_sub_u32 s8, s8, s30
    s_cmpk_ge_u32 s8, 1028
    s_cbranch_scc1 .ap_147
    s_waitcnt vmcnt(5)
    s_cmpk_ge_u32 s8, 928
    s_cbranch_scc1 .ap_147
    s_waitcnt vmcnt(4)
    s_bitcmp1_b64 s[14:15], 26
    s_cbranch_scc0 1
    s_waitcnt vmcnt(2)
    s_cmpk_ge_u32 s8, 808
    s_cbranch_scc1 .ap_147
    s_waitcnt vmcnt(1)
.ap_147:
    s_add_u32 s63, s69, 409600
    buffer_load_dwordx4 v[88:91], v1, s[40:43], s63 offen nt
    s_memrealtime s[8:9]
    s_waitcnt vmcnt(8)
    s_waitcnt lgkmcnt(0)
    s_sub_u32 s8, s8, s30
    s_cmpk_ge_u32 s8, 1067
    s_cbranch_scc1 .ap_148
    s_waitcnt vmcnt(5)
    s_cmpk_ge_u32 s8, 967
    s_cbranch_scc1 .ap_148
    s_waitcnt vmcnt(4)
    s_cmpk_ge_u32 s8, 847
    s_cbranch_scc1 .ap_148
    s_waitcnt vmcnt(1)
.ap_148:
    s_add_u32 m0, s101, 49152
    s_add_u32 s56, s100, 3538944
    buffer_load_dwordx4 v6, s[48:51], s56 offen nt lds
    s_memrealtime s[8:9]
    s_waitcnt vmcnt(8)
    s_waitcnt lgkmcnt(0)
    s_sub_u32 s8, s8, s30
    s_cmpk_ge_u32 s8, 1067
    s_cbranch_scc1 .ap_149
    s_waitcnt vmcnt(5)
    s_cmpk_ge_u32 s8, 967
    s_cbranch_scc1 .ap_149
    s_waitcnt vmcnt(4)
    s_bitcmp1_b64 s[14:15], 27
    s_cbranch_scc0 1
    s_waitcnt vmcnt(2)
    s_cmpk_ge_u32 s8, 847
    s_cbranch_scc1 .ap_149
    s_waitcnt vmcnt(1)
.ap_149:
    s_add_u32 s63, s69, 417792
    buffer_load_dwordx4 v[92:95], v1, s[40:43], s63 offen nt
    s_memrealtime s[8:9]
    s_waitcnt vmcnt(8)
    s_waitcnt lgkmcnt(0)
    s_sub_u32 s8, s8, s30
    s_cmpk_ge_u32 s8, 1106
    s_cbranch_scc1 .ap_150
    s_waitcnt vmcnt(5)
    s_cmpk_ge_u32 s8, 1006
    s_cbranch_scc1 .ap_150
    s_waitcnt vmcnt(4)
    s_bitcmp1_b64 s[14:15], 28
    s_cbranch_scc0 1
    s_waitcnt vmcnt(2)
    s_cmpk_ge_u32 s8, 886
    s_cbranch_scc1 .ap_150
    s_waitcnt vmcnt(1)
.ap_150:
    s_add_u32 s63, s69, 425984
    buffer_load_dwordx4 v[120:123], v1, s[40:43], s63 offen nt
    s_memrealtime s[8:9]
    s_waitcnt vmcnt(8)
    s_waitcnt lgkmcnt(0)
    s_sub_u32 s8, s8, s30
    s_cmpk_ge_u32 s8, 1145
    s_cbranch_scc1 .ap_151
    s_waitcnt vmcnt(5)
    s_cmpk_ge_u32 s8, 1045
    s_cbranch_scc1 .ap_151
    s_waitcnt vmcnt(4)
    s_bitcmp1_b64 s[14:15], 29
    s_cbranch_scc0 1
    s_waitcnt vmcnt(2)
    s_cmpk_ge_u32 s8, 925
    s_cbranch_scc1 .ap_151
    s_waitcnt vmcnt(1)
.ap_151:
    s_add_u32 s63, s69, 434176
    buffer_load_dwordx4 v[124:127], v1, s[40:43], s63 offen nt
    s_memrealtime s[8:9]
    s_waitcnt vmcnt(8)
    s_waitcnt lgkmcnt(0)
    s_sub_u32 s8, s8, s30
    s_cmpk_ge_u32 s8, 1184
    s_cbranch_scc1 .ap_152
    s_waitcnt vmcnt(5)
    s_cmpk_ge_u32 s8, 1084
    s_cbranch_scc1 .ap_152
    s_waitcnt vmcnt(4)
    s_bitcmp1_b64 s[14:15], 30
    s_cbranch_scc0 1
    s_waitcnt vmcnt(2)
    s_cmpk_ge_u32 s8, 964
    s_cbranch_scc1 .ap_152
    s_waitcnt vmcnt(1)
.ap_152:
    s_add_u32 s63, s69, 442368
    buffer_load_dwordx4 v[152:155], v1, s[40:43], s63 offen nt
    s_memrealtime s[8:9]
    s_waitcnt vmcnt(8)
    s_waitcnt lgkmcnt(0)
    s_sub_u32 s8, s8, s30
    s_cmpk_ge_u32 s8, 1223
    s_cbranch_scc1 .ap_153
    s_waitcnt vmcnt(5)
    s_cmpk_ge_u32 s8, 1123
    s_cbranch_scc1 .ap_153
    s_waitcnt vmcnt(4)
    s_cmpk_ge_u32 s8, 1003
    s_cbranch_scc1 .ap_153
    s_waitcnt vmcnt(1)
.ap_153:
    s_add_u32 m0, s101, 57344
    s_add_u32 s56, s100, 4128768
    buffer_load_dwordx4 v6, s[48:51], s56 offen nt lds
    s_memrealtime s[8:9]
    s_waitcnt vmcnt(8)
    s_waitcnt lgkmcnt(0)
    s_sub_u32 s8, s8, s30
    s_cmpk_ge_u32 s8, 1223
    s_cbranch_scc1 .ap_154
    s_waitcnt vmcnt(5)
    s_cmpk_ge_u32 s8, 1123
    s_cbranch_scc1 .ap_154
    s_waitcnt vmcnt(4)
    s_bitcmp1_b64 s[14:15], 31
    s_cbranch_scc0 1
    s_waitcnt vmcnt(2)
    s_cmpk_ge_u32 s8, 1003
    s_cbranch_scc1 .ap_154
    s_waitcnt vmcnt(1)
.ap_154:
    s_add_u32 s63, s69, 450560
    buffer_load_dwordx4 v[156:159], v1, s[40:43], s63 offen nt
    s_memrealtime s[8:9]
    s_waitcnt vmcnt(8)
    s_waitcnt lgkmcnt(0)
    s_sub_u32 s8, s8, s30
    s_cmpk_ge_u32 s8, 1262
    s_cbranch_scc1 .ap_155
    s_waitcnt vmcnt(5)
    s_cmpk_ge_u32 s8, 1162
    s_cbranch_scc1 .ap_155
    s_waitcnt vmcnt(4)
    s_bitcmp1_b64 s[14:15], 32
    s_cbranch_scc0 1
    s_waitcnt vmcnt(2)
    s_cmpk_ge_u32 s8, 1042
    s_cbranch_scc1 .ap_155
    s_waitcnt vmcnt(1)
.ap_155:
    v_bfe_u32 v1, v0, 4, 2
    v_and_b32 v10, 0xf0, v2
    v_lshlrev_b32 v1, 2, v1
    v_bfe_u32 v1, s6, v1, 4
    v_lshl_add_u32 v1, v1, 8, v10
    s_add_u32 s63, s69, 0
    buffer_load_dwordx4 v[160:163], v1, s[44:47], s63 offen nt
    s_branch .Lsk_b1_0
.Lst_b1_0:
    s_branch .Lrt_b1_0
.Lsk_b1_0:
    s_memrealtime s[8:9]
    s_waitcnt vmcnt(8)
    s_waitcnt lgkmcnt(0)
    s_sub_u32 s8, s8, s30
    s_cmpk_ge_u32 s8, 1298
    s_cbranch_scc1 .ap_156
    s_waitcnt vmcnt(5)
    s_cmpk_ge_u32 s8, 1198
    s_cbranch_scc1 .ap_156
    s_waitcnt vmcnt(4)
    s_bitcmp1_b64 s[14:15], 33
    s_cbranch_scc0 1
    s_waitcnt vmcnt(2)
    s_cmpk_ge_u32 s8, 1078
    s_cbranch_scc1 .ap_156
    s_waitcnt vmcnt(1)
.ap_156:
    s_add_u32 s63, s69, 8192
    buffer_load_dwordx4 v[164:167], v1, s[44:47], s63 offen nt
    s_memrealtime s[8:9]
    s_waitcnt vmcnt(8)
    s_waitcnt lgkmcnt(0)
    s_sub_u32 s8, s8, s30
    s_cmpk_ge_u32 s8, 1335
    s_cbranch_scc1 .ap_157
    s_waitcnt vmcnt(5)
    s_cmpk_ge_u32 s8, 1235
    s_cbranch_scc1 .ap_157
    s_waitcnt vmcnt(4)
    s_bitcmp1_b64 s[14:15], 34
    s_cbranch_scc0 1
    s_waitcnt vmcnt(2)
    s_cmpk_ge_u32 s8, 1115
    s_cbranch_scc1 .ap_157
    s_waitcnt vmcnt(1)
.ap_157:
    s_add_u32 s63, s69, 16384
    buffer_load_dwordx4 v[168:171], v1, s[44:47], s63 offen nt
    s_memrealtime s[8:9]
    s_waitcnt vmcnt(8)
    s_waitcnt lgkmcnt(0)
    s_sub_u32 s8, s8, s30
    s_cmpk_ge_u32 s8, 1371
    s_cbranch_scc1 .ap_158
    s_waitcnt vmcnt(5)
    s_cmpk_ge_u32 s8, 1271
    s_cbranch_scc1 .ap_158
    s_waitcnt vmcnt(4)
    s_cmpk_ge_u32 s8, 1151
    s_cbranch_scc1 .ap_158
    s_waitcnt vmcnt(1)
.ap_158:
    s_add_u32 m0, s101, 65536
    s_add_u32 s56, s100, 4718592
    buffer_load_dwordx4 v6, s[48:51], s56 offen nt lds
    s_memrealtime s[8:9]
    s_waitcnt vmcnt(8)
    s_waitcnt lgkmcnt(0)
    s_sub_u32 s8, s8, s30
    s_cmpk_ge_u32 s8, 1371
    s_cbranch_scc1 .ap_159
    s_waitcnt vmcnt(5)
    s_cmpk_ge_u32 s8, 1271
    s_cbranch_scc1 .ap_159
    s_waitcnt vmcnt(4)
    s_bitcmp1_b64 s[14:15], 35
    s_cbranch_scc0 1
    s_waitcnt vmcnt(2)
    s_cmpk_ge_u32 s8, 1151
    s_cbranch_scc1 .ap_159
    s_waitcnt vmcnt(1)
.ap_159:
    s_add_u32 s63, s69, 24576
    buffer_load_dwordx4 v[172:175], v1, s[44:47], s63 offen nt
    s_memrealtime s[8:9]
    s_waitcnt vmcnt(8)
    s_waitcnt lgkmcnt(0)
    s_sub_u32 s8, s8, s30
    s_cmpk_ge_u32 s8, 1408
    s_cbranch_scc1 .ap_160
    s_waitcnt vmcnt(5)
    s_cmpk_ge_u32 s8, 1308
    s_cbranch_scc1 .ap_160
    s_waitcnt vmcnt(4)
    s_bitcmp1_b64 s[14:15], 36
    s_cbranch_scc0 1
    s_waitcnt vmcnt(2)
    s_cmpk_ge_u32 s8, 1188
    s_cbranch_scc1 .ap_160
    s_waitcnt vmcnt(1)
.ap_160:
    s_add_u32 s63, s69, 32768
    buffer_load_dwordx4 v[176:179], v1, s[44:47], s63 offen nt
    buffer_load_dwordx4 v[16:19], v7, s[36:39], s58 offen offset:0 sc1
    buffer_load_dwordx4 v[20:23], v7, s[36:39], s58 offen offset:256 sc1
    s_memrealtime s[8:9]
    s_waitcnt vmcnt(8)
    s_waitcnt lgkmcnt(0)
    s_sub_u32 s8, s8, s30
    s_cmpk_ge_u32 s8, 1444
    s_cbranch_scc1 .ap_161
    s_waitcnt vmcnt(5)
    s_cmpk_ge_u32 s8, 1344
    s_cbranch_scc1 .ap_161
    s_waitcnt vmcnt(4)
    s_bitcmp1_b64 s[14:15], 37
    s_cbranch_scc0 1
    s_waitcnt vmcnt(2)
    s_cmpk_ge_u32 s8, 1224
    s_cbranch_scc1 .ap_161
    s_waitcnt vmcnt(1)
.ap_161:
    s_add_u32 s63, s69, 40960
    buffer_load_dwordx4 v[180:183], v1, s[44:47], s63 offen nt
    s_memrealtime s[8:9]
    s_waitcnt vmcnt(8)
    s_waitcnt lgkmcnt(0)
    s_sub_u32 s8, s8, s30
    s_cmpk_ge_u32 s8, 1481
    s_cbranch_scc1 .ap_162
    s_waitcnt vmcnt(5)
    s_cmpk_ge_u32 s8, 1381
    s_cbranch_scc1 .ap_162
    s_waitcnt vmcnt(4)
    s_bitcmp1_b64 s[14:15], 38
    s_cbranch_scc0 1
    s_waitcnt vmcnt(2)
    s_cmpk_ge_u32 s8, 1261
    s_cbranch_scc1 .ap_162
    s_waitcnt vmcnt(1)
.ap_162:
    s_add_u32 s63, s69, 49152
    buffer_load_dwordx4 v[184:187], v1, s[44:47], s63 offen nt
    s_memrealtime s[8:9]
    s_waitcnt vmcnt(8)
    s_waitcnt lgkmcnt(0)
    s_sub_u32 s8, s8, s30
    s_cmpk_ge_u32 s8, 1517
    s_cbranch_scc1 .ap_163
    s_waitcnt vmcnt(5)
    s_cmpk_ge_u32 s8, 1417
    s_cbranch_scc1 .ap_163
    s_waitcnt vmcnt(4)
    s_cmpk_ge_u32 s8, 1297
    s_cbranch_scc1 .ap_163
    s_waitcnt vmcnt(1)
.ap_163:
    s_add_u32 m0, s101, 73728
    s_add_u32 s56, s100, 0
    buffer_load_dwordx4 v6, s[52:55], s56 offen nt lds
    s_memrealtime s[8:9]
    s_waitcnt vmcnt(8)
    s_waitcnt lgkmcnt(0)
    s_sub_u32 s8, s8, s30
    s_cmpk_ge_u32 s8, 1517
    s_cbranch_scc1 .ap_164
    s_waitcnt vmcnt(5)
    s_cmpk_ge_u32 s8, 1417
    s_cbranch_scc1 .ap_164
    s_waitcnt vmcnt(4)
    s_bitcmp1_b64 s[14:15], 39
    s_cbranch_scc0 1
    s_waitcnt vmcnt(2)
    s_cmpk_ge_u32 s8, 1297
    s_cbranch_scc1 .ap_164
    s_waitcnt vmcnt(1)
.ap_164:
    s_add_u32 s63, s69, 57344
    buffer_load_dwordx4 v[188:191], v1, s[44:47], s63 offen nt
    s_memrealtime s[8:9]
    s_waitcnt vmcnt(8)
    s_waitcnt lgkmcnt(0)
    s_sub_u32 s8, s8, s30
    s_cmpk_ge_u32 s8, 1554
    s_cbranch_scc1 .ap_165
    s_waitcnt vmcnt(5)
    s_cmpk_ge_u32 s8, 1454
    s_cbranch_scc1 .ap_165
    s_waitcnt vmcnt(4)
    s_bitcmp1_b64 s[14:15], 40
    s_cbranch_scc0 1
    s_waitcnt vmcnt(2)
    s_cmpk_ge_u32 s8, 1334
    s_cbranch_scc1 .ap_165
    s_waitcnt vmcnt(1)
.ap_165:
    s_add_u32 s63, s69, 131072
    buffer_load_dwordx4 v[192:195], v1, s[44:47], s63 offen nt
    s_waitcnt vmcnt(5)
    s_branch .gpc_167
.gp_166:
    buffer_load_dwordx4 v[16:19], v7, s[36:39], s58 offen offset:0 sc1
    buffer_load_dwordx4 v[20:23], v7, s[36:39], s58 offen offset:256 sc1
    s_waitcnt vmcnt(0)
.gpc_167:
    v_min_u32 v10, v17, v19
    v_max_u32 v11, v17, v19
    v_min3_u32 v10, v10, v21, v23
    v_max3_u32 v11, v11, v21, v23
    v_cmp_eq_u32 vcc, s34, v10
    v_cmp_eq_u32 s[56:57], s34, v11
    s_and_b64 vcc, vcc, s[56:57]
    s_cmp_eq_u64 vcc, -1
    s_nop 2
    s_cbranch_scc1 .gpd_168
    s_sub_u32 s35, s35, 1
    s_cbranch_scc1 .Lexit
    s_sleep 1
    s_branch .gp_166
.gpd_168:
    s_mov_b32 vcc_lo, 0xcccccccc
    s_mov_b32 vcc_hi, 0xcccccccc
    v_cndmask_b32_e64 v24, v16, 0, vcc
    v_cndmask_b32_e64 v25, v18, 0, vcc
    v_cndmask_b32_e64 v26, v20, 0, vcc
    v_cndmask_b32_e64 v27, v22, 0, vcc
    v_cndmask_b32_e32 v28, 0, v16, vcc
    v_cndmask_b32_e32 v29, 0, v18, vcc
    v_cndmask_b32_e32 v30, 0, v20, vcc
    v_cndmask_b32_e32 v31, 0, v22, vcc
    v_mfma_f32_16x16x32_bf16 v[16:19], v[32:35], v[24:27], 0
    v_mfma_f32_16x16x32_bf16 v[32:35], v[40:43], v[24:27], 0
    v_mfma_f32_16x16x32_bf16 v[16:19], v[36:39], v[28:31], v[16:19]
    v_mfma_f32_16x16x32_bf16 v[40:43], v[48:51], v[24:27], 0
    v_mfma_f32_16x16x32_bf16 v[32:35], v[44:47], v[28:31], v[32:35]
    v_mfma_f32_16x16x32_bf16 v[48:51], v[56:59], v[24:27], 0
    v_mfma_f32_16x16x32_bf16 v[40:43], v[52:55], v[28:31], v[40:43]
    v_mfma_f32_16x16x32_bf16 v[56:59], v[64:67], v[24:27], 0
    v_mfma_f32_16x16x32_bf16 v[48:51], v[60:63], v[28:31], v[48:51]
    s_nop 1
    v_add_f32_dpp v10, v17, v16 row_ror:12 row_mask:0xf bank_mask:0x1
    s_branch .Lsk_b1_1
.Lst_b1_1:
    s_branch .Lrt_b1_1
.Lsk_b1_1:
    s_memrealtime s[8:9]
    s_waitcnt lgkmcnt(0)
    s_sub_u32 s8, s8, s30
    s_cmpk_ge_u32 s8, 1591
    s_nop 0
    s_cbranch_scc1 .ap_169
    s_waitcnt vmcnt(5)
    s_cmpk_ge_u32 s8, 1491
    s_cbranch_scc1 .ap_169
    s_waitcnt vmcnt(4)
    s_bitcmp1_b64 s[14:15], 41
    s_cbranch_scc0 1
    s_waitcnt vmcnt(2)
    s_cmpk_ge_u32 s8, 1371
    s_cbranch_scc1 .ap_169
    s_waitcnt vmcnt(1)
.ap_169:
    s_add_u32 s63, s69, 139264
    buffer_load_dwordx4 v[196:199], v1, s[44:47], s63 offen nt
    v_mfma_f32_16x16x32_bf16 v[64:67], v[72:75], v[24:27], 0
    v_mfma_f32_16x16x32_bf16 v[56:59], v[68:71], v[28:31], v[56:59]
    v_add_f32_dpp v11, v33, v32 row_ror:12 row_mask:0xf bank_mask:0x1
    v_add_f32_dpp v10, v18, v10 row_ror:8 row_mask:0xf bank_mask:0x1
    v_mfma_f32_16x16x32_bf16 v[72:75], v[80:83], v[24:27], 0
    v_mfma_f32_16x16x32_bf16 v[64:67], v[76:79], v[28:31], v[64:67]
    v_add_f32_dpp v12, v41, v40 row_ror:12 row_mask:0xf bank_mask:0x1
    v_add_f32_dpp v11, v34, v11 row_ror:8 row_mask:0xf bank_mask:0x1
    v_add_f32_dpp v10, v19, v10 row_ror:4 row_mask:0xf bank_mask:0x1
    v_mfma_f32_16x16x32_bf16 v[80:83], v[88:91], v[24:27], 0
    v_mfma_f32_16x16x32_bf16 v[72:75], v[84:87], v[28:31], v[72:75]
    v_add_f32_dpp v13, v49, v48 row_ror:12 row_mask:0xf bank_mask:0x1
    v_add_f32_dpp v12, v42, v12 row_ror:8 row_mask:0xf bank_mask:0x1
    v_add_f32_dpp v11, v35, v11 row_ror:4 row_mask:0xf bank_mask:0x1
    v_mfma_f32_16x16x32_bf16 v[88:91], v[96:99], v[24:27], 0
    v_mfma_f32_16x16x32_bf16 v[80:83], v[92:95], v[28:31], v[80:83]
    v_add_f32_dpp v10, v58, v57 row_ror:12 row_mask:0xf bank_mask:0x2
    v_add_f32_dpp v13, v50, v13 row_ror:8 row_mask:0xf bank_mask:0x1
    v_add_f32_dpp v12, v43, v12 row_ror:4 row_mask:0xf bank_mask:0x1
    s_memrealtime s[8:9]
    s_waitcnt lgkmcnt(0)
    s_sub_u32 s8, s8, s30
    s_cmpk_ge_u32 s8, 1602
    s_nop 0
    s_cbranch_scc1 .ap_170
    s_waitcnt vmcnt(5)
    s_cmpk_ge_u32 s8, 1502
    s_cbranch_scc1 .ap_170
    s_waitcnt vmcnt(4)
    s_bitcmp1_b64 s[14:15], 42
    s_cbranch_scc0 1
    s_waitcnt vmcnt(2)
    s_cmpk_ge_u32 s8, 1382
    s_cbranch_scc1 .ap_170
    s_waitcnt vmcnt(1)
.ap_170:
    s_add_u32 s63, s69, 147456
    buffer_load_dwordx4 v[200:203], v1, s[44:47], s63 offen nt
    s_memrealtime s[8:9]
    s_waitcnt lgkmcnt(0)
    s_sub_u32 s8, s8, s30
    s_cmpk_ge_u32 s8, 1613
    s_cbranch_scc1 .ap_171
    s_waitcnt vmcnt(5)
    s_cmpk_ge_u32 s8, 1513
    s_cbranch_scc1 .ap_171
    s_waitcnt vmcnt(4)
    s_cmpk_ge_u32 s8, 1393
    s_cbranch_scc1 .ap_171
    s_waitcnt vmcnt(1)
.ap_171:
    s_add_u32 m0, s101, 81920
    s_add_u32 s56, s100, 589824
    buffer_load_dwordx4 v6, s[52:55], s56 offen nt lds
    v_mfma_f32_16x16x32_bf16 v[96:99], v[104:107], v[24:27], 0
    v_mfma_f32_16x16x32_bf16 v[88:91], v[100:103], v[28:31], v[88:91]
    v_add_f32_dpp v11, v66, v65 row_ror:12 row_mask:0xf bank_mask:0x2
    v_add_f32_dpp v10, v59, v10 row_ror:8 row_mask:0xf bank_mask:0x2
    v_add_f32_dpp v13, v51, v13 row_ror:4 row_mask:0xf bank_mask:0x1
    v_mfma_f32_16x16x32_bf16 v[104:107], v[112:115], v[24:27], 0
    v_mfma_f32_16x16x32_bf16 v[96:99], v[108:111], v[28:31], v[96:99]
    v_add_f32_dpp v12, v74, v73 row_ror:12 row_mask:0xf bank_mask:0x2
    v_add_f32_dpp v11, v67, v11 row_ror:8 row_mask:0xf bank_mask:0x2
    v_add_f32_dpp v10, v56, v10 row_ror:4 row_mask:0xf bank_mask:0x2
    v_mfma_f32_16x16x32_bf16 v[112:115], v[120:123], v[24:27], 0
    v_mfma_f32_16x16x32_bf16 v[104:107], v[116:119], v[28:31], v[104:107]
    v_add_f32_dpp v13, v82, v81 row_ror:12 row_mask:0xf bank_mask:0x2
    v_add_f32_dpp v12, v75, v12 row_ror:8 row_mask:0xf bank_mask:0x2
    v_add_f32_dpp v11, v64, v11 row_ror:4 row_mask:0xf bank_mask:0x2
    v_mfma_f32_16x16x32_bf16 v[120:123], v[128:131], v[24:27], 0
    v_mfma_f32_16x16x32_bf16 v[112:115], v[124:127], v[28:31], v[112:115]
    v_add_f32_dpp v10, v91, v90 row_ror:12 row_mask:0xf bank_mask:0x4
    v_add_f32_dpp v13, v83, v13 row_ror:8 row_mask:0xf bank_mask:0x2
    v_add_f32_dpp v12, v72, v12 row_ror:4 row_mask:0xf bank_mask:0x2
    s_memrealtime s[8:9]
    s_waitcnt lgkmcnt(0)
    s_sub_u32 s8, s8, s30
    s_cmpk_ge_u32 s8, 1613
    s_nop 0
    s_cbranch_scc1 .ap_172
    s_waitcnt vmcnt(5)
    s_cmpk_ge_u32 s8, 1513
    s_cbranch_scc1 .ap_172
    s_waitcnt vmcnt(4)
    s_bitcmp1_b64 s[14:15], 43
    s_cbranch_scc0 1
    s_waitcnt vmcnt(2)
    s_cmpk_ge_u32 s8, 1393
    s_cbranch_scc1 .ap_172
    s_waitcnt vmcnt(1)
.ap_172:
    s_add_u32 s63, s69, 155648
    buffer_load_dwordx4 v[204:207], v1, s[44:47], s63 offen nt
    v_mfma_f32_16x16x32_bf16 v[128:131], v[136:139], v[24:27], 0
    v_mfma_f32_16x16x32_bf16 v[120:123], v[132:135], v[28:31], v[120:123]
    v_add_f32_dpp v11, v99, v98 row_ror:12 row_mask:0xf bank_mask:0x4
    v_add_f32_dpp v10, v88, v10 row_ror:8 row_mask:0xf bank_mask:0x4
    v_add_f32_dpp v13, v80, v13 row_ror:4 row_mask:0xf bank_mask:0x2
    v_mfma_f32_16x16x32_bf16 v[136:139], v[144:147], v[24:27], 0
    v_mfma_f32_16x16x32_bf16 v[128:131], v[140:143], v[28:31], v[128:131]
    v_add_f32_dpp v12, v107, v106 row_ror:12 row_mask:0xf bank_mask:0x4
    v_add_f32_dpp v11, v96, v11 row_ror:8 row_mask:0xf bank_mask:0x4
    v_add_f32_dpp v10, v89, v10 row_ror:4 row_mask:0xf bank_mask:0x4
    v_mfma_f32_16x16x32_bf16 v[144:147], v[152:155], v[24:27], 0
    v_mfma_f32_16x16x32_bf16 v[136:139], v[148:151], v[28:31], v[136:139]
    v_add_f32_dpp v13, v115, v114 row_ror:12 row_mask:0xf bank_mask:0x4
    v_add_f32_dpp v12, v104, v12 row_ror:8 row_mask:0xf bank_mask:0x4
    v_add_f32_dpp v11, v97, v11 row_ror:4 row_mask:0xf bank_mask:0x4
    v_mfma_f32_16x16x32_bf16 v[144:147], v[156:159], v[28:31], v[144:147]
    v_add_f32_dpp v10, v120, v123 row_ror:12 row_mask:0xf bank_mask:0x8
    v_add_f32_dpp v13, v112, v13 row_ror:8 row_mask:0xf bank_mask:0x4
    v_add_f32_dpp v12, v105, v12 row_ror:4 row_mask:0xf bank_mask:0x4
    s_memrealtime s[8:9]
    s_waitcnt vmcnt(8)
    s_waitcnt lgkmcnt(0)
    s_sub_u32 s8, s8, s30
    s_cmpk_ge_u32 s8, 1624
    s_cbranch_scc1 .ap_173
    s_waitcnt vmcnt(5)
    s_cmpk_ge_u32 s8, 1524
    s_cbranch_scc1 .ap_173
    s_waitcnt vmcnt(4)
    s_bitcmp1_b64 s[14:15], 44
    s_cbranch_scc0 1
    s_waitcnt vmcnt(2)
    s_cmpk_ge_u32 s8, 1404
    s_cbranch_scc1 .ap_173
    s_waitcnt vmcnt(1)
.ap_173:
    s_add_u32 s63, s69, 163840
    buffer_load_dwordx4 v[208:211], v1, s[44:47], s63 offen nt
    s_cmp_eq_u32 s3, 0
    s_cbranch_scc1 .Lst_b2_0
    s_cmp_eq_u32 s3, 1
    s_cbranch_scc1 .Lst_b2_1
    s_cmp_eq_u32 s3, 2
    s_cbranch_scc1 .Lst_b2_2
    s_cmp_eq_u32 s3, 3
    s_cbranch_scc1 .Lst_b2_3
.Lrt_b2_0:
.Lrt_b2_1:
.Lrt_b2_2:
.Lrt_b2_3:
    v_add_f32_dpp v11, v128, v131 row_ror:12 row_mask:0xf bank_mask:0x8
    v_add_f32_dpp v10, v121, v10 row_ror:8 row_mask:0xf bank_mask:0x8
    v_add_f32_dpp v13, v113, v13 row_ror:4 row_mask:0xf bank_mask:0x4
    v_add_f32_dpp v12, v136, v139 row_ror:12 row_mask:0xf bank_mask:0x8
    v_add_f32_dpp v11, v129, v11 row_ror:8 row_mask:0xf bank_mask:0x8
    v_add_f32_dpp v10, v122, v10 row_ror:4 row_mask:0xf bank_mask:0x8
    v_add_f32_dpp v13, v144, v147 row_ror:12 row_mask:0xf bank_mask:0x8
    v_add_f32_dpp v12, v137, v12 row_ror:8 row_mask:0xf bank_mask:0x8
    v_add_f32_dpp v11, v130, v11 row_ror:4 row_mask:0xf bank_mask:0x8
    v_add_f32_dpp v13, v145, v13 row_ror:8 row_mask:0xf bank_mask:0x8
    v_add_f32_dpp v12, v138, v12 row_ror:4 row_mask:0xf bank_mask:0x8
    s_memrealtime s[8:9]
    s_waitcnt vmcnt(8)
    s_waitcnt lgkmcnt(0)
    s_sub_u32 s8, s8, s30
    s_cmpk_ge_u32 s8, 1636
    s_cbranch_scc1 .ap_174
    s_waitcnt vmcnt(5)
    s_cmpk_ge_u32 s8, 1536
    s_cbranch_scc1 .ap_174
    s_waitcnt vmcnt(4)
    s_bitcmp1_b64 s[14:15], 45
    s_cbranch_scc0 1
    s_waitcnt vmcnt(2)
    s_cmpk_ge_u32 s8, 1416
    s_cbranch_scc1 .ap_174
    s_branch .Lsk_b1_2
.Lst_b1_2:
    s_branch .Lrt_b1_2
.Lsk_b1_2:
    s_waitcnt vmcnt(1)
.ap_174:
    s_add_u32 s63, s69, 172032
    buffer_load_dwordx4 v[212:215], v1, s[44:47], s63 offen nt
    v_add_f32_dpp v13, v146, v13 row_ror:4 row_mask:0xf bank_mask:0x8
    s_mov_b32 s60, 0x3db504f3
    s_mov_b32 s61, 0x3db504f3
    v_cvt_pk_bf16_f32 v10, v10, v11
    v_and_b32 v11, 0xffff0000, v10
    v_lshlrev_b32 v10, 16, v10
    v_cvt_pk_bf16_f32 v12, v12, v13
    v_and_b32 v13, 0xffff0000, v12
    v_lshlrev_b32 v12, 16, v12
    v_pk_mul_f32 v[10:11], v[10:11], s[60:61]
    v_pk_mul_f32 v[12:13], v[12:13], s[60:61]
    v_cvt_pk_bf16_f32 v10, v10, v11
    v_and_b32 v11, 0xffff0000, v10
    v_lshlrev_b32 v10, 16, v10
    v_cvt_pk_bf16_f32 v12, v12, v13
    v_and_b32 v13, 0xffff0000, v12
    v_lshlrev_b32 v12, 16, v12
    v_max_f32 v14, v10, v11
    v_max3_f32 v14, v14, v12, v13
    s_mov_b32 s60, 0x3fb8aa3b
    v_mov_b32 v22, s34
    v_mov_b32 v23, s34
    v_max_f32_dpp v14, v14, v14 quad_perm:[2,3,0,1] row_mask:0xf bank_mask:0xf
    s_nop 1
    v_max_f32_dpp v14, v14, v14 row_ror:4 row_mask:0xf bank_mask:0xf
    s_nop 1
    v_max_f32_dpp v14, v14, v14 row_ror:8 row_mask:0xf bank_mask:0xf
    v_mov_b32 v15, v14
    s_nop 1
    v_permlane16_swap_b32 v15, v14
    v_max_f32 v14, v15, v14
    v_mov_b32 v15, v14
    s_nop 1
    v_permlane32_swap_b32 v15, v14
    v_max_f32 v14, v15, v14
    v_mul_f32 v15, 0xbfb8aa3b, v14
    v_fma_f32 v10, v10, s60, v15
    v_fma_f32 v11, v11, s60, v15
    v_fma_f32 v12, v12, s60, v15
    v_fma_f32 v13, v13, s60, v15
    v_exp_f32 v10, v10
    v_exp_f32 v11, v11
    v_exp_f32 v12, v12
    v_exp_f32 v13, v13
    v_mov_b32 v20, v14
    v_pk_add_f32 v[16:17], v[10:11], v[12:13]
    v_add_f32 v21, v16, v17
    s_lshl_b32 s60, s68, 5
    s_lshl_b32 s61, s3, 4
    s_add_u32 s61, s61, 159104
    v_add_u32 v16, s61, v3
    v_mov_b32 v17, 159232
    v_mov_b32 v18, 1
    s_add_u32 s60, s60, s59
    v_add_f32_dpp v21, v21, v21 quad_perm:[2,3,0,1] row_mask:0xf bank_mask:0xf
    s_nop 1
    v_add_f32_dpp v21, v21, v21 row_ror:4 row_mask:0xf bank_mask:0xf
    s_nop 1
    v_add_f32_dpp v21, v21, v21 row_ror:8 row_mask:0xf bank_mask:0xf
    v_mov_b32 v15, v21
    s_nop 1
    v_permlane16_swap_b32 v15, v21
    v_add_f32 v21, v15, v21
    v_mov_b32 v15, v21
    s_nop 1
    v_permlane32_swap_b32 v15, v21
    v_add_f32 v21, v15, v21
    s_mov_b64 exec, 3
    ds_write_b64 v16, v[20:21]
    s_mov_b64 exec, 1
    ds_add_rtn_u32 v18, v17, v18
    s_mov_b64 exec, -1
    v_and_b32 v16, 0x78, v3
    v_or_b32 v16, 159104, v16
    s_waitcnt lgkmcnt(0)
    v_readfirstlane_b32 s61, v18
    s_cmp_eq_u32 s61, 7
    s_nop 3
    s_cbranch_scc0 .mlc_175
    ds_read_b64 v[18:19], v16
    s_waitcnt lgkmcnt(0)
    v_mov_b32 v20, v18
    s_nop 1
    v_max_f32_dpp v20, v20, v20 quad_perm:[2,3,0,1] row_mask:0xf bank_mask:0xf
    s_nop 1
    v_max_f32_dpp v20, v20, v20 row_ror:4 row_mask:0xf bank_mask:0xf
    s_nop 1
    v_max_f32_dpp v20, v20, v20 row_ror:8 row_mask:0xf bank_mask:0xf
    v_sub_f32 v18, v18, v20
    v_mul_f32 v18, 0x3fb8aa3b, v18
    v_exp_f32 v18, v18
    s_nop 0
    v_mul_f32 v21, v18, v19
    s_nop 1
    v_add_f32_dpp v21, v21, v21 quad_perm:[2,3,0,1] row_mask:0xf bank_mask:0xf
    s_nop 1
    v_add_f32_dpp v21, v21, v21 row_ror:4 row_mask:0xf bank_mask:0xf
    s_nop 1
    v_add_f32_dpp v21, v21, v21 row_ror:8 row_mask:0xf bank_mask:0xf
    s_mov_b64 exec, 3
    buffer_store_dwordx4 v[20:23], v2, s[36:39], s60 offen sc1
    s_mov_b64 exec, -1
.mlc_175:
    s_memrealtime s[8:9]
    s_waitcnt vmcnt(8)
    s_waitcnt lgkmcnt(0)
    s_sub_u32 s8, s8, s30
    s_cmpk_ge_u32 s8, 1668
    s_cbranch_scc1 .ap_176
    s_waitcnt vmcnt(5)
    s_cmpk_ge_u32 s8, 1568
    s_cbranch_scc1 .ap_176
    s_waitcnt vmcnt(4)
    s_bitcmp1_b64 s[14:15], 46
    s_cbranch_scc0 1
    s_waitcnt vmcnt(2)
    s_cmpk_ge_u32 s8, 1448
    s_cbranch_scc1 .ap_176
    s_waitcnt vmcnt(1)
.ap_176:
    s_add_u32 s63, s69, 180224
    buffer_load_dwordx4 v[216:219], v1, s[44:47], s63 offen nt
    s_memrealtime s[8:9]
    s_waitcnt vmcnt(8)
    s_waitcnt lgkmcnt(0)
    s_sub_u32 s8, s8, s30
    s_cmpk_ge_u32 s8, 1700
    s_cbranch_scc1 .ap_177
    s_waitcnt vmcnt(5)
    s_cmpk_ge_u32 s8, 1600
    s_cbranch_scc1 .ap_177
    s_waitcnt vmcnt(4)
    s_bitcmp1_b64 s[14:15], 47
    s_cbranch_scc0 1
    s_waitcnt vmcnt(2)
    s_cmpk_ge_u32 s8, 1480
    s_cbranch_scc1 .ap_177
    s_waitcnt vmcnt(1)
.ap_177:
    s_add_u32 s63, s69, 188416
    buffer_load_dwordx4 v[220:223], v1, s[44:47], s63 offen nt
    s_and_b32 s56, s64, 0
    s_mul_i32 s56, s56, 18432
    s_mul_i32 s57, s3, 2304
    s_add_u32 s56, s56, s57
    s_add_u32 s56, s56, 0x37000
    buffer_load_dwordx4 v[32:35], v2, s[36:39], s56 offen offset:0 sc1
    buffer_load_dwordx4 v[40:43], v2, s[36:39], s56 offen offset:1024 sc1
    buffer_load_dwordx2 v[48:49], v5, s[36:39], s56 offen offset:0 sc1
    s_branch .Lsk_b1_3
.Lst_b1_3:
    s_branch .Lrt_b1_3
.Lsk_b1_3:
    s_memrealtime s[8:9]
    s_waitcnt vmcnt(11)
    s_waitcnt lgkmcnt(0)
    s_sub_u32 s8, s8, s30
    s_cmpk_ge_u32 s8, 1732
    s_cbranch_scc1 .ap_178
    s_waitcnt vmcnt(8)
    s_cmpk_ge_u32 s8, 1632
    s_cbranch_scc1 .ap_178
    s_waitcnt vmcnt(7)
    s_bitcmp1_b64 s[14:15], 48
    s_cbranch_scc0 1
    s_waitcnt vmcnt(5)
    s_cmpk_ge_u32 s8, 1512
    s_cbranch_scc1 .ap_178
    s_waitcnt vmcnt(4)
.ap_178:
    s_add_u32 s63, s69, 262144
    buffer_load_dwordx4 v[224:227], v1, s[44:47], s63 offen nt
    s_memrealtime s[8:9]
    s_waitcnt vmcnt(11)
    s_waitcnt lgkmcnt(0)
    s_sub_u32 s8, s8, s30
    s_cmpk_ge_u32 s8, 1764
    s_cbranch_scc1 .ap_179
    s_waitcnt vmcnt(8)
    s_cmpk_ge_u32 s8, 1664
    s_cbranch_scc1 .ap_179
    s_waitcnt vmcnt(7)
    s_bitcmp1_b64 s[14:15], 49
    s_cbranch_scc0 1
    s_waitcnt vmcnt(5)
    s_cmpk_ge_u32 s8, 1544
    s_cbranch_scc1 .ap_179
    s_waitcnt vmcnt(4)
.ap_179:
    s_add_u32 s63, s69, 270336
    buffer_load_dwordx4 v[228:231], v1, s[44:47], s63 offen nt
    s_and_b32 s56, s64, 0
    s_mul_i32 s56, s56, 18432
    s_mul_i32 s57, s3, 2304
    s_add_u32 s56, s56, s57
    s_add_u32 s56, s56, 0x49000
    buffer_load_dwordx4 v[56:59], v2, s[36:39], s56 offen offset:0 sc1
    buffer_load_dwordx4 v[64:67], v2, s[36:39], s56 offen offset:1024 sc1
    buffer_load_dwordx2 v[72:73], v5, s[36:39], s56 offen offset:0 sc1
    s_memrealtime s[8:9]
    s_waitcnt vmcnt(14)
    s_waitcnt lgkmcnt(0)
    s_sub_u32 s8, s8, s30
    s_cmpk_ge_u32 s8, 1796
    s_cbranch_scc1 .ap_180
    s_waitcnt vmcnt(11)
    s_cmpk_ge_u32 s8, 1696
    s_cbranch_scc1 .ap_180
    s_waitcnt vmcnt(10)
    s_bitcmp1_b64 s[14:15], 50
    s_cbranch_scc0 1
    s_waitcnt vmcnt(8)
    s_cmpk_ge_u32 s8, 1576
    s_cbranch_scc1 .ap_180
    s_waitcnt vmcnt(4)
.ap_180:
    s_add_u32 s63, s69, 278528
    buffer_load_dwordx4 v[232:235], v1, s[44:47], s63 offen nt
    s_memrealtime s[8:9]
    s_waitcnt vmcnt(14)
    s_waitcnt lgkmcnt(0)
    s_sub_u32 s8, s8, s30
    s_cmpk_ge_u32 s8, 1828
    s_cbranch_scc1 .ap_181
    s_waitcnt vmcnt(11)
    s_cmpk_ge_u32 s8, 1728
    s_cbranch_scc1 .ap_181
    s_waitcnt vmcnt(10)
    s_bitcmp1_b64 s[14:15], 51
    s_cbranch_scc0 1
    s_waitcnt vmcnt(5)
    s_cmpk_ge_u32 s8, 1608
    s_cbranch_scc1 .ap_181
    s_waitcnt vmcnt(4)
.ap_181:
    s_add_u32 s63, s69, 286720
    buffer_load_dwordx4 v[236:239], v1, s[44:47], s63 offen nt
    s_memrealtime s[8:9]
    s_waitcnt vmcnt(14)
    s_waitcnt lgkmcnt(0)
    s_sub_u32 s8, s8, s30
    s_cmpk_ge_u32 s8, 1860
    s_cbranch_scc1 .ap_182
    s_waitcnt vmcnt(11)
    s_cmpk_ge_u32 s8, 1760
    s_cbranch_scc1 .ap_182
    s_waitcnt vmcnt(10)
    s_bitcmp1_b64 s[14:15], 52
    s_cbranch_scc0 1
    s_waitcnt vmcnt(5)
    s_cmpk_ge_u32 s8, 1640
    s_cbranch_scc1 .ap_182
    s_waitcnt vmcnt(1)
.ap_182:
    s_add_u32 s63, s69, 294912
    buffer_load_dwordx4 v[240:243], v1, s[44:47], s63 offen nt
    s_memrealtime s[8:9]
    s_waitcnt vmcnt(14)
    s_waitcnt lgkmcnt(0)
    s_sub_u32 s8, s8, s30
    s_cmpk_ge_u32 s8, 1892
    s_cbranch_scc1 .ap_183
    s_waitcnt vmcnt(11)
    s_cmpk_ge_u32 s8, 1792
    s_cbranch_scc1 .ap_183
    s_waitcnt vmcnt(7)
    s_bitcmp1_b64 s[14:15], 53
    s_cbranch_scc0 1
    s_waitcnt vmcnt(2)
    s_cmpk_ge_u32 s8, 1672
    s_cbranch_scc1 .ap_183
    s_waitcnt vmcnt(1)
.ap_183:
    s_add_u32 s63, s69, 303104
    buffer_load_dwordx4 v[244:247], v1, s[44:47], s63 offen nt
    s_and_b32 s0, s0, 0xffffff80
    s_sub_u32 s0, s0, 1024
    buffer_load_dword v28, v4, s[36:39], s0 offen sc1
    buffer_load_dwordx4 v[24:27], v9, s[36:39], s59 offen offset:0 sc1
    s_memrealtime s[8:9]
    s_waitcnt vmcnt(15)
    s_waitcnt lgkmcnt(0)
    s_sub_u32 s8, s8, s30
    s_cmpk_ge_u32 s8, 1924
    s_cbranch_scc1 .ap_184
    s_waitcnt vmcnt(9)
    s_cmpk_ge_u32 s8, 1824
    s_cbranch_scc1 .ap_184
    s_waitcnt vmcnt(5)
    s_bitcmp1_b64 s[14:15], 54
    s_cbranch_scc0 1
    s_waitcnt vmcnt(3)
    s_cmpk_ge_u32 s8, 1704
    s_cbranch_scc1 .ap_184
    s_waitcnt vmcnt(2)
.ap_184:
    s_add_u32 s63, s69, 311296
    buffer_load_dwordx4 v[248:251], v1, s[44:47], s63 offen nt
    s_memrealtime s[8:9]
    s_waitcnt vmcnt(15)
    s_waitcnt lgkmcnt(0)
    s_sub_u32 s8, s8, s30
    s_cmpk_ge_u32 s8, 1956
    s_cbranch_scc1 .ap_185
    s_waitcnt vmcnt(6)
    s_cmpk_ge_u32 s8, 1856
    s_cbranch_scc1 .ap_185
    s_waitcnt vmcnt(5)
    s_bitcmp1_b64 s[14:15], 55
    s_cbranch_scc0 1
    s_waitcnt vmcnt(3)
    s_cmpk_ge_u32 s8, 1736
    s_cbranch_scc1 .ap_185
    s_waitcnt vmcnt(1)
.ap_185:
    s_add_u32 s63, s69, 319488
    buffer_load_dwordx4 v[252:255], v1, s[44:47], s63 offen nt
    s_memrealtime s[8:9]
    s_waitcnt vmcnt(12)
    s_waitcnt lgkmcnt(0)
    s_sub_u32 s8, s8, s30
    s_cmpk_ge_u32 s8, 1988
    s_cbranch_scc1 .ap_186
    s_waitcnt vmcnt(6)
    s_cmpk_ge_u32 s8, 1888
    s_cbranch_scc1 .ap_186
    s_waitcnt vmcnt(5)
    s_bitcmp1_b64 s[14:15], 56
    s_cbranch_scc0 1
    s_waitcnt vmcnt(2)
    s_cmpk_ge_u32 s8, 1768
    s_cbranch_scc1 .ap_186
    s_waitcnt vmcnt(1)
.ap_186:
    s_add_u32 s63, s69, 393216
    buffer_load_dwordx4 v[36:39], v1, s[44:47], s63 offen nt
    s_memrealtime s[8:9]
    s_waitcnt vmcnt(12)
    s_waitcnt lgkmcnt(0)
    s_sub_u32 s8, s8, s30
    s_cmpk_ge_u32 s8, 2020
    s_cbranch_scc1 .ap_187
    s_waitcnt vmcnt(6)
    s_cmpk_ge_u32 s8, 1920
    s_cbranch_scc1 .ap_187
    s_waitcnt vmcnt(5)
    s_bitcmp1_b64 s[14:15], 57
    s_cbranch_scc0 1
    s_waitcnt vmcnt(2)
    s_cmpk_ge_u32 s8, 1800
    s_cbranch_scc1 .ap_187
    s_waitcnt vmcnt(1)
.ap_187:
    s_add_u32 s63, s69, 401408
    buffer_load_dwordx4 v[44:47], v1, s[44:47], s63 offen nt
    s_memrealtime s[8:9]
    s_waitcnt vmcnt(9)
    s_waitcnt lgkmcnt(0)
    s_sub_u32 s8, s8, s30
    s_cmpk_ge_u32 s8, 2052
    s_cbranch_scc1 .ap_188
    s_waitcnt vmcnt(6)
    s_cmpk_ge_u32 s8, 1952
    s_cbranch_scc1 .ap_188
    s_waitcnt vmcnt(4)
    s_bitcmp1_b64 s[14:15], 58
    s_cbranch_scc0 1
    s_waitcnt vmcnt(2)
    s_cmpk_ge_u32 s8, 1832
    s_cbranch_scc1 .ap_188
    s_waitcnt vmcnt(1)
.ap_188:
    s_add_u32 s63, s69, 409600
    buffer_load_dwordx4 v[52:55], v1, s[44:47], s63 offen nt
    s_waitcnt vmcnt(5)
    s_branch .gpc_190
.gp_189:
    buffer_load_dwordx4 v[24:27], v9, s[36:39], s59 offen offset:0 sc1
    s_waitcnt vmcnt(0)
.gpc_190:
    v_cmp_eq_u32 vcc, s34, v26
    s_cmp_eq_u64 vcc, -1
    s_nop 3
    s_cbranch_scc1 .gpd_191
    s_sub_u32 s35, s35, 1
    s_cbranch_scc1 .Lexit
    s_sleep 1
    s_branch .gp_189
.gpd_191:
    v_cmp_eq_u32 vcc, s1, v28
    s_cmp_eq_u64 vcc, -1
    s_cselect_b32 s0, 0x800000, 0
    s_branch .Lsk_b1_4
.Lst_b1_4:
    s_branch .Lrt_b1_4
.Lsk_b1_4:
    v_mov_b32 v16, v24
    s_nop 1
    v_max_f32_dpp v16, v16, v16 row_ror:4 row_mask:0xf bank_mask:0xf
    v_sub_f32 v17, v24, v16
    v_sub_f32 v18, v14, v16
    v_mul_f32 v17, 0x3fb8aa3b, v17
    v_mul_f32 v18, 0x3fb8aa3b, v18
    v_exp_f32 v17, v17
    v_exp_f32 v18, v18
    v_mul_f32 v17, v17, v25
    s_nop 1
    v_add_f32_dpp v17, v17, v17 row_ror:4 row_mask:0xf bank_mask:0xf
    v_rcp_f32 v19, v17
    s_nop 0
    v_fma_f32 v15, -v17, v19, 1.0
    v_fma_f32 v19, v15, v19, v19
    v_mul_f32 v18, v18, v19
    v_mul_f32 v10, v10, v18
    v_mul_f32 v11, v11, v18
    v_mul_f32 v12, v12, v18
    v_mul_f32 v13, v13, v18
    v_mov_b32_dpp v112, v10 quad_perm:[2,3,0,1] row_mask:0xf bank_mask:0xf
    v_mov_b32_dpp v113, v11 quad_perm:[2,3,0,1] row_mask:0xf bank_mask:0xf
    v_mov_b32_dpp v114, v12 quad_perm:[2,3,0,1] row_mask:0xf bank_mask:0xf
    v_mov_b32_dpp v115, v13 quad_perm:[2,3,0,1] row_mask:0xf bank_mask:0xf
    v_cvt_pk_bf16_f32 v96, v10, v112
    v_cvt_pk_bf16_f32 v100, v11, v113
    v_cvt_pk_bf16_f32 v104, v12, v114
    v_cvt_pk_bf16_f32 v108, v13, v115
    v_mov_b32_dpp v97, v96 row_ror:12 row_mask:0xf bank_mask:0xf
    v_mov_b32_dpp v101, v100 row_ror:12 row_mask:0xf bank_mask:0xf
    v_mov_b32_dpp v105, v104 row_ror:12 row_mask:0xf bank_mask:0xf
    v_mov_b32_dpp v109, v108 row_ror:12 row_mask:0xf bank_mask:0xf
    v_mov_b32_dpp v98, v96 row_ror:8 row_mask:0xf bank_mask:0xf
    v_mov_b32_dpp v102, v100 row_ror:8 row_mask:0xf bank_mask:0xf
    v_mov_b32_dpp v106, v104 row_ror:8 row_mask:0xf bank_mask:0xf
    v_mov_b32_dpp v110, v108 row_ror:8 row_mask:0xf bank_mask:0xf
    v_mov_b32_dpp v99, v96 row_ror:4 row_mask:0xf bank_mask:0xf
    v_mov_b32_dpp v103, v100 row_ror:4 row_mask:0xf bank_mask:0xf
    v_mov_b32_dpp v107, v104 row_ror:4 row_mask:0xf bank_mask:0xf
    v_mov_b32_dpp v111, v108 row_ror:4 row_mask:0xf bank_mask:0xf
    s_lshl_b32 s60, s3, 10
    s_add_u32 s60, s60, 147456
    v_lshlrev_b32 v10, 5, v0
    v_add_u32 v10, s60, v10
    s_memrealtime s[8:9]
    s_waitcnt lgkmcnt(0)
    s_sub_u32 s8, s8, s30
    s_cmpk_ge_u32 s8, 2084
    s_cbranch_scc1 .ap_192
    s_waitcnt vmcnt(5)
    s_cmpk_ge_u32 s8, 1984
    s_cbranch_scc1 .ap_192
    s_waitcnt vmcnt(4)
    s_bitcmp1_b64 s[14:15], 59
    s_cbranch_scc0 1
    s_waitcnt vmcnt(2)
    s_cmpk_ge_u32 s8, 1864
    s_cbranch_scc1 .ap_192
    s_waitcnt vmcnt(1)
.ap_192:
    s_add_u32 s63, s69, 417792
    buffer_load_dwordx4 v[60:63], v1, s[44:47], s63 offen nt
    v_perm_b32 v112, v164, v160, s94
    v_perm_b32 v113, v172, v168, s94
    v_perm_b32 v114, v180, v176, s94
    v_perm_b32 v115, v188, v184, s94
    s_nop 1
    v_mfma_f32_16x16x32_bf16 v[128:131], v[96:99], v[112:115], 0
    v_perm_b32 v116, v164, v160, s95
    v_perm_b32 v117, v172, v168, s95
    v_perm_b32 v118, v180, v176, s95
    v_perm_b32 v119, v188, v184, s95
    s_nop 1
    v_mfma_f32_16x16x32_bf16 v[132:135], v[96:99], v[116:119], 0
    v_perm_b32 v120, v165, v161, s94
    v_perm_b32 v121, v173, v169, s94
    v_perm_b32 v122, v181, v177, s94
    v_perm_b32 v123, v189, v185, s94
    s_nop 1
    v_mfma_f32_16x16x32_bf16 v[136:139], v[96:99], v[120:123], 0
    v_perm_b32 v124, v165, v161, s95
    v_perm_b32 v125, v173, v169, s95
    v_perm_b32 v126, v181, v177, s95
    v_perm_b32 v127, v189, v185, s95
    s_nop 1
    v_mfma_f32_16x16x32_bf16 v[140:143], v[96:99], v[124:127], 0
    v_perm_b32 v112, v166, v162, s94
    v_perm_b32 v113, v174, v170, s94
    v_perm_b32 v114, v182, v178, s94
    v_perm_b32 v115, v190, v186, s94
    s_nop 1
    v_mfma_f32_16x16x32_bf16 v[144:147], v[96:99], v[112:115], 0
    v_perm_b32 v116, v166, v162, s95
    v_perm_b32 v117, v174, v170, s95
    v_perm_b32 v118, v182, v178, s95
    v_perm_b32 v119, v190, v186, s95
    s_nop 1
    v_mfma_f32_16x16x32_bf16 v[148:151], v[96:99], v[116:119], 0
    v_perm_b32 v120, v167, v163, s94
    v_perm_b32 v121, v175, v171, s94
    v_perm_b32 v122, v183, v179, s94
    v_perm_b32 v123, v191, v187, s94
    s_nop 1
    v_mfma_f32_16x16x32_bf16 v[152:155], v[96:99], v[120:123], 0
    v_perm_b32 v124, v167, v163, s95
    v_perm_b32 v125, v175, v171, s95
    v_perm_b32 v126, v183, v179, s95
    v_perm_b32 v127, v191, v187, s95
    s_nop 1
    v_mfma_f32_16x16x32_bf16 v[156:159], v[96:99], v[124:127], 0
    s_memrealtime s[8:9]
    s_waitcnt lgkmcnt(0)
    s_sub_u32 s8, s8, s30
    s_cmpk_ge_u32 s8, 2116
    s_nop 3
    s_cbranch_scc1 .ap_193
    s_waitcnt vmcnt(5)
    s_cmpk_ge_u32 s8, 2016
    s_cbranch_scc1 .ap_193
    s_waitcnt vmcnt(4)
    s_bitcmp1_b64 s[14:15], 60
    s_cbranch_scc0 1
    s_waitcnt vmcnt(2)
    s_cmpk_ge_u32 s8, 1896
    s_cbranch_scc1 .ap_193
    s_waitcnt vmcnt(1)
.ap_193:
    s_add_u32 s63, s69, 425984
    buffer_load_dwordx4 v[68:71], v1, s[44:47], s63 offen nt
    v_perm_b32 v112, v196, v192, s94
    v_perm_b32 v113, v204, v200, s94
    v_perm_b32 v114, v212, v208, s94
    v_perm_b32 v115, v220, v216, s94
    s_nop 1
    v_mfma_f32_16x16x32_bf16 v[128:131], v[100:103], v[112:115], v[128:131]
    v_perm_b32 v116, v196, v192, s95
    v_perm_b32 v117, v204, v200, s95
    v_perm_b32 v118, v212, v208, s95
    v_perm_b32 v119, v220, v216, s95
    s_nop 1
    v_mfma_f32_16x16x32_bf16 v[132:135], v[100:103], v[116:119], v[132:135]
    v_perm_b32 v120, v197, v193, s94
    v_perm_b32 v121, v205, v201, s94
    v_perm_b32 v122, v213, v209, s94
    v_perm_b32 v123, v221, v217, s94
    s_nop 1
    v_mfma_f32_16x16x32_bf16 v[136:139], v[100:103], v[120:123], v[136:139]
    v_perm_b32 v124, v197, v193, s95
    v_perm_b32 v125, v205, v201, s95
    v_perm_b32 v126, v213, v209, s95
    v_perm_b32 v127, v221, v217, s95
    s_nop 1
    v_mfma_f32_16x16x32_bf16 v[140:143], v[100:103], v[124:127], v[140:143]
    v_perm_b32 v112, v198, v194, s94
    v_perm_b32 v113, v206, v202, s94
    v_perm_b32 v114, v214, v210, s94
    v_perm_b32 v115, v222, v218, s94
    s_nop 1
    v_mfma_f32_16x16x32_bf16 v[144:147], v[100:103], v[112:115], v[144:147]
    v_perm_b32 v116, v198, v194, s95
    v_perm_b32 v117, v206, v202, s95
    v_perm_b32 v118, v214, v210, s95
    v_perm_b32 v119, v222, v218, s95
    s_nop 1
    v_mfma_f32_16x16x32_bf16 v[148:151], v[100:103], v[116:119], v[148:151]
    v_perm_b32 v120, v199, v195, s94
    v_perm_b32 v121, v207, v203, s94
    s_branch .Lsk_b1_5
.Lst_b1_5:
    s_branch .Lrt_b1_5
.Lsk_b1_5:
    v_perm_b32 v122, v215, v211, s94
    v_perm_b32 v123, v223, v219, s94
    s_nop 1
    v_mfma_f32_16x16x32_bf16 v[152:155], v[100:103], v[120:123], v[152:155]
    v_perm_b32 v124, v199, v195, s95
    v_perm_b32 v125, v207, v203, s95
    v_perm_b32 v126, v215, v211, s95
    v_perm_b32 v127, v223, v219, s95
    s_nop 1
    v_mfma_f32_16x16x32_bf16 v[156:159], v[100:103], v[124:127], v[156:159]
    s_memrealtime s[8:9]
    s_waitcnt lgkmcnt(0)
    s_sub_u32 s8, s8, s30
    s_cmpk_ge_u32 s8, 2148
    s_nop 3
    s_cbranch_scc1 .ap_194
    s_waitcnt vmcnt(5)
    s_cmpk_ge_u32 s8, 2048
    s_cbranch_scc1 .ap_194
    s_waitcnt vmcnt(4)
    s_bitcmp1_b64 s[14:15], 61
    s_cbranch_scc0 1
    s_waitcnt vmcnt(2)
    s_cmpk_ge_u32 s8, 1928
    s_cbranch_scc1 .ap_194
    s_waitcnt vmcnt(1)
.ap_194:
    s_add_u32 s63, s69, 434176
    buffer_load_dwordx4 v[76:79], v1, s[44:47], s63 offen nt
    s_waitcnt vmcnt(6)
    v_perm_b32 v112, v228, v224, s94
    v_perm_b32 v113, v236, v232, s94
    v_perm_b32 v114, v244, v240, s94
    v_perm_b32 v115, v252, v248, s94
    s_nop 1
    v_mfma_f32_16x16x32_bf16 v[128:131], v[104:107], v[112:115], v[128:131]
    v_perm_b32 v116, v228, v224, s95
    v_perm_b32 v117, v236, v232, s95
    v_perm_b32 v118, v244, v240, s95
    v_perm_b32 v119, v252, v248, s95
    s_nop 1
    v_mfma_f32_16x16x32_bf16 v[132:135], v[104:107], v[116:119], v[132:135]
    v_perm_b32 v120, v229, v225, s94
    v_perm_b32 v121, v237, v233, s94
    v_perm_b32 v122, v245, v241, s94
    v_perm_b32 v123, v253, v249, s94
    s_nop 1
    v_mfma_f32_16x16x32_bf16 v[136:139], v[104:107], v[120:123], v[136:139]
    v_perm_b32 v124, v229, v225, s95
    v_perm_b32 v125, v237, v233, s95
    v_perm_b32 v126, v245, v241, s95
    v_perm_b32 v127, v253, v249, s95
    s_nop 1
    v_mfma_f32_16x16x32_bf16 v[140:143], v[104:107], v[124:127], v[140:143]
    v_perm_b32 v112, v230, v226, s94
    v_perm_b32 v113, v238, v234, s94
    v_perm_b32 v114, v246, v242, s94
    v_perm_b32 v115, v254, v250, s94
    s_nop 1
    v_mfma_f32_16x16x32_bf16 v[144:147], v[104:107], v[112:115], v[144:147]
    v_perm_b32 v116, v230, v226, s95
    v_perm_b32 v117, v238, v234, s95
    v_perm_b32 v118, v246, v242, s95
    v_perm_b32 v119, v254, v250, s95
    s_nop 1
    v_mfma_f32_16x16x32_bf16 v[148:151], v[104:107], v[116:119], v[148:151]
    v_perm_b32 v120, v231, v227, s94
    v_perm_b32 v121, v239, v235, s94
    v_perm_b32 v122, v247, v243, s94
    v_perm_b32 v123, v255, v251, s94
    s_nop 1
    v_mfma_f32_16x16x32_bf16 v[152:155], v[104:107], v[120:123], v[152:155]
    v_perm_b32 v124, v231, v227, s95
    v_perm_b32 v125, v239, v235, s95
    v_perm_b32 v126, v247, v243, s95
    v_perm_b32 v127, v255, v251, s95
    s_nop 1
    v_mfma_f32_16x16x32_bf16 v[156:159], v[104:107], v[124:127], v[156:159]
    s_memrealtime s[8:9]
    s_waitcnt lgkmcnt(0)
    s_sub_u32 s8, s8, s30
    s_cmpk_ge_u32 s8, 2180
    s_nop 3
    s_cbranch_scc1 .ap_195
    s_waitcnt vmcnt(5)
    s_cmpk_ge_u32 s8, 2080
    s_cbranch_scc1 .ap_195
    s_waitcnt vmcnt(4)
    s_bitcmp1_b64 s[14:15], 62
    s_cbranch_scc0 1
    s_waitcnt vmcnt(2)
    s_cmpk_ge_u32 s8, 1960
    s_cbranch_scc1 .ap_195
    s_waitcnt vmcnt(1)
.ap_195:
    s_add_u32 s63, s69, 442368
    buffer_load_dwordx4 v[84:87], v1, s[44:47], s63 offen nt
    s_memrealtime s[8:9]
    s_waitcnt lgkmcnt(0)
    s_sub_u32 s8, s8, s30
    s_cmpk_ge_u32 s8, 2212
    s_cbranch_scc1 .ap_196
    s_waitcnt vmcnt(5)
    s_cmpk_ge_u32 s8, 2112
    s_cbranch_scc1 .ap_196
    s_waitcnt vmcnt(4)
    s_bitcmp1_b64 s[14:15], 63
    s_cbranch_scc0 1
    s_waitcnt vmcnt(2)
    s_cmpk_ge_u32 s8, 1992
    s_cbranch_scc1 .ap_196
    s_waitcnt vmcnt(1)
.ap_196:
    s_add_u32 s63, s69, 450560
    buffer_load_dwordx4 v[92:95], v1, s[44:47], s63 offen nt
    s_setprio 0
    s_waitcnt vmcnt(6)
    v_perm_b32 v160, v44, v36, s94
    v_perm_b32 v164, v44, v36, s95
    v_perm_b32 v168, v45, v37, s94
    v_perm_b32 v172, v45, v37, s95
    v_perm_b32 v176, v46, v38, s94
    v_perm_b32 v180, v46, v38, s95
    v_perm_b32 v184, v47, v39, s94
    v_perm_b32 v188, v47, v39, s95
    s_waitcnt vmcnt(4)
    v_perm_b32 v161, v60, v52, s94
    v_perm_b32 v165, v60, v52, s95
    v_perm_b32 v169, v61, v53, s94
    v_perm_b32 v173, v61, v53, s95
    v_perm_b32 v177, v62, v54, s94
    v_perm_b32 v181, v62, v54, s95
    v_perm_b32 v185, v63, v55, s94
    v_perm_b32 v189, v63, v55, s95
    s_waitcnt vmcnt(2)
    v_perm_b32 v162, v76, v68, s94
    v_perm_b32 v166, v76, v68, s95
    v_perm_b32 v170, v77, v69, s94
    v_perm_b32 v174, v77, v69, s95
    v_perm_b32 v178, v78, v70, s94
    v_perm_b32 v182, v78, v70, s95
    v_perm_b32 v186, v79, v71, s94
    v_perm_b32 v190, v79, v71, s95
    s_branch .Lsk_b1_6
    .fill 48, 4, 0xbf800000
.Lst_b1_6:
    s_branch .Lrt_b1_6
.Lsk_b1_6:
    s_waitcnt vmcnt(0)
    s_add_u32 m0, s101, 90112
    s_add_u32 s56, s100, 1179648
    buffer_load_dwordx4 v6, s[52:55], s56 offen nt lds
    s_add_u32 m0, s101, 98304
    s_add_u32 s56, s100, 1769472
    buffer_load_dwordx4 v6, s[52:55], s56 offen nt lds
    s_add_u32 m0, s101, 106496
    s_add_u32 s56, s100, 2359296
    buffer_load_dwordx4 v6, s[52:55], s56 offen nt lds
    s_add_u32 m0, s101, 114688
    s_add_u32 s56, s100, 2949120
    buffer_load_dwordx4 v6, s[52:55], s56 offen nt lds
    v_perm_b32 v163, v92, v84, s94
    v_perm_b32 v167, v92, v84, s95
    v_perm_b32 v171, v93, v85, s94
    v_mfma_f32_16x16x32_bf16 v[128:131], v[108:111], v[160:163], v[128:131]
    v_perm_b32 v175, v93, v85, s95
    v_mfma_f32_16x16x32_bf16 v[132:135], v[108:111], v[164:167], v[132:135]
    v_perm_b32 v179, v94, v86, s94
    v_mfma_f32_16x16x32_bf16 v[136:139], v[108:111], v[168:171], v[136:139]
    v_perm_b32 v183, v94, v86, s95
    v_mfma_f32_16x16x32_bf16 v[140:143], v[108:111], v[172:175], v[140:143]
    v_perm_b32 v187, v95, v87, s94
    v_mfma_f32_16x16x32_bf16 v[144:147], v[108:111], v[176:179], v[144:147]
    v_perm_b32 v191, v95, v87, s95
    v_mfma_f32_16x16x32_bf16 v[148:151], v[108:111], v[180:183], v[148:151]
    v_mfma_f32_16x16x32_bf16 v[152:155], v[108:111], v[184:187], v[152:155]
    v_mfma_f32_16x16x32_bf16 v[156:159], v[108:111], v[188:191], v[156:159]
    s_mov_b64 exec, 0xffff
    ds_write2_b32 v10, v128, v129 offset0:0 offset1:128
    ds_write2_b32 v10, v132, v133 offset0:1 offset1:129
    ds_write2_b32 v10, v136, v137 offset0:2 offset1:130
    ds_write2_b32 v10, v140, v141 offset0:3 offset1:131
    ds_write2_b32 v10, v144, v145 offset0:4 offset1:132
    ds_write2_b32 v10, v148, v149 offset0:5 offset1:133
    ds_write2_b32 v10, v152, v153 offset0:6 offset1:134
    ds_write2_b32 v10, v156, v157 offset0:7 offset1:135
    s_mov_b64 exec, -1
    s_waitcnt lgkmcnt(0)
    s_barrier
    s_cmp_lg_u32 s3, 7
    s_cbranch_scc1 .opub_197
    v_add_u32 v10, 147456, v2
    ds_read_b128 v[196:199], v10 offset:0
    ds_read_b128 v[200:203], v10 offset:1024
    ds_read_b128 v[204:207], v10 offset:2048
    ds_read_b128 v[208:211], v10 offset:3072
    ds_read_b128 v[212:215], v10 offset:4096
    ds_read_b128 v[216:219], v10 offset:5120
    ds_read_b128 v[220:223], v10 offset:6144
    ds_read_b128 v[224:227], v10 offset:7168
    v_lshrrev_b32 v11, 5, v0
    v_lshlrev_b32 v11, 13, v11
    v_and_b32 v12, 31, v0
    v_lshl_add_u32 v11, v12, 4, v11
    s_lshl4_add_u32 s56, s67, s66
    s_lshl1_add_u32 s56, s56, s68
    s_lshl_b32 s56, s56, 9
    s_add_u32 s56, s56, 0xa0000
    s_mov_b32 s60, 0x07060503
    s_mov_b32 s61, 0x07060502
    s_mov_b32 s62, 0x07060501
    v_mov_b32 v15, s34
    s_waitcnt lgkmcnt(6)
    v_pk_add_f32 v[196:197], v[196:197], v[200:201]
    v_pk_add_f32 v[198:199], v[198:199], v[202:203]
    s_waitcnt lgkmcnt(5)
    v_pk_add_f32 v[196:197], v[196:197], v[204:205]
    v_pk_add_f32 v[198:199], v[198:199], v[206:207]
    s_waitcnt lgkmcnt(4)
    v_pk_add_f32 v[196:197], v[196:197], v[208:209]
    v_pk_add_f32 v[198:199], v[198:199], v[210:211]
    s_waitcnt lgkmcnt(3)
    v_pk_add_f32 v[196:197], v[196:197], v[212:213]
    v_pk_add_f32 v[198:199], v[198:199], v[214:215]
    s_waitcnt lgkmcnt(2)
    v_pk_add_f32 v[196:197], v[196:197], v[216:217]
    v_pk_add_f32 v[198:199], v[198:199], v[218:219]
    s_waitcnt lgkmcnt(1)
    v_pk_add_f32 v[196:197], v[196:197], v[220:221]
    v_pk_add_f32 v[198:199], v[198:199], v[222:223]
    s_waitcnt lgkmcnt(0)
    v_pk_add_f32 v[196:197], v[196:197], v[224:225]
    v_pk_add_f32 v[198:199], v[198:199], v[226:227]
    v_perm_b32 v12, v196, v199, s60
    v_perm_b32 v13, v197, v199, s61
    v_perm_b32 v14, v198, v199, s62
    s_add_u32 s57, s56, 0x800000
    buffer_store_dwordx4 v[12:15], v11, s[36:39], s57 offen
    s_cmp_lg_u32 s0, 0
    s_nop 0
    s_cbranch_scc1 .nosl_198
    buffer_store_dwordx4 v[12:15], v11, s[36:39], s56 offen sc1
.nosl_198:
.opub_197:
    s_mov_b32 s61, s101
    v_lshrrev_b32 v25, 4, v0
    v_bfe_u32 v26, v0, 1, 1
    v_lshl_add_u32 v25, v25, 1, v26
    v_bfe_u32 v26, v0, 2, 2
    v_lshl_add_u32 v19, v25, 3, v26
    v_lshlrev_b32 v19, 7, v19
    v_and_b32 v25, 3, v25
    v_lshrrev_b32 v26, 1, v26
    v_lshl_add_u32 v25, v25, 1, v26
    v_xor_b32 v25, s3, v25
    v_lshl_add_u32 v19, v25, 4, v19
    v_and_b32 v25, 1, v0
    v_lshl_add_u32 v19, v25, 3, v19
    v_add_u32 v20, 32768, v19
    ds_read_b64_tr_b16 v[160:161], v19 offset:0
    ds_read_b64_tr_b16 v[162:163], v19 offset:512
    ds_read_b64_tr_b16 v[164:165], v19 offset:8192
    ds_read_b64_tr_b16 v[166:167], v19 offset:8704
    ds_read_b64_tr_b16 v[168:169], v19 offset:16384
    ds_read_b64_tr_b16 v[170:171], v19 offset:16896
    ds_read_b64_tr_b16 v[172:173], v19 offset:24576
    ds_read_b64_tr_b16 v[174:175], v19 offset:25088
    ds_read_b64_tr_b16 v[176:177], v20 offset:0
    s_branch .Lsk_b1_7
.Lst_b1_7:
    s_branch .Lrt_b1_7
.Lsk_b1_7:
    ds_read_b64_tr_b16 v[178:179], v20 offset:512
    ds_read_b64_tr_b16 v[180:181], v20 offset:8192
    ds_read_b64_tr_b16 v[182:183], v20 offset:8704
    ds_read_b64_tr_b16 v[184:185], v20 offset:16384
    ds_read_b64_tr_b16 v[186:187], v20 offset:16896
    ds_read_b64_tr_b16 v[188:189], v20 offset:24576
    ds_read_b64_tr_b16 v[190:191], v20 offset:25088
    ds_read_b64_tr_b16 v[192:193], v20 offset:32768
    ds_read_b64_tr_b16 v[194:195], v20 offset:33280
    v_add_u32 v19, 73728, v19
    v_add_u32 v20, 73728, v20
    s_mov_b32 s48, s22
    s_and_b32 s49, s23, 0xffff
    s_mov_b32 s50, 0x510000
    s_mov_b32 s51, 0x00020000
    s_mul_i32 s69, s99, 73728
    s_mul_i32 s56, s3, 9216
    s_add_u32 s69, s69, s56
    v_bfe_u32 v25, v0, 4, 1
    s_and_b32 s56, s3, 1
    s_lshl_b32 s56, s56, 2
    v_lshl_or_b32 v25, v25, 1, s56
    v_and_b32 v26, 7, v0
    v_xor_b32 v25, v25, v26
    v_lshrrev_b32 v26, 3, v0
    v_mul_u32_u24 v26, 1152, v26
    v_lshl_add_u32 v24, v25, 4, v26
    s_and_b32 s58, s64, 0
    s_mul_i32 s58, s58, 18432
    s_mul_i32 s59, s3, 2304
    s_add_u32 s58, s58, s59
    s_add_u32 s62, s58, 0x37000
    s_add_u32 s63, s58, 0x49000
    s_mul_i32 s101, s64, 18432
    s_add_u32 s101, s101, s59
    s_add_u32 s101, s101, 0x170000
    s_waitcnt lgkmcnt(0)
    s_barrier
    s_add_u32 m0, s61, 122880
    s_add_u32 s56, s100, 3538944
    buffer_load_dwordx4 v6, s[52:55], s56 offen nt lds
    s_add_u32 m0, s61, 131072
    s_add_u32 s56, s100, 4128768
    buffer_load_dwordx4 v6, s[52:55], s56 offen nt lds
    s_add_u32 m0, s61, 139264
    s_add_u32 s56, s100, 4718592
    buffer_load_dwordx4 v6, s[52:55], s56 offen nt lds
    s_add_u32 m0, s61, 0
    s_nop 0
    buffer_load_dwordx4 v24, s[48:51], s69 offen offset:0 nt lds
    s_add_u32 m0, s61, 8064
    s_nop 0
    buffer_load_dwordx4 v24, s[48:51], s69 offen offset:128 nt lds
    s_add_u32 m0, s61, 16128
    s_nop 0
    buffer_load_dwordx4 v24, s[48:51], s69 offen offset:256 nt lds
    s_add_u32 m0, s61, 24192
    s_nop 0
    buffer_load_dwordx4 v24, s[48:51], s69 offen offset:384 nt lds
    s_add_u32 m0, s61, 32256
    s_nop 0
    buffer_load_dwordx4 v24, s[48:51], s69 offen offset:512 nt lds
    s_add_u32 m0, s61, 40320
    s_nop 0
    buffer_load_dwordx4 v24, s[48:51], s69 offen offset:640 nt lds
    s_add_u32 m0, s61, 48384
    s_nop 0
    buffer_load_dwordx4 v24, s[48:51], s69 offen offset:768 nt lds
    s_add_u32 m0, s61, 56448
    s_nop 0
    buffer_load_dwordx4 v24, s[48:51], s69 offen offset:896 nt lds
    s_add_u32 m0, s61, 64512
    s_nop 0
    buffer_load_dwordx4 v24, s[48:51], s69 offen offset:1024 nt lds
    v_bfe_u32 v16, v0, 1, 3
    v_mul_u32_u24 v16, 1312, v16
    v_lshrrev_b32 v25, 4, v0
    v_lshl_add_u32 v16, v25, 5, v16
    v_and_b32 v25, 1, v0
    v_lshl_add_u32 v16, v25, 4, v16
    v_add_u32 v16, 147456, v16
    s_mul_i32 s56, s3, 1312
    s_add_u32 s56, s56, 147456
    v_add_u32 v17, s56, v3
    v_add_u32 v18, s56, v4
    v_bfe_u32 v21, v0, 1, 3
    v_mul_u32_u24 v21, 144, v21
    v_bfe_u32 v25, v0, 4, 1
    v_lshl_add_u32 v21, v25, 3, v21
    v_lshrrev_b32 v25, 5, v0
    v_lshl_add_u32 v21, v25, 2, v21
    v_and_b32 v25, 1, v0
    v_lshl_add_u32 v21, v25, 1, v21
    s_lshl_b32 s56, s3, 4
    s_add_u32 s56, s56, 157952
    v_add_u32 v21, s56, v21
    v_and_b32 v22, 15, v0
    v_lshlrev_b32 v22, 3, v22
    s_mul_i32 s56, s3, 144
    s_add_u32 s56, s56, 157952
    v_add_u32 v22, s56, v22
    s_mov_b32 s56, 157952
    v_bfe_u32 v22, v0, 1, 3
    v_mul_u32_u24 v22, 144, v22
    v_and_b32 v25, 48, v0
    v_add3_u32 v22, v22, v25, s56
    v_bfe_u32 v23, v0, 1, 3
    v_mul_u32_u24 v23, 9216, v23
    v_and_b32 v25, 1, v0
    v_lshl_add_u32 v23, v25, 4, v23
    v_and_b32 v25, 48, v0
    v_lshl_add_u32 v23, v25, 1, v23
    v_lshrrev_b32 v25, 4, v0
    v_bfe_u32 v26, v0, 2, 2
    v_lshl_add_u32 v28, v25, 3, v26
    v_lshlrev_b32 v28, 7, v28
    v_and_b32 v25, 1, v25
    v_lshrrev_b32 v26, 1, v26
    v_lshl_add_u32 v25, v25, 1, v26
    s_and_b32 s56, s3, 1
    s_lshl_b32 s56, s56, 1
    v_xor_b32 v25, s56, v25
    v_and_b32 v26, 3, v0
    v_lshl_add_u32 v28, v26, 3, v28
    s_lshr_b32 s56, s3, 1
    s_lshl_b32 s56, s56, 13
    v_add_u32 v28, s56, v28
    v_xor_b32 v26, 1, v25
    v_lshl_add_u32 v29, v26, 5, v28
    v_lshl_add_u32 v28, v25, 5, v28
    v_add_u32 v30, 0x10000, v28
    v_add_u32 v31, 0x10000, v29
    s_mul_i32 s59, s3, 73728
    s_lshl_b32 s56, s99, 7
    s_add_u32 s59, s59, s56
    s_add_u32 s59, s59, 0x1a0000
    s_add_u32 s99, s59, 589824
    s_add_u32 s100, s59, 1179648
    s_branch .gpc_200
.gp_199:
    buffer_load_dwordx4 v[32:35], v2, s[36:39], s62 offen offset:0 sc1
    buffer_load_dwordx4 v[40:43], v2, s[36:39], s62 offen offset:1024 sc1
    buffer_load_dwordx2 v[48:49], v5, s[36:39], s62 offen offset:0 sc1
    buffer_load_dwordx4 v[56:59], v2, s[36:39], s63 offen offset:0 sc1
    buffer_load_dwordx4 v[64:67], v2, s[36:39], s63 offen offset:1024 sc1
    buffer_load_dwordx2 v[72:73], v5, s[36:39], s63 offen offset:0 sc1
    s_waitcnt vmcnt(0)
.gpc_200:
    v_min_u32 v25, v33, v35
    v_max_u32 v26, v33, v35
    v_min3_u32 v25, v25, v41, v43
    v_max3_u32 v26, v26, v41, v43
    v_min3_u32 v25, v25, v49, v57
    v_max3_u32 v26, v26, v49, v57
    v_min3_u32 v25, v25, v59, v65
    v_max3_u32 v26, v26, v59, v65
    v_min3_u32 v25, v25, v67, v73
    v_max3_u32 v26, v26, v67, v73
    v_cmp_eq_u32 vcc, s34, v25
    v_cmp_eq_u32 s[56:57], s34, v26
    s_and_b64 vcc, vcc, s[56:57]
    s_cmp_eq_u64 vcc, -1
    s_nop 2
    s_cbranch_scc1 .gpd_201
    s_sub_u32 s35, s35, 1
    s_cbranch_scc1 .Lexit
    s_sleep 2
    s_branch .gp_199
.gpd_201:
    v_lshlrev_b32 v206, 16, v32
    s_branch .Lsk_b2_0
.Lst_b2_0:
    s_branch .Lrt_b2_0
.Lsk_b2_0:
    v_and_b32 v207, 0xffff0000, v32
    v_lshlrev_b32 v216, 16, v56
    v_and_b32 v217, 0xffff0000, v56
    v_lshlrev_b32 v208, 16, v34
    v_and_b32 v209, 0xffff0000, v34
    v_lshlrev_b32 v218, 16, v58
    v_and_b32 v219, 0xffff0000, v58
    v_lshlrev_b32 v210, 16, v40
    v_and_b32 v211, 0xffff0000, v40
    v_lshlrev_b32 v220, 16, v64
    v_and_b32 v221, 0xffff0000, v64
    v_lshlrev_b32 v212, 16, v42
    v_and_b32 v213, 0xffff0000, v42
    v_lshlrev_b32 v222, 16, v66
    v_and_b32 v223, 0xffff0000, v66
    v_lshlrev_b32 v214, 16, v48
    v_and_b32 v215, 0xffff0000, v48
    v_lshlrev_b32 v224, 16, v72
    v_and_b32 v225, 0xffff0000, v72
    s_waitcnt vmcnt(9)
    s_barrier
    ds_read_b64_tr_b16 v[68:69], v19 offset:0
    ds_read_b64_tr_b16 v[70:71], v19 offset:512
    ds_read_b64_tr_b16 v[72:73], v19 offset:8192
    ds_read_b64_tr_b16 v[74:75], v19 offset:8704
    ds_read_b64_tr_b16 v[76:77], v19 offset:16384
    ds_read_b64_tr_b16 v[78:79], v19 offset:16896
    ds_read_b64_tr_b16 v[80:81], v19 offset:24576
    ds_read_b64_tr_b16 v[82:83], v19 offset:25088
    ds_read_b64_tr_b16 v[84:85], v20 offset:0
    ds_read_b64_tr_b16 v[86:87], v20 offset:512
    ds_read_b64_tr_b16 v[88:89], v20 offset:8192
    ds_read_b64_tr_b16 v[90:91], v20 offset:8704
    ds_read_b64_tr_b16 v[92:93], v20 offset:16384
    ds_read_b64_tr_b16 v[94:95], v20 offset:16896
    ds_read_b64_tr_b16 v[96:97], v20 offset:24576
    ds_read_b64_tr_b16 v[98:99], v20 offset:25088
    ds_read_b64_tr_b16 v[100:101], v20 offset:32768
    ds_read_b64_tr_b16 v[102:103], v20 offset:33280
    s_waitcnt vmcnt(0)
    s_barrier
    ds_read_b64_tr_b16 v[104:105], v28 offset:0
    ds_read_b64_tr_b16 v[106:107], v28 offset:512
    ds_read_b64_tr_b16 v[108:109], v29 offset:0
    ds_read_b64_tr_b16 v[110:111], v29 offset:512
    ds_read_b64_tr_b16 v[112:113], v28 offset:4096
    ds_read_b64_tr_b16 v[114:115], v28 offset:4608
    ds_read_b64_tr_b16 v[116:117], v29 offset:4096
    ds_read_b64_tr_b16 v[118:119], v29 offset:4608
    ds_read_b64_tr_b16 v[120:121], v28 offset:32768
    ds_read_b64_tr_b16 v[122:123], v28 offset:33280
    ds_read_b64_tr_b16 v[124:125], v29 offset:32768
    ds_read_b64_tr_b16 v[126:127], v29 offset:33280
    ds_read_b64_tr_b16 v[128:129], v28 offset:36864
    ds_read_b64_tr_b16 v[130:131], v28 offset:37376
    ds_read_b64_tr_b16 v[132:133], v29 offset:36864
    ds_read_b64_tr_b16 v[134:135], v29 offset:37376
    s_cmp_ge_u32 s3, 2
    s_cbranch_scc1 .Lbc_nodn3
    ds_read_b64_tr_b16 v[136:137], v30 offset:0
    ds_read_b64_tr_b16 v[138:139], v30 offset:512
    ds_read_b64_tr_b16 v[140:141], v31 offset:0
    ds_read_b64_tr_b16 v[142:143], v31 offset:512
    ds_read_b64_tr_b16 v[144:145], v30 offset:4096
    ds_read_b64_tr_b16 v[146:147], v30 offset:4608
    ds_read_b64_tr_b16 v[148:149], v31 offset:4096
    ds_read_b64_tr_b16 v[150:151], v31 offset:4608
.Lbc_nodn3:
    s_branch .Lsk_b2_1
    .fill 151, 4, 0xbf800000
.Lst_b2_1:
    s_branch .Lrt_b2_1
.Lsk_b2_1:
    s_mov_b32 s69, 0
.gp_202:
    s_add_u32 s69, s69, 1
    s_and_b32 s56, s69, 0x41
    s_cmp_lg_u32 s56, 0x41
    s_cselect_b32 s56, 0, 0x800000
    s_xor_b32 s56, s56, s0
    s_add_u32 s58, s101, s56
    buffer_load_dwordx4 v[196:199], v2, s[36:39], s58 offen offset:0 sc1
    buffer_load_dwordx4 v[200:203], v2, s[36:39], s58 offen offset:1024 sc1
    buffer_load_dwordx2 v[204:205], v5, s[36:39], s58 offen offset:0 sc1
    s_waitcnt vmcnt(0)
    v_min3_u32 v25, v197, v199, v201
    v_max3_u32 v26, v197, v199, v201
    v_min3_u32 v25, v25, v203, v205
    v_max3_u32 v26, v26, v203, v205
    v_cmp_eq_u32 vcc, s34, v25
    v_cmp_eq_u32 s[56:57], s34, v26
    s_and_b64 vcc, vcc, s[56:57]
    s_cmp_eq_u64 vcc, -1
    s_nop 2
    s_cbranch_scc1 .gpd_203
    s_sub_u32 s35, s35, 1
    s_cbranch_scc1 .Lexit
    s_branch .gp_202
.gpd_203:
    s_mov_b32 s56, 0x3f803f80
    v_dot2_f32_bf16 v236, v196, s56, 0
    v_dot2_f32_bf16 v237, v196, v196, 0
    v_dot2_f32_bf16 v236, v198, s56, v236
    v_dot2_f32_bf16 v237, v198, v198, v237
    v_dot2_f32_bf16 v236, v200, s56, v236
    v_dot2_f32_bf16 v237, v200, v200, v237
    v_dot2_f32_bf16 v236, v202, s56, v236
    v_dot2_f32_bf16 v237, v202, v202, v237
    s_mov_b64 exec, 0xffffffff
    v_dot2_f32_bf16 v236, v204, s56, v236
    v_dot2_f32_bf16 v237, v204, v204, v237
    s_mov_b64 exec, -1
    s_nop 1
    v_permlane32_swap_b32 v236, v237
    v_add_f32 v236, v236, v237
    v_mov_b32 v238, v236
    s_nop 1
    v_permlane16_swap_b32 v238, v236
    v_add_f32 v236, v238, v236
    v_lshlrev_b32 v226, 16, v196
    v_and_b32 v227, 0xffff0000, v196
    v_add_f32_dpp v236, v236, v236 row_ror:8 row_mask:0xf bank_mask:0xf
    v_lshlrev_b32 v228, 16, v198
    v_and_b32 v229, 0xffff0000, v198
    v_add_f32_dpp v236, v236, v236 row_ror:4 row_mask:0xf bank_mask:0xf
    v_lshlrev_b32 v230, 16, v200
    v_and_b32 v231, 0xffff0000, v200
    v_add_f32_dpp v236, v236, v236 quad_perm:[2,3,0,1] row_mask:0xf bank_mask:0xf
    v_lshlrev_b32 v232, 16, v202
    v_and_b32 v233, 0xffff0000, v202
    v_add_f32_dpp v236, v236, v236 quad_perm:[1,0,3,2] row_mask:0xf bank_mask:0xf
    v_mul_f32 v236, 0x3ae38e39, v236
    v_lshlrev_b32 v234, 16, v204
    v_and_b32 v235, 0xffff0000, v204
    v_readlane_b32 s56, v236, 0
    v_readlane_b32 s57, v236, 32
    s_nop 0
    v_mov_b32 v236, s56
    v_fma_f32 v237, -v236, v236, s57
    v_max_f32 v237, 0, v237
    v_cvt_pk_bf16_f32 v238, -v236, v237
    v_and_b32 v239, 0xffff0000, v238
    v_add_f32 v239, 0x3727c5ac, v239
    v_lshlrev_b32 v236, 16, v238
    v_cvt_pk_bf16_f32 v239, v239, v239
    v_lshlrev_b32 v239, 16, v239
    v_sqrt_f32 v239, v239
    v_mov_b32 v237, v236
    v_cvt_pk_bf16_f32 v239, v239, v239
    v_lshlrev_b32 v239, 16, v239
    v_rcp_f32 v238, v239
    v_rcp_f32 v239, v239
    v_pk_add_f32 v[226:227], v[226:227], v[236:237]
    v_pk_add_f32 v[228:229], v[228:229], v[236:237]
    v_pk_add_f32 v[230:231], v[230:231], v[236:237]
    v_pk_add_f32 v[232:233], v[232:233], v[236:237]
    v_pk_add_f32 v[234:235], v[234:235], v[236:237]
    v_cvt_pk_bf16_f32 v226, v226, v227
    v_and_b32 v227, 0xffff0000, v226
    v_lshlrev_b32 v226, 16, v226
    v_cvt_pk_bf16_f32 v228, v228, v229
    v_and_b32 v229, 0xffff0000, v228
    v_lshlrev_b32 v228, 16, v228
    v_cvt_pk_bf16_f32 v230, v230, v231
    v_and_b32 v231, 0xffff0000, v230
    v_lshlrev_b32 v230, 16, v230
    v_cvt_pk_bf16_f32 v232, v232, v233
    v_and_b32 v233, 0xffff0000, v232
    v_lshlrev_b32 v232, 16, v232
    v_cvt_pk_bf16_f32 v234, v234, v235
    v_and_b32 v235, 0xffff0000, v234
    v_lshlrev_b32 v234, 16, v234
    v_pk_mul_f32 v[226:227], v[226:227], v[238:239]
    v_pk_mul_f32 v[228:229], v[228:229], v[238:239]
    v_pk_mul_f32 v[230:231], v[230:231], v[238:239]
    v_pk_mul_f32 v[232:233], v[232:233], v[238:239]
    v_pk_mul_f32 v[234:235], v[234:235], v[238:239]
    v_cvt_pk_bf16_f32 v226, v226, v227
    v_and_b32 v227, 0xffff0000, v226
    v_lshlrev_b32 v226, 16, v226
    v_cvt_pk_bf16_f32 v228, v228, v229
    v_and_b32 v229, 0xffff0000, v228
    v_lshlrev_b32 v228, 16, v228
    v_cvt_pk_bf16_f32 v230, v230, v231
    v_and_b32 v231, 0xffff0000, v230
    v_lshlrev_b32 v230, 16, v230
    v_cvt_pk_bf16_f32 v232, v232, v233
    v_and_b32 v233, 0xffff0000, v232
    v_lshlrev_b32 v232, 16, v232
    v_cvt_pk_bf16_f32 v234, v234, v235
    v_and_b32 v235, 0xffff0000, v234
    v_lshlrev_b32 v234, 16, v234
    v_pk_mul_f32 v[226:227], v[226:227], v[216:217]
    v_pk_mul_f32 v[228:229], v[228:229], v[218:219]
    v_pk_mul_f32 v[230:231], v[230:231], v[220:221]
    v_pk_mul_f32 v[232:233], v[232:233], v[222:223]
    v_pk_mul_f32 v[234:235], v[234:235], v[224:225]
    v_cvt_pk_bf16_f32 v226, v226, v227
    v_and_b32 v227, 0xffff0000, v226
    v_lshlrev_b32 v226, 16, v226
    v_cvt_pk_bf16_f32 v228, v228, v229
    v_and_b32 v229, 0xffff0000, v228
    v_lshlrev_b32 v228, 16, v228
    v_cvt_pk_bf16_f32 v230, v230, v231
    v_and_b32 v231, 0xffff0000, v230
    v_lshlrev_b32 v230, 16, v230
    v_cvt_pk_bf16_f32 v232, v232, v233
    v_and_b32 v233, 0xffff0000, v232
    v_lshlrev_b32 v232, 16, v232
    v_cvt_pk_bf16_f32 v234, v234, v235
    v_and_b32 v235, 0xffff0000, v234
    v_lshlrev_b32 v234, 16, v234
    v_pk_add_f32 v[226:227], v[226:227], v[206:207]
    v_pk_add_f32 v[228:229], v[228:229], v[208:209]
    v_pk_add_f32 v[230:231], v[230:231], v[210:211]
    v_pk_add_f32 v[232:233], v[232:233], v[212:213]
    v_pk_add_f32 v[234:235], v[234:235], v[214:215]
    v_cvt_pk_bf16_f32 v242, v226, v227
    v_cvt_pk_bf16_f32 v243, v228, v229
    v_cvt_pk_bf16_f32 v244, v230, v231
    v_cvt_pk_bf16_f32 v245, v232, v233
    v_cvt_pk_bf16_f32 v246, v234, v235
    ds_write_b64 v17, v[242:243] offset:0
    ds_write_b64 v17, v[244:245] offset:512
    ds_write_b32 v18, v246 offset:0
    s_branch .Lsk_b2_2
    .fill 21, 4, 0xbf800000
.Lst_b2_2:
    s_branch .Lrt_b2_2
.Lsk_b2_2:
    s_waitcnt lgkmcnt(0)
    s_barrier
    ds_read_b128 v[32:35], v16 offset:0
    ds_read_b128 v[36:39], v16 offset:128
    ds_read_b128 v[40:43], v16 offset:256
    ds_read_b128 v[44:47], v16 offset:384
    ds_read_b128 v[48:51], v16 offset:512
    ds_read_b128 v[52:55], v16 offset:640
    ds_read_b128 v[56:59], v16 offset:768
    ds_read_b128 v[60:63], v16 offset:896
    ds_read_b128 v[64:67], v16 offset:1024
    s_waitcnt lgkmcnt(8)
    v_mfma_f32_16x16x32_bf16 v[152:155], v[160:163], v[32:35], 0
    v_mfma_f32_16x16x32_bf16 v[156:159], v[68:71], v[32:35], 0
    s_waitcnt lgkmcnt(7)
    v_mfma_f32_16x16x32_bf16 v[152:155], v[164:167], v[36:39], v[152:155]
    v_mfma_f32_16x16x32_bf16 v[156:159], v[72:75], v[36:39], v[156:159]
    s_waitcnt lgkmcnt(6)
    v_mfma_f32_16x16x32_bf16 v[152:155], v[168:171], v[40:43], v[152:155]
    v_mfma_f32_16x16x32_bf16 v[156:159], v[76:79], v[40:43], v[156:159]
    s_waitcnt lgkmcnt(5)
    v_mfma_f32_16x16x32_bf16 v[152:155], v[172:175], v[44:47], v[152:155]
    v_mfma_f32_16x16x32_bf16 v[156:159], v[80:83], v[44:47], v[156:159]
    s_waitcnt lgkmcnt(4)
    v_mfma_f32_16x16x32_bf16 v[152:155], v[176:179], v[48:51], v[152:155]
    v_mfma_f32_16x16x32_bf16 v[156:159], v[84:87], v[48:51], v[156:159]
    s_waitcnt lgkmcnt(3)
    v_mfma_f32_16x16x32_bf16 v[152:155], v[180:183], v[52:55], v[152:155]
    v_mfma_f32_16x16x32_bf16 v[156:159], v[88:91], v[52:55], v[156:159]
    s_waitcnt lgkmcnt(2)
    v_mfma_f32_16x16x32_bf16 v[152:155], v[184:187], v[56:59], v[152:155]
    v_mfma_f32_16x16x32_bf16 v[156:159], v[92:95], v[56:59], v[156:159]
    s_waitcnt lgkmcnt(1)
    v_mfma_f32_16x16x32_bf16 v[152:155], v[188:191], v[60:63], v[152:155]
    v_mfma_f32_16x16x32_bf16 v[156:159], v[96:99], v[60:63], v[156:159]
    s_waitcnt lgkmcnt(0)
    v_mfma_f32_16x16x32_bf16 v[152:155], v[192:195], v[64:67], v[152:155]
    v_mfma_f32_16x16x32_bf16 v[156:159], v[100:103], v[64:67], v[156:159]
    s_nop 6
    v_permlane32_swap_b32 v152, v154
    v_permlane32_swap_b32 v153, v155
    v_permlane32_swap_b32 v156, v158
    v_permlane32_swap_b32 v157, v159
    v_cndmask_b32 v153, v153, v154, s[96:97]
    v_cndmask_b32 v152, v152, v155, s[96:97]
    v_cndmask_b32 v157, v157, v158, s[96:97]
    v_cndmask_b32 v156, v156, v159, s[96:97]
    v_add_f32_dpp v12, v153, v152 quad_perm:[1,0,3,2] row_mask:0xf bank_mask:0xf
    s_nop 0
    v_add_f32_dpp v13, v157, v156 quad_perm:[1,0,3,2] row_mask:0xf bank_mask:0xf
    v_cvt_pk_bf16_f32 v12, v12, v13
    v_and_b32 v14, 0xffff0000, v12
    v_lshlrev_b32 v12, 16, v12
    v_max_f32 v12, 0xc2ae0000, v12
    v_min_f32 v27, 0x43000000, v12
    v_mul_f32 v25, 0xbfb8aa3b, v27
    v_fma_f32 v26, v27, s98, -v25
    v_fmac_f32 v26, 0xb2a57060, v27
    v_exp_f32 v25, v25
    v_mul_f32 v26, 0x3f317218, v26
    v_fmac_f32 v25, v25, v26
    v_add_f32 v25, 1.0, v25
    v_rcp_f32 v26, v25
    s_nop 0
    v_mul_f32 v27, v12, v26
    v_fma_f32 v25, -v27, v25, v12
    v_fma_f32 v12, v25, v26, v27
    v_cvt_pk_bf16_f32 v12, v12, v12
    v_lshlrev_b32 v12, 16, v12
    v_mul_f32 v12, v12, v14
    v_cvt_pk_bf16_f32 v12, v12, v12
    ds_write_b16 v21, v12
    s_mov_b32 s60, 0x07060503
    s_mov_b32 s61, 0x07060502
    s_mov_b32 s62, 0x07060501
    s_mov_b32 vcc_lo, 0xaaaaaaaa
    s_mov_b32 vcc_hi, 0xaaaaaaaa
    v_mov_b32 v59, s34
    v_mov_b32 v63, s34
    v_mov_b32 v67, s34
    s_branch .Lsk_b2_3
    .fill 75, 4, 0xbf800000
.Lst_b2_3:
    s_branch .Lrt_b2_3
.Lsk_b2_3:
    s_cmp_ge_u32 s3, 2
    s_waitcnt lgkmcnt(0)
    s_barrier
    ds_read_b128 v[8:11], v22
    ds_read_b128 v[12:15], v22 offset:64
    s_waitcnt lgkmcnt(1)
    v_mfma_f32_16x16x32_bf16 v[32:35], v[104:107], v[8:11], 0
    v_mfma_f32_16x16x32_bf16 v[36:39], v[108:111], v[8:11], 0
    s_waitcnt lgkmcnt(0)
    v_mfma_f32_16x16x32_bf16 v[32:35], v[112:115], v[12:15], v[32:35]
    v_mfma_f32_16x16x32_bf16 v[36:39], v[116:119], v[12:15], v[36:39]
    v_mfma_f32_16x16x32_bf16 v[40:43], v[120:123], v[8:11], 0
    v_mfma_f32_16x16x32_bf16 v[44:47], v[124:127], v[8:11], 0
    v_mfma_f32_16x16x32_bf16 v[40:43], v[128:131], v[12:15], v[40:43]
    v_mfma_f32_16x16x32_bf16 v[44:47], v[132:135], v[12:15], v[44:47]
    s_cbranch_scc0 .Lbc_three
    s_nop 3
    v_cndmask_b32 v32, v32, v36, vcc
    v_cndmask_b32 v33, v33, v37, vcc
    v_cndmask_b32 v34, v34, v38, vcc
    v_cndmask_b32 v35, v35, v39, vcc
    v_perm_b32 v56, v32, v35, s60
    v_perm_b32 v57, v33, v35, s61
    v_perm_b32 v58, v34, v35, s62
    buffer_store_dwordx4 v[56:59], v23, s[36:39], s59 offen sc1
    v_cndmask_b32 v40, v40, v44, vcc
    v_cndmask_b32 v41, v41, v45, vcc
    v_cndmask_b32 v42, v42, v46, vcc
    v_cndmask_b32 v43, v43, v47, vcc
    v_perm_b32 v60, v40, v43, s60
    v_perm_b32 v61, v41, v43, s61
    v_perm_b32 v62, v42, v43, s62
    buffer_store_dwordx4 v[60:63], v23, s[36:39], s99 offen sc1
    s_nop 1
    s_branch .Lexit
.Lbc_three:
    v_mfma_f32_16x16x32_bf16 v[48:51], v[136:139], v[8:11], 0
    v_mfma_f32_16x16x32_bf16 v[52:55], v[140:143], v[8:11], 0
    v_mfma_f32_16x16x32_bf16 v[48:51], v[144:147], v[12:15], v[48:51]
    v_mfma_f32_16x16x32_bf16 v[52:55], v[148:151], v[12:15], v[52:55]
    v_cndmask_b32 v32, v32, v36, vcc
    v_cndmask_b32 v33, v33, v37, vcc
    v_cndmask_b32 v34, v34, v38, vcc
    v_cndmask_b32 v35, v35, v39, vcc
    v_perm_b32 v56, v32, v35, s60
    v_perm_b32 v57, v33, v35, s61
    v_perm_b32 v58, v34, v35, s62
    buffer_store_dwordx4 v[56:59], v23, s[36:39], s59 offen sc1
    v_cndmask_b32 v40, v40, v44, vcc
    v_cndmask_b32 v41, v41, v45, vcc
    v_cndmask_b32 v42, v42, v46, vcc
    v_cndmask_b32 v43, v43, v47, vcc
    v_perm_b32 v60, v40, v43, s60
    v_perm_b32 v61, v41, v43, s61
    v_perm_b32 v62, v42, v43, s62
    buffer_store_dwordx4 v[60:63], v23, s[36:39], s99 offen sc1
    v_cndmask_b32 v48, v48, v52, vcc
    v_cndmask_b32 v49, v49, v53, vcc
    v_cndmask_b32 v50, v50, v54, vcc
    v_cndmask_b32 v51, v51, v55, vcc
    v_perm_b32 v64, v48, v51, s60
    v_perm_b32 v65, v49, v51, s61
    v_perm_b32 v66, v50, v51, s62
    buffer_store_dwordx4 v[64:67], v23, s[36:39], s100 offen sc1
.Lexit:
.Lend:
s_endpgm
.section .rodata,"a"
.p2align 6
.amdhsa_kernel adaLN_cond__sliding_block_cached__moe_arch_mod__decode_kernel
  .amdhsa_next_free_vgpr 256
  .amdhsa_next_free_sgpr 102
  .amdhsa_accum_offset 256
  .amdhsa_group_segment_fixed_size 0
  .amdhsa_kernarg_size 120
  .amdhsa_user_sgpr_count 2
  .amdhsa_user_sgpr_kernarg_segment_ptr 1
  .amdhsa_system_sgpr_workgroup_id_x 1
.end_amdhsa_kernel
```

```asm
; @launch grid=(256,1,1) block=(512,1,1) lds=159360
.amdgcn_target "amdgcn-amd-amdhsa--gfx950"
.text
.p2align 12
.globl adaLN_cond__sliding_block_cached__moe_arch_mod__decode_kernel
.p2align 8
.type adaLN_cond__sliding_block_cached__moe_arch_mod__decode_kernel,@function
adaLN_cond__sliding_block_cached__moe_arch_mod__decode_kernel:
    s_cmp_ge_u32 s2, 256
    s_cbranch_scc1 .Lend
    s_load_dwordx16 s[4:19], s[0:1], 0
    s_load_dwordx8 s[20:27], s[0:1], 64
    s_load_dwordx4 s[28:31], s[0:1], 96
    s_load_dwordx2 s[32:33], s[0:1], 112
    s_memrealtime s[70:71]
    v_lshrrev_b32 v1, 6, v0
    v_and_b32 v0, 63, v0
    v_readfirstlane_b32 s3, v1
    s_cmp_lt_u32 s3, 4
    s_nop 3
    s_cbranch_scc1 .Ltw_done
    s_cmp_lt_u32 s2, 72
    s_cbranch_scc1 .Ltw_m
    s_cmp_lt_u32 s2, 144
    s_cbranch_scc1 .Ltw_b
    s_cmp_lt_u32 s2, 208
    s_cbranch_scc1 .Ltw_q
    s_cmp_eq_u32 s3, 4
    s_cbranch_scc1 .Lst_a0_0
    s_cmp_eq_u32 s3, 5
    s_cbranch_scc1 .Lst_a0_1
.Lrt_a0_0:
.Lrt_a0_1:
    s_branch .Ltw_done
.Ltw_m:
    s_cmp_eq_u32 s3, 4
    s_cbranch_scc1 .Lst_m0_0
    s_cmp_eq_u32 s3, 5
    s_cbranch_scc1 .Lst_m0_1
.Lrt_m0_1:
    s_cmp_eq_u32 s3, 6
    s_cbranch_scc1 .Lst_m0_2
.Lrt_m0_2:
    s_cmp_eq_u32 s3, 7
    s_cbranch_scc1 .Lst_m0_3
    s_cmp_eq_u32 s3, 5
    s_cbranch_scc1 .Lst_m0_4
    s_cmp_eq_u32 s3, 6
    s_cbranch_scc1 .Lrt_m0_5
.Lrt_m0_0:
.Lrt_m0_3:
.Lrt_m0_4:
.Lrt_m0_5:
    s_branch .Ltw_done
.Ltw_b:
    s_cmp_eq_u32 s3, 4
    s_cbranch_scc1 .Lst_b0_0
    s_cmp_eq_u32 s3, 5
    s_cbranch_scc1 .Lst_b0_1
    s_cmp_eq_u32 s3, 6
    s_cbranch_scc1 .Lst_b0_2
    s_cmp_eq_u32 s3, 7
    s_cbranch_scc1 .Lst_b0_3
.Lrt_b0_0:
.Lrt_b0_1:
.Lrt_b0_2:
.Lrt_b0_3:
    s_branch .Ltw_done
.Ltw_q:
    s_cmp_eq_u32 s3, 4
    s_cbranch_scc1 .Lst_q0_0
    s_cmp_eq_u32 s3, 5
    s_cbranch_scc1 .Lst_q0_1
    s_cmp_eq_u32 s3, 6
    s_cbranch_scc1 .Lst_q0_2
    s_cmp_eq_u32 s3, 7
    s_cbranch_scc1 .Lst_q0_3
.Lrt_q0_0:
.Lrt_q0_1:
.Lrt_q0_2:
.Lrt_q0_3:
.Ltw_done:
    s_mov_b32 s35, 0x3ffff
    s_mov_b32 s98, 0xbfb8aa3b
    s_mov_b32 s94, 0x05040100
    s_mov_b32 s95, 0x07060302
    s_mov_b32 s96, 0xaaaaaaaa
    s_mov_b32 s97, 0xaaaaaaaa
    s_and_b32 s64, s2, 7
    s_lshr_b32 s65, s2, 3
    s_mov_b32 s58, 0x2554433
    s_mov_b32 s59, 0x2877661
    s_cmp_ge_u32 s65, 16
    s_cselect_b32 s58, 0xbb1aa998, s58
    s_cselect_b32 s59, 0xffeeddcc, s59
    s_lshl_b32 s57, s65, 2
    s_lshr_b64 s[58:59], s[58:59], s57
    s_lshl1_add_u32 s59, s64, 1
    s_mul_i32 s58, s58, s59
    s_add_u32 s58, s58, s64
    s_add_u32 s58, s58, s59
    s_and_b32 s66, s58, 7
    s_bfe_u32 s67, s58, 0x10003
    s_lshl1_add_u32 s67, s64, s67
    s_lshr_b32 s68, 0xaab5d42a, s65
    s_and_b32 s68, s68, 1
    s_movk_i32 s60, 0x7651
    s_cselect_b32 s60, 0x4320, s60
    s_lshl4_add_u32 s69, s66, s67
    s_lshl_b32 s69, s69, 21
    s_cmp_eq_u32 s64, 7
    s_cselect_b32 s58, 0x4040, 0
    s_or_b32 s58, s58, 0x208180
    s_bitcmp1_b32 s58, s65
    s_cselect_b32 s60, s60, 0x3210
    s_and_b32 s57, s3, 1
    s_and_b32 s59, s3, 6
    s_cmpk_eq_u32 s60, 0x3210
    s_cselect_b32 s57, s68, s57
    s_cselect_b32 s59, s3, s59
    s_lshl_b32 s57, s57, 16
    s_lshl_b32 s59, s59, 10
    s_add_u32 s69, s69, s57
    s_add_u32 s69, s69, s59
    s_add_u32 s69, s69, 0x180000
    v_bfe_u32 v1, v0, 2, 2
    v_lshlrev_b32 v1, 2, v1
    v_bfe_u32 v1, s60, v1, 4
    v_lshrrev_b32 v2, 4, v0
    v_lshl_add_u32 v1, v1, 2, v2
    v_and_b32 v2, 3, v0
    v_lshl_add_u32 v1, v1, 2, v2
    v_lshlrev_b32 v1, 4, v1
    v_lshlrev_b32 v2, 4, v0
    v_lshlrev_b32 v3, 3, v0
    v_and_b32 v4, 31, v0
    v_lshlrev_b32 v4, 2, v4
    v_add_u32 v4, 1024, v4
    v_lshlrev_b32 v5, 1, v4
    s_waitcnt lgkmcnt(0)
    s_load_dword s34, s[32:33], 0
    s_mov_b32 s40, s6
    s_and_b32 s41, s7, 0xffff
    s_mov_b32 s42, 0x10000000
    s_mov_b32 s43, 0x00020000
    s_mov_b32 s6, s60
    s_add_u32 s63, s69, 0
    buffer_load_dwordx4 v[32:35], v1, s[40:43], s63 offen nt
    s_add_u32 s63, s69, 8192
    buffer_load_dwordx4 v[36:39], v1, s[40:43], s63 offen nt
    s_add_u32 s63, s69, 16384
    buffer_load_dwordx4 v[64:67], v1, s[40:43], s63 offen nt
    s_add_u32 s63, s69, 24576
    buffer_load_dwordx4 v[68:71], v1, s[40:43], s63 offen nt
.Lnokpre:
    s_mov_b32 s44, s8
    s_and_b32 s45, s9, 0xffff
    s_mov_b32 s46, 0x10000000
    s_mov_b32 s47, 0x00020000
    s_cmp_eq_u32 s3, 0
    s_cselect_b64 exec, 1, 0
    buffer_load_dword v255, v2, s[44:47], s69 offen nt
    s_mov_b64 exec, -1
    s_mov_b32 s36, s32
    s_and_b32 s37, s33, 0xffff
    s_mov_b32 s38, 0x40000000
    s_mov_b32 s39, 0x00020000
    s_lshl3_add_u32 s56, s3, s2
    s_cmp_lt_u32 s56, 8
    s_cbranch_scc0 .Let_no
    s_lshl2_add_u32 s56, s2, 0x4a1000
    v_lshlrev_b32 v6, 8, v0
    v_mov_b32 v7, s70
    s_mov_b64 exec, 3
    buffer_store_dword v7, v6, s[36:39], s56 offen sc1
    s_mov_b64 exec, -1
.Let_no:
    v_mov_b32 v6, 159232
    v_mov_b32 v7, 0
    ds_write_b32 v6, v7
    s_waitcnt lgkmcnt(0)
    s_barrier
    s_cmp_lt_u32 s3, 4
    s_cbranch_scc1 1
    s_setprio 1
    s_cmp_lt_u32 s65, 9
    s_cbranch_scc1 .Lm
    s_cmp_lt_u32 s65, 18
    s_cbranch_scc1 .Lbc
    s_sub_u32 s65, s65, 18
    s_cmp_ge_u32 s65, 8
    s_cbranch_scc1 .La_early
    s_cmp_eq_u32 s65, 3
    s_mov_b32 s14, 0xb55aab55
    s_cselect_b32 s14, 0x8421084, s14
    s_mov_b32 s15, 0x5aab55aa
    s_cselect_b32 s15, 0x42108421, s15
    s_add_u32 s30, s70, 0
    s_mov_b32 s31, s70
    v_bfe_u32 v16, v0, 1, 3
    v_mul_u32_u24 v16, 1312, v16
    v_lshrrev_b32 v12, 4, v0
    v_lshl_add_u32 v16, v12, 5, v16
    v_and_b32 v12, 1, v0
    v_lshl_add_u32 v16, v12, 4, v16
    v_add_u32 v16, 147456, v16
    s_mul_i32 s56, s3, 1312
    s_add_u32 s56, s56, 147456
    v_add_u32 v17, s56, v3
    v_add_u32 v18, s56, v4
    v_lshrrev_b32 v12, 4, v0
    v_bfe_u32 v13, v0, 1, 1
    v_lshl_add_u32 v12, v12, 1, v13
    v_bfe_u32 v13, v0, 2, 2
    v_lshl_add_u32 v20, v12, 3, v13
    v_lshlrev_b32 v20, 7, v20
    v_and_b32 v12, 3, v12
    v_lshrrev_b32 v13, 1, v13
    v_lshl_add_u32 v12, v12, 1, v13
    v_xor_b32 v12, s3, v12
    v_lshl_add_u32 v20, v12, 4, v20
    v_and_b32 v12, 1, v0
    v_lshl_add_u32 v20, v12, 3, v20
    v_bfe_u32 v23, v0, 1, 3
    v_mul_u32_u24 v23, 144, v23
    v_bfe_u32 v12, v0, 4, 1
    v_lshl_add_u32 v23, v12, 3, v23
    s_branch .Lsk_q0_0
.Lst_q0_0:
    s_branch .Lrt_q0_0
.Lsk_q0_0:
    v_lshrrev_b32 v12, 5, v0
    v_lshl_add_u32 v23, v12, 2, v23
    v_and_b32 v12, 1, v0
    v_lshl_add_u32 v23, v12, 1, v23
    s_lshl_b32 s56, s3, 4
    s_add_u32 s56, s56, 157952
    v_add_u32 v23, s56, v23
    v_and_b32 v24, 15, v0
    v_lshlrev_b32 v24, 3, v24
    s_mul_i32 s56, s3, 144
    s_add_u32 s56, s56, 157952
    v_add_u32 v24, s56, v24
    v_add_u32 v21, 32768, v20
    s_lshl_b32 s100, s3, 10
    s_mul_i32 s58, s3, 1152
    s_mov_b32 s52, s4
    s_and_b32 s53, s5, 0xffff
    s_mov_b32 s54, 0x2400
    s_mov_b32 s55, 0x00020000
    buffer_load_dwordx2 v[246:247], v3, s[52:55], s58 offen
    buffer_load_dwordx2 v[248:249], v3, s[52:55], s58 offen offset:512
    buffer_load_dword v250, v4, s[52:55], s58 offen
    s_mov_b32 s48, s10
    s_and_b32 s49, s11, 0xffff
    s_mov_b32 s50, 0x480000
    s_mov_b32 s51, 0x00020000
    v_bfe_u32 v12, v0, 4, 1
    s_and_b32 s56, s3, 3
    s_lshl_b32 s56, s56, 1
    v_or_b32 v12, s56, v12
    v_and_b32 v19, 7, v0
    v_xor_b32 v12, v12, v19
    v_lshrrev_b32 v19, 3, v0
    v_mul_u32_u24 v19, 8192, v19
    v_lshl_add_u32 v19, v12, 4, v19
    s_lshl3_add_u32 s101, s64, s65
    s_lshl_b32 s57, s3, 16
    s_lshl_b32 s59, s101, 7
    s_add_u32 s57, s57, s59
    s_mov_b32 s99, s57
    s_add_u32 m0, s100, 0
    s_add_u32 s56, s99, 0
    buffer_load_dwordx4 v19, s[48:51], s56 offen nt lds
    s_add_u32 s63, s69, 32768
    buffer_load_dwordx4 v[96:99], v1, s[40:43], s63 offen nt
    s_waitcnt lgkmcnt(0)
    s_add_u32 s34, s34, 1
    s_getreg_b32 s1, hwreg(HW_REG_XCC_ID)
    s_lshl_b32 s1, s1, 24
    s_add_u32 s1, s1, s34
    s_lshr_b32 s0, s2, 3
    s_lshl_b32 s63, s64, 8
    s_add_u32 s0, s0, s63
    s_lshl2_add_u32 s0, s0, 0x480000
    v_mov_b32 v30, s1
    s_cmp_eq_u32 s3, 0
    s_cselect_b64 exec, 1, 0
    buffer_store_dword v30, v2, s[36:39], s0 offen sc1
    s_mov_b64 exec, -1
    s_and_b32 s58, s101, 1
    s_lshl_b32 s101, s101, 8
    s_lshl_b32 s58, s58, 7
    s_sub_u32 s101, s101, s58
    s_lshl_b32 s58, s3, 14
    s_add_u32 s101, s101, s58
    s_add_u32 s101, s101, 0x70000
    s_and_b32 s58, s64, 1
    s_mul_i32 s58, s58, 18432
    s_mul_i32 s59, s3, 2304
    s_add_u32 s58, s58, s59
    s_add_u32 s58, s58, 0x1000
    s_add_u32 s59, s58, 73728
    s_waitcnt vmcnt(5)
    s_add_u32 m0, s100, 8192
    s_add_u32 s56, s99, 524288
    buffer_load_dwordx4 v19, s[48:51], s56 offen nt lds
    s_waitcnt vmcnt(5)
    s_add_u32 s63, s69, 40960
    buffer_load_dwordx4 v[100:103], v1, s[40:43], s63 offen nt
    s_waitcnt vmcnt(5)
    s_add_u32 m0, s100, 16384
    s_add_u32 s56, s99, 1048576
    buffer_load_dwordx4 v19, s[48:51], s56 offen nt lds
    s_waitcnt vmcnt(5)
    s_add_u32 s63, s69, 49152
    buffer_load_dwordx4 v[128:131], v1, s[40:43], s63 offen nt
    v_lshlrev_b32 v236, 16, v246
    v_and_b32 v237, 0xffff0000, v246
    v_lshlrev_b32 v238, 16, v247
    v_and_b32 v239, 0xffff0000, v247
    v_lshlrev_b32 v240, 16, v248
    v_and_b32 v241, 0xffff0000, v248
    v_lshlrev_b32 v242, 16, v249
    v_and_b32 v243, 0xffff0000, v249
    v_lshlrev_b32 v244, 16, v250
    v_and_b32 v245, 0xffff0000, v250
    s_mov_b32 s56, 0x3f803f80
    v_dot2_f32_bf16 v10, v246, s56, 0
    v_dot2_f32_bf16 v11, v246, v246, 0
    v_dot2_f32_bf16 v10, v247, s56, v10
    v_dot2_f32_bf16 v11, v247, v247, v11
    v_dot2_f32_bf16 v10, v248, s56, v10
    v_dot2_f32_bf16 v11, v248, v248, v11
    v_dot2_f32_bf16 v10, v249, s56, v10
    v_dot2_f32_bf16 v11, v249, v249, v11
    s_mov_b64 exec, 0xffffffff
    v_dot2_f32_bf16 v10, v250, s56, v10
    v_dot2_f32_bf16 v11, v250, v250, v11
    s_mov_b64 exec, -1
    s_nop 1
    v_permlane32_swap_b32 v10, v11
    v_add_f32 v10, v10, v11
    v_mov_b32 v12, v10
    s_nop 1
    v_permlane16_swap_b32 v12, v10
    v_add_f32 v10, v12, v10
    s_nop 1
    v_add_f32_dpp v10, v10, v10 row_ror:8 row_mask:0xf bank_mask:0xf
    s_nop 1
    v_add_f32_dpp v10, v10, v10 row_ror:4 row_mask:0xf bank_mask:0xf
    s_nop 1
    v_add_f32_dpp v10, v10, v10 quad_perm:[2,3,0,1] row_mask:0xf bank_mask:0xf
    s_nop 1
    v_add_f32_dpp v10, v10, v10 quad_perm:[1,0,3,2] row_mask:0xf bank_mask:0xf
    v_mul_f32 v10, 0x3ae38e39, v10
    s_nop 0
    v_readlane_b32 s56, v10, 0
    v_readlane_b32 s57, v10, 32
    s_nop 0
    v_mov_b32 v10, s56
    v_fma_f32 v11, -v10, v10, s57
    v_max_f32 v11, 0, v11
    v_cvt_pk_bf16_f32 v12, -v10, v11
    v_and_b32 v13, 0xffff0000, v12
    v_add_f32 v13, 0x3727c5ac, v13
    v_lshlrev_b32 v10, 16, v12
    v_cvt_pk_bf16_f32 v13, v13, v13
    v_lshlrev_b32 v13, 16, v13
    v_sqrt_f32 v13, v13
    v_mov_b32 v11, v10
    v_cvt_pk_bf16_f32 v13, v13, v13
    v_lshlrev_b32 v13, 16, v13
    v_rcp_f32 v12, v13
    v_rcp_f32 v13, v13
    v_pk_add_f32 v[236:237], v[236:237], v[10:11]
    v_pk_add_f32 v[238:239], v[238:239], v[10:11]
    v_pk_add_f32 v[240:241], v[240:241], v[10:11]
    v_pk_add_f32 v[242:243], v[242:243], v[10:11]
    v_pk_add_f32 v[244:245], v[244:245], v[10:11]
    v_cvt_pk_bf16_f32 v236, v236, v237
    v_and_b32 v237, 0xffff0000, v236
    v_lshlrev_b32 v236, 16, v236
    v_cvt_pk_bf16_f32 v238, v238, v239
    v_and_b32 v239, 0xffff0000, v238
    v_lshlrev_b32 v238, 16, v238
    v_cvt_pk_bf16_f32 v240, v240, v241
    v_and_b32 v241, 0xffff0000, v240
    v_lshlrev_b32 v240, 16, v240
    v_cvt_pk_bf16_f32 v242, v242, v243
    v_and_b32 v243, 0xffff0000, v242
    v_lshlrev_b32 v242, 16, v242
    v_cvt_pk_bf16_f32 v244, v244, v245
    v_and_b32 v245, 0xffff0000, v244
    v_lshlrev_b32 v244, 16, v244
    v_pk_mul_f32 v[236:237], v[236:237], v[12:13]
    v_pk_mul_f32 v[238:239], v[238:239], v[12:13]
    v_pk_mul_f32 v[240:241], v[240:241], v[12:13]
    v_pk_mul_f32 v[242:243], v[242:243], v[12:13]
    v_pk_mul_f32 v[244:245], v[244:245], v[12:13]
    v_cvt_pk_bf16_f32 v236, v236, v237
    v_and_b32 v237, 0xffff0000, v236
    v_lshlrev_b32 v236, 16, v236
    v_cvt_pk_bf16_f32 v238, v238, v239
    v_and_b32 v239, 0xffff0000, v238
    v_lshlrev_b32 v238, 16, v238
    v_cvt_pk_bf16_f32 v240, v240, v241
    v_and_b32 v241, 0xffff0000, v240
    v_lshlrev_b32 v240, 16, v240
    v_cvt_pk_bf16_f32 v242, v242, v243
    v_and_b32 v243, 0xffff0000, v242
    v_lshlrev_b32 v242, 16, v242
    v_cvt_pk_bf16_f32 v244, v244, v245
    v_and_b32 v245, 0xffff0000, v244
    v_lshlrev_b32 v244, 16, v244
    s_branch .Lsk_q0_1
.Lst_q0_1:
    s_branch .Lrt_q0_1
.Lsk_q0_1:
    s_waitcnt vmcnt(5)
    s_add_u32 m0, s100, 24576
    s_add_u32 s56, s99, 1572864
    buffer_load_dwordx4 v19, s[48:51], s56 offen nt lds
    s_waitcnt vmcnt(4)
    s_add_u32 s63, s69, 57344
    buffer_load_dwordx4 v[132:135], v1, s[40:43], s63 offen nt
    s_waitcnt vmcnt(4)
    s_add_u32 m0, s100, 32768
    s_add_u32 s56, s99, 2097152
    buffer_load_dwordx4 v19, s[48:51], s56 offen nt lds
    s_waitcnt vmcnt(4)
    s_add_u32 s63, s69, 131072
    buffer_load_dwordx4 v[40:43], v1, s[40:43], s63 offen nt
    s_waitcnt vmcnt(4)
    s_add_u32 m0, s100, 40960
    s_add_u32 s56, s99, 2621440
    buffer_load_dwordx4 v19, s[48:51], s56 offen nt lds
    s_waitcnt vmcnt(4)
    s_add_u32 s63, s69, 139264
    buffer_load_dwordx4 v[44:47], v1, s[40:43], s63 offen nt
    s_waitcnt vmcnt(4)
    s_add_u32 m0, s100, 49152
    s_add_u32 s56, s99, 3145728
    buffer_load_dwordx4 v19, s[48:51], s56 offen nt lds
    s_waitcnt vmcnt(4)
    s_add_u32 s63, s69, 147456
    buffer_load_dwordx4 v[72:75], v1, s[40:43], s63 offen nt
    s_waitcnt vmcnt(4)
    s_add_u32 m0, s100, 57344
    s_add_u32 s56, s99, 3670016
    buffer_load_dwordx4 v19, s[48:51], s56 offen nt lds
    s_waitcnt vmcnt(4)
    s_add_u32 s63, s69, 155648
    buffer_load_dwordx4 v[76:79], v1, s[40:43], s63 offen nt
    s_waitcnt vmcnt(4)
    s_add_u32 m0, s100, 65536
    s_add_u32 s56, s99, 4194304
    buffer_load_dwordx4 v19, s[48:51], s56 offen nt lds
    s_waitcnt vmcnt(4)
    s_add_u32 s63, s69, 163840
    buffer_load_dwordx4 v[104:107], v1, s[40:43], s63 offen nt
    s_waitcnt vmcnt(4)
    s_add_u32 s63, s69, 172032
    buffer_load_dwordx4 v[108:111], v1, s[40:43], s63 offen nt
    s_waitcnt vmcnt(4)
    s_add_u32 s63, s69, 180224
    buffer_load_dwordx4 v[136:139], v1, s[40:43], s63 offen nt
    s_waitcnt vmcnt(4)
    s_add_u32 s63, s69, 188416
    buffer_load_dwordx4 v[140:143], v1, s[40:43], s63 offen nt
    s_waitcnt vmcnt(4)
    s_add_u32 s63, s69, 262144
    buffer_load_dwordx4 v[48:51], v1, s[40:43], s63 offen nt
    s_waitcnt vmcnt(4)
    s_add_u32 s63, s69, 270336
    buffer_load_dwordx4 v[52:55], v1, s[40:43], s63 offen nt
    buffer_load_dwordx4 v[196:199], v2, s[36:39], s58 offen offset:0 sc1
    buffer_load_dwordx4 v[200:203], v2, s[36:39], s58 offen offset:1024 sc1
    buffer_load_dwordx2 v[204:205], v5, s[36:39], s58 offen offset:0 sc1
    buffer_load_dwordx4 v[206:209], v2, s[36:39], s59 offen offset:0 sc1
    buffer_load_dwordx4 v[210:213], v2, s[36:39], s59 offen offset:1024 sc1
    buffer_load_dwordx2 v[214:215], v5, s[36:39], s59 offen offset:0 sc1
    s_add_u32 s63, s69, 278528
    buffer_load_dwordx4 v[80:83], v1, s[40:43], s63 offen nt
    s_add_u32 s63, s69, 286720
    buffer_load_dwordx4 v[84:87], v1, s[40:43], s63 offen nt
    s_add_u32 s63, s69, 294912
    buffer_load_dwordx4 v[112:115], v1, s[40:43], s63 offen nt
    s_barrier
    ds_read_b64_tr_b16 v[160:161], v20 offset:0
    ds_read_b64_tr_b16 v[162:163], v20 offset:512
    ds_read_b64_tr_b16 v[164:165], v20 offset:8192
    ds_read_b64_tr_b16 v[166:167], v20 offset:8704
    ds_read_b64_tr_b16 v[168:169], v20 offset:16384
    ds_read_b64_tr_b16 v[170:171], v20 offset:16896
    ds_read_b64_tr_b16 v[172:173], v20 offset:24576
    ds_read_b64_tr_b16 v[174:175], v20 offset:25088
    ds_read_b64_tr_b16 v[176:177], v21 offset:0
    ds_read_b64_tr_b16 v[178:179], v21 offset:512
    ds_read_b64_tr_b16 v[180:181], v21 offset:8192
    ds_read_b64_tr_b16 v[182:183], v21 offset:8704
    ds_read_b64_tr_b16 v[184:185], v21 offset:16384
    ds_read_b64_tr_b16 v[186:187], v21 offset:16896
    ds_read_b64_tr_b16 v[188:189], v21 offset:24576
    ds_read_b64_tr_b16 v[190:191], v21 offset:25088
    ds_read_b64_tr_b16 v[192:193], v21 offset:32768
    ds_read_b64_tr_b16 v[194:195], v21 offset:33280
    s_add_u32 s63, s69, 303104
    buffer_load_dwordx4 v[116:119], v1, s[40:43], s63 offen nt
    s_waitcnt vmcnt(4)
    s_branch .gpc_2
.gp_1:
    buffer_load_dwordx4 v[196:199], v2, s[36:39], s58 offen offset:0 sc1
    buffer_load_dwordx4 v[200:203], v2, s[36:39], s58 offen offset:1024 sc1
    buffer_load_dwordx2 v[204:205], v5, s[36:39], s58 offen offset:0 sc1
    buffer_load_dwordx4 v[206:209], v2, s[36:39], s59 offen offset:0 sc1
    buffer_load_dwordx4 v[210:213], v2, s[36:39], s59 offen offset:1024 sc1
    buffer_load_dwordx2 v[214:215], v5, s[36:39], s59 offen offset:0 sc1
    s_waitcnt vmcnt(0)
.gpc_2:
    v_min_u32 v10, v197, v199
    v_max_u32 v11, v197, v199
    v_min3_u32 v10, v10, v201, v203
    v_max3_u32 v11, v11, v201, v203
    v_min3_u32 v10, v10, v205, v207
    v_max3_u32 v11, v11, v205, v207
    v_min3_u32 v10, v10, v209, v211
    v_max3_u32 v11, v11, v209, v211
    v_min3_u32 v10, v10, v213, v215
    v_max3_u32 v11, v11, v213, v215
    v_cmp_eq_u32 vcc, s34, v10
    v_cmp_eq_u32 s[56:57], s34, v11
    s_and_b64 vcc, vcc, s[56:57]
    s_cmp_eq_u64 vcc, -1
    s_nop 2
    s_cbranch_scc1 .gpd_3
    s_sub_u32 s35, s35, 1
    s_cbranch_scc1 .Lexit
    s_branch .gp_1
.gpd_3:
    s_add_u32 s63, s69, 311296
    buffer_load_dwordx4 v[144:147], v1, s[40:43], s63 offen nt
    v_and_b32 v207, 0xffff0000, v206
    v_lshlrev_b32 v206, 16, v206
    v_and_b32 v209, 0xffff0000, v208
    v_lshlrev_b32 v208, 16, v208
    v_and_b32 v211, 0xffff0000, v210
    v_lshlrev_b32 v210, 16, v210
    v_and_b32 v213, 0xffff0000, v212
    v_lshlrev_b32 v212, 16, v212
    v_and_b32 v215, 0xffff0000, v214
    v_lshlrev_b32 v214, 16, v214
    v_and_b32 v197, 0xffff0000, v196
    v_lshlrev_b32 v196, 16, v196
    v_and_b32 v199, 0xffff0000, v198
    v_lshlrev_b32 v198, 16, v198
    v_and_b32 v201, 0xffff0000, v200
    v_lshlrev_b32 v200, 16, v200
    v_and_b32 v203, 0xffff0000, v202
    v_lshlrev_b32 v202, 16, v202
    v_and_b32 v205, 0xffff0000, v204
    v_lshlrev_b32 v204, 16, v204
    v_pk_mul_f32 v[236:237], v[236:237], v[206:207]
    v_pk_mul_f32 v[238:239], v[238:239], v[208:209]
    v_pk_mul_f32 v[240:241], v[240:241], v[210:211]
    v_pk_mul_f32 v[242:243], v[242:243], v[212:213]
    v_pk_mul_f32 v[244:245], v[244:245], v[214:215]
    v_cvt_pk_bf16_f32 v236, v236, v237
    v_and_b32 v237, 0xffff0000, v236
    v_lshlrev_b32 v236, 16, v236
    v_cvt_pk_bf16_f32 v238, v238, v239
    v_and_b32 v239, 0xffff0000, v238
    s_branch .Lsk_q0_2
.Lst_q0_2:
    s_branch .Lrt_q0_2
.Lsk_q0_2:
    v_lshlrev_b32 v238, 16, v238
    v_cvt_pk_bf16_f32 v240, v240, v241
    v_and_b32 v241, 0xffff0000, v240
    v_lshlrev_b32 v240, 16, v240
    v_cvt_pk_bf16_f32 v242, v242, v243
    v_and_b32 v243, 0xffff0000, v242
    v_lshlrev_b32 v242, 16, v242
    v_cvt_pk_bf16_f32 v244, v244, v245
    s_branch .Lsk_q0_3
.Lst_q0_3:
    s_branch .Lrt_q0_3
.Lsk_q0_3:
    v_and_b32 v245, 0xffff0000, v244
    v_lshlrev_b32 v244, 16, v244
    v_pk_add_f32 v[236:237], v[236:237], v[196:197]
    v_pk_add_f32 v[238:239], v[238:239], v[198:199]
    v_pk_add_f32 v[240:241], v[240:241], v[200:201]
    v_pk_add_f32 v[242:243], v[242:243], v[202:203]
    v_pk_add_f32 v[244:245], v[244:245], v[204:205]
    v_cvt_pk_bf16_f32 v246, v236, v237
    v_cvt_pk_bf16_f32 v247, v238, v239
    v_cvt_pk_bf16_f32 v248, v240, v241
    v_cvt_pk_bf16_f32 v249, v242, v243
    v_cvt_pk_bf16_f32 v250, v244, v245
    ds_write_b64 v17, v[246:247] offset:0
    ds_write_b64 v17, v[248:249] offset:512
    ds_write_b32 v18, v250 offset:0
    s_add_u32 s63, s69, 319488
    buffer_load_dwordx4 v[148:151], v1, s[40:43], s63 offen nt
    s_waitcnt lgkmcnt(0)
    s_barrier
    s_add_u32 s63, s69, 393216
    buffer_load_dwordx4 v[56:59], v1, s[40:43], s63 offen nt
    ds_read_b128 v[196:199], v16 offset:0
    ds_read_b128 v[200:203], v16 offset:128
    ds_read_b128 v[204:207], v16 offset:256
    ds_read_b128 v[208:211], v16 offset:384
    ds_read_b128 v[212:215], v16 offset:512
    ds_read_b128 v[216:219], v16 offset:640
    ds_read_b128 v[220:223], v16 offset:768
    ds_read_b128 v[224:227], v16 offset:896
    ds_read_b128 v[228:231], v16 offset:1024
    s_waitcnt lgkmcnt(8)
    v_mfma_f32_16x16x32_bf16 v[232:235], v[160:163], v[196:199], 0
    s_waitcnt lgkmcnt(7)
    v_mfma_f32_16x16x32_bf16 v[232:235], v[164:167], v[200:203], v[232:235]
    s_waitcnt lgkmcnt(6)
    v_mfma_f32_16x16x32_bf16 v[232:235], v[168:171], v[204:207], v[232:235]
    s_waitcnt lgkmcnt(5)
    v_mfma_f32_16x16x32_bf16 v[232:235], v[172:175], v[208:211], v[232:235]
    s_waitcnt lgkmcnt(4)
    v_mfma_f32_16x16x32_bf16 v[232:235], v[176:179], v[212:215], v[232:235]
    s_waitcnt lgkmcnt(3)
    v_mfma_f32_16x16x32_bf16 v[232:235], v[180:183], v[216:219], v[232:235]
    s_waitcnt lgkmcnt(2)
    v_mfma_f32_16x16x32_bf16 v[232:235], v[184:187], v[220:223], v[232:235]
    s_waitcnt lgkmcnt(1)
    v_mfma_f32_16x16x32_bf16 v[232:235], v[188:191], v[224:227], v[232:235]
    s_waitcnt lgkmcnt(0)
    v_mfma_f32_16x16x32_bf16 v[232:235], v[192:195], v[228:231], v[232:235]
    s_nop 7
    v_permlane32_swap_b32 v232, v234
    v_permlane32_swap_b32 v233, v235
    v_cndmask_b32 v233, v233, v234, s[96:97]
    v_cndmask_b32 v232, v232, v235, s[96:97]
    s_nop 1
    v_add_f32_dpp v236, v233, v232 quad_perm:[1,0,3,2] row_mask:0xf bank_mask:0xf
    v_and_b32 v12, 1, v0
    v_lshlrev_b32 v12, 8, v12
    v_bfe_u32 v13, v0, 1, 3
    v_lshl_add_u32 v12, v13, 4, v12
    v_cvt_pk_bf16_f32 v236, v236, v236
    ds_write_b16 v23, v236
    v_mov_b32 v243, s34
    s_waitcnt lgkmcnt(0)
    s_barrier
    ds_read2_b32 v[244:245], v24 offset1:1
    v_mov_b32 v241, s34
    s_waitcnt lgkmcnt(0)
    v_mov_b32 v240, v244
    v_mov_b32 v242, v245
    s_mov_b64 exec, 0xffff
    buffer_store_dwordx4 v[240:243], v12, s[36:39], s101 offen sc1
    s_mov_b64 exec, -1
    s_mov_b64 s[18:19], 0
    v_mov_b32 v6, 0
    s_waitcnt vmcnt(3)
    s_bitcmp1_b64 s[14:15], 25
    s_cbranch_scc0 1
    s_waitcnt vmcnt(2)
    s_add_u32 s63, s69, 401408
    buffer_load_dwordx4 v[60:63], v1, s[40:43], s63 offen nt
    s_branch .Ln_att
.La_early:
    s_branch .Lsk_a0_0
.Lst_a0_0:
    s_branch .Lrt_a0_0
.Lsk_a0_0:
    s_mov_b32 s14, 0x6ddb76dd
    s_mov_b32 s15, 0xdb76ddb7
    s_add_u32 s30, s70, -55
    s_mov_b32 s31, s70
    s_cmp_ge_u32 s65, 11
    s_cselect_b32 s99, 1, 0
    s_mul_i32 s57, s99, 3
    s_sub_u32 s100, s65, s57
    s_sub_u32 s100, s100, 8
    s_lshl1_add_u32 s99, s64, s99
    s_mov_b32 s48, s12
    s_and_b32 s49, s13, 0xffff
    s_mov_b32 s50, 0x480000
    s_mov_b32 s51, 0x00020000
    v_bfe_u32 v12, v0, 4, 1
    s_and_b32 s56, s3, 1
    s_lshl_b32 s56, s56, 2
    v_lshl_or_b32 v12, v12, 1, s56
    v_and_b32 v13, 7, v0
    v_xor_b32 v12, v12, v13
    v_lshrrev_b32 v13, 3, v0
    v_mul_u32_u24 v13, 1152, v13
    v_lshl_add_u32 v6, v12, 4, v13
    s_mul_i32 s101, s99, 294912
    s_mul_i32 s56, s100, 384
    s_add_u32 s101, s101, s56
    s_mul_i32 s56, s3, 9216
    s_add_u32 s101, s101, s56
    s_lshl_b32 s57, s3, 10
    s_waitcnt vmcnt(4)
    s_add_u32 m0, s57, 0
    s_add_u32 s56, s101, 0
    buffer_load_dwordx4 v6, s[48:51], s56 offen nt lds
    s_waitcnt vmcnt(4)
    s_add_u32 m0, s57, 32768
    s_add_u32 s56, s101, 128
    buffer_load_dwordx4 v6, s[48:51], s56 offen nt lds
    s_waitcnt vmcnt(4)
    s_bitcmp1_b64 s[14:15], 4
    s_cbranch_scc0 1
    s_waitcnt vmcnt(3)
    s_add_u32 s63, s69, 32768
    buffer_load_dwordx4 v[96:99], v1, s[40:43], s63 offen nt
    s_waitcnt vmcnt(4)
    s_bitcmp1_b64 s[14:15], 5
    s_cbranch_scc0 1
    s_waitcnt vmcnt(2)
    s_add_u32 s63, s69, 40960
    buffer_load_dwordx4 v[100:103], v1, s[40:43], s63 offen nt
    s_waitcnt vmcnt(3)
    s_add_u32 m0, s57, 65536
    s_add_u32 s56, s101, 256
    buffer_load_dwordx4 v6, s[48:51], s56 offen nt lds
    s_waitcnt vmcnt(3)
    s_bitcmp1_b64 s[14:15], 6
    s_cbranch_scc0 1
    s_waitcnt vmcnt(2)
    s_add_u32 s63, s69, 49152
    buffer_load_dwordx4 v[128:131], v1, s[40:43], s63 offen nt
    s_waitcnt vmcnt(3)
    s_bitcmp1_b64 s[14:15], 7
    s_cbranch_scc0 1
    s_waitcnt vmcnt(2)
    s_add_u32 s63, s69, 57344
    buffer_load_dwordx4 v[132:135], v1, s[40:43], s63 offen nt
    s_waitcnt vmcnt(3)
    s_add_u32 m0, s57, 8192
    s_add_u32 s56, s101, 73728
    buffer_load_dwordx4 v6, s[48:51], s56 offen nt lds
    s_waitcnt vmcnt(3)
    s_bitcmp1_b64 s[14:15], 8
    s_cbranch_scc0 1
    s_waitcnt vmcnt(2)
    s_add_u32 s63, s69, 131072
    buffer_load_dwordx4 v[40:43], v1, s[40:43], s63 offen nt
    s_waitcnt vmcnt(3)
    s_bitcmp1_b64 s[14:15], 9
    s_cbranch_scc0 1
    s_waitcnt vmcnt(2)
    s_add_u32 s63, s69, 139264
    buffer_load_dwordx4 v[44:47], v1, s[40:43], s63 offen nt
    s_waitcnt vmcnt(3)
    s_add_u32 m0, s57, 40960
    s_add_u32 s56, s101, 73856
    buffer_load_dwordx4 v6, s[48:51], s56 offen nt lds
    s_waitcnt vmcnt(3)
    s_bitcmp1_b64 s[14:15], 10
    s_cbranch_scc0 1
    s_waitcnt vmcnt(2)
    s_add_u32 s63, s69, 147456
    buffer_load_dwordx4 v[72:75], v1, s[40:43], s63 offen nt
    s_waitcnt vmcnt(3)
    s_bitcmp1_b64 s[14:15], 11
    s_cbranch_scc0 1
    s_waitcnt vmcnt(2)
    s_add_u32 s63, s69, 155648
    buffer_load_dwordx4 v[76:79], v1, s[40:43], s63 offen nt
    s_waitcnt vmcnt(3)
    s_add_u32 m0, s57, 73728
    s_add_u32 s56, s101, 73984
    buffer_load_dwordx4 v6, s[48:51], s56 offen nt lds
    s_waitcnt vmcnt(3)
    s_waitcnt lgkmcnt(0)
    s_add_u32 s34, s34, 1
    s_getreg_b32 s1, hwreg(HW_REG_XCC_ID)
    s_lshl_b32 s1, s1, 24
    s_add_u32 s1, s1, s34
    s_lshr_b32 s0, s2, 3
    s_lshl_b32 s63, s64, 8
    s_add_u32 s0, s0, s63
    s_lshl2_add_u32 s0, s0, 0x480000
    v_mov_b32 v30, s1
    s_cmp_eq_u32 s3, 0
    s_cselect_b64 exec, 1, 0
    buffer_store_dword v30, v2, s[36:39], s0 offen sc1
    s_mov_b64 exec, -1
    s_bitcmp1_b64 s[14:15], 12
    s_cbranch_scc0 1
    s_waitcnt vmcnt(3)
    s_add_u32 s63, s69, 163840
    buffer_load_dwordx4 v[104:107], v1, s[40:43], s63 offen nt
    s_waitcnt vmcnt(4)
    s_bitcmp1_b64 s[14:15], 13
    s_cbranch_scc0 1
    s_waitcnt vmcnt(3)
    s_add_u32 s63, s69, 172032
    buffer_load_dwordx4 v[108:111], v1, s[40:43], s63 offen nt
    s_waitcnt vmcnt(4)
    s_add_u32 m0, s57, 16384
    s_add_u32 s56, s101, 147456
    buffer_load_dwordx4 v6, s[48:51], s56 offen nt lds
    s_waitcnt vmcnt(4)
    s_bitcmp1_b64 s[14:15], 14
    s_cbranch_scc0 1
    s_waitcnt vmcnt(2)
    s_add_u32 s63, s69, 180224
    buffer_load_dwordx4 v[136:139], v1, s[40:43], s63 offen nt
    s_waitcnt vmcnt(3)
    s_bitcmp1_b64 s[14:15], 15
    s_cbranch_scc0 1
    s_waitcnt vmcnt(2)
    s_add_u32 s63, s69, 188416
    buffer_load_dwordx4 v[140:143], v1, s[40:43], s63 offen nt
    s_waitcnt vmcnt(3)
    s_add_u32 m0, s57, 49152
    s_add_u32 s56, s101, 147584
    buffer_load_dwordx4 v6, s[48:51], s56 offen nt lds
    s_waitcnt vmcnt(3)
    s_bitcmp1_b64 s[14:15], 16
    s_cbranch_scc0 1
    s_waitcnt vmcnt(2)
    s_add_u32 s63, s69, 262144
    buffer_load_dwordx4 v[48:51], v1, s[40:43], s63 offen nt
    s_waitcnt vmcnt(3)
    s_bitcmp1_b64 s[14:15], 17
    s_cbranch_scc0 1
    s_waitcnt vmcnt(2)
    s_add_u32 s63, s69, 270336
    buffer_load_dwordx4 v[52:55], v1, s[40:43], s63 offen nt
    s_waitcnt vmcnt(3)
    s_add_u32 m0, s57, 81920
    s_add_u32 s56, s101, 147712
    buffer_load_dwordx4 v6, s[48:51], s56 offen nt lds
    s_waitcnt vmcnt(3)
    s_bitcmp1_b64 s[14:15], 18
    s_cbranch_scc0 1
    s_waitcnt vmcnt(2)
    s_add_u32 s63, s69, 278528
    buffer_load_dwordx4 v[80:83], v1, s[40:43], s63 offen nt
    s_waitcnt vmcnt(3)
    s_bitcmp1_b64 s[14:15], 19
    s_cbranch_scc0 1
    s_waitcnt vmcnt(2)
    s_add_u32 s63, s69, 286720
    buffer_load_dwordx4 v[84:87], v1, s[40:43], s63 offen nt
    s_waitcnt vmcnt(3)
    s_bitcmp1_b64 s[14:15], 20
    s_cbranch_scc0 1
    s_waitcnt vmcnt(2)
    s_add_u32 s63, s69, 294912
    buffer_load_dwordx4 v[112:115], v1, s[40:43], s63 offen nt
    s_waitcnt vmcnt(3)
    s_bitcmp1_b64 s[14:15], 21
    s_cbranch_scc0 1
    s_waitcnt vmcnt(2)
    s_add_u32 s63, s69, 303104
    buffer_load_dwordx4 v[116:119], v1, s[40:43], s63 offen nt
    s_waitcnt vmcnt(3)
    s_bitcmp1_b64 s[14:15], 22
    s_cbranch_scc0 1
    s_waitcnt vmcnt(2)
    s_add_u32 s63, s69, 311296
    buffer_load_dwordx4 v[144:147], v1, s[40:43], s63 offen nt
    s_branch .Lsk_a0_1
.Lst_a0_1:
    s_branch .Lrt_a0_1
.Lsk_a0_1:
    s_waitcnt vmcnt(3)
    s_bitcmp1_b64 s[14:15], 23
    s_cbranch_scc0 1
    s_waitcnt vmcnt(2)
    s_add_u32 s63, s69, 319488
    buffer_load_dwordx4 v[148:151], v1, s[40:43], s63 offen nt
    s_waitcnt vmcnt(3)
    s_bitcmp1_b64 s[14:15], 24
    s_cbranch_scc0 1
    s_waitcnt vmcnt(2)
    s_add_u32 s63, s69, 393216
    buffer_load_dwordx4 v[56:59], v1, s[40:43], s63 offen nt
    s_waitcnt vmcnt(3)
    s_bitcmp1_b64 s[14:15], 25
    s_cbranch_scc0 1
    s_waitcnt vmcnt(2)
    s_add_u32 s63, s69, 401408
    buffer_load_dwordx4 v[60:63], v1, s[40:43], s63 offen nt
    s_mov_b64 s[18:19], -1
.Ln_att:
    v_and_b32 v8, 1, v0
    v_lshlrev_b32 v8, 8, v8
    v_and_b32 v9, 0x3c, v0
    v_lshl_add_u32 v9, v9, 2, v8
    v_add_u32 v7, v9, v8
    v_and_b32 v9, 0x3c, v0
    v_lshrrev_b32 v8, 4, v8
    v_and_b32 v9, 4, v0
    v_lshl_add_u32 v9, v9, 3, v8
    s_lshl_b32 s58, s66, 14
    s_lshl_b32 s59, s67, 10
    s_add_u32 s58, s58, s59
    s_add_u32 s58, s58, 0x70000
    s_lshl4_add_u32 s59, s66, s67
    s_lshl_b32 s59, s59, 7
    s_add_u32 s59, s59, 0x430000
    s_memrealtime s[8:9]
    s_waitcnt vmcnt(8)
    s_waitcnt lgkmcnt(0)
    s_sub_u32 s8, s8, s30
    s_cmpk_ge_u32 s8, 1211
    s_cbranch_scc1 .ap_4
    s_waitcnt vmcnt(5)
    s_cmpk_ge_u32 s8, 1111
    s_cbranch_scc1 .ap_4
    s_waitcnt vmcnt(3)
    s_bitcmp1_b64 s[14:15], 26
    s_cbranch_scc0 1
    s_waitcnt vmcnt(2)
    s_cmpk_ge_u32 s8, 991
    s_cbranch_scc1 .ap_4
    s_waitcnt vmcnt(1)
.ap_4:
    s_add_u32 s63, s69, 409600
    buffer_load_dwordx4 v[88:91], v1, s[40:43], s63 offen nt
    v_and_b32 v157, 7, v0
    v_lshlrev_b32 v157, 2, v157
    s_mov_b32 s63, 0x4a1000
    buffer_load_dword v156, v157, s[36:39], s63 offen
    s_cmp_eq_u32 s3, 0
    s_cbranch_scc1 .Lst_n1_0
.Lrt_n1_0:
    s_cmp_eq_u32 s3, 1
    s_cbranch_scc1 .Lst_n1_1
    s_cmp_eq_u32 s3, 2
    s_cbranch_scc1 .Lst_n1_2
    s_cmp_eq_u32 s3, 3
    s_cbranch_scc1 .Lst_n1_3
    s_cmp_eq_u32 s3, 4
    s_cbranch_scc1 .Lst_n1_4
    s_cmp_eq_u32 s3, 5
    s_cbranch_scc1 .Lst_n1_5
    s_cmp_eq_u32 s3, 6
    s_cbranch_scc1 .Lst_n1_6
    s_cmp_eq_u32 s3, 7
    s_cbranch_scc1 .Lst_n1_7
    s_cmp_eq_u32 s3, 0
    s_cbranch_scc1 .Lrt_n1_8
.Lrt_n1_1:
.Lrt_n1_2:
.Lrt_n1_3:
.Lrt_n1_4:
.Lrt_n1_5:
.Lrt_n1_6:
.Lrt_n1_7:
.Lrt_n1_8:
    s_memrealtime s[8:9]
    s_waitcnt vmcnt(9)
    s_waitcnt lgkmcnt(0)
    s_sub_u32 s8, s8, s30
    s_cmpk_ge_u32 s8, 1238
    s_cbranch_scc1 .ap_5
    s_waitcnt vmcnt(6)
    s_cmpk_ge_u32 s8, 1138
    s_cbranch_scc1 .ap_5
    s_waitcnt vmcnt(4)
    s_bitcmp1_b64 s[14:15], 27
    s_cbranch_scc0 1
    s_waitcnt vmcnt(3)
    s_cmpk_ge_u32 s8, 1018
    s_cbranch_scc1 .ap_5
    s_waitcnt vmcnt(2)
.ap_5:
    s_add_u32 s63, s69, 417792
    buffer_load_dwordx4 v[92:95], v1, s[40:43], s63 offen nt
    s_memrealtime s[8:9]
    s_waitcnt vmcnt(9)
    s_waitcnt lgkmcnt(0)
    s_sub_u32 s8, s8, s30
    s_cmpk_ge_u32 s8, 1265
    s_cbranch_scc1 .ap_6
    s_waitcnt vmcnt(6)
    s_cmpk_ge_u32 s8, 1165
    s_cbranch_scc1 .ap_6
    s_waitcnt vmcnt(4)
    s_bitcmp1_b64 s[14:15], 28
    s_cbranch_scc0 1
    s_waitcnt vmcnt(3)
    s_cmpk_ge_u32 s8, 1045
    s_cbranch_scc1 .ap_6
    s_waitcnt vmcnt(2)
.ap_6:
    s_add_u32 s63, s69, 425984
    buffer_load_dwordx4 v[120:123], v1, s[40:43], s63 offen nt
    s_memrealtime s[8:9]
    s_waitcnt vmcnt(9)
    s_waitcnt lgkmcnt(0)
    s_sub_u32 s8, s8, s30
    s_cmpk_ge_u32 s8, 1292
    s_cbranch_scc1 .ap_7
    s_waitcnt vmcnt(6)
    s_cmpk_ge_u32 s8, 1192
    s_cbranch_scc1 .ap_7
    s_waitcnt vmcnt(4)
    s_bitcmp1_b64 s[14:15], 29
    s_cbranch_scc0 1
    s_waitcnt vmcnt(3)
    s_cmpk_ge_u32 s8, 1072
    s_cbranch_scc1 .ap_7
    s_waitcnt vmcnt(1)
.ap_7:
    s_add_u32 s63, s69, 434176
    buffer_load_dwordx4 v[124:127], v1, s[40:43], s63 offen nt
    s_memrealtime s[8:9]
    s_waitcnt vmcnt(9)
    s_waitcnt lgkmcnt(0)
    s_sub_u32 s8, s8, s30
    s_cmpk_ge_u32 s8, 1320
    s_cbranch_scc1 .ap_8
    s_waitcnt vmcnt(6)
    s_cmpk_ge_u32 s8, 1220
    s_cbranch_scc1 .ap_8
    s_waitcnt vmcnt(4)
    s_bitcmp1_b64 s[14:15], 30
    s_cbranch_scc0 1
    s_waitcnt vmcnt(2)
    s_cmpk_ge_u32 s8, 1100
    s_cbranch_scc1 .ap_8
    s_waitcnt vmcnt(1)
.ap_8:
    s_add_u32 s63, s69, 442368
    buffer_load_dwordx4 v[152:155], v1, s[40:43], s63 offen nt
    s_waitcnt vmcnt(4)
    s_sub_u32 s63, s70, 300
    v_subrev_u32 v156, s63, v156
    v_mov_b32 v157, 600
    v_cmp_lt_u32 s[8:9], v156, v157
    v_add_u32_dpp v156, v156, v156 quad_perm:[1,0,3,2] row_mask:0xf bank_mask:0xf
    s_nop 1
    v_add_u32_dpp v156, v156, v156 quad_perm:[2,3,0,1] row_mask:0xf bank_mask:0xf
    s_nop 1
    v_add_u32_dpp v156, v156, v156 row_ror:4 row_mask:0xf bank_mask:0xf
    s_nop 0
    v_readfirstlane_b32 s63, v156
    s_cmp_eq_u64 s[8:9], -1
    s_nop 3
    s_cbranch_scc0 .et_9
    s_lshr_b32 s63, s63, 3
    s_sub_u32 s63, s63, 300
    s_add_u32 s30, s30, s63
    s_add_u32 s31, s31, s63
.et_9:
    s_memrealtime s[8:9]
    s_waitcnt lgkmcnt(0)
    s_sub_u32 s8, s8, s30
    s_cmpk_ge_u32 s8, 1347
    s_cbranch_scc1 .ap_10
    s_waitcnt vmcnt(4)
    s_cmpk_ge_u32 s8, 1247
    s_cbranch_scc1 .ap_10
    s_waitcnt vmcnt(3)
    s_bitcmp1_b64 s[14:15], 31
    s_cbranch_scc0 1
    s_waitcnt vmcnt(2)
    s_cmpk_ge_u32 s8, 1127
    s_cbranch_scc1 .ap_10
    s_waitcnt vmcnt(1)
.ap_10:
    s_add_u32 s63, s69, 450560
    buffer_load_dwordx4 v[156:159], v1, s[40:43], s63 offen nt
    s_memrealtime s[8:9]
    s_waitcnt lgkmcnt(0)
    s_sub_u32 s8, s8, s30
    s_cmpk_ge_u32 s8, 1374
    s_cbranch_scc1 .ap_11
    s_waitcnt vmcnt(5)
    s_cmpk_ge_u32 s8, 1274
    s_cbranch_scc1 .ap_11
    s_waitcnt vmcnt(3)
    s_bitcmp1_b64 s[14:15], 32
    s_cbranch_scc0 1
    s_waitcnt vmcnt(2)
    s_cmpk_ge_u32 s8, 1154
    s_cbranch_scc1 .ap_11
    s_waitcnt vmcnt(1)
.ap_11:
    v_bfe_u32 v1, v0, 4, 2
    v_and_b32 v10, 0xf0, v2
    v_lshlrev_b32 v1, 2, v1
    v_bfe_u32 v1, s6, v1, 4
    v_lshl_add_u32 v1, v1, 8, v10
    s_add_u32 s63, s69, 0
    buffer_load_dwordx4 v[160:163], v1, s[44:47], s63 offen nt
    s_memrealtime s[8:9]
    s_waitcnt lgkmcnt(0)
    s_sub_u32 s8, s8, s30
    s_cmpk_ge_u32 s8, 1401
    s_cbranch_scc1 .ap_12
    s_waitcnt vmcnt(5)
    s_cmpk_ge_u32 s8, 1301
    s_cbranch_scc1 .ap_12
    s_waitcnt vmcnt(3)
    s_bitcmp1_b64 s[14:15], 33
    s_cbranch_scc0 1
    s_waitcnt vmcnt(2)
    s_cmpk_ge_u32 s8, 1181
    s_cbranch_scc1 .ap_12
    s_waitcnt vmcnt(1)
.ap_12:
    s_add_u32 s63, s69, 8192
    buffer_load_dwordx4 v[164:167], v1, s[44:47], s63 offen nt
    s_memrealtime s[8:9]
    s_waitcnt lgkmcnt(0)
    s_sub_u32 s8, s8, s30
    s_cmpk_ge_u32 s8, 1428
    s_cbranch_scc1 .ap_13
    s_waitcnt vmcnt(5)
    s_cmpk_ge_u32 s8, 1328
    s_cbranch_scc1 .ap_13
    s_waitcnt vmcnt(3)
    s_bitcmp1_b64 s[14:15], 34
    s_cbranch_scc0 1
    s_waitcnt vmcnt(2)
    s_cmpk_ge_u32 s8, 1208
    s_cbranch_scc1 .ap_13
    s_branch .Lsk_n1_0
.Lst_n1_0:
    s_branch .Lrt_n1_0
.Lsk_n1_0:
    s_waitcnt vmcnt(1)
.ap_13:
    s_add_u32 s63, s69, 16384
    buffer_load_dwordx4 v[168:171], v1, s[44:47], s63 offen nt
    s_memrealtime s[8:9]
    s_waitcnt lgkmcnt(0)
    s_sub_u32 s8, s8, s30
    s_cmpk_ge_u32 s8, 1456
    s_cbranch_scc1 .ap_14
    s_waitcnt vmcnt(5)
    s_cmpk_ge_u32 s8, 1356
    s_cbranch_scc1 .ap_14
    s_waitcnt vmcnt(3)
    s_bitcmp1_b64 s[14:15], 35
    s_cbranch_scc0 1
    s_waitcnt vmcnt(2)
    s_cmpk_ge_u32 s8, 1236
    s_cbranch_scc1 .ap_14
    s_waitcnt vmcnt(1)
.ap_14:
    s_add_u32 s63, s69, 24576
    buffer_load_dwordx4 v[172:175], v1, s[44:47], s63 offen nt
    buffer_load_dwordx4 v[16:19], v7, s[36:39], s58 offen offset:0 sc1
    buffer_load_dwordx4 v[20:23], v7, s[36:39], s58 offen offset:256 sc1
    s_memrealtime s[8:9]
    s_waitcnt vmcnt(8)
    s_waitcnt lgkmcnt(0)
    s_sub_u32 s8, s8, s30
    s_cmpk_ge_u32 s8, 1486
    s_cbranch_scc1 .ap_15
    s_waitcnt vmcnt(5)
    s_cmpk_ge_u32 s8, 1386
    s_cbranch_scc1 .ap_15
    s_waitcnt vmcnt(3)
    s_bitcmp1_b64 s[14:15], 36
    s_cbranch_scc0 1
    s_waitcnt vmcnt(2)
    s_cmpk_ge_u32 s8, 1266
    s_cbranch_scc1 .ap_15
    s_waitcnt vmcnt(1)
.ap_15:
    s_add_u32 s63, s69, 32768
    buffer_load_dwordx4 v[176:179], v1, s[44:47], s63 offen nt
    s_memrealtime s[8:9]
    s_waitcnt vmcnt(8)
    s_waitcnt lgkmcnt(0)
    s_sub_u32 s8, s8, s30
    s_cmpk_ge_u32 s8, 1516
    s_cbranch_scc1 .ap_16
    s_waitcnt vmcnt(5)
    s_cmpk_ge_u32 s8, 1416
    s_cbranch_scc1 .ap_16
    s_waitcnt vmcnt(3)
    s_bitcmp1_b64 s[14:15], 37
    s_cbranch_scc0 1
    s_waitcnt vmcnt(2)
    s_cmpk_ge_u32 s8, 1296
    s_cbranch_scc1 .ap_16
    s_waitcnt vmcnt(1)
.ap_16:
    s_add_u32 s63, s69, 40960
    buffer_load_dwordx4 v[180:183], v1, s[44:47], s63 offen nt
    s_memrealtime s[8:9]
    s_waitcnt vmcnt(8)
    s_waitcnt lgkmcnt(0)
    s_sub_u32 s8, s8, s30
    s_cmpk_ge_u32 s8, 1546
    s_cbranch_scc1 .ap_17
    s_waitcnt vmcnt(5)
    s_cmpk_ge_u32 s8, 1446
    s_cbranch_scc1 .ap_17
    s_waitcnt vmcnt(3)
    s_bitcmp1_b64 s[14:15], 38
    s_cbranch_scc0 1
    s_waitcnt vmcnt(2)
    s_cmpk_ge_u32 s8, 1326
    s_cbranch_scc1 .ap_17
    s_waitcnt vmcnt(1)
.ap_17:
    s_add_u32 s63, s69, 49152
    buffer_load_dwordx4 v[184:187], v1, s[44:47], s63 offen nt
    s_waitcnt vmcnt(3)
    s_branch .gpc_19
.gp_18:
    buffer_load_dwordx4 v[16:19], v7, s[36:39], s58 offen offset:0 sc1
    buffer_load_dwordx4 v[20:23], v7, s[36:39], s58 offen offset:256 sc1
    s_waitcnt vmcnt(0)
.gpc_19:
    v_min_u32 v10, v17, v19
    v_max_u32 v11, v17, v19
    v_min3_u32 v10, v10, v21, v23
    v_max3_u32 v11, v11, v21, v23
    v_cmp_eq_u32 vcc, s34, v10
    v_cmp_eq_u32 s[56:57], s34, v11
    s_and_b64 vcc, vcc, s[56:57]
    s_cmp_eq_u64 vcc, -1
    s_nop 2
    s_cbranch_scc1 .gpd_20
    s_sub_u32 s35, s35, 1
    s_cbranch_scc1 .Lexit
    s_sleep 1
    s_branch .gp_18
.gpd_20:
    s_mov_b32 vcc_lo, 0xcccccccc
    s_mov_b32 vcc_hi, 0xcccccccc
    v_cndmask_b32_e64 v24, v16, 0, vcc
    v_cndmask_b32_e64 v25, v18, 0, vcc
    v_cndmask_b32_e64 v26, v20, 0, vcc
    v_cndmask_b32_e64 v27, v22, 0, vcc
    v_cndmask_b32_e32 v28, 0, v16, vcc
    v_cndmask_b32_e32 v29, 0, v18, vcc
    v_cndmask_b32_e32 v30, 0, v20, vcc
    v_cndmask_b32_e32 v31, 0, v22, vcc
    v_mfma_f32_16x16x32_bf16 v[16:19], v[32:35], v[24:27], 0
    v_mfma_f32_16x16x32_bf16 v[32:35], v[40:43], v[24:27], 0
    v_mfma_f32_16x16x32_bf16 v[16:19], v[36:39], v[28:31], v[16:19]
    v_mfma_f32_16x16x32_bf16 v[40:43], v[48:51], v[24:27], 0
    v_mfma_f32_16x16x32_bf16 v[32:35], v[44:47], v[28:31], v[32:35]
    v_mfma_f32_16x16x32_bf16 v[48:51], v[56:59], v[24:27], 0
    v_mfma_f32_16x16x32_bf16 v[40:43], v[52:55], v[28:31], v[40:43]
    v_mfma_f32_16x16x32_bf16 v[56:59], v[64:67], v[24:27], 0
    v_mfma_f32_16x16x32_bf16 v[48:51], v[60:63], v[28:31], v[48:51]
    s_nop 1
    v_add_f32_dpp v10, v17, v16 row_ror:12 row_mask:0xf bank_mask:0x1
    s_memrealtime s[8:9]
    s_waitcnt lgkmcnt(0)
    s_sub_u32 s8, s8, s30
    s_cmpk_ge_u32 s8, 1576
    s_nop 0
    s_cbranch_scc1 .ap_21
    s_waitcnt vmcnt(3)
    s_cmpk_ge_u32 s8, 1476
    s_cbranch_scc1 .ap_21
    s_waitcnt vmcnt(3)
    s_bitcmp1_b64 s[14:15], 39
    s_cbranch_scc0 1
    s_waitcnt vmcnt(2)
    s_cmpk_ge_u32 s8, 1356
    s_cbranch_scc1 .ap_21
    s_waitcnt vmcnt(1)
.ap_21:
    s_add_u32 s63, s69, 57344
    buffer_load_dwordx4 v[188:191], v1, s[44:47], s63 offen nt
    v_mfma_f32_16x16x32_bf16 v[64:67], v[72:75], v[24:27], 0
    v_mfma_f32_16x16x32_bf16 v[56:59], v[68:71], v[28:31], v[56:59]
    v_add_f32_dpp v11, v33, v32 row_ror:12 row_mask:0xf bank_mask:0x1
    v_add_f32_dpp v10, v18, v10 row_ror:8 row_mask:0xf bank_mask:0x1
    v_mfma_f32_16x16x32_bf16 v[72:75], v[80:83], v[24:27], 0
    v_mfma_f32_16x16x32_bf16 v[64:67], v[76:79], v[28:31], v[64:67]
    v_add_f32_dpp v12, v41, v40 row_ror:12 row_mask:0xf bank_mask:0x1
    v_add_f32_dpp v11, v34, v11 row_ror:8 row_mask:0xf bank_mask:0x1
    v_add_f32_dpp v10, v19, v10 row_ror:4 row_mask:0xf bank_mask:0x1
    v_mfma_f32_16x16x32_bf16 v[80:83], v[88:91], v[24:27], 0
    v_mfma_f32_16x16x32_bf16 v[72:75], v[84:87], v[28:31], v[72:75]
    v_add_f32_dpp v13, v49, v48 row_ror:12 row_mask:0xf bank_mask:0x1
    v_add_f32_dpp v12, v42, v12 row_ror:8 row_mask:0xf bank_mask:0x1
    v_add_f32_dpp v11, v35, v11 row_ror:4 row_mask:0xf bank_mask:0x1
    v_mfma_f32_16x16x32_bf16 v[88:91], v[96:99], v[24:27], 0
    v_mfma_f32_16x16x32_bf16 v[80:83], v[92:95], v[28:31], v[80:83]
    v_add_f32_dpp v10, v58, v57 row_ror:12 row_mask:0xf bank_mask:0x2
    v_add_f32_dpp v13, v50, v13 row_ror:8 row_mask:0xf bank_mask:0x1
    v_add_f32_dpp v12, v43, v12 row_ror:4 row_mask:0xf bank_mask:0x1
    s_memrealtime s[8:9]
    s_waitcnt lgkmcnt(0)
    s_sub_u32 s8, s8, s30
    s_cmpk_ge_u32 s8, 1606
    s_nop 0
    s_cbranch_scc1 .ap_22
    s_waitcnt vmcnt(4)
    s_cmpk_ge_u32 s8, 1506
    s_cbranch_scc1 .ap_22
    s_waitcnt vmcnt(3)
    s_bitcmp1_b64 s[14:15], 40
    s_cbranch_scc0 1
    s_waitcnt vmcnt(2)
    s_cmpk_ge_u32 s8, 1386
    s_cbranch_scc1 .ap_22
    s_waitcnt vmcnt(1)
.ap_22:
    s_add_u32 s63, s69, 131072
    buffer_load_dwordx4 v[192:195], v1, s[44:47], s63 offen nt
    v_mfma_f32_16x16x32_bf16 v[96:99], v[104:107], v[24:27], 0
    v_mfma_f32_16x16x32_bf16 v[88:91], v[100:103], v[28:31], v[88:91]
    v_add_f32_dpp v11, v66, v65 row_ror:12 row_mask:0xf bank_mask:0x2
    v_add_f32_dpp v10, v59, v10 row_ror:8 row_mask:0xf bank_mask:0x2
    v_add_f32_dpp v13, v51, v13 row_ror:4 row_mask:0xf bank_mask:0x1
    v_mfma_f32_16x16x32_bf16 v[104:107], v[112:115], v[24:27], 0
    v_mfma_f32_16x16x32_bf16 v[96:99], v[108:111], v[28:31], v[96:99]
    v_add_f32_dpp v12, v74, v73 row_ror:12 row_mask:0xf bank_mask:0x2
    v_add_f32_dpp v11, v67, v11 row_ror:8 row_mask:0xf bank_mask:0x2
    v_add_f32_dpp v10, v56, v10 row_ror:4 row_mask:0xf bank_mask:0x2
    v_mfma_f32_16x16x32_bf16 v[112:115], v[120:123], v[24:27], 0
    v_mfma_f32_16x16x32_bf16 v[104:107], v[116:119], v[28:31], v[104:107]
    v_add_f32_dpp v13, v82, v81 row_ror:12 row_mask:0xf bank_mask:0x2
    v_add_f32_dpp v12, v75, v12 row_ror:8 row_mask:0xf bank_mask:0x2
    v_add_f32_dpp v11, v64, v11 row_ror:4 row_mask:0xf bank_mask:0x2
    v_mfma_f32_16x16x32_bf16 v[120:123], v[128:131], v[24:27], 0
    v_mfma_f32_16x16x32_bf16 v[112:115], v[124:127], v[28:31], v[112:115]
    v_add_f32_dpp v10, v91, v90 row_ror:12 row_mask:0xf bank_mask:0x4
    v_add_f32_dpp v13, v83, v13 row_ror:8 row_mask:0xf bank_mask:0x2
    v_add_f32_dpp v12, v72, v12 row_ror:4 row_mask:0xf bank_mask:0x2
    s_branch .Lsk_n1_1
.Lst_n1_1:
    s_branch .Lrt_n1_1
.Lsk_n1_1:
    s_memrealtime s[8:9]
    s_waitcnt lgkmcnt(0)
    s_sub_u32 s8, s8, s30
    s_cmpk_ge_u32 s8, 1636
    s_nop 0
    s_cbranch_scc1 .ap_23
    s_waitcnt vmcnt(5)
    s_cmpk_ge_u32 s8, 1536
    s_cbranch_scc1 .ap_23
    s_waitcnt vmcnt(3)
    s_bitcmp1_b64 s[14:15], 41
    s_cbranch_scc0 1
    s_waitcnt vmcnt(2)
    s_cmpk_ge_u32 s8, 1416
    s_cbranch_scc1 .ap_23
    s_waitcnt vmcnt(1)
.ap_23:
    s_add_u32 s63, s69, 139264
    buffer_load_dwordx4 v[196:199], v1, s[44:47], s63 offen nt
    v_mfma_f32_16x16x32_bf16 v[128:131], v[136:139], v[24:27], 0
    v_mfma_f32_16x16x32_bf16 v[120:123], v[132:135], v[28:31], v[120:123]
    v_add_f32_dpp v11, v99, v98 row_ror:12 row_mask:0xf bank_mask:0x4
    v_add_f32_dpp v10, v88, v10 row_ror:8 row_mask:0xf bank_mask:0x4
    v_add_f32_dpp v13, v80, v13 row_ror:4 row_mask:0xf bank_mask:0x2
    v_mfma_f32_16x16x32_bf16 v[136:139], v[144:147], v[24:27], 0
    v_mfma_f32_16x16x32_bf16 v[128:131], v[140:143], v[28:31], v[128:131]
    v_add_f32_dpp v12, v107, v106 row_ror:12 row_mask:0xf bank_mask:0x4
    v_add_f32_dpp v11, v96, v11 row_ror:8 row_mask:0xf bank_mask:0x4
    v_add_f32_dpp v10, v89, v10 row_ror:4 row_mask:0xf bank_mask:0x4
    v_mfma_f32_16x16x32_bf16 v[144:147], v[152:155], v[24:27], 0
    v_mfma_f32_16x16x32_bf16 v[136:139], v[148:151], v[28:31], v[136:139]
    v_add_f32_dpp v13, v115, v114 row_ror:12 row_mask:0xf bank_mask:0x4
    v_add_f32_dpp v12, v104, v12 row_ror:8 row_mask:0xf bank_mask:0x4
    v_add_f32_dpp v11, v97, v11 row_ror:4 row_mask:0xf bank_mask:0x4
    v_mfma_f32_16x16x32_bf16 v[144:147], v[156:159], v[28:31], v[144:147]
    v_add_f32_dpp v10, v120, v123 row_ror:12 row_mask:0xf bank_mask:0x8
    v_add_f32_dpp v13, v112, v13 row_ror:8 row_mask:0xf bank_mask:0x4
    v_add_f32_dpp v12, v105, v12 row_ror:4 row_mask:0xf bank_mask:0x4
    s_branch .Lsk_n1_2
.Lst_n1_2:
    s_branch .Lrt_n1_2
.Lsk_n1_2:
    s_memrealtime s[8:9]
    s_waitcnt lgkmcnt(0)
    s_sub_u32 s8, s8, s30
    s_cmpk_ge_u32 s8, 1666
    s_nop 0
    s_cbranch_scc1 .ap_24
    s_waitcnt vmcnt(5)
    s_cmpk_ge_u32 s8, 1566
    s_cbranch_scc1 .ap_24
    s_waitcnt vmcnt(3)
    s_bitcmp1_b64 s[14:15], 42
    s_cbranch_scc0 1
    s_waitcnt vmcnt(2)
    s_cmpk_ge_u32 s8, 1446
    s_cbranch_scc1 .ap_24
    s_waitcnt vmcnt(1)
.ap_24:
    s_add_u32 s63, s69, 147456
    buffer_load_dwordx4 v[200:203], v1, s[44:47], s63 offen nt
    v_add_f32_dpp v11, v128, v131 row_ror:12 row_mask:0xf bank_mask:0x8
    v_add_f32_dpp v10, v121, v10 row_ror:8 row_mask:0xf bank_mask:0x8
    v_add_f32_dpp v13, v113, v13 row_ror:4 row_mask:0xf bank_mask:0x4
    v_add_f32_dpp v12, v136, v139 row_ror:12 row_mask:0xf bank_mask:0x8
    v_add_f32_dpp v11, v129, v11 row_ror:8 row_mask:0xf bank_mask:0x8
    v_add_f32_dpp v10, v122, v10 row_ror:4 row_mask:0xf bank_mask:0x8
    v_add_f32_dpp v13, v144, v147 row_ror:12 row_mask:0xf bank_mask:0x8
    v_add_f32_dpp v12, v137, v12 row_ror:8 row_mask:0xf bank_mask:0x8
    v_add_f32_dpp v11, v130, v11 row_ror:4 row_mask:0xf bank_mask:0x8
    v_add_f32_dpp v13, v145, v13 row_ror:8 row_mask:0xf bank_mask:0x8
    v_add_f32_dpp v12, v138, v12 row_ror:4 row_mask:0xf bank_mask:0x8
    s_memrealtime s[8:9]
    s_waitcnt lgkmcnt(0)
    s_sub_u32 s8, s8, s30
    s_cmpk_ge_u32 s8, 1696
    s_cbranch_scc1 .ap_25
    s_waitcnt vmcnt(5)
    s_cmpk_ge_u32 s8, 1596
    s_cbranch_scc1 .ap_25
    s_waitcnt vmcnt(3)
    s_bitcmp1_b64 s[14:15], 43
    s_cbranch_scc0 1
    s_waitcnt vmcnt(2)
    s_cmpk_ge_u32 s8, 1476
    s_cbranch_scc1 .ap_25
    s_waitcnt vmcnt(1)
.ap_25:
    s_add_u32 s63, s69, 155648
    buffer_load_dwordx4 v[204:207], v1, s[44:47], s63 offen nt
    v_add_f32_dpp v13, v146, v13 row_ror:4 row_mask:0xf bank_mask:0x8
    s_mov_b32 s60, 0x3db504f3
    s_mov_b32 s61, 0x3db504f3
    v_cvt_pk_bf16_f32 v10, v10, v11
    v_and_b32 v11, 0xffff0000, v10
    v_lshlrev_b32 v10, 16, v10
    v_cvt_pk_bf16_f32 v12, v12, v13
    v_and_b32 v13, 0xffff0000, v12
    v_lshlrev_b32 v12, 16, v12
    v_pk_mul_f32 v[10:11], v[10:11], s[60:61]
    v_pk_mul_f32 v[12:13], v[12:13], s[60:61]
    v_cvt_pk_bf16_f32 v10, v10, v11
    v_and_b32 v11, 0xffff0000, v10
    v_lshlrev_b32 v10, 16, v10
    v_cvt_pk_bf16_f32 v12, v12, v13
    v_and_b32 v13, 0xffff0000, v12
    v_lshlrev_b32 v12, 16, v12
    v_max_f32 v14, v10, v11
    v_max3_f32 v14, v14, v12, v13
    s_mov_b32 s60, 0x3fb8aa3b
    v_mov_b32 v22, s34
    v_mov_b32 v23, s34
    v_max_f32_dpp v14, v14, v14 quad_perm:[2,3,0,1] row_mask:0xf bank_mask:0xf
    s_nop 1
    v_max_f32_dpp v14, v14, v14 row_ror:4 row_mask:0xf bank_mask:0xf
    s_nop 1
    v_max_f32_dpp v14, v14, v14 row_ror:8 row_mask:0xf bank_mask:0xf
    v_mov_b32 v15, v14
    s_nop 1
    v_permlane16_swap_b32 v15, v14
    v_max_f32 v14, v15, v14
    v_mov_b32 v15, v14
    s_nop 1
    v_permlane32_swap_b32 v15, v14
    v_max_f32 v14, v15, v14
    v_mul_f32 v15, 0xbfb8aa3b, v14
    v_fma_f32 v10, v10, s60, v15
    v_fma_f32 v11, v11, s60, v15
    v_fma_f32 v12, v12, s60, v15
    v_fma_f32 v13, v13, s60, v15
    v_exp_f32 v10, v10
    v_exp_f32 v11, v11
    v_exp_f32 v12, v12
    v_exp_f32 v13, v13
    v_mov_b32 v20, v14
    v_pk_add_f32 v[16:17], v[10:11], v[12:13]
    v_add_f32 v21, v16, v17
    s_lshl_b32 s60, s68, 5
    s_lshl_b32 s61, s3, 4
    s_add_u32 s61, s61, 159104
    v_add_u32 v16, s61, v3
    v_mov_b32 v17, 159232
    v_mov_b32 v18, 1
    s_add_u32 s60, s60, s59
    v_add_f32_dpp v21, v21, v21 quad_perm:[2,3,0,1] row_mask:0xf bank_mask:0xf
    s_nop 1
    v_add_f32_dpp v21, v21, v21 row_ror:4 row_mask:0xf bank_mask:0xf
    s_nop 1
    v_add_f32_dpp v21, v21, v21 row_ror:8 row_mask:0xf bank_mask:0xf
    v_mov_b32 v15, v21
    s_nop 1
    v_permlane16_swap_b32 v15, v21
    v_add_f32 v21, v15, v21
    v_mov_b32 v15, v21
    s_nop 1
    v_permlane32_swap_b32 v15, v21
    v_add_f32 v21, v15, v21
    s_mov_b64 exec, 3
    ds_write_b64 v16, v[20:21]
    s_mov_b64 exec, 1
    ds_add_rtn_u32 v18, v17, v18
    s_mov_b64 exec, -1
    v_and_b32 v16, 0x78, v3
    v_or_b32 v16, 159104, v16
    s_waitcnt lgkmcnt(0)
    v_readfirstlane_b32 s61, v18
    s_cmp_eq_u32 s61, 7
    s_nop 3
    s_cbranch_scc0 .mlc_26
    ds_read_b64 v[18:19], v16
    s_waitcnt lgkmcnt(0)
    v_mov_b32 v20, v18
    s_nop 1
    v_max_f32_dpp v20, v20, v20 quad_perm:[2,3,0,1] row_mask:0xf bank_mask:0xf
    s_nop 1
    v_max_f32_dpp v20, v20, v20 row_ror:4 row_mask:0xf bank_mask:0xf
    s_nop 1
    v_max_f32_dpp v20, v20, v20 row_ror:8 row_mask:0xf bank_mask:0xf
    v_sub_f32 v18, v18, v20
    v_mul_f32 v18, 0x3fb8aa3b, v18
    v_exp_f32 v18, v18
    s_nop 0
    v_mul_f32 v21, v18, v19
    s_nop 1
    v_add_f32_dpp v21, v21, v21 quad_perm:[2,3,0,1] row_mask:0xf bank_mask:0xf
    s_nop 1
    v_add_f32_dpp v21, v21, v21 row_ror:4 row_mask:0xf bank_mask:0xf
    s_nop 1
    v_add_f32_dpp v21, v21, v21 row_ror:8 row_mask:0xf bank_mask:0xf
    s_mov_b64 exec, 3
    buffer_store_dwordx4 v[20:23], v2, s[36:39], s60 offen sc1
    s_mov_b64 exec, -1
.mlc_26:
    s_memrealtime s[8:9]
    s_waitcnt lgkmcnt(0)
    s_sub_u32 s8, s8, s30
    s_cmpk_ge_u32 s8, 1726
    s_cbranch_scc1 .ap_27
    s_waitcnt vmcnt(5)
    s_cmpk_ge_u32 s8, 1626
    s_cbranch_scc1 .ap_27
    s_waitcnt vmcnt(3)
    s_bitcmp1_b64 s[14:15], 44
    s_cbranch_scc0 1
    s_waitcnt vmcnt(2)
    s_cmpk_ge_u32 s8, 1506
    s_cbranch_scc1 .ap_27
    s_waitcnt vmcnt(1)
.ap_27:
    s_add_u32 s63, s69, 163840
    buffer_load_dwordx4 v[208:211], v1, s[44:47], s63 offen nt
    s_memrealtime s[8:9]
    s_waitcnt vmcnt(8)
    s_waitcnt lgkmcnt(0)
    s_sub_u32 s8, s8, s30
    s_cmpk_ge_u32 s8, 1756
    s_cbranch_scc1 .ap_28
    s_waitcnt vmcnt(5)
    s_cmpk_ge_u32 s8, 1656
    s_cbranch_scc1 .ap_28
    s_waitcnt vmcnt(3)
    s_bitcmp1_b64 s[14:15], 45
    s_cbranch_scc0 1
    s_waitcnt vmcnt(2)
    s_cmpk_ge_u32 s8, 1536
    s_cbranch_scc1 .ap_28
    s_waitcnt vmcnt(1)
.ap_28:
    s_add_u32 s63, s69, 172032
    buffer_load_dwordx4 v[212:215], v1, s[44:47], s63 offen nt
    s_memrealtime s[8:9]
    s_waitcnt vmcnt(8)
    s_waitcnt lgkmcnt(0)
    s_sub_u32 s8, s8, s30
    s_cmpk_ge_u32 s8, 1788
    s_cbranch_scc1 .ap_29
    s_waitcnt vmcnt(5)
    s_cmpk_ge_u32 s8, 1688
    s_cbranch_scc1 .ap_29
    s_waitcnt vmcnt(3)
    s_bitcmp1_b64 s[14:15], 46
    s_cbranch_scc0 1
    s_waitcnt vmcnt(2)
    s_cmpk_ge_u32 s8, 1568
    s_cbranch_scc1 .ap_29
    s_waitcnt vmcnt(1)
.ap_29:
    s_add_u32 s63, s69, 180224
    buffer_load_dwordx4 v[216:219], v1, s[44:47], s63 offen nt
    s_branch .Lsk_n1_3
.Lst_n1_3:
    s_branch .Lrt_n1_3
.Lsk_n1_3:
    s_memrealtime s[8:9]
    s_waitcnt vmcnt(8)
    s_waitcnt lgkmcnt(0)
    s_sub_u32 s8, s8, s30
    s_cmpk_ge_u32 s8, 1820
    s_cbranch_scc1 .ap_30
    s_waitcnt vmcnt(5)
    s_cmpk_ge_u32 s8, 1720
    s_cbranch_scc1 .ap_30
    s_waitcnt vmcnt(3)
    s_bitcmp1_b64 s[14:15], 47
    s_cbranch_scc0 1
    s_waitcnt vmcnt(2)
    s_cmpk_ge_u32 s8, 1600
    s_cbranch_scc1 .ap_30
    s_waitcnt vmcnt(1)
.ap_30:
    s_add_u32 s63, s69, 188416
    buffer_load_dwordx4 v[220:223], v1, s[44:47], s63 offen nt
    s_memrealtime s[8:9]
    s_waitcnt vmcnt(8)
    s_waitcnt lgkmcnt(0)
    s_sub_u32 s8, s8, s30
    s_cmpk_ge_u32 s8, 1852
    s_cbranch_scc1 .ap_31
    s_waitcnt vmcnt(5)
    s_cmpk_ge_u32 s8, 1752
    s_cbranch_scc1 .ap_31
    s_waitcnt vmcnt(3)
    s_bitcmp1_b64 s[14:15], 48
    s_cbranch_scc0 1
    s_waitcnt vmcnt(2)
    s_cmpk_ge_u32 s8, 1632
    s_cbranch_scc1 .ap_31
    s_waitcnt vmcnt(1)
.ap_31:
    s_add_u32 s63, s69, 262144
    buffer_load_dwordx4 v[224:227], v1, s[44:47], s63 offen nt
    s_memrealtime s[8:9]
    s_waitcnt vmcnt(8)
    s_waitcnt lgkmcnt(0)
    s_sub_u32 s8, s8, s30
    s_cmpk_ge_u32 s8, 1884
    s_cbranch_scc1 .ap_32
    s_waitcnt vmcnt(5)
    s_cmpk_ge_u32 s8, 1784
    s_cbranch_scc1 .ap_32
    s_waitcnt vmcnt(3)
    s_bitcmp1_b64 s[14:15], 49
    s_cbranch_scc0 1
    s_waitcnt vmcnt(2)
    s_cmpk_ge_u32 s8, 1664
    s_cbranch_scc1 .ap_32
    s_waitcnt vmcnt(1)
.ap_32:
    s_add_u32 s63, s69, 270336
    buffer_load_dwordx4 v[228:231], v1, s[44:47], s63 offen nt
    s_memrealtime s[8:9]
    s_waitcnt vmcnt(8)
    s_waitcnt lgkmcnt(0)
    s_sub_u32 s8, s8, s30
    s_cmpk_ge_u32 s8, 1916
    s_cbranch_scc1 .ap_33
    s_waitcnt vmcnt(5)
    s_cmpk_ge_u32 s8, 1816
    s_cbranch_scc1 .ap_33
    s_waitcnt vmcnt(3)
    s_bitcmp1_b64 s[14:15], 50
    s_cbranch_scc0 1
    s_waitcnt vmcnt(2)
    s_cmpk_ge_u32 s8, 1696
    s_cbranch_scc1 .ap_33
    s_waitcnt vmcnt(1)
.ap_33:
    s_add_u32 s63, s69, 278528
    buffer_load_dwordx4 v[232:235], v1, s[44:47], s63 offen nt
    s_memrealtime s[8:9]
    s_waitcnt vmcnt(8)
    s_waitcnt lgkmcnt(0)
    s_sub_u32 s8, s8, s30
    s_cmpk_ge_u32 s8, 1948
    s_cbranch_scc1 .ap_34
    s_waitcnt vmcnt(5)
    s_cmpk_ge_u32 s8, 1848
    s_cbranch_scc1 .ap_34
    s_waitcnt vmcnt(3)
    s_bitcmp1_b64 s[14:15], 51
    s_cbranch_scc0 1
    s_waitcnt vmcnt(2)
    s_cmpk_ge_u32 s8, 1728
    s_cbranch_scc1 .ap_34
    s_waitcnt vmcnt(1)
.ap_34:
    s_add_u32 s63, s69, 286720
    buffer_load_dwordx4 v[236:239], v1, s[44:47], s63 offen nt
    s_memrealtime s[8:9]
    s_waitcnt vmcnt(8)
    s_waitcnt lgkmcnt(0)
    s_sub_u32 s8, s8, s30
    s_cmpk_ge_u32 s8, 1980
    s_cbranch_scc1 .ap_35
    s_waitcnt vmcnt(5)
    s_cmpk_ge_u32 s8, 1880
    s_cbranch_scc1 .ap_35
    s_waitcnt vmcnt(3)
    s_bitcmp1_b64 s[14:15], 52
    s_cbranch_scc0 1
    s_waitcnt vmcnt(2)
    s_cmpk_ge_u32 s8, 1760
    s_cbranch_scc1 .ap_35
    s_waitcnt vmcnt(1)
.ap_35:
    s_add_u32 s63, s69, 294912
    buffer_load_dwordx4 v[240:243], v1, s[44:47], s63 offen nt
    s_memrealtime s[8:9]
    s_waitcnt vmcnt(8)
    s_waitcnt lgkmcnt(0)
    s_sub_u32 s8, s8, s30
    s_cmpk_ge_u32 s8, 2012
    s_cbranch_scc1 .ap_36
    s_waitcnt vmcnt(5)
    s_cmpk_ge_u32 s8, 1912
    s_cbranch_scc1 .ap_36
    s_waitcnt vmcnt(3)
    s_bitcmp1_b64 s[14:15], 53
    s_cbranch_scc0 1
    s_waitcnt vmcnt(2)
    s_cmpk_ge_u32 s8, 1792
    s_cbranch_scc1 .ap_36
    s_waitcnt vmcnt(1)
.ap_36:
    s_add_u32 s63, s69, 303104
    buffer_load_dwordx4 v[244:247], v1, s[44:47], s63 offen nt
    s_and_b32 s0, s0, 0xffffff80
    s_sub_u32 s0, s0, 1024
    buffer_load_dword v28, v4, s[36:39], s0 offen sc1
    buffer_load_dwordx4 v[24:27], v9, s[36:39], s59 offen offset:0 sc1
    s_memrealtime s[8:9]
    s_waitcnt vmcnt(9)
    s_waitcnt lgkmcnt(0)
    s_sub_u32 s8, s8, s30
    s_cmpk_ge_u32 s8, 2044
    s_cbranch_scc1 .ap_37
    s_waitcnt vmcnt(6)
    s_cmpk_ge_u32 s8, 1944
    s_cbranch_scc1 .ap_37
    s_waitcnt vmcnt(4)
    s_bitcmp1_b64 s[14:15], 54
    s_cbranch_scc0 1
    s_waitcnt vmcnt(3)
    s_cmpk_ge_u32 s8, 1824
    s_cbranch_scc1 .ap_37
    s_waitcnt vmcnt(2)
.ap_37:
    s_add_u32 s63, s69, 311296
    buffer_load_dwordx4 v[248:251], v1, s[44:47], s63 offen nt
    s_memrealtime s[8:9]
    s_waitcnt vmcnt(9)
    s_waitcnt lgkmcnt(0)
    s_sub_u32 s8, s8, s30
    s_cmpk_ge_u32 s8, 2076
    s_cbranch_scc1 .ap_38
    s_waitcnt vmcnt(6)
    s_cmpk_ge_u32 s8, 1976
    s_cbranch_scc1 .ap_38
    s_waitcnt vmcnt(4)
    s_bitcmp1_b64 s[14:15], 55
    s_cbranch_scc0 1
    s_waitcnt vmcnt(3)
    s_cmpk_ge_u32 s8, 1856
    s_cbranch_scc1 .ap_38
    s_waitcnt vmcnt(1)
.ap_38:
    s_add_u32 s63, s69, 319488
    buffer_load_dwordx4 v[252:255], v1, s[44:47], s63 offen nt
    s_memrealtime s[8:9]
    s_waitcnt vmcnt(9)
    s_waitcnt lgkmcnt(0)
    s_sub_u32 s8, s8, s30
    s_cmpk_ge_u32 s8, 2108
    s_cbranch_scc1 .ap_39
    s_waitcnt vmcnt(6)
    s_cmpk_ge_u32 s8, 2008
    s_cbranch_scc1 .ap_39
    s_waitcnt vmcnt(4)
    s_bitcmp1_b64 s[14:15], 56
    s_cbranch_scc0 1
    s_waitcnt vmcnt(2)
    s_cmpk_ge_u32 s8, 1888
    s_cbranch_scc1 .ap_39
    s_waitcnt vmcnt(1)
.ap_39:
    s_add_u32 s63, s69, 393216
    buffer_load_dwordx4 v[36:39], v1, s[44:47], s63 offen nt
    s_memrealtime s[8:9]
    s_waitcnt vmcnt(9)
    s_waitcnt lgkmcnt(0)
    s_sub_u32 s8, s8, s30
    s_cmpk_ge_u32 s8, 2140
    s_cbranch_scc1 .ap_40
    s_waitcnt vmcnt(6)
    s_cmpk_ge_u32 s8, 2040
    s_cbranch_scc1 .ap_40
    s_waitcnt vmcnt(3)
    s_bitcmp1_b64 s[14:15], 57
    s_cbranch_scc0 1
    s_waitcnt vmcnt(2)
    s_cmpk_ge_u32 s8, 1920
    s_cbranch_scc1 .ap_40
    s_waitcnt vmcnt(1)
.ap_40:
    s_add_u32 s63, s69, 401408
    buffer_load_dwordx4 v[44:47], v1, s[44:47], s63 offen nt
    s_memrealtime s[8:9]
    s_waitcnt vmcnt(9)
    s_waitcnt lgkmcnt(0)
    s_sub_u32 s8, s8, s30
    s_cmpk_ge_u32 s8, 2172
    s_cbranch_scc1 .ap_41
    s_waitcnt vmcnt(6)
    s_cmpk_ge_u32 s8, 2072
    s_cbranch_scc1 .ap_41
    s_waitcnt vmcnt(3)
    s_bitcmp1_b64 s[14:15], 58
    s_cbranch_scc0 1
    s_waitcnt vmcnt(2)
    s_cmpk_ge_u32 s8, 1952
    s_cbranch_scc1 .ap_41
    s_waitcnt vmcnt(1)
.ap_41:
    s_add_u32 s63, s69, 409600
    buffer_load_dwordx4 v[52:55], v1, s[44:47], s63 offen nt
    s_waitcnt vmcnt(5)
    s_branch .gpc_43
.gp_42:
    buffer_load_dwordx4 v[24:27], v9, s[36:39], s59 offen offset:0 sc1
    s_waitcnt vmcnt(0)
.gpc_43:
    v_cmp_eq_u32 vcc, s34, v26
    s_cmp_eq_u64 vcc, -1
    s_nop 3
    s_cbranch_scc1 .gpd_44
    s_sub_u32 s35, s35, 1
    s_branch .Lsk_n1_4
.Lst_n1_4:
    s_branch .Lrt_n1_4
.Lsk_n1_4:
    s_cbranch_scc1 .Lexit
    s_sleep 1
    s_branch .gp_42
.gpd_44:
    v_cmp_eq_u32 vcc, s1, v28
    s_cmp_eq_u64 vcc, -1
    s_cselect_b32 s0, 0x800000, 0
    v_mov_b32 v16, v24
    s_nop 1
    v_max_f32_dpp v16, v16, v16 row_ror:4 row_mask:0xf bank_mask:0xf
    v_sub_f32 v17, v24, v16
    v_sub_f32 v18, v14, v16
    v_mul_f32 v17, 0x3fb8aa3b, v17
    v_mul_f32 v18, 0x3fb8aa3b, v18
    v_exp_f32 v17, v17
    v_exp_f32 v18, v18
    v_mul_f32 v17, v17, v25
    s_nop 1
    v_add_f32_dpp v17, v17, v17 row_ror:4 row_mask:0xf bank_mask:0xf
    v_rcp_f32 v19, v17
    s_nop 0
    v_fma_f32 v15, -v17, v19, 1.0
    v_fma_f32 v19, v15, v19, v19
    v_mul_f32 v18, v18, v19
    v_mul_f32 v10, v10, v18
    v_mul_f32 v11, v11, v18
    v_mul_f32 v12, v12, v18
    v_mul_f32 v13, v13, v18
    v_mov_b32_dpp v112, v10 quad_perm:[2,3,0,1] row_mask:0xf bank_mask:0xf
    v_mov_b32_dpp v113, v11 quad_perm:[2,3,0,1] row_mask:0xf bank_mask:0xf
    v_mov_b32_dpp v114, v12 quad_perm:[2,3,0,1] row_mask:0xf bank_mask:0xf
    v_mov_b32_dpp v115, v13 quad_perm:[2,3,0,1] row_mask:0xf bank_mask:0xf
    v_cvt_pk_bf16_f32 v96, v10, v112
    v_cvt_pk_bf16_f32 v100, v11, v113
    v_cvt_pk_bf16_f32 v104, v12, v114
    v_cvt_pk_bf16_f32 v108, v13, v115
    v_mov_b32_dpp v97, v96 row_ror:12 row_mask:0xf bank_mask:0xf
    v_mov_b32_dpp v101, v100 row_ror:12 row_mask:0xf bank_mask:0xf
    v_mov_b32_dpp v105, v104 row_ror:12 row_mask:0xf bank_mask:0xf
    v_mov_b32_dpp v109, v108 row_ror:12 row_mask:0xf bank_mask:0xf
    v_mov_b32_dpp v98, v96 row_ror:8 row_mask:0xf bank_mask:0xf
    v_mov_b32_dpp v102, v100 row_ror:8 row_mask:0xf bank_mask:0xf
    v_mov_b32_dpp v106, v104 row_ror:8 row_mask:0xf bank_mask:0xf
    v_mov_b32_dpp v110, v108 row_ror:8 row_mask:0xf bank_mask:0xf
    v_mov_b32_dpp v99, v96 row_ror:4 row_mask:0xf bank_mask:0xf
    v_mov_b32_dpp v103, v100 row_ror:4 row_mask:0xf bank_mask:0xf
    v_mov_b32_dpp v107, v104 row_ror:4 row_mask:0xf bank_mask:0xf
    v_mov_b32_dpp v111, v108 row_ror:4 row_mask:0xf bank_mask:0xf
    s_lshl_b32 s60, s3, 10
    s_add_u32 s60, s60, 147456
    v_lshlrev_b32 v10, 5, v0
    v_add_u32 v10, s60, v10
    s_memrealtime s[8:9]
    s_waitcnt lgkmcnt(0)
    s_sub_u32 s8, s8, s30
    s_cmpk_ge_u32 s8, 2204
    s_cbranch_scc1 .ap_45
    s_waitcnt vmcnt(5)
    s_cmpk_ge_u32 s8, 2104
    s_cbranch_scc1 .ap_45
    s_waitcnt vmcnt(3)
    s_bitcmp1_b64 s[14:15], 59
    s_cbranch_scc0 1
    s_waitcnt vmcnt(2)
    s_cmpk_ge_u32 s8, 1984
    s_cbranch_scc1 .ap_45
    s_waitcnt vmcnt(1)
.ap_45:
    s_add_u32 s63, s69, 417792
    buffer_load_dwordx4 v[60:63], v1, s[44:47], s63 offen nt
    v_perm_b32 v112, v164, v160, s94
    v_perm_b32 v113, v172, v168, s94
    v_perm_b32 v114, v180, v176, s94
    v_perm_b32 v115, v188, v184, s94
    s_nop 1
    v_mfma_f32_16x16x32_bf16 v[128:131], v[96:99], v[112:115], 0
    v_perm_b32 v116, v164, v160, s95
    v_perm_b32 v117, v172, v168, s95
    v_perm_b32 v118, v180, v176, s95
    v_perm_b32 v119, v188, v184, s95
    s_nop 1
    v_mfma_f32_16x16x32_bf16 v[132:135], v[96:99], v[116:119], 0
    v_perm_b32 v120, v165, v161, s94
    v_perm_b32 v121, v173, v169, s94
    v_perm_b32 v122, v181, v177, s94
    v_perm_b32 v123, v189, v185, s94
    s_nop 1
    v_mfma_f32_16x16x32_bf16 v[136:139], v[96:99], v[120:123], 0
    v_perm_b32 v124, v165, v161, s95
    v_perm_b32 v125, v173, v169, s95
    v_perm_b32 v126, v181, v177, s95
    v_perm_b32 v127, v189, v185, s95
    s_nop 1
    v_mfma_f32_16x16x32_bf16 v[140:143], v[96:99], v[124:127], 0
    v_perm_b32 v112, v166, v162, s94
    v_perm_b32 v113, v174, v170, s94
    v_perm_b32 v114, v182, v178, s94
    v_perm_b32 v115, v190, v186, s94
    s_nop 1
    v_mfma_f32_16x16x32_bf16 v[144:147], v[96:99], v[112:115], 0
    v_perm_b32 v116, v166, v162, s95
    v_perm_b32 v117, v174, v170, s95
    v_perm_b32 v118, v182, v178, s95
    v_perm_b32 v119, v190, v186, s95
    s_nop 1
    v_mfma_f32_16x16x32_bf16 v[148:151], v[96:99], v[116:119], 0
    v_perm_b32 v120, v167, v163, s94
    v_perm_b32 v121, v175, v171, s94
    v_perm_b32 v122, v183, v179, s94
    v_perm_b32 v123, v191, v187, s94
    s_nop 1
    v_mfma_f32_16x16x32_bf16 v[152:155], v[96:99], v[120:123], 0
    v_perm_b32 v124, v167, v163, s95
    v_perm_b32 v125, v175, v171, s95
    v_perm_b32 v126, v183, v179, s95
    v_perm_b32 v127, v191, v187, s95
    s_nop 1
    v_mfma_f32_16x16x32_bf16 v[156:159], v[96:99], v[124:127], 0
    s_memrealtime s[8:9]
    s_waitcnt lgkmcnt(0)
    s_sub_u32 s8, s8, s30
    s_cmpk_ge_u32 s8, 2236
    s_nop 3
    s_cbranch_scc1 .ap_46
    s_waitcnt vmcnt(5)
    s_cmpk_ge_u32 s8, 2136
    s_cbranch_scc1 .ap_46
    s_waitcnt vmcnt(3)
    s_bitcmp1_b64 s[14:15], 60
    s_cbranch_scc0 1
    s_waitcnt vmcnt(2)
    s_cmpk_ge_u32 s8, 2016
    s_cbranch_scc1 .ap_46
    s_waitcnt vmcnt(1)
.ap_46:
    s_add_u32 s63, s69, 425984
    buffer_load_dwordx4 v[68:71], v1, s[44:47], s63 offen nt
    v_perm_b32 v112, v196, v192, s94
    v_perm_b32 v113, v204, v200, s94
    v_perm_b32 v114, v212, v208, s94
    v_perm_b32 v115, v220, v216, s94
    s_nop 1
    v_mfma_f32_16x16x32_bf16 v[128:131], v[100:103], v[112:115], v[128:131]
    v_perm_b32 v116, v196, v192, s95
    v_perm_b32 v117, v204, v200, s95
    v_perm_b32 v118, v212, v208, s95
    v_perm_b32 v119, v220, v216, s95
    s_nop 1
    v_mfma_f32_16x16x32_bf16 v[132:135], v[100:103], v[116:119], v[132:135]
    v_perm_b32 v120, v197, v193, s94
    v_perm_b32 v121, v205, v201, s94
    v_perm_b32 v122, v213, v209, s94
    v_perm_b32 v123, v221, v217, s94
    s_nop 1
    v_mfma_f32_16x16x32_bf16 v[136:139], v[100:103], v[120:123], v[136:139]
    v_perm_b32 v124, v197, v193, s95
    v_perm_b32 v125, v205, v201, s95
    v_perm_b32 v126, v213, v209, s95
    v_perm_b32 v127, v221, v217, s95
    s_nop 1
    v_mfma_f32_16x16x32_bf16 v[140:143], v[100:103], v[124:127], v[140:143]
    v_perm_b32 v112, v198, v194, s94
    v_perm_b32 v113, v206, v202, s94
    v_perm_b32 v114, v214, v210, s94
    v_perm_b32 v115, v222, v218, s94
    s_nop 1
    v_mfma_f32_16x16x32_bf16 v[144:147], v[100:103], v[112:115], v[144:147]
    v_perm_b32 v116, v198, v194, s95
    v_perm_b32 v117, v206, v202, s95
    v_perm_b32 v118, v214, v210, s95
    v_perm_b32 v119, v222, v218, s95
    s_branch .Lsk_n1_5
.Lst_n1_5:
    s_branch .Lrt_n1_5
.Lsk_n1_5:
    s_nop 1
    v_mfma_f32_16x16x32_bf16 v[148:151], v[100:103], v[116:119], v[148:151]
    v_perm_b32 v120, v199, v195, s94
    v_perm_b32 v121, v207, v203, s94
    v_perm_b32 v122, v215, v211, s94
    v_perm_b32 v123, v223, v219, s94
    s_nop 1
    v_mfma_f32_16x16x32_bf16 v[152:155], v[100:103], v[120:123], v[152:155]
    v_perm_b32 v124, v199, v195, s95
    v_perm_b32 v125, v207, v203, s95
    v_perm_b32 v126, v215, v211, s95
    v_perm_b32 v127, v223, v219, s95
    s_nop 1
    v_mfma_f32_16x16x32_bf16 v[156:159], v[100:103], v[124:127], v[156:159]
    s_memrealtime s[8:9]
    s_waitcnt lgkmcnt(0)
    s_sub_u32 s8, s8, s30
    s_cmpk_ge_u32 s8, 2268
    s_nop 3
    s_cbranch_scc1 .ap_47
    s_waitcnt vmcnt(5)
    s_cmpk_ge_u32 s8, 2168
    s_cbranch_scc1 .ap_47
    s_waitcnt vmcnt(3)
    s_bitcmp1_b64 s[14:15], 61
    s_cbranch_scc0 1
    s_waitcnt vmcnt(2)
    s_cmpk_ge_u32 s8, 2048
    s_cbranch_scc1 .ap_47
    s_waitcnt vmcnt(1)
.ap_47:
    s_add_u32 s63, s69, 434176
    buffer_load_dwordx4 v[76:79], v1, s[44:47], s63 offen nt
    s_waitcnt vmcnt(6)
    v_perm_b32 v112, v228, v224, s94
    v_perm_b32 v113, v236, v232, s94
    v_perm_b32 v114, v244, v240, s94
    v_perm_b32 v115, v252, v248, s94
    s_nop 1
    v_mfma_f32_16x16x32_bf16 v[128:131], v[104:107], v[112:115], v[128:131]
    v_perm_b32 v116, v228, v224, s95
    v_perm_b32 v117, v236, v232, s95
    v_perm_b32 v118, v244, v240, s95
    v_perm_b32 v119, v252, v248, s95
    s_nop 1
    v_mfma_f32_16x16x32_bf16 v[132:135], v[104:107], v[116:119], v[132:135]
    v_perm_b32 v120, v229, v225, s94
    v_perm_b32 v121, v237, v233, s94
    v_perm_b32 v122, v245, v241, s94
    v_perm_b32 v123, v253, v249, s94
    s_nop 1
    v_mfma_f32_16x16x32_bf16 v[136:139], v[104:107], v[120:123], v[136:139]
    v_perm_b32 v124, v229, v225, s95
    v_perm_b32 v125, v237, v233, s95
    v_perm_b32 v126, v245, v241, s95
    v_perm_b32 v127, v253, v249, s95
    s_nop 1
    v_mfma_f32_16x16x32_bf16 v[140:143], v[104:107], v[124:127], v[140:143]
    v_perm_b32 v112, v230, v226, s94
    v_perm_b32 v113, v238, v234, s94
    v_perm_b32 v114, v246, v242, s94
    v_perm_b32 v115, v254, v250, s94
    s_nop 1
    v_mfma_f32_16x16x32_bf16 v[144:147], v[104:107], v[112:115], v[144:147]
    v_perm_b32 v116, v230, v226, s95
    v_perm_b32 v117, v238, v234, s95
    v_perm_b32 v118, v246, v242, s95
    v_perm_b32 v119, v254, v250, s95
    s_nop 1
    v_mfma_f32_16x16x32_bf16 v[148:151], v[104:107], v[116:119], v[148:151]
    v_perm_b32 v120, v231, v227, s94
    v_perm_b32 v121, v239, v235, s94
    v_perm_b32 v122, v247, v243, s94
    v_perm_b32 v123, v255, v251, s94
    s_nop 1
    v_mfma_f32_16x16x32_bf16 v[152:155], v[104:107], v[120:123], v[152:155]
    v_perm_b32 v124, v231, v227, s95
    v_perm_b32 v125, v239, v235, s95
    v_perm_b32 v126, v247, v243, s95
    v_perm_b32 v127, v255, v251, s95
    s_nop 1
    v_mfma_f32_16x16x32_bf16 v[156:159], v[104:107], v[124:127], v[156:159]
    s_memrealtime s[8:9]
    s_waitcnt lgkmcnt(0)
    s_sub_u32 s8, s8, s30
    s_cmpk_ge_u32 s8, 2300
    s_nop 3
    s_cbranch_scc1 .ap_48
    s_waitcnt vmcnt(5)
    s_cmpk_ge_u32 s8, 2200
    s_cbranch_scc1 .ap_48
    s_waitcnt vmcnt(3)
    s_bitcmp1_b64 s[14:15], 62
    s_cbranch_scc0 1
    s_waitcnt vmcnt(2)
    s_cmpk_ge_u32 s8, 2080
    s_cbranch_scc1 .ap_48
    s_waitcnt vmcnt(1)
.ap_48:
    s_add_u32 s63, s69, 442368
    buffer_load_dwordx4 v[84:87], v1, s[44:47], s63 offen nt
    s_memrealtime s[8:9]
    s_waitcnt lgkmcnt(0)
    s_sub_u32 s8, s8, s30
    s_cmpk_ge_u32 s8, 2332
    s_cbranch_scc1 .ap_49
    s_waitcnt vmcnt(5)
    s_cmpk_ge_u32 s8, 2232
    s_cbranch_scc1 .ap_49
    s_waitcnt vmcnt(3)
    s_bitcmp1_b64 s[14:15], 63
    s_cbranch_scc0 1
    s_waitcnt vmcnt(2)
    s_cmpk_ge_u32 s8, 2112
    s_cbranch_scc1 .ap_49
    s_waitcnt vmcnt(1)
.ap_49:
    s_add_u32 s63, s69, 450560
    buffer_load_dwordx4 v[92:95], v1, s[44:47], s63 offen nt
    s_setprio 0
    s_waitcnt vmcnt(6)
    v_perm_b32 v160, v44, v36, s94
    v_perm_b32 v164, v44, v36, s95
    v_perm_b32 v168, v45, v37, s94
    v_perm_b32 v172, v45, v37, s95
    v_perm_b32 v176, v46, v38, s94
    v_perm_b32 v180, v46, v38, s95
    v_perm_b32 v184, v47, v39, s94
    v_perm_b32 v188, v47, v39, s95
    s_waitcnt vmcnt(4)
    v_perm_b32 v161, v60, v52, s94
    v_perm_b32 v165, v60, v52, s95
    v_perm_b32 v169, v61, v53, s94
    v_perm_b32 v173, v61, v53, s95
    v_perm_b32 v177, v62, v54, s94
    v_perm_b32 v181, v62, v54, s95
    v_perm_b32 v185, v63, v55, s94
    v_perm_b32 v189, v63, v55, s95
    s_branch .Lsk_n1_6
.Lst_n1_6:
    s_branch .Lrt_n1_6
.Lsk_n1_6:
    s_waitcnt vmcnt(2)
    v_perm_b32 v162, v76, v68, s94
    v_perm_b32 v166, v76, v68, s95
    v_perm_b32 v170, v77, v69, s94
    v_perm_b32 v174, v77, v69, s95
    v_perm_b32 v178, v78, v70, s94
    v_perm_b32 v182, v78, v70, s95
    v_perm_b32 v186, v79, v71, s94
    v_perm_b32 v190, v79, v71, s95
    s_waitcnt vmcnt(0)
    s_cmp_lt_u32 s65, 8
    s_cbranch_scc1 .wol_50
    s_lshl_b32 s56, s3, 10
    s_add_u32 m0, s56, 24576
    s_add_u32 s56, s101, 221184
    s_mov_b64 exec, s[18:19]
    buffer_load_dwordx4 v6, s[48:51], s56 offen nt lds
    s_mov_b64 exec, -1
    s_lshl_b32 s56, s3, 10
    s_add_u32 m0, s56, 57344
    s_add_u32 s56, s101, 221312
    s_mov_b64 exec, s[18:19]
    buffer_load_dwordx4 v6, s[48:51], s56 offen nt lds
    s_mov_b64 exec, -1
    s_lshl_b32 s56, s3, 10
    s_add_u32 m0, s56, 90112
    s_add_u32 s56, s101, 221440
    s_mov_b64 exec, s[18:19]
    buffer_load_dwordx4 v6, s[48:51], s56 offen nt lds
    s_mov_b64 exec, -1
.wol_50:
    v_perm_b32 v163, v92, v84, s94
    v_perm_b32 v167, v92, v84, s95
    v_perm_b32 v171, v93, v85, s94
    v_mfma_f32_16x16x32_bf16 v[128:131], v[108:111], v[160:163], v[128:131]
    v_perm_b32 v175, v93, v85, s95
    v_mfma_f32_16x16x32_bf16 v[132:135], v[108:111], v[164:167], v[132:135]
    v_perm_b32 v179, v94, v86, s94
    v_mfma_f32_16x16x32_bf16 v[136:139], v[108:111], v[168:171], v[136:139]
    v_perm_b32 v183, v94, v86, s95
    v_mfma_f32_16x16x32_bf16 v[140:143], v[108:111], v[172:175], v[140:143]
    v_perm_b32 v187, v95, v87, s94
    v_mfma_f32_16x16x32_bf16 v[144:147], v[108:111], v[176:179], v[144:147]
    v_perm_b32 v191, v95, v87, s95
    v_mfma_f32_16x16x32_bf16 v[148:151], v[108:111], v[180:183], v[148:151]
    v_mfma_f32_16x16x32_bf16 v[152:155], v[108:111], v[184:187], v[152:155]
    v_mfma_f32_16x16x32_bf16 v[156:159], v[108:111], v[188:191], v[156:159]
    s_mov_b64 exec, 0xffff
    ds_write2_b32 v10, v128, v129 offset0:0 offset1:128
    ds_write2_b32 v10, v132, v133 offset0:1 offset1:129
    ds_write2_b32 v10, v136, v137 offset0:2 offset1:130
    ds_write2_b32 v10, v140, v141 offset0:3 offset1:131
    ds_write2_b32 v10, v144, v145 offset0:4 offset1:132
    ds_write2_b32 v10, v148, v149 offset0:5 offset1:133
    ds_write2_b32 v10, v152, v153 offset0:6 offset1:134
    ds_write2_b32 v10, v156, v157 offset0:7 offset1:135
    s_mov_b64 exec, -1
    s_waitcnt lgkmcnt(0)
    s_barrier
    s_cmp_lg_u32 s3, 7
    s_cbranch_scc1 .opub_51
    v_add_u32 v10, 147456, v2
    ds_read_b128 v[196:199], v10 offset:0
    ds_read_b128 v[200:203], v10 offset:1024
    ds_read_b128 v[204:207], v10 offset:2048
    ds_read_b128 v[208:211], v10 offset:3072
    ds_read_b128 v[212:215], v10 offset:4096
    ds_read_b128 v[216:219], v10 offset:5120
    ds_read_b128 v[220:223], v10 offset:6144
    ds_read_b128 v[224:227], v10 offset:7168
    v_lshrrev_b32 v11, 5, v0
    v_lshlrev_b32 v11, 13, v11
    v_and_b32 v12, 31, v0
    v_lshl_add_u32 v11, v12, 4, v11
    s_lshl4_add_u32 s56, s67, s66
    s_lshl1_add_u32 s56, s56, s68
    s_lshl_b32 s56, s56, 9
    s_add_u32 s56, s56, 0xa0000
    s_mov_b32 s60, 0x07060503
    s_mov_b32 s61, 0x07060502
    s_mov_b32 s62, 0x07060501
    v_mov_b32 v15, s34
    s_waitcnt lgkmcnt(6)
    v_pk_add_f32 v[196:197], v[196:197], v[200:201]
    v_pk_add_f32 v[198:199], v[198:199], v[202:203]
    s_waitcnt lgkmcnt(5)
    v_pk_add_f32 v[196:197], v[196:197], v[204:205]
    v_pk_add_f32 v[198:199], v[198:199], v[206:207]
    s_waitcnt lgkmcnt(4)
    v_pk_add_f32 v[196:197], v[196:197], v[208:209]
    v_pk_add_f32 v[198:199], v[198:199], v[210:211]
    s_waitcnt lgkmcnt(3)
    v_pk_add_f32 v[196:197], v[196:197], v[212:213]
    v_pk_add_f32 v[198:199], v[198:199], v[214:215]
    s_waitcnt lgkmcnt(2)
    v_pk_add_f32 v[196:197], v[196:197], v[216:217]
    v_pk_add_f32 v[198:199], v[198:199], v[218:219]
    s_waitcnt lgkmcnt(1)
    v_pk_add_f32 v[196:197], v[196:197], v[220:221]
    v_pk_add_f32 v[198:199], v[198:199], v[222:223]
    s_waitcnt lgkmcnt(0)
    v_pk_add_f32 v[196:197], v[196:197], v[224:225]
    v_pk_add_f32 v[198:199], v[198:199], v[226:227]
    v_perm_b32 v12, v196, v199, s60
    v_perm_b32 v13, v197, v199, s61
    v_perm_b32 v14, v198, v199, s62
    s_add_u32 s57, s56, 0x800000
    buffer_store_dwordx4 v[12:15], v11, s[36:39], s57 offen
    s_cmp_lg_u32 s0, 0
    s_nop 0
    s_cbranch_scc1 .nosl_52
    buffer_store_dwordx4 v[12:15], v11, s[36:39], s56 offen sc1
.nosl_52:
.opub_51:
    s_cmp_lt_u32 s65, 8
    s_nop 0
    s_cbranch_scc1 .Lexit
    v_mov_b32 v6, 0
    v_bfe_u32 v7, v0, 4, 1
    v_lshl_add_u32 v6, v7, 7, v6
    v_bfe_u32 v7, v0, 2, 2
    v_lshl_add_u32 v6, v7, 5, v6
    v_bfe_u32 v7, v0, 5, 1
    v_lshl_add_u32 v6, v7, 4, v6
    v_bfe_u32 v7, v0, 0, 2
    v_lshl_add_u32 v6, v7, 2, v6
    s_mul_i32 s56, s3, 528
    s_add_u32 s56, s56, 131072
    v_add_u32 v6, s56, v6
    s_lshl4_add_u32 s101, s99, s3
    s_lshl_b32 s101, s101, 10
    s_add_u32 s101, s101, 0xa0000
    v_add_u32 v5, 8192, v2
    s_cmp_ge_u32 s3, 6
    s_nop 0
    s_cbranch_scc1 .La_w67
    v_lshrrev_b32 v16, 4, v0
    v_bfe_u32 v17, v0, 2, 2
    v_lshl_add_u32 v7, v16, 3, v17
    v_lshlrev_b32 v7, 7, v7
    v_and_b32 v16, 1, v16
    v_lshrrev_b32 v17, 1, v17
    v_lshl_add_u32 v16, v16, 1, v17
    s_and_b32 s56, s3, 1
    s_lshl_b32 s56, s56, 1
    v_xor_b32 v16, s56, v16
    v_and_b32 v17, 3, v0
    v_lshl_add_u32 v7, v17, 3, v7
    s_lshr_b32 s56, s3, 1
    s_lshl_b32 s56, s56, 15
    v_add_u32 v7, s56, v7
    v_xor_b32 v17, 1, v16
    v_lshl_add_u32 v8, v17, 5, v7
    v_lshl_add_u32 v7, v16, 5, v7
    ds_read_b64_tr_b16 v[32:33], v7 offset:0
    ds_read_b64_tr_b16 v[34:35], v7 offset:512
    ds_read_b64_tr_b16 v[64:65], v8 offset:0
    ds_read_b64_tr_b16 v[66:67], v8 offset:512
    ds_read_b64_tr_b16 v[36:37], v7 offset:4096
    ds_read_b64_tr_b16 v[38:39], v7 offset:4608
    ds_read_b64_tr_b16 v[68:69], v8 offset:4096
    ds_read_b64_tr_b16 v[70:71], v8 offset:4608
    ds_read_b64_tr_b16 v[40:41], v7 offset:8192
    ds_read_b64_tr_b16 v[42:43], v7 offset:8704
    s_branch .Lsk_n1_7
.Lst_n1_7:
    s_branch .Lrt_n1_7
.Lsk_n1_7:
    ds_read_b64_tr_b16 v[72:73], v8 offset:8192
    ds_read_b64_tr_b16 v[74:75], v8 offset:8704
    ds_read_b64_tr_b16 v[44:45], v7 offset:12288
    ds_read_b64_tr_b16 v[46:47], v7 offset:12800
    ds_read_b64_tr_b16 v[76:77], v8 offset:12288
    ds_read_b64_tr_b16 v[78:79], v8 offset:12800
    ds_read_b64_tr_b16 v[48:49], v7 offset:16384
    ds_read_b64_tr_b16 v[50:51], v7 offset:16896
    ds_read_b64_tr_b16 v[80:81], v8 offset:16384
    ds_read_b64_tr_b16 v[82:83], v8 offset:16896
    ds_read_b64_tr_b16 v[52:53], v7 offset:20480
    ds_read_b64_tr_b16 v[54:55], v7 offset:20992
    ds_read_b64_tr_b16 v[84:85], v8 offset:20480
    ds_read_b64_tr_b16 v[86:87], v8 offset:20992
    s_mov_b32 s56, 131072
    v_bfe_u32 v9, v0, 1, 3
    v_mul_u32_u24 v9, 528, v9
    v_and_b32 v16, 48, v0
    v_lshl_add_u32 v9, v16, 1, v9
    v_and_b32 v16, 1, v0
    v_lshlrev_b32 v16, 4, v16
    v_add3_u32 v9, v9, v16, s56
    v_lshrrev_b32 v10, 4, v0
    v_and_b32 v16, 1, v0
    v_lshl_add_u32 v10, v10, 1, v16
    v_mul_u32_u24 v10, 36864, v10
    v_bfe_u32 v16, v0, 1, 3
    v_lshl_add_u32 v10, v16, 4, v10
    s_mul_i32 s59, s100, 3
    s_lshr_b32 s56, s3, 1
    s_add_u32 s59, s59, s56
    s_lshl4_add_u32 s59, s59, s99
    s_and_b32 s56, s3, 1
    s_lshl1_add_u32 s59, s59, s56
    s_lshl_b32 s59, s59, 7
    s_add_u32 s59, s59, 0xe0000
    v_mov_b32 v139, s34
    v_mov_b32 v140, 0x4444
    v_mov_b32 v141, 0xeeee
    v_cndmask_b32 v140, v140, v141, s[96:97]
    v_mov_b32 v128, 0
    v_mov_b32 v129, 0
    v_mov_b32 v130, 0
    v_mov_b32 v131, 0
    v_mov_b32 v132, 0
    v_mov_b32 v133, 0
    v_mov_b32 v134, 0
    v_mov_b32 v135, 0
    s_waitcnt vmcnt(0)
    s_barrier
    ds_read_b64_tr_b16 v[56:57], v7 offset:24576
    ds_read_b64_tr_b16 v[58:59], v7 offset:25088
    ds_read_b64_tr_b16 v[88:89], v8 offset:24576
    ds_read_b64_tr_b16 v[90:91], v8 offset:25088
    ds_read_b64_tr_b16 v[60:61], v7 offset:28672
    ds_read_b64_tr_b16 v[62:63], v7 offset:29184
    ds_read_b64_tr_b16 v[92:93], v8 offset:28672
    ds_read_b64_tr_b16 v[94:95], v8 offset:29184
    s_branch .La_poll
.La_w67:
    s_cmp_eq_u32 s3, 7
    s_cbranch_scc0 2
    s_waitcnt vmcnt(1)
    s_branch 1
    s_waitcnt vmcnt(0)
    s_barrier
.La_poll:
    s_mov_b32 s60, 0x04000c0c
    s_mov_b32 s61, 0x0706000c
    s_mov_b32 s69, 0
.gp_53:
    s_add_u32 s69, s69, 1
    s_and_b32 s56, s69, 0x41
    s_cmp_lg_u32 s56, 0x41
    s_cselect_b32 s56, 0, 0x800000
    s_xor_b32 s56, s56, s0
    s_add_u32 s58, s101, s56
    buffer_load_dwordx4 v[16:19], v2, s[36:39], s58 offen offset:0 sc1
    buffer_load_dwordx4 v[20:23], v5, s[36:39], s58 offen offset:0 sc1
    s_waitcnt vmcnt(0)
    v_cmp_eq_u32 vcc, s34, v19
    v_cmp_eq_u32 s[56:57], s34, v23
    s_and_b64 vcc, vcc, s[56:57]
    s_cmp_eq_u64 vcc, -1
    s_nop 2
    s_cbranch_scc1 .gpd_54
    s_sub_u32 s35, s35, 1
    s_cbranch_scc1 .Lexit
    s_branch .gp_53
.gpd_54:
    v_perm_b32 v19, v16, v17, s60
    v_perm_b32 v19, v19, v18, s61
    v_perm_b32 v23, v20, v21, s60
    v_perm_b32 v23, v23, v22, s61
    v_permlane32_swap_b32 v16, v18
    v_permlane32_swap_b32 v17, v19
    v_permlane32_swap_b32 v20, v22
    v_permlane32_swap_b32 v21, v23
    v_pk_add_f32 v[16:17], v[16:17], v[18:19]
    v_pk_add_f32 v[20:21], v[20:21], v[22:23]
    v_cvt_pk_bf16_f32 v16, v16, v17
    v_cvt_pk_bf16_f32 v20, v20, v21
    ds_write2_b32 v6, v16, v20 offset1:64
    s_mov_b32 s60, 0x07060503
    s_mov_b32 s61, 0x07060502
    s_mov_b32 s62, 0x07060501
    s_mov_b32 vcc_lo, 0x55555555
    s_mov_b32 vcc_hi, 0x55555555
    s_waitcnt lgkmcnt(0)
    s_barrier
    s_cmp_ge_u32 s3, 6
    s_cbranch_scc1 .Lexit
    ds_read_b128 v[96:99], v9 offset:0
    ds_read_b128 v[100:103], v9 offset:128
    ds_read_b128 v[104:107], v9 offset:256
    ds_read_b128 v[108:111], v9 offset:384
    s_waitcnt lgkmcnt(3)
    v_smfmac_f32_16x16x64_bf16 v[128:131], v[96:99], v[32:39], v140
    v_smfmac_f32_16x16x64_bf16 v[132:135], v[96:99], v[64:71], v140
    s_waitcnt lgkmcnt(2)
    v_smfmac_f32_16x16x64_bf16 v[128:131], v[100:103], v[40:47], v140
    v_smfmac_f32_16x16x64_bf16 v[132:135], v[100:103], v[72:79], v140
    s_waitcnt lgkmcnt(1)
    v_smfmac_f32_16x16x64_bf16 v[128:131], v[104:107], v[48:55], v140
    v_smfmac_f32_16x16x64_bf16 v[132:135], v[104:107], v[80:87], v140
    s_waitcnt lgkmcnt(0)
    v_smfmac_f32_16x16x64_bf16 v[128:131], v[108:111], v[56:63], v140
    v_smfmac_f32_16x16x64_bf16 v[132:135], v[108:111], v[88:95], v140
    s_nop 6
    v_add_f32 v128, v128, v129
    v_add_f32 v130, v130, v131
    v_add_f32 v132, v132, v133
    v_add_f32 v134, v134, v135
    s_not_b64 vcc, vcc
    v_cndmask_b32_dpp v129, v128, v130, vcc quad_perm:[1,0,3,2] row_mask:0xf bank_mask:0xf
    v_cndmask_b32_dpp v131, v132, v134, vcc quad_perm:[1,0,3,2] row_mask:0xf bank_mask:0xf
    s_not_b64 vcc, vcc
    v_cndmask_b32_dpp v128, v130, v128, vcc quad_perm:[1,0,3,2] row_mask:0xf bank_mask:0xf
    v_cndmask_b32_dpp v130, v134, v132, vcc quad_perm:[1,0,3,2] row_mask:0xf bank_mask:0xf
    v_perm_b32 v136, v128, v131, s60
    v_perm_b32 v137, v129, v131, s61
    v_perm_b32 v138, v130, v131, s62
    buffer_store_dwordx4 v[136:139], v10, s[36:39], s59 offen sc1
    s_nop 1
    s_branch .Lexit
.Lm:
    s_branch .Lsk_m0_0
.Lst_m0_0:
    s_branch .Lrt_m0_0
.Lsk_m0_0:
    s_cmp_lt_u32 s2, 54
    s_mov_b32 s14, 0xfdff7fdf
    s_cselect_b32 s14, 0x6b5ad6b5, s14
    s_mov_b32 s15, 0xff7fdff7
    s_cselect_b32 s15, 0x5ad6b5ad, s15
    s_add_u32 s30, s70, 0
    s_mov_b32 s31, s70
    v_bfe_u32 v16, v0, 1, 3
    v_mul_u32_u24 v16, 1312, v16
    v_lshrrev_b32 v12, 4, v0
    v_lshl_add_u32 v16, v12, 5, v16
    v_and_b32 v12, 1, v0
    v_lshl_add_u32 v16, v12, 4, v16
    v_add_u32 v16, 147456, v16
    s_mul_i32 s56, s3, 1312
    s_add_u32 s56, s56, 147456
    v_add_u32 v17, s56, v3
    v_add_u32 v18, s56, v4
    v_lshrrev_b32 v12, 4, v0
    v_bfe_u32 v13, v0, 1, 1
    v_lshl_add_u32 v12, v12, 1, v13
    v_bfe_u32 v13, v0, 2, 2
    v_lshl_add_u32 v20, v12, 3, v13
    v_lshlrev_b32 v20, 7, v20
    v_and_b32 v12, 3, v12
    v_lshrrev_b32 v13, 1, v13
    v_lshl_add_u32 v12, v12, 1, v13
    v_xor_b32 v12, s3, v12
    v_lshl_add_u32 v20, v12, 4, v20
    v_and_b32 v12, 1, v0
    v_lshl_add_u32 v20, v12, 3, v20
    v_bfe_u32 v23, v0, 1, 3
    v_mul_u32_u24 v23, 144, v23
    v_bfe_u32 v12, v0, 4, 1
    v_lshl_add_u32 v23, v12, 3, v23
    v_lshrrev_b32 v12, 5, v0
    v_lshl_add_u32 v23, v12, 2, v23
    v_and_b32 v12, 1, v0
    v_lshl_add_u32 v23, v12, 1, v23
    s_lshl_b32 s56, s3, 4
    s_add_u32 s56, s56, 157952
    v_add_u32 v23, s56, v23
    v_and_b32 v24, 15, v0
    v_lshlrev_b32 v24, 3, v24
    s_mul_i32 s56, s3, 144
    s_add_u32 s56, s56, 157952
    v_add_u32 v24, s56, v24
    v_add_u32 v21, 32768, v20
    s_lshl_b32 s100, s3, 10
    s_mov_b32 s99, s2
    s_cmp_ge_u32 s99, 18
    s_cbranch_scc1 .Lm_rel
    s_mul_i32 s58, s3, 1152
    s_mov_b32 s52, s24
    s_and_b32 s53, s25, 0xffff
    s_mov_b32 s54, 0x2400
    s_mov_b32 s55, 0x00020000
    buffer_load_dwordx2 v[246:247], v3, s[52:55], s58 offen
    buffer_load_dwordx2 v[248:249], v3, s[52:55], s58 offen offset:512
    buffer_load_dword v250, v4, s[52:55], s58 offen
    s_mov_b32 s48, s26
    s_and_b32 s49, s27, 0xffff
    s_mov_b32 s50, 0x3cc000
    s_mov_b32 s51, 0x00020000
    v_bfe_u32 v12, v0, 4, 1
    s_and_b32 s56, s3, 3
    s_lshl_b32 s56, s56, 1
    v_or_b32 v12, s56, v12
    v_and_b32 v19, 7, v0
    v_xor_b32 v12, v12, v19
    v_lshrrev_b32 v19, 3, v0
    v_mul_u32_u24 v19, 6912, v19
    v_lshl_add_u32 v19, v12, 4, v19
    s_mul_i32 s57, s3, 55296
    s_lshl_b32 s59, s99, 7
    s_add_u32 s57, s57, s59
    s_add_u32 m0, s100, 0
    s_add_u32 s56, s57, 0
    buffer_load_dwordx4 v19, s[48:51], s56 offen nt lds
    s_add_u32 m0, s100, 8192
    s_add_u32 s56, s57, 442368
    buffer_load_dwordx4 v19, s[48:51], s56 offen nt lds
    s_add_u32 m0, s100, 16384
    s_add_u32 s56, s57, 884736
    buffer_load_dwordx4 v19, s[48:51], s56 offen nt lds
    s_add_u32 m0, s100, 24576
    s_add_u32 s56, s57, 1327104
    buffer_load_dwordx4 v19, s[48:51], s56 offen nt lds
    s_add_u32 m0, s100, 32768
    s_add_u32 s56, s57, 1769472
    buffer_load_dwordx4 v19, s[48:51], s56 offen nt lds
    s_add_u32 m0, s100, 40960
    s_add_u32 s56, s57, 2211840
    buffer_load_dwordx4 v19, s[48:51], s56 offen nt lds
    s_add_u32 m0, s100, 49152
    s_add_u32 s56, s57, 2654208
    buffer_load_dwordx4 v19, s[48:51], s56 offen nt lds
    s_add_u32 m0, s100, 57344
    s_add_u32 s56, s57, 3096576
    buffer_load_dwordx4 v19, s[48:51], s56 offen nt lds
    s_add_u32 m0, s100, 65536
    s_add_u32 s56, s57, 3538944
    buffer_load_dwordx4 v19, s[48:51], s56 offen nt lds
    s_waitcnt lgkmcnt(0)
    s_add_u32 s34, s34, 1
    s_getreg_b32 s1, hwreg(HW_REG_XCC_ID)
    s_lshl_b32 s1, s1, 24
    s_add_u32 s1, s1, s34
    s_lshr_b32 s0, s2, 3
    s_lshl_b32 s63, s64, 8
    s_add_u32 s0, s0, s63
    s_lshl2_add_u32 s0, s0, 0x480000
    v_mov_b32 v30, s1
    s_cmp_eq_u32 s3, 0
    s_cselect_b64 exec, 1, 0
    buffer_store_dword v30, v2, s[36:39], s0 offen sc1
    s_mov_b64 exec, -1
    v_lshrrev_b32 v12, 4, v0
    v_mul_u32_u24 v12, 18432, v12
    v_and_b32 v13, 15, v0
    v_lshl_add_u32 v22, v13, 4, v12
    s_mul_i32 s57, s99, 57
    s_lshr_b32 s57, s57, 9
    s_mul_i32 s58, s57, 9
    s_sub_u32 s58, s99, s58
    s_mul_i32 s59, s57, 73728
    s_lshl_b32 s58, s58, 8
    s_add_u32 s59, s59, s58
    s_mul_i32 s58, s3, 2304
    s_add_u32 s59, s59, s58
    s_add_u32 s59, s59, 0x1000
    s_mov_b32 s58, 0
    s_cmp_eq_u32 s57, 1
    s_cselect_b32 s58, 1.0, s58
    s_cmp_eq_u32 s57, 4
    s_cselect_b32 s58, 1.0, s58
    s_waitcnt vmcnt(10)
    v_lshlrev_b32 v236, 16, v246
    v_and_b32 v237, 0xffff0000, v246
    v_max_f32 v236, 0xc2ae0000, v236
    v_min_f32 v242, 0x43000000, v236
    v_mul_f32 v238, 0xbfb8aa3b, v242
    v_fma_f32 v240, v242, s98, -v238
    v_fmac_f32 v240, 0xb2a57060, v242
    v_exp_f32 v238, v238
    v_mul_f32 v240, 0x3f317218, v240
    v_fmac_f32 v238, v238, v240
    v_add_f32 v238, 1.0, v238
    v_rcp_f32 v240, v238
    s_nop 0
    v_mul_f32 v242, v236, v240
    v_fma_f32 v238, -v242, v238, v236
    v_fma_f32 v236, v238, v240, v242
    v_max_f32 v237, 0xc2ae0000, v237
    v_min_f32 v243, 0x43000000, v237
    v_mul_f32 v239, 0xbfb8aa3b, v243
    v_fma_f32 v241, v243, s98, -v239
    v_fmac_f32 v241, 0xb2a57060, v243
    v_exp_f32 v239, v239
    v_mul_f32 v241, 0x3f317218, v241
    v_fmac_f32 v239, v239, v241
    v_add_f32 v239, 1.0, v239
    v_rcp_f32 v241, v239
    s_nop 0
    v_mul_f32 v243, v237, v241
    v_fma_f32 v239, -v243, v239, v237
    v_fma_f32 v237, v239, v241, v243
    s_branch .Lsk_m0_1
.Lst_m0_1:
    s_branch .Lrt_m0_1
.Lsk_m0_1:
    v_cvt_pk_bf16_f32 v246, v236, v237
    v_lshlrev_b32 v236, 16, v247
    v_and_b32 v237, 0xffff0000, v247
    v_max_f32 v236, 0xc2ae0000, v236
    v_min_f32 v242, 0x43000000, v236
    v_mul_f32 v238, 0xbfb8aa3b, v242
    v_fma_f32 v240, v242, s98, -v238
    v_fmac_f32 v240, 0xb2a57060, v242
    v_exp_f32 v238, v238
    v_mul_f32 v240, 0x3f317218, v240
    v_fmac_f32 v238, v238, v240
    v_add_f32 v238, 1.0, v238
    v_rcp_f32 v240, v238
    s_nop 0
    v_mul_f32 v242, v236, v240
    v_fma_f32 v238, -v242, v238, v236
    v_fma_f32 v236, v238, v240, v242
    v_max_f32 v237, 0xc2ae0000, v237
    v_min_f32 v243, 0x43000000, v237
    v_mul_f32 v239, 0xbfb8aa3b, v243
    v_fma_f32 v241, v243, s98, -v239
    v_fmac_f32 v241, 0xb2a57060, v243
    v_exp_f32 v239, v239
    v_mul_f32 v241, 0x3f317218, v241
    v_fmac_f32 v239, v239, v241
    v_add_f32 v239, 1.0, v239
    v_rcp_f32 v241, v239
    s_nop 0
    v_mul_f32 v243, v237, v241
    v_fma_f32 v239, -v243, v239, v237
    v_fma_f32 v237, v239, v241, v243
    v_cvt_pk_bf16_f32 v247, v236, v237
    v_lshlrev_b32 v236, 16, v248
    v_and_b32 v237, 0xffff0000, v248
    v_max_f32 v236, 0xc2ae0000, v236
    v_min_f32 v242, 0x43000000, v236
    v_mul_f32 v238, 0xbfb8aa3b, v242
    v_fma_f32 v240, v242, s98, -v238
    v_fmac_f32 v240, 0xb2a57060, v242
    v_exp_f32 v238, v238
    v_mul_f32 v240, 0x3f317218, v240
    v_fmac_f32 v238, v238, v240
    v_add_f32 v238, 1.0, v238
    v_rcp_f32 v240, v238
    s_nop 0
    v_mul_f32 v242, v236, v240
    v_fma_f32 v238, -v242, v238, v236
    v_fma_f32 v236, v238, v240, v242
    v_max_f32 v237, 0xc2ae0000, v237
    v_min_f32 v243, 0x43000000, v237
    v_mul_f32 v239, 0xbfb8aa3b, v243
    v_fma_f32 v241, v243, s98, -v239
    v_fmac_f32 v241, 0xb2a57060, v243
    v_exp_f32 v239, v239
    v_mul_f32 v241, 0x3f317218, v241
    v_fmac_f32 v239, v239, v241
    v_add_f32 v239, 1.0, v239
    v_rcp_f32 v241, v239
    s_nop 0
    v_mul_f32 v243, v237, v241
    v_fma_f32 v239, -v243, v239, v237
    v_fma_f32 v237, v239, v241, v243
    v_cvt_pk_bf16_f32 v248, v236, v237
    v_lshlrev_b32 v236, 16, v249
    v_and_b32 v237, 0xffff0000, v249
    v_max_f32 v236, 0xc2ae0000, v236
    v_min_f32 v242, 0x43000000, v236
    v_mul_f32 v238, 0xbfb8aa3b, v242
    v_fma_f32 v240, v242, s98, -v238
    v_fmac_f32 v240, 0xb2a57060, v242
    v_exp_f32 v238, v238
    v_mul_f32 v240, 0x3f317218, v240
    v_fmac_f32 v238, v238, v240
    v_add_f32 v238, 1.0, v238
    v_rcp_f32 v240, v238
    s_nop 0
    v_mul_f32 v242, v236, v240
    v_fma_f32 v238, -v242, v238, v236
    v_fma_f32 v236, v238, v240, v242
    v_max_f32 v237, 0xc2ae0000, v237
    v_min_f32 v243, 0x43000000, v237
    v_mul_f32 v239, 0xbfb8aa3b, v243
    v_fma_f32 v241, v243, s98, -v239
    v_fmac_f32 v241, 0xb2a57060, v243
    v_exp_f32 v239, v239
    v_mul_f32 v241, 0x3f317218, v241
    v_fmac_f32 v239, v239, v241
    v_add_f32 v239, 1.0, v239
    v_rcp_f32 v241, v239
    s_nop 0
    v_mul_f32 v243, v237, v241
    v_fma_f32 v239, -v243, v239, v237
    v_fma_f32 v237, v239, v241, v243
    v_cvt_pk_bf16_f32 v249, v236, v237
    v_lshlrev_b32 v236, 16, v250
    v_and_b32 v237, 0xffff0000, v250
    v_max_f32 v236, 0xc2ae0000, v236
    v_min_f32 v242, 0x43000000, v236
    v_mul_f32 v238, 0xbfb8aa3b, v242
    v_fma_f32 v240, v242, s98, -v238
    v_fmac_f32 v240, 0xb2a57060, v242
    v_exp_f32 v238, v238
    v_mul_f32 v240, 0x3f317218, v240
    v_fmac_f32 v238, v238, v240
    v_add_f32 v238, 1.0, v238
    v_rcp_f32 v240, v238
    s_nop 0
    v_mul_f32 v242, v236, v240
    v_fma_f32 v238, -v242, v238, v236
    v_fma_f32 v236, v238, v240, v242
    v_max_f32 v237, 0xc2ae0000, v237
    v_min_f32 v243, 0x43000000, v237
    v_mul_f32 v239, 0xbfb8aa3b, v243
    v_fma_f32 v241, v243, s98, -v239
    v_fmac_f32 v241, 0xb2a57060, v243
    v_exp_f32 v239, v239
    v_mul_f32 v241, 0x3f317218, v241
    v_fmac_f32 v239, v239, v241
    v_add_f32 v239, 1.0, v239
    v_rcp_f32 v241, v239
    s_nop 0
    v_mul_f32 v243, v237, v241
    v_fma_f32 v239, -v243, v239, v237
    v_fma_f32 v237, v239, v241, v243
    v_cvt_pk_bf16_f32 v250, v236, v237
    ds_write_b64 v17, v[246:247] offset:0
    ds_write_b64 v17, v[248:249] offset:512
    ds_write_b32 v18, v250 offset:0
    s_waitcnt vmcnt(1)
    s_waitcnt lgkmcnt(0)
    s_barrier
    ds_read_b64_tr_b16 v[160:161], v20 offset:0
    ds_read_b64_tr_b16 v[162:163], v20 offset:512
    ds_read_b64_tr_b16 v[164:165], v20 offset:8192
    ds_read_b64_tr_b16 v[166:167], v20 offset:8704
    ds_read_b64_tr_b16 v[168:169], v20 offset:16384
    ds_read_b64_tr_b16 v[170:171], v20 offset:16896
    ds_read_b64_tr_b16 v[172:173], v20 offset:24576
    ds_read_b64_tr_b16 v[174:175], v20 offset:25088
    ds_read_b64_tr_b16 v[176:177], v21 offset:0
    ds_read_b64_tr_b16 v[178:179], v21 offset:512
    ds_read_b64_tr_b16 v[180:181], v21 offset:8192
    ds_read_b64_tr_b16 v[182:183], v21 offset:8704
    ds_read_b64_tr_b16 v[184:185], v21 offset:16384
    ds_read_b64_tr_b16 v[186:187], v21 offset:16896
    ds_read_b64_tr_b16 v[188:189], v21 offset:24576
    ds_read_b64_tr_b16 v[190:191], v21 offset:25088
    ds_read_b64_tr_b16 v[192:193], v21 offset:32768
    ds_read_b64_tr_b16 v[194:195], v21 offset:33280
    ds_read_b128 v[196:199], v16 offset:0
    ds_read_b128 v[200:203], v16 offset:128
    ds_read_b128 v[204:207], v16 offset:256
    ds_read_b128 v[208:211], v16 offset:384
    ds_read_b128 v[212:215], v16 offset:512
    ds_read_b128 v[216:219], v16 offset:640
    ds_read_b128 v[220:223], v16 offset:768
    ds_read_b128 v[224:227], v16 offset:896
    ds_read_b128 v[228:231], v16 offset:1024
    s_waitcnt lgkmcnt(8)
    v_mfma_f32_16x16x32_bf16 v[232:235], v[160:163], v[196:199], 0
    s_waitcnt lgkmcnt(7)
    v_mfma_f32_16x16x32_bf16 v[232:235], v[164:167], v[200:203], v[232:235]
    s_waitcnt lgkmcnt(6)
    v_mfma_f32_16x16x32_bf16 v[232:235], v[168:171], v[204:207], v[232:235]
    s_branch .Lsk_m0_2
.Lst_m0_2:
    s_branch .Lrt_m0_2
.Lsk_m0_2:
    s_waitcnt lgkmcnt(5)
    v_mfma_f32_16x16x32_bf16 v[232:235], v[172:175], v[208:211], v[232:235]
    s_waitcnt lgkmcnt(4)
    v_mfma_f32_16x16x32_bf16 v[232:235], v[176:179], v[212:215], v[232:235]
    s_waitcnt lgkmcnt(3)
    v_mfma_f32_16x16x32_bf16 v[232:235], v[180:183], v[216:219], v[232:235]
    s_waitcnt lgkmcnt(2)
    v_mfma_f32_16x16x32_bf16 v[232:235], v[184:187], v[220:223], v[232:235]
    s_waitcnt lgkmcnt(1)
    v_mfma_f32_16x16x32_bf16 v[232:235], v[188:191], v[224:227], v[232:235]
    s_waitcnt lgkmcnt(0)
    v_mfma_f32_16x16x32_bf16 v[232:235], v[192:195], v[228:231], v[232:235]
    s_nop 7
    v_permlane32_swap_b32 v232, v234
    v_permlane32_swap_b32 v233, v235
    v_cndmask_b32 v233, v233, v234, s[96:97]
    v_cndmask_b32 v232, v232, v235, s[96:97]
    s_nop 1
    v_add_f32_dpp v236, v233, v232 quad_perm:[1,0,3,2] row_mask:0xf bank_mask:0xf
    v_cvt_pk_bf16_f32 v236, v236, v236
    v_lshlrev_b32 v236, 16, v236
    v_add_f32 v236, s58, v236
    v_cvt_pk_bf16_f32 v236, v236, v236
    ds_write_b16 v23, v236
    v_mov_b32 v243, s34
    s_waitcnt lgkmcnt(0)
    s_barrier
    ds_read2_b32 v[244:245], v24 offset1:1
    v_mov_b32 v241, s34
    s_waitcnt lgkmcnt(0)
    v_mov_b32 v240, v244
    v_mov_b32 v242, v245
    s_bfm_b64 exec, 32, 0
    buffer_store_dwordx4 v[240:243], v22, s[36:39], s59 offen sc1
    s_mov_b64 exec, -1
    s_add_u32 s63, s69, 32768
    buffer_load_dwordx4 v[96:99], v1, s[40:43], s63 offen nt
    s_add_u32 s63, s69, 40960
    buffer_load_dwordx4 v[100:103], v1, s[40:43], s63 offen nt
    s_add_u32 s63, s69, 49152
    buffer_load_dwordx4 v[128:131], v1, s[40:43], s63 offen nt
    s_add_u32 s63, s69, 57344
    buffer_load_dwordx4 v[132:135], v1, s[40:43], s63 offen nt
    s_waitcnt vmcnt(3)
    s_add_u32 s63, s69, 131072
    buffer_load_dwordx4 v[40:43], v1, s[40:43], s63 offen nt
    s_waitcnt vmcnt(3)
    s_add_u32 s63, s69, 139264
    buffer_load_dwordx4 v[44:47], v1, s[40:43], s63 offen nt
    s_waitcnt vmcnt(3)
    s_add_u32 s63, s69, 147456
    buffer_load_dwordx4 v[72:75], v1, s[40:43], s63 offen nt
    s_waitcnt vmcnt(3)
    s_add_u32 s63, s69, 155648
    buffer_load_dwordx4 v[76:79], v1, s[40:43], s63 offen nt
    s_waitcnt vmcnt(3)
    s_add_u32 s63, s69, 163840
    buffer_load_dwordx4 v[104:107], v1, s[40:43], s63 offen nt
    s_waitcnt vmcnt(3)
    s_add_u32 s63, s69, 172032
    buffer_load_dwordx4 v[108:111], v1, s[40:43], s63 offen nt
    s_waitcnt vmcnt(3)
    s_add_u32 s63, s69, 180224
    buffer_load_dwordx4 v[136:139], v1, s[40:43], s63 offen nt
    s_waitcnt vmcnt(3)
    s_add_u32 s63, s69, 188416
    buffer_load_dwordx4 v[140:143], v1, s[40:43], s63 offen nt
    s_waitcnt vmcnt(3)
    s_add_u32 s63, s69, 262144
    buffer_load_dwordx4 v[48:51], v1, s[40:43], s63 offen nt
    s_waitcnt vmcnt(3)
    s_add_u32 s63, s69, 270336
    buffer_load_dwordx4 v[52:55], v1, s[40:43], s63 offen nt
    s_branch .Le_done
.Lm_rel:
    s_waitcnt vmcnt(4)
    s_bitcmp1_b64 s[14:15], 4
    s_cbranch_scc0 1
    s_waitcnt vmcnt(3)
    s_add_u32 s63, s69, 32768
    buffer_load_dwordx4 v[96:99], v1, s[40:43], s63 offen nt
    s_waitcnt vmcnt(4)
    s_bitcmp1_b64 s[14:15], 5
    s_cbranch_scc0 1
    s_waitcnt vmcnt(3)
    s_add_u32 s63, s69, 40960
    buffer_load_dwordx4 v[100:103], v1, s[40:43], s63 offen nt
    s_waitcnt vmcnt(4)
    s_bitcmp1_b64 s[14:15], 6
    s_cbranch_scc0 1
    s_waitcnt vmcnt(3)
    s_add_u32 s63, s69, 49152
    buffer_load_dwordx4 v[128:131], v1, s[40:43], s63 offen nt
    s_waitcnt vmcnt(4)
    s_bitcmp1_b64 s[14:15], 7
    s_cbranch_scc0 1
    s_waitcnt vmcnt(2)
    s_add_u32 s63, s69, 57344
    buffer_load_dwordx4 v[132:135], v1, s[40:43], s63 offen nt
    s_waitcnt vmcnt(3)
    s_bitcmp1_b64 s[14:15], 8
    s_cbranch_scc0 1
    s_waitcnt vmcnt(2)
    s_add_u32 s63, s69, 131072
    buffer_load_dwordx4 v[40:43], v1, s[40:43], s63 offen nt
    s_waitcnt vmcnt(3)
    s_bitcmp1_b64 s[14:15], 9
    s_cbranch_scc0 1
    s_waitcnt vmcnt(2)
    s_add_u32 s63, s69, 139264
    buffer_load_dwordx4 v[44:47], v1, s[40:43], s63 offen nt
    s_waitcnt lgkmcnt(0)
    s_add_u32 s34, s34, 1
    s_getreg_b32 s1, hwreg(HW_REG_XCC_ID)
    s_lshl_b32 s1, s1, 24
    s_add_u32 s1, s1, s34
    s_lshr_b32 s0, s2, 3
    s_lshl_b32 s63, s64, 8
    s_add_u32 s0, s0, s63
    s_lshl2_add_u32 s0, s0, 0x480000
    v_mov_b32 v30, s1
    s_cmp_eq_u32 s3, 0
    s_cselect_b64 exec, 1, 0
    buffer_store_dword v30, v2, s[36:39], s0 offen sc1
    s_mov_b64 exec, -1
    s_cmp_lt_u32 s99, 54
    s_cbranch_scc1 .Lmr_part
    s_waitcnt vmcnt(4)
    s_bitcmp1_b64 s[14:15], 10
    s_cbranch_scc0 1
    s_waitcnt vmcnt(3)
    s_add_u32 s63, s69, 147456
    buffer_load_dwordx4 v[72:75], v1, s[40:43], s63 offen nt
    s_waitcnt vmcnt(4)
    s_bitcmp1_b64 s[14:15], 11
    s_cbranch_scc0 1
    s_waitcnt vmcnt(3)
    s_add_u32 s63, s69, 155648
    buffer_load_dwordx4 v[76:79], v1, s[40:43], s63 offen nt
    s_waitcnt vmcnt(4)
    s_bitcmp1_b64 s[14:15], 12
    s_cbranch_scc0 1
    s_waitcnt vmcnt(3)
    s_add_u32 s63, s69, 163840
    buffer_load_dwordx4 v[104:107], v1, s[40:43], s63 offen nt
    s_waitcnt vmcnt(4)
    s_bitcmp1_b64 s[14:15], 13
    s_cbranch_scc0 1
    s_waitcnt vmcnt(2)
    s_add_u32 s63, s69, 172032
    buffer_load_dwordx4 v[108:111], v1, s[40:43], s63 offen nt
    s_waitcnt vmcnt(3)
    s_bitcmp1_b64 s[14:15], 14
    s_cbranch_scc0 1
    s_waitcnt vmcnt(2)
    s_add_u32 s63, s69, 180224
    buffer_load_dwordx4 v[136:139], v1, s[40:43], s63 offen nt
    s_waitcnt vmcnt(3)
    s_bitcmp1_b64 s[14:15], 15
    s_cbranch_scc0 1
    s_waitcnt vmcnt(2)
    s_add_u32 s63, s69, 188416
    buffer_load_dwordx4 v[140:143], v1, s[40:43], s63 offen nt
    s_waitcnt vmcnt(3)
    s_bitcmp1_b64 s[14:15], 16
    s_cbranch_scc0 1
    s_waitcnt vmcnt(2)
    s_add_u32 s63, s69, 262144
    buffer_load_dwordx4 v[48:51], v1, s[40:43], s63 offen nt
    s_waitcnt vmcnt(3)
    s_bitcmp1_b64 s[14:15], 17
    s_cbranch_scc0 1
    s_waitcnt vmcnt(2)
    s_add_u32 s63, s69, 270336
    buffer_load_dwordx4 v[52:55], v1, s[40:43], s63 offen nt
    s_branch .Le_done
.Lmr_part:
    s_mul_i32 s58, s3, 1152
    s_mov_b32 s52, s24
    s_and_b32 s53, s25, 0xffff
    s_mov_b32 s54, 0x2400
    s_mov_b32 s55, 0x00020000
    buffer_load_dwordx2 v[246:247], v3, s[52:55], s58 offen
    buffer_load_dwordx2 v[248:249], v3, s[52:55], s58 offen offset:512
    buffer_load_dword v250, v4, s[52:55], s58 offen
    s_mov_b32 s48, s26
    s_and_b32 s49, s27, 0xffff
    s_mov_b32 s50, 0x3cc000
    s_mov_b32 s51, 0x00020000
    s_branch .Lsk_m0_3
.Lst_m0_3:
    s_branch .Lrt_m0_3
.Lsk_m0_3:
    v_bfe_u32 v12, v0, 4, 1
    s_and_b32 s56, s3, 3
    s_lshl_b32 s56, s56, 1
    v_or_b32 v12, s56, v12
    v_and_b32 v19, 7, v0
    v_xor_b32 v12, v12, v19
    v_lshrrev_b32 v19, 3, v0
    v_mul_u32_u24 v19, 6912, v19
    v_lshl_add_u32 v19, v12, 4, v19
    s_mul_i32 s57, s3, 55296
    s_lshl_b32 s59, s99, 7
    s_add_u32 s57, s57, s59
    s_add_u32 m0, s100, 0
    s_add_u32 s56, s57, 0
    buffer_load_dwordx4 v19, s[48:51], s56 offen nt lds
    s_add_u32 m0, s100, 8192
    s_add_u32 s56, s57, 442368
    buffer_load_dwordx4 v19, s[48:51], s56 offen nt lds
    s_add_u32 m0, s100, 16384
    s_add_u32 s56, s57, 884736
    buffer_load_dwordx4 v19, s[48:51], s56 offen nt lds
    s_add_u32 m0, s100, 24576
    s_add_u32 s56, s57, 1327104
    buffer_load_dwordx4 v19, s[48:51], s56 offen nt lds
    s_add_u32 m0, s100, 32768
    s_add_u32 s56, s57, 1769472
    buffer_load_dwordx4 v19, s[48:51], s56 offen nt lds
    s_add_u32 m0, s100, 40960
    s_add_u32 s56, s57, 2211840
    buffer_load_dwordx4 v19, s[48:51], s56 offen nt lds
    s_add_u32 m0, s100, 49152
    s_add_u32 s56, s57, 2654208
    buffer_load_dwordx4 v19, s[48:51], s56 offen nt lds
    s_add_u32 m0, s100, 57344
    s_add_u32 s56, s57, 3096576
    buffer_load_dwordx4 v19, s[48:51], s56 offen nt lds
    s_add_u32 m0, s100, 65536
    s_add_u32 s56, s57, 3538944
    buffer_load_dwordx4 v19, s[48:51], s56 offen nt lds
    v_lshrrev_b32 v12, 4, v0
    v_mul_u32_u24 v12, 18432, v12
    v_and_b32 v13, 15, v0
    v_lshl_add_u32 v22, v13, 4, v12
    s_mul_i32 s57, s99, 57
    s_lshr_b32 s57, s57, 9
    s_mul_i32 s58, s57, 9
    s_sub_u32 s58, s99, s58
    s_mul_i32 s59, s57, 73728
    s_lshl_b32 s58, s58, 8
    s_add_u32 s59, s59, s58
    s_mul_i32 s58, s3, 2304
    s_add_u32 s59, s59, s58
    s_add_u32 s59, s59, 0x1000
    s_mov_b32 s58, 0
    s_cmp_eq_u32 s57, 1
    s_cselect_b32 s58, 1.0, s58
    s_cmp_eq_u32 s57, 4
    s_cselect_b32 s58, 1.0, s58
    s_waitcnt vmcnt(9)
    v_lshlrev_b32 v236, 16, v246
    v_and_b32 v237, 0xffff0000, v246
    v_max_f32 v236, 0xc2ae0000, v236
    v_min_f32 v242, 0x43000000, v236
    v_mul_f32 v238, 0xbfb8aa3b, v242
    v_fma_f32 v240, v242, s98, -v238
    v_fmac_f32 v240, 0xb2a57060, v242
    v_exp_f32 v238, v238
    v_mul_f32 v240, 0x3f317218, v240
    v_fmac_f32 v238, v238, v240
    v_add_f32 v238, 1.0, v238
    v_rcp_f32 v240, v238
    s_nop 0
    v_mul_f32 v242, v236, v240
    v_fma_f32 v238, -v242, v238, v236
    v_fma_f32 v236, v238, v240, v242
    v_max_f32 v237, 0xc2ae0000, v237
    v_min_f32 v243, 0x43000000, v237
    v_mul_f32 v239, 0xbfb8aa3b, v243
    v_fma_f32 v241, v243, s98, -v239
    v_fmac_f32 v241, 0xb2a57060, v243
    v_exp_f32 v239, v239
    v_mul_f32 v241, 0x3f317218, v241
    v_fmac_f32 v239, v239, v241
    v_add_f32 v239, 1.0, v239
    v_rcp_f32 v241, v239
    s_nop 0
    v_mul_f32 v243, v237, v241
    v_fma_f32 v239, -v243, v239, v237
    v_fma_f32 v237, v239, v241, v243
    v_cvt_pk_bf16_f32 v246, v236, v237
    v_lshlrev_b32 v236, 16, v247
    v_and_b32 v237, 0xffff0000, v247
    v_max_f32 v236, 0xc2ae0000, v236
    v_min_f32 v242, 0x43000000, v236
    v_mul_f32 v238, 0xbfb8aa3b, v242
    v_fma_f32 v240, v242, s98, -v238
    v_fmac_f32 v240, 0xb2a57060, v242
    v_exp_f32 v238, v238
    v_mul_f32 v240, 0x3f317218, v240
    v_fmac_f32 v238, v238, v240
    v_add_f32 v238, 1.0, v238
    v_rcp_f32 v240, v238
    s_nop 0
    v_mul_f32 v242, v236, v240
    v_fma_f32 v238, -v242, v238, v236
    v_fma_f32 v236, v238, v240, v242
    v_max_f32 v237, 0xc2ae0000, v237
    v_min_f32 v243, 0x43000000, v237
    v_mul_f32 v239, 0xbfb8aa3b, v243
    v_fma_f32 v241, v243, s98, -v239
    v_fmac_f32 v241, 0xb2a57060, v243
    v_exp_f32 v239, v239
    v_mul_f32 v241, 0x3f317218, v241
    v_fmac_f32 v239, v239, v241
    v_add_f32 v239, 1.0, v239
    v_rcp_f32 v241, v239
    s_nop 0
    v_mul_f32 v243, v237, v241
    v_fma_f32 v239, -v243, v239, v237
    v_fma_f32 v237, v239, v241, v243
    v_cvt_pk_bf16_f32 v247, v236, v237
    v_lshlrev_b32 v236, 16, v248
    v_and_b32 v237, 0xffff0000, v248
    v_max_f32 v236, 0xc2ae0000, v236
    v_min_f32 v242, 0x43000000, v236
    v_mul_f32 v238, 0xbfb8aa3b, v242
    v_fma_f32 v240, v242, s98, -v238
    v_fmac_f32 v240, 0xb2a57060, v242
    v_exp_f32 v238, v238
    v_mul_f32 v240, 0x3f317218, v240
    v_fmac_f32 v238, v238, v240
    v_add_f32 v238, 1.0, v238
    v_rcp_f32 v240, v238
    s_nop 0
    v_mul_f32 v242, v236, v240
    v_fma_f32 v238, -v242, v238, v236
    v_fma_f32 v236, v238, v240, v242
    v_max_f32 v237, 0xc2ae0000, v237
    v_min_f32 v243, 0x43000000, v237
    v_mul_f32 v239, 0xbfb8aa3b, v243
    v_fma_f32 v241, v243, s98, -v239
    v_fmac_f32 v241, 0xb2a57060, v243
    v_exp_f32 v239, v239
    v_mul_f32 v241, 0x3f317218, v241
    v_fmac_f32 v239, v239, v241
    v_add_f32 v239, 1.0, v239
    v_rcp_f32 v241, v239
    s_nop 0
    v_mul_f32 v243, v237, v241
    v_fma_f32 v239, -v243, v239, v237
    v_fma_f32 v237, v239, v241, v243
    v_cvt_pk_bf16_f32 v248, v236, v237
    v_lshlrev_b32 v236, 16, v249
    v_and_b32 v237, 0xffff0000, v249
    v_max_f32 v236, 0xc2ae0000, v236
    v_min_f32 v242, 0x43000000, v236
    v_mul_f32 v238, 0xbfb8aa3b, v242
    v_fma_f32 v240, v242, s98, -v238
    v_fmac_f32 v240, 0xb2a57060, v242
    v_exp_f32 v238, v238
    v_mul_f32 v240, 0x3f317218, v240
    v_fmac_f32 v238, v238, v240
    v_add_f32 v238, 1.0, v238
    v_rcp_f32 v240, v238
    s_nop 0
    v_mul_f32 v242, v236, v240
    v_fma_f32 v238, -v242, v238, v236
    v_fma_f32 v236, v238, v240, v242
    v_max_f32 v237, 0xc2ae0000, v237
    v_min_f32 v243, 0x43000000, v237
    v_mul_f32 v239, 0xbfb8aa3b, v243
    s_branch .Lsk_m0_4
.Lst_m0_4:
    s_branch .Lrt_m0_4
.Lsk_m0_4:
    v_fma_f32 v241, v243, s98, -v239
    v_fmac_f32 v241, 0xb2a57060, v243
    v_exp_f32 v239, v239
    v_mul_f32 v241, 0x3f317218, v241
    v_fmac_f32 v239, v239, v241
    v_add_f32 v239, 1.0, v239
    v_rcp_f32 v241, v239
    s_nop 0
    v_mul_f32 v243, v237, v241
    v_fma_f32 v239, -v243, v239, v237
    v_fma_f32 v237, v239, v241, v243
    v_cvt_pk_bf16_f32 v249, v236, v237
    v_lshlrev_b32 v236, 16, v250
    v_and_b32 v237, 0xffff0000, v250
    v_max_f32 v236, 0xc2ae0000, v236
    v_min_f32 v242, 0x43000000, v236
    v_mul_f32 v238, 0xbfb8aa3b, v242
    v_fma_f32 v240, v242, s98, -v238
    v_fmac_f32 v240, 0xb2a57060, v242
    v_exp_f32 v238, v238
    v_mul_f32 v240, 0x3f317218, v240
    v_fmac_f32 v238, v238, v240
    v_add_f32 v238, 1.0, v238
    v_rcp_f32 v240, v238
    s_nop 0
    v_mul_f32 v242, v236, v240
    v_fma_f32 v238, -v242, v238, v236
    v_fma_f32 v236, v238, v240, v242
    v_max_f32 v237, 0xc2ae0000, v237
    v_min_f32 v243, 0x43000000, v237
    v_mul_f32 v239, 0xbfb8aa3b, v243
    v_fma_f32 v241, v243, s98, -v239
    v_fmac_f32 v241, 0xb2a57060, v243
    v_exp_f32 v239, v239
    v_mul_f32 v241, 0x3f317218, v241
    v_fmac_f32 v239, v239, v241
    v_add_f32 v239, 1.0, v239
    v_rcp_f32 v241, v239
    s_nop 0
    v_mul_f32 v243, v237, v241
    v_fma_f32 v239, -v243, v239, v237
    v_fma_f32 v237, v239, v241, v243
    v_cvt_pk_bf16_f32 v250, v236, v237
    ds_write_b64 v17, v[246:247] offset:0
    ds_write_b64 v17, v[248:249] offset:512
    ds_write_b32 v18, v250 offset:0
    s_waitcnt vmcnt(3)
    s_add_u32 s63, s69, 147456
    buffer_load_dwordx4 v[72:75], v1, s[40:43], s63 offen nt
    s_waitcnt vmcnt(3)
    s_add_u32 s63, s69, 155648
    buffer_load_dwordx4 v[76:79], v1, s[40:43], s63 offen nt
    s_waitcnt vmcnt(3)
    s_add_u32 s63, s69, 163840
    buffer_load_dwordx4 v[104:107], v1, s[40:43], s63 offen nt
    s_waitcnt vmcnt(3)
    s_add_u32 s63, s69, 172032
    buffer_load_dwordx4 v[108:111], v1, s[40:43], s63 offen nt
    s_waitcnt vmcnt(3)
    s_add_u32 s63, s69, 180224
    buffer_load_dwordx4 v[136:139], v1, s[40:43], s63 offen nt
    s_waitcnt vmcnt(3)
    s_add_u32 s63, s69, 188416
    buffer_load_dwordx4 v[140:143], v1, s[40:43], s63 offen nt
    s_waitcnt vmcnt(3)
    s_add_u32 s63, s69, 262144
    buffer_load_dwordx4 v[48:51], v1, s[40:43], s63 offen nt
    s_waitcnt vmcnt(3)
    s_add_u32 s63, s69, 270336
    buffer_load_dwordx4 v[52:55], v1, s[40:43], s63 offen nt
    s_waitcnt lgkmcnt(0)
    s_barrier
    ds_read_b64_tr_b16 v[160:161], v20 offset:0
    ds_read_b64_tr_b16 v[162:163], v20 offset:512
    ds_read_b64_tr_b16 v[164:165], v20 offset:8192
    ds_read_b64_tr_b16 v[166:167], v20 offset:8704
    ds_read_b64_tr_b16 v[168:169], v20 offset:16384
    ds_read_b64_tr_b16 v[170:171], v20 offset:16896
    ds_read_b64_tr_b16 v[172:173], v20 offset:24576
    ds_read_b64_tr_b16 v[174:175], v20 offset:25088
    ds_read_b64_tr_b16 v[176:177], v21 offset:0
    ds_read_b64_tr_b16 v[178:179], v21 offset:512
    ds_read_b64_tr_b16 v[180:181], v21 offset:8192
    ds_read_b64_tr_b16 v[182:183], v21 offset:8704
    ds_read_b64_tr_b16 v[184:185], v21 offset:16384
    ds_read_b64_tr_b16 v[186:187], v21 offset:16896
    ds_read_b64_tr_b16 v[188:189], v21 offset:24576
    ds_read_b64_tr_b16 v[190:191], v21 offset:25088
    ds_read_b64_tr_b16 v[192:193], v21 offset:32768
    ds_read_b64_tr_b16 v[194:195], v21 offset:33280
    ds_read_b128 v[196:199], v16 offset:0
    ds_read_b128 v[200:203], v16 offset:128
    ds_read_b128 v[204:207], v16 offset:256
    ds_read_b128 v[208:211], v16 offset:384
    ds_read_b128 v[212:215], v16 offset:512
    ds_read_b128 v[216:219], v16 offset:640
    ds_read_b128 v[220:223], v16 offset:768
    ds_read_b128 v[224:227], v16 offset:896
    ds_read_b128 v[228:231], v16 offset:1024
    s_waitcnt lgkmcnt(8)
    v_mfma_f32_16x16x32_bf16 v[232:235], v[160:163], v[196:199], 0
    s_waitcnt lgkmcnt(7)
    v_mfma_f32_16x16x32_bf16 v[232:235], v[164:167], v[200:203], v[232:235]
    s_waitcnt lgkmcnt(6)
    v_mfma_f32_16x16x32_bf16 v[232:235], v[168:171], v[204:207], v[232:235]
    s_waitcnt lgkmcnt(5)
    v_mfma_f32_16x16x32_bf16 v[232:235], v[172:175], v[208:211], v[232:235]
    s_waitcnt lgkmcnt(4)
    v_mfma_f32_16x16x32_bf16 v[232:235], v[176:179], v[212:215], v[232:235]
    s_waitcnt lgkmcnt(3)
    v_mfma_f32_16x16x32_bf16 v[232:235], v[180:183], v[216:219], v[232:235]
    s_waitcnt lgkmcnt(2)
    v_mfma_f32_16x16x32_bf16 v[232:235], v[184:187], v[220:223], v[232:235]
    s_waitcnt lgkmcnt(1)
    v_mfma_f32_16x16x32_bf16 v[232:235], v[188:191], v[224:227], v[232:235]
    s_waitcnt lgkmcnt(0)
    v_mfma_f32_16x16x32_bf16 v[232:235], v[192:195], v[228:231], v[232:235]
    s_nop 7
    v_permlane32_swap_b32 v232, v234
    v_permlane32_swap_b32 v233, v235
    v_cndmask_b32 v233, v233, v234, s[96:97]
    v_cndmask_b32 v232, v232, v235, s[96:97]
    s_nop 1
    v_add_f32_dpp v236, v233, v232 quad_perm:[1,0,3,2] row_mask:0xf bank_mask:0xf
    v_cvt_pk_bf16_f32 v236, v236, v236
    v_lshlrev_b32 v236, 16, v236
    v_add_f32 v236, s58, v236
    v_cvt_pk_bf16_f32 v236, v236, v236
    ds_write_b16 v23, v236
    v_mov_b32 v243, s34
    s_waitcnt lgkmcnt(0)
    s_barrier
    ds_read2_b32 v[244:245], v24 offset1:1
    v_mov_b32 v241, s34
    s_waitcnt lgkmcnt(0)
    v_mov_b32 v240, v244
    v_mov_b32 v242, v245
    s_bfm_b64 exec, 16, 0
    buffer_store_dwordx4 v[240:243], v22, s[36:39], s59 offen sc1
    s_mov_b64 exec, -1
.Le_done:
    v_and_b32 v8, 1, v0
    v_lshlrev_b32 v8, 8, v8
    v_and_b32 v9, 0x3c, v0
    v_lshl_add_u32 v9, v9, 2, v8
    v_add_u32 v7, v9, v8
    v_and_b32 v9, 0x3c, v0
    v_lshrrev_b32 v8, 4, v8
    v_and_b32 v9, 4, v0
    v_lshl_add_u32 v9, v9, 3, v8
    s_lshl_b32 s58, s66, 14
    s_lshl_b32 s59, s67, 10
    s_add_u32 s58, s58, s59
    s_add_u32 s58, s58, 0x70000
    s_lshl4_add_u32 s59, s66, s67
    s_lshl_b32 s59, s59, 7
    s_add_u32 s59, s59, 0x430000
    s_waitcnt vmcnt(3)
    s_bitcmp1_b64 s[14:15], 18
    s_cbranch_scc0 1
    s_waitcnt vmcnt(2)
    s_add_u32 s63, s69, 278528
    buffer_load_dwordx4 v[80:83], v1, s[40:43], s63 offen nt
    v_and_b32 v157, 7, v0
    v_lshlrev_b32 v157, 2, v157
    s_mov_b32 s63, 0x4a1000
    buffer_load_dword v156, v157, s[36:39], s63 offen
    s_cmp_eq_u32 s3, 0
    s_cbranch_scc1 .Lst_m1_0
    s_cmp_eq_u32 s3, 1
    s_cbranch_scc1 .Lst_m1_1
    s_cmp_eq_u32 s3, 2
    s_cbranch_scc1 .Lst_m1_2
    s_cmp_eq_u32 s3, 3
    s_cbranch_scc1 .Lst_m1_3
    s_cmp_eq_u32 s3, 4
    s_cbranch_scc1 .Lst_m1_4
    s_cmp_eq_u32 s3, 5
    s_cbranch_scc1 .Lst_m1_5
    s_cmp_eq_u32 s3, 6
    s_cbranch_scc1 .Lst_m1_6
    s_cmp_eq_u32 s3, 7
    s_cbranch_scc1 .Lst_m1_7
.Lrt_m1_0:
.Lrt_m1_1:
.Lrt_m1_2:
.Lrt_m1_3:
.Lrt_m1_4:
.Lrt_m1_5:
.Lrt_m1_6:
.Lrt_m1_7:
    s_memrealtime s[8:9]
    s_waitcnt lgkmcnt(0)
    s_sub_u32 s8, s8, s30
    s_cmpk_ge_u32 s8, 912
    s_cbranch_scc1 .ap_55
    s_waitcnt vmcnt(5)
    s_cmpk_ge_u32 s8, 812
    s_cbranch_scc1 .ap_55
    s_waitcnt vmcnt(4)
    s_bitcmp1_b64 s[14:15], 19
    s_cbranch_scc0 1
    s_waitcnt vmcnt(3)
    s_cmpk_ge_u32 s8, 692
    s_cbranch_scc1 .ap_55
    s_waitcnt vmcnt(2)
.ap_55:
    s_add_u32 s63, s69, 286720
    buffer_load_dwordx4 v[84:87], v1, s[40:43], s63 offen nt
    s_memrealtime s[8:9]
    s_waitcnt lgkmcnt(0)
    s_sub_u32 s8, s8, s30
    s_cmpk_ge_u32 s8, 957
    s_cbranch_scc1 .ap_56
    s_waitcnt vmcnt(6)
    s_cmpk_ge_u32 s8, 857
    s_cbranch_scc1 .ap_56
    s_waitcnt vmcnt(4)
    s_bitcmp1_b64 s[14:15], 20
    s_cbranch_scc0 1
    s_waitcnt vmcnt(3)
    s_cmpk_ge_u32 s8, 737
    s_cbranch_scc1 .ap_56
    s_waitcnt vmcnt(2)
.ap_56:
    s_add_u32 s63, s69, 294912
    buffer_load_dwordx4 v[112:115], v1, s[40:43], s63 offen nt
    s_memrealtime s[8:9]
    s_waitcnt lgkmcnt(0)
    s_sub_u32 s8, s8, s30
    s_cmpk_ge_u32 s8, 1002
    s_cbranch_scc1 .ap_57
    s_waitcnt vmcnt(6)
    s_cmpk_ge_u32 s8, 902
    s_cbranch_scc1 .ap_57
    s_waitcnt vmcnt(4)
    s_bitcmp1_b64 s[14:15], 21
    s_cbranch_scc0 1
    s_waitcnt vmcnt(3)
    s_cmpk_ge_u32 s8, 782
    s_cbranch_scc1 .ap_57
    s_waitcnt vmcnt(1)
.ap_57:
    s_add_u32 s63, s69, 303104
    buffer_load_dwordx4 v[116:119], v1, s[40:43], s63 offen nt
    s_memrealtime s[8:9]
    s_waitcnt lgkmcnt(0)
    s_sub_u32 s8, s8, s30
    s_cmpk_ge_u32 s8, 1048
    s_cbranch_scc1 .ap_58
    s_waitcnt vmcnt(6)
    s_cmpk_ge_u32 s8, 948
    s_cbranch_scc1 .ap_58
    s_waitcnt vmcnt(4)
    s_bitcmp1_b64 s[14:15], 22
    s_cbranch_scc0 1
    s_waitcnt vmcnt(2)
    s_cmpk_ge_u32 s8, 828
    s_cbranch_scc1 .ap_58
    s_waitcnt vmcnt(1)
.ap_58:
    s_add_u32 s63, s69, 311296
    buffer_load_dwordx4 v[144:147], v1, s[40:43], s63 offen nt
    s_waitcnt vmcnt(4)
    s_sub_u32 s63, s70, 300
    v_subrev_u32 v156, s63, v156
    v_mov_b32 v157, 600
    v_cmp_lt_u32 s[8:9], v156, v157
    v_add_u32_dpp v156, v156, v156 quad_perm:[1,0,3,2] row_mask:0xf bank_mask:0xf
    s_nop 1
    v_add_u32_dpp v156, v156, v156 quad_perm:[2,3,0,1] row_mask:0xf bank_mask:0xf
    s_nop 1
    v_add_u32_dpp v156, v156, v156 row_ror:4 row_mask:0xf bank_mask:0xf
    s_nop 0
    v_readfirstlane_b32 s63, v156
    s_cmp_eq_u64 s[8:9], -1
    s_nop 3
    s_cbranch_scc0 .et_59
    s_lshr_b32 s63, s63, 3
    s_sub_u32 s63, s63, 300
    s_add_u32 s30, s30, s63
    s_add_u32 s31, s31, s63
.et_59:
    s_memrealtime s[8:9]
    s_waitcnt lgkmcnt(0)
    s_sub_u32 s8, s8, s30
    s_cmpk_ge_u32 s8, 1093
    s_cbranch_scc1 .ap_60
    s_waitcnt vmcnt(4)
    s_cmpk_ge_u32 s8, 993
    s_cbranch_scc1 .ap_60
    s_waitcnt vmcnt(3)
    s_bitcmp1_b64 s[14:15], 23
    s_cbranch_scc0 1
    s_waitcnt vmcnt(2)
    s_cmpk_ge_u32 s8, 873
    s_cbranch_scc1 .ap_60
    s_waitcnt vmcnt(1)
.ap_60:
    s_add_u32 s63, s69, 319488
    buffer_load_dwordx4 v[148:151], v1, s[40:43], s63 offen nt
    s_memrealtime s[8:9]
    s_waitcnt lgkmcnt(0)
    s_sub_u32 s8, s8, s30
    s_cmpk_ge_u32 s8, 1138
    s_cbranch_scc1 .ap_61
    s_waitcnt vmcnt(5)
    s_cmpk_ge_u32 s8, 1038
    s_cbranch_scc1 .ap_61
    s_waitcnt vmcnt(3)
    s_bitcmp1_b64 s[14:15], 24
    s_cbranch_scc0 1
    s_waitcnt vmcnt(2)
    s_cmpk_ge_u32 s8, 918
    s_cbranch_scc1 .ap_61
    s_waitcnt vmcnt(1)
.ap_61:
    s_add_u32 s63, s69, 393216
    buffer_load_dwordx4 v[56:59], v1, s[40:43], s63 offen nt
    s_memrealtime s[8:9]
    s_waitcnt lgkmcnt(0)
    s_sub_u32 s8, s8, s30
    s_cmpk_ge_u32 s8, 1184
    s_cbranch_scc1 .ap_62
    s_waitcnt vmcnt(5)
    s_cmpk_ge_u32 s8, 1084
    s_cbranch_scc1 .ap_62
    s_waitcnt vmcnt(3)
    s_bitcmp1_b64 s[14:15], 25
    s_cbranch_scc0 1
    s_waitcnt vmcnt(2)
    s_cmpk_ge_u32 s8, 964
    s_cbranch_scc1 .ap_62
    s_waitcnt vmcnt(1)
.ap_62:
    s_add_u32 s63, s69, 401408
    buffer_load_dwordx4 v[60:63], v1, s[40:43], s63 offen nt
    s_memrealtime s[8:9]
    s_waitcnt lgkmcnt(0)
    s_sub_u32 s8, s8, s30
    s_cmpk_ge_u32 s8, 1211
    s_cbranch_scc1 .ap_63
    s_waitcnt vmcnt(5)
    s_cmpk_ge_u32 s8, 1111
    s_cbranch_scc1 .ap_63
    s_waitcnt vmcnt(3)
    s_bitcmp1_b64 s[14:15], 26
    s_cbranch_scc0 1
    s_waitcnt vmcnt(2)
    s_cmpk_ge_u32 s8, 991
    s_cbranch_scc1 .ap_63
    s_waitcnt vmcnt(1)
.ap_63:
    s_add_u32 s63, s69, 409600
    buffer_load_dwordx4 v[88:91], v1, s[40:43], s63 offen nt
    s_memrealtime s[8:9]
    s_waitcnt lgkmcnt(0)
    s_sub_u32 s8, s8, s30
    s_cmpk_ge_u32 s8, 1238
    s_cbranch_scc1 .ap_64
    s_waitcnt vmcnt(5)
    s_cmpk_ge_u32 s8, 1138
    s_cbranch_scc1 .ap_64
    s_waitcnt vmcnt(3)
    s_bitcmp1_b64 s[14:15], 27
    s_cbranch_scc0 1
    s_waitcnt vmcnt(2)
    s_cmpk_ge_u32 s8, 1018
    s_cbranch_scc1 .ap_64
    s_branch .Lsk_m1_0
.Lst_m1_0:
    s_branch .Lrt_m1_0
.Lsk_m1_0:
    s_waitcnt vmcnt(1)
.ap_64:
    s_add_u32 s63, s69, 417792
    buffer_load_dwordx4 v[92:95], v1, s[40:43], s63 offen nt
    s_memrealtime s[8:9]
    s_waitcnt vmcnt(8)
    s_waitcnt lgkmcnt(0)
    s_sub_u32 s8, s8, s30
    s_cmpk_ge_u32 s8, 1265
    s_cbranch_scc1 .ap_65
    s_waitcnt vmcnt(5)
    s_cmpk_ge_u32 s8, 1165
    s_cbranch_scc1 .ap_65
    s_waitcnt vmcnt(3)
    s_bitcmp1_b64 s[14:15], 28
    s_cbranch_scc0 1
    s_waitcnt vmcnt(2)
    s_cmpk_ge_u32 s8, 1045
    s_cbranch_scc1 .ap_65
    s_waitcnt vmcnt(1)
.ap_65:
    s_add_u32 s63, s69, 425984
    buffer_load_dwordx4 v[120:123], v1, s[40:43], s63 offen nt
    s_memrealtime s[8:9]
    s_waitcnt vmcnt(8)
    s_waitcnt lgkmcnt(0)
    s_sub_u32 s8, s8, s30
    s_cmpk_ge_u32 s8, 1292
    s_cbranch_scc1 .ap_66
    s_waitcnt vmcnt(5)
    s_cmpk_ge_u32 s8, 1192
    s_cbranch_scc1 .ap_66
    s_waitcnt vmcnt(3)
    s_bitcmp1_b64 s[14:15], 29
    s_cbranch_scc0 1
    s_waitcnt vmcnt(2)
    s_cmpk_ge_u32 s8, 1072
    s_cbranch_scc1 .ap_66
    s_waitcnt vmcnt(1)
.ap_66:
    s_add_u32 s63, s69, 434176
    buffer_load_dwordx4 v[124:127], v1, s[40:43], s63 offen nt
    s_memrealtime s[8:9]
    s_waitcnt vmcnt(8)
    s_waitcnt lgkmcnt(0)
    s_sub_u32 s8, s8, s30
    s_cmpk_ge_u32 s8, 1320
    s_cbranch_scc1 .ap_67
    s_waitcnt vmcnt(5)
    s_cmpk_ge_u32 s8, 1220
    s_cbranch_scc1 .ap_67
    s_waitcnt vmcnt(3)
    s_bitcmp1_b64 s[14:15], 30
    s_cbranch_scc0 1
    s_waitcnt vmcnt(2)
    s_cmpk_ge_u32 s8, 1100
    s_cbranch_scc1 .ap_67
    s_waitcnt vmcnt(1)
.ap_67:
    s_add_u32 s63, s69, 442368
    buffer_load_dwordx4 v[152:155], v1, s[40:43], s63 offen nt
    s_memrealtime s[8:9]
    s_waitcnt vmcnt(8)
    s_waitcnt lgkmcnt(0)
    s_sub_u32 s8, s8, s30
    s_cmpk_ge_u32 s8, 1347
    s_cbranch_scc1 .ap_68
    s_waitcnt vmcnt(5)
    s_cmpk_ge_u32 s8, 1247
    s_cbranch_scc1 .ap_68
    s_waitcnt vmcnt(3)
    s_bitcmp1_b64 s[14:15], 31
    s_cbranch_scc0 1
    s_waitcnt vmcnt(2)
    s_cmpk_ge_u32 s8, 1127
    s_cbranch_scc1 .ap_68
    s_waitcnt vmcnt(1)
.ap_68:
    s_add_u32 s63, s69, 450560
    buffer_load_dwordx4 v[156:159], v1, s[40:43], s63 offen nt
    s_memrealtime s[8:9]
    s_waitcnt vmcnt(8)
    s_waitcnt lgkmcnt(0)
    s_sub_u32 s8, s8, s30
    s_cmpk_ge_u32 s8, 1374
    s_cbranch_scc1 .ap_69
    s_waitcnt vmcnt(5)
    s_cmpk_ge_u32 s8, 1274
    s_cbranch_scc1 .ap_69
    s_waitcnt vmcnt(3)
    s_bitcmp1_b64 s[14:15], 32
    s_cbranch_scc0 1
    s_waitcnt vmcnt(2)
    s_cmpk_ge_u32 s8, 1154
    s_cbranch_scc1 .ap_69
    s_waitcnt vmcnt(1)
.ap_69:
    v_bfe_u32 v1, v0, 4, 2
    v_and_b32 v10, 0xf0, v2
    v_lshlrev_b32 v1, 2, v1
    v_bfe_u32 v1, s6, v1, 4
    v_lshl_add_u32 v1, v1, 8, v10
    s_add_u32 s63, s69, 0
    buffer_load_dwordx4 v[160:163], v1, s[44:47], s63 offen nt
    s_memrealtime s[8:9]
    s_waitcnt vmcnt(8)
    s_waitcnt lgkmcnt(0)
    s_sub_u32 s8, s8, s30
    s_cmpk_ge_u32 s8, 1401
    s_cbranch_scc1 .ap_70
    s_waitcnt vmcnt(5)
    s_cmpk_ge_u32 s8, 1301
    s_cbranch_scc1 .ap_70
    s_waitcnt vmcnt(3)
    s_bitcmp1_b64 s[14:15], 33
    s_cbranch_scc0 1
    s_waitcnt vmcnt(2)
    s_cmpk_ge_u32 s8, 1181
    s_cbranch_scc1 .ap_70
    s_waitcnt vmcnt(1)
.ap_70:
    s_add_u32 s63, s69, 8192
    buffer_load_dwordx4 v[164:167], v1, s[44:47], s63 offen nt
    s_memrealtime s[8:9]
    s_waitcnt vmcnt(8)
    s_waitcnt lgkmcnt(0)
    s_sub_u32 s8, s8, s30
    s_cmpk_ge_u32 s8, 1428
    s_cbranch_scc1 .ap_71
    s_waitcnt vmcnt(5)
    s_cmpk_ge_u32 s8, 1328
    s_cbranch_scc1 .ap_71
    s_waitcnt vmcnt(3)
    s_bitcmp1_b64 s[14:15], 34
    s_cbranch_scc0 1
    s_waitcnt vmcnt(2)
    s_cmpk_ge_u32 s8, 1208
    s_cbranch_scc1 .ap_71
    s_waitcnt vmcnt(1)
.ap_71:
    s_add_u32 s63, s69, 16384
    buffer_load_dwordx4 v[168:171], v1, s[44:47], s63 offen nt
    s_memrealtime s[8:9]
    s_waitcnt vmcnt(8)
    s_waitcnt lgkmcnt(0)
    s_sub_u32 s8, s8, s30
    s_cmpk_ge_u32 s8, 1456
    s_cbranch_scc1 .ap_72
    s_waitcnt vmcnt(5)
    s_cmpk_ge_u32 s8, 1356
    s_cbranch_scc1 .ap_72
    s_waitcnt vmcnt(3)
    s_bitcmp1_b64 s[14:15], 35
    s_cbranch_scc0 1
    s_waitcnt vmcnt(2)
    s_cmpk_ge_u32 s8, 1236
    s_cbranch_scc1 .ap_72
    s_waitcnt vmcnt(1)
.ap_72:
    s_add_u32 s63, s69, 24576
    buffer_load_dwordx4 v[172:175], v1, s[44:47], s63 offen nt
    buffer_load_dwordx4 v[16:19], v7, s[36:39], s58 offen offset:0 sc1
    buffer_load_dwordx4 v[20:23], v7, s[36:39], s58 offen offset:256 sc1
    s_memrealtime s[8:9]
    s_waitcnt vmcnt(8)
    s_waitcnt lgkmcnt(0)
    s_sub_u32 s8, s8, s30
    s_cmpk_ge_u32 s8, 1486
    s_cbranch_scc1 .ap_73
    s_waitcnt vmcnt(5)
    s_cmpk_ge_u32 s8, 1386
    s_cbranch_scc1 .ap_73
    s_waitcnt vmcnt(3)
    s_bitcmp1_b64 s[14:15], 36
    s_cbranch_scc0 1
    s_waitcnt vmcnt(2)
    s_cmpk_ge_u32 s8, 1266
    s_cbranch_scc1 .ap_73
    s_waitcnt vmcnt(1)
.ap_73:
    s_add_u32 s63, s69, 32768
    buffer_load_dwordx4 v[176:179], v1, s[44:47], s63 offen nt
    s_memrealtime s[8:9]
    s_waitcnt vmcnt(8)
    s_waitcnt lgkmcnt(0)
    s_sub_u32 s8, s8, s30
    s_cmpk_ge_u32 s8, 1516
    s_cbranch_scc1 .ap_74
    s_waitcnt vmcnt(5)
    s_cmpk_ge_u32 s8, 1416
    s_cbranch_scc1 .ap_74
    s_waitcnt vmcnt(3)
    s_bitcmp1_b64 s[14:15], 37
    s_cbranch_scc0 1
    s_waitcnt vmcnt(2)
    s_cmpk_ge_u32 s8, 1296
    s_cbranch_scc1 .ap_74
    s_waitcnt vmcnt(1)
.ap_74:
    s_add_u32 s63, s69, 40960
    buffer_load_dwordx4 v[180:183], v1, s[44:47], s63 offen nt
    s_memrealtime s[8:9]
    s_waitcnt vmcnt(8)
    s_waitcnt lgkmcnt(0)
    s_sub_u32 s8, s8, s30
    s_cmpk_ge_u32 s8, 1546
    s_cbranch_scc1 .ap_75
    s_waitcnt vmcnt(5)
    s_cmpk_ge_u32 s8, 1446
    s_cbranch_scc1 .ap_75
    s_waitcnt vmcnt(3)
    s_bitcmp1_b64 s[14:15], 38
    s_cbranch_scc0 1
    s_waitcnt vmcnt(2)
    s_cmpk_ge_u32 s8, 1326
    s_cbranch_scc1 .ap_75
    s_waitcnt vmcnt(1)
.ap_75:
    s_add_u32 s63, s69, 49152
    buffer_load_dwordx4 v[184:187], v1, s[44:47], s63 offen nt
    s_waitcnt vmcnt(3)
    s_branch .gpc_77
.gp_76:
    buffer_load_dwordx4 v[16:19], v7, s[36:39], s58 offen offset:0 sc1
    buffer_load_dwordx4 v[20:23], v7, s[36:39], s58 offen offset:256 sc1
    s_waitcnt vmcnt(0)
.gpc_77:
    v_min_u32 v10, v17, v19
    v_max_u32 v11, v17, v19
    v_min3_u32 v10, v10, v21, v23
    v_max3_u32 v11, v11, v21, v23
    v_cmp_eq_u32 vcc, s34, v10
    v_cmp_eq_u32 s[56:57], s34, v11
    s_and_b64 vcc, vcc, s[56:57]
    s_cmp_eq_u64 vcc, -1
    s_nop 2
    s_cbranch_scc1 .gpd_78
    s_sub_u32 s35, s35, 1
    s_branch .Lsk_m1_1
.Lst_m1_1:
    s_branch .Lrt_m1_1
.Lsk_m1_1:
    s_cbranch_scc1 .Lexit
    s_sleep 1
    s_branch .gp_76
.gpd_78:
    s_mov_b32 vcc_lo, 0xcccccccc
    s_mov_b32 vcc_hi, 0xcccccccc
    v_cndmask_b32_e64 v24, v16, 0, vcc
    v_cndmask_b32_e64 v25, v18, 0, vcc
    v_cndmask_b32_e64 v26, v20, 0, vcc
    v_cndmask_b32_e64 v27, v22, 0, vcc
    v_cndmask_b32_e32 v28, 0, v16, vcc
    v_cndmask_b32_e32 v29, 0, v18, vcc
    v_cndmask_b32_e32 v30, 0, v20, vcc
    v_cndmask_b32_e32 v31, 0, v22, vcc
    v_mfma_f32_16x16x32_bf16 v[16:19], v[32:35], v[24:27], 0
    v_mfma_f32_16x16x32_bf16 v[32:35], v[40:43], v[24:27], 0
    v_mfma_f32_16x16x32_bf16 v[16:19], v[36:39], v[28:31], v[16:19]
    v_mfma_f32_16x16x32_bf16 v[40:43], v[48:51], v[24:27], 0
    v_mfma_f32_16x16x32_bf16 v[32:35], v[44:47], v[28:31], v[32:35]
    v_mfma_f32_16x16x32_bf16 v[48:51], v[56:59], v[24:27], 0
    v_mfma_f32_16x16x32_bf16 v[40:43], v[52:55], v[28:31], v[40:43]
    v_mfma_f32_16x16x32_bf16 v[56:59], v[64:67], v[24:27], 0
    v_mfma_f32_16x16x32_bf16 v[48:51], v[60:63], v[28:31], v[48:51]
    s_nop 1
    v_add_f32_dpp v10, v17, v16 row_ror:12 row_mask:0xf bank_mask:0x1
    s_memrealtime s[8:9]
    s_waitcnt lgkmcnt(0)
    s_sub_u32 s8, s8, s30
    s_cmpk_ge_u32 s8, 1576
    s_nop 0
    s_cbranch_scc1 .ap_79
    s_waitcnt vmcnt(3)
    s_cmpk_ge_u32 s8, 1476
    s_cbranch_scc1 .ap_79
    s_waitcnt vmcnt(3)
    s_bitcmp1_b64 s[14:15], 39
    s_cbranch_scc0 1
    s_waitcnt vmcnt(2)
    s_cmpk_ge_u32 s8, 1356
    s_cbranch_scc1 .ap_79
    s_waitcnt vmcnt(1)
.ap_79:
    s_add_u32 s63, s69, 57344
    buffer_load_dwordx4 v[188:191], v1, s[44:47], s63 offen nt
    v_mfma_f32_16x16x32_bf16 v[64:67], v[72:75], v[24:27], 0
    v_mfma_f32_16x16x32_bf16 v[56:59], v[68:71], v[28:31], v[56:59]
    v_add_f32_dpp v11, v33, v32 row_ror:12 row_mask:0xf bank_mask:0x1
    v_add_f32_dpp v10, v18, v10 row_ror:8 row_mask:0xf bank_mask:0x1
    v_mfma_f32_16x16x32_bf16 v[72:75], v[80:83], v[24:27], 0
    v_mfma_f32_16x16x32_bf16 v[64:67], v[76:79], v[28:31], v[64:67]
    v_add_f32_dpp v12, v41, v40 row_ror:12 row_mask:0xf bank_mask:0x1
    v_add_f32_dpp v11, v34, v11 row_ror:8 row_mask:0xf bank_mask:0x1
    v_add_f32_dpp v10, v19, v10 row_ror:4 row_mask:0xf bank_mask:0x1
    v_mfma_f32_16x16x32_bf16 v[80:83], v[88:91], v[24:27], 0
    v_mfma_f32_16x16x32_bf16 v[72:75], v[84:87], v[28:31], v[72:75]
    v_add_f32_dpp v13, v49, v48 row_ror:12 row_mask:0xf bank_mask:0x1
    v_add_f32_dpp v12, v42, v12 row_ror:8 row_mask:0xf bank_mask:0x1
    v_add_f32_dpp v11, v35, v11 row_ror:4 row_mask:0xf bank_mask:0x1
    v_mfma_f32_16x16x32_bf16 v[88:91], v[96:99], v[24:27], 0
    v_mfma_f32_16x16x32_bf16 v[80:83], v[92:95], v[28:31], v[80:83]
    v_add_f32_dpp v10, v58, v57 row_ror:12 row_mask:0xf bank_mask:0x2
    v_add_f32_dpp v13, v50, v13 row_ror:8 row_mask:0xf bank_mask:0x1
    v_add_f32_dpp v12, v43, v12 row_ror:4 row_mask:0xf bank_mask:0x1
    s_memrealtime s[8:9]
    s_waitcnt lgkmcnt(0)
    s_sub_u32 s8, s8, s30
    s_cmpk_ge_u32 s8, 1606
    s_nop 0
    s_cbranch_scc1 .ap_80
    s_waitcnt vmcnt(4)
    s_cmpk_ge_u32 s8, 1506
    s_cbranch_scc1 .ap_80
    s_waitcnt vmcnt(3)
    s_bitcmp1_b64 s[14:15], 40
    s_cbranch_scc0 1
    s_waitcnt vmcnt(2)
    s_cmpk_ge_u32 s8, 1386
    s_cbranch_scc1 .ap_80
    s_waitcnt vmcnt(1)
.ap_80:
    s_add_u32 s63, s69, 131072
    buffer_load_dwordx4 v[192:195], v1, s[44:47], s63 offen nt
    v_mfma_f32_16x16x32_bf16 v[96:99], v[104:107], v[24:27], 0
    v_mfma_f32_16x16x32_bf16 v[88:91], v[100:103], v[28:31], v[88:91]
    v_add_f32_dpp v11, v66, v65 row_ror:12 row_mask:0xf bank_mask:0x2
    v_add_f32_dpp v10, v59, v10 row_ror:8 row_mask:0xf bank_mask:0x2
    v_add_f32_dpp v13, v51, v13 row_ror:4 row_mask:0xf bank_mask:0x1
    v_mfma_f32_16x16x32_bf16 v[104:107], v[112:115], v[24:27], 0
    v_mfma_f32_16x16x32_bf16 v[96:99], v[108:111], v[28:31], v[96:99]
    v_add_f32_dpp v12, v74, v73 row_ror:12 row_mask:0xf bank_mask:0x2
    v_add_f32_dpp v11, v67, v11 row_ror:8 row_mask:0xf bank_mask:0x2
    v_add_f32_dpp v10, v56, v10 row_ror:4 row_mask:0xf bank_mask:0x2
    v_mfma_f32_16x16x32_bf16 v[112:115], v[120:123], v[24:27], 0
    v_mfma_f32_16x16x32_bf16 v[104:107], v[116:119], v[28:31], v[104:107]
    v_add_f32_dpp v13, v82, v81 row_ror:12 row_mask:0xf bank_mask:0x2
    v_add_f32_dpp v12, v75, v12 row_ror:8 row_mask:0xf bank_mask:0x2
    v_add_f32_dpp v11, v64, v11 row_ror:4 row_mask:0xf bank_mask:0x2
    v_mfma_f32_16x16x32_bf16 v[120:123], v[128:131], v[24:27], 0
    v_mfma_f32_16x16x32_bf16 v[112:115], v[124:127], v[28:31], v[112:115]
    v_add_f32_dpp v10, v91, v90 row_ror:12 row_mask:0xf bank_mask:0x4
    v_add_f32_dpp v13, v83, v13 row_ror:8 row_mask:0xf bank_mask:0x2
    v_add_f32_dpp v12, v72, v12 row_ror:4 row_mask:0xf bank_mask:0x2
    s_memrealtime s[8:9]
    s_waitcnt lgkmcnt(0)
    s_sub_u32 s8, s8, s30
    s_cmpk_ge_u32 s8, 1636
    s_nop 0
    s_cbranch_scc1 .ap_81
    s_waitcnt vmcnt(5)
    s_cmpk_ge_u32 s8, 1536
    s_cbranch_scc1 .ap_81
    s_waitcnt vmcnt(3)
    s_bitcmp1_b64 s[14:15], 41
    s_cbranch_scc0 1
    s_waitcnt vmcnt(2)
    s_cmpk_ge_u32 s8, 1416
    s_cbranch_scc1 .ap_81
    s_waitcnt vmcnt(1)
.ap_81:
    s_add_u32 s63, s69, 139264
    buffer_load_dwordx4 v[196:199], v1, s[44:47], s63 offen nt
    v_mfma_f32_16x16x32_bf16 v[128:131], v[136:139], v[24:27], 0
    v_mfma_f32_16x16x32_bf16 v[120:123], v[132:135], v[28:31], v[120:123]
    v_add_f32_dpp v11, v99, v98 row_ror:12 row_mask:0xf bank_mask:0x4
    v_add_f32_dpp v10, v88, v10 row_ror:8 row_mask:0xf bank_mask:0x4
    v_add_f32_dpp v13, v80, v13 row_ror:4 row_mask:0xf bank_mask:0x2
    v_mfma_f32_16x16x32_bf16 v[136:139], v[144:147], v[24:27], 0
    v_mfma_f32_16x16x32_bf16 v[128:131], v[140:143], v[28:31], v[128:131]
    v_add_f32_dpp v12, v107, v106 row_ror:12 row_mask:0xf bank_mask:0x4
    v_add_f32_dpp v11, v96, v11 row_ror:8 row_mask:0xf bank_mask:0x4
    v_add_f32_dpp v10, v89, v10 row_ror:4 row_mask:0xf bank_mask:0x4
    v_mfma_f32_16x16x32_bf16 v[144:147], v[152:155], v[24:27], 0
    v_mfma_f32_16x16x32_bf16 v[136:139], v[148:151], v[28:31], v[136:139]
    v_add_f32_dpp v13, v115, v114 row_ror:12 row_mask:0xf bank_mask:0x4
    v_add_f32_dpp v12, v104, v12 row_ror:8 row_mask:0xf bank_mask:0x4
    v_add_f32_dpp v11, v97, v11 row_ror:4 row_mask:0xf bank_mask:0x4
    v_mfma_f32_16x16x32_bf16 v[144:147], v[156:159], v[28:31], v[144:147]
    v_add_f32_dpp v10, v120, v123 row_ror:12 row_mask:0xf bank_mask:0x8
    v_add_f32_dpp v13, v112, v13 row_ror:8 row_mask:0xf bank_mask:0x4
    v_add_f32_dpp v12, v105, v12 row_ror:4 row_mask:0xf bank_mask:0x4
    s_memrealtime s[8:9]
    s_waitcnt lgkmcnt(0)
    s_sub_u32 s8, s8, s30
    s_cmpk_ge_u32 s8, 1666
    s_nop 0
    s_cbranch_scc1 .ap_82
    s_waitcnt vmcnt(5)
    s_cmpk_ge_u32 s8, 1566
    s_cbranch_scc1 .ap_82
    s_waitcnt vmcnt(3)
    s_bitcmp1_b64 s[14:15], 42
    s_cbranch_scc0 1
    s_waitcnt vmcnt(2)
    s_cmpk_ge_u32 s8, 1446
    s_cbranch_scc1 .ap_82
    s_waitcnt vmcnt(1)
.ap_82:
    s_add_u32 s63, s69, 147456
    buffer_load_dwordx4 v[200:203], v1, s[44:47], s63 offen nt
    v_add_f32_dpp v11, v128, v131 row_ror:12 row_mask:0xf bank_mask:0x8
    v_add_f32_dpp v10, v121, v10 row_ror:8 row_mask:0xf bank_mask:0x8
    v_add_f32_dpp v13, v113, v13 row_ror:4 row_mask:0xf bank_mask:0x4
    v_add_f32_dpp v12, v136, v139 row_ror:12 row_mask:0xf bank_mask:0x8
    v_add_f32_dpp v11, v129, v11 row_ror:8 row_mask:0xf bank_mask:0x8
    v_add_f32_dpp v10, v122, v10 row_ror:4 row_mask:0xf bank_mask:0x8
    v_add_f32_dpp v13, v144, v147 row_ror:12 row_mask:0xf bank_mask:0x8
    v_add_f32_dpp v12, v137, v12 row_ror:8 row_mask:0xf bank_mask:0x8
    v_add_f32_dpp v11, v130, v11 row_ror:4 row_mask:0xf bank_mask:0x8
    v_add_f32_dpp v13, v145, v13 row_ror:8 row_mask:0xf bank_mask:0x8
    v_add_f32_dpp v12, v138, v12 row_ror:4 row_mask:0xf bank_mask:0x8
    s_memrealtime s[8:9]
    s_waitcnt lgkmcnt(0)
    s_sub_u32 s8, s8, s30
    s_cmpk_ge_u32 s8, 1696
    s_cbranch_scc1 .ap_83
    s_waitcnt vmcnt(5)
    s_cmpk_ge_u32 s8, 1596
    s_cbranch_scc1 .ap_83
    s_branch .Lsk_m1_2
.Lst_m1_2:
    s_branch .Lrt_m1_2
.Lsk_m1_2:
    s_waitcnt vmcnt(3)
    s_bitcmp1_b64 s[14:15], 43
    s_cbranch_scc0 1
    s_waitcnt vmcnt(2)
    s_cmpk_ge_u32 s8, 1476
    s_cbranch_scc1 .ap_83
    s_waitcnt vmcnt(1)
.ap_83:
    s_add_u32 s63, s69, 155648
    buffer_load_dwordx4 v[204:207], v1, s[44:47], s63 offen nt
    v_add_f32_dpp v13, v146, v13 row_ror:4 row_mask:0xf bank_mask:0x8
    s_mov_b32 s60, 0x3db504f3
    s_mov_b32 s61, 0x3db504f3
    v_cvt_pk_bf16_f32 v10, v10, v11
    v_and_b32 v11, 0xffff0000, v10
    v_lshlrev_b32 v10, 16, v10
    v_cvt_pk_bf16_f32 v12, v12, v13
    v_and_b32 v13, 0xffff0000, v12
    v_lshlrev_b32 v12, 16, v12
    v_pk_mul_f32 v[10:11], v[10:11], s[60:61]
    v_pk_mul_f32 v[12:13], v[12:13], s[60:61]
    v_cvt_pk_bf16_f32 v10, v10, v11
    v_and_b32 v11, 0xffff0000, v10
    v_lshlrev_b32 v10, 16, v10
    v_cvt_pk_bf16_f32 v12, v12, v13
    v_and_b32 v13, 0xffff0000, v12
    v_lshlrev_b32 v12, 16, v12
    v_max_f32 v14, v10, v11
    v_max3_f32 v14, v14, v12, v13
    s_mov_b32 s60, 0x3fb8aa3b
    v_mov_b32 v22, s34
    v_mov_b32 v23, s34
    v_max_f32_dpp v14, v14, v14 quad_perm:[2,3,0,1] row_mask:0xf bank_mask:0xf
    s_nop 1
    v_max_f32_dpp v14, v14, v14 row_ror:4 row_mask:0xf bank_mask:0xf
    s_nop 1
    v_max_f32_dpp v14, v14, v14 row_ror:8 row_mask:0xf bank_mask:0xf
    v_mov_b32 v15, v14
    s_nop 1
    v_permlane16_swap_b32 v15, v14
    v_max_f32 v14, v15, v14
    v_mov_b32 v15, v14
    s_nop 1
    v_permlane32_swap_b32 v15, v14
    v_max_f32 v14, v15, v14
    v_mul_f32 v15, 0xbfb8aa3b, v14
    v_fma_f32 v10, v10, s60, v15
    v_fma_f32 v11, v11, s60, v15
    v_fma_f32 v12, v12, s60, v15
    v_fma_f32 v13, v13, s60, v15
    v_exp_f32 v10, v10
    v_exp_f32 v11, v11
    v_exp_f32 v12, v12
    v_exp_f32 v13, v13
    v_mov_b32 v20, v14
    v_pk_add_f32 v[16:17], v[10:11], v[12:13]
    v_add_f32 v21, v16, v17
    s_lshl_b32 s60, s68, 5
    s_lshl_b32 s61, s3, 4
    s_add_u32 s61, s61, 159104
    v_add_u32 v16, s61, v3
    v_mov_b32 v17, 159232
    v_mov_b32 v18, 1
    s_add_u32 s60, s60, s59
    v_add_f32_dpp v21, v21, v21 quad_perm:[2,3,0,1] row_mask:0xf bank_mask:0xf
    s_nop 1
    v_add_f32_dpp v21, v21, v21 row_ror:4 row_mask:0xf bank_mask:0xf
    s_nop 1
    v_add_f32_dpp v21, v21, v21 row_ror:8 row_mask:0xf bank_mask:0xf
    v_mov_b32 v15, v21
    s_nop 1
    v_permlane16_swap_b32 v15, v21
    v_add_f32 v21, v15, v21
    v_mov_b32 v15, v21
    s_nop 1
    v_permlane32_swap_b32 v15, v21
    v_add_f32 v21, v15, v21
    s_mov_b64 exec, 3
    ds_write_b64 v16, v[20:21]
    s_mov_b64 exec, 1
    ds_add_rtn_u32 v18, v17, v18
    s_mov_b64 exec, -1
    v_and_b32 v16, 0x78, v3
    v_or_b32 v16, 159104, v16
    s_waitcnt lgkmcnt(0)
    v_readfirstlane_b32 s61, v18
    s_cmp_eq_u32 s61, 7
    s_nop 3
    s_cbranch_scc0 .mlc_84
    ds_read_b64 v[18:19], v16
    s_waitcnt lgkmcnt(0)
    v_mov_b32 v20, v18
    s_nop 1
    v_max_f32_dpp v20, v20, v20 quad_perm:[2,3,0,1] row_mask:0xf bank_mask:0xf
    s_nop 1
    v_max_f32_dpp v20, v20, v20 row_ror:4 row_mask:0xf bank_mask:0xf
    s_nop 1
    v_max_f32_dpp v20, v20, v20 row_ror:8 row_mask:0xf bank_mask:0xf
    v_sub_f32 v18, v18, v20
    v_mul_f32 v18, 0x3fb8aa3b, v18
    v_exp_f32 v18, v18
    s_nop 0
    v_mul_f32 v21, v18, v19
    s_nop 1
    v_add_f32_dpp v21, v21, v21 quad_perm:[2,3,0,1] row_mask:0xf bank_mask:0xf
    s_nop 1
    v_add_f32_dpp v21, v21, v21 row_ror:4 row_mask:0xf bank_mask:0xf
    s_nop 1
    v_add_f32_dpp v21, v21, v21 row_ror:8 row_mask:0xf bank_mask:0xf
    s_mov_b64 exec, 3
    buffer_store_dwordx4 v[20:23], v2, s[36:39], s60 offen sc1
    s_mov_b64 exec, -1
.mlc_84:
    s_memrealtime s[8:9]
    s_waitcnt lgkmcnt(0)
    s_sub_u32 s8, s8, s30
    s_cmpk_ge_u32 s8, 1726
    s_cbranch_scc1 .ap_85
    s_waitcnt vmcnt(5)
    s_cmpk_ge_u32 s8, 1626
    s_cbranch_scc1 .ap_85
    s_waitcnt vmcnt(3)
    s_bitcmp1_b64 s[14:15], 44
    s_cbranch_scc0 1
    s_waitcnt vmcnt(2)
    s_cmpk_ge_u32 s8, 1506
    s_cbranch_scc1 .ap_85
    s_waitcnt vmcnt(1)
.ap_85:
    s_add_u32 s63, s69, 163840
    buffer_load_dwordx4 v[208:211], v1, s[44:47], s63 offen nt
    s_cmp_eq_u32 s3, 0
    s_cbranch_scc1 .Lst_m2_0
    s_cmp_eq_u32 s3, 1
    s_cbranch_scc1 .Lst_m2_1
    s_cmp_eq_u32 s3, 2
    s_cbranch_scc1 .Lrt_m2_2
    s_cmp_eq_u32 s3, 3
    s_cbranch_scc1 .Lrt_m2_3
.Lrt_m2_0:
.Lrt_m2_1:
.Lrt_m2_2:
.Lrt_m2_3:
    v_mov_b32 v16, 0
    v_bfe_u32 v17, v0, 3, 1
    v_lshl_add_u32 v16, v17, 5, v16
    v_bfe_u32 v17, v0, 5, 1
    v_lshl_add_u32 v16, v17, 4, v16
    v_bfe_u32 v17, v0, 0, 3
    v_lshl_add_u32 v16, v17, 1, v16
    v_bfe_u32 v17, v0, 4, 1
    v_lshl_add_u32 v16, v17, 0, v16
    v_lshlrev_b32 v7, 1, v16
    v_and_b32 v8, 62, v16
    v_lshlrev_b32 v8, 2, v8
    s_mul_i32 s100, s3, 1152
    s_lshl_b32 s56, s65, 7
    s_add_u32 s100, s100, s56
    s_mov_b32 s52, s4
    s_and_b32 s53, s5, 0xffff
    s_mov_b32 s54, 0x2400
    s_mov_b32 s55, 0x00020000
    buffer_load_ushort v40, v7, s[52:55], s100 offen
    s_lshr_b32 s56, s64, 1
    s_and_b32 s57, s3, 3
    s_cmp_lg_u32 s56, s57
    s_cselect_b64 exec, 0, -1
    s_mov_b32 s48, s16
    s_and_b32 s49, s17, 0xffff
    s_mov_b32 s50, 0x480
    s_mov_b32 s51, 0x00020000
    buffer_load_dwordx2 v[48:49], v3, s[48:51], 0 offen
    buffer_load_dwordx2 v[50:51], v3, s[48:51], 0 offen offset:512
    buffer_load_dword v34, v4, s[48:51], 0 offen
    s_mov_b32 s48, s28
    s_and_b32 s49, s29, 0xffff
    s_mov_b32 s50, 0x2400
    s_mov_b32 s51, 0x00020000
    buffer_load_ushort v39, v7, s[48:51], s100 offen nt
    s_mov_b64 exec, -1
    s_memrealtime s[8:9]
    s_waitcnt vmcnt(13)
    s_waitcnt lgkmcnt(0)
    s_sub_u32 s8, s8, s30
    s_cmpk_ge_u32 s8, 1756
    s_cbranch_scc1 .ap_86
    s_waitcnt vmcnt(10)
    s_cmpk_ge_u32 s8, 1656
    s_cbranch_scc1 .ap_86
    s_waitcnt vmcnt(8)
    s_bitcmp1_b64 s[14:15], 45
    s_cbranch_scc0 1
    s_waitcnt vmcnt(7)
    s_cmpk_ge_u32 s8, 1536
    s_cbranch_scc1 .ap_86
    s_waitcnt vmcnt(6)
.ap_86:
    s_add_u32 s63, s69, 172032
    buffer_load_dwordx4 v[212:215], v1, s[44:47], s63 offen nt
    s_memrealtime s[8:9]
    s_waitcnt vmcnt(13)
    s_waitcnt lgkmcnt(0)
    s_sub_u32 s8, s8, s30
    s_cmpk_ge_u32 s8, 1788
    s_cbranch_scc1 .ap_87
    s_branch .Lsk_m1_3
.Lst_m1_3:
    s_branch .Lrt_m1_3
.Lsk_m1_3:
    s_waitcnt vmcnt(10)
    s_cmpk_ge_u32 s8, 1688
    s_cbranch_scc1 .ap_87
    s_waitcnt vmcnt(8)
    s_bitcmp1_b64 s[14:15], 46
    s_cbranch_scc0 1
    s_waitcnt vmcnt(7)
    s_cmpk_ge_u32 s8, 1568
    s_cbranch_scc1 .ap_87
    s_waitcnt vmcnt(6)
.ap_87:
    s_add_u32 s63, s69, 180224
    buffer_load_dwordx4 v[216:219], v1, s[44:47], s63 offen nt
    s_memrealtime s[8:9]
    s_waitcnt vmcnt(13)
    s_waitcnt lgkmcnt(0)
    s_sub_u32 s8, s8, s30
    s_cmpk_ge_u32 s8, 1820
    s_cbranch_scc1 .ap_88
    s_waitcnt vmcnt(10)
    s_cmpk_ge_u32 s8, 1720
    s_cbranch_scc1 .ap_88
    s_waitcnt vmcnt(8)
    s_bitcmp1_b64 s[14:15], 47
    s_cbranch_scc0 1
    s_waitcnt vmcnt(7)
    s_cmpk_ge_u32 s8, 1600
    s_cbranch_scc1 .ap_88
    s_waitcnt vmcnt(1)
.ap_88:
    s_add_u32 s63, s69, 188416
    buffer_load_dwordx4 v[220:223], v1, s[44:47], s63 offen nt
    s_memrealtime s[8:9]
    s_waitcnt vmcnt(13)
    s_waitcnt lgkmcnt(0)
    s_sub_u32 s8, s8, s30
    s_cmpk_ge_u32 s8, 1852
    s_cbranch_scc1 .ap_89
    s_waitcnt vmcnt(10)
    s_cmpk_ge_u32 s8, 1752
    s_cbranch_scc1 .ap_89
    s_waitcnt vmcnt(8)
    s_bitcmp1_b64 s[14:15], 48
    s_cbranch_scc0 1
    s_waitcnt vmcnt(2)
    s_cmpk_ge_u32 s8, 1632
    s_cbranch_scc1 .ap_89
    s_waitcnt vmcnt(1)
.ap_89:
    s_add_u32 s63, s69, 262144
    buffer_load_dwordx4 v[224:227], v1, s[44:47], s63 offen nt
    s_memrealtime s[8:9]
    s_waitcnt vmcnt(13)
    s_waitcnt lgkmcnt(0)
    s_sub_u32 s8, s8, s30
    s_cmpk_ge_u32 s8, 1884
    s_cbranch_scc1 .ap_90
    s_waitcnt vmcnt(10)
    s_cmpk_ge_u32 s8, 1784
    s_cbranch_scc1 .ap_90
    s_waitcnt vmcnt(3)
    s_bitcmp1_b64 s[14:15], 49
    s_cbranch_scc0 1
    s_waitcnt vmcnt(2)
    s_cmpk_ge_u32 s8, 1664
    s_cbranch_scc1 .ap_90
    s_waitcnt vmcnt(1)
.ap_90:
    s_add_u32 s63, s69, 270336
    buffer_load_dwordx4 v[228:231], v1, s[44:47], s63 offen nt
    s_memrealtime s[8:9]
    s_waitcnt vmcnt(13)
    s_waitcnt lgkmcnt(0)
    s_sub_u32 s8, s8, s30
    s_cmpk_ge_u32 s8, 1916
    s_cbranch_scc1 .ap_91
    s_waitcnt vmcnt(10)
    s_cmpk_ge_u32 s8, 1816
    s_cbranch_scc1 .ap_91
    s_waitcnt vmcnt(3)
    s_bitcmp1_b64 s[14:15], 50
    s_cbranch_scc0 1
    s_waitcnt vmcnt(2)
    s_cmpk_ge_u32 s8, 1696
    s_cbranch_scc1 .ap_91
    s_waitcnt vmcnt(1)
.ap_91:
    s_add_u32 s63, s69, 278528
    buffer_load_dwordx4 v[232:235], v1, s[44:47], s63 offen nt
    s_memrealtime s[8:9]
    s_waitcnt vmcnt(13)
    s_waitcnt lgkmcnt(0)
    s_sub_u32 s8, s8, s30
    s_cmpk_ge_u32 s8, 1948
    s_cbranch_scc1 .ap_92
    s_waitcnt vmcnt(5)
    s_cmpk_ge_u32 s8, 1848
    s_cbranch_scc1 .ap_92
    s_waitcnt vmcnt(3)
    s_bitcmp1_b64 s[14:15], 51
    s_cbranch_scc0 1
    s_waitcnt vmcnt(2)
    s_cmpk_ge_u32 s8, 1728
    s_cbranch_scc1 .ap_92
    s_waitcnt vmcnt(1)
.ap_92:
    s_add_u32 s63, s69, 286720
    buffer_load_dwordx4 v[236:239], v1, s[44:47], s63 offen nt
    s_memrealtime s[8:9]
    s_waitcnt vmcnt(13)
    s_waitcnt lgkmcnt(0)
    s_sub_u32 s8, s8, s30
    s_cmpk_ge_u32 s8, 1980
    s_cbranch_scc1 .ap_93
    s_waitcnt vmcnt(5)
    s_cmpk_ge_u32 s8, 1880
    s_cbranch_scc1 .ap_93
    s_waitcnt vmcnt(3)
    s_bitcmp1_b64 s[14:15], 52
    s_cbranch_scc0 1
    s_waitcnt vmcnt(2)
    s_cmpk_ge_u32 s8, 1760
    s_cbranch_scc1 .ap_93
    s_waitcnt vmcnt(1)
.ap_93:
    s_add_u32 s63, s69, 294912
    buffer_load_dwordx4 v[240:243], v1, s[44:47], s63 offen nt
    s_memrealtime s[8:9]
    s_waitcnt vmcnt(13)
    s_waitcnt lgkmcnt(0)
    s_sub_u32 s8, s8, s30
    s_cmpk_ge_u32 s8, 2012
    s_cbranch_scc1 .ap_94
    s_waitcnt vmcnt(5)
    s_cmpk_ge_u32 s8, 1912
    s_cbranch_scc1 .ap_94
    s_waitcnt vmcnt(3)
    s_bitcmp1_b64 s[14:15], 53
    s_cbranch_scc0 1
    s_waitcnt vmcnt(2)
    s_cmpk_ge_u32 s8, 1792
    s_cbranch_scc1 .ap_94
    s_waitcnt vmcnt(1)
.ap_94:
    s_add_u32 s63, s69, 303104
    buffer_load_dwordx4 v[244:247], v1, s[44:47], s63 offen nt
    s_and_b32 s0, s0, 0xffffff80
    s_sub_u32 s0, s0, 1024
    buffer_load_dword v28, v4, s[36:39], s0 offen sc1
    buffer_load_dwordx4 v[24:27], v9, s[36:39], s59 offen offset:0 sc1
    s_memrealtime s[8:9]
    s_waitcnt vmcnt(9)
    s_waitcnt lgkmcnt(0)
    s_sub_u32 s8, s8, s30
    s_cmpk_ge_u32 s8, 2044
    s_cbranch_scc1 .ap_95
    s_waitcnt vmcnt(6)
    s_cmpk_ge_u32 s8, 1944
    s_cbranch_scc1 .ap_95
    s_waitcnt vmcnt(4)
    s_bitcmp1_b64 s[14:15], 54
    s_cbranch_scc0 1
    s_waitcnt vmcnt(3)
    s_cmpk_ge_u32 s8, 1824
    s_cbranch_scc1 .ap_95
    s_waitcnt vmcnt(2)
.ap_95:
    s_add_u32 s63, s69, 311296
    buffer_load_dwordx4 v[248:251], v1, s[44:47], s63 offen nt
    s_memrealtime s[8:9]
    s_waitcnt vmcnt(9)
    s_waitcnt lgkmcnt(0)
    s_sub_u32 s8, s8, s30
    s_cmpk_ge_u32 s8, 2076
    s_cbranch_scc1 .ap_96
    s_waitcnt vmcnt(6)
    s_cmpk_ge_u32 s8, 1976
    s_cbranch_scc1 .ap_96
    s_waitcnt vmcnt(4)
    s_bitcmp1_b64 s[14:15], 55
    s_cbranch_scc0 1
    s_waitcnt vmcnt(3)
    s_cmpk_ge_u32 s8, 1856
    s_cbranch_scc1 .ap_96
    s_branch .Lsk_m1_4
.Lst_m1_4:
    s_branch .Lrt_m1_4
.Lsk_m1_4:
    s_waitcnt vmcnt(1)
.ap_96:
    s_add_u32 s63, s69, 319488
    buffer_load_dwordx4 v[252:255], v1, s[44:47], s63 offen nt
    s_memrealtime s[8:9]
    s_waitcnt vmcnt(9)
    s_waitcnt lgkmcnt(0)
    s_sub_u32 s8, s8, s30
    s_cmpk_ge_u32 s8, 2108
    s_cbranch_scc1 .ap_97
    s_waitcnt vmcnt(6)
    s_cmpk_ge_u32 s8, 2008
    s_cbranch_scc1 .ap_97
    s_waitcnt vmcnt(4)
    s_bitcmp1_b64 s[14:15], 56
    s_cbranch_scc0 1
    s_waitcnt vmcnt(2)
    s_cmpk_ge_u32 s8, 1888
    s_cbranch_scc1 .ap_97
    s_waitcnt vmcnt(1)
.ap_97:
    s_add_u32 s63, s69, 393216
    buffer_load_dwordx4 v[36:39], v1, s[44:47], s63 offen nt
    s_memrealtime s[8:9]
    s_waitcnt vmcnt(9)
    s_waitcnt lgkmcnt(0)
    s_sub_u32 s8, s8, s30
    s_cmpk_ge_u32 s8, 2140
    s_cbranch_scc1 .ap_98
    s_waitcnt vmcnt(6)
    s_cmpk_ge_u32 s8, 2040
    s_cbranch_scc1 .ap_98
    s_waitcnt vmcnt(3)
    s_bitcmp1_b64 s[14:15], 57
    s_cbranch_scc0 1
    s_waitcnt vmcnt(2)
    s_cmpk_ge_u32 s8, 1920
    s_cbranch_scc1 .ap_98
    s_waitcnt vmcnt(1)
.ap_98:
    s_add_u32 s63, s69, 401408
    buffer_load_dwordx4 v[44:47], v1, s[44:47], s63 offen nt
    s_memrealtime s[8:9]
    s_waitcnt vmcnt(9)
    s_waitcnt lgkmcnt(0)
    s_sub_u32 s8, s8, s30
    s_cmpk_ge_u32 s8, 2172
    s_cbranch_scc1 .ap_99
    s_waitcnt vmcnt(6)
    s_cmpk_ge_u32 s8, 2072
    s_cbranch_scc1 .ap_99
    s_waitcnt vmcnt(3)
    s_bitcmp1_b64 s[14:15], 58
    s_cbranch_scc0 1
    s_waitcnt vmcnt(2)
    s_cmpk_ge_u32 s8, 1952
    s_cbranch_scc1 .ap_99
    s_waitcnt vmcnt(1)
.ap_99:
    s_add_u32 s63, s69, 409600
    buffer_load_dwordx4 v[52:55], v1, s[44:47], s63 offen nt
    s_waitcnt vmcnt(5)
    s_branch .gpc_101
.gp_100:
    buffer_load_dwordx4 v[24:27], v9, s[36:39], s59 offen offset:0 sc1
    s_waitcnt vmcnt(0)
.gpc_101:
    v_cmp_eq_u32 vcc, s34, v26
    s_cmp_eq_u64 vcc, -1
    s_nop 3
    s_cbranch_scc1 .gpd_102
    s_sub_u32 s35, s35, 1
    s_cbranch_scc1 .Lexit
    s_sleep 1
    s_branch .gp_100
.gpd_102:
    v_cmp_eq_u32 vcc, s1, v28
    s_cmp_eq_u64 vcc, -1
    s_cselect_b32 s0, 0x800000, 0
    v_mov_b32 v16, v24
    s_nop 1
    v_max_f32_dpp v16, v16, v16 row_ror:4 row_mask:0xf bank_mask:0xf
    v_sub_f32 v17, v24, v16
    v_sub_f32 v18, v14, v16
    v_mul_f32 v17, 0x3fb8aa3b, v17
    v_mul_f32 v18, 0x3fb8aa3b, v18
    v_exp_f32 v17, v17
    v_exp_f32 v18, v18
    v_mul_f32 v17, v17, v25
    s_nop 1
    v_add_f32_dpp v17, v17, v17 row_ror:4 row_mask:0xf bank_mask:0xf
    v_rcp_f32 v19, v17
    s_nop 0
    v_fma_f32 v15, -v17, v19, 1.0
    v_fma_f32 v19, v15, v19, v19
    v_mul_f32 v18, v18, v19
    v_mul_f32 v10, v10, v18
    v_mul_f32 v11, v11, v18
    v_mul_f32 v12, v12, v18
    v_mul_f32 v13, v13, v18
    v_mov_b32_dpp v112, v10 quad_perm:[2,3,0,1] row_mask:0xf bank_mask:0xf
    v_mov_b32_dpp v113, v11 quad_perm:[2,3,0,1] row_mask:0xf bank_mask:0xf
    v_mov_b32_dpp v114, v12 quad_perm:[2,3,0,1] row_mask:0xf bank_mask:0xf
    v_mov_b32_dpp v115, v13 quad_perm:[2,3,0,1] row_mask:0xf bank_mask:0xf
    v_cvt_pk_bf16_f32 v96, v10, v112
    v_cvt_pk_bf16_f32 v100, v11, v113
    v_cvt_pk_bf16_f32 v104, v12, v114
    v_cvt_pk_bf16_f32 v108, v13, v115
    v_mov_b32_dpp v97, v96 row_ror:12 row_mask:0xf bank_mask:0xf
    v_mov_b32_dpp v101, v100 row_ror:12 row_mask:0xf bank_mask:0xf
    v_mov_b32_dpp v105, v104 row_ror:12 row_mask:0xf bank_mask:0xf
    v_mov_b32_dpp v109, v108 row_ror:12 row_mask:0xf bank_mask:0xf
    v_mov_b32_dpp v98, v96 row_ror:8 row_mask:0xf bank_mask:0xf
    v_mov_b32_dpp v102, v100 row_ror:8 row_mask:0xf bank_mask:0xf
    v_mov_b32_dpp v106, v104 row_ror:8 row_mask:0xf bank_mask:0xf
    v_mov_b32_dpp v110, v108 row_ror:8 row_mask:0xf bank_mask:0xf
    v_mov_b32_dpp v99, v96 row_ror:4 row_mask:0xf bank_mask:0xf
    v_mov_b32_dpp v103, v100 row_ror:4 row_mask:0xf bank_mask:0xf
    v_mov_b32_dpp v107, v104 row_ror:4 row_mask:0xf bank_mask:0xf
    v_mov_b32_dpp v111, v108 row_ror:4 row_mask:0xf bank_mask:0xf
    s_lshl_b32 s60, s3, 10
    s_add_u32 s60, s60, 147456
    v_lshlrev_b32 v10, 5, v0
    v_add_u32 v10, s60, v10
    s_memrealtime s[8:9]
    s_waitcnt lgkmcnt(0)
    s_sub_u32 s8, s8, s30
    s_cmpk_ge_u32 s8, 2204
    s_cbranch_scc1 .ap_103
    s_waitcnt vmcnt(5)
    s_cmpk_ge_u32 s8, 2104
    s_cbranch_scc1 .ap_103
    s_waitcnt vmcnt(3)
    s_bitcmp1_b64 s[14:15], 59
    s_cbranch_scc0 1
    s_waitcnt vmcnt(2)
    s_cmpk_ge_u32 s8, 1984
    s_cbranch_scc1 .ap_103
    s_waitcnt vmcnt(1)
.ap_103:
    s_add_u32 s63, s69, 417792
    buffer_load_dwordx4 v[60:63], v1, s[44:47], s63 offen nt
    v_perm_b32 v112, v164, v160, s94
    v_perm_b32 v113, v172, v168, s94
    v_perm_b32 v114, v180, v176, s94
    v_perm_b32 v115, v188, v184, s94
    s_nop 1
    v_mfma_f32_16x16x32_bf16 v[128:131], v[96:99], v[112:115], 0
    v_perm_b32 v116, v164, v160, s95
    v_perm_b32 v117, v172, v168, s95
    v_perm_b32 v118, v180, v176, s95
    v_perm_b32 v119, v188, v184, s95
    s_nop 1
    v_mfma_f32_16x16x32_bf16 v[132:135], v[96:99], v[116:119], 0
    v_perm_b32 v120, v165, v161, s94
    v_perm_b32 v121, v173, v169, s94
    v_perm_b32 v122, v181, v177, s94
    v_perm_b32 v123, v189, v185, s94
    s_nop 1
    v_mfma_f32_16x16x32_bf16 v[136:139], v[96:99], v[120:123], 0
    v_perm_b32 v124, v165, v161, s95
    v_perm_b32 v125, v173, v169, s95
    v_perm_b32 v126, v181, v177, s95
    v_perm_b32 v127, v189, v185, s95
    s_nop 1
    v_mfma_f32_16x16x32_bf16 v[140:143], v[96:99], v[124:127], 0
    v_perm_b32 v112, v166, v162, s94
    v_perm_b32 v113, v174, v170, s94
    v_perm_b32 v114, v182, v178, s94
    v_perm_b32 v115, v190, v186, s94
    s_nop 1
    v_mfma_f32_16x16x32_bf16 v[144:147], v[96:99], v[112:115], 0
    v_perm_b32 v116, v166, v162, s95
    v_perm_b32 v117, v174, v170, s95
    v_perm_b32 v118, v182, v178, s95
    v_perm_b32 v119, v190, v186, s95
    s_nop 1
    v_mfma_f32_16x16x32_bf16 v[148:151], v[96:99], v[116:119], 0
    v_perm_b32 v120, v167, v163, s94
    v_perm_b32 v121, v175, v171, s94
    v_perm_b32 v122, v183, v179, s94
    v_perm_b32 v123, v191, v187, s94
    s_nop 1
    v_mfma_f32_16x16x32_bf16 v[152:155], v[96:99], v[120:123], 0
    v_perm_b32 v124, v167, v163, s95
    v_perm_b32 v125, v175, v171, s95
    v_perm_b32 v126, v183, v179, s95
    v_perm_b32 v127, v191, v187, s95
    s_nop 1
    v_mfma_f32_16x16x32_bf16 v[156:159], v[96:99], v[124:127], 0
    s_memrealtime s[8:9]
    s_waitcnt lgkmcnt(0)
    s_sub_u32 s8, s8, s30
    s_cmpk_ge_u32 s8, 2236
    s_nop 3
    s_cbranch_scc1 .ap_104
    s_branch .Lsk_m1_5
.Lst_m1_5:
    s_branch .Lrt_m1_5
.Lsk_m1_5:
    s_waitcnt vmcnt(5)
    s_cmpk_ge_u32 s8, 2136
    s_cbranch_scc1 .ap_104
    s_waitcnt vmcnt(3)
    s_bitcmp1_b64 s[14:15], 60
    s_cbranch_scc0 1
    s_waitcnt vmcnt(2)
    s_cmpk_ge_u32 s8, 2016
    s_cbranch_scc1 .ap_104
    s_waitcnt vmcnt(1)
.ap_104:
    s_add_u32 s63, s69, 425984
    buffer_load_dwordx4 v[68:71], v1, s[44:47], s63 offen nt
    v_perm_b32 v112, v196, v192, s94
    v_perm_b32 v113, v204, v200, s94
    v_perm_b32 v114, v212, v208, s94
    v_perm_b32 v115, v220, v216, s94
    s_nop 1
    v_mfma_f32_16x16x32_bf16 v[128:131], v[100:103], v[112:115], v[128:131]
    v_perm_b32 v116, v196, v192, s95
    v_perm_b32 v117, v204, v200, s95
    v_perm_b32 v118, v212, v208, s95
    v_perm_b32 v119, v220, v216, s95
    s_nop 1
    v_mfma_f32_16x16x32_bf16 v[132:135], v[100:103], v[116:119], v[132:135]
    v_perm_b32 v120, v197, v193, s94
    v_perm_b32 v121, v205, v201, s94
    v_perm_b32 v122, v213, v209, s94
    v_perm_b32 v123, v221, v217, s94
    s_nop 1
    v_mfma_f32_16x16x32_bf16 v[136:139], v[100:103], v[120:123], v[136:139]
    v_perm_b32 v124, v197, v193, s95
    v_perm_b32 v125, v205, v201, s95
    v_perm_b32 v126, v213, v209, s95
    v_perm_b32 v127, v221, v217, s95
    s_nop 1
    v_mfma_f32_16x16x32_bf16 v[140:143], v[100:103], v[124:127], v[140:143]
    v_perm_b32 v112, v198, v194, s94
    v_perm_b32 v113, v206, v202, s94
    v_perm_b32 v114, v214, v210, s94
    v_perm_b32 v115, v222, v218, s94
    s_nop 1
    v_mfma_f32_16x16x32_bf16 v[144:147], v[100:103], v[112:115], v[144:147]
    v_perm_b32 v116, v198, v194, s95
    v_perm_b32 v117, v206, v202, s95
    v_perm_b32 v118, v214, v210, s95
    v_perm_b32 v119, v222, v218, s95
    s_nop 1
    v_mfma_f32_16x16x32_bf16 v[148:151], v[100:103], v[116:119], v[148:151]
    v_perm_b32 v120, v199, v195, s94
    v_perm_b32 v121, v207, v203, s94
    v_perm_b32 v122, v215, v211, s94
    v_perm_b32 v123, v223, v219, s94
    s_nop 1
    v_mfma_f32_16x16x32_bf16 v[152:155], v[100:103], v[120:123], v[152:155]
    v_perm_b32 v124, v199, v195, s95
    v_perm_b32 v125, v207, v203, s95
    v_perm_b32 v126, v215, v211, s95
    v_perm_b32 v127, v223, v219, s95
    s_nop 1
    v_mfma_f32_16x16x32_bf16 v[156:159], v[100:103], v[124:127], v[156:159]
    s_memrealtime s[8:9]
    s_waitcnt lgkmcnt(0)
    s_sub_u32 s8, s8, s30
    s_cmpk_ge_u32 s8, 2268
    s_nop 3
    s_cbranch_scc1 .ap_105
    s_waitcnt vmcnt(5)
    s_cmpk_ge_u32 s8, 2168
    s_cbranch_scc1 .ap_105
    s_waitcnt vmcnt(3)
    s_bitcmp1_b64 s[14:15], 61
    s_cbranch_scc0 1
    s_waitcnt vmcnt(2)
    s_cmpk_ge_u32 s8, 2048
    s_cbranch_scc1 .ap_105
    s_waitcnt vmcnt(1)
.ap_105:
    s_add_u32 s63, s69, 434176
    buffer_load_dwordx4 v[76:79], v1, s[44:47], s63 offen nt
    s_waitcnt vmcnt(6)
    v_perm_b32 v112, v228, v224, s94
    v_perm_b32 v113, v236, v232, s94
    v_perm_b32 v114, v244, v240, s94
    v_perm_b32 v115, v252, v248, s94
    s_nop 1
    v_mfma_f32_16x16x32_bf16 v[128:131], v[104:107], v[112:115], v[128:131]
    v_perm_b32 v116, v228, v224, s95
    v_perm_b32 v117, v236, v232, s95
    v_perm_b32 v118, v244, v240, s95
    v_perm_b32 v119, v252, v248, s95
    s_nop 1
    v_mfma_f32_16x16x32_bf16 v[132:135], v[104:107], v[116:119], v[132:135]
    v_perm_b32 v120, v229, v225, s94
    v_perm_b32 v121, v237, v233, s94
    v_perm_b32 v122, v245, v241, s94
    v_perm_b32 v123, v253, v249, s94
    s_nop 1
    v_mfma_f32_16x16x32_bf16 v[136:139], v[104:107], v[120:123], v[136:139]
    v_perm_b32 v124, v229, v225, s95
    v_perm_b32 v125, v237, v233, s95
    v_perm_b32 v126, v245, v241, s95
    v_perm_b32 v127, v253, v249, s95
    s_nop 1
    v_mfma_f32_16x16x32_bf16 v[140:143], v[104:107], v[124:127], v[140:143]
    v_perm_b32 v112, v230, v226, s94
    v_perm_b32 v113, v238, v234, s94
    v_perm_b32 v114, v246, v242, s94
    v_perm_b32 v115, v254, v250, s94
    s_nop 1
    v_mfma_f32_16x16x32_bf16 v[144:147], v[104:107], v[112:115], v[144:147]
    v_perm_b32 v116, v230, v226, s95
    v_perm_b32 v117, v238, v234, s95
    v_perm_b32 v118, v246, v242, s95
    v_perm_b32 v119, v254, v250, s95
    s_nop 1
    v_mfma_f32_16x16x32_bf16 v[148:151], v[104:107], v[116:119], v[148:151]
    v_perm_b32 v120, v231, v227, s94
    v_perm_b32 v121, v239, v235, s94
    v_perm_b32 v122, v247, v243, s94
    v_perm_b32 v123, v255, v251, s94
    s_nop 1
    v_mfma_f32_16x16x32_bf16 v[152:155], v[104:107], v[120:123], v[152:155]
    v_perm_b32 v124, v231, v227, s95
    v_perm_b32 v125, v239, v235, s95
    v_perm_b32 v126, v247, v243, s95
    v_perm_b32 v127, v255, v251, s95
    s_nop 1
    v_mfma_f32_16x16x32_bf16 v[156:159], v[104:107], v[124:127], v[156:159]
    s_memrealtime s[8:9]
    s_waitcnt lgkmcnt(0)
    s_sub_u32 s8, s8, s30
    s_cmpk_ge_u32 s8, 2300
    s_nop 3
    s_cbranch_scc1 .ap_106
    s_waitcnt vmcnt(5)
    s_cmpk_ge_u32 s8, 2200
    s_cbranch_scc1 .ap_106
    s_waitcnt vmcnt(3)
    s_bitcmp1_b64 s[14:15], 62
    s_cbranch_scc0 1
    s_waitcnt vmcnt(2)
    s_cmpk_ge_u32 s8, 2080
    s_cbranch_scc1 .ap_106
    s_waitcnt vmcnt(1)
.ap_106:
    s_add_u32 s63, s69, 442368
    buffer_load_dwordx4 v[84:87], v1, s[44:47], s63 offen nt
    s_memrealtime s[8:9]
    s_waitcnt lgkmcnt(0)
    s_sub_u32 s8, s8, s30
    s_cmpk_ge_u32 s8, 2332
    s_cbranch_scc1 .ap_107
    s_waitcnt vmcnt(5)
    s_cmpk_ge_u32 s8, 2232
    s_cbranch_scc1 .ap_107
    s_waitcnt vmcnt(3)
    s_bitcmp1_b64 s[14:15], 63
    s_cbranch_scc0 1
    s_waitcnt vmcnt(2)
    s_cmpk_ge_u32 s8, 2112
    s_cbranch_scc1 .ap_107
    s_waitcnt vmcnt(1)
.ap_107:
    s_add_u32 s63, s69, 450560
    buffer_load_dwordx4 v[92:95], v1, s[44:47], s63 offen nt
    s_setprio 0
    s_waitcnt vmcnt(6)
    v_perm_b32 v160, v44, v36, s94
    v_perm_b32 v164, v44, v36, s95
    v_perm_b32 v168, v45, v37, s94
    v_perm_b32 v172, v45, v37, s95
    v_perm_b32 v176, v46, v38, s94
    v_perm_b32 v180, v46, v38, s95
    v_perm_b32 v184, v47, v39, s94
    v_perm_b32 v188, v47, v39, s95
    s_branch .Lsk_m1_6
.Lst_m1_6:
    s_branch .Lrt_m1_6
.Lsk_m1_6:
    s_waitcnt vmcnt(4)
    v_perm_b32 v161, v60, v52, s94
    v_perm_b32 v165, v60, v52, s95
    v_perm_b32 v169, v61, v53, s94
    v_perm_b32 v173, v61, v53, s95
    v_perm_b32 v177, v62, v54, s94
    v_perm_b32 v181, v62, v54, s95
    v_perm_b32 v185, v63, v55, s94
    v_perm_b32 v189, v63, v55, s95
    s_waitcnt vmcnt(2)
    v_perm_b32 v162, v76, v68, s94
    v_perm_b32 v166, v76, v68, s95
    v_perm_b32 v170, v77, v69, s94
    v_perm_b32 v174, v77, v69, s95
    v_perm_b32 v178, v78, v70, s94
    v_perm_b32 v182, v78, v70, s95
    v_perm_b32 v186, v79, v71, s94
    v_perm_b32 v190, v79, v71, s95
    s_waitcnt vmcnt(0)
    v_perm_b32 v163, v92, v84, s94
    v_perm_b32 v167, v92, v84, s95
    v_perm_b32 v171, v93, v85, s94
    v_mfma_f32_16x16x32_bf16 v[128:131], v[108:111], v[160:163], v[128:131]
    v_perm_b32 v175, v93, v85, s95
    v_mfma_f32_16x16x32_bf16 v[132:135], v[108:111], v[164:167], v[132:135]
    v_perm_b32 v179, v94, v86, s94
    v_mfma_f32_16x16x32_bf16 v[136:139], v[108:111], v[168:171], v[136:139]
    v_perm_b32 v183, v94, v86, s95
    v_mfma_f32_16x16x32_bf16 v[140:143], v[108:111], v[172:175], v[140:143]
    v_perm_b32 v187, v95, v87, s94
    v_mfma_f32_16x16x32_bf16 v[144:147], v[108:111], v[176:179], v[144:147]
    v_perm_b32 v191, v95, v87, s95
    v_mfma_f32_16x16x32_bf16 v[148:151], v[108:111], v[180:183], v[148:151]
    v_mfma_f32_16x16x32_bf16 v[152:155], v[108:111], v[184:187], v[152:155]
    v_mfma_f32_16x16x32_bf16 v[156:159], v[108:111], v[188:191], v[156:159]
    s_mov_b64 exec, 0xffff
    ds_write2_b32 v10, v128, v129 offset0:0 offset1:128
    ds_write2_b32 v10, v132, v133 offset0:1 offset1:129
    ds_write2_b32 v10, v136, v137 offset0:2 offset1:130
    ds_write2_b32 v10, v140, v141 offset0:3 offset1:131
    ds_write2_b32 v10, v144, v145 offset0:4 offset1:132
    ds_write2_b32 v10, v148, v149 offset0:5 offset1:133
    ds_write2_b32 v10, v152, v153 offset0:6 offset1:134
    ds_write2_b32 v10, v156, v157 offset0:7 offset1:135
    s_mov_b64 exec, -1
    s_waitcnt lgkmcnt(0)
    s_barrier
    s_cmp_lg_u32 s3, 7
    s_cbranch_scc1 .opub_108
    v_add_u32 v10, 147456, v2
    ds_read_b128 v[196:199], v10 offset:0
    ds_read_b128 v[200:203], v10 offset:1024
    ds_read_b128 v[204:207], v10 offset:2048
    ds_read_b128 v[208:211], v10 offset:3072
    ds_read_b128 v[212:215], v10 offset:4096
    ds_read_b128 v[216:219], v10 offset:5120
    ds_read_b128 v[220:223], v10 offset:6144
    ds_read_b128 v[224:227], v10 offset:7168
    v_lshrrev_b32 v11, 5, v0
    v_lshlrev_b32 v11, 13, v11
    v_and_b32 v12, 31, v0
    v_lshl_add_u32 v11, v12, 4, v11
    s_lshl4_add_u32 s56, s67, s66
    s_lshl1_add_u32 s56, s56, s68
    s_lshl_b32 s56, s56, 9
    s_add_u32 s56, s56, 0xa0000
    s_mov_b32 s60, 0x07060503
    s_mov_b32 s61, 0x07060502
    s_mov_b32 s62, 0x07060501
    v_mov_b32 v15, s34
    s_waitcnt lgkmcnt(6)
    v_pk_add_f32 v[196:197], v[196:197], v[200:201]
    v_pk_add_f32 v[198:199], v[198:199], v[202:203]
    s_waitcnt lgkmcnt(5)
    v_pk_add_f32 v[196:197], v[196:197], v[204:205]
    v_pk_add_f32 v[198:199], v[198:199], v[206:207]
    s_waitcnt lgkmcnt(4)
    v_pk_add_f32 v[196:197], v[196:197], v[208:209]
    v_pk_add_f32 v[198:199], v[198:199], v[210:211]
    s_waitcnt lgkmcnt(3)
    v_pk_add_f32 v[196:197], v[196:197], v[212:213]
    v_pk_add_f32 v[198:199], v[198:199], v[214:215]
    s_waitcnt lgkmcnt(2)
    v_pk_add_f32 v[196:197], v[196:197], v[216:217]
    v_pk_add_f32 v[198:199], v[198:199], v[218:219]
    s_waitcnt lgkmcnt(1)
    v_pk_add_f32 v[196:197], v[196:197], v[220:221]
    v_pk_add_f32 v[198:199], v[198:199], v[222:223]
    s_waitcnt lgkmcnt(0)
    v_pk_add_f32 v[196:197], v[196:197], v[224:225]
    v_pk_add_f32 v[198:199], v[198:199], v[226:227]
    v_perm_b32 v12, v196, v199, s60
    v_perm_b32 v13, v197, v199, s61
    v_perm_b32 v14, v198, v199, s62
    s_add_u32 s57, s56, 0x800000
    buffer_store_dwordx4 v[12:15], v11, s[36:39], s57 offen
    s_cmp_lg_u32 s0, 0
    s_nop 0
    s_cbranch_scc1 .nosl_109
    buffer_store_dwordx4 v[12:15], v11, s[36:39], s56 offen sc1
.nosl_109:
.opub_108:
    s_and_b32 s58, s64, 0
    s_mul_i32 s58, s58, 18432
    s_mul_i32 s59, s3, 2304
    s_add_u32 s58, s58, s59
    s_add_u32 s62, s58, 0x37000
    s_add_u32 s63, s58, 0x49000
    s_mul_i32 s101, s64, 18432
    s_add_u32 s101, s101, s59
    s_add_u32 s101, s101, 0x170000
    s_lshl_b32 s56, s65, 8
    s_add_u32 s58, s58, s56
    s_add_u32 s58, s58, 0x25000
    s_add_u32 s99, s101, s56
    s_lshr_b32 s56, s64, 1
    s_and_b32 s57, s3, 3
    s_cmp_lg_u32 s56, s57
    s_cbranch_scc1 .Lr_ga
    s_add_u32 s59, s58, 73728
    s_add_u32 s60, s58, 147456
    s_add_u32 s61, s58, 221184
.gp_110:
    buffer_load_dwordx4 v[56:59], v2, s[36:39], s62 offen offset:0 sc1
    buffer_load_dwordx4 v[60:63], v2, s[36:39], s62 offen offset:1024 sc1
    buffer_load_dwordx2 v[64:65], v5, s[36:39], s62 offen offset:0 sc1
    buffer_load_dwordx4 v[66:69], v2, s[36:39], s63 offen offset:0 sc1
    buffer_load_dwordx4 v[70:73], v2, s[36:39], s63 offen offset:1024 sc1
    buffer_load_dwordx2 v[74:75], v5, s[36:39], s63 offen offset:0 sc1
    buffer_load_dwordx2 v[76:77], v8, s[36:39], s59 offen offset:0 sc1
    buffer_load_dwordx2 v[78:79], v8, s[36:39], s60 offen offset:0 sc1
    buffer_load_dwordx2 v[80:81], v8, s[36:39], s61 offen offset:0 sc1
    buffer_load_dwordx2 v[42:43], v8, s[36:39], s58 offen offset:0 sc1
    s_waitcnt vmcnt(0)
.gpc_111:
    v_min_u32 v24, v57, v59
    v_max_u32 v25, v57, v59
    v_min3_u32 v24, v24, v61, v63
    v_max3_u32 v25, v25, v61, v63
    v_min3_u32 v24, v24, v65, v67
    v_max3_u32 v25, v25, v65, v67
    v_min3_u32 v24, v24, v69, v71
    v_max3_u32 v25, v25, v69, v71
    v_min3_u32 v24, v24, v73, v75
    v_max3_u32 v25, v25, v73, v75
    v_min3_u32 v24, v24, v77, v79
    v_max3_u32 v25, v25, v77, v79
    v_min3_u32 v24, v24, v81, v43
    v_max3_u32 v25, v25, v81, v43
    v_cmp_eq_u32 vcc, s34, v24
    v_cmp_eq_u32 s[56:57], s34, v25
    s_and_b64 vcc, vcc, s[56:57]
    s_cmp_eq_u64 vcc, -1
    s_nop 2
    s_cbranch_scc1 .gpd_112
    s_sub_u32 s35, s35, 1
    s_cbranch_scc1 .Lexit
    s_sleep 2
    s_branch .gp_110
.gpd_112:
    v_and_b32 v57, 0xffff0000, v56
    s_branch .Lsk_m1_7
.Lst_m1_7:
    s_branch .Lrt_m1_7
.Lsk_m1_7:
    v_lshlrev_b32 v56, 16, v56
    v_and_b32 v67, 0xffff0000, v66
    v_lshlrev_b32 v66, 16, v66
    v_and_b32 v59, 0xffff0000, v58
    v_lshlrev_b32 v58, 16, v58
    v_and_b32 v69, 0xffff0000, v68
    v_lshlrev_b32 v68, 16, v68
    v_and_b32 v61, 0xffff0000, v60
    v_lshlrev_b32 v60, 16, v60
    v_and_b32 v71, 0xffff0000, v70
    v_lshlrev_b32 v70, 16, v70
    v_and_b32 v63, 0xffff0000, v62
    v_lshlrev_b32 v62, 16, v62
    v_and_b32 v73, 0xffff0000, v72
    v_lshlrev_b32 v72, 16, v72
    v_and_b32 v65, 0xffff0000, v64
    v_lshlrev_b32 v64, 16, v64
    v_and_b32 v75, 0xffff0000, v74
    v_lshlrev_b32 v74, 16, v74
    v_lshlrev_b32 v77, 16, v76
    v_and_b32 v76, 0xffff0000, v76
    s_mov_b32 vcc_lo, 0xffff0000
    s_mov_b32 vcc_hi, 0xffff0000
    v_cndmask_b32 v77, v77, v76, vcc
    v_lshlrev_b32 v79, 16, v78
    v_and_b32 v78, 0xffff0000, v78
    s_mov_b32 vcc_lo, 0xffff0000
    s_mov_b32 vcc_hi, 0xffff0000
    v_cndmask_b32 v79, v79, v78, vcc
    v_lshlrev_b32 v81, 16, v80
    v_and_b32 v80, 0xffff0000, v80
    s_mov_b32 vcc_lo, 0xffff0000
    s_mov_b32 vcc_hi, 0xffff0000
    v_cndmask_b32 v81, v81, v80, vcc
    s_nop 1
    s_branch .Lr_ga2
.Lr_ga:
.gp_113:
    buffer_load_dwordx2 v[42:43], v8, s[36:39], s58 offen offset:0 sc1
    s_waitcnt vmcnt(0)
.gpc_114:
    v_cmp_eq_u32 vcc, s34, v43
    s_cmp_eq_u64 vcc, -1
    s_nop 3
    s_cbranch_scc1 .gpd_115
    s_sub_u32 s35, s35, 1
    s_cbranch_scc1 .Lexit
    s_sleep 2
    s_branch .gp_113
.gpd_115:
.Lr_ga2:
    v_lshlrev_b32 v40, 16, v40
    v_lshlrev_b32 v41, 16, v42
    v_and_b32 v42, 0xffff0000, v42
    s_mov_b32 vcc_lo, 0xffff0000
    s_mov_b32 vcc_hi, 0xffff0000
    v_cndmask_b32 v41, v41, v42, vcc
    s_mul_i32 s59, s3, 9
    s_add_u32 s59, s59, s65
    s_lshl_b32 s59, s59, 12
    s_add_u32 s59, s59, 0xe0000
    s_mov_b32 s60, 0x04000c0c
    s_mov_b32 s61, 0x0706000c
    v_mov_b32 v45, s34
    v_mov_b32 v47, s34
.gp_116:
    buffer_load_dwordx4 v[16:19], v2, s[36:39], s59 offen offset:0 sc1
    buffer_load_dwordx4 v[20:23], v2, s[36:39], s59 offen offset:1024 sc1
    buffer_load_dwordx4 v[24:27], v2, s[36:39], s59 offen offset:2048 sc1
    buffer_load_dwordx4 v[28:31], v2, s[36:39], s59 offen offset:3072 sc1
    s_waitcnt vmcnt(0)
.gpc_117:
    v_min_u32 v32, v19, v23
    v_max_u32 v33, v19, v23
    v_min3_u32 v32, v32, v27, v31
    v_max3_u32 v33, v33, v27, v31
    v_cmp_eq_u32 vcc, s34, v32
    v_cmp_eq_u32 s[56:57], s34, v33
    s_and_b64 vcc, vcc, s[56:57]
    s_cmp_eq_u64 vcc, -1
    s_nop 2
    s_cbranch_scc1 .gpd_118
    s_sub_u32 s35, s35, 1
    s_cbranch_scc1 .Lexit
    s_branch .gp_116
.gpd_118:
    v_perm_b32 v19, v16, v17, s60
    v_perm_b32 v19, v19, v18, s61
    v_perm_b32 v23, v20, v21, s60
    v_perm_b32 v23, v23, v22, s61
    v_perm_b32 v27, v24, v25, s60
    v_perm_b32 v27, v27, v26, s61
    v_perm_b32 v31, v28, v29, s60
    v_perm_b32 v31, v31, v30, s61
    v_pk_add_f32 v[16:17], v[16:17], v[20:21]
    v_pk_add_f32 v[18:19], v[18:19], v[22:23]
    v_pk_add_f32 v[24:25], v[24:25], v[28:29]
    v_pk_add_f32 v[26:27], v[26:27], v[30:31]
    v_pk_add_f32 v[16:17], v[16:17], v[24:25]
    v_pk_add_f32 v[18:19], v[18:19], v[26:27]
    s_nop 1
    v_permlane32_swap_b32 v16, v18
    v_permlane32_swap_b32 v17, v19
    v_pk_add_f32 v[16:17], v[16:17], v[18:19]
    s_nop 1
    v_permlane16_swap_b32 v16, v17
    v_add_f32 v16, v16, v17
    v_cvt_pk_bf16_f32 v16, v16, v16
    v_lshlrev_b32 v16, 16, v16
    v_mul_f32 v16, v16, v41
    v_cvt_pk_bf16_f32 v16, v16, v16
    v_lshlrev_b32 v16, 16, v16
    v_add_f32 v17, v16, v40
    v_add_f32 v16, v16, v40
    v_mov_b32 v40, v16
    s_nop 0
    v_permlane16_swap_b32 v16, v17
    v_cvt_pk_bf16_f32 v44, v16, v17
    s_mov_b32 exec_lo, 0xffff
    s_mov_b32 exec_hi, 0xffff
    s_add_u32 s57, s99, 0x800000
    buffer_store_dwordx2 v[44:45], v8, s[36:39], s57 offen
    s_cmp_lg_u32 s0, 0
    s_cbranch_scc1 .nosl_119
    buffer_store_dwordx2 v[44:45], v8, s[36:39], s99 offen sc1
.nosl_119:
    s_mov_b64 exec, -1
    s_lshr_b32 s56, s64, 1
    s_and_b32 s57, s3, 3
    s_cmp_lg_u32 s56, s57
    s_cbranch_scc1 .Lexit
    v_cvt_pk_bf16_f32 v40, v40, v40
    v_lshlrev_b32 v40, 16, v40
    s_mov_b32 s69, 0
.gp_120:
    s_add_u32 s69, s69, 1
    s_and_b32 s56, s69, 0x41
    s_cmp_lg_u32 s56, 0x41
    s_cselect_b32 s56, 0, 0x800000
    s_xor_b32 s56, s56, s0
    s_add_u32 s58, s101, s56
    buffer_load_dwordx4 v[84:87], v2, s[36:39], s58 offen offset:0 sc1
    buffer_load_dwordx4 v[88:91], v2, s[36:39], s58 offen offset:1024 sc1
    buffer_load_dwordx2 v[92:93], v5, s[36:39], s58 offen offset:0 sc1
    s_waitcnt vmcnt(0)
    v_min3_u32 v24, v85, v87, v89
    v_max3_u32 v25, v85, v87, v89
    v_min3_u32 v24, v24, v91, v93
    v_max3_u32 v25, v25, v91, v93
    v_cmp_eq_u32 vcc, s34, v24
    s_branch .Lsk_m2_0
.Lst_m2_0:
    s_branch .Lrt_m2_0
.Lsk_m2_0:
    v_cmp_eq_u32 s[56:57], s34, v25
    s_and_b64 vcc, vcc, s[56:57]
    s_cmp_eq_u64 vcc, -1
    s_nop 2
    s_cbranch_scc1 .gpd_121
    s_sub_u32 s35, s35, 1
    s_cbranch_scc1 .Lexit
    s_sleep 1
    s_branch .gp_120
.gpd_121:
    s_mov_b32 s56, 0x3f803f80
    v_dot2_f32_bf16 v104, v84, s56, 0
    v_dot2_f32_bf16 v105, v84, v84, 0
    v_dot2_f32_bf16 v104, v86, s56, v104
    v_dot2_f32_bf16 v105, v86, v86, v105
    v_dot2_f32_bf16 v104, v88, s56, v104
    v_dot2_f32_bf16 v105, v88, v88, v105
    v_dot2_f32_bf16 v104, v90, s56, v104
    v_dot2_f32_bf16 v105, v90, v90, v105
    s_mov_b64 exec, 0xffffffff
    v_dot2_f32_bf16 v104, v92, s56, v104
    v_dot2_f32_bf16 v105, v92, v92, v105
    s_mov_b64 exec, -1
    s_nop 1
    v_permlane32_swap_b32 v104, v105
    v_add_f32 v104, v104, v105
    v_mov_b32 v106, v104
    s_nop 1
    v_permlane16_swap_b32 v106, v104
    v_add_f32 v104, v106, v104
    v_and_b32 v95, 0xffff0000, v84
    v_lshlrev_b32 v94, 16, v84
    v_add_f32_dpp v104, v104, v104 row_ror:8 row_mask:0xf bank_mask:0xf
    v_and_b32 v97, 0xffff0000, v86
    v_lshlrev_b32 v96, 16, v86
    v_add_f32_dpp v104, v104, v104 row_ror:4 row_mask:0xf bank_mask:0xf
    v_and_b32 v99, 0xffff0000, v88
    v_lshlrev_b32 v98, 16, v88
    v_add_f32_dpp v104, v104, v104 quad_perm:[2,3,0,1] row_mask:0xf bank_mask:0xf
    v_and_b32 v101, 0xffff0000, v90
    v_lshlrev_b32 v100, 16, v90
    v_add_f32_dpp v104, v104, v104 quad_perm:[1,0,3,2] row_mask:0xf bank_mask:0xf
    v_mul_f32 v104, 0x3ae38e39, v104
    v_and_b32 v103, 0xffff0000, v92
    v_lshlrev_b32 v102, 16, v92
    v_readlane_b32 s56, v104, 0
    v_readlane_b32 s57, v104, 32
    s_nop 0
    v_mov_b32 v104, s56
    v_fma_f32 v105, -v104, v104, s57
    v_max_f32 v105, 0, v105
    v_cvt_pk_bf16_f32 v106, -v104, v105
    v_and_b32 v107, 0xffff0000, v106
    v_add_f32 v107, 0x3727c5ac, v107
    v_lshlrev_b32 v104, 16, v106
    v_cvt_pk_bf16_f32 v107, v107, v107
    v_lshlrev_b32 v107, 16, v107
    v_sqrt_f32 v107, v107
    v_mov_b32 v105, v104
    v_cvt_pk_bf16_f32 v107, v107, v107
    v_lshlrev_b32 v107, 16, v107
    v_rcp_f32 v106, v107
    v_rcp_f32 v107, v107
    v_pk_add_f32 v[94:95], v[94:95], v[104:105]
    v_pk_add_f32 v[96:97], v[96:97], v[104:105]
    v_pk_add_f32 v[98:99], v[98:99], v[104:105]
    v_pk_add_f32 v[100:101], v[100:101], v[104:105]
    v_pk_add_f32 v[102:103], v[102:103], v[104:105]
    v_cvt_pk_bf16_f32 v94, v94, v95
    v_and_b32 v95, 0xffff0000, v94
    v_lshlrev_b32 v94, 16, v94
    v_cvt_pk_bf16_f32 v96, v96, v97
    v_and_b32 v97, 0xffff0000, v96
    v_lshlrev_b32 v96, 16, v96
    v_cvt_pk_bf16_f32 v98, v98, v99
    v_and_b32 v99, 0xffff0000, v98
    v_lshlrev_b32 v98, 16, v98
    v_cvt_pk_bf16_f32 v100, v100, v101
    v_and_b32 v101, 0xffff0000, v100
    v_lshlrev_b32 v100, 16, v100
    v_cvt_pk_bf16_f32 v102, v102, v103
    v_and_b32 v103, 0xffff0000, v102
    v_lshlrev_b32 v102, 16, v102
    v_pk_mul_f32 v[94:95], v[94:95], v[106:107]
    v_pk_mul_f32 v[96:97], v[96:97], v[106:107]
    v_pk_mul_f32 v[98:99], v[98:99], v[106:107]
    v_pk_mul_f32 v[100:101], v[100:101], v[106:107]
    v_pk_mul_f32 v[102:103], v[102:103], v[106:107]
    v_cvt_pk_bf16_f32 v94, v94, v95
    v_and_b32 v95, 0xffff0000, v94
    v_lshlrev_b32 v94, 16, v94
    v_cvt_pk_bf16_f32 v96, v96, v97
    v_and_b32 v97, 0xffff0000, v96
    v_lshlrev_b32 v96, 16, v96
    v_cvt_pk_bf16_f32 v98, v98, v99
    v_and_b32 v99, 0xffff0000, v98
    v_lshlrev_b32 v98, 16, v98
    v_cvt_pk_bf16_f32 v100, v100, v101
    v_and_b32 v101, 0xffff0000, v100
    v_lshlrev_b32 v100, 16, v100
    v_cvt_pk_bf16_f32 v102, v102, v103
    v_and_b32 v103, 0xffff0000, v102
    v_lshlrev_b32 v102, 16, v102
    v_pk_mul_f32 v[94:95], v[94:95], v[66:67]
    v_pk_mul_f32 v[96:97], v[96:97], v[68:69]
    v_pk_mul_f32 v[98:99], v[98:99], v[70:71]
    v_pk_mul_f32 v[100:101], v[100:101], v[72:73]
    v_pk_mul_f32 v[102:103], v[102:103], v[74:75]
    v_cvt_pk_bf16_f32 v94, v94, v95
    v_and_b32 v95, 0xffff0000, v94
    v_lshlrev_b32 v94, 16, v94
    v_cvt_pk_bf16_f32 v96, v96, v97
    v_and_b32 v97, 0xffff0000, v96
    v_lshlrev_b32 v96, 16, v96
    v_cvt_pk_bf16_f32 v98, v98, v99
    v_and_b32 v99, 0xffff0000, v98
    v_lshlrev_b32 v98, 16, v98
    v_cvt_pk_bf16_f32 v100, v100, v101
    v_and_b32 v101, 0xffff0000, v100
    v_lshlrev_b32 v100, 16, v100
    v_cvt_pk_bf16_f32 v102, v102, v103
    v_and_b32 v103, 0xffff0000, v102
    v_lshlrev_b32 v102, 16, v102
    v_pk_add_f32 v[94:95], v[94:95], v[56:57]
    v_pk_add_f32 v[96:97], v[96:97], v[58:59]
    v_pk_add_f32 v[98:99], v[98:99], v[60:61]
    v_pk_add_f32 v[100:101], v[100:101], v[62:63]
    v_pk_add_f32 v[102:103], v[102:103], v[64:65]
    v_cvt_pk_bf16_f32 v110, v94, v95
    v_cvt_pk_bf16_f32 v111, v96, v97
    v_cvt_pk_bf16_f32 v112, v98, v99
    v_cvt_pk_bf16_f32 v113, v100, v101
    v_cvt_pk_bf16_f32 v114, v102, v103
    v_dot2_f32_bf16 v14, v110, v48, 0
    v_dot2_f32_bf16 v14, v111, v49, v14
    v_dot2_f32_bf16 v14, v112, v50, v14
    v_dot2_f32_bf16 v14, v113, v51, v14
    s_mov_b64 exec, 0xffffffff
    v_dot2_f32_bf16 v14, v114, v34, v14
    s_mov_b64 exec, -1
    s_nop 1
    v_mov_b32 v15, v14
    s_nop 1
    v_permlane32_swap_b32 v15, v14
    v_add_f32 v14, v15, v14
    v_mov_b32 v15, v14
    s_nop 1
    v_permlane16_swap_b32 v15, v14
    v_add_f32 v14, v15, v14
    s_nop 1
    v_add_f32_dpp v14, v14, v14 row_ror:8 row_mask:0xf bank_mask:0xf
    s_nop 1
    v_add_f32_dpp v14, v14, v14 row_ror:4 row_mask:0xf bank_mask:0xf
    s_nop 1
    v_add_f32_dpp v14, v14, v14 quad_perm:[2,3,0,1] row_mask:0xf bank_mask:0xf
    s_nop 1
    v_add_f32_dpp v14, v14, v14 quad_perm:[1,0,3,2] row_mask:0xf bank_mask:0xf
    v_cvt_pk_bf16_f32 v14, v14, v14
    v_lshlrev_b32 v14, 16, v14
    v_max_f32 v14, 0xc2ae0000, v14
    v_min_f32 v14, 0x43000000, v14
    v_mul_f32 v15, 0xbfb8aa3b, v14
    v_fma_f32 v16, v14, s98, -v15
    v_fmac_f32 v16, 0xb2a57060, v14
    v_exp_f32 v15, v15
    v_mul_f32 v16, 0x3f317218, v16
    v_fmac_f32 v15, v15, v16
    v_add_f32 v15, 1.0, v15
    s_branch .Lsk_m2_1
.Lst_m2_1:
    s_branch .Lrt_m2_1
.Lsk_m2_1:
    v_rcp_f32 v16, v15
    s_nop 0
    v_fma_f32 v15, -v15, v16, 1.0
    v_fma_f32 v14, v15, v16, v16
    v_cvt_pk_bf16_f32 v14, v14, v14
    v_lshlrev_b32 v14, 16, v14
    v_add_f32 v41, v40, v104
    v_cvt_pk_bf16_f32 v41, v41, v41
    v_lshlrev_b32 v41, 16, v41
    v_mul_f32 v41, v41, v106
    v_cvt_pk_bf16_f32 v41, v41, v41
    v_lshlrev_b32 v41, 16, v41
    v_mul_f32 v41, v41, v79
    v_cvt_pk_bf16_f32 v41, v41, v41
    v_lshlrev_b32 v41, 16, v41
    v_add_f32 v41, v41, v77
    v_cvt_pk_bf16_f32 v41, v41, v41
    v_lshlrev_b32 v41, 16, v41
    s_and_b32 s62, s64, 1
    s_lshl1_add_u32 s58, s65, s62
    s_lshl3_add_u32 s58, s58, s3
    s_mul_i32 s58, s58, 9216
    s_add_u32 s58, s58, 0x1a0000
    s_add_u32 s59, s58, 4096
    s_add_u32 s63, s58, 8192
    s_cmp_eq_u32 s62, 0
    s_mov_b32 s56, 0x00ff00ff
    s_cselect_b32 s62, s56, 0xff00ff00
    s_mov_b32 s60, 0x04000c0c
    s_mov_b32 s61, 0x0706000c
    s_mov_b32 s48, s28
    s_and_b32 s49, s29, 0xffff
    s_mov_b32 s50, 0x2400
    s_mov_b32 s51, 0x00020000
.gp_122:
    buffer_load_dwordx4 v[120:123], v2, s[36:39], s58 offen offset:0 sc1
    buffer_load_dwordx4 v[124:127], v2, s[36:39], s58 offen offset:1024 sc1
    buffer_load_dwordx4 v[128:131], v2, s[36:39], s58 offen offset:2048 sc1
    buffer_load_dwordx4 v[132:135], v2, s[36:39], s58 offen offset:3072 sc1
    buffer_load_dwordx4 v[136:139], v2, s[36:39], s59 offen offset:0 sc1
    buffer_load_dwordx4 v[140:143], v2, s[36:39], s59 offen offset:1024 sc1
    buffer_load_dwordx4 v[144:147], v2, s[36:39], s59 offen offset:2048 sc1
    buffer_load_dwordx4 v[148:151], v2, s[36:39], s59 offen offset:3072 sc1
    buffer_load_dwordx4 v[152:155], v2, s[36:39], s63 offen offset:0 sc1
    s_waitcnt vmcnt(0)
.gpc_123:
    v_min3_u32 v24, v123, v127, v131
    v_max3_u32 v25, v123, v127, v131
    v_min3_u32 v24, v24, v135, v139
    v_max3_u32 v25, v25, v135, v139
    v_min3_u32 v24, v24, v143, v147
    v_max3_u32 v25, v25, v143, v147
    v_min3_u32 v24, v24, v151, v155
    v_max3_u32 v25, v25, v151, v155
    v_cmp_eq_u32 vcc, s34, v24
    v_cmp_eq_u32 s[56:57], s34, v25
    s_and_b64 vcc, vcc, s[56:57]
    s_cmp_eq_u64 vcc, -1
    s_nop 2
    s_cbranch_scc1 .gpd_124
    s_sub_u32 s35, s35, 1
    s_cbranch_scc1 .Lexit
    s_branch .gp_122
.gpd_124:
    v_perm_b32 v123, v120, v121, s60
    v_perm_b32 v123, v123, v122, s61
    v_perm_b32 v127, v124, v125, s60
    v_perm_b32 v127, v127, v126, s61
    v_perm_b32 v131, v128, v129, s60
    v_perm_b32 v131, v131, v130, s61
    v_perm_b32 v135, v132, v133, s60
    v_perm_b32 v135, v135, v134, s61
    v_perm_b32 v139, v136, v137, s60
    v_perm_b32 v139, v139, v138, s61
    v_perm_b32 v143, v140, v141, s60
    v_perm_b32 v143, v143, v142, s61
    v_perm_b32 v147, v144, v145, s60
    v_perm_b32 v147, v147, v146, s61
    v_perm_b32 v151, v148, v149, s60
    v_perm_b32 v151, v151, v150, s61
    v_perm_b32 v155, v152, v153, s60
    v_perm_b32 v155, v155, v154, s61
    v_pk_add_f32 v[120:121], v[120:121], v[124:125]
    v_pk_add_f32 v[122:123], v[122:123], v[126:127]
    v_pk_add_f32 v[128:129], v[128:129], v[132:133]
    v_pk_add_f32 v[130:131], v[130:131], v[134:135]
    v_pk_add_f32 v[136:137], v[136:137], v[140:141]
    v_pk_add_f32 v[138:139], v[138:139], v[142:143]
    v_pk_add_f32 v[144:145], v[144:145], v[148:149]
    v_pk_add_f32 v[146:147], v[146:147], v[150:151]
    v_pk_add_f32 v[120:121], v[120:121], v[128:129]
    v_pk_add_f32 v[122:123], v[122:123], v[130:131]
    v_pk_add_f32 v[136:137], v[136:137], v[144:145]
    v_pk_add_f32 v[138:139], v[138:139], v[146:147]
    v_pk_add_f32 v[120:121], v[120:121], v[136:137]
    v_pk_add_f32 v[122:123], v[122:123], v[138:139]
    v_pk_add_f32 v[120:121], v[120:121], v[152:153]
    v_pk_add_f32 v[122:123], v[122:123], v[154:155]
    s_nop 1
    v_permlane32_swap_b32 v120, v122
    v_permlane32_swap_b32 v121, v123
    v_pk_add_f32 v[120:121], v[120:121], v[122:123]
    s_nop 1
    v_permlane16_swap_b32 v120, v121
    v_add_f32 v120, v120, v121
    s_nop 1
    v_add_f32_dpp v120, v120, v120 row_ror:8 row_mask:0xf bank_mask:0xf
    v_cvt_pk_bf16_f32 v120, v120, v120
    v_lshlrev_b32 v120, 16, v120
    v_mul_f32 v120, v120, v14
    v_cvt_pk_bf16_f32 v120, v120, v120
    v_lshlrev_b32 v120, 16, v120
    v_add_f32 v120, v120, v41
    v_cvt_pk_bf16_f32 v120, v120, v120
    v_lshlrev_b32 v120, 16, v120
    v_mul_f32 v120, v120, v81
    v_cvt_pk_bf16_f32 v120, v120, v120
    v_lshlrev_b32 v120, 16, v120
    v_add_f32 v120, v120, v40
    v_cvt_pk_bf16_f32 v120, v120, v120
    s_mov_b32 exec_lo, s62
    s_mov_b32 exec_hi, s62
    buffer_store_short v120, v7, s[48:51], s100 offen
    s_mov_b64 exec, -1
    s_or_b32 s56, s2, s3
    s_cmp_lg_u32 s56, 0
    s_cbranch_scc1 .Lexit
    v_mov_b32 v13, s34
    v_mov_b32 v12, 0
    s_mov_b64 exec, 1
    buffer_store_dword v13, v12, s[36:39], 0 offen
    s_mov_b64 exec, -1
    s_branch .Lexit
.Lbc:
    s_branch .Lsk_b0_0
.Lst_b0_0:
    s_branch .Lrt_b0_0
.Lsk_b0_0:
    s_sub_u32 s56, s65, 9
    s_mov_b32 s57, 0x63054210
    s_cmp_eq_u32 s65, 14
    s_cselect_b32 s56, s64, s56
    s_cselect_b32 s57, 0x37654210, s57
    s_cselect_b32 s99, 8, s64
    s_lshl_b32 s56, s56, 2
    s_lshr_b32 s56, s57, s56
    s_and_b32 s56, s56, 7
    s_cmp_eq_u32 s65, 17
    s_cselect_b32 s56, 7, s56
    s_lshl3_add_u32 s99, s99, s56
    s_and_b32 s56, s99, 7
    s_cmp_eq_u32 s56, 3
    s_mov_b32 s14, 0xb5b5b5b5
    s_cselect_b32 s14, 0x0, s14
    s_mov_b32 s15, 0xd6d6b6b6
    s_cselect_b32 s15, 0x0, s15
    s_cselect_b32 s30, -50, 0
    s_add_u32 s30, s30, 0
    s_add_u32 s30, s30, s70
    s_mov_b32 s31, s70
    s_mov_b32 s48, s18
    s_and_b32 s49, s19, 0xffff
    s_mov_b32 s50, 0x510000
    s_mov_b32 s51, 0x00020000
    s_mov_b32 s52, s20
    s_and_b32 s53, s21, 0xffff
    s_mov_b32 s54, 0x510000
    s_mov_b32 s55, 0x00020000
    v_bfe_u32 v12, v0, 4, 1
    s_and_b32 s56, s3, 3
    s_lshl_b32 s56, s56, 1
    v_or_b32 v12, s56, v12
    v_and_b32 v6, 7, v0
    v_xor_b32 v12, v12, v6
    v_lshrrev_b32 v6, 3, v0
    v_mul_u32_u24 v6, 9216, v6
    v_lshl_add_u32 v6, v12, 4, v6
    s_mul_i32 s100, s3, 73728
    s_lshl_b32 s56, s99, 7
    s_add_u32 s100, s100, s56
    s_lshl_b32 s101, s3, 10
    s_waitcnt lgkmcnt(0)
    s_add_u32 s34, s34, 1
    s_getreg_b32 s1, hwreg(HW_REG_XCC_ID)
    s_lshl_b32 s1, s1, 24
    s_add_u32 s1, s1, s34
    s_lshr_b32 s0, s2, 3
    s_lshl_b32 s63, s64, 8
    s_add_u32 s0, s0, s63
    s_lshl2_add_u32 s0, s0, 0x480000
    v_mov_b32 v30, s1
    s_cmp_eq_u32 s3, 0
    s_cselect_b64 exec, 1, 0
    buffer_store_dword v30, v2, s[36:39], s0 offen sc1
    s_mov_b64 exec, -1
    v_and_b32 v8, 1, v0
    v_lshlrev_b32 v8, 8, v8
    v_and_b32 v9, 0x3c, v0
    v_lshl_add_u32 v9, v9, 2, v8
    v_add_u32 v7, v9, v8
    v_and_b32 v9, 0x3c, v0
    v_lshrrev_b32 v8, 4, v8
    v_and_b32 v9, 4, v0
    v_lshl_add_u32 v9, v9, 3, v8
    s_lshl_b32 s58, s66, 14
    s_lshl_b32 s59, s67, 10
    s_add_u32 s58, s58, s59
    s_add_u32 s58, s58, 0x70000
    s_lshl4_add_u32 s59, s66, s67
    s_lshl_b32 s59, s59, 7
    s_add_u32 s59, s59, 0x430000
    s_bitcmp1_b64 s[14:15], 4
    s_cbranch_scc0 1
    s_waitcnt vmcnt(4)
    s_add_u32 s63, s69, 32768
    buffer_load_dwordx4 v[96:99], v1, s[40:43], s63 offen nt
    s_waitcnt vmcnt(6)
    s_add_u32 m0, s101, 0
    s_add_u32 s56, s100, 0
    buffer_load_dwordx4 v6, s[48:51], s56 offen nt lds
    s_waitcnt vmcnt(6)
    s_bitcmp1_b64 s[14:15], 5
    s_cbranch_scc0 1
    s_waitcnt vmcnt(4)
    s_add_u32 s63, s69, 40960
    buffer_load_dwordx4 v[100:103], v1, s[40:43], s63 offen nt
    s_waitcnt vmcnt(6)
    s_bitcmp1_b64 s[14:15], 6
    s_cbranch_scc0 1
    s_waitcnt vmcnt(2)
    s_add_u32 s63, s69, 49152
    buffer_load_dwordx4 v[128:131], v1, s[40:43], s63 offen nt
    s_cmp_eq_u32 s3, 0
    s_cbranch_scc1 .Lst_b1_0
    s_cmp_eq_u32 s3, 1
    s_cbranch_scc1 .Lst_b1_1
    s_cmp_eq_u32 s3, 2
    s_cbranch_scc1 .Lst_b1_2
    s_cmp_eq_u32 s3, 3
    s_cbranch_scc1 .Lst_b1_3
    s_cmp_eq_u32 s3, 4
    s_cbranch_scc1 .Lst_b1_4
    s_cmp_eq_u32 s3, 5
    s_cbranch_scc1 .Lst_b1_5
    s_cmp_eq_u32 s3, 6
    s_cbranch_scc1 .Lst_b1_6
    s_cmp_eq_u32 s3, 7
    s_cbranch_scc1 .Lst_b1_7
.Lrt_b1_0:
.Lrt_b1_1:
.Lrt_b1_2:
.Lrt_b1_3:
.Lrt_b1_4:
.Lrt_b1_5:
.Lrt_b1_6:
.Lrt_b1_7:
    s_waitcnt vmcnt(6)
    s_add_u32 m0, s101, 8192
    s_add_u32 s56, s100, 589824
    buffer_load_dwordx4 v6, s[48:51], s56 offen nt lds
    s_waitcnt vmcnt(4)
    s_bitcmp1_b64 s[14:15], 7
    s_cbranch_scc0 1
    s_waitcnt vmcnt(2)
    s_add_u32 s63, s69, 57344
    buffer_load_dwordx4 v[132:135], v1, s[40:43], s63 offen nt
    s_waitcnt vmcnt(4)
    s_bitcmp1_b64 s[14:15], 8
    s_cbranch_scc0 1
    s_waitcnt vmcnt(2)
    s_add_u32 s63, s69, 131072
    buffer_load_dwordx4 v[40:43], v1, s[40:43], s63 offen nt
    s_memrealtime s[8:9]
    s_waitcnt lgkmcnt(0)
    s_sub_u32 s8, s8, s30
    s_cmpk_ge_u32 s8, 437
    s_cbranch_scc1 .ap_125
    s_waitcnt vmcnt(5)
    s_cmpk_ge_u32 s8, 337
    s_cbranch_scc1 .ap_125
    s_waitcnt vmcnt(4)
    s_bitcmp1_b64 s[14:15], 9
    s_cbranch_scc0 1
    s_waitcnt vmcnt(2)
    s_cmpk_ge_u32 s8, 217
    s_cbranch_scc1 .ap_125
    s_waitcnt vmcnt(1)
.ap_125:
    s_add_u32 s63, s69, 139264
    buffer_load_dwordx4 v[44:47], v1, s[40:43], s63 offen nt
    s_memrealtime s[8:9]
    s_waitcnt lgkmcnt(0)
    s_sub_u32 s8, s8, s30
    s_cmpk_ge_u32 s8, 471
    s_cbranch_scc1 .ap_126
    s_waitcnt vmcnt(5)
    s_cmpk_ge_u32 s8, 371
    s_cbranch_scc1 .ap_126
    s_waitcnt vmcnt(4)
    s_bitcmp1_b64 s[14:15], 10
    s_cbranch_scc0 1
    s_waitcnt vmcnt(2)
    s_cmpk_ge_u32 s8, 251
    s_cbranch_scc1 .ap_126
    s_waitcnt vmcnt(1)
.ap_126:
    s_add_u32 s63, s69, 147456
    buffer_load_dwordx4 v[72:75], v1, s[40:43], s63 offen nt
    s_memrealtime s[8:9]
    s_waitcnt lgkmcnt(0)
    s_sub_u32 s8, s8, s30
    s_cmpk_ge_u32 s8, 505
    s_cbranch_scc1 .ap_127
    s_waitcnt vmcnt(5)
    s_cmpk_ge_u32 s8, 405
    s_cbranch_scc1 .ap_127
    s_waitcnt vmcnt(4)
    s_cmpk_ge_u32 s8, 285
    s_cbranch_scc1 .ap_127
    s_waitcnt vmcnt(1)
.ap_127:
    s_add_u32 m0, s101, 16384
    s_add_u32 s56, s100, 1179648
    buffer_load_dwordx4 v6, s[48:51], s56 offen nt lds
    s_memrealtime s[8:9]
    s_waitcnt lgkmcnt(0)
    s_sub_u32 s8, s8, s30
    s_cmpk_ge_u32 s8, 505
    s_cbranch_scc1 .ap_128
    s_waitcnt vmcnt(5)
    s_cmpk_ge_u32 s8, 405
    s_cbranch_scc1 .ap_128
    s_waitcnt vmcnt(4)
    s_bitcmp1_b64 s[14:15], 11
    s_cbranch_scc0 1
    s_waitcnt vmcnt(2)
    s_cmpk_ge_u32 s8, 285
    s_cbranch_scc1 .ap_128
    s_waitcnt vmcnt(1)
.ap_128:
    s_add_u32 s63, s69, 155648
    buffer_load_dwordx4 v[76:79], v1, s[40:43], s63 offen nt
    s_memrealtime s[8:9]
    s_waitcnt vmcnt(8)
    s_waitcnt lgkmcnt(0)
    s_sub_u32 s8, s8, s30
    s_cmpk_ge_u32 s8, 539
    s_cbranch_scc1 .ap_129
    s_waitcnt vmcnt(5)
    s_cmpk_ge_u32 s8, 439
    s_cbranch_scc1 .ap_129
    s_waitcnt vmcnt(4)
    s_bitcmp1_b64 s[14:15], 12
    s_cbranch_scc0 1
    s_waitcnt vmcnt(2)
    s_cmpk_ge_u32 s8, 319
    s_cbranch_scc1 .ap_129
    s_waitcnt vmcnt(1)
.ap_129:
    s_add_u32 s63, s69, 163840
    buffer_load_dwordx4 v[104:107], v1, s[40:43], s63 offen nt
    v_and_b32 v157, 7, v0
    v_lshlrev_b32 v157, 2, v157
    s_mov_b32 s63, 0x4a1100
    buffer_load_dword v156, v157, s[36:39], s63 offen
    s_branch .Lsk_b0_1
.Lst_b0_1:
    s_branch .Lrt_b0_1
.Lsk_b0_1:
    s_memrealtime s[8:9]
    s_waitcnt vmcnt(9)
    s_waitcnt lgkmcnt(0)
    s_sub_u32 s8, s8, s30
    s_cmpk_ge_u32 s8, 573
    s_cbranch_scc1 .ap_130
    s_waitcnt vmcnt(6)
    s_cmpk_ge_u32 s8, 473
    s_cbranch_scc1 .ap_130
    s_waitcnt vmcnt(5)
    s_bitcmp1_b64 s[14:15], 13
    s_cbranch_scc0 1
    s_waitcnt vmcnt(3)
    s_cmpk_ge_u32 s8, 353
    s_cbranch_scc1 .ap_130
    s_waitcnt vmcnt(2)
.ap_130:
    s_add_u32 s63, s69, 172032
    buffer_load_dwordx4 v[108:111], v1, s[40:43], s63 offen nt
    s_memrealtime s[8:9]
    s_waitcnt vmcnt(9)
    s_waitcnt lgkmcnt(0)
    s_sub_u32 s8, s8, s30
    s_cmpk_ge_u32 s8, 607
    s_cbranch_scc1 .ap_131
    s_waitcnt vmcnt(6)
    s_cmpk_ge_u32 s8, 507
    s_cbranch_scc1 .ap_131
    s_waitcnt vmcnt(5)
    s_bitcmp1_b64 s[14:15], 14
    s_cbranch_scc0 1
    s_waitcnt vmcnt(3)
    s_cmpk_ge_u32 s8, 387
    s_cbranch_scc1 .ap_131
    s_waitcnt vmcnt(2)
.ap_131:
    s_add_u32 s63, s69, 180224
    buffer_load_dwordx4 v[136:139], v1, s[40:43], s63 offen nt
    s_memrealtime s[8:9]
    s_waitcnt vmcnt(9)
    s_waitcnt lgkmcnt(0)
    s_sub_u32 s8, s8, s30
    s_cmpk_ge_u32 s8, 641
    s_cbranch_scc1 .ap_132
    s_waitcnt vmcnt(6)
    s_cmpk_ge_u32 s8, 541
    s_cbranch_scc1 .ap_132
    s_waitcnt vmcnt(5)
    s_cmpk_ge_u32 s8, 421
    s_cbranch_scc1 .ap_132
    s_waitcnt vmcnt(1)
.ap_132:
    s_add_u32 m0, s101, 24576
    s_add_u32 s56, s100, 1769472
    buffer_load_dwordx4 v6, s[48:51], s56 offen nt lds
    s_memrealtime s[8:9]
    s_waitcnt vmcnt(9)
    s_waitcnt lgkmcnt(0)
    s_sub_u32 s8, s8, s30
    s_cmpk_ge_u32 s8, 641
    s_cbranch_scc1 .ap_133
    s_waitcnt vmcnt(6)
    s_cmpk_ge_u32 s8, 541
    s_cbranch_scc1 .ap_133
    s_waitcnt vmcnt(5)
    s_bitcmp1_b64 s[14:15], 15
    s_cbranch_scc0 1
    s_waitcnt vmcnt(2)
    s_cmpk_ge_u32 s8, 421
    s_cbranch_scc1 .ap_133
    s_waitcnt vmcnt(1)
.ap_133:
    s_add_u32 s63, s69, 188416
    buffer_load_dwordx4 v[140:143], v1, s[40:43], s63 offen nt
    s_memrealtime s[8:9]
    s_waitcnt vmcnt(9)
    s_waitcnt lgkmcnt(0)
    s_sub_u32 s8, s8, s30
    s_cmpk_ge_u32 s8, 675
    s_cbranch_scc1 .ap_134
    s_waitcnt vmcnt(6)
    s_cmpk_ge_u32 s8, 575
    s_cbranch_scc1 .ap_134
    s_waitcnt vmcnt(5)
    s_bitcmp1_b64 s[14:15], 16
    s_cbranch_scc0 1
    s_waitcnt vmcnt(2)
    s_cmpk_ge_u32 s8, 455
    s_cbranch_scc1 .ap_134
    s_waitcnt vmcnt(1)
.ap_134:
    s_add_u32 s63, s69, 262144
    buffer_load_dwordx4 v[48:51], v1, s[40:43], s63 offen nt
    s_waitcnt vmcnt(5)
    s_sub_u32 s63, s70, 300
    v_subrev_u32 v156, s63, v156
    v_mov_b32 v157, 600
    v_cmp_lt_u32 s[8:9], v156, v157
    v_add_u32_dpp v156, v156, v156 quad_perm:[1,0,3,2] row_mask:0xf bank_mask:0xf
    s_nop 1
    v_add_u32_dpp v156, v156, v156 quad_perm:[2,3,0,1] row_mask:0xf bank_mask:0xf
    s_nop 1
    v_add_u32_dpp v156, v156, v156 row_ror:4 row_mask:0xf bank_mask:0xf
    s_nop 0
    v_readfirstlane_b32 s63, v156
    s_cmp_eq_u64 s[8:9], -1
    s_nop 3
    s_cbranch_scc0 .et_135
    s_lshr_b32 s63, s63, 3
    s_sub_u32 s63, s63, 300
    s_add_u32 s30, s30, s63
    s_add_u32 s31, s31, s63
.et_135:
    s_memrealtime s[8:9]
    s_waitcnt lgkmcnt(0)
    s_sub_u32 s8, s8, s30
    s_cmpk_ge_u32 s8, 709
    s_cbranch_scc1 .ap_136
    s_waitcnt vmcnt(5)
    s_cmpk_ge_u32 s8, 609
    s_cbranch_scc1 .ap_136
    s_waitcnt vmcnt(4)
    s_bitcmp1_b64 s[14:15], 17
    s_cbranch_scc0 1
    s_waitcnt vmcnt(2)
    s_cmpk_ge_u32 s8, 489
    s_cbranch_scc1 .ap_136
    s_waitcnt vmcnt(1)
.ap_136:
    s_add_u32 s63, s69, 270336
    buffer_load_dwordx4 v[52:55], v1, s[40:43], s63 offen nt
    s_memrealtime s[8:9]
    s_waitcnt lgkmcnt(0)
    s_sub_u32 s8, s8, s30
    s_cmpk_ge_u32 s8, 744
    s_cbranch_scc1 .ap_137
    s_waitcnt vmcnt(5)
    s_cmpk_ge_u32 s8, 644
    s_cbranch_scc1 .ap_137
    s_waitcnt vmcnt(4)
    s_bitcmp1_b64 s[14:15], 18
    s_cbranch_scc0 1
    s_waitcnt vmcnt(2)
    s_cmpk_ge_u32 s8, 524
    s_cbranch_scc1 .ap_137
    s_waitcnt vmcnt(1)
.ap_137:
    s_add_u32 s63, s69, 278528
    buffer_load_dwordx4 v[80:83], v1, s[40:43], s63 offen nt
    s_memrealtime s[8:9]
    s_waitcnt lgkmcnt(0)
    s_sub_u32 s8, s8, s30
    s_cmpk_ge_u32 s8, 779
    s_cbranch_scc1 .ap_138
    s_waitcnt vmcnt(5)
    s_cmpk_ge_u32 s8, 679
    s_cbranch_scc1 .ap_138
    s_waitcnt vmcnt(4)
    s_cmpk_ge_u32 s8, 559
    s_cbranch_scc1 .ap_138
    s_waitcnt vmcnt(1)
.ap_138:
    s_add_u32 m0, s101, 32768
    s_add_u32 s56, s100, 2359296
    buffer_load_dwordx4 v6, s[48:51], s56 offen nt lds
    s_memrealtime s[8:9]
    s_waitcnt lgkmcnt(0)
    s_sub_u32 s8, s8, s30
    s_cmpk_ge_u32 s8, 779
    s_cbranch_scc1 .ap_139
    s_waitcnt vmcnt(5)
    s_cmpk_ge_u32 s8, 679
    s_cbranch_scc1 .ap_139
    s_waitcnt vmcnt(4)
    s_bitcmp1_b64 s[14:15], 19
    s_cbranch_scc0 1
    s_waitcnt vmcnt(2)
    s_cmpk_ge_u32 s8, 559
    s_cbranch_scc1 .ap_139
    s_waitcnt vmcnt(1)
.ap_139:
    s_add_u32 s63, s69, 286720
    buffer_load_dwordx4 v[84:87], v1, s[40:43], s63 offen nt
    s_memrealtime s[8:9]
    s_waitcnt vmcnt(8)
    s_waitcnt lgkmcnt(0)
    s_sub_u32 s8, s8, s30
    s_cmpk_ge_u32 s8, 814
    s_cbranch_scc1 .ap_140
    s_waitcnt vmcnt(5)
    s_cmpk_ge_u32 s8, 714
    s_cbranch_scc1 .ap_140
    s_waitcnt vmcnt(4)
    s_bitcmp1_b64 s[14:15], 20
    s_cbranch_scc0 1
    s_waitcnt vmcnt(2)
    s_cmpk_ge_u32 s8, 594
    s_cbranch_scc1 .ap_140
    s_waitcnt vmcnt(1)
.ap_140:
    s_add_u32 s63, s69, 294912
    buffer_load_dwordx4 v[112:115], v1, s[40:43], s63 offen nt
    s_memrealtime s[8:9]
    s_waitcnt vmcnt(8)
    s_waitcnt lgkmcnt(0)
    s_sub_u32 s8, s8, s30
    s_cmpk_ge_u32 s8, 849
    s_cbranch_scc1 .ap_141
    s_waitcnt vmcnt(5)
    s_cmpk_ge_u32 s8, 749
    s_cbranch_scc1 .ap_141
    s_waitcnt vmcnt(4)
    s_bitcmp1_b64 s[14:15], 21
    s_cbranch_scc0 1
    s_waitcnt vmcnt(2)
    s_cmpk_ge_u32 s8, 629
    s_cbranch_scc1 .ap_141
    s_waitcnt vmcnt(1)
.ap_141:
    s_add_u32 s63, s69, 303104
    buffer_load_dwordx4 v[116:119], v1, s[40:43], s63 offen nt
    s_memrealtime s[8:9]
    s_waitcnt vmcnt(8)
    s_waitcnt lgkmcnt(0)
    s_sub_u32 s8, s8, s30
    s_cmpk_ge_u32 s8, 884
    s_cbranch_scc1 .ap_142
    s_waitcnt vmcnt(5)
    s_cmpk_ge_u32 s8, 784
    s_cbranch_scc1 .ap_142
    s_waitcnt vmcnt(4)
    s_bitcmp1_b64 s[14:15], 22
    s_cbranch_scc0 1
    s_waitcnt vmcnt(2)
    s_cmpk_ge_u32 s8, 664
    s_cbranch_scc1 .ap_142
    s_waitcnt vmcnt(1)
.ap_142:
    s_add_u32 s63, s69, 311296
    buffer_load_dwordx4 v[144:147], v1, s[40:43], s63 offen nt
    s_branch .Lsk_b0_2
.Lst_b0_2:
    s_branch .Lrt_b0_2
.Lsk_b0_2:
    s_memrealtime s[8:9]
    s_waitcnt vmcnt(8)
    s_waitcnt lgkmcnt(0)
    s_sub_u32 s8, s8, s30
    s_cmpk_ge_u32 s8, 919
    s_cbranch_scc1 .ap_143
    s_waitcnt vmcnt(5)
    s_cmpk_ge_u32 s8, 819
    s_cbranch_scc1 .ap_143
    s_waitcnt vmcnt(4)
    s_cmpk_ge_u32 s8, 699
    s_cbranch_scc1 .ap_143
    s_waitcnt vmcnt(1)
.ap_143:
    s_add_u32 m0, s101, 40960
    s_add_u32 s56, s100, 2949120
    buffer_load_dwordx4 v6, s[48:51], s56 offen nt lds
    s_memrealtime s[8:9]
    s_waitcnt vmcnt(8)
    s_waitcnt lgkmcnt(0)
    s_sub_u32 s8, s8, s30
    s_cmpk_ge_u32 s8, 919
    s_cbranch_scc1 .ap_144
    s_waitcnt vmcnt(5)
    s_cmpk_ge_u32 s8, 819
    s_cbranch_scc1 .ap_144
    s_waitcnt vmcnt(4)
    s_bitcmp1_b64 s[14:15], 23
    s_cbranch_scc0 1
    s_waitcnt vmcnt(2)
    s_cmpk_ge_u32 s8, 699
    s_cbranch_scc1 .ap_144
    s_waitcnt vmcnt(1)
.ap_144:
    s_add_u32 s63, s69, 319488
    buffer_load_dwordx4 v[148:151], v1, s[40:43], s63 offen nt
    s_memrealtime s[8:9]
    s_waitcnt vmcnt(8)
    s_waitcnt lgkmcnt(0)
    s_sub_u32 s8, s8, s30
    s_cmpk_ge_u32 s8, 954
    s_cbranch_scc1 .ap_145
    s_waitcnt vmcnt(5)
    s_cmpk_ge_u32 s8, 854
    s_cbranch_scc1 .ap_145
    s_waitcnt vmcnt(4)
    s_bitcmp1_b64 s[14:15], 24
    s_cbranch_scc0 1
    s_waitcnt vmcnt(2)
    s_cmpk_ge_u32 s8, 734
    s_cbranch_scc1 .ap_145
    s_waitcnt vmcnt(1)
.ap_145:
    s_add_u32 s63, s69, 393216
    buffer_load_dwordx4 v[56:59], v1, s[40:43], s63 offen nt
    s_memrealtime s[8:9]
    s_waitcnt vmcnt(8)
    s_waitcnt lgkmcnt(0)
    s_sub_u32 s8, s8, s30
    s_cmpk_ge_u32 s8, 990
    s_cbranch_scc1 .ap_146
    s_waitcnt vmcnt(5)
    s_cmpk_ge_u32 s8, 890
    s_cbranch_scc1 .ap_146
    s_waitcnt vmcnt(4)
    s_bitcmp1_b64 s[14:15], 25
    s_cbranch_scc0 1
    s_waitcnt vmcnt(2)
    s_cmpk_ge_u32 s8, 770
    s_cbranch_scc1 .ap_146
    s_waitcnt vmcnt(1)
.ap_146:
    s_add_u32 s63, s69, 401408
    buffer_load_dwordx4 v[60:63], v1, s[40:43], s63 offen nt
    s_memrealtime s[8:9]
    s_waitcnt vmcnt(8)
    s_waitcnt lgkmcnt(0)
    s_sub_u32 s8, s8, s30
    s_cmpk_ge_u32 s8, 1028
    s_cbranch_scc1 .ap_147
    s_waitcnt vmcnt(5)
    s_cmpk_ge_u32 s8, 928
    s_cbranch_scc1 .ap_147
    s_waitcnt vmcnt(4)
    s_bitcmp1_b64 s[14:15], 26
    s_cbranch_scc0 1
    s_waitcnt vmcnt(2)
    s_cmpk_ge_u32 s8, 808
    s_cbranch_scc1 .ap_147
    s_waitcnt vmcnt(1)
.ap_147:
    s_add_u32 s63, s69, 409600
    buffer_load_dwordx4 v[88:91], v1, s[40:43], s63 offen nt
    s_memrealtime s[8:9]
    s_waitcnt vmcnt(8)
    s_waitcnt lgkmcnt(0)
    s_sub_u32 s8, s8, s30
    s_cmpk_ge_u32 s8, 1067
    s_cbranch_scc1 .ap_148
    s_waitcnt vmcnt(5)
    s_cmpk_ge_u32 s8, 967
    s_cbranch_scc1 .ap_148
    s_waitcnt vmcnt(4)
    s_cmpk_ge_u32 s8, 847
    s_cbranch_scc1 .ap_148
    s_waitcnt vmcnt(1)
.ap_148:
    s_add_u32 m0, s101, 49152
    s_add_u32 s56, s100, 3538944
    buffer_load_dwordx4 v6, s[48:51], s56 offen nt lds
    s_memrealtime s[8:9]
    s_waitcnt vmcnt(8)
    s_waitcnt lgkmcnt(0)
    s_sub_u32 s8, s8, s30
    s_cmpk_ge_u32 s8, 1067
    s_cbranch_scc1 .ap_149
    s_waitcnt vmcnt(5)
    s_cmpk_ge_u32 s8, 967
    s_cbranch_scc1 .ap_149
    s_waitcnt vmcnt(4)
    s_bitcmp1_b64 s[14:15], 27
    s_cbranch_scc0 1
    s_waitcnt vmcnt(2)
    s_cmpk_ge_u32 s8, 847
    s_cbranch_scc1 .ap_149
    s_waitcnt vmcnt(1)
.ap_149:
    s_add_u32 s63, s69, 417792
    buffer_load_dwordx4 v[92:95], v1, s[40:43], s63 offen nt
    s_memrealtime s[8:9]
    s_waitcnt vmcnt(8)
    s_waitcnt lgkmcnt(0)
    s_sub_u32 s8, s8, s30
    s_cmpk_ge_u32 s8, 1106
    s_cbranch_scc1 .ap_150
    s_waitcnt vmcnt(5)
    s_cmpk_ge_u32 s8, 1006
    s_cbranch_scc1 .ap_150
    s_waitcnt vmcnt(4)
    s_bitcmp1_b64 s[14:15], 28
    s_cbranch_scc0 1
    s_waitcnt vmcnt(2)
    s_cmpk_ge_u32 s8, 886
    s_cbranch_scc1 .ap_150
    s_waitcnt vmcnt(1)
.ap_150:
    s_add_u32 s63, s69, 425984
    buffer_load_dwordx4 v[120:123], v1, s[40:43], s63 offen nt
    s_memrealtime s[8:9]
    s_waitcnt vmcnt(8)
    s_waitcnt lgkmcnt(0)
    s_sub_u32 s8, s8, s30
    s_cmpk_ge_u32 s8, 1145
    s_cbranch_scc1 .ap_151
    s_waitcnt vmcnt(5)
    s_cmpk_ge_u32 s8, 1045
    s_cbranch_scc1 .ap_151
    s_waitcnt vmcnt(4)
    s_bitcmp1_b64 s[14:15], 29
    s_cbranch_scc0 1
    s_waitcnt vmcnt(2)
    s_cmpk_ge_u32 s8, 925
    s_cbranch_scc1 .ap_151
    s_waitcnt vmcnt(1)
.ap_151:
    s_add_u32 s63, s69, 434176
    buffer_load_dwordx4 v[124:127], v1, s[40:43], s63 offen nt
    s_memrealtime s[8:9]
    s_waitcnt vmcnt(8)
    s_waitcnt lgkmcnt(0)
    s_sub_u32 s8, s8, s30
    s_cmpk_ge_u32 s8, 1184
    s_cbranch_scc1 .ap_152
    s_waitcnt vmcnt(5)
    s_cmpk_ge_u32 s8, 1084
    s_cbranch_scc1 .ap_152
    s_waitcnt vmcnt(4)
    s_bitcmp1_b64 s[14:15], 30
    s_cbranch_scc0 1
    s_waitcnt vmcnt(2)
    s_cmpk_ge_u32 s8, 964
    s_cbranch_scc1 .ap_152
    s_waitcnt vmcnt(1)
.ap_152:
    s_add_u32 s63, s69, 442368
    buffer_load_dwordx4 v[152:155], v1, s[40:43], s63 offen nt
    s_memrealtime s[8:9]
    s_waitcnt vmcnt(8)
    s_waitcnt lgkmcnt(0)
    s_sub_u32 s8, s8, s30
    s_cmpk_ge_u32 s8, 1223
    s_cbranch_scc1 .ap_153
    s_waitcnt vmcnt(5)
    s_cmpk_ge_u32 s8, 1123
    s_cbranch_scc1 .ap_153
    s_waitcnt vmcnt(4)
    s_cmpk_ge_u32 s8, 1003
    s_cbranch_scc1 .ap_153
    s_waitcnt vmcnt(1)
.ap_153:
    s_add_u32 m0, s101, 57344
    s_add_u32 s56, s100, 4128768
    buffer_load_dwordx4 v6, s[48:51], s56 offen nt lds
    s_memrealtime s[8:9]
    s_waitcnt vmcnt(8)
    s_waitcnt lgkmcnt(0)
    s_sub_u32 s8, s8, s30
    s_cmpk_ge_u32 s8, 1223
    s_cbranch_scc1 .ap_154
    s_waitcnt vmcnt(5)
    s_cmpk_ge_u32 s8, 1123
    s_cbranch_scc1 .ap_154
    s_waitcnt vmcnt(4)
    s_bitcmp1_b64 s[14:15], 31
    s_cbranch_scc0 1
    s_waitcnt vmcnt(2)
    s_cmpk_ge_u32 s8, 1003
    s_cbranch_scc1 .ap_154
    s_waitcnt vmcnt(1)
.ap_154:
    s_add_u32 s63, s69, 450560
    buffer_load_dwordx4 v[156:159], v1, s[40:43], s63 offen nt
    s_memrealtime s[8:9]
    s_waitcnt vmcnt(8)
    s_waitcnt lgkmcnt(0)
    s_sub_u32 s8, s8, s30
    s_cmpk_ge_u32 s8, 1262
    s_cbranch_scc1 .ap_155
    s_waitcnt vmcnt(5)
    s_cmpk_ge_u32 s8, 1162
    s_cbranch_scc1 .ap_155
    s_waitcnt vmcnt(4)
    s_bitcmp1_b64 s[14:15], 32
    s_cbranch_scc0 1
    s_waitcnt vmcnt(2)
    s_cmpk_ge_u32 s8, 1042
    s_cbranch_scc1 .ap_155
    s_waitcnt vmcnt(1)
.ap_155:
    v_bfe_u32 v1, v0, 4, 2
    v_and_b32 v10, 0xf0, v2
    v_lshlrev_b32 v1, 2, v1
    v_bfe_u32 v1, s6, v1, 4
    v_lshl_add_u32 v1, v1, 8, v10
    s_add_u32 s63, s69, 0
    buffer_load_dwordx4 v[160:163], v1, s[44:47], s63 offen nt
    s_branch .Lsk_b0_3
.Lst_b0_3:
    s_branch .Lrt_b0_3
.Lsk_b0_3:
    s_memrealtime s[8:9]
    s_waitcnt vmcnt(8)
    s_waitcnt lgkmcnt(0)
    s_sub_u32 s8, s8, s30
    s_cmpk_ge_u32 s8, 1298
    s_cbranch_scc1 .ap_156
    s_waitcnt vmcnt(5)
    s_cmpk_ge_u32 s8, 1198
    s_cbranch_scc1 .ap_156
    s_waitcnt vmcnt(4)
    s_bitcmp1_b64 s[14:15], 33
    s_cbranch_scc0 1
    s_waitcnt vmcnt(2)
    s_cmpk_ge_u32 s8, 1078
    s_cbranch_scc1 .ap_156
    s_waitcnt vmcnt(1)
.ap_156:
    s_add_u32 s63, s69, 8192
    buffer_load_dwordx4 v[164:167], v1, s[44:47], s63 offen nt
    s_memrealtime s[8:9]
    s_waitcnt vmcnt(8)
    s_waitcnt lgkmcnt(0)
    s_sub_u32 s8, s8, s30
    s_cmpk_ge_u32 s8, 1335
    s_cbranch_scc1 .ap_157
    s_waitcnt vmcnt(5)
    s_cmpk_ge_u32 s8, 1235
    s_cbranch_scc1 .ap_157
    s_waitcnt vmcnt(4)
    s_bitcmp1_b64 s[14:15], 34
    s_cbranch_scc0 1
    s_waitcnt vmcnt(2)
    s_cmpk_ge_u32 s8, 1115
    s_cbranch_scc1 .ap_157
    s_waitcnt vmcnt(1)
.ap_157:
    s_add_u32 s63, s69, 16384
    buffer_load_dwordx4 v[168:171], v1, s[44:47], s63 offen nt
    s_memrealtime s[8:9]
    s_waitcnt vmcnt(8)
    s_waitcnt lgkmcnt(0)
    s_sub_u32 s8, s8, s30
    s_cmpk_ge_u32 s8, 1371
    s_cbranch_scc1 .ap_158
    s_waitcnt vmcnt(5)
    s_cmpk_ge_u32 s8, 1271
    s_cbranch_scc1 .ap_158
    s_waitcnt vmcnt(4)
    s_cmpk_ge_u32 s8, 1151
    s_cbranch_scc1 .ap_158
    s_waitcnt vmcnt(1)
.ap_158:
    s_add_u32 m0, s101, 65536
    s_add_u32 s56, s100, 4718592
    buffer_load_dwordx4 v6, s[48:51], s56 offen nt lds
    s_memrealtime s[8:9]
    s_waitcnt vmcnt(8)
    s_waitcnt lgkmcnt(0)
    s_sub_u32 s8, s8, s30
    s_cmpk_ge_u32 s8, 1371
    s_cbranch_scc1 .ap_159
    s_waitcnt vmcnt(5)
    s_cmpk_ge_u32 s8, 1271
    s_cbranch_scc1 .ap_159
    s_waitcnt vmcnt(4)
    s_bitcmp1_b64 s[14:15], 35
    s_cbranch_scc0 1
    s_waitcnt vmcnt(2)
    s_cmpk_ge_u32 s8, 1151
    s_cbranch_scc1 .ap_159
    s_waitcnt vmcnt(1)
.ap_159:
    s_add_u32 s63, s69, 24576
    buffer_load_dwordx4 v[172:175], v1, s[44:47], s63 offen nt
    s_memrealtime s[8:9]
    s_waitcnt vmcnt(8)
    s_waitcnt lgkmcnt(0)
    s_sub_u32 s8, s8, s30
    s_cmpk_ge_u32 s8, 1408
    s_cbranch_scc1 .ap_160
    s_waitcnt vmcnt(5)
    s_cmpk_ge_u32 s8, 1308
    s_cbranch_scc1 .ap_160
    s_waitcnt vmcnt(4)
    s_bitcmp1_b64 s[14:15], 36
    s_cbranch_scc0 1
    s_waitcnt vmcnt(2)
    s_cmpk_ge_u32 s8, 1188
    s_cbranch_scc1 .ap_160
    s_waitcnt vmcnt(1)
.ap_160:
    s_add_u32 s63, s69, 32768
    buffer_load_dwordx4 v[176:179], v1, s[44:47], s63 offen nt
    buffer_load_dwordx4 v[16:19], v7, s[36:39], s58 offen offset:0 sc1
    buffer_load_dwordx4 v[20:23], v7, s[36:39], s58 offen offset:256 sc1
    s_memrealtime s[8:9]
    s_waitcnt vmcnt(8)
    s_waitcnt lgkmcnt(0)
    s_sub_u32 s8, s8, s30
    s_cmpk_ge_u32 s8, 1444
    s_cbranch_scc1 .ap_161
    s_waitcnt vmcnt(5)
    s_cmpk_ge_u32 s8, 1344
    s_cbranch_scc1 .ap_161
    s_waitcnt vmcnt(4)
    s_bitcmp1_b64 s[14:15], 37
    s_cbranch_scc0 1
    s_waitcnt vmcnt(2)
    s_cmpk_ge_u32 s8, 1224
    s_cbranch_scc1 .ap_161
    s_waitcnt vmcnt(1)
.ap_161:
    s_add_u32 s63, s69, 40960
    buffer_load_dwordx4 v[180:183], v1, s[44:47], s63 offen nt
    s_memrealtime s[8:9]
    s_waitcnt vmcnt(8)
    s_waitcnt lgkmcnt(0)
    s_sub_u32 s8, s8, s30
    s_cmpk_ge_u32 s8, 1481
    s_cbranch_scc1 .ap_162
    s_waitcnt vmcnt(5)
    s_cmpk_ge_u32 s8, 1381
    s_cbranch_scc1 .ap_162
    s_waitcnt vmcnt(4)
    s_bitcmp1_b64 s[14:15], 38
    s_cbranch_scc0 1
    s_waitcnt vmcnt(2)
    s_cmpk_ge_u32 s8, 1261
    s_cbranch_scc1 .ap_162
    s_waitcnt vmcnt(1)
.ap_162:
    s_add_u32 s63, s69, 49152
    buffer_load_dwordx4 v[184:187], v1, s[44:47], s63 offen nt
    s_memrealtime s[8:9]
    s_waitcnt vmcnt(8)
    s_waitcnt lgkmcnt(0)
    s_sub_u32 s8, s8, s30
    s_cmpk_ge_u32 s8, 1517
    s_cbranch_scc1 .ap_163
    s_waitcnt vmcnt(5)
    s_cmpk_ge_u32 s8, 1417
    s_cbranch_scc1 .ap_163
    s_waitcnt vmcnt(4)
    s_cmpk_ge_u32 s8, 1297
    s_cbranch_scc1 .ap_163
    s_waitcnt vmcnt(1)
.ap_163:
    s_add_u32 m0, s101, 73728
    s_add_u32 s56, s100, 0
    buffer_load_dwordx4 v6, s[52:55], s56 offen nt lds
    s_memrealtime s[8:9]
    s_waitcnt vmcnt(8)
    s_waitcnt lgkmcnt(0)
    s_sub_u32 s8, s8, s30
    s_cmpk_ge_u32 s8, 1517
    s_cbranch_scc1 .ap_164
    s_waitcnt vmcnt(5)
    s_cmpk_ge_u32 s8, 1417
    s_cbranch_scc1 .ap_164
    s_waitcnt vmcnt(4)
    s_bitcmp1_b64 s[14:15], 39
    s_cbranch_scc0 1
    s_waitcnt vmcnt(2)
    s_cmpk_ge_u32 s8, 1297
    s_cbranch_scc1 .ap_164
    s_waitcnt vmcnt(1)
.ap_164:
    s_add_u32 s63, s69, 57344
    buffer_load_dwordx4 v[188:191], v1, s[44:47], s63 offen nt
    s_memrealtime s[8:9]
    s_waitcnt vmcnt(8)
    s_waitcnt lgkmcnt(0)
    s_sub_u32 s8, s8, s30
    s_cmpk_ge_u32 s8, 1554
    s_cbranch_scc1 .ap_165
    s_waitcnt vmcnt(5)
    s_cmpk_ge_u32 s8, 1454
    s_cbranch_scc1 .ap_165
    s_waitcnt vmcnt(4)
    s_bitcmp1_b64 s[14:15], 40
    s_cbranch_scc0 1
    s_waitcnt vmcnt(2)
    s_cmpk_ge_u32 s8, 1334
    s_cbranch_scc1 .ap_165
    s_waitcnt vmcnt(1)
.ap_165:
    s_add_u32 s63, s69, 131072
    buffer_load_dwordx4 v[192:195], v1, s[44:47], s63 offen nt
    s_waitcnt vmcnt(5)
    s_branch .gpc_167
.gp_166:
    buffer_load_dwordx4 v[16:19], v7, s[36:39], s58 offen offset:0 sc1
    buffer_load_dwordx4 v[20:23], v7, s[36:39], s58 offen offset:256 sc1
    s_waitcnt vmcnt(0)
.gpc_167:
    v_min_u32 v10, v17, v19
    v_max_u32 v11, v17, v19
    v_min3_u32 v10, v10, v21, v23
    v_max3_u32 v11, v11, v21, v23
    v_cmp_eq_u32 vcc, s34, v10
    v_cmp_eq_u32 s[56:57], s34, v11
    s_and_b64 vcc, vcc, s[56:57]
    s_cmp_eq_u64 vcc, -1
    s_nop 2
    s_cbranch_scc1 .gpd_168
    s_sub_u32 s35, s35, 1
    s_cbranch_scc1 .Lexit
    s_sleep 1
    s_branch .gp_166
.gpd_168:
    s_mov_b32 vcc_lo, 0xcccccccc
    s_mov_b32 vcc_hi, 0xcccccccc
    v_cndmask_b32_e64 v24, v16, 0, vcc
    v_cndmask_b32_e64 v25, v18, 0, vcc
    v_cndmask_b32_e64 v26, v20, 0, vcc
    v_cndmask_b32_e64 v27, v22, 0, vcc
    v_cndmask_b32_e32 v28, 0, v16, vcc
    v_cndmask_b32_e32 v29, 0, v18, vcc
    v_cndmask_b32_e32 v30, 0, v20, vcc
    v_cndmask_b32_e32 v31, 0, v22, vcc
    v_mfma_f32_16x16x32_bf16 v[16:19], v[32:35], v[24:27], 0
    v_mfma_f32_16x16x32_bf16 v[32:35], v[40:43], v[24:27], 0
    v_mfma_f32_16x16x32_bf16 v[16:19], v[36:39], v[28:31], v[16:19]
    v_mfma_f32_16x16x32_bf16 v[40:43], v[48:51], v[24:27], 0
    v_mfma_f32_16x16x32_bf16 v[32:35], v[44:47], v[28:31], v[32:35]
    v_mfma_f32_16x16x32_bf16 v[48:51], v[56:59], v[24:27], 0
    v_mfma_f32_16x16x32_bf16 v[40:43], v[52:55], v[28:31], v[40:43]
    v_mfma_f32_16x16x32_bf16 v[56:59], v[64:67], v[24:27], 0
    v_mfma_f32_16x16x32_bf16 v[48:51], v[60:63], v[28:31], v[48:51]
    s_nop 1
    v_add_f32_dpp v10, v17, v16 row_ror:12 row_mask:0xf bank_mask:0x1
    s_branch .Lsk_b1_0
.Lst_b1_0:
    s_branch .Lrt_b1_0
.Lsk_b1_0:
    s_memrealtime s[8:9]
    s_waitcnt lgkmcnt(0)
    s_sub_u32 s8, s8, s30
    s_cmpk_ge_u32 s8, 1591
    s_nop 0
    s_cbranch_scc1 .ap_169
    s_waitcnt vmcnt(5)
    s_cmpk_ge_u32 s8, 1491
    s_cbranch_scc1 .ap_169
    s_waitcnt vmcnt(4)
    s_bitcmp1_b64 s[14:15], 41
    s_cbranch_scc0 1
    s_waitcnt vmcnt(2)
    s_cmpk_ge_u32 s8, 1371
    s_cbranch_scc1 .ap_169
    s_waitcnt vmcnt(1)
.ap_169:
    s_add_u32 s63, s69, 139264
    buffer_load_dwordx4 v[196:199], v1, s[44:47], s63 offen nt
    v_mfma_f32_16x16x32_bf16 v[64:67], v[72:75], v[24:27], 0
    v_mfma_f32_16x16x32_bf16 v[56:59], v[68:71], v[28:31], v[56:59]
    v_add_f32_dpp v11, v33, v32 row_ror:12 row_mask:0xf bank_mask:0x1
    v_add_f32_dpp v10, v18, v10 row_ror:8 row_mask:0xf bank_mask:0x1
    v_mfma_f32_16x16x32_bf16 v[72:75], v[80:83], v[24:27], 0
    v_mfma_f32_16x16x32_bf16 v[64:67], v[76:79], v[28:31], v[64:67]
    v_add_f32_dpp v12, v41, v40 row_ror:12 row_mask:0xf bank_mask:0x1
    v_add_f32_dpp v11, v34, v11 row_ror:8 row_mask:0xf bank_mask:0x1
    v_add_f32_dpp v10, v19, v10 row_ror:4 row_mask:0xf bank_mask:0x1
    v_mfma_f32_16x16x32_bf16 v[80:83], v[88:91], v[24:27], 0
    v_mfma_f32_16x16x32_bf16 v[72:75], v[84:87], v[28:31], v[72:75]
    v_add_f32_dpp v13, v49, v48 row_ror:12 row_mask:0xf bank_mask:0x1
    v_add_f32_dpp v12, v42, v12 row_ror:8 row_mask:0xf bank_mask:0x1
    v_add_f32_dpp v11, v35, v11 row_ror:4 row_mask:0xf bank_mask:0x1
    v_mfma_f32_16x16x32_bf16 v[88:91], v[96:99], v[24:27], 0
    v_mfma_f32_16x16x32_bf16 v[80:83], v[92:95], v[28:31], v[80:83]
    v_add_f32_dpp v10, v58, v57 row_ror:12 row_mask:0xf bank_mask:0x2
    v_add_f32_dpp v13, v50, v13 row_ror:8 row_mask:0xf bank_mask:0x1
    v_add_f32_dpp v12, v43, v12 row_ror:4 row_mask:0xf bank_mask:0x1
    s_memrealtime s[8:9]
    s_waitcnt lgkmcnt(0)
    s_sub_u32 s8, s8, s30
    s_cmpk_ge_u32 s8, 1602
    s_nop 0
    s_cbranch_scc1 .ap_170
    s_waitcnt vmcnt(5)
    s_cmpk_ge_u32 s8, 1502
    s_cbranch_scc1 .ap_170
    s_waitcnt vmcnt(4)
    s_bitcmp1_b64 s[14:15], 42
    s_cbranch_scc0 1
    s_waitcnt vmcnt(2)
    s_cmpk_ge_u32 s8, 1382
    s_cbranch_scc1 .ap_170
    s_waitcnt vmcnt(1)
.ap_170:
    s_add_u32 s63, s69, 147456
    buffer_load_dwordx4 v[200:203], v1, s[44:47], s63 offen nt
    s_memrealtime s[8:9]
    s_waitcnt lgkmcnt(0)
    s_sub_u32 s8, s8, s30
    s_cmpk_ge_u32 s8, 1613
    s_cbranch_scc1 .ap_171
    s_waitcnt vmcnt(5)
    s_cmpk_ge_u32 s8, 1513
    s_cbranch_scc1 .ap_171
    s_waitcnt vmcnt(4)
    s_cmpk_ge_u32 s8, 1393
    s_cbranch_scc1 .ap_171
    s_waitcnt vmcnt(1)
.ap_171:
    s_add_u32 m0, s101, 81920
    s_add_u32 s56, s100, 589824
    buffer_load_dwordx4 v6, s[52:55], s56 offen nt lds
    v_mfma_f32_16x16x32_bf16 v[96:99], v[104:107], v[24:27], 0
    v_mfma_f32_16x16x32_bf16 v[88:91], v[100:103], v[28:31], v[88:91]
    v_add_f32_dpp v11, v66, v65 row_ror:12 row_mask:0xf bank_mask:0x2
    v_add_f32_dpp v10, v59, v10 row_ror:8 row_mask:0xf bank_mask:0x2
    v_add_f32_dpp v13, v51, v13 row_ror:4 row_mask:0xf bank_mask:0x1
    v_mfma_f32_16x16x32_bf16 v[104:107], v[112:115], v[24:27], 0
    v_mfma_f32_16x16x32_bf16 v[96:99], v[108:111], v[28:31], v[96:99]
    v_add_f32_dpp v12, v74, v73 row_ror:12 row_mask:0xf bank_mask:0x2
    v_add_f32_dpp v11, v67, v11 row_ror:8 row_mask:0xf bank_mask:0x2
    v_add_f32_dpp v10, v56, v10 row_ror:4 row_mask:0xf bank_mask:0x2
    v_mfma_f32_16x16x32_bf16 v[112:115], v[120:123], v[24:27], 0
    v_mfma_f32_16x16x32_bf16 v[104:107], v[116:119], v[28:31], v[104:107]
    v_add_f32_dpp v13, v82, v81 row_ror:12 row_mask:0xf bank_mask:0x2
    v_add_f32_dpp v12, v75, v12 row_ror:8 row_mask:0xf bank_mask:0x2
    v_add_f32_dpp v11, v64, v11 row_ror:4 row_mask:0xf bank_mask:0x2
    v_mfma_f32_16x16x32_bf16 v[120:123], v[128:131], v[24:27], 0
    v_mfma_f32_16x16x32_bf16 v[112:115], v[124:127], v[28:31], v[112:115]
    v_add_f32_dpp v10, v91, v90 row_ror:12 row_mask:0xf bank_mask:0x4
    v_add_f32_dpp v13, v83, v13 row_ror:8 row_mask:0xf bank_mask:0x2
    v_add_f32_dpp v12, v72, v12 row_ror:4 row_mask:0xf bank_mask:0x2
    s_memrealtime s[8:9]
    s_waitcnt lgkmcnt(0)
    s_sub_u32 s8, s8, s30
    s_cmpk_ge_u32 s8, 1613
    s_nop 0
    s_cbranch_scc1 .ap_172
    s_waitcnt vmcnt(5)
    s_cmpk_ge_u32 s8, 1513
    s_cbranch_scc1 .ap_172
    s_waitcnt vmcnt(4)
    s_bitcmp1_b64 s[14:15], 43
    s_cbranch_scc0 1
    s_waitcnt vmcnt(2)
    s_cmpk_ge_u32 s8, 1393
    s_cbranch_scc1 .ap_172
    s_waitcnt vmcnt(1)
.ap_172:
    s_add_u32 s63, s69, 155648
    buffer_load_dwordx4 v[204:207], v1, s[44:47], s63 offen nt
    v_mfma_f32_16x16x32_bf16 v[128:131], v[136:139], v[24:27], 0
    v_mfma_f32_16x16x32_bf16 v[120:123], v[132:135], v[28:31], v[120:123]
    v_add_f32_dpp v11, v99, v98 row_ror:12 row_mask:0xf bank_mask:0x4
    v_add_f32_dpp v10, v88, v10 row_ror:8 row_mask:0xf bank_mask:0x4
    v_add_f32_dpp v13, v80, v13 row_ror:4 row_mask:0xf bank_mask:0x2
    v_mfma_f32_16x16x32_bf16 v[136:139], v[144:147], v[24:27], 0
    v_mfma_f32_16x16x32_bf16 v[128:131], v[140:143], v[28:31], v[128:131]
    v_add_f32_dpp v12, v107, v106 row_ror:12 row_mask:0xf bank_mask:0x4
    v_add_f32_dpp v11, v96, v11 row_ror:8 row_mask:0xf bank_mask:0x4
    v_add_f32_dpp v10, v89, v10 row_ror:4 row_mask:0xf bank_mask:0x4
    v_mfma_f32_16x16x32_bf16 v[144:147], v[152:155], v[24:27], 0
    v_mfma_f32_16x16x32_bf16 v[136:139], v[148:151], v[28:31], v[136:139]
    v_add_f32_dpp v13, v115, v114 row_ror:12 row_mask:0xf bank_mask:0x4
    v_add_f32_dpp v12, v104, v12 row_ror:8 row_mask:0xf bank_mask:0x4
    v_add_f32_dpp v11, v97, v11 row_ror:4 row_mask:0xf bank_mask:0x4
    v_mfma_f32_16x16x32_bf16 v[144:147], v[156:159], v[28:31], v[144:147]
    v_add_f32_dpp v10, v120, v123 row_ror:12 row_mask:0xf bank_mask:0x8
    v_add_f32_dpp v13, v112, v13 row_ror:8 row_mask:0xf bank_mask:0x4
    v_add_f32_dpp v12, v105, v12 row_ror:4 row_mask:0xf bank_mask:0x4
    s_memrealtime s[8:9]
    s_waitcnt vmcnt(8)
    s_waitcnt lgkmcnt(0)
    s_sub_u32 s8, s8, s30
    s_cmpk_ge_u32 s8, 1624
    s_cbranch_scc1 .ap_173
    s_waitcnt vmcnt(5)
    s_cmpk_ge_u32 s8, 1524
    s_cbranch_scc1 .ap_173
    s_waitcnt vmcnt(4)
    s_bitcmp1_b64 s[14:15], 44
    s_cbranch_scc0 1
    s_waitcnt vmcnt(2)
    s_cmpk_ge_u32 s8, 1404
    s_cbranch_scc1 .ap_173
    s_waitcnt vmcnt(1)
.ap_173:
    s_add_u32 s63, s69, 163840
    buffer_load_dwordx4 v[208:211], v1, s[44:47], s63 offen nt
    s_cmp_eq_u32 s3, 0
    s_cbranch_scc1 .Lst_b2_0
    s_cmp_eq_u32 s3, 1
    s_cbranch_scc1 .Lst_b2_1
    s_cmp_eq_u32 s3, 2
    s_cbranch_scc1 .Lst_b2_2
    s_cmp_eq_u32 s3, 3
    s_cbranch_scc1 .Lst_b2_3
.Lrt_b2_0:
.Lrt_b2_1:
.Lrt_b2_2:
.Lrt_b2_3:
    v_add_f32_dpp v11, v128, v131 row_ror:12 row_mask:0xf bank_mask:0x8
    v_add_f32_dpp v10, v121, v10 row_ror:8 row_mask:0xf bank_mask:0x8
    v_add_f32_dpp v13, v113, v13 row_ror:4 row_mask:0xf bank_mask:0x4
    v_add_f32_dpp v12, v136, v139 row_ror:12 row_mask:0xf bank_mask:0x8
    v_add_f32_dpp v11, v129, v11 row_ror:8 row_mask:0xf bank_mask:0x8
    v_add_f32_dpp v10, v122, v10 row_ror:4 row_mask:0xf bank_mask:0x8
    v_add_f32_dpp v13, v144, v147 row_ror:12 row_mask:0xf bank_mask:0x8
    v_add_f32_dpp v12, v137, v12 row_ror:8 row_mask:0xf bank_mask:0x8
    v_add_f32_dpp v11, v130, v11 row_ror:4 row_mask:0xf bank_mask:0x8
    v_add_f32_dpp v13, v145, v13 row_ror:8 row_mask:0xf bank_mask:0x8
    v_add_f32_dpp v12, v138, v12 row_ror:4 row_mask:0xf bank_mask:0x8
    s_memrealtime s[8:9]
    s_waitcnt vmcnt(8)
    s_waitcnt lgkmcnt(0)
    s_sub_u32 s8, s8, s30
    s_cmpk_ge_u32 s8, 1636
    s_cbranch_scc1 .ap_174
    s_waitcnt vmcnt(5)
    s_cmpk_ge_u32 s8, 1536
    s_cbranch_scc1 .ap_174
    s_branch .Lsk_b1_1
.Lst_b1_1:
    s_branch .Lrt_b1_1
.Lsk_b1_1:
    s_waitcnt vmcnt(4)
    s_bitcmp1_b64 s[14:15], 45
    s_cbranch_scc0 1
    s_waitcnt vmcnt(2)
    s_cmpk_ge_u32 s8, 1416
    s_cbranch_scc1 .ap_174
    s_waitcnt vmcnt(1)
.ap_174:
    s_add_u32 s63, s69, 172032
    buffer_load_dwordx4 v[212:215], v1, s[44:47], s63 offen nt
    v_add_f32_dpp v13, v146, v13 row_ror:4 row_mask:0xf bank_mask:0x8
    s_mov_b32 s60, 0x3db504f3
    s_mov_b32 s61, 0x3db504f3
    v_cvt_pk_bf16_f32 v10, v10, v11
    v_and_b32 v11, 0xffff0000, v10
    v_lshlrev_b32 v10, 16, v10
    v_cvt_pk_bf16_f32 v12, v12, v13
    v_and_b32 v13, 0xffff0000, v12
    v_lshlrev_b32 v12, 16, v12
    v_pk_mul_f32 v[10:11], v[10:11], s[60:61]
    v_pk_mul_f32 v[12:13], v[12:13], s[60:61]
    v_cvt_pk_bf16_f32 v10, v10, v11
    v_and_b32 v11, 0xffff0000, v10
    v_lshlrev_b32 v10, 16, v10
    v_cvt_pk_bf16_f32 v12, v12, v13
    v_and_b32 v13, 0xffff0000, v12
    v_lshlrev_b32 v12, 16, v12
    v_max_f32 v14, v10, v11
    v_max3_f32 v14, v14, v12, v13
    s_mov_b32 s60, 0x3fb8aa3b
    v_mov_b32 v22, s34
    v_mov_b32 v23, s34
    v_max_f32_dpp v14, v14, v14 quad_perm:[2,3,0,1] row_mask:0xf bank_mask:0xf
    s_nop 1
    v_max_f32_dpp v14, v14, v14 row_ror:4 row_mask:0xf bank_mask:0xf
    s_nop 1
    v_max_f32_dpp v14, v14, v14 row_ror:8 row_mask:0xf bank_mask:0xf
    v_mov_b32 v15, v14
    s_nop 1
    v_permlane16_swap_b32 v15, v14
    v_max_f32 v14, v15, v14
    v_mov_b32 v15, v14
    s_nop 1
    v_permlane32_swap_b32 v15, v14
    v_max_f32 v14, v15, v14
    v_mul_f32 v15, 0xbfb8aa3b, v14
    v_fma_f32 v10, v10, s60, v15
    v_fma_f32 v11, v11, s60, v15
    v_fma_f32 v12, v12, s60, v15
    v_fma_f32 v13, v13, s60, v15
    v_exp_f32 v10, v10
    v_exp_f32 v11, v11
    v_exp_f32 v12, v12
    v_exp_f32 v13, v13
    v_mov_b32 v20, v14
    v_pk_add_f32 v[16:17], v[10:11], v[12:13]
    v_add_f32 v21, v16, v17
    s_lshl_b32 s60, s68, 5
    s_lshl_b32 s61, s3, 4
    s_add_u32 s61, s61, 159104
    v_add_u32 v16, s61, v3
    v_mov_b32 v17, 159232
    v_mov_b32 v18, 1
    s_add_u32 s60, s60, s59
    v_add_f32_dpp v21, v21, v21 quad_perm:[2,3,0,1] row_mask:0xf bank_mask:0xf
    s_nop 1
    v_add_f32_dpp v21, v21, v21 row_ror:4 row_mask:0xf bank_mask:0xf
    s_nop 1
    v_add_f32_dpp v21, v21, v21 row_ror:8 row_mask:0xf bank_mask:0xf
    v_mov_b32 v15, v21
    s_nop 1
    v_permlane16_swap_b32 v15, v21
    v_add_f32 v21, v15, v21
    v_mov_b32 v15, v21
    s_nop 1
    v_permlane32_swap_b32 v15, v21
    v_add_f32 v21, v15, v21
    s_mov_b64 exec, 3
    ds_write_b64 v16, v[20:21]
    s_mov_b64 exec, 1
    ds_add_rtn_u32 v18, v17, v18
    s_mov_b64 exec, -1
    v_and_b32 v16, 0x78, v3
    v_or_b32 v16, 159104, v16
    s_waitcnt lgkmcnt(0)
    v_readfirstlane_b32 s61, v18
    s_cmp_eq_u32 s61, 7
    s_nop 3
    s_cbranch_scc0 .mlc_175
    ds_read_b64 v[18:19], v16
    s_waitcnt lgkmcnt(0)
    v_mov_b32 v20, v18
    s_nop 1
    v_max_f32_dpp v20, v20, v20 quad_perm:[2,3,0,1] row_mask:0xf bank_mask:0xf
    s_nop 1
    v_max_f32_dpp v20, v20, v20 row_ror:4 row_mask:0xf bank_mask:0xf
    s_nop 1
    v_max_f32_dpp v20, v20, v20 row_ror:8 row_mask:0xf bank_mask:0xf
    v_sub_f32 v18, v18, v20
    v_mul_f32 v18, 0x3fb8aa3b, v18
    v_exp_f32 v18, v18
    s_nop 0
    v_mul_f32 v21, v18, v19
    s_nop 1
    v_add_f32_dpp v21, v21, v21 quad_perm:[2,3,0,1] row_mask:0xf bank_mask:0xf
    s_nop 1
    v_add_f32_dpp v21, v21, v21 row_ror:4 row_mask:0xf bank_mask:0xf
    s_nop 1
    v_add_f32_dpp v21, v21, v21 row_ror:8 row_mask:0xf bank_mask:0xf
    s_mov_b64 exec, 3
    buffer_store_dwordx4 v[20:23], v2, s[36:39], s60 offen sc1
    s_mov_b64 exec, -1
.mlc_175:
    s_memrealtime s[8:9]
    s_waitcnt vmcnt(8)
    s_waitcnt lgkmcnt(0)
    s_sub_u32 s8, s8, s30
    s_cmpk_ge_u32 s8, 1668
    s_cbranch_scc1 .ap_176
    s_waitcnt vmcnt(5)
    s_cmpk_ge_u32 s8, 1568
    s_cbranch_scc1 .ap_176
    s_waitcnt vmcnt(4)
    s_bitcmp1_b64 s[14:15], 46
    s_cbranch_scc0 1
    s_waitcnt vmcnt(2)
    s_cmpk_ge_u32 s8, 1448
    s_cbranch_scc1 .ap_176
    s_waitcnt vmcnt(1)
.ap_176:
    s_add_u32 s63, s69, 180224
    buffer_load_dwordx4 v[216:219], v1, s[44:47], s63 offen nt
    s_memrealtime s[8:9]
    s_waitcnt vmcnt(8)
    s_waitcnt lgkmcnt(0)
    s_sub_u32 s8, s8, s30
    s_cmpk_ge_u32 s8, 1700
    s_cbranch_scc1 .ap_177
    s_waitcnt vmcnt(5)
    s_cmpk_ge_u32 s8, 1600
    s_cbranch_scc1 .ap_177
    s_waitcnt vmcnt(4)
    s_bitcmp1_b64 s[14:15], 47
    s_cbranch_scc0 1
    s_waitcnt vmcnt(2)
    s_cmpk_ge_u32 s8, 1480
    s_cbranch_scc1 .ap_177
    s_waitcnt vmcnt(1)
.ap_177:
    s_add_u32 s63, s69, 188416
    buffer_load_dwordx4 v[220:223], v1, s[44:47], s63 offen nt
    s_and_b32 s56, s64, 0
    s_mul_i32 s56, s56, 18432
    s_mul_i32 s57, s3, 2304
    s_add_u32 s56, s56, s57
    s_add_u32 s56, s56, 0x37000
    buffer_load_dwordx4 v[32:35], v2, s[36:39], s56 offen offset:0 sc1
    buffer_load_dwordx4 v[40:43], v2, s[36:39], s56 offen offset:1024 sc1
    buffer_load_dwordx2 v[48:49], v5, s[36:39], s56 offen offset:0 sc1
    s_branch .Lsk_b1_2
.Lst_b1_2:
    s_branch .Lrt_b1_2
.Lsk_b1_2:
    s_memrealtime s[8:9]
    s_waitcnt vmcnt(11)
    s_waitcnt lgkmcnt(0)
    s_sub_u32 s8, s8, s30
    s_cmpk_ge_u32 s8, 1732
    s_cbranch_scc1 .ap_178
    s_waitcnt vmcnt(8)
    s_cmpk_ge_u32 s8, 1632
    s_cbranch_scc1 .ap_178
    s_waitcnt vmcnt(7)
    s_bitcmp1_b64 s[14:15], 48
    s_cbranch_scc0 1
    s_waitcnt vmcnt(5)
    s_cmpk_ge_u32 s8, 1512
    s_cbranch_scc1 .ap_178
    s_waitcnt vmcnt(4)
.ap_178:
    s_add_u32 s63, s69, 262144
    buffer_load_dwordx4 v[224:227], v1, s[44:47], s63 offen nt
    s_memrealtime s[8:9]
    s_waitcnt vmcnt(11)
    s_waitcnt lgkmcnt(0)
    s_sub_u32 s8, s8, s30
    s_cmpk_ge_u32 s8, 1764
    s_cbranch_scc1 .ap_179
    s_waitcnt vmcnt(8)
    s_cmpk_ge_u32 s8, 1664
    s_cbranch_scc1 .ap_179
    s_waitcnt vmcnt(7)
    s_bitcmp1_b64 s[14:15], 49
    s_cbranch_scc0 1
    s_waitcnt vmcnt(5)
    s_cmpk_ge_u32 s8, 1544
    s_cbranch_scc1 .ap_179
    s_waitcnt vmcnt(4)
.ap_179:
    s_add_u32 s63, s69, 270336
    buffer_load_dwordx4 v[228:231], v1, s[44:47], s63 offen nt
    s_and_b32 s56, s64, 0
    s_mul_i32 s56, s56, 18432
    s_mul_i32 s57, s3, 2304
    s_add_u32 s56, s56, s57
    s_add_u32 s56, s56, 0x49000
    buffer_load_dwordx4 v[56:59], v2, s[36:39], s56 offen offset:0 sc1
    buffer_load_dwordx4 v[64:67], v2, s[36:39], s56 offen offset:1024 sc1
    buffer_load_dwordx2 v[72:73], v5, s[36:39], s56 offen offset:0 sc1
    s_memrealtime s[8:9]
    s_waitcnt vmcnt(14)
    s_waitcnt lgkmcnt(0)
    s_sub_u32 s8, s8, s30
    s_cmpk_ge_u32 s8, 1796
    s_cbranch_scc1 .ap_180
    s_waitcnt vmcnt(11)
    s_cmpk_ge_u32 s8, 1696
    s_cbranch_scc1 .ap_180
    s_waitcnt vmcnt(10)
    s_bitcmp1_b64 s[14:15], 50
    s_cbranch_scc0 1
    s_waitcnt vmcnt(8)
    s_cmpk_ge_u32 s8, 1576
    s_cbranch_scc1 .ap_180
    s_waitcnt vmcnt(4)
.ap_180:
    s_add_u32 s63, s69, 278528
    buffer_load_dwordx4 v[232:235], v1, s[44:47], s63 offen nt
    s_memrealtime s[8:9]
    s_waitcnt vmcnt(14)
    s_waitcnt lgkmcnt(0)
    s_sub_u32 s8, s8, s30
    s_cmpk_ge_u32 s8, 1828
    s_cbranch_scc1 .ap_181
    s_waitcnt vmcnt(11)
    s_cmpk_ge_u32 s8, 1728
    s_cbranch_scc1 .ap_181
    s_waitcnt vmcnt(10)
    s_bitcmp1_b64 s[14:15], 51
    s_cbranch_scc0 1
    s_waitcnt vmcnt(5)
    s_cmpk_ge_u32 s8, 1608
    s_cbranch_scc1 .ap_181
    s_waitcnt vmcnt(4)
.ap_181:
    s_add_u32 s63, s69, 286720
    buffer_load_dwordx4 v[236:239], v1, s[44:47], s63 offen nt
    s_memrealtime s[8:9]
    s_waitcnt vmcnt(14)
    s_waitcnt lgkmcnt(0)
    s_sub_u32 s8, s8, s30
    s_cmpk_ge_u32 s8, 1860
    s_cbranch_scc1 .ap_182
    s_waitcnt vmcnt(11)
    s_cmpk_ge_u32 s8, 1760
    s_cbranch_scc1 .ap_182
    s_waitcnt vmcnt(10)
    s_bitcmp1_b64 s[14:15], 52
    s_cbranch_scc0 1
    s_waitcnt vmcnt(5)
    s_cmpk_ge_u32 s8, 1640
    s_cbranch_scc1 .ap_182
    s_waitcnt vmcnt(1)
.ap_182:
    s_add_u32 s63, s69, 294912
    buffer_load_dwordx4 v[240:243], v1, s[44:47], s63 offen nt
    s_memrealtime s[8:9]
    s_waitcnt vmcnt(14)
    s_waitcnt lgkmcnt(0)
    s_sub_u32 s8, s8, s30
    s_cmpk_ge_u32 s8, 1892
    s_cbranch_scc1 .ap_183
    s_waitcnt vmcnt(11)
    s_cmpk_ge_u32 s8, 1792
    s_cbranch_scc1 .ap_183
    s_waitcnt vmcnt(7)
    s_bitcmp1_b64 s[14:15], 53
    s_cbranch_scc0 1
    s_waitcnt vmcnt(2)
    s_cmpk_ge_u32 s8, 1672
    s_cbranch_scc1 .ap_183
    s_waitcnt vmcnt(1)
.ap_183:
    s_add_u32 s63, s69, 303104
    buffer_load_dwordx4 v[244:247], v1, s[44:47], s63 offen nt
    s_and_b32 s0, s0, 0xffffff80
    s_sub_u32 s0, s0, 1024
    buffer_load_dword v28, v4, s[36:39], s0 offen sc1
    buffer_load_dwordx4 v[24:27], v9, s[36:39], s59 offen offset:0 sc1
    s_memrealtime s[8:9]
    s_waitcnt vmcnt(15)
    s_waitcnt lgkmcnt(0)
    s_sub_u32 s8, s8, s30
    s_cmpk_ge_u32 s8, 1924
    s_cbranch_scc1 .ap_184
    s_waitcnt vmcnt(9)
    s_cmpk_ge_u32 s8, 1824
    s_cbranch_scc1 .ap_184
    s_waitcnt vmcnt(5)
    s_bitcmp1_b64 s[14:15], 54
    s_cbranch_scc0 1
    s_waitcnt vmcnt(3)
    s_cmpk_ge_u32 s8, 1704
    s_cbranch_scc1 .ap_184
    s_waitcnt vmcnt(2)
.ap_184:
    s_add_u32 s63, s69, 311296
    buffer_load_dwordx4 v[248:251], v1, s[44:47], s63 offen nt
    s_memrealtime s[8:9]
    s_waitcnt vmcnt(15)
    s_waitcnt lgkmcnt(0)
    s_sub_u32 s8, s8, s30
    s_cmpk_ge_u32 s8, 1956
    s_cbranch_scc1 .ap_185
    s_waitcnt vmcnt(6)
    s_cmpk_ge_u32 s8, 1856
    s_cbranch_scc1 .ap_185
    s_waitcnt vmcnt(5)
    s_bitcmp1_b64 s[14:15], 55
    s_cbranch_scc0 1
    s_waitcnt vmcnt(3)
    s_cmpk_ge_u32 s8, 1736
    s_cbranch_scc1 .ap_185
    s_waitcnt vmcnt(1)
.ap_185:
    s_add_u32 s63, s69, 319488
    buffer_load_dwordx4 v[252:255], v1, s[44:47], s63 offen nt
    s_memrealtime s[8:9]
    s_waitcnt vmcnt(12)
    s_waitcnt lgkmcnt(0)
    s_sub_u32 s8, s8, s30
    s_cmpk_ge_u32 s8, 1988
    s_cbranch_scc1 .ap_186
    s_waitcnt vmcnt(6)
    s_cmpk_ge_u32 s8, 1888
    s_cbranch_scc1 .ap_186
    s_waitcnt vmcnt(5)
    s_bitcmp1_b64 s[14:15], 56
    s_cbranch_scc0 1
    s_waitcnt vmcnt(2)
    s_cmpk_ge_u32 s8, 1768
    s_cbranch_scc1 .ap_186
    s_waitcnt vmcnt(1)
.ap_186:
    s_add_u32 s63, s69, 393216
    buffer_load_dwordx4 v[36:39], v1, s[44:47], s63 offen nt
    s_memrealtime s[8:9]
    s_waitcnt vmcnt(12)
    s_waitcnt lgkmcnt(0)
    s_sub_u32 s8, s8, s30
    s_cmpk_ge_u32 s8, 2020
    s_cbranch_scc1 .ap_187
    s_waitcnt vmcnt(6)
    s_cmpk_ge_u32 s8, 1920
    s_cbranch_scc1 .ap_187
    s_waitcnt vmcnt(5)
    s_bitcmp1_b64 s[14:15], 57
    s_cbranch_scc0 1
    s_waitcnt vmcnt(2)
    s_cmpk_ge_u32 s8, 1800
    s_cbranch_scc1 .ap_187
    s_waitcnt vmcnt(1)
.ap_187:
    s_add_u32 s63, s69, 401408
    buffer_load_dwordx4 v[44:47], v1, s[44:47], s63 offen nt
    s_memrealtime s[8:9]
    s_waitcnt vmcnt(9)
    s_waitcnt lgkmcnt(0)
    s_sub_u32 s8, s8, s30
    s_cmpk_ge_u32 s8, 2052
    s_cbranch_scc1 .ap_188
    s_waitcnt vmcnt(6)
    s_cmpk_ge_u32 s8, 1952
    s_cbranch_scc1 .ap_188
    s_waitcnt vmcnt(4)
    s_bitcmp1_b64 s[14:15], 58
    s_cbranch_scc0 1
    s_waitcnt vmcnt(2)
    s_cmpk_ge_u32 s8, 1832
    s_cbranch_scc1 .ap_188
    s_waitcnt vmcnt(1)
.ap_188:
    s_add_u32 s63, s69, 409600
    buffer_load_dwordx4 v[52:55], v1, s[44:47], s63 offen nt
    s_waitcnt vmcnt(5)
    s_branch .gpc_190
.gp_189:
    buffer_load_dwordx4 v[24:27], v9, s[36:39], s59 offen offset:0 sc1
    s_waitcnt vmcnt(0)
.gpc_190:
    v_cmp_eq_u32 vcc, s34, v26
    s_cmp_eq_u64 vcc, -1
    s_nop 3
    s_cbranch_scc1 .gpd_191
    s_sub_u32 s35, s35, 1
    s_cbranch_scc1 .Lexit
    s_branch .Lsk_b1_3
.Lst_b1_3:
    s_branch .Lrt_b1_3
.Lsk_b1_3:
    s_sleep 1
    s_branch .gp_189
.gpd_191:
    v_cmp_eq_u32 vcc, s1, v28
    s_cmp_eq_u64 vcc, -1
    s_cselect_b32 s0, 0x800000, 0
    v_mov_b32 v16, v24
    s_nop 1
    v_max_f32_dpp v16, v16, v16 row_ror:4 row_mask:0xf bank_mask:0xf
    v_sub_f32 v17, v24, v16
    v_sub_f32 v18, v14, v16
    v_mul_f32 v17, 0x3fb8aa3b, v17
    v_mul_f32 v18, 0x3fb8aa3b, v18
    v_exp_f32 v17, v17
    v_exp_f32 v18, v18
    v_mul_f32 v17, v17, v25
    s_nop 1
    v_add_f32_dpp v17, v17, v17 row_ror:4 row_mask:0xf bank_mask:0xf
    v_rcp_f32 v19, v17
    s_nop 0
    v_fma_f32 v15, -v17, v19, 1.0
    v_fma_f32 v19, v15, v19, v19
    v_mul_f32 v18, v18, v19
    v_mul_f32 v10, v10, v18
    v_mul_f32 v11, v11, v18
    v_mul_f32 v12, v12, v18
    v_mul_f32 v13, v13, v18
    v_mov_b32_dpp v112, v10 quad_perm:[2,3,0,1] row_mask:0xf bank_mask:0xf
    v_mov_b32_dpp v113, v11 quad_perm:[2,3,0,1] row_mask:0xf bank_mask:0xf
    v_mov_b32_dpp v114, v12 quad_perm:[2,3,0,1] row_mask:0xf bank_mask:0xf
    v_mov_b32_dpp v115, v13 quad_perm:[2,3,0,1] row_mask:0xf bank_mask:0xf
    v_cvt_pk_bf16_f32 v96, v10, v112
    v_cvt_pk_bf16_f32 v100, v11, v113
    v_cvt_pk_bf16_f32 v104, v12, v114
    v_cvt_pk_bf16_f32 v108, v13, v115
    v_mov_b32_dpp v97, v96 row_ror:12 row_mask:0xf bank_mask:0xf
    v_mov_b32_dpp v101, v100 row_ror:12 row_mask:0xf bank_mask:0xf
    v_mov_b32_dpp v105, v104 row_ror:12 row_mask:0xf bank_mask:0xf
    v_mov_b32_dpp v109, v108 row_ror:12 row_mask:0xf bank_mask:0xf
    v_mov_b32_dpp v98, v96 row_ror:8 row_mask:0xf bank_mask:0xf
    v_mov_b32_dpp v102, v100 row_ror:8 row_mask:0xf bank_mask:0xf
    v_mov_b32_dpp v106, v104 row_ror:8 row_mask:0xf bank_mask:0xf
    v_mov_b32_dpp v110, v108 row_ror:8 row_mask:0xf bank_mask:0xf
    v_mov_b32_dpp v99, v96 row_ror:4 row_mask:0xf bank_mask:0xf
    v_mov_b32_dpp v103, v100 row_ror:4 row_mask:0xf bank_mask:0xf
    v_mov_b32_dpp v107, v104 row_ror:4 row_mask:0xf bank_mask:0xf
    v_mov_b32_dpp v111, v108 row_ror:4 row_mask:0xf bank_mask:0xf
    s_lshl_b32 s60, s3, 10
    s_add_u32 s60, s60, 147456
    v_lshlrev_b32 v10, 5, v0
    v_add_u32 v10, s60, v10
    s_memrealtime s[8:9]
    s_waitcnt lgkmcnt(0)
    s_sub_u32 s8, s8, s30
    s_cmpk_ge_u32 s8, 2084
    s_cbranch_scc1 .ap_192
    s_waitcnt vmcnt(5)
    s_cmpk_ge_u32 s8, 1984
    s_cbranch_scc1 .ap_192
    s_waitcnt vmcnt(4)
    s_bitcmp1_b64 s[14:15], 59
    s_cbranch_scc0 1
    s_waitcnt vmcnt(2)
    s_cmpk_ge_u32 s8, 1864
    s_cbranch_scc1 .ap_192
    s_waitcnt vmcnt(1)
.ap_192:
    s_add_u32 s63, s69, 417792
    buffer_load_dwordx4 v[60:63], v1, s[44:47], s63 offen nt
    v_perm_b32 v112, v164, v160, s94
    v_perm_b32 v113, v172, v168, s94
    v_perm_b32 v114, v180, v176, s94
    v_perm_b32 v115, v188, v184, s94
    s_nop 1
    v_mfma_f32_16x16x32_bf16 v[128:131], v[96:99], v[112:115], 0
    v_perm_b32 v116, v164, v160, s95
    v_perm_b32 v117, v172, v168, s95
    v_perm_b32 v118, v180, v176, s95
    v_perm_b32 v119, v188, v184, s95
    s_nop 1
    v_mfma_f32_16x16x32_bf16 v[132:135], v[96:99], v[116:119], 0
    v_perm_b32 v120, v165, v161, s94
    v_perm_b32 v121, v173, v169, s94
    v_perm_b32 v122, v181, v177, s94
    v_perm_b32 v123, v189, v185, s94
    s_nop 1
    v_mfma_f32_16x16x32_bf16 v[136:139], v[96:99], v[120:123], 0
    v_perm_b32 v124, v165, v161, s95
    v_perm_b32 v125, v173, v169, s95
    v_perm_b32 v126, v181, v177, s95
    v_perm_b32 v127, v189, v185, s95
    s_nop 1
    v_mfma_f32_16x16x32_bf16 v[140:143], v[96:99], v[124:127], 0
    v_perm_b32 v112, v166, v162, s94
    v_perm_b32 v113, v174, v170, s94
    v_perm_b32 v114, v182, v178, s94
    v_perm_b32 v115, v190, v186, s94
    s_nop 1
    v_mfma_f32_16x16x32_bf16 v[144:147], v[96:99], v[112:115], 0
    v_perm_b32 v116, v166, v162, s95
    v_perm_b32 v117, v174, v170, s95
    v_perm_b32 v118, v182, v178, s95
    v_perm_b32 v119, v190, v186, s95
    s_nop 1
    v_mfma_f32_16x16x32_bf16 v[148:151], v[96:99], v[116:119], 0
    v_perm_b32 v120, v167, v163, s94
    v_perm_b32 v121, v175, v171, s94
    v_perm_b32 v122, v183, v179, s94
    v_perm_b32 v123, v191, v187, s94
    s_nop 1
    v_mfma_f32_16x16x32_bf16 v[152:155], v[96:99], v[120:123], 0
    v_perm_b32 v124, v167, v163, s95
    v_perm_b32 v125, v175, v171, s95
    v_perm_b32 v126, v183, v179, s95
    v_perm_b32 v127, v191, v187, s95
    s_nop 1
    v_mfma_f32_16x16x32_bf16 v[156:159], v[96:99], v[124:127], 0
    s_memrealtime s[8:9]
    s_waitcnt lgkmcnt(0)
    s_sub_u32 s8, s8, s30
    s_cmpk_ge_u32 s8, 2116
    s_nop 3
    s_cbranch_scc1 .ap_193
    s_waitcnt vmcnt(5)
    s_cmpk_ge_u32 s8, 2016
    s_cbranch_scc1 .ap_193
    s_waitcnt vmcnt(4)
    s_bitcmp1_b64 s[14:15], 60
    s_cbranch_scc0 1
    s_waitcnt vmcnt(2)
    s_cmpk_ge_u32 s8, 1896
    s_cbranch_scc1 .ap_193
    s_waitcnt vmcnt(1)
.ap_193:
    s_add_u32 s63, s69, 425984
    buffer_load_dwordx4 v[68:71], v1, s[44:47], s63 offen nt
    v_perm_b32 v112, v196, v192, s94
    v_perm_b32 v113, v204, v200, s94
    v_perm_b32 v114, v212, v208, s94
    v_perm_b32 v115, v220, v216, s94
    s_nop 1
    v_mfma_f32_16x16x32_bf16 v[128:131], v[100:103], v[112:115], v[128:131]
    v_perm_b32 v116, v196, v192, s95
    v_perm_b32 v117, v204, v200, s95
    v_perm_b32 v118, v212, v208, s95
    v_perm_b32 v119, v220, v216, s95
    s_nop 1
    v_mfma_f32_16x16x32_bf16 v[132:135], v[100:103], v[116:119], v[132:135]
    v_perm_b32 v120, v197, v193, s94
    v_perm_b32 v121, v205, v201, s94
    v_perm_b32 v122, v213, v209, s94
    v_perm_b32 v123, v221, v217, s94
    s_nop 1
    v_mfma_f32_16x16x32_bf16 v[136:139], v[100:103], v[120:123], v[136:139]
    v_perm_b32 v124, v197, v193, s95
    v_perm_b32 v125, v205, v201, s95
    v_perm_b32 v126, v213, v209, s95
    v_perm_b32 v127, v221, v217, s95
    s_nop 1
    v_mfma_f32_16x16x32_bf16 v[140:143], v[100:103], v[124:127], v[140:143]
    v_perm_b32 v112, v198, v194, s94
    v_perm_b32 v113, v206, v202, s94
    v_perm_b32 v114, v214, v210, s94
    v_perm_b32 v115, v222, v218, s94
    s_nop 1
    v_mfma_f32_16x16x32_bf16 v[144:147], v[100:103], v[112:115], v[144:147]
    v_perm_b32 v116, v198, v194, s95
    v_perm_b32 v117, v206, v202, s95
    v_perm_b32 v118, v214, v210, s95
    v_perm_b32 v119, v222, v218, s95
    s_branch .Lsk_b1_4
.Lst_b1_4:
    s_branch .Lrt_b1_4
.Lsk_b1_4:
    s_nop 1
    v_mfma_f32_16x16x32_bf16 v[148:151], v[100:103], v[116:119], v[148:151]
    v_perm_b32 v120, v199, v195, s94
    v_perm_b32 v121, v207, v203, s94
    v_perm_b32 v122, v215, v211, s94
    v_perm_b32 v123, v223, v219, s94
    s_nop 1
    v_mfma_f32_16x16x32_bf16 v[152:155], v[100:103], v[120:123], v[152:155]
    v_perm_b32 v124, v199, v195, s95
    v_perm_b32 v125, v207, v203, s95
    v_perm_b32 v126, v215, v211, s95
    v_perm_b32 v127, v223, v219, s95
    s_nop 1
    v_mfma_f32_16x16x32_bf16 v[156:159], v[100:103], v[124:127], v[156:159]
    s_memrealtime s[8:9]
    s_waitcnt lgkmcnt(0)
    s_sub_u32 s8, s8, s30
    s_cmpk_ge_u32 s8, 2148
    s_nop 3
    s_cbranch_scc1 .ap_194
    s_waitcnt vmcnt(5)
    s_cmpk_ge_u32 s8, 2048
    s_cbranch_scc1 .ap_194
    s_waitcnt vmcnt(4)
    s_bitcmp1_b64 s[14:15], 61
    s_cbranch_scc0 1
    s_waitcnt vmcnt(2)
    s_cmpk_ge_u32 s8, 1928
    s_cbranch_scc1 .ap_194
    s_waitcnt vmcnt(1)
.ap_194:
    s_add_u32 s63, s69, 434176
    buffer_load_dwordx4 v[76:79], v1, s[44:47], s63 offen nt
    s_waitcnt vmcnt(6)
    v_perm_b32 v112, v228, v224, s94
    v_perm_b32 v113, v236, v232, s94
    v_perm_b32 v114, v244, v240, s94
    v_perm_b32 v115, v252, v248, s94
    s_nop 1
    v_mfma_f32_16x16x32_bf16 v[128:131], v[104:107], v[112:115], v[128:131]
    v_perm_b32 v116, v228, v224, s95
    v_perm_b32 v117, v236, v232, s95
    v_perm_b32 v118, v244, v240, s95
    v_perm_b32 v119, v252, v248, s95
    s_nop 1
    v_mfma_f32_16x16x32_bf16 v[132:135], v[104:107], v[116:119], v[132:135]
    v_perm_b32 v120, v229, v225, s94
    v_perm_b32 v121, v237, v233, s94
    v_perm_b32 v122, v245, v241, s94
    v_perm_b32 v123, v253, v249, s94
    s_nop 1
    v_mfma_f32_16x16x32_bf16 v[136:139], v[104:107], v[120:123], v[136:139]
    v_perm_b32 v124, v229, v225, s95
    v_perm_b32 v125, v237, v233, s95
    v_perm_b32 v126, v245, v241, s95
    v_perm_b32 v127, v253, v249, s95
    s_nop 1
    v_mfma_f32_16x16x32_bf16 v[140:143], v[104:107], v[124:127], v[140:143]
    v_perm_b32 v112, v230, v226, s94
    v_perm_b32 v113, v238, v234, s94
    v_perm_b32 v114, v246, v242, s94
    v_perm_b32 v115, v254, v250, s94
    s_nop 1
    v_mfma_f32_16x16x32_bf16 v[144:147], v[104:107], v[112:115], v[144:147]
    v_perm_b32 v116, v230, v226, s95
    v_perm_b32 v117, v238, v234, s95
    v_perm_b32 v118, v246, v242, s95
    v_perm_b32 v119, v254, v250, s95
    s_nop 1
    v_mfma_f32_16x16x32_bf16 v[148:151], v[104:107], v[116:119], v[148:151]
    v_perm_b32 v120, v231, v227, s94
    v_perm_b32 v121, v239, v235, s94
    v_perm_b32 v122, v247, v243, s94
    v_perm_b32 v123, v255, v251, s94
    s_nop 1
    v_mfma_f32_16x16x32_bf16 v[152:155], v[104:107], v[120:123], v[152:155]
    v_perm_b32 v124, v231, v227, s95
    v_perm_b32 v125, v239, v235, s95
    v_perm_b32 v126, v247, v243, s95
    v_perm_b32 v127, v255, v251, s95
    s_nop 1
    v_mfma_f32_16x16x32_bf16 v[156:159], v[104:107], v[124:127], v[156:159]
    s_memrealtime s[8:9]
    s_waitcnt lgkmcnt(0)
    s_sub_u32 s8, s8, s30
    s_cmpk_ge_u32 s8, 2180
    s_nop 3
    s_cbranch_scc1 .ap_195
    s_waitcnt vmcnt(5)
    s_cmpk_ge_u32 s8, 2080
    s_cbranch_scc1 .ap_195
    s_waitcnt vmcnt(4)
    s_bitcmp1_b64 s[14:15], 62
    s_cbranch_scc0 1
    s_waitcnt vmcnt(2)
    s_cmpk_ge_u32 s8, 1960
    s_cbranch_scc1 .ap_195
    s_waitcnt vmcnt(1)
.ap_195:
    s_add_u32 s63, s69, 442368
    buffer_load_dwordx4 v[84:87], v1, s[44:47], s63 offen nt
    s_memrealtime s[8:9]
    s_waitcnt lgkmcnt(0)
    s_sub_u32 s8, s8, s30
    s_cmpk_ge_u32 s8, 2212
    s_cbranch_scc1 .ap_196
    s_waitcnt vmcnt(5)
    s_cmpk_ge_u32 s8, 2112
    s_cbranch_scc1 .ap_196
    s_waitcnt vmcnt(4)
    s_bitcmp1_b64 s[14:15], 63
    s_cbranch_scc0 1
    s_waitcnt vmcnt(2)
    s_cmpk_ge_u32 s8, 1992
    s_cbranch_scc1 .ap_196
    s_waitcnt vmcnt(1)
.ap_196:
    s_add_u32 s63, s69, 450560
    buffer_load_dwordx4 v[92:95], v1, s[44:47], s63 offen nt
    s_setprio 0
    s_waitcnt vmcnt(6)
    v_perm_b32 v160, v44, v36, s94
    v_perm_b32 v164, v44, v36, s95
    v_perm_b32 v168, v45, v37, s94
    v_perm_b32 v172, v45, v37, s95
    v_perm_b32 v176, v46, v38, s94
    v_perm_b32 v180, v46, v38, s95
    v_perm_b32 v184, v47, v39, s94
    v_perm_b32 v188, v47, v39, s95
    s_waitcnt vmcnt(4)
    v_perm_b32 v161, v60, v52, s94
    v_perm_b32 v165, v60, v52, s95
    v_perm_b32 v169, v61, v53, s94
    v_perm_b32 v173, v61, v53, s95
    v_perm_b32 v177, v62, v54, s94
    v_perm_b32 v181, v62, v54, s95
    v_perm_b32 v185, v63, v55, s94
    v_perm_b32 v189, v63, v55, s95
    s_waitcnt vmcnt(2)
    v_perm_b32 v162, v76, v68, s94
    v_perm_b32 v166, v76, v68, s95
    v_perm_b32 v170, v77, v69, s94
    v_perm_b32 v174, v77, v69, s95
    v_perm_b32 v178, v78, v70, s94
    v_perm_b32 v182, v78, v70, s95
    v_perm_b32 v186, v79, v71, s94
    v_perm_b32 v190, v79, v71, s95
    s_branch .Lsk_b1_5
    .fill 42, 4, 0xbf800000
.Lst_b1_5:
    s_branch .Lrt_b1_5
.Lsk_b1_5:
    s_waitcnt vmcnt(0)
    s_add_u32 m0, s101, 90112
    s_add_u32 s56, s100, 1179648
    buffer_load_dwordx4 v6, s[52:55], s56 offen nt lds
    s_add_u32 m0, s101, 98304
    s_add_u32 s56, s100, 1769472
    buffer_load_dwordx4 v6, s[52:55], s56 offen nt lds
    s_add_u32 m0, s101, 106496
    s_add_u32 s56, s100, 2359296
    buffer_load_dwordx4 v6, s[52:55], s56 offen nt lds
    s_add_u32 m0, s101, 114688
    s_add_u32 s56, s100, 2949120
    buffer_load_dwordx4 v6, s[52:55], s56 offen nt lds
    v_perm_b32 v163, v92, v84, s94
    v_perm_b32 v167, v92, v84, s95
    v_perm_b32 v171, v93, v85, s94
    v_mfma_f32_16x16x32_bf16 v[128:131], v[108:111], v[160:163], v[128:131]
    v_perm_b32 v175, v93, v85, s95
    v_mfma_f32_16x16x32_bf16 v[132:135], v[108:111], v[164:167], v[132:135]
    v_perm_b32 v179, v94, v86, s94
    v_mfma_f32_16x16x32_bf16 v[136:139], v[108:111], v[168:171], v[136:139]
    v_perm_b32 v183, v94, v86, s95
    v_mfma_f32_16x16x32_bf16 v[140:143], v[108:111], v[172:175], v[140:143]
    v_perm_b32 v187, v95, v87, s94
    v_mfma_f32_16x16x32_bf16 v[144:147], v[108:111], v[176:179], v[144:147]
    v_perm_b32 v191, v95, v87, s95
    v_mfma_f32_16x16x32_bf16 v[148:151], v[108:111], v[180:183], v[148:151]
    v_mfma_f32_16x16x32_bf16 v[152:155], v[108:111], v[184:187], v[152:155]
    v_mfma_f32_16x16x32_bf16 v[156:159], v[108:111], v[188:191], v[156:159]
    s_mov_b64 exec, 0xffff
    ds_write2_b32 v10, v128, v129 offset0:0 offset1:128
    ds_write2_b32 v10, v132, v133 offset0:1 offset1:129
    ds_write2_b32 v10, v136, v137 offset0:2 offset1:130
    ds_write2_b32 v10, v140, v141 offset0:3 offset1:131
    ds_write2_b32 v10, v144, v145 offset0:4 offset1:132
    ds_write2_b32 v10, v148, v149 offset0:5 offset1:133
    ds_write2_b32 v10, v152, v153 offset0:6 offset1:134
    ds_write2_b32 v10, v156, v157 offset0:7 offset1:135
    s_mov_b64 exec, -1
    s_waitcnt lgkmcnt(0)
    s_barrier
    s_cmp_lg_u32 s3, 7
    s_cbranch_scc1 .opub_197
    v_add_u32 v10, 147456, v2
    ds_read_b128 v[196:199], v10 offset:0
    ds_read_b128 v[200:203], v10 offset:1024
    ds_read_b128 v[204:207], v10 offset:2048
    ds_read_b128 v[208:211], v10 offset:3072
    ds_read_b128 v[212:215], v10 offset:4096
    ds_read_b128 v[216:219], v10 offset:5120
    ds_read_b128 v[220:223], v10 offset:6144
    ds_read_b128 v[224:227], v10 offset:7168
    v_lshrrev_b32 v11, 5, v0
    v_lshlrev_b32 v11, 13, v11
    v_and_b32 v12, 31, v0
    v_lshl_add_u32 v11, v12, 4, v11
    s_lshl4_add_u32 s56, s67, s66
    s_lshl1_add_u32 s56, s56, s68
    s_lshl_b32 s56, s56, 9
    s_add_u32 s56, s56, 0xa0000
    s_mov_b32 s60, 0x07060503
    s_mov_b32 s61, 0x07060502
    s_mov_b32 s62, 0x07060501
    v_mov_b32 v15, s34
    s_waitcnt lgkmcnt(6)
    v_pk_add_f32 v[196:197], v[196:197], v[200:201]
    v_pk_add_f32 v[198:199], v[198:199], v[202:203]
    s_waitcnt lgkmcnt(5)
    v_pk_add_f32 v[196:197], v[196:197], v[204:205]
    v_pk_add_f32 v[198:199], v[198:199], v[206:207]
    s_waitcnt lgkmcnt(4)
    v_pk_add_f32 v[196:197], v[196:197], v[208:209]
    v_pk_add_f32 v[198:199], v[198:199], v[210:211]
    s_waitcnt lgkmcnt(3)
    v_pk_add_f32 v[196:197], v[196:197], v[212:213]
    v_pk_add_f32 v[198:199], v[198:199], v[214:215]
    s_waitcnt lgkmcnt(2)
    v_pk_add_f32 v[196:197], v[196:197], v[216:217]
    v_pk_add_f32 v[198:199], v[198:199], v[218:219]
    s_waitcnt lgkmcnt(1)
    v_pk_add_f32 v[196:197], v[196:197], v[220:221]
    v_pk_add_f32 v[198:199], v[198:199], v[222:223]
    s_waitcnt lgkmcnt(0)
    v_pk_add_f32 v[196:197], v[196:197], v[224:225]
    v_pk_add_f32 v[198:199], v[198:199], v[226:227]
    v_perm_b32 v12, v196, v199, s60
    v_perm_b32 v13, v197, v199, s61
    v_perm_b32 v14, v198, v199, s62
    s_add_u32 s57, s56, 0x800000
    buffer_store_dwordx4 v[12:15], v11, s[36:39], s57 offen
    s_cmp_lg_u32 s0, 0
    s_nop 0
    s_cbranch_scc1 .nosl_198
    buffer_store_dwordx4 v[12:15], v11, s[36:39], s56 offen sc1
.nosl_198:
.opub_197:
    s_mov_b32 s61, s101
    v_lshrrev_b32 v25, 4, v0
    v_bfe_u32 v26, v0, 1, 1
    v_lshl_add_u32 v25, v25, 1, v26
    v_bfe_u32 v26, v0, 2, 2
    v_lshl_add_u32 v19, v25, 3, v26
    v_lshlrev_b32 v19, 7, v19
    v_and_b32 v25, 3, v25
    v_lshrrev_b32 v26, 1, v26
    v_lshl_add_u32 v25, v25, 1, v26
    v_xor_b32 v25, s3, v25
    v_lshl_add_u32 v19, v25, 4, v19
    v_and_b32 v25, 1, v0
    v_lshl_add_u32 v19, v25, 3, v19
    v_add_u32 v20, 32768, v19
    ds_read_b64_tr_b16 v[160:161], v19 offset:0
    ds_read_b64_tr_b16 v[162:163], v19 offset:512
    ds_read_b64_tr_b16 v[168:169], v19 offset:8192
    ds_read_b64_tr_b16 v[170:171], v19 offset:8704
    ds_read_b64_tr_b16 v[176:177], v19 offset:16384
    ds_read_b64_tr_b16 v[178:179], v19 offset:16896
    ds_read_b64_tr_b16 v[184:185], v19 offset:24576
    ds_read_b64_tr_b16 v[186:187], v19 offset:25088
    ds_read_b64_tr_b16 v[192:193], v20 offset:0
    s_branch .Lsk_b1_6
.Lst_b1_6:
    s_branch .Lrt_b1_6
.Lsk_b1_6:
    ds_read_b64_tr_b16 v[194:195], v20 offset:512
    ds_read_b64_tr_b16 v[200:201], v20 offset:8192
    ds_read_b64_tr_b16 v[202:203], v20 offset:8704
    ds_read_b64_tr_b16 v[208:209], v20 offset:16384
    ds_read_b64_tr_b16 v[210:211], v20 offset:16896
    ds_read_b64_tr_b16 v[216:217], v20 offset:24576
    ds_read_b64_tr_b16 v[218:219], v20 offset:25088
    ds_read_b64_tr_b16 v[224:225], v20 offset:32768
    ds_read_b64_tr_b16 v[226:227], v20 offset:33280
    v_add_u32 v19, 73728, v19
    v_add_u32 v20, 73728, v20
    s_mov_b32 s48, s22
    s_and_b32 s49, s23, 0xffff
    s_mov_b32 s50, 0x510000
    s_mov_b32 s51, 0x00020000
    s_mul_i32 s69, s99, 73728
    s_mul_i32 s56, s3, 9216
    s_add_u32 s69, s69, s56
    v_bfe_u32 v25, v0, 4, 1
    s_and_b32 s56, s3, 1
    s_lshl_b32 s56, s56, 2
    v_lshl_or_b32 v25, v25, 1, s56
    v_and_b32 v26, 7, v0
    v_xor_b32 v25, v25, v26
    v_lshrrev_b32 v26, 3, v0
    v_mul_u32_u24 v26, 1152, v26
    v_lshl_add_u32 v24, v25, 4, v26
    s_and_b32 s58, s64, 0
    s_mul_i32 s58, s58, 18432
    s_mul_i32 s59, s3, 2304
    s_add_u32 s58, s58, s59
    s_add_u32 s62, s58, 0x37000
    s_add_u32 s63, s58, 0x49000
    s_mul_i32 s101, s64, 18432
    s_add_u32 s101, s101, s59
    s_add_u32 s101, s101, 0x170000
    s_waitcnt lgkmcnt(0)
    s_barrier
    s_add_u32 m0, s61, 122880
    s_add_u32 s56, s100, 3538944
    buffer_load_dwordx4 v6, s[52:55], s56 offen nt lds
    s_add_u32 m0, s61, 131072
    s_add_u32 s56, s100, 4128768
    buffer_load_dwordx4 v6, s[52:55], s56 offen nt lds
    s_add_u32 m0, s61, 139264
    s_add_u32 s56, s100, 4718592
    buffer_load_dwordx4 v6, s[52:55], s56 offen nt lds
    s_add_u32 m0, s61, 0
    s_nop 0
    buffer_load_dwordx4 v24, s[48:51], s69 offen offset:0 nt lds
    s_add_u32 m0, s61, 8064
    s_nop 0
    buffer_load_dwordx4 v24, s[48:51], s69 offen offset:128 nt lds
    s_add_u32 m0, s61, 16128
    s_nop 0
    buffer_load_dwordx4 v24, s[48:51], s69 offen offset:256 nt lds
    s_add_u32 m0, s61, 24192
    s_nop 0
    buffer_load_dwordx4 v24, s[48:51], s69 offen offset:384 nt lds
    s_add_u32 m0, s61, 32256
    s_nop 0
    buffer_load_dwordx4 v24, s[48:51], s69 offen offset:512 nt lds
    s_add_u32 m0, s61, 40320
    s_nop 0
    buffer_load_dwordx4 v24, s[48:51], s69 offen offset:640 nt lds
    s_add_u32 m0, s61, 48384
    s_nop 0
    buffer_load_dwordx4 v24, s[48:51], s69 offen offset:768 nt lds
    s_add_u32 m0, s61, 56448
    s_nop 0
    buffer_load_dwordx4 v24, s[48:51], s69 offen offset:896 nt lds
    s_add_u32 m0, s61, 64512
    s_nop 0
    buffer_load_dwordx4 v24, s[48:51], s69 offen offset:1024 nt lds
    v_bfe_u32 v16, v0, 1, 3
    v_mul_u32_u24 v16, 1312, v16
    v_lshrrev_b32 v25, 4, v0
    v_lshl_add_u32 v16, v25, 5, v16
    v_and_b32 v25, 1, v0
    v_lshl_add_u32 v16, v25, 4, v16
    v_add_u32 v16, 147456, v16
    s_mul_i32 s56, s3, 1312
    s_add_u32 s56, s56, 147456
    v_add_u32 v17, s56, v3
    v_add_u32 v18, s56, v4
    v_bfe_u32 v21, v0, 1, 3
    v_mul_u32_u24 v21, 144, v21
    v_bfe_u32 v25, v0, 4, 1
    v_lshl_add_u32 v21, v25, 3, v21
    v_lshrrev_b32 v25, 5, v0
    v_lshl_add_u32 v21, v25, 2, v21
    v_and_b32 v25, 1, v0
    v_lshl_add_u32 v21, v25, 1, v21
    s_lshl_b32 s56, s3, 4
    s_add_u32 s56, s56, 157952
    v_add_u32 v21, s56, v21
    v_and_b32 v22, 15, v0
    v_lshlrev_b32 v22, 3, v22
    s_mul_i32 s56, s3, 144
    s_add_u32 s56, s56, 157952
    v_add_u32 v22, s56, v22
    s_mul_i32 s56, s3, 1312
    s_add_u32 s56, s56, 147456
    v_mov_b32 v17, s56
    v_bfe_u32 v25, v0, 4, 2
    v_lshl_add_u32 v17, v25, 7, v17
    v_bfe_u32 v25, v0, 1, 1
    v_lshl_add_u32 v17, v25, 6, v17
    v_bfe_u32 v25, v0, 3, 1
    v_lshl_add_u32 v17, v25, 5, v17
    v_bfe_u32 v25, v0, 2, 1
    v_lshl_add_u32 v17, v25, 3, v17
    v_bfe_u32 v25, v0, 0, 1
    v_lshl_add_u32 v17, v25, 2, v17
    s_add_u32 s56, s56, 1024
    v_mov_b32 v18, s56
    v_bfe_u32 v25, v0, 2, 1
    v_lshl_add_u32 v18, v25, 6, v18
    v_bfe_u32 v25, v0, 4, 1
    v_lshl_add_u32 v18, v25, 5, v18
    v_bfe_u32 v25, v0, 0, 1
    v_lshl_add_u32 v18, v25, 4, v18
    v_bfe_u32 v25, v0, 3, 1
    v_lshl_add_u32 v18, v25, 3, v18
    v_bfe_u32 v25, v0, 1, 1
    v_lshl_add_u32 v18, v25, 2, v18
    v_lshrrev_b32 v25, 3, v0
    v_mul_u32_u24 v21, 144, v25
    v_and_b32 v25, 7, v0
    v_lshl_add_u32 v21, v25, 1, v21
    s_lshl_b32 s56, s3, 4
    v_lshrrev_b32 v25, 3, v0
    v_mul_u32_u24 v26, 144, v25
    v_mov_b32 v21, v26
    v_bfe_u32 v25, v0, 1, 1
    v_lshl_add_u32 v21, v25, 4, v21
    v_bfe_u32 v25, v0, 2, 1
    v_lshl_add_u32 v21, v25, 2, v21
    v_bfe_u32 v25, v0, 0, 1
    v_lshl_add_u32 v21, v25, 1, v21
    s_and_b32 s57, s3, 1
    s_lshl_b32 s57, s57, 3
    s_sub_u32 s56, s56, s57
    s_add_u32 s56, s56, 157952
    v_add_u32 v21, s56, v21
    v_mov_b32 v156, 0x4444
    v_mov_b32 v25, 0xeeee
    v_cndmask_b32 v156, v156, v25, s[96:97]
    v_mov_b32 v152, 0
    v_mov_b32 v153, 0
    v_mov_b32 v154, 0
    v_mov_b32 v155, 0
    v_mov_b32 v232, 0
    v_mov_b32 v233, 0
    v_mov_b32 v234, 0
    v_mov_b32 v235, 0
    v_mov_b32 v236, 0
    v_mov_b32 v237, 0
    v_mov_b32 v238, 0
    v_mov_b32 v239, 0
    v_mov_b32 v240, 0
    v_mov_b32 v241, 0
    v_mov_b32 v242, 0
    v_mov_b32 v243, 0
    v_mov_b32 v244, 0
    v_mov_b32 v245, 0
    s_branch .Lsk_b1_7
.Lst_b1_7:
    s_branch .Lrt_b1_7
.Lsk_b1_7:
    v_mov_b32 v246, 0
    v_mov_b32 v247, 0
    v_mov_b32 v248, 0
    v_mov_b32 v249, 0
    v_mov_b32 v250, 0
    v_mov_b32 v251, 0
    v_mov_b32 v252, 0
    v_mov_b32 v253, 0
    v_mov_b32 v254, 0
    v_mov_b32 v255, 0
    s_mov_b32 s56, 157952
    v_bfe_u32 v22, v0, 1, 3
    v_mul_u32_u24 v22, 144, v22
    v_and_b32 v25, 48, v0
    v_lshl_add_u32 v22, v25, 1, v22
    v_and_b32 v25, 1, v0
    v_lshlrev_b32 v25, 4, v25
    v_add3_u32 v22, v22, v25, s56
    v_lshrrev_b32 v23, 4, v0
    v_and_b32 v25, 1, v0
    v_lshl_add_u32 v23, v23, 1, v25
    v_mul_u32_u24 v23, 9216, v23
    v_bfe_u32 v25, v0, 1, 3
    v_lshl_add_u32 v23, v25, 4, v23
    v_lshrrev_b32 v25, 4, v0
    v_bfe_u32 v26, v0, 2, 2
    v_lshl_add_u32 v28, v25, 3, v26
    v_lshlrev_b32 v28, 7, v28
    v_and_b32 v25, 1, v25
    v_lshrrev_b32 v26, 1, v26
    v_lshl_add_u32 v25, v25, 1, v26
    s_and_b32 s56, s3, 1
    s_lshl_b32 s56, s56, 1
    v_xor_b32 v25, s56, v25
    v_and_b32 v26, 3, v0
    v_lshl_add_u32 v28, v26, 3, v28
    s_lshr_b32 s56, s3, 1
    s_lshl_b32 s56, s56, 13
    v_add_u32 v28, s56, v28
    v_xor_b32 v26, 1, v25
    v_lshl_add_u32 v29, v26, 5, v28
    v_lshl_add_u32 v28, v25, 5, v28
    v_add_u32 v30, 0x10000, v28
    v_add_u32 v31, 0x10000, v29
    s_mul_i32 s59, s3, 73728
    s_lshl_b32 s56, s99, 7
    s_add_u32 s59, s59, s56
    s_add_u32 s59, s59, 0x1a0000
    s_add_u32 s99, s59, 589824
    s_add_u32 s100, s59, 1179648
    s_branch .gpc_200
.gp_199:
    buffer_load_dwordx4 v[32:35], v2, s[36:39], s62 offen offset:0 sc1
    buffer_load_dwordx4 v[40:43], v2, s[36:39], s62 offen offset:1024 sc1
    buffer_load_dwordx2 v[48:49], v5, s[36:39], s62 offen offset:0 sc1
    buffer_load_dwordx4 v[56:59], v2, s[36:39], s63 offen offset:0 sc1
    buffer_load_dwordx4 v[64:67], v2, s[36:39], s63 offen offset:1024 sc1
    buffer_load_dwordx2 v[72:73], v5, s[36:39], s63 offen offset:0 sc1
    s_waitcnt vmcnt(0)
.gpc_200:
    v_min_u32 v25, v33, v35
    v_max_u32 v26, v33, v35
    v_min3_u32 v25, v25, v41, v43
    v_max3_u32 v26, v26, v41, v43
    v_min3_u32 v25, v25, v49, v57
    v_max3_u32 v26, v26, v49, v57
    v_min3_u32 v25, v25, v59, v65
    v_max3_u32 v26, v26, v59, v65
    v_min3_u32 v25, v25, v67, v73
    v_max3_u32 v26, v26, v67, v73
    v_cmp_eq_u32 vcc, s34, v25
    v_cmp_eq_u32 s[56:57], s34, v26
    s_and_b64 vcc, vcc, s[56:57]
    s_cmp_eq_u64 vcc, -1
    s_nop 2
    s_cbranch_scc1 .gpd_201
    s_sub_u32 s35, s35, 1
    s_cbranch_scc1 .Lexit
    s_sleep 2
    s_branch .gp_199
.gpd_201:
    v_lshlrev_b32 v78, 16, v32
    v_and_b32 v79, 0xffff0000, v32
    v_lshlrev_b32 v88, 16, v56
    v_and_b32 v89, 0xffff0000, v56
    v_lshlrev_b32 v80, 16, v34
    v_and_b32 v81, 0xffff0000, v34
    v_lshlrev_b32 v90, 16, v58
    v_and_b32 v91, 0xffff0000, v58
    v_lshlrev_b32 v82, 16, v40
    v_and_b32 v83, 0xffff0000, v40
    v_lshlrev_b32 v92, 16, v64
    v_and_b32 v93, 0xffff0000, v64
    v_lshlrev_b32 v84, 16, v42
    v_and_b32 v85, 0xffff0000, v42
    v_lshlrev_b32 v94, 16, v66
    v_and_b32 v95, 0xffff0000, v66
    v_lshlrev_b32 v86, 16, v48
    v_and_b32 v87, 0xffff0000, v48
    v_lshlrev_b32 v96, 16, v72
    v_and_b32 v97, 0xffff0000, v72
    s_waitcnt vmcnt(9)
    s_barrier
    ds_read_b64_tr_b16 v[164:165], v19 offset:0
    ds_read_b64_tr_b16 v[166:167], v19 offset:512
    ds_read_b64_tr_b16 v[172:173], v19 offset:8192
    ds_read_b64_tr_b16 v[174:175], v19 offset:8704
    ds_read_b64_tr_b16 v[180:181], v19 offset:16384
    ds_read_b64_tr_b16 v[182:183], v19 offset:16896
    ds_read_b64_tr_b16 v[188:189], v19 offset:24576
    ds_read_b64_tr_b16 v[190:191], v19 offset:25088
    ds_read_b64_tr_b16 v[196:197], v20 offset:0
    ds_read_b64_tr_b16 v[198:199], v20 offset:512
    ds_read_b64_tr_b16 v[204:205], v20 offset:8192
    ds_read_b64_tr_b16 v[206:207], v20 offset:8704
    ds_read_b64_tr_b16 v[212:213], v20 offset:16384
    ds_read_b64_tr_b16 v[214:215], v20 offset:16896
    ds_read_b64_tr_b16 v[220:221], v20 offset:24576
    ds_read_b64_tr_b16 v[222:223], v20 offset:25088
    ds_read_b64_tr_b16 v[228:229], v20 offset:32768
    ds_read_b64_tr_b16 v[230:231], v20 offset:33280
    s_waitcnt lgkmcnt(0)
    v_mov_b32 v8, v160
    v_mov_b32 v9, v161
    v_mov_b32 v10, v162
    v_mov_b32 v11, v163
    v_mov_b32_dpp v160, v164 row_ror:8 row_mask:0xf bank_mask:0xc
    v_mov_b32_dpp v161, v165 row_ror:8 row_mask:0xf bank_mask:0xc
    v_mov_b32_dpp v162, v166 row_ror:8 row_mask:0xf bank_mask:0xc
    v_mov_b32_dpp v163, v167 row_ror:8 row_mask:0xf bank_mask:0xc
    v_mov_b32_dpp v164, v8 row_ror:8 row_mask:0xf bank_mask:0x3
    v_mov_b32_dpp v165, v9 row_ror:8 row_mask:0xf bank_mask:0x3
    v_mov_b32_dpp v166, v10 row_ror:8 row_mask:0xf bank_mask:0x3
    v_mov_b32_dpp v167, v11 row_ror:8 row_mask:0xf bank_mask:0x3
    v_mov_b32 v8, v168
    v_mov_b32 v9, v169
    v_mov_b32 v10, v170
    v_mov_b32 v11, v171
    v_mov_b32_dpp v168, v172 row_ror:8 row_mask:0xf bank_mask:0xc
    v_mov_b32_dpp v169, v173 row_ror:8 row_mask:0xf bank_mask:0xc
    v_mov_b32_dpp v170, v174 row_ror:8 row_mask:0xf bank_mask:0xc
    v_mov_b32_dpp v171, v175 row_ror:8 row_mask:0xf bank_mask:0xc
    v_mov_b32_dpp v172, v8 row_ror:8 row_mask:0xf bank_mask:0x3
    v_mov_b32_dpp v173, v9 row_ror:8 row_mask:0xf bank_mask:0x3
    v_mov_b32_dpp v174, v10 row_ror:8 row_mask:0xf bank_mask:0x3
    v_mov_b32_dpp v175, v11 row_ror:8 row_mask:0xf bank_mask:0x3
    v_mov_b32 v8, v176
    v_mov_b32 v9, v177
    v_mov_b32 v10, v178
    v_mov_b32 v11, v179
    v_mov_b32_dpp v176, v180 row_ror:8 row_mask:0xf bank_mask:0xc
    v_mov_b32_dpp v177, v181 row_ror:8 row_mask:0xf bank_mask:0xc
    v_mov_b32_dpp v178, v182 row_ror:8 row_mask:0xf bank_mask:0xc
    v_mov_b32_dpp v179, v183 row_ror:8 row_mask:0xf bank_mask:0xc
    v_mov_b32_dpp v180, v8 row_ror:8 row_mask:0xf bank_mask:0x3
    v_mov_b32_dpp v181, v9 row_ror:8 row_mask:0xf bank_mask:0x3
    v_mov_b32_dpp v182, v10 row_ror:8 row_mask:0xf bank_mask:0x3
    v_mov_b32_dpp v183, v11 row_ror:8 row_mask:0xf bank_mask:0x3
    v_mov_b32 v8, v184
    v_mov_b32 v9, v185
    v_mov_b32 v10, v186
    v_mov_b32 v11, v187
    v_mov_b32_dpp v184, v188 row_ror:8 row_mask:0xf bank_mask:0xc
    v_mov_b32_dpp v185, v189 row_ror:8 row_mask:0xf bank_mask:0xc
    v_mov_b32_dpp v186, v190 row_ror:8 row_mask:0xf bank_mask:0xc
    v_mov_b32_dpp v187, v191 row_ror:8 row_mask:0xf bank_mask:0xc
    v_mov_b32_dpp v188, v8 row_ror:8 row_mask:0xf bank_mask:0x3
    v_mov_b32_dpp v189, v9 row_ror:8 row_mask:0xf bank_mask:0x3
    v_mov_b32_dpp v190, v10 row_ror:8 row_mask:0xf bank_mask:0x3
    v_mov_b32_dpp v191, v11 row_ror:8 row_mask:0xf bank_mask:0x3
    v_mov_b32 v8, v192
    v_mov_b32 v9, v193
    v_mov_b32 v10, v194
    v_mov_b32 v11, v195
    v_mov_b32_dpp v192, v196 row_ror:8 row_mask:0xf bank_mask:0xc
    v_mov_b32_dpp v193, v197 row_ror:8 row_mask:0xf bank_mask:0xc
    s_branch .Lsk_b2_0
.Lst_b2_0:
    s_branch .Lrt_b2_0
.Lsk_b2_0:
    v_mov_b32_dpp v194, v198 row_ror:8 row_mask:0xf bank_mask:0xc
    v_mov_b32_dpp v195, v199 row_ror:8 row_mask:0xf bank_mask:0xc
    v_mov_b32_dpp v196, v8 row_ror:8 row_mask:0xf bank_mask:0x3
    v_mov_b32_dpp v197, v9 row_ror:8 row_mask:0xf bank_mask:0x3
    v_mov_b32_dpp v198, v10 row_ror:8 row_mask:0xf bank_mask:0x3
    v_mov_b32_dpp v199, v11 row_ror:8 row_mask:0xf bank_mask:0x3
    v_mov_b32 v8, v200
    v_mov_b32 v9, v201
    v_mov_b32 v10, v202
    v_mov_b32 v11, v203
    v_mov_b32_dpp v200, v204 row_ror:8 row_mask:0xf bank_mask:0xc
    v_mov_b32_dpp v201, v205 row_ror:8 row_mask:0xf bank_mask:0xc
    v_mov_b32_dpp v202, v206 row_ror:8 row_mask:0xf bank_mask:0xc
    v_mov_b32_dpp v203, v207 row_ror:8 row_mask:0xf bank_mask:0xc
    v_mov_b32_dpp v204, v8 row_ror:8 row_mask:0xf bank_mask:0x3
    v_mov_b32_dpp v205, v9 row_ror:8 row_mask:0xf bank_mask:0x3
    v_mov_b32_dpp v206, v10 row_ror:8 row_mask:0xf bank_mask:0x3
    v_mov_b32_dpp v207, v11 row_ror:8 row_mask:0xf bank_mask:0x3
    v_mov_b32 v8, v208
    v_mov_b32 v9, v209
    v_mov_b32 v10, v210
    v_mov_b32 v11, v211
    v_mov_b32_dpp v208, v212 row_ror:8 row_mask:0xf bank_mask:0xc
    v_mov_b32_dpp v209, v213 row_ror:8 row_mask:0xf bank_mask:0xc
    v_mov_b32_dpp v210, v214 row_ror:8 row_mask:0xf bank_mask:0xc
    v_mov_b32_dpp v211, v215 row_ror:8 row_mask:0xf bank_mask:0xc
    v_mov_b32_dpp v212, v8 row_ror:8 row_mask:0xf bank_mask:0x3
    v_mov_b32_dpp v213, v9 row_ror:8 row_mask:0xf bank_mask:0x3
    v_mov_b32_dpp v214, v10 row_ror:8 row_mask:0xf bank_mask:0x3
    v_mov_b32_dpp v215, v11 row_ror:8 row_mask:0xf bank_mask:0x3
    v_mov_b32 v8, v216
    v_mov_b32 v9, v217
    v_mov_b32 v10, v218
    v_mov_b32 v11, v219
    v_mov_b32_dpp v216, v220 row_ror:8 row_mask:0xf bank_mask:0xc
    v_mov_b32_dpp v217, v221 row_ror:8 row_mask:0xf bank_mask:0xc
    v_mov_b32_dpp v218, v222 row_ror:8 row_mask:0xf bank_mask:0xc
    v_mov_b32_dpp v219, v223 row_ror:8 row_mask:0xf bank_mask:0xc
    v_mov_b32_dpp v220, v8 row_ror:8 row_mask:0xf bank_mask:0x3
    v_mov_b32_dpp v221, v9 row_ror:8 row_mask:0xf bank_mask:0x3
    v_mov_b32_dpp v222, v10 row_ror:8 row_mask:0xf bank_mask:0x3
    v_mov_b32_dpp v223, v11 row_ror:8 row_mask:0xf bank_mask:0x3
    v_mov_b32 v8, v224
    v_mov_b32 v9, v225
    v_mov_b32 v10, v226
    v_mov_b32 v11, v227
    v_mov_b32_dpp v224, v228 row_ror:8 row_mask:0xf bank_mask:0xc
    v_mov_b32_dpp v225, v229 row_ror:8 row_mask:0xf bank_mask:0xc
    v_mov_b32_dpp v226, v230 row_ror:8 row_mask:0xf bank_mask:0xc
    v_mov_b32_dpp v227, v231 row_ror:8 row_mask:0xf bank_mask:0xc
    v_mov_b32_dpp v228, v8 row_ror:8 row_mask:0xf bank_mask:0x3
    v_mov_b32_dpp v229, v9 row_ror:8 row_mask:0xf bank_mask:0x3
    v_mov_b32_dpp v230, v10 row_ror:8 row_mask:0xf bank_mask:0x3
    v_mov_b32_dpp v231, v11 row_ror:8 row_mask:0xf bank_mask:0x3
    s_waitcnt vmcnt(0)
    s_barrier
    ds_read_b64_tr_b16 v[104:105], v28 offset:0
    ds_read_b64_tr_b16 v[106:107], v28 offset:512
    ds_read_b64_tr_b16 v[112:113], v29 offset:0
    ds_read_b64_tr_b16 v[114:115], v29 offset:512
    ds_read_b64_tr_b16 v[108:109], v28 offset:4096
    ds_read_b64_tr_b16 v[110:111], v28 offset:4608
    ds_read_b64_tr_b16 v[116:117], v29 offset:4096
    ds_read_b64_tr_b16 v[118:119], v29 offset:4608
    ds_read_b64_tr_b16 v[120:121], v28 offset:32768
    ds_read_b64_tr_b16 v[122:123], v28 offset:33280
    ds_read_b64_tr_b16 v[128:129], v29 offset:32768
    ds_read_b64_tr_b16 v[130:131], v29 offset:33280
    ds_read_b64_tr_b16 v[124:125], v28 offset:36864
    ds_read_b64_tr_b16 v[126:127], v28 offset:37376
    ds_read_b64_tr_b16 v[132:133], v29 offset:36864
    ds_read_b64_tr_b16 v[134:135], v29 offset:37376
    s_cmp_ge_u32 s3, 2
    s_cbranch_scc1 .Lbc_nodn3
    ds_read_b64_tr_b16 v[136:137], v30 offset:0
    ds_read_b64_tr_b16 v[138:139], v30 offset:512
    ds_read_b64_tr_b16 v[144:145], v31 offset:0
    ds_read_b64_tr_b16 v[146:147], v31 offset:512
    ds_read_b64_tr_b16 v[140:141], v30 offset:4096
    ds_read_b64_tr_b16 v[142:143], v30 offset:4608
    ds_read_b64_tr_b16 v[148:149], v31 offset:4096
    ds_read_b64_tr_b16 v[150:151], v31 offset:4608
.Lbc_nodn3:
    s_branch .Lsk_b2_1
    .fill 125, 4, 0xbf800000
.Lst_b2_1:
    s_branch .Lrt_b2_1
.Lsk_b2_1:
    s_mov_b32 s69, 0
.gp_202:
    s_add_u32 s69, s69, 1
    s_and_b32 s56, s69, 0x41
    s_cmp_lg_u32 s56, 0x41
    s_cselect_b32 s56, 0, 0x800000
    s_xor_b32 s56, s56, s0
    s_add_u32 s58, s101, s56
    buffer_load_dwordx4 v[68:71], v2, s[36:39], s58 offen offset:0 sc1
    buffer_load_dwordx4 v[72:75], v2, s[36:39], s58 offen offset:1024 sc1
    buffer_load_dwordx2 v[76:77], v5, s[36:39], s58 offen offset:0 sc1
    s_waitcnt vmcnt(0)
    v_min3_u32 v25, v69, v71, v73
    v_max3_u32 v26, v69, v71, v73
    v_min3_u32 v25, v25, v75, v77
    v_max3_u32 v26, v26, v75, v77
    v_cmp_eq_u32 vcc, s34, v25
    v_cmp_eq_u32 s[56:57], s34, v26
    s_and_b64 vcc, vcc, s[56:57]
    s_cmp_eq_u64 vcc, -1
    s_nop 2
    s_cbranch_scc1 .gpd_203
    s_sub_u32 s35, s35, 1
    s_cbranch_scc1 .Lexit
    s_branch .gp_202
.gpd_203:
    s_mov_b32 s56, 0x3f803f80
    v_dot2_f32_bf16 v98, v68, s56, 0
    v_dot2_f32_bf16 v99, v68, v68, 0
    v_dot2_f32_bf16 v98, v70, s56, v98
    v_dot2_f32_bf16 v99, v70, v70, v99
    v_dot2_f32_bf16 v98, v72, s56, v98
    v_dot2_f32_bf16 v99, v72, v72, v99
    v_dot2_f32_bf16 v98, v74, s56, v98
    v_dot2_f32_bf16 v99, v74, v74, v99
    s_mov_b64 exec, 0xffffffff
    v_dot2_f32_bf16 v98, v76, s56, v98
    v_dot2_f32_bf16 v99, v76, v76, v99
    s_mov_b64 exec, -1
    s_nop 1
    v_permlane32_swap_b32 v98, v99
    v_add_f32 v98, v98, v99
    v_mov_b32 v100, v98
    s_nop 1
    v_permlane16_swap_b32 v100, v98
    v_add_f32 v98, v100, v98
    v_and_b32 v69, 0xffff0000, v68
    v_lshlrev_b32 v68, 16, v68
    v_add_f32_dpp v98, v98, v98 row_ror:8 row_mask:0xf bank_mask:0xf
    v_and_b32 v71, 0xffff0000, v70
    v_lshlrev_b32 v70, 16, v70
    v_add_f32_dpp v98, v98, v98 row_ror:4 row_mask:0xf bank_mask:0xf
    v_and_b32 v73, 0xffff0000, v72
    v_lshlrev_b32 v72, 16, v72
    v_add_f32_dpp v98, v98, v98 quad_perm:[2,3,0,1] row_mask:0xf bank_mask:0xf
    v_and_b32 v75, 0xffff0000, v74
    v_lshlrev_b32 v74, 16, v74
    v_add_f32_dpp v98, v98, v98 quad_perm:[1,0,3,2] row_mask:0xf bank_mask:0xf
    v_mul_f32 v98, 0x3ae38e39, v98
    v_and_b32 v77, 0xffff0000, v76
    v_lshlrev_b32 v76, 16, v76
    v_readlane_b32 s56, v98, 0
    v_readlane_b32 s57, v98, 32
    s_nop 0
    v_mov_b32 v98, s56
    v_fma_f32 v99, -v98, v98, s57
    v_max_f32 v99, 0, v99
    v_cvt_pk_bf16_f32 v100, -v98, v99
    v_and_b32 v101, 0xffff0000, v100
    v_add_f32 v101, 0x3727c5ac, v101
    v_lshlrev_b32 v98, 16, v100
    v_cvt_pk_bf16_f32 v101, v101, v101
    v_lshlrev_b32 v101, 16, v101
    v_sqrt_f32 v101, v101
    v_mov_b32 v99, v98
    v_cvt_pk_bf16_f32 v101, v101, v101
    v_lshlrev_b32 v101, 16, v101
    v_rcp_f32 v100, v101
    v_rcp_f32 v101, v101
    v_pk_add_f32 v[68:69], v[68:69], v[98:99]
    v_pk_add_f32 v[70:71], v[70:71], v[98:99]
    v_pk_add_f32 v[72:73], v[72:73], v[98:99]
    v_pk_add_f32 v[74:75], v[74:75], v[98:99]
    v_pk_add_f32 v[76:77], v[76:77], v[98:99]
    v_cvt_pk_bf16_f32 v68, v68, v69
    v_and_b32 v69, 0xffff0000, v68
    v_lshlrev_b32 v68, 16, v68
    v_cvt_pk_bf16_f32 v70, v70, v71
    v_and_b32 v71, 0xffff0000, v70
    v_lshlrev_b32 v70, 16, v70
    v_cvt_pk_bf16_f32 v72, v72, v73
    v_and_b32 v73, 0xffff0000, v72
    v_lshlrev_b32 v72, 16, v72
    v_cvt_pk_bf16_f32 v74, v74, v75
    v_and_b32 v75, 0xffff0000, v74
    v_lshlrev_b32 v74, 16, v74
    v_cvt_pk_bf16_f32 v76, v76, v77
    v_and_b32 v77, 0xffff0000, v76
    v_lshlrev_b32 v76, 16, v76
    v_pk_mul_f32 v[68:69], v[68:69], v[100:101]
    v_pk_mul_f32 v[70:71], v[70:71], v[100:101]
    v_pk_mul_f32 v[72:73], v[72:73], v[100:101]
    v_pk_mul_f32 v[74:75], v[74:75], v[100:101]
    v_pk_mul_f32 v[76:77], v[76:77], v[100:101]
    v_cvt_pk_bf16_f32 v68, v68, v69
    v_and_b32 v69, 0xffff0000, v68
    v_lshlrev_b32 v68, 16, v68
    v_cvt_pk_bf16_f32 v70, v70, v71
    v_and_b32 v71, 0xffff0000, v70
    v_lshlrev_b32 v70, 16, v70
    v_cvt_pk_bf16_f32 v72, v72, v73
    v_and_b32 v73, 0xffff0000, v72
    v_lshlrev_b32 v72, 16, v72
    v_cvt_pk_bf16_f32 v74, v74, v75
    v_and_b32 v75, 0xffff0000, v74
    v_lshlrev_b32 v74, 16, v74
    v_cvt_pk_bf16_f32 v76, v76, v77
    v_and_b32 v77, 0xffff0000, v76
    v_lshlrev_b32 v76, 16, v76
    v_pk_mul_f32 v[68:69], v[68:69], v[88:89]
    v_pk_mul_f32 v[70:71], v[70:71], v[90:91]
    v_pk_mul_f32 v[72:73], v[72:73], v[92:93]
    v_pk_mul_f32 v[74:75], v[74:75], v[94:95]
    v_pk_mul_f32 v[76:77], v[76:77], v[96:97]
    v_cvt_pk_bf16_f32 v68, v68, v69
    v_and_b32 v69, 0xffff0000, v68
    v_lshlrev_b32 v68, 16, v68
    v_cvt_pk_bf16_f32 v70, v70, v71
    v_and_b32 v71, 0xffff0000, v70
    s_branch .Lsk_b2_2
.Lst_b2_2:
    s_branch .Lrt_b2_2
.Lsk_b2_2:
    v_lshlrev_b32 v70, 16, v70
    v_cvt_pk_bf16_f32 v72, v72, v73
    v_and_b32 v73, 0xffff0000, v72
    v_lshlrev_b32 v72, 16, v72
    v_cvt_pk_bf16_f32 v74, v74, v75
    v_and_b32 v75, 0xffff0000, v74
    v_lshlrev_b32 v74, 16, v74
    v_cvt_pk_bf16_f32 v76, v76, v77
    v_and_b32 v77, 0xffff0000, v76
    v_lshlrev_b32 v76, 16, v76
    v_pk_add_f32 v[68:69], v[68:69], v[78:79]
    v_pk_add_f32 v[70:71], v[70:71], v[80:81]
    v_pk_add_f32 v[72:73], v[72:73], v[82:83]
    v_pk_add_f32 v[74:75], v[74:75], v[84:85]
    v_pk_add_f32 v[76:77], v[76:77], v[86:87]
    v_cvt_pk_bf16_f32 v8, v68, v69
    v_cvt_pk_bf16_f32 v9, v70, v71
    v_cvt_pk_bf16_f32 v10, v72, v73
    v_cvt_pk_bf16_f32 v11, v74, v75
    v_cvt_pk_bf16_f32 v12, v76, v77
    ds_write2_b32 v17, v8, v9 offset0:0 offset1:4
    ds_write2_b32 v17, v10, v11 offset0:128 offset1:132
    ds_write_b32 v18, v12
    s_waitcnt lgkmcnt(0)
    s_barrier
    ds_read_b128 v[32:35], v16 offset:0
    ds_read_b128 v[36:39], v16 offset:128
    ds_read_b128 v[40:43], v16 offset:256
    ds_read_b128 v[44:47], v16 offset:384
    ds_read_b128 v[48:51], v16 offset:512
    ds_read_b128 v[52:55], v16 offset:640
    ds_read_b128 v[56:59], v16 offset:768
    ds_read_b128 v[60:63], v16 offset:896
    ds_read_b128 v[64:67], v16 offset:1024
    s_waitcnt lgkmcnt(8)
    v_smfmac_f32_16x16x64_bf16 v[152:155], v[32:35], v[160:167], v156
    s_waitcnt lgkmcnt(7)
    v_smfmac_f32_16x16x64_bf16 v[152:155], v[36:39], v[168:175], v156
    s_waitcnt lgkmcnt(6)
    v_smfmac_f32_16x16x64_bf16 v[152:155], v[40:43], v[176:183], v156
    s_waitcnt lgkmcnt(5)
    v_smfmac_f32_16x16x64_bf16 v[152:155], v[44:47], v[184:191], v156
    s_waitcnt lgkmcnt(4)
    v_smfmac_f32_16x16x64_bf16 v[152:155], v[48:51], v[192:199], v156
    s_waitcnt lgkmcnt(3)
    v_smfmac_f32_16x16x64_bf16 v[152:155], v[52:55], v[200:207], v156
    s_waitcnt lgkmcnt(2)
    v_smfmac_f32_16x16x64_bf16 v[152:155], v[56:59], v[208:215], v156
    s_waitcnt lgkmcnt(1)
    v_smfmac_f32_16x16x64_bf16 v[152:155], v[60:63], v[216:223], v156
    s_waitcnt lgkmcnt(0)
    v_smfmac_f32_16x16x64_bf16 v[152:155], v[64:67], v[224:231], v156
    s_nop 7
    v_add_f32 v12, v152, v153
    v_add_f32 v13, v154, v155
    v_cvt_pk_bf16_f32 v13, v12, v13
    v_lshlrev_b32 v12, 16, v13
    v_and_b32 v14, 0xffff0000, v13
    v_mov_b32 v13, v14
    s_nop 0
    v_mov_b32_dpp v14, v12 row_ror:8 row_mask:0xf bank_mask:0x3
    v_mov_b32_dpp v12, v13 row_ror:8 row_mask:0xf bank_mask:0xc
    v_max_f32 v12, 0xc2ae0000, v12
    v_min_f32 v27, 0x43000000, v12
    v_mul_f32 v25, 0xbfb8aa3b, v27
    v_fma_f32 v26, v27, s98, -v25
    v_fmac_f32 v26, 0xb2a57060, v27
    v_exp_f32 v25, v25
    v_mul_f32 v26, 0x3f317218, v26
    v_fmac_f32 v25, v25, v26
    v_add_f32 v25, 1.0, v25
    v_rcp_f32 v26, v25
    s_nop 0
    v_mul_f32 v27, v12, v26
    v_fma_f32 v25, -v27, v25, v12
    v_fma_f32 v12, v25, v26, v27
    v_cvt_pk_bf16_f32 v12, v12, v12
    v_lshlrev_b32 v12, 16, v12
    v_mul_f32 v12, v12, v14
    v_cvt_pk_bf16_f32 v12, v12, v12
    ds_write_b16 v21, v12
    s_mov_b32 s60, 0x07060503
    s_mov_b32 s61, 0x07060502
    s_mov_b32 s62, 0x07060501
    s_mov_b32 vcc_lo, 0x55555555
    s_mov_b32 vcc_hi, 0x55555555
    v_mov_b32 v59, s34
    v_mov_b32 v63, s34
    v_mov_b32 v67, s34
    s_branch .Lsk_b2_3
    .fill 123, 4, 0xbf800000
.Lst_b2_3:
    s_branch .Lrt_b2_3
.Lsk_b2_3:
    s_cmp_ge_u32 s3, 2
    s_waitcnt lgkmcnt(0)
    s_barrier
    ds_read_b128 v[8:11], v22
    s_waitcnt lgkmcnt(0)
    v_smfmac_f32_16x16x64_bf16 v[232:235], v[8:11], v[104:111], v156
    v_smfmac_f32_16x16x64_bf16 v[236:239], v[8:11], v[112:119], v156
    v_smfmac_f32_16x16x64_bf16 v[240:243], v[8:11], v[120:127], v156
    v_smfmac_f32_16x16x64_bf16 v[244:247], v[8:11], v[128:135], v156
    s_cbranch_scc0 .Lbc_three
    s_nop 4
    v_add_f32 v232, v232, v233
    v_add_f32 v234, v234, v235
    v_add_f32 v236, v236, v237
    v_add_f32 v238, v238, v239
    s_not_b64 vcc, vcc
    v_cndmask_b32_dpp v233, v232, v234, vcc quad_perm:[1,0,3,2] row_mask:0xf bank_mask:0xf
    v_cndmask_b32_dpp v235, v236, v238, vcc quad_perm:[1,0,3,2] row_mask:0xf bank_mask:0xf
    s_not_b64 vcc, vcc
    v_cndmask_b32_dpp v232, v234, v232, vcc quad_perm:[1,0,3,2] row_mask:0xf bank_mask:0xf
    v_cndmask_b32_dpp v234, v238, v236, vcc quad_perm:[1,0,3,2] row_mask:0xf bank_mask:0xf
    v_perm_b32 v56, v232, v235, s60
    v_perm_b32 v57, v233, v235, s61
    v_perm_b32 v58, v234, v235, s62
    buffer_store_dwordx4 v[56:59], v23, s[36:39], s59 offen sc1
    v_add_f32 v240, v240, v241
    v_add_f32 v242, v242, v243
    v_add_f32 v244, v244, v245
    v_add_f32 v246, v246, v247
    s_not_b64 vcc, vcc
    v_cndmask_b32_dpp v241, v240, v242, vcc quad_perm:[1,0,3,2] row_mask:0xf bank_mask:0xf
    v_cndmask_b32_dpp v243, v244, v246, vcc quad_perm:[1,0,3,2] row_mask:0xf bank_mask:0xf
    s_not_b64 vcc, vcc
    v_cndmask_b32_dpp v240, v242, v240, vcc quad_perm:[1,0,3,2] row_mask:0xf bank_mask:0xf
    v_cndmask_b32_dpp v242, v246, v244, vcc quad_perm:[1,0,3,2] row_mask:0xf bank_mask:0xf
    v_perm_b32 v60, v240, v243, s60
    v_perm_b32 v61, v241, v243, s61
    v_perm_b32 v62, v242, v243, s62
    buffer_store_dwordx4 v[60:63], v23, s[36:39], s99 offen sc1
    s_nop 1
    s_branch .Lexit
.Lbc_three:
    v_smfmac_f32_16x16x64_bf16 v[248:251], v[8:11], v[136:143], v156
    v_smfmac_f32_16x16x64_bf16 v[252:255], v[8:11], v[144:151], v156
    s_nop 3
    v_add_f32 v232, v232, v233
    v_add_f32 v234, v234, v235
    v_add_f32 v236, v236, v237
    v_add_f32 v238, v238, v239
    s_not_b64 vcc, vcc
    v_cndmask_b32_dpp v233, v232, v234, vcc quad_perm:[1,0,3,2] row_mask:0xf bank_mask:0xf
    v_cndmask_b32_dpp v235, v236, v238, vcc quad_perm:[1,0,3,2] row_mask:0xf bank_mask:0xf
    s_not_b64 vcc, vcc
    v_cndmask_b32_dpp v232, v234, v232, vcc quad_perm:[1,0,3,2] row_mask:0xf bank_mask:0xf
    v_cndmask_b32_dpp v234, v238, v236, vcc quad_perm:[1,0,3,2] row_mask:0xf bank_mask:0xf
    v_perm_b32 v56, v232, v235, s60
    v_perm_b32 v57, v233, v235, s61
    v_perm_b32 v58, v234, v235, s62
    buffer_store_dwordx4 v[56:59], v23, s[36:39], s59 offen sc1
    v_add_f32 v240, v240, v241
    v_add_f32 v242, v242, v243
    v_add_f32 v244, v244, v245
    v_add_f32 v246, v246, v247
    s_not_b64 vcc, vcc
    v_cndmask_b32_dpp v241, v240, v242, vcc quad_perm:[1,0,3,2] row_mask:0xf bank_mask:0xf
    v_cndmask_b32_dpp v243, v244, v246, vcc quad_perm:[1,0,3,2] row_mask:0xf bank_mask:0xf
    s_not_b64 vcc, vcc
    v_cndmask_b32_dpp v240, v242, v240, vcc quad_perm:[1,0,3,2] row_mask:0xf bank_mask:0xf
    v_cndmask_b32_dpp v242, v246, v244, vcc quad_perm:[1,0,3,2] row_mask:0xf bank_mask:0xf
    v_perm_b32 v60, v240, v243, s60
    v_perm_b32 v61, v241, v243, s61
    v_perm_b32 v62, v242, v243, s62
    buffer_store_dwordx4 v[60:63], v23, s[36:39], s99 offen sc1
    v_add_f32 v248, v248, v249
    v_add_f32 v250, v250, v251
    v_add_f32 v252, v252, v253
    v_add_f32 v254, v254, v255
    s_not_b64 vcc, vcc
    v_cndmask_b32_dpp v249, v248, v250, vcc quad_perm:[1,0,3,2] row_mask:0xf bank_mask:0xf
    v_cndmask_b32_dpp v251, v252, v254, vcc quad_perm:[1,0,3,2] row_mask:0xf bank_mask:0xf
    s_not_b64 vcc, vcc
    v_cndmask_b32_dpp v248, v250, v248, vcc quad_perm:[1,0,3,2] row_mask:0xf bank_mask:0xf
    v_cndmask_b32_dpp v250, v254, v252, vcc quad_perm:[1,0,3,2] row_mask:0xf bank_mask:0xf
    v_perm_b32 v64, v248, v251, s60
    v_perm_b32 v65, v249, v251, s61
    v_perm_b32 v66, v250, v251, s62
    buffer_store_dwordx4 v[64:67], v23, s[36:39], s100 offen sc1
.Lexit:
.Lend:
s_endpgm
.section .rodata,"a"
.p2align 6
.amdhsa_kernel adaLN_cond__sliding_block_cached__moe_arch_mod__decode_kernel
  .amdhsa_next_free_vgpr 256
  .amdhsa_next_free_sgpr 102
  .amdhsa_accum_offset 256
  .amdhsa_group_segment_fixed_size 0
  .amdhsa_kernarg_size 120
  .amdhsa_user_sgpr_count 2
  .amdhsa_user_sgpr_kernarg_segment_ptr 1
  .amdhsa_system_sgpr_workgroup_id_x 1
.end_amdhsa_kernel
```

```asm
; @launch grid=(256,1,1) block=(512,1,1) lds=159360
.amdgcn_target "amdgcn-amd-amdhsa--gfx950"
.text
.p2align 12
.globl adaLN_cond__sliding_block_cached__moe_arch_mod__decode_kernel
.p2align 8
.type adaLN_cond__sliding_block_cached__moe_arch_mod__decode_kernel,@function
adaLN_cond__sliding_block_cached__moe_arch_mod__decode_kernel:
    s_cmp_ge_u32 s2, 256
    s_cbranch_scc1 .Lend
    s_load_dwordx16 s[4:19], s[0:1], 0
    s_load_dwordx8 s[20:27], s[0:1], 64
    s_load_dwordx4 s[28:31], s[0:1], 96
    s_load_dwordx2 s[32:33], s[0:1], 112
    s_memrealtime s[70:71]
    v_lshrrev_b32 v1, 6, v0
    v_and_b32 v0, 63, v0
    v_readfirstlane_b32 s3, v1
    s_cmp_lt_u32 s3, 4
    s_nop 3
    s_cbranch_scc1 .Ltw_done
    s_cmp_lt_u32 s2, 72
    s_cbranch_scc1 .Ltw_m
    s_cmp_lt_u32 s2, 144
    s_cbranch_scc1 .Ltw_b
    s_cmp_lt_u32 s2, 208
    s_cbranch_scc1 .Ltw_q
    s_cmp_eq_u32 s3, 4
    s_cbranch_scc1 .Lst_a0_0
    s_cmp_eq_u32 s3, 5
    s_cbranch_scc1 .Lst_a0_1
.Lrt_a0_0:
.Lrt_a0_1:
    s_branch .Ltw_done
.Ltw_m:
    s_cmp_eq_u32 s3, 4
    s_cbranch_scc1 .Lst_m0_0
    s_cmp_eq_u32 s3, 5
    s_cbranch_scc1 .Lst_m0_1
.Lrt_m0_1:
    s_cmp_eq_u32 s3, 6
    s_cbranch_scc1 .Lst_m0_2
.Lrt_m0_2:
    s_cmp_eq_u32 s3, 7
    s_cbranch_scc1 .Lst_m0_3
    s_cmp_eq_u32 s3, 5
    s_cbranch_scc1 .Lst_m0_4
    s_cmp_eq_u32 s3, 6
    s_cbranch_scc1 .Lrt_m0_5
.Lrt_m0_0:
.Lrt_m0_3:
.Lrt_m0_4:
.Lrt_m0_5:
    s_branch .Ltw_done
.Ltw_b:
    s_cmp_eq_u32 s3, 4
    s_cbranch_scc1 .Lst_b0_0
    s_cmp_eq_u32 s3, 5
    s_cbranch_scc1 .Lst_b0_1
    s_cmp_eq_u32 s3, 6
    s_cbranch_scc1 .Lst_b0_2
    s_cmp_eq_u32 s3, 7
    s_cbranch_scc1 .Lst_b0_3
.Lrt_b0_0:
.Lrt_b0_1:
.Lrt_b0_2:
.Lrt_b0_3:
    s_branch .Ltw_done
.Ltw_q:
    s_cmp_eq_u32 s3, 4
    s_cbranch_scc1 .Lst_q0_0
    s_cmp_eq_u32 s3, 5
    s_cbranch_scc1 .Lst_q0_1
    s_cmp_eq_u32 s3, 6
    s_cbranch_scc1 .Lst_q0_2
    s_cmp_eq_u32 s3, 7
    s_cbranch_scc1 .Lst_q0_3
.Lrt_q0_0:
.Lrt_q0_1:
.Lrt_q0_2:
.Lrt_q0_3:
.Ltw_done:
    s_mov_b32 s35, 0x3ffff
    s_mov_b32 s98, 0xbfb8aa3b
    s_mov_b32 s94, 0x05040100
    s_mov_b32 s95, 0x07060302
    s_mov_b32 s96, 0xaaaaaaaa
    s_mov_b32 s97, 0xaaaaaaaa
    s_and_b32 s64, s2, 7
    s_lshr_b32 s65, s2, 3
    s_mov_b32 s58, 0x2554433
    s_mov_b32 s59, 0x2877661
    s_cmp_ge_u32 s65, 16
    s_cselect_b32 s58, 0xbb1aa998, s58
    s_cselect_b32 s59, 0xffeeddcc, s59
    s_lshl_b32 s57, s65, 2
    s_lshr_b64 s[58:59], s[58:59], s57
    s_lshl1_add_u32 s59, s64, 1
    s_mul_i32 s58, s58, s59
    s_add_u32 s58, s58, s64
    s_add_u32 s58, s58, s59
    s_and_b32 s66, s58, 7
    s_bfe_u32 s67, s58, 0x10003
    s_lshl1_add_u32 s67, s64, s67
    s_lshr_b32 s68, 0xaab5d42a, s65
    s_and_b32 s68, s68, 1
    s_movk_i32 s60, 0x7651
    s_cselect_b32 s60, 0x4320, s60
    s_lshl4_add_u32 s69, s66, s67
    s_lshl_b32 s69, s69, 21
    s_cmp_eq_u32 s64, 7
    s_cselect_b32 s58, 0x4040, 0
    s_or_b32 s58, s58, 0x208180
    s_bitcmp1_b32 s58, s65
    s_cselect_b32 s60, s60, 0x3210
    s_and_b32 s57, s3, 1
    s_and_b32 s59, s3, 6
    s_cmpk_eq_u32 s60, 0x3210
    s_cselect_b32 s57, s68, s57
    s_cselect_b32 s59, s3, s59
    s_lshl_b32 s57, s57, 16
    s_lshl_b32 s59, s59, 10
    s_add_u32 s69, s69, s57
    s_add_u32 s69, s69, s59
    s_add_u32 s69, s69, 0x180000
    v_bfe_u32 v1, v0, 2, 2
    v_lshlrev_b32 v1, 2, v1
    v_bfe_u32 v1, s60, v1, 4
    v_lshrrev_b32 v2, 4, v0
    v_lshl_add_u32 v1, v1, 2, v2
    v_and_b32 v2, 3, v0
    v_lshl_add_u32 v1, v1, 2, v2
    v_lshlrev_b32 v1, 4, v1
    v_lshlrev_b32 v2, 4, v0
    v_lshlrev_b32 v3, 3, v0
    v_and_b32 v4, 31, v0
    v_lshlrev_b32 v4, 2, v4
    v_add_u32 v4, 1024, v4
    v_lshlrev_b32 v5, 1, v4
    s_waitcnt lgkmcnt(0)
    s_load_dword s34, s[32:33], 0
    s_mov_b32 s40, s6
    s_and_b32 s41, s7, 0xffff
    s_mov_b32 s42, 0x10000000
    s_mov_b32 s43, 0x00020000
    s_mov_b32 s6, s60
    s_add_u32 s63, s69, 0
    buffer_load_dwordx4 v[32:35], v1, s[40:43], s63 offen nt
    s_add_u32 s63, s69, 8192
    buffer_load_dwordx4 v[36:39], v1, s[40:43], s63 offen nt
    s_add_u32 s63, s69, 16384
    buffer_load_dwordx4 v[64:67], v1, s[40:43], s63 offen nt
    s_add_u32 s63, s69, 24576
    buffer_load_dwordx4 v[68:71], v1, s[40:43], s63 offen nt
.Lnokpre:
    s_mov_b32 s44, s8
    s_and_b32 s45, s9, 0xffff
    s_mov_b32 s46, 0x10000000
    s_mov_b32 s47, 0x00020000
    s_cmp_eq_u32 s3, 0
    s_cselect_b64 exec, 1, 0
    buffer_load_dword v255, v2, s[44:47], s69 offen nt
    s_mov_b64 exec, -1
    s_mov_b32 s36, s32
    s_and_b32 s37, s33, 0xffff
    s_mov_b32 s38, 0x40000000
    s_mov_b32 s39, 0x00020000
    s_lshl3_add_u32 s56, s3, s2
    s_cmp_lt_u32 s56, 8
    s_cbranch_scc0 .Let_no
    s_lshl2_add_u32 s56, s2, 0x4a1000
    v_lshlrev_b32 v6, 8, v0
    v_mov_b32 v7, s70
    s_mov_b64 exec, 3
    buffer_store_dword v7, v6, s[36:39], s56 offen sc1
    s_mov_b64 exec, -1
.Let_no:
    v_mov_b32 v6, 159232
    v_mov_b32 v7, 0
    ds_write_b32 v6, v7
    s_waitcnt lgkmcnt(0)
    s_barrier
    s_cmp_lt_u32 s3, 4
    s_cbranch_scc1 1
    s_setprio 1
    s_cmp_lt_u32 s65, 9
    s_cbranch_scc1 .Lm
    s_cmp_lt_u32 s65, 18
    s_cbranch_scc1 .Lbc
    s_sub_u32 s65, s65, 18
    s_cmp_ge_u32 s65, 8
    s_cbranch_scc1 .La_early
    s_cmp_eq_u32 s65, 3
    s_mov_b32 s14, 0xb55aab55
    s_cselect_b32 s14, 0x8421084, s14
    s_mov_b32 s15, 0x5aab55aa
    s_cselect_b32 s15, 0x42108421, s15
    s_add_u32 s30, s70, 0
    s_mov_b32 s31, s70
    v_bfe_u32 v16, v0, 1, 3
    v_mul_u32_u24 v16, 1312, v16
    v_lshrrev_b32 v12, 4, v0
    v_lshl_add_u32 v16, v12, 5, v16
    v_and_b32 v12, 1, v0
    v_lshl_add_u32 v16, v12, 4, v16
    v_add_u32 v16, 147456, v16
    s_mul_i32 s56, s3, 1312
    s_add_u32 s56, s56, 147456
    v_add_u32 v17, s56, v3
    v_add_u32 v18, s56, v4
    v_lshrrev_b32 v12, 4, v0
    v_bfe_u32 v13, v0, 1, 1
    v_lshl_add_u32 v12, v12, 1, v13
    v_bfe_u32 v13, v0, 2, 2
    v_lshl_add_u32 v20, v12, 3, v13
    v_lshlrev_b32 v20, 7, v20
    v_and_b32 v12, 3, v12
    v_lshrrev_b32 v13, 1, v13
    v_lshl_add_u32 v12, v12, 1, v13
    v_xor_b32 v12, s3, v12
    v_lshl_add_u32 v20, v12, 4, v20
    v_and_b32 v12, 1, v0
    v_lshl_add_u32 v20, v12, 3, v20
    v_bfe_u32 v23, v0, 1, 3
    v_mul_u32_u24 v23, 144, v23
    v_bfe_u32 v12, v0, 4, 1
    v_lshl_add_u32 v23, v12, 3, v23
    s_branch .Lsk_q0_0
.Lst_q0_0:
    s_branch .Lrt_q0_0
.Lsk_q0_0:
    v_lshrrev_b32 v12, 5, v0
    v_lshl_add_u32 v23, v12, 2, v23
    v_and_b32 v12, 1, v0
    v_lshl_add_u32 v23, v12, 1, v23
    s_lshl_b32 s56, s3, 4
    s_add_u32 s56, s56, 157952
    v_add_u32 v23, s56, v23
    v_and_b32 v24, 15, v0
    v_lshlrev_b32 v24, 3, v24
    s_mul_i32 s56, s3, 144
    s_add_u32 s56, s56, 157952
    v_add_u32 v24, s56, v24
    v_add_u32 v21, 32768, v20
    s_lshl_b32 s100, s3, 10
    s_mul_i32 s58, s3, 1152
    s_mov_b32 s52, s4
    s_and_b32 s53, s5, 0xffff
    s_mov_b32 s54, 0x2400
    s_mov_b32 s55, 0x00020000
    buffer_load_dwordx2 v[246:247], v3, s[52:55], s58 offen
    buffer_load_dwordx2 v[248:249], v3, s[52:55], s58 offen offset:512
    buffer_load_dword v250, v4, s[52:55], s58 offen
    s_mov_b32 s48, s10
    s_and_b32 s49, s11, 0xffff
    s_mov_b32 s50, 0x480000
    s_mov_b32 s51, 0x00020000
    v_bfe_u32 v12, v0, 4, 1
    s_and_b32 s56, s3, 3
    s_lshl_b32 s56, s56, 1
    v_or_b32 v12, s56, v12
    v_and_b32 v19, 7, v0
    v_xor_b32 v12, v12, v19
    v_lshrrev_b32 v19, 3, v0
    v_mul_u32_u24 v19, 8192, v19
    v_lshl_add_u32 v19, v12, 4, v19
    s_lshl3_add_u32 s101, s64, s65
    s_lshl_b32 s57, s3, 16
    s_lshl_b32 s59, s101, 7
    s_add_u32 s57, s57, s59
    s_mov_b32 s99, s57
    s_add_u32 m0, s100, 0
    s_add_u32 s56, s99, 0
    buffer_load_dwordx4 v19, s[48:51], s56 offen nt lds
    s_add_u32 s63, s69, 32768
    buffer_load_dwordx4 v[96:99], v1, s[40:43], s63 offen nt
    s_waitcnt lgkmcnt(0)
    s_add_u32 s34, s34, 1
    s_getreg_b32 s1, hwreg(HW_REG_XCC_ID)
    s_lshl_b32 s1, s1, 24
    s_add_u32 s1, s1, s34
    s_lshr_b32 s0, s2, 3
    s_lshl_b32 s63, s64, 8
    s_add_u32 s0, s0, s63
    s_lshl2_add_u32 s0, s0, 0x480000
    v_mov_b32 v30, s1
    s_cmp_eq_u32 s3, 0
    s_cselect_b64 exec, 1, 0
    buffer_store_dword v30, v2, s[36:39], s0 offen sc1
    s_mov_b64 exec, -1
    s_and_b32 s58, s101, 1
    s_lshl_b32 s101, s101, 8
    s_lshl_b32 s58, s58, 7
    s_sub_u32 s101, s101, s58
    s_lshl_b32 s58, s3, 14
    s_add_u32 s101, s101, s58
    s_add_u32 s101, s101, 0x70000
    s_and_b32 s58, s64, 1
    s_mul_i32 s58, s58, 18432
    s_mul_i32 s59, s3, 2304
    s_add_u32 s58, s58, s59
    s_add_u32 s58, s58, 0x1000
    s_add_u32 s59, s58, 73728
    s_waitcnt vmcnt(5)
    s_add_u32 m0, s100, 8192
    s_add_u32 s56, s99, 524288
    buffer_load_dwordx4 v19, s[48:51], s56 offen nt lds
    s_waitcnt vmcnt(5)
    s_add_u32 s63, s69, 40960
    buffer_load_dwordx4 v[100:103], v1, s[40:43], s63 offen nt
    s_waitcnt vmcnt(5)
    s_add_u32 m0, s100, 16384
    s_add_u32 s56, s99, 1048576
    buffer_load_dwordx4 v19, s[48:51], s56 offen nt lds
    s_waitcnt vmcnt(5)
    s_add_u32 s63, s69, 49152
    buffer_load_dwordx4 v[128:131], v1, s[40:43], s63 offen nt
    v_lshlrev_b32 v236, 16, v246
    v_and_b32 v237, 0xffff0000, v246
    v_lshlrev_b32 v238, 16, v247
    v_and_b32 v239, 0xffff0000, v247
    v_lshlrev_b32 v240, 16, v248
    v_and_b32 v241, 0xffff0000, v248
    v_lshlrev_b32 v242, 16, v249
    v_and_b32 v243, 0xffff0000, v249
    v_lshlrev_b32 v244, 16, v250
    v_and_b32 v245, 0xffff0000, v250
    s_mov_b32 s56, 0x3f803f80
    v_dot2_f32_bf16 v10, v246, s56, 0
    v_dot2_f32_bf16 v11, v246, v246, 0
    v_dot2_f32_bf16 v10, v247, s56, v10
    v_dot2_f32_bf16 v11, v247, v247, v11
    v_dot2_f32_bf16 v10, v248, s56, v10
    v_dot2_f32_bf16 v11, v248, v248, v11
    v_dot2_f32_bf16 v10, v249, s56, v10
    v_dot2_f32_bf16 v11, v249, v249, v11
    s_mov_b64 exec, 0xffffffff
    v_dot2_f32_bf16 v10, v250, s56, v10
    v_dot2_f32_bf16 v11, v250, v250, v11
    s_mov_b64 exec, -1
    s_nop 1
    v_permlane32_swap_b32 v10, v11
    v_add_f32 v10, v10, v11
    v_mov_b32 v12, v10
    s_nop 1
    v_permlane16_swap_b32 v12, v10
    v_add_f32 v10, v12, v10
    s_nop 1
    v_add_f32_dpp v10, v10, v10 row_ror:8 row_mask:0xf bank_mask:0xf
    s_nop 1
    v_add_f32_dpp v10, v10, v10 row_ror:4 row_mask:0xf bank_mask:0xf
    s_nop 1
    v_add_f32_dpp v10, v10, v10 quad_perm:[2,3,0,1] row_mask:0xf bank_mask:0xf
    s_nop 1
    v_add_f32_dpp v10, v10, v10 quad_perm:[1,0,3,2] row_mask:0xf bank_mask:0xf
    v_mul_f32 v10, 0x3ae38e39, v10
    s_nop 0
    v_readlane_b32 s56, v10, 0
    v_readlane_b32 s57, v10, 32
    s_nop 0
    v_mov_b32 v10, s56
    v_fma_f32 v11, -v10, v10, s57
    v_max_f32 v11, 0, v11
    v_cvt_pk_bf16_f32 v12, -v10, v11
    v_and_b32 v13, 0xffff0000, v12
    v_add_f32 v13, 0x3727c5ac, v13
    v_lshlrev_b32 v10, 16, v12
    v_cvt_pk_bf16_f32 v13, v13, v13
    v_lshlrev_b32 v13, 16, v13
    v_sqrt_f32 v13, v13
    v_mov_b32 v11, v10
    v_cvt_pk_bf16_f32 v13, v13, v13
    v_lshlrev_b32 v13, 16, v13
    v_rcp_f32 v12, v13
    v_rcp_f32 v13, v13
    v_pk_add_f32 v[236:237], v[236:237], v[10:11]
    v_pk_add_f32 v[238:239], v[238:239], v[10:11]
    v_pk_add_f32 v[240:241], v[240:241], v[10:11]
    v_pk_add_f32 v[242:243], v[242:243], v[10:11]
    v_pk_add_f32 v[244:245], v[244:245], v[10:11]
    v_cvt_pk_bf16_f32 v236, v236, v237
    v_and_b32 v237, 0xffff0000, v236
    v_lshlrev_b32 v236, 16, v236
    v_cvt_pk_bf16_f32 v238, v238, v239
    v_and_b32 v239, 0xffff0000, v238
    v_lshlrev_b32 v238, 16, v238
    v_cvt_pk_bf16_f32 v240, v240, v241
    v_and_b32 v241, 0xffff0000, v240
    v_lshlrev_b32 v240, 16, v240
    v_cvt_pk_bf16_f32 v242, v242, v243
    v_and_b32 v243, 0xffff0000, v242
    v_lshlrev_b32 v242, 16, v242
    v_cvt_pk_bf16_f32 v244, v244, v245
    v_and_b32 v245, 0xffff0000, v244
    v_lshlrev_b32 v244, 16, v244
    v_pk_mul_f32 v[236:237], v[236:237], v[12:13]
    v_pk_mul_f32 v[238:239], v[238:239], v[12:13]
    v_pk_mul_f32 v[240:241], v[240:241], v[12:13]
    v_pk_mul_f32 v[242:243], v[242:243], v[12:13]
    v_pk_mul_f32 v[244:245], v[244:245], v[12:13]
    v_cvt_pk_bf16_f32 v236, v236, v237
    v_and_b32 v237, 0xffff0000, v236
    v_lshlrev_b32 v236, 16, v236
    v_cvt_pk_bf16_f32 v238, v238, v239
    v_and_b32 v239, 0xffff0000, v238
    v_lshlrev_b32 v238, 16, v238
    v_cvt_pk_bf16_f32 v240, v240, v241
    v_and_b32 v241, 0xffff0000, v240
    v_lshlrev_b32 v240, 16, v240
    v_cvt_pk_bf16_f32 v242, v242, v243
    v_and_b32 v243, 0xffff0000, v242
    v_lshlrev_b32 v242, 16, v242
    v_cvt_pk_bf16_f32 v244, v244, v245
    v_and_b32 v245, 0xffff0000, v244
    v_lshlrev_b32 v244, 16, v244
    s_branch .Lsk_q0_1
.Lst_q0_1:
    s_branch .Lrt_q0_1
.Lsk_q0_1:
    s_waitcnt vmcnt(5)
    s_add_u32 m0, s100, 24576
    s_add_u32 s56, s99, 1572864
    buffer_load_dwordx4 v19, s[48:51], s56 offen nt lds
    s_waitcnt vmcnt(4)
    s_add_u32 s63, s69, 57344
    buffer_load_dwordx4 v[132:135], v1, s[40:43], s63 offen nt
    s_waitcnt vmcnt(4)
    s_add_u32 m0, s100, 32768
    s_add_u32 s56, s99, 2097152
    buffer_load_dwordx4 v19, s[48:51], s56 offen nt lds
    s_waitcnt vmcnt(4)
    s_add_u32 s63, s69, 131072
    buffer_load_dwordx4 v[40:43], v1, s[40:43], s63 offen nt
    s_waitcnt vmcnt(4)
    s_add_u32 m0, s100, 40960
    s_add_u32 s56, s99, 2621440
    buffer_load_dwordx4 v19, s[48:51], s56 offen nt lds
    s_waitcnt vmcnt(4)
    s_add_u32 s63, s69, 139264
    buffer_load_dwordx4 v[44:47], v1, s[40:43], s63 offen nt
    s_waitcnt vmcnt(4)
    s_add_u32 m0, s100, 49152
    s_add_u32 s56, s99, 3145728
    buffer_load_dwordx4 v19, s[48:51], s56 offen nt lds
    s_waitcnt vmcnt(4)
    s_add_u32 s63, s69, 147456
    buffer_load_dwordx4 v[72:75], v1, s[40:43], s63 offen nt
    s_waitcnt vmcnt(4)
    s_add_u32 m0, s100, 57344
    s_add_u32 s56, s99, 3670016
    buffer_load_dwordx4 v19, s[48:51], s56 offen nt lds
    s_waitcnt vmcnt(4)
    s_add_u32 s63, s69, 155648
    buffer_load_dwordx4 v[76:79], v1, s[40:43], s63 offen nt
    s_waitcnt vmcnt(4)
    s_add_u32 m0, s100, 65536
    s_add_u32 s56, s99, 4194304
    buffer_load_dwordx4 v19, s[48:51], s56 offen nt lds
    s_waitcnt vmcnt(4)
    s_add_u32 s63, s69, 163840
    buffer_load_dwordx4 v[104:107], v1, s[40:43], s63 offen nt
    s_waitcnt vmcnt(4)
    s_add_u32 s63, s69, 172032
    buffer_load_dwordx4 v[108:111], v1, s[40:43], s63 offen nt
    s_waitcnt vmcnt(4)
    s_add_u32 s63, s69, 180224
    buffer_load_dwordx4 v[136:139], v1, s[40:43], s63 offen nt
    s_waitcnt vmcnt(4)
    s_add_u32 s63, s69, 188416
    buffer_load_dwordx4 v[140:143], v1, s[40:43], s63 offen nt
    s_waitcnt vmcnt(4)
    s_add_u32 s63, s69, 262144
    buffer_load_dwordx4 v[48:51], v1, s[40:43], s63 offen nt
    s_waitcnt vmcnt(4)
    s_add_u32 s63, s69, 270336
    buffer_load_dwordx4 v[52:55], v1, s[40:43], s63 offen nt
    buffer_load_dwordx4 v[196:199], v2, s[36:39], s58 offen offset:0 sc1
    buffer_load_dwordx4 v[200:203], v2, s[36:39], s58 offen offset:1024 sc1
    buffer_load_dwordx2 v[204:205], v5, s[36:39], s58 offen offset:0 sc1
    buffer_load_dwordx4 v[206:209], v2, s[36:39], s59 offen offset:0 sc1
    buffer_load_dwordx4 v[210:213], v2, s[36:39], s59 offen offset:1024 sc1
    buffer_load_dwordx2 v[214:215], v5, s[36:39], s59 offen offset:0 sc1
    s_add_u32 s63, s69, 278528
    buffer_load_dwordx4 v[80:83], v1, s[40:43], s63 offen nt
    s_add_u32 s63, s69, 286720
    buffer_load_dwordx4 v[84:87], v1, s[40:43], s63 offen nt
    s_add_u32 s63, s69, 294912
    buffer_load_dwordx4 v[112:115], v1, s[40:43], s63 offen nt
    s_barrier
    ds_read_b64_tr_b16 v[160:161], v20 offset:0
    ds_read_b64_tr_b16 v[162:163], v20 offset:512
    ds_read_b64_tr_b16 v[164:165], v20 offset:8192
    ds_read_b64_tr_b16 v[166:167], v20 offset:8704
    ds_read_b64_tr_b16 v[168:169], v20 offset:16384
    ds_read_b64_tr_b16 v[170:171], v20 offset:16896
    ds_read_b64_tr_b16 v[172:173], v20 offset:24576
    ds_read_b64_tr_b16 v[174:175], v20 offset:25088
    ds_read_b64_tr_b16 v[176:177], v21 offset:0
    ds_read_b64_tr_b16 v[178:179], v21 offset:512
    ds_read_b64_tr_b16 v[180:181], v21 offset:8192
    ds_read_b64_tr_b16 v[182:183], v21 offset:8704
    ds_read_b64_tr_b16 v[184:185], v21 offset:16384
    ds_read_b64_tr_b16 v[186:187], v21 offset:16896
    ds_read_b64_tr_b16 v[188:189], v21 offset:24576
    ds_read_b64_tr_b16 v[190:191], v21 offset:25088
    ds_read_b64_tr_b16 v[192:193], v21 offset:32768
    ds_read_b64_tr_b16 v[194:195], v21 offset:33280
    s_add_u32 s63, s69, 303104
    buffer_load_dwordx4 v[116:119], v1, s[40:43], s63 offen nt
    s_waitcnt vmcnt(4)
    s_branch .gpc_2
.gp_1:
    buffer_load_dwordx4 v[196:199], v2, s[36:39], s58 offen offset:0 sc1
    buffer_load_dwordx4 v[200:203], v2, s[36:39], s58 offen offset:1024 sc1
    buffer_load_dwordx2 v[204:205], v5, s[36:39], s58 offen offset:0 sc1
    buffer_load_dwordx4 v[206:209], v2, s[36:39], s59 offen offset:0 sc1
    buffer_load_dwordx4 v[210:213], v2, s[36:39], s59 offen offset:1024 sc1
    buffer_load_dwordx2 v[214:215], v5, s[36:39], s59 offen offset:0 sc1
    s_waitcnt vmcnt(0)
.gpc_2:
    v_min_u32 v10, v197, v199
    v_max_u32 v11, v197, v199
    v_min3_u32 v10, v10, v201, v203
    v_max3_u32 v11, v11, v201, v203
    v_min3_u32 v10, v10, v205, v207
    v_max3_u32 v11, v11, v205, v207
    v_min3_u32 v10, v10, v209, v211
    v_max3_u32 v11, v11, v209, v211
    v_min3_u32 v10, v10, v213, v215
    v_max3_u32 v11, v11, v213, v215
    v_cmp_eq_u32 vcc, s34, v10
    v_cmp_eq_u32 s[56:57], s34, v11
    s_and_b64 vcc, vcc, s[56:57]
    s_cmp_eq_u64 vcc, -1
    s_nop 2
    s_cbranch_scc1 .gpd_3
    s_sub_u32 s35, s35, 1
    s_cbranch_scc1 .Lexit
    s_branch .gp_1
.gpd_3:
    s_add_u32 s63, s69, 311296
    buffer_load_dwordx4 v[144:147], v1, s[40:43], s63 offen nt
    v_and_b32 v207, 0xffff0000, v206
    v_lshlrev_b32 v206, 16, v206
    v_and_b32 v209, 0xffff0000, v208
    v_lshlrev_b32 v208, 16, v208
    v_and_b32 v211, 0xffff0000, v210
    v_lshlrev_b32 v210, 16, v210
    v_and_b32 v213, 0xffff0000, v212
    v_lshlrev_b32 v212, 16, v212
    v_and_b32 v215, 0xffff0000, v214
    v_lshlrev_b32 v214, 16, v214
    v_and_b32 v197, 0xffff0000, v196
    v_lshlrev_b32 v196, 16, v196
    v_and_b32 v199, 0xffff0000, v198
    v_lshlrev_b32 v198, 16, v198
    v_and_b32 v201, 0xffff0000, v200
    v_lshlrev_b32 v200, 16, v200
    v_and_b32 v203, 0xffff0000, v202
    v_lshlrev_b32 v202, 16, v202
    v_and_b32 v205, 0xffff0000, v204
    v_lshlrev_b32 v204, 16, v204
    v_pk_mul_f32 v[236:237], v[236:237], v[206:207]
    v_pk_mul_f32 v[238:239], v[238:239], v[208:209]
    v_pk_mul_f32 v[240:241], v[240:241], v[210:211]
    v_pk_mul_f32 v[242:243], v[242:243], v[212:213]
    v_pk_mul_f32 v[244:245], v[244:245], v[214:215]
    v_cvt_pk_bf16_f32 v236, v236, v237
    v_and_b32 v237, 0xffff0000, v236
    v_lshlrev_b32 v236, 16, v236
    v_cvt_pk_bf16_f32 v238, v238, v239
    v_and_b32 v239, 0xffff0000, v238
    s_branch .Lsk_q0_2
.Lst_q0_2:
    s_branch .Lrt_q0_2
.Lsk_q0_2:
    v_lshlrev_b32 v238, 16, v238
    v_cvt_pk_bf16_f32 v240, v240, v241
    v_and_b32 v241, 0xffff0000, v240
    v_lshlrev_b32 v240, 16, v240
    v_cvt_pk_bf16_f32 v242, v242, v243
    v_and_b32 v243, 0xffff0000, v242
    v_lshlrev_b32 v242, 16, v242
    v_cvt_pk_bf16_f32 v244, v244, v245
    s_branch .Lsk_q0_3
.Lst_q0_3:
    s_branch .Lrt_q0_3
.Lsk_q0_3:
    v_and_b32 v245, 0xffff0000, v244
    v_lshlrev_b32 v244, 16, v244
    v_pk_add_f32 v[236:237], v[236:237], v[196:197]
    v_pk_add_f32 v[238:239], v[238:239], v[198:199]
    v_pk_add_f32 v[240:241], v[240:241], v[200:201]
    v_pk_add_f32 v[242:243], v[242:243], v[202:203]
    v_pk_add_f32 v[244:245], v[244:245], v[204:205]
    v_cvt_pk_bf16_f32 v246, v236, v237
    v_cvt_pk_bf16_f32 v247, v238, v239
    v_cvt_pk_bf16_f32 v248, v240, v241
    v_cvt_pk_bf16_f32 v249, v242, v243
    v_cvt_pk_bf16_f32 v250, v244, v245
    ds_write_b64 v17, v[246:247] offset:0
    ds_write_b64 v17, v[248:249] offset:512
    ds_write_b32 v18, v250 offset:0
    s_add_u32 s63, s69, 319488
    buffer_load_dwordx4 v[148:151], v1, s[40:43], s63 offen nt
    s_waitcnt lgkmcnt(0)
    s_barrier
    s_add_u32 s63, s69, 393216
    buffer_load_dwordx4 v[56:59], v1, s[40:43], s63 offen nt
    ds_read_b128 v[196:199], v16 offset:0
    ds_read_b128 v[200:203], v16 offset:128
    ds_read_b128 v[204:207], v16 offset:256
    ds_read_b128 v[208:211], v16 offset:384
    ds_read_b128 v[212:215], v16 offset:512
    ds_read_b128 v[216:219], v16 offset:640
    ds_read_b128 v[220:223], v16 offset:768
    ds_read_b128 v[224:227], v16 offset:896
    ds_read_b128 v[228:231], v16 offset:1024
    s_waitcnt lgkmcnt(8)
    v_mfma_f32_16x16x32_bf16 v[232:235], v[160:163], v[196:199], 0
    s_waitcnt lgkmcnt(7)
    v_mfma_f32_16x16x32_bf16 v[232:235], v[164:167], v[200:203], v[232:235]
    s_waitcnt lgkmcnt(6)
    v_mfma_f32_16x16x32_bf16 v[232:235], v[168:171], v[204:207], v[232:235]
    s_waitcnt lgkmcnt(5)
    v_mfma_f32_16x16x32_bf16 v[232:235], v[172:175], v[208:211], v[232:235]
    s_waitcnt lgkmcnt(4)
    v_mfma_f32_16x16x32_bf16 v[232:235], v[176:179], v[212:215], v[232:235]
    s_waitcnt lgkmcnt(3)
    v_mfma_f32_16x16x32_bf16 v[232:235], v[180:183], v[216:219], v[232:235]
    s_waitcnt lgkmcnt(2)
    v_mfma_f32_16x16x32_bf16 v[232:235], v[184:187], v[220:223], v[232:235]
    s_waitcnt lgkmcnt(1)
    v_mfma_f32_16x16x32_bf16 v[232:235], v[188:191], v[224:227], v[232:235]
    s_waitcnt lgkmcnt(0)
    v_mfma_f32_16x16x32_bf16 v[232:235], v[192:195], v[228:231], v[232:235]
    s_nop 7
    v_permlane32_swap_b32 v232, v234
    v_permlane32_swap_b32 v233, v235
    v_cndmask_b32 v233, v233, v234, s[96:97]
    v_cndmask_b32 v232, v232, v235, s[96:97]
    s_nop 1
    v_add_f32_dpp v236, v233, v232 quad_perm:[1,0,3,2] row_mask:0xf bank_mask:0xf
    v_and_b32 v12, 1, v0
    v_lshlrev_b32 v12, 8, v12
    v_bfe_u32 v13, v0, 1, 3
    v_lshl_add_u32 v12, v13, 4, v12
    v_cvt_pk_bf16_f32 v236, v236, v236
    ds_write_b16 v23, v236
    v_mov_b32 v243, s34
    s_waitcnt lgkmcnt(0)
    s_barrier
    ds_read2_b32 v[244:245], v24 offset1:1
    v_mov_b32 v241, s34
    s_waitcnt lgkmcnt(0)
    v_mov_b32 v240, v244
    v_mov_b32 v242, v245
    s_mov_b64 exec, 0xffff
    buffer_store_dwordx4 v[240:243], v12, s[36:39], s101 offen sc1
    s_mov_b64 exec, -1
    s_mov_b64 s[18:19], 0
    v_mov_b32 v6, 0
    s_waitcnt vmcnt(3)
    s_bitcmp1_b64 s[14:15], 25
    s_cbranch_scc0 1
    s_waitcnt vmcnt(2)
    s_add_u32 s63, s69, 401408
    buffer_load_dwordx4 v[60:63], v1, s[40:43], s63 offen nt
    s_branch .Ln_att
.La_early:
    s_branch .Lsk_a0_0
.Lst_a0_0:
    s_branch .Lrt_a0_0
.Lsk_a0_0:
    s_mov_b32 s14, 0x6ddb76dd
    s_mov_b32 s15, 0xdb76ddb7
    s_add_u32 s30, s70, -55
    s_mov_b32 s31, s70
    s_cmp_ge_u32 s65, 11
    s_cselect_b32 s99, 1, 0
    s_mul_i32 s57, s99, 3
    s_sub_u32 s100, s65, s57
    s_sub_u32 s100, s100, 8
    s_lshl1_add_u32 s99, s64, s99
    s_mov_b32 s48, s12
    s_and_b32 s49, s13, 0xffff
    s_mov_b32 s50, 0x480000
    s_mov_b32 s51, 0x00020000
    v_bfe_u32 v12, v0, 4, 1
    s_and_b32 s56, s3, 1
    s_lshl_b32 s56, s56, 2
    v_lshl_or_b32 v12, v12, 1, s56
    v_and_b32 v13, 7, v0
    v_xor_b32 v12, v12, v13
    v_lshrrev_b32 v13, 3, v0
    v_mul_u32_u24 v13, 1152, v13
    v_lshl_add_u32 v6, v12, 4, v13
    s_mul_i32 s101, s99, 294912
    s_mul_i32 s56, s100, 384
    s_add_u32 s101, s101, s56
    s_mul_i32 s56, s3, 9216
    s_add_u32 s101, s101, s56
    s_lshl_b32 s57, s3, 10
    s_waitcnt vmcnt(4)
    s_add_u32 m0, s57, 0
    s_add_u32 s56, s101, 0
    buffer_load_dwordx4 v6, s[48:51], s56 offen nt lds
    s_waitcnt vmcnt(4)
    s_add_u32 m0, s57, 32768
    s_add_u32 s56, s101, 128
    buffer_load_dwordx4 v6, s[48:51], s56 offen nt lds
    s_waitcnt vmcnt(4)
    s_bitcmp1_b64 s[14:15], 4
    s_cbranch_scc0 1
    s_waitcnt vmcnt(3)
    s_add_u32 s63, s69, 32768
    buffer_load_dwordx4 v[96:99], v1, s[40:43], s63 offen nt
    s_waitcnt vmcnt(4)
    s_bitcmp1_b64 s[14:15], 5
    s_cbranch_scc0 1
    s_waitcnt vmcnt(2)
    s_add_u32 s63, s69, 40960
    buffer_load_dwordx4 v[100:103], v1, s[40:43], s63 offen nt
    s_waitcnt vmcnt(3)
    s_add_u32 m0, s57, 65536
    s_add_u32 s56, s101, 256
    buffer_load_dwordx4 v6, s[48:51], s56 offen nt lds
    s_waitcnt vmcnt(3)
    s_bitcmp1_b64 s[14:15], 6
    s_cbranch_scc0 1
    s_waitcnt vmcnt(2)
    s_add_u32 s63, s69, 49152
    buffer_load_dwordx4 v[128:131], v1, s[40:43], s63 offen nt
    s_waitcnt vmcnt(3)
    s_bitcmp1_b64 s[14:15], 7
    s_cbranch_scc0 1
    s_waitcnt vmcnt(2)
    s_add_u32 s63, s69, 57344
    buffer_load_dwordx4 v[132:135], v1, s[40:43], s63 offen nt
    s_waitcnt vmcnt(3)
    s_add_u32 m0, s57, 8192
    s_add_u32 s56, s101, 73728
    buffer_load_dwordx4 v6, s[48:51], s56 offen nt lds
    s_waitcnt vmcnt(3)
    s_bitcmp1_b64 s[14:15], 8
    s_cbranch_scc0 1
    s_waitcnt vmcnt(2)
    s_add_u32 s63, s69, 131072
    buffer_load_dwordx4 v[40:43], v1, s[40:43], s63 offen nt
    s_waitcnt vmcnt(3)
    s_bitcmp1_b64 s[14:15], 9
    s_cbranch_scc0 1
    s_waitcnt vmcnt(2)
    s_add_u32 s63, s69, 139264
    buffer_load_dwordx4 v[44:47], v1, s[40:43], s63 offen nt
    s_waitcnt vmcnt(3)
    s_add_u32 m0, s57, 40960
    s_add_u32 s56, s101, 73856
    buffer_load_dwordx4 v6, s[48:51], s56 offen nt lds
    s_waitcnt vmcnt(3)
    s_bitcmp1_b64 s[14:15], 10
    s_cbranch_scc0 1
    s_waitcnt vmcnt(2)
    s_add_u32 s63, s69, 147456
    buffer_load_dwordx4 v[72:75], v1, s[40:43], s63 offen nt
    s_waitcnt vmcnt(3)
    s_bitcmp1_b64 s[14:15], 11
    s_cbranch_scc0 1
    s_waitcnt vmcnt(2)
    s_add_u32 s63, s69, 155648
    buffer_load_dwordx4 v[76:79], v1, s[40:43], s63 offen nt
    s_waitcnt vmcnt(3)
    s_add_u32 m0, s57, 73728
    s_add_u32 s56, s101, 73984
    buffer_load_dwordx4 v6, s[48:51], s56 offen nt lds
    s_waitcnt vmcnt(3)
    s_waitcnt lgkmcnt(0)
    s_add_u32 s34, s34, 1
    s_getreg_b32 s1, hwreg(HW_REG_XCC_ID)
    s_lshl_b32 s1, s1, 24
    s_add_u32 s1, s1, s34
    s_lshr_b32 s0, s2, 3
    s_lshl_b32 s63, s64, 8
    s_add_u32 s0, s0, s63
    s_lshl2_add_u32 s0, s0, 0x480000
    v_mov_b32 v30, s1
    s_cmp_eq_u32 s3, 0
    s_cselect_b64 exec, 1, 0
    buffer_store_dword v30, v2, s[36:39], s0 offen sc1
    s_mov_b64 exec, -1
    s_bitcmp1_b64 s[14:15], 12
    s_cbranch_scc0 1
    s_waitcnt vmcnt(3)
    s_add_u32 s63, s69, 163840
    buffer_load_dwordx4 v[104:107], v1, s[40:43], s63 offen nt
    s_waitcnt vmcnt(4)
    s_bitcmp1_b64 s[14:15], 13
    s_cbranch_scc0 1
    s_waitcnt vmcnt(3)
    s_add_u32 s63, s69, 172032
    buffer_load_dwordx4 v[108:111], v1, s[40:43], s63 offen nt
    s_waitcnt vmcnt(4)
    s_add_u32 m0, s57, 16384
    s_add_u32 s56, s101, 147456
    buffer_load_dwordx4 v6, s[48:51], s56 offen nt lds
    s_waitcnt vmcnt(4)
    s_bitcmp1_b64 s[14:15], 14
    s_cbranch_scc0 1
    s_waitcnt vmcnt(2)
    s_add_u32 s63, s69, 180224
    buffer_load_dwordx4 v[136:139], v1, s[40:43], s63 offen nt
    s_waitcnt vmcnt(3)
    s_bitcmp1_b64 s[14:15], 15
    s_cbranch_scc0 1
    s_waitcnt vmcnt(2)
    s_add_u32 s63, s69, 188416
    buffer_load_dwordx4 v[140:143], v1, s[40:43], s63 offen nt
    s_waitcnt vmcnt(3)
    s_add_u32 m0, s57, 49152
    s_add_u32 s56, s101, 147584
    buffer_load_dwordx4 v6, s[48:51], s56 offen nt lds
    s_waitcnt vmcnt(3)
    s_bitcmp1_b64 s[14:15], 16
    s_cbranch_scc0 1
    s_waitcnt vmcnt(2)
    s_add_u32 s63, s69, 262144
    buffer_load_dwordx4 v[48:51], v1, s[40:43], s63 offen nt
    s_waitcnt vmcnt(3)
    s_bitcmp1_b64 s[14:15], 17
    s_cbranch_scc0 1
    s_waitcnt vmcnt(2)
    s_add_u32 s63, s69, 270336
    buffer_load_dwordx4 v[52:55], v1, s[40:43], s63 offen nt
    s_waitcnt vmcnt(3)
    s_add_u32 m0, s57, 81920
    s_add_u32 s56, s101, 147712
    buffer_load_dwordx4 v6, s[48:51], s56 offen nt lds
    s_waitcnt vmcnt(3)
    s_bitcmp1_b64 s[14:15], 18
    s_cbranch_scc0 1
    s_waitcnt vmcnt(2)
    s_add_u32 s63, s69, 278528
    buffer_load_dwordx4 v[80:83], v1, s[40:43], s63 offen nt
    s_waitcnt vmcnt(3)
    s_bitcmp1_b64 s[14:15], 19
    s_cbranch_scc0 1
    s_waitcnt vmcnt(2)
    s_add_u32 s63, s69, 286720
    buffer_load_dwordx4 v[84:87], v1, s[40:43], s63 offen nt
    s_waitcnt vmcnt(3)
    s_bitcmp1_b64 s[14:15], 20
    s_cbranch_scc0 1
    s_waitcnt vmcnt(2)
    s_add_u32 s63, s69, 294912
    buffer_load_dwordx4 v[112:115], v1, s[40:43], s63 offen nt
    s_waitcnt vmcnt(3)
    s_bitcmp1_b64 s[14:15], 21
    s_cbranch_scc0 1
    s_waitcnt vmcnt(2)
    s_add_u32 s63, s69, 303104
    buffer_load_dwordx4 v[116:119], v1, s[40:43], s63 offen nt
    s_waitcnt vmcnt(3)
    s_bitcmp1_b64 s[14:15], 22
    s_cbranch_scc0 1
    s_waitcnt vmcnt(2)
    s_add_u32 s63, s69, 311296
    buffer_load_dwordx4 v[144:147], v1, s[40:43], s63 offen nt
    s_branch .Lsk_a0_1
.Lst_a0_1:
    s_branch .Lrt_a0_1
.Lsk_a0_1:
    s_waitcnt vmcnt(3)
    s_bitcmp1_b64 s[14:15], 23
    s_cbranch_scc0 1
    s_waitcnt vmcnt(2)
    s_add_u32 s63, s69, 319488
    buffer_load_dwordx4 v[148:151], v1, s[40:43], s63 offen nt
    s_waitcnt vmcnt(3)
    s_bitcmp1_b64 s[14:15], 24
    s_cbranch_scc0 1
    s_waitcnt vmcnt(2)
    s_add_u32 s63, s69, 393216
    buffer_load_dwordx4 v[56:59], v1, s[40:43], s63 offen nt
    s_waitcnt vmcnt(3)
    s_bitcmp1_b64 s[14:15], 25
    s_cbranch_scc0 1
    s_waitcnt vmcnt(2)
    s_add_u32 s63, s69, 401408
    buffer_load_dwordx4 v[60:63], v1, s[40:43], s63 offen nt
    s_mov_b64 s[18:19], -1
.Ln_att:
    v_and_b32 v8, 1, v0
    v_lshlrev_b32 v8, 8, v8
    v_and_b32 v9, 0x3c, v0
    v_lshl_add_u32 v9, v9, 2, v8
    v_add_u32 v7, v9, v8
    v_and_b32 v9, 0x3c, v0
    v_lshrrev_b32 v8, 4, v8
    v_and_b32 v9, 4, v0
    v_lshl_add_u32 v9, v9, 3, v8
    s_lshl_b32 s58, s66, 14
    s_lshl_b32 s59, s67, 10
    s_add_u32 s58, s58, s59
    s_add_u32 s58, s58, 0x70000
    s_lshl4_add_u32 s59, s66, s67
    s_lshl_b32 s59, s59, 7
    s_add_u32 s59, s59, 0x430000
    s_memrealtime s[8:9]
    s_waitcnt vmcnt(8)
    s_waitcnt lgkmcnt(0)
    s_sub_u32 s8, s8, s30
    s_cmpk_ge_u32 s8, 1211
    s_cbranch_scc1 .ap_4
    s_waitcnt vmcnt(5)
    s_cmpk_ge_u32 s8, 1111
    s_cbranch_scc1 .ap_4
    s_waitcnt vmcnt(3)
    s_bitcmp1_b64 s[14:15], 26
    s_cbranch_scc0 1
    s_waitcnt vmcnt(2)
    s_cmpk_ge_u32 s8, 991
    s_cbranch_scc1 .ap_4
    s_waitcnt vmcnt(1)
.ap_4:
    s_add_u32 s63, s69, 409600
    buffer_load_dwordx4 v[88:91], v1, s[40:43], s63 offen nt
    v_and_b32 v157, 7, v0
    v_lshlrev_b32 v157, 2, v157
    s_mov_b32 s63, 0x4a1000
    buffer_load_dword v156, v157, s[36:39], s63 offen
    s_cmp_eq_u32 s3, 0
    s_cbranch_scc1 .Lst_n1_0
.Lrt_n1_0:
    s_cmp_eq_u32 s3, 1
    s_cbranch_scc1 .Lst_n1_1
    s_cmp_eq_u32 s3, 2
    s_cbranch_scc1 .Lst_n1_2
    s_cmp_eq_u32 s3, 3
    s_cbranch_scc1 .Lst_n1_3
    s_cmp_eq_u32 s3, 4
    s_cbranch_scc1 .Lst_n1_4
    s_cmp_eq_u32 s3, 5
    s_cbranch_scc1 .Lst_n1_5
    s_cmp_eq_u32 s3, 6
    s_cbranch_scc1 .Lst_n1_6
    s_cmp_eq_u32 s3, 7
    s_cbranch_scc1 .Lst_n1_7
    s_cmp_eq_u32 s3, 0
    s_cbranch_scc1 .Lrt_n1_8
.Lrt_n1_1:
.Lrt_n1_2:
.Lrt_n1_3:
.Lrt_n1_4:
.Lrt_n1_5:
.Lrt_n1_6:
.Lrt_n1_7:
.Lrt_n1_8:
    s_memrealtime s[8:9]
    s_waitcnt vmcnt(9)
    s_waitcnt lgkmcnt(0)
    s_sub_u32 s8, s8, s30
    s_cmpk_ge_u32 s8, 1238
    s_cbranch_scc1 .ap_5
    s_waitcnt vmcnt(6)
    s_cmpk_ge_u32 s8, 1138
    s_cbranch_scc1 .ap_5
    s_waitcnt vmcnt(4)
    s_bitcmp1_b64 s[14:15], 27
    s_cbranch_scc0 1
    s_waitcnt vmcnt(3)
    s_cmpk_ge_u32 s8, 1018
    s_cbranch_scc1 .ap_5
    s_waitcnt vmcnt(2)
.ap_5:
    s_add_u32 s63, s69, 417792
    buffer_load_dwordx4 v[92:95], v1, s[40:43], s63 offen nt
    s_memrealtime s[8:9]
    s_waitcnt vmcnt(9)
    s_waitcnt lgkmcnt(0)
    s_sub_u32 s8, s8, s30
    s_cmpk_ge_u32 s8, 1265
    s_cbranch_scc1 .ap_6
    s_waitcnt vmcnt(6)
    s_cmpk_ge_u32 s8, 1165
    s_cbranch_scc1 .ap_6
    s_waitcnt vmcnt(4)
    s_bitcmp1_b64 s[14:15], 28
    s_cbranch_scc0 1
    s_waitcnt vmcnt(3)
    s_cmpk_ge_u32 s8, 1045
    s_cbranch_scc1 .ap_6
    s_waitcnt vmcnt(2)
.ap_6:
    s_add_u32 s63, s69, 425984
    buffer_load_dwordx4 v[120:123], v1, s[40:43], s63 offen nt
    s_memrealtime s[8:9]
    s_waitcnt vmcnt(9)
    s_waitcnt lgkmcnt(0)
    s_sub_u32 s8, s8, s30
    s_cmpk_ge_u32 s8, 1292
    s_cbranch_scc1 .ap_7
    s_waitcnt vmcnt(6)
    s_cmpk_ge_u32 s8, 1192
    s_cbranch_scc1 .ap_7
    s_waitcnt vmcnt(4)
    s_bitcmp1_b64 s[14:15], 29
    s_cbranch_scc0 1
    s_waitcnt vmcnt(3)
    s_cmpk_ge_u32 s8, 1072
    s_cbranch_scc1 .ap_7
    s_waitcnt vmcnt(1)
.ap_7:
    s_add_u32 s63, s69, 434176
    buffer_load_dwordx4 v[124:127], v1, s[40:43], s63 offen nt
    s_memrealtime s[8:9]
    s_waitcnt vmcnt(9)
    s_waitcnt lgkmcnt(0)
    s_sub_u32 s8, s8, s30
    s_cmpk_ge_u32 s8, 1320
    s_cbranch_scc1 .ap_8
    s_waitcnt vmcnt(6)
    s_cmpk_ge_u32 s8, 1220
    s_cbranch_scc1 .ap_8
    s_waitcnt vmcnt(4)
    s_bitcmp1_b64 s[14:15], 30
    s_cbranch_scc0 1
    s_waitcnt vmcnt(2)
    s_cmpk_ge_u32 s8, 1100
    s_cbranch_scc1 .ap_8
    s_waitcnt vmcnt(1)
.ap_8:
    s_add_u32 s63, s69, 442368
    buffer_load_dwordx4 v[152:155], v1, s[40:43], s63 offen nt
    s_waitcnt vmcnt(4)
    s_sub_u32 s63, s70, 300
    v_subrev_u32 v156, s63, v156
    v_mov_b32 v157, 600
    v_cmp_lt_u32 s[8:9], v156, v157
    v_add_u32_dpp v156, v156, v156 quad_perm:[1,0,3,2] row_mask:0xf bank_mask:0xf
    s_nop 1
    v_add_u32_dpp v156, v156, v156 quad_perm:[2,3,0,1] row_mask:0xf bank_mask:0xf
    s_nop 1
    v_add_u32_dpp v156, v156, v156 row_ror:4 row_mask:0xf bank_mask:0xf
    s_nop 0
    v_readfirstlane_b32 s63, v156
    s_cmp_eq_u64 s[8:9], -1
    s_nop 3
    s_cbranch_scc0 .et_9
    s_lshr_b32 s63, s63, 3
    s_sub_u32 s63, s63, 300
    s_add_u32 s30, s30, s63
    s_add_u32 s31, s31, s63
.et_9:
    s_memrealtime s[8:9]
    s_waitcnt lgkmcnt(0)
    s_sub_u32 s8, s8, s30
    s_cmpk_ge_u32 s8, 1347
    s_cbranch_scc1 .ap_10
    s_waitcnt vmcnt(4)
    s_cmpk_ge_u32 s8, 1247
    s_cbranch_scc1 .ap_10
    s_waitcnt vmcnt(3)
    s_bitcmp1_b64 s[14:15], 31
    s_cbranch_scc0 1
    s_waitcnt vmcnt(2)
    s_cmpk_ge_u32 s8, 1127
    s_cbranch_scc1 .ap_10
    s_waitcnt vmcnt(1)
.ap_10:
    s_add_u32 s63, s69, 450560
    buffer_load_dwordx4 v[156:159], v1, s[40:43], s63 offen nt
    s_memrealtime s[8:9]
    s_waitcnt lgkmcnt(0)
    s_sub_u32 s8, s8, s30
    s_cmpk_ge_u32 s8, 1374
    s_cbranch_scc1 .ap_11
    s_waitcnt vmcnt(5)
    s_cmpk_ge_u32 s8, 1274
    s_cbranch_scc1 .ap_11
    s_waitcnt vmcnt(3)
    s_bitcmp1_b64 s[14:15], 32
    s_cbranch_scc0 1
    s_waitcnt vmcnt(2)
    s_cmpk_ge_u32 s8, 1154
    s_cbranch_scc1 .ap_11
    s_waitcnt vmcnt(1)
.ap_11:
    v_bfe_u32 v1, v0, 4, 2
    v_and_b32 v10, 0xf0, v2
    v_lshlrev_b32 v1, 2, v1
    v_bfe_u32 v1, s6, v1, 4
    v_lshl_add_u32 v1, v1, 8, v10
    s_add_u32 s63, s69, 0
    buffer_load_dwordx4 v[160:163], v1, s[44:47], s63 offen nt
    s_memrealtime s[8:9]
    s_waitcnt lgkmcnt(0)
    s_sub_u32 s8, s8, s30
    s_cmpk_ge_u32 s8, 1401
    s_cbranch_scc1 .ap_12
    s_waitcnt vmcnt(5)
    s_cmpk_ge_u32 s8, 1301
    s_cbranch_scc1 .ap_12
    s_waitcnt vmcnt(3)
    s_bitcmp1_b64 s[14:15], 33
    s_cbranch_scc0 1
    s_waitcnt vmcnt(2)
    s_cmpk_ge_u32 s8, 1181
    s_cbranch_scc1 .ap_12
    s_waitcnt vmcnt(1)
.ap_12:
    s_add_u32 s63, s69, 8192
    buffer_load_dwordx4 v[164:167], v1, s[44:47], s63 offen nt
    s_memrealtime s[8:9]
    s_waitcnt lgkmcnt(0)
    s_sub_u32 s8, s8, s30
    s_cmpk_ge_u32 s8, 1428
    s_cbranch_scc1 .ap_13
    s_waitcnt vmcnt(5)
    s_cmpk_ge_u32 s8, 1328
    s_cbranch_scc1 .ap_13
    s_waitcnt vmcnt(3)
    s_bitcmp1_b64 s[14:15], 34
    s_cbranch_scc0 1
    s_waitcnt vmcnt(2)
    s_cmpk_ge_u32 s8, 1208
    s_cbranch_scc1 .ap_13
    s_branch .Lsk_n1_0
.Lst_n1_0:
    s_branch .Lrt_n1_0
.Lsk_n1_0:
    s_waitcnt vmcnt(1)
.ap_13:
    s_add_u32 s63, s69, 16384
    buffer_load_dwordx4 v[168:171], v1, s[44:47], s63 offen nt
    s_memrealtime s[8:9]
    s_waitcnt lgkmcnt(0)
    s_sub_u32 s8, s8, s30
    s_cmpk_ge_u32 s8, 1456
    s_cbranch_scc1 .ap_14
    s_waitcnt vmcnt(5)
    s_cmpk_ge_u32 s8, 1356
    s_cbranch_scc1 .ap_14
    s_waitcnt vmcnt(3)
    s_bitcmp1_b64 s[14:15], 35
    s_cbranch_scc0 1
    s_waitcnt vmcnt(2)
    s_cmpk_ge_u32 s8, 1236
    s_cbranch_scc1 .ap_14
    s_waitcnt vmcnt(1)
.ap_14:
    s_add_u32 s63, s69, 24576
    buffer_load_dwordx4 v[172:175], v1, s[44:47], s63 offen nt
    buffer_load_dwordx4 v[16:19], v7, s[36:39], s58 offen offset:0 sc1
    buffer_load_dwordx4 v[20:23], v7, s[36:39], s58 offen offset:256 sc1
    s_memrealtime s[8:9]
    s_waitcnt vmcnt(8)
    s_waitcnt lgkmcnt(0)
    s_sub_u32 s8, s8, s30
    s_cmpk_ge_u32 s8, 1486
    s_cbranch_scc1 .ap_15
    s_waitcnt vmcnt(5)
    s_cmpk_ge_u32 s8, 1386
    s_cbranch_scc1 .ap_15
    s_waitcnt vmcnt(3)
    s_bitcmp1_b64 s[14:15], 36
    s_cbranch_scc0 1
    s_waitcnt vmcnt(2)
    s_cmpk_ge_u32 s8, 1266
    s_cbranch_scc1 .ap_15
    s_waitcnt vmcnt(1)
.ap_15:
    s_add_u32 s63, s69, 32768
    buffer_load_dwordx4 v[176:179], v1, s[44:47], s63 offen nt
    s_memrealtime s[8:9]
    s_waitcnt vmcnt(8)
    s_waitcnt lgkmcnt(0)
    s_sub_u32 s8, s8, s30
    s_cmpk_ge_u32 s8, 1516
    s_cbranch_scc1 .ap_16
    s_waitcnt vmcnt(5)
    s_cmpk_ge_u32 s8, 1416
    s_cbranch_scc1 .ap_16
    s_waitcnt vmcnt(3)
    s_bitcmp1_b64 s[14:15], 37
    s_cbranch_scc0 1
    s_waitcnt vmcnt(2)
    s_cmpk_ge_u32 s8, 1296
    s_cbranch_scc1 .ap_16
    s_waitcnt vmcnt(1)
.ap_16:
    s_add_u32 s63, s69, 40960
    buffer_load_dwordx4 v[180:183], v1, s[44:47], s63 offen nt
    s_memrealtime s[8:9]
    s_waitcnt vmcnt(8)
    s_waitcnt lgkmcnt(0)
    s_sub_u32 s8, s8, s30
    s_cmpk_ge_u32 s8, 1546
    s_cbranch_scc1 .ap_17
    s_waitcnt vmcnt(5)
    s_cmpk_ge_u32 s8, 1446
    s_cbranch_scc1 .ap_17
    s_waitcnt vmcnt(3)
    s_bitcmp1_b64 s[14:15], 38
    s_cbranch_scc0 1
    s_waitcnt vmcnt(2)
    s_cmpk_ge_u32 s8, 1326
    s_cbranch_scc1 .ap_17
    s_waitcnt vmcnt(1)
.ap_17:
    s_add_u32 s63, s69, 49152
    buffer_load_dwordx4 v[184:187], v1, s[44:47], s63 offen nt
    s_waitcnt vmcnt(3)
    s_branch .gpc_19
.gp_18:
    buffer_load_dwordx4 v[16:19], v7, s[36:39], s58 offen offset:0 sc1
    buffer_load_dwordx4 v[20:23], v7, s[36:39], s58 offen offset:256 sc1
    s_waitcnt vmcnt(0)
.gpc_19:
    v_min_u32 v10, v17, v19
    v_max_u32 v11, v17, v19
    v_min3_u32 v10, v10, v21, v23
    v_max3_u32 v11, v11, v21, v23
    v_cmp_eq_u32 vcc, s34, v10
    v_cmp_eq_u32 s[56:57], s34, v11
    s_and_b64 vcc, vcc, s[56:57]
    s_cmp_eq_u64 vcc, -1
    s_nop 2
    s_cbranch_scc1 .gpd_20
    s_sub_u32 s35, s35, 1
    s_cbranch_scc1 .Lexit
    s_sleep 1
    s_branch .gp_18
.gpd_20:
    s_mov_b32 vcc_lo, 0xcccccccc
    s_mov_b32 vcc_hi, 0xcccccccc
    v_cndmask_b32_e64 v24, v16, 0, vcc
    v_cndmask_b32_e64 v25, v18, 0, vcc
    v_cndmask_b32_e64 v26, v20, 0, vcc
    v_cndmask_b32_e64 v27, v22, 0, vcc
    v_cndmask_b32_e32 v28, 0, v16, vcc
    v_cndmask_b32_e32 v29, 0, v18, vcc
    v_cndmask_b32_e32 v30, 0, v20, vcc
    v_cndmask_b32_e32 v31, 0, v22, vcc
    v_mfma_f32_16x16x32_bf16 v[16:19], v[32:35], v[24:27], 0
    v_mfma_f32_16x16x32_bf16 v[32:35], v[40:43], v[24:27], 0
    v_mfma_f32_16x16x32_bf16 v[16:19], v[36:39], v[28:31], v[16:19]
    v_mfma_f32_16x16x32_bf16 v[40:43], v[48:51], v[24:27], 0
    v_mfma_f32_16x16x32_bf16 v[32:35], v[44:47], v[28:31], v[32:35]
    v_mfma_f32_16x16x32_bf16 v[48:51], v[56:59], v[24:27], 0
    v_mfma_f32_16x16x32_bf16 v[40:43], v[52:55], v[28:31], v[40:43]
    v_mfma_f32_16x16x32_bf16 v[56:59], v[64:67], v[24:27], 0
    v_mfma_f32_16x16x32_bf16 v[48:51], v[60:63], v[28:31], v[48:51]
    s_nop 1
    v_add_f32_dpp v10, v17, v16 row_ror:12 row_mask:0xf bank_mask:0x1
    s_memrealtime s[8:9]
    s_waitcnt lgkmcnt(0)
    s_sub_u32 s8, s8, s30
    s_cmpk_ge_u32 s8, 1576
    s_nop 0
    s_cbranch_scc1 .ap_21
    s_waitcnt vmcnt(3)
    s_cmpk_ge_u32 s8, 1476
    s_cbranch_scc1 .ap_21
    s_waitcnt vmcnt(3)
    s_bitcmp1_b64 s[14:15], 39
    s_cbranch_scc0 1
    s_waitcnt vmcnt(2)
    s_cmpk_ge_u32 s8, 1356
    s_cbranch_scc1 .ap_21
    s_waitcnt vmcnt(1)
.ap_21:
    s_add_u32 s63, s69, 57344
    buffer_load_dwordx4 v[188:191], v1, s[44:47], s63 offen nt
    v_mfma_f32_16x16x32_bf16 v[64:67], v[72:75], v[24:27], 0
    v_mfma_f32_16x16x32_bf16 v[56:59], v[68:71], v[28:31], v[56:59]
    v_add_f32_dpp v11, v33, v32 row_ror:12 row_mask:0xf bank_mask:0x1
    v_add_f32_dpp v10, v18, v10 row_ror:8 row_mask:0xf bank_mask:0x1
    v_mfma_f32_16x16x32_bf16 v[72:75], v[80:83], v[24:27], 0
    v_mfma_f32_16x16x32_bf16 v[64:67], v[76:79], v[28:31], v[64:67]
    v_add_f32_dpp v12, v41, v40 row_ror:12 row_mask:0xf bank_mask:0x1
    v_add_f32_dpp v11, v34, v11 row_ror:8 row_mask:0xf bank_mask:0x1
    v_add_f32_dpp v10, v19, v10 row_ror:4 row_mask:0xf bank_mask:0x1
    v_mfma_f32_16x16x32_bf16 v[80:83], v[88:91], v[24:27], 0
    v_mfma_f32_16x16x32_bf16 v[72:75], v[84:87], v[28:31], v[72:75]
    v_add_f32_dpp v13, v49, v48 row_ror:12 row_mask:0xf bank_mask:0x1
    v_add_f32_dpp v12, v42, v12 row_ror:8 row_mask:0xf bank_mask:0x1
    v_add_f32_dpp v11, v35, v11 row_ror:4 row_mask:0xf bank_mask:0x1
    v_mfma_f32_16x16x32_bf16 v[88:91], v[96:99], v[24:27], 0
    v_mfma_f32_16x16x32_bf16 v[80:83], v[92:95], v[28:31], v[80:83]
    v_add_f32_dpp v10, v58, v57 row_ror:12 row_mask:0xf bank_mask:0x2
    v_add_f32_dpp v13, v50, v13 row_ror:8 row_mask:0xf bank_mask:0x1
    v_add_f32_dpp v12, v43, v12 row_ror:4 row_mask:0xf bank_mask:0x1
    s_memrealtime s[8:9]
    s_waitcnt lgkmcnt(0)
    s_sub_u32 s8, s8, s30
    s_cmpk_ge_u32 s8, 1606
    s_nop 0
    s_cbranch_scc1 .ap_22
    s_waitcnt vmcnt(4)
    s_cmpk_ge_u32 s8, 1506
    s_cbranch_scc1 .ap_22
    s_waitcnt vmcnt(3)
    s_bitcmp1_b64 s[14:15], 40
    s_cbranch_scc0 1
    s_waitcnt vmcnt(2)
    s_cmpk_ge_u32 s8, 1386
    s_cbranch_scc1 .ap_22
    s_waitcnt vmcnt(1)
.ap_22:
    s_add_u32 s63, s69, 131072
    buffer_load_dwordx4 v[192:195], v1, s[44:47], s63 offen nt
    v_mfma_f32_16x16x32_bf16 v[96:99], v[104:107], v[24:27], 0
    v_mfma_f32_16x16x32_bf16 v[88:91], v[100:103], v[28:31], v[88:91]
    v_add_f32_dpp v11, v66, v65 row_ror:12 row_mask:0xf bank_mask:0x2
    v_add_f32_dpp v10, v59, v10 row_ror:8 row_mask:0xf bank_mask:0x2
    v_add_f32_dpp v13, v51, v13 row_ror:4 row_mask:0xf bank_mask:0x1
    v_mfma_f32_16x16x32_bf16 v[104:107], v[112:115], v[24:27], 0
    v_mfma_f32_16x16x32_bf16 v[96:99], v[108:111], v[28:31], v[96:99]
    v_add_f32_dpp v12, v74, v73 row_ror:12 row_mask:0xf bank_mask:0x2
    v_add_f32_dpp v11, v67, v11 row_ror:8 row_mask:0xf bank_mask:0x2
    v_add_f32_dpp v10, v56, v10 row_ror:4 row_mask:0xf bank_mask:0x2
    v_mfma_f32_16x16x32_bf16 v[112:115], v[120:123], v[24:27], 0
    v_mfma_f32_16x16x32_bf16 v[104:107], v[116:119], v[28:31], v[104:107]
    v_add_f32_dpp v13, v82, v81 row_ror:12 row_mask:0xf bank_mask:0x2
    v_add_f32_dpp v12, v75, v12 row_ror:8 row_mask:0xf bank_mask:0x2
    v_add_f32_dpp v11, v64, v11 row_ror:4 row_mask:0xf bank_mask:0x2
    v_mfma_f32_16x16x32_bf16 v[120:123], v[128:131], v[24:27], 0
    v_mfma_f32_16x16x32_bf16 v[112:115], v[124:127], v[28:31], v[112:115]
    v_add_f32_dpp v10, v91, v90 row_ror:12 row_mask:0xf bank_mask:0x4
    v_add_f32_dpp v13, v83, v13 row_ror:8 row_mask:0xf bank_mask:0x2
    v_add_f32_dpp v12, v72, v12 row_ror:4 row_mask:0xf bank_mask:0x2
    s_branch .Lsk_n1_1
.Lst_n1_1:
    s_branch .Lrt_n1_1
.Lsk_n1_1:
    s_memrealtime s[8:9]
    s_waitcnt lgkmcnt(0)
    s_sub_u32 s8, s8, s30
    s_cmpk_ge_u32 s8, 1636
    s_nop 0
    s_cbranch_scc1 .ap_23
    s_waitcnt vmcnt(5)
    s_cmpk_ge_u32 s8, 1536
    s_cbranch_scc1 .ap_23
    s_waitcnt vmcnt(3)
    s_bitcmp1_b64 s[14:15], 41
    s_cbranch_scc0 1
    s_waitcnt vmcnt(2)
    s_cmpk_ge_u32 s8, 1416
    s_cbranch_scc1 .ap_23
    s_waitcnt vmcnt(1)
.ap_23:
    s_add_u32 s63, s69, 139264
    buffer_load_dwordx4 v[196:199], v1, s[44:47], s63 offen nt
    v_mfma_f32_16x16x32_bf16 v[128:131], v[136:139], v[24:27], 0
    v_mfma_f32_16x16x32_bf16 v[120:123], v[132:135], v[28:31], v[120:123]
    v_add_f32_dpp v11, v99, v98 row_ror:12 row_mask:0xf bank_mask:0x4
    v_add_f32_dpp v10, v88, v10 row_ror:8 row_mask:0xf bank_mask:0x4
    v_add_f32_dpp v13, v80, v13 row_ror:4 row_mask:0xf bank_mask:0x2
    v_mfma_f32_16x16x32_bf16 v[136:139], v[144:147], v[24:27], 0
    v_mfma_f32_16x16x32_bf16 v[128:131], v[140:143], v[28:31], v[128:131]
    v_add_f32_dpp v12, v107, v106 row_ror:12 row_mask:0xf bank_mask:0x4
    v_add_f32_dpp v11, v96, v11 row_ror:8 row_mask:0xf bank_mask:0x4
    v_add_f32_dpp v10, v89, v10 row_ror:4 row_mask:0xf bank_mask:0x4
    v_mfma_f32_16x16x32_bf16 v[144:147], v[152:155], v[24:27], 0
    v_mfma_f32_16x16x32_bf16 v[136:139], v[148:151], v[28:31], v[136:139]
    v_add_f32_dpp v13, v115, v114 row_ror:12 row_mask:0xf bank_mask:0x4
    v_add_f32_dpp v12, v104, v12 row_ror:8 row_mask:0xf bank_mask:0x4
    v_add_f32_dpp v11, v97, v11 row_ror:4 row_mask:0xf bank_mask:0x4
    v_mfma_f32_16x16x32_bf16 v[144:147], v[156:159], v[28:31], v[144:147]
    v_add_f32_dpp v10, v120, v123 row_ror:12 row_mask:0xf bank_mask:0x8
    v_add_f32_dpp v13, v112, v13 row_ror:8 row_mask:0xf bank_mask:0x4
    v_add_f32_dpp v12, v105, v12 row_ror:4 row_mask:0xf bank_mask:0x4
    s_branch .Lsk_n1_2
.Lst_n1_2:
    s_branch .Lrt_n1_2
.Lsk_n1_2:
    s_memrealtime s[8:9]
    s_waitcnt lgkmcnt(0)
    s_sub_u32 s8, s8, s30
    s_cmpk_ge_u32 s8, 1666
    s_nop 0
    s_cbranch_scc1 .ap_24
    s_waitcnt vmcnt(5)
    s_cmpk_ge_u32 s8, 1566
    s_cbranch_scc1 .ap_24
    s_waitcnt vmcnt(3)
    s_bitcmp1_b64 s[14:15], 42
    s_cbranch_scc0 1
    s_waitcnt vmcnt(2)
    s_cmpk_ge_u32 s8, 1446
    s_cbranch_scc1 .ap_24
    s_waitcnt vmcnt(1)
.ap_24:
    s_add_u32 s63, s69, 147456
    buffer_load_dwordx4 v[200:203], v1, s[44:47], s63 offen nt
    v_add_f32_dpp v11, v128, v131 row_ror:12 row_mask:0xf bank_mask:0x8
    v_add_f32_dpp v10, v121, v10 row_ror:8 row_mask:0xf bank_mask:0x8
    v_add_f32_dpp v13, v113, v13 row_ror:4 row_mask:0xf bank_mask:0x4
    v_add_f32_dpp v12, v136, v139 row_ror:12 row_mask:0xf bank_mask:0x8
    v_add_f32_dpp v11, v129, v11 row_ror:8 row_mask:0xf bank_mask:0x8
    v_add_f32_dpp v10, v122, v10 row_ror:4 row_mask:0xf bank_mask:0x8
    v_add_f32_dpp v13, v144, v147 row_ror:12 row_mask:0xf bank_mask:0x8
    v_add_f32_dpp v12, v137, v12 row_ror:8 row_mask:0xf bank_mask:0x8
    v_add_f32_dpp v11, v130, v11 row_ror:4 row_mask:0xf bank_mask:0x8
    v_add_f32_dpp v13, v145, v13 row_ror:8 row_mask:0xf bank_mask:0x8
    v_add_f32_dpp v12, v138, v12 row_ror:4 row_mask:0xf bank_mask:0x8
    s_memrealtime s[8:9]
    s_waitcnt lgkmcnt(0)
    s_sub_u32 s8, s8, s30
    s_cmpk_ge_u32 s8, 1696
    s_cbranch_scc1 .ap_25
    s_waitcnt vmcnt(5)
    s_cmpk_ge_u32 s8, 1596
    s_cbranch_scc1 .ap_25
    s_waitcnt vmcnt(3)
    s_bitcmp1_b64 s[14:15], 43
    s_cbranch_scc0 1
    s_waitcnt vmcnt(2)
    s_cmpk_ge_u32 s8, 1476
    s_cbranch_scc1 .ap_25
    s_waitcnt vmcnt(1)
.ap_25:
    s_add_u32 s63, s69, 155648
    buffer_load_dwordx4 v[204:207], v1, s[44:47], s63 offen nt
    v_add_f32_dpp v13, v146, v13 row_ror:4 row_mask:0xf bank_mask:0x8
    s_mov_b32 s60, 0x3db504f3
    s_mov_b32 s61, 0x3db504f3
    v_cvt_pk_bf16_f32 v10, v10, v11
    v_and_b32 v11, 0xffff0000, v10
    v_lshlrev_b32 v10, 16, v10
    v_cvt_pk_bf16_f32 v12, v12, v13
    v_and_b32 v13, 0xffff0000, v12
    v_lshlrev_b32 v12, 16, v12
    v_pk_mul_f32 v[10:11], v[10:11], s[60:61]
    v_pk_mul_f32 v[12:13], v[12:13], s[60:61]
    v_cvt_pk_bf16_f32 v10, v10, v11
    v_and_b32 v11, 0xffff0000, v10
    v_lshlrev_b32 v10, 16, v10
    v_cvt_pk_bf16_f32 v12, v12, v13
    v_and_b32 v13, 0xffff0000, v12
    v_lshlrev_b32 v12, 16, v12
    v_max_f32 v14, v10, v11
    v_max3_f32 v14, v14, v12, v13
    s_mov_b32 s60, 0x3fb8aa3b
    v_mov_b32 v22, s34
    v_mov_b32 v23, s34
    v_max_f32_dpp v14, v14, v14 quad_perm:[2,3,0,1] row_mask:0xf bank_mask:0xf
    s_nop 1
    v_max_f32_dpp v14, v14, v14 row_ror:4 row_mask:0xf bank_mask:0xf
    s_nop 1
    v_max_f32_dpp v14, v14, v14 row_ror:8 row_mask:0xf bank_mask:0xf
    v_mov_b32 v15, v14
    s_nop 1
    v_permlane16_swap_b32 v15, v14
    v_max_f32 v14, v15, v14
    v_mov_b32 v15, v14
    s_nop 1
    v_permlane32_swap_b32 v15, v14
    v_max_f32 v14, v15, v14
    v_mul_f32 v15, 0xbfb8aa3b, v14
    v_fma_f32 v10, v10, s60, v15
    v_fma_f32 v11, v11, s60, v15
    v_fma_f32 v12, v12, s60, v15
    v_fma_f32 v13, v13, s60, v15
    v_exp_f32 v10, v10
    v_exp_f32 v11, v11
    v_exp_f32 v12, v12
    v_exp_f32 v13, v13
    v_mov_b32 v20, v14
    v_pk_add_f32 v[16:17], v[10:11], v[12:13]
    v_add_f32 v21, v16, v17
    s_lshl_b32 s60, s68, 5
    s_lshl_b32 s61, s3, 4
    s_add_u32 s61, s61, 159104
    v_add_u32 v16, s61, v3
    v_mov_b32 v17, 159232
    v_mov_b32 v18, 1
    s_add_u32 s60, s60, s59
    v_add_f32_dpp v21, v21, v21 quad_perm:[2,3,0,1] row_mask:0xf bank_mask:0xf
    s_nop 1
    v_add_f32_dpp v21, v21, v21 row_ror:4 row_mask:0xf bank_mask:0xf
    s_nop 1
    v_add_f32_dpp v21, v21, v21 row_ror:8 row_mask:0xf bank_mask:0xf
    v_mov_b32 v15, v21
    s_nop 1
    v_permlane16_swap_b32 v15, v21
    v_add_f32 v21, v15, v21
    v_mov_b32 v15, v21
    s_nop 1
    v_permlane32_swap_b32 v15, v21
    v_add_f32 v21, v15, v21
    s_mov_b64 exec, 3
    ds_write_b64 v16, v[20:21]
    s_mov_b64 exec, 1
    ds_add_rtn_u32 v18, v17, v18
    s_mov_b64 exec, -1
    v_and_b32 v16, 0x78, v3
    v_or_b32 v16, 159104, v16
    s_waitcnt lgkmcnt(0)
    v_readfirstlane_b32 s61, v18
    s_cmp_eq_u32 s61, 7
    s_nop 3
    s_cbranch_scc0 .mlc_26
    ds_read_b64 v[18:19], v16
    s_waitcnt lgkmcnt(0)
    v_mov_b32 v20, v18
    s_nop 1
    v_max_f32_dpp v20, v20, v20 quad_perm:[2,3,0,1] row_mask:0xf bank_mask:0xf
    s_nop 1
    v_max_f32_dpp v20, v20, v20 row_ror:4 row_mask:0xf bank_mask:0xf
    s_nop 1
    v_max_f32_dpp v20, v20, v20 row_ror:8 row_mask:0xf bank_mask:0xf
    v_sub_f32 v18, v18, v20
    v_mul_f32 v18, 0x3fb8aa3b, v18
    v_exp_f32 v18, v18
    s_nop 0
    v_mul_f32 v21, v18, v19
    s_nop 1
    v_add_f32_dpp v21, v21, v21 quad_perm:[2,3,0,1] row_mask:0xf bank_mask:0xf
    s_nop 1
    v_add_f32_dpp v21, v21, v21 row_ror:4 row_mask:0xf bank_mask:0xf
    s_nop 1
    v_add_f32_dpp v21, v21, v21 row_ror:8 row_mask:0xf bank_mask:0xf
    s_mov_b64 exec, 3
    buffer_store_dwordx4 v[20:23], v2, s[36:39], s60 offen sc1
    s_mov_b64 exec, -1
.mlc_26:
    s_memrealtime s[8:9]
    s_waitcnt lgkmcnt(0)
    s_sub_u32 s8, s8, s30
    s_cmpk_ge_u32 s8, 1726
    s_cbranch_scc1 .ap_27
    s_waitcnt vmcnt(5)
    s_cmpk_ge_u32 s8, 1626
    s_cbranch_scc1 .ap_27
    s_waitcnt vmcnt(3)
    s_bitcmp1_b64 s[14:15], 44
    s_cbranch_scc0 1
    s_waitcnt vmcnt(2)
    s_cmpk_ge_u32 s8, 1506
    s_cbranch_scc1 .ap_27
    s_waitcnt vmcnt(1)
.ap_27:
    s_add_u32 s63, s69, 163840
    buffer_load_dwordx4 v[208:211], v1, s[44:47], s63 offen nt
    s_memrealtime s[8:9]
    s_waitcnt vmcnt(8)
    s_waitcnt lgkmcnt(0)
    s_sub_u32 s8, s8, s30
    s_cmpk_ge_u32 s8, 1756
    s_cbranch_scc1 .ap_28
    s_waitcnt vmcnt(5)
    s_cmpk_ge_u32 s8, 1656
    s_cbranch_scc1 .ap_28
    s_waitcnt vmcnt(3)
    s_bitcmp1_b64 s[14:15], 45
    s_cbranch_scc0 1
    s_waitcnt vmcnt(2)
    s_cmpk_ge_u32 s8, 1536
    s_cbranch_scc1 .ap_28
    s_waitcnt vmcnt(1)
.ap_28:
    s_add_u32 s63, s69, 172032
    buffer_load_dwordx4 v[212:215], v1, s[44:47], s63 offen nt
    s_memrealtime s[8:9]
    s_waitcnt vmcnt(8)
    s_waitcnt lgkmcnt(0)
    s_sub_u32 s8, s8, s30
    s_cmpk_ge_u32 s8, 1788
    s_cbranch_scc1 .ap_29
    s_waitcnt vmcnt(5)
    s_cmpk_ge_u32 s8, 1688
    s_cbranch_scc1 .ap_29
    s_waitcnt vmcnt(3)
    s_bitcmp1_b64 s[14:15], 46
    s_cbranch_scc0 1
    s_waitcnt vmcnt(2)
    s_cmpk_ge_u32 s8, 1568
    s_cbranch_scc1 .ap_29
    s_waitcnt vmcnt(1)
.ap_29:
    s_add_u32 s63, s69, 180224
    buffer_load_dwordx4 v[216:219], v1, s[44:47], s63 offen nt
    s_branch .Lsk_n1_3
.Lst_n1_3:
    s_branch .Lrt_n1_3
.Lsk_n1_3:
    s_memrealtime s[8:9]
    s_waitcnt vmcnt(8)
    s_waitcnt lgkmcnt(0)
    s_sub_u32 s8, s8, s30
    s_cmpk_ge_u32 s8, 1820
    s_cbranch_scc1 .ap_30
    s_waitcnt vmcnt(5)
    s_cmpk_ge_u32 s8, 1720
    s_cbranch_scc1 .ap_30
    s_waitcnt vmcnt(3)
    s_bitcmp1_b64 s[14:15], 47
    s_cbranch_scc0 1
    s_waitcnt vmcnt(2)
    s_cmpk_ge_u32 s8, 1600
    s_cbranch_scc1 .ap_30
    s_waitcnt vmcnt(1)
.ap_30:
    s_add_u32 s63, s69, 188416
    buffer_load_dwordx4 v[220:223], v1, s[44:47], s63 offen nt
    s_memrealtime s[8:9]
    s_waitcnt vmcnt(8)
    s_waitcnt lgkmcnt(0)
    s_sub_u32 s8, s8, s30
    s_cmpk_ge_u32 s8, 1852
    s_cbranch_scc1 .ap_31
    s_waitcnt vmcnt(5)
    s_cmpk_ge_u32 s8, 1752
    s_cbranch_scc1 .ap_31
    s_waitcnt vmcnt(3)
    s_bitcmp1_b64 s[14:15], 48
    s_cbranch_scc0 1
    s_waitcnt vmcnt(2)
    s_cmpk_ge_u32 s8, 1632
    s_cbranch_scc1 .ap_31
    s_waitcnt vmcnt(1)
.ap_31:
    s_add_u32 s63, s69, 262144
    buffer_load_dwordx4 v[224:227], v1, s[44:47], s63 offen nt
    s_memrealtime s[8:9]
    s_waitcnt vmcnt(8)
    s_waitcnt lgkmcnt(0)
    s_sub_u32 s8, s8, s30
    s_cmpk_ge_u32 s8, 1884
    s_cbranch_scc1 .ap_32
    s_waitcnt vmcnt(5)
    s_cmpk_ge_u32 s8, 1784
    s_cbranch_scc1 .ap_32
    s_waitcnt vmcnt(3)
    s_bitcmp1_b64 s[14:15], 49
    s_cbranch_scc0 1
    s_waitcnt vmcnt(2)
    s_cmpk_ge_u32 s8, 1664
    s_cbranch_scc1 .ap_32
    s_waitcnt vmcnt(1)
.ap_32:
    s_add_u32 s63, s69, 270336
    buffer_load_dwordx4 v[228:231], v1, s[44:47], s63 offen nt
    s_memrealtime s[8:9]
    s_waitcnt vmcnt(8)
    s_waitcnt lgkmcnt(0)
    s_sub_u32 s8, s8, s30
    s_cmpk_ge_u32 s8, 1916
    s_cbranch_scc1 .ap_33
    s_waitcnt vmcnt(5)
    s_cmpk_ge_u32 s8, 1816
    s_cbranch_scc1 .ap_33
    s_waitcnt vmcnt(3)
    s_bitcmp1_b64 s[14:15], 50
    s_cbranch_scc0 1
    s_waitcnt vmcnt(2)
    s_cmpk_ge_u32 s8, 1696
    s_cbranch_scc1 .ap_33
    s_waitcnt vmcnt(1)
.ap_33:
    s_add_u32 s63, s69, 278528
    buffer_load_dwordx4 v[232:235], v1, s[44:47], s63 offen nt
    s_memrealtime s[8:9]
    s_waitcnt vmcnt(8)
    s_waitcnt lgkmcnt(0)
    s_sub_u32 s8, s8, s30
    s_cmpk_ge_u32 s8, 1948
    s_cbranch_scc1 .ap_34
    s_waitcnt vmcnt(5)
    s_cmpk_ge_u32 s8, 1848
    s_cbranch_scc1 .ap_34
    s_waitcnt vmcnt(3)
    s_bitcmp1_b64 s[14:15], 51
    s_cbranch_scc0 1
    s_waitcnt vmcnt(2)
    s_cmpk_ge_u32 s8, 1728
    s_cbranch_scc1 .ap_34
    s_waitcnt vmcnt(1)
.ap_34:
    s_add_u32 s63, s69, 286720
    buffer_load_dwordx4 v[236:239], v1, s[44:47], s63 offen nt
    s_memrealtime s[8:9]
    s_waitcnt vmcnt(8)
    s_waitcnt lgkmcnt(0)
    s_sub_u32 s8, s8, s30
    s_cmpk_ge_u32 s8, 1980
    s_cbranch_scc1 .ap_35
    s_waitcnt vmcnt(5)
    s_cmpk_ge_u32 s8, 1880
    s_cbranch_scc1 .ap_35
    s_waitcnt vmcnt(3)
    s_bitcmp1_b64 s[14:15], 52
    s_cbranch_scc0 1
    s_waitcnt vmcnt(2)
    s_cmpk_ge_u32 s8, 1760
    s_cbranch_scc1 .ap_35
    s_waitcnt vmcnt(1)
.ap_35:
    s_add_u32 s63, s69, 294912
    buffer_load_dwordx4 v[240:243], v1, s[44:47], s63 offen nt
    s_memrealtime s[8:9]
    s_waitcnt vmcnt(8)
    s_waitcnt lgkmcnt(0)
    s_sub_u32 s8, s8, s30
    s_cmpk_ge_u32 s8, 2012
    s_cbranch_scc1 .ap_36
    s_waitcnt vmcnt(5)
    s_cmpk_ge_u32 s8, 1912
    s_cbranch_scc1 .ap_36
    s_waitcnt vmcnt(3)
    s_bitcmp1_b64 s[14:15], 53
    s_cbranch_scc0 1
    s_waitcnt vmcnt(2)
    s_cmpk_ge_u32 s8, 1792
    s_cbranch_scc1 .ap_36
    s_waitcnt vmcnt(1)
.ap_36:
    s_add_u32 s63, s69, 303104
    buffer_load_dwordx4 v[244:247], v1, s[44:47], s63 offen nt
    s_and_b32 s0, s0, 0xffffff80
    s_sub_u32 s0, s0, 1024
    buffer_load_dword v28, v4, s[36:39], s0 offen sc1
    buffer_load_dwordx4 v[24:27], v9, s[36:39], s59 offen offset:0 sc1
    s_memrealtime s[8:9]
    s_waitcnt vmcnt(9)
    s_waitcnt lgkmcnt(0)
    s_sub_u32 s8, s8, s30
    s_cmpk_ge_u32 s8, 2044
    s_cbranch_scc1 .ap_37
    s_waitcnt vmcnt(6)
    s_cmpk_ge_u32 s8, 1944
    s_cbranch_scc1 .ap_37
    s_waitcnt vmcnt(4)
    s_bitcmp1_b64 s[14:15], 54
    s_cbranch_scc0 1
    s_waitcnt vmcnt(3)
    s_cmpk_ge_u32 s8, 1824
    s_cbranch_scc1 .ap_37
    s_waitcnt vmcnt(2)
.ap_37:
    s_add_u32 s63, s69, 311296
    buffer_load_dwordx4 v[248:251], v1, s[44:47], s63 offen nt
    s_memrealtime s[8:9]
    s_waitcnt vmcnt(9)
    s_waitcnt lgkmcnt(0)
    s_sub_u32 s8, s8, s30
    s_cmpk_ge_u32 s8, 2076
    s_cbranch_scc1 .ap_38
    s_waitcnt vmcnt(6)
    s_cmpk_ge_u32 s8, 1976
    s_cbranch_scc1 .ap_38
    s_waitcnt vmcnt(4)
    s_bitcmp1_b64 s[14:15], 55
    s_cbranch_scc0 1
    s_waitcnt vmcnt(3)
    s_cmpk_ge_u32 s8, 1856
    s_cbranch_scc1 .ap_38
    s_waitcnt vmcnt(1)
.ap_38:
    s_add_u32 s63, s69, 319488
    buffer_load_dwordx4 v[252:255], v1, s[44:47], s63 offen nt
    s_memrealtime s[8:9]
    s_waitcnt vmcnt(9)
    s_waitcnt lgkmcnt(0)
    s_sub_u32 s8, s8, s30
    s_cmpk_ge_u32 s8, 2108
    s_cbranch_scc1 .ap_39
    s_waitcnt vmcnt(6)
    s_cmpk_ge_u32 s8, 2008
    s_cbranch_scc1 .ap_39
    s_waitcnt vmcnt(4)
    s_bitcmp1_b64 s[14:15], 56
    s_cbranch_scc0 1
    s_waitcnt vmcnt(2)
    s_cmpk_ge_u32 s8, 1888
    s_cbranch_scc1 .ap_39
    s_waitcnt vmcnt(1)
.ap_39:
    s_add_u32 s63, s69, 393216
    buffer_load_dwordx4 v[36:39], v1, s[44:47], s63 offen nt
    s_memrealtime s[8:9]
    s_waitcnt vmcnt(9)
    s_waitcnt lgkmcnt(0)
    s_sub_u32 s8, s8, s30
    s_cmpk_ge_u32 s8, 2140
    s_cbranch_scc1 .ap_40
    s_waitcnt vmcnt(6)
    s_cmpk_ge_u32 s8, 2040
    s_cbranch_scc1 .ap_40
    s_waitcnt vmcnt(3)
    s_bitcmp1_b64 s[14:15], 57
    s_cbranch_scc0 1
    s_waitcnt vmcnt(2)
    s_cmpk_ge_u32 s8, 1920
    s_cbranch_scc1 .ap_40
    s_waitcnt vmcnt(1)
.ap_40:
    s_add_u32 s63, s69, 401408
    buffer_load_dwordx4 v[44:47], v1, s[44:47], s63 offen nt
    s_memrealtime s[8:9]
    s_waitcnt vmcnt(9)
    s_waitcnt lgkmcnt(0)
    s_sub_u32 s8, s8, s30
    s_cmpk_ge_u32 s8, 2172
    s_cbranch_scc1 .ap_41
    s_waitcnt vmcnt(6)
    s_cmpk_ge_u32 s8, 2072
    s_cbranch_scc1 .ap_41
    s_waitcnt vmcnt(3)
    s_bitcmp1_b64 s[14:15], 58
    s_cbranch_scc0 1
    s_waitcnt vmcnt(2)
    s_cmpk_ge_u32 s8, 1952
    s_cbranch_scc1 .ap_41
    s_waitcnt vmcnt(1)
.ap_41:
    s_add_u32 s63, s69, 409600
    buffer_load_dwordx4 v[52:55], v1, s[44:47], s63 offen nt
    s_waitcnt vmcnt(5)
    s_branch .gpc_43
.gp_42:
    buffer_load_dwordx4 v[24:27], v9, s[36:39], s59 offen offset:0 sc1
    s_waitcnt vmcnt(0)
.gpc_43:
    v_cmp_eq_u32 vcc, s34, v26
    s_cmp_eq_u64 vcc, -1
    s_nop 3
    s_cbranch_scc1 .gpd_44
    s_sub_u32 s35, s35, 1
    s_branch .Lsk_n1_4
.Lst_n1_4:
    s_branch .Lrt_n1_4
.Lsk_n1_4:
    s_cbranch_scc1 .Lexit
    s_sleep 1
    s_branch .gp_42
.gpd_44:
    v_cmp_eq_u32 vcc, s1, v28
    s_cmp_eq_u64 vcc, -1
    s_cselect_b32 s0, 0x800000, 0
    v_mov_b32 v16, v24
    s_nop 1
    v_max_f32_dpp v16, v16, v16 row_ror:4 row_mask:0xf bank_mask:0xf
    v_sub_f32 v17, v24, v16
    v_sub_f32 v18, v14, v16
    v_mul_f32 v17, 0x3fb8aa3b, v17
    v_mul_f32 v18, 0x3fb8aa3b, v18
    v_exp_f32 v17, v17
    v_exp_f32 v18, v18
    v_mul_f32 v17, v17, v25
    s_nop 1
    v_add_f32_dpp v17, v17, v17 row_ror:4 row_mask:0xf bank_mask:0xf
    v_rcp_f32 v19, v17
    s_nop 0
    v_fma_f32 v15, -v17, v19, 1.0
    v_fma_f32 v19, v15, v19, v19
    v_mul_f32 v18, v18, v19
    v_mul_f32 v10, v10, v18
    v_mul_f32 v11, v11, v18
    v_mul_f32 v12, v12, v18
    v_mul_f32 v13, v13, v18
    v_mov_b32_dpp v112, v10 quad_perm:[2,3,0,1] row_mask:0xf bank_mask:0xf
    v_mov_b32_dpp v113, v11 quad_perm:[2,3,0,1] row_mask:0xf bank_mask:0xf
    v_mov_b32_dpp v114, v12 quad_perm:[2,3,0,1] row_mask:0xf bank_mask:0xf
    v_mov_b32_dpp v115, v13 quad_perm:[2,3,0,1] row_mask:0xf bank_mask:0xf
    v_cvt_pk_bf16_f32 v96, v10, v112
    v_cvt_pk_bf16_f32 v100, v11, v113
    v_cvt_pk_bf16_f32 v104, v12, v114
    v_cvt_pk_bf16_f32 v108, v13, v115
    v_mov_b32_dpp v97, v96 row_ror:12 row_mask:0xf bank_mask:0xf
    v_mov_b32_dpp v101, v100 row_ror:12 row_mask:0xf bank_mask:0xf
    v_mov_b32_dpp v105, v104 row_ror:12 row_mask:0xf bank_mask:0xf
    v_mov_b32_dpp v109, v108 row_ror:12 row_mask:0xf bank_mask:0xf
    v_mov_b32_dpp v98, v96 row_ror:8 row_mask:0xf bank_mask:0xf
    v_mov_b32_dpp v102, v100 row_ror:8 row_mask:0xf bank_mask:0xf
    v_mov_b32_dpp v106, v104 row_ror:8 row_mask:0xf bank_mask:0xf
    v_mov_b32_dpp v110, v108 row_ror:8 row_mask:0xf bank_mask:0xf
    v_mov_b32_dpp v99, v96 row_ror:4 row_mask:0xf bank_mask:0xf
    v_mov_b32_dpp v103, v100 row_ror:4 row_mask:0xf bank_mask:0xf
    v_mov_b32_dpp v107, v104 row_ror:4 row_mask:0xf bank_mask:0xf
    v_mov_b32_dpp v111, v108 row_ror:4 row_mask:0xf bank_mask:0xf
    s_lshl_b32 s60, s3, 10
    s_add_u32 s60, s60, 147456
    v_lshlrev_b32 v10, 5, v0
    v_add_u32 v10, s60, v10
    s_memrealtime s[8:9]
    s_waitcnt lgkmcnt(0)
    s_sub_u32 s8, s8, s30
    s_cmpk_ge_u32 s8, 2204
    s_cbranch_scc1 .ap_45
    s_waitcnt vmcnt(5)
    s_cmpk_ge_u32 s8, 2104
    s_cbranch_scc1 .ap_45
    s_waitcnt vmcnt(3)
    s_bitcmp1_b64 s[14:15], 59
    s_cbranch_scc0 1
    s_waitcnt vmcnt(2)
    s_cmpk_ge_u32 s8, 1984
    s_cbranch_scc1 .ap_45
    s_waitcnt vmcnt(1)
.ap_45:
    s_add_u32 s63, s69, 417792
    buffer_load_dwordx4 v[60:63], v1, s[44:47], s63 offen nt
    v_perm_b32 v112, v164, v160, s94
    v_perm_b32 v113, v172, v168, s94
    v_perm_b32 v114, v180, v176, s94
    v_perm_b32 v115, v188, v184, s94
    s_nop 1
    v_mfma_f32_16x16x32_bf16 v[128:131], v[96:99], v[112:115], 0
    v_perm_b32 v116, v164, v160, s95
    v_perm_b32 v117, v172, v168, s95
    v_perm_b32 v118, v180, v176, s95
    v_perm_b32 v119, v188, v184, s95
    s_nop 1
    v_mfma_f32_16x16x32_bf16 v[132:135], v[96:99], v[116:119], 0
    v_perm_b32 v120, v165, v161, s94
    v_perm_b32 v121, v173, v169, s94
    v_perm_b32 v122, v181, v177, s94
    v_perm_b32 v123, v189, v185, s94
    s_nop 1
    v_mfma_f32_16x16x32_bf16 v[136:139], v[96:99], v[120:123], 0
    v_perm_b32 v124, v165, v161, s95
    v_perm_b32 v125, v173, v169, s95
    v_perm_b32 v126, v181, v177, s95
    v_perm_b32 v127, v189, v185, s95
    s_nop 1
    v_mfma_f32_16x16x32_bf16 v[140:143], v[96:99], v[124:127], 0
    v_perm_b32 v112, v166, v162, s94
    v_perm_b32 v113, v174, v170, s94
    v_perm_b32 v114, v182, v178, s94
    v_perm_b32 v115, v190, v186, s94
    s_nop 1
    v_mfma_f32_16x16x32_bf16 v[144:147], v[96:99], v[112:115], 0
    v_perm_b32 v116, v166, v162, s95
    v_perm_b32 v117, v174, v170, s95
    v_perm_b32 v118, v182, v178, s95
    v_perm_b32 v119, v190, v186, s95
    s_nop 1
    v_mfma_f32_16x16x32_bf16 v[148:151], v[96:99], v[116:119], 0
    v_perm_b32 v120, v167, v163, s94
    v_perm_b32 v121, v175, v171, s94
    v_perm_b32 v122, v183, v179, s94
    v_perm_b32 v123, v191, v187, s94
    s_nop 1
    v_mfma_f32_16x16x32_bf16 v[152:155], v[96:99], v[120:123], 0
    v_perm_b32 v124, v167, v163, s95
    v_perm_b32 v125, v175, v171, s95
    v_perm_b32 v126, v183, v179, s95
    v_perm_b32 v127, v191, v187, s95
    s_nop 1
    v_mfma_f32_16x16x32_bf16 v[156:159], v[96:99], v[124:127], 0
    s_memrealtime s[8:9]
    s_waitcnt lgkmcnt(0)
    s_sub_u32 s8, s8, s30
    s_cmpk_ge_u32 s8, 2236
    s_nop 3
    s_cbranch_scc1 .ap_46
    s_waitcnt vmcnt(5)
    s_cmpk_ge_u32 s8, 2136
    s_cbranch_scc1 .ap_46
    s_waitcnt vmcnt(3)
    s_bitcmp1_b64 s[14:15], 60
    s_cbranch_scc0 1
    s_waitcnt vmcnt(2)
    s_cmpk_ge_u32 s8, 2016
    s_cbranch_scc1 .ap_46
    s_waitcnt vmcnt(1)
.ap_46:
    s_add_u32 s63, s69, 425984
    buffer_load_dwordx4 v[68:71], v1, s[44:47], s63 offen nt
    v_perm_b32 v112, v196, v192, s94
    v_perm_b32 v113, v204, v200, s94
    v_perm_b32 v114, v212, v208, s94
    v_perm_b32 v115, v220, v216, s94
    s_nop 1
    v_mfma_f32_16x16x32_bf16 v[128:131], v[100:103], v[112:115], v[128:131]
    v_perm_b32 v116, v196, v192, s95
    v_perm_b32 v117, v204, v200, s95
    v_perm_b32 v118, v212, v208, s95
    v_perm_b32 v119, v220, v216, s95
    s_nop 1
    v_mfma_f32_16x16x32_bf16 v[132:135], v[100:103], v[116:119], v[132:135]
    v_perm_b32 v120, v197, v193, s94
    v_perm_b32 v121, v205, v201, s94
    v_perm_b32 v122, v213, v209, s94
    v_perm_b32 v123, v221, v217, s94
    s_nop 1
    v_mfma_f32_16x16x32_bf16 v[136:139], v[100:103], v[120:123], v[136:139]
    v_perm_b32 v124, v197, v193, s95
    v_perm_b32 v125, v205, v201, s95
    v_perm_b32 v126, v213, v209, s95
    v_perm_b32 v127, v221, v217, s95
    s_nop 1
    v_mfma_f32_16x16x32_bf16 v[140:143], v[100:103], v[124:127], v[140:143]
    v_perm_b32 v112, v198, v194, s94
    v_perm_b32 v113, v206, v202, s94
    v_perm_b32 v114, v214, v210, s94
    v_perm_b32 v115, v222, v218, s94
    s_nop 1
    v_mfma_f32_16x16x32_bf16 v[144:147], v[100:103], v[112:115], v[144:147]
    v_perm_b32 v116, v198, v194, s95
    v_perm_b32 v117, v206, v202, s95
    v_perm_b32 v118, v214, v210, s95
    v_perm_b32 v119, v222, v218, s95
    s_branch .Lsk_n1_5
.Lst_n1_5:
    s_branch .Lrt_n1_5
.Lsk_n1_5:
    s_nop 1
    v_mfma_f32_16x16x32_bf16 v[148:151], v[100:103], v[116:119], v[148:151]
    v_perm_b32 v120, v199, v195, s94
    v_perm_b32 v121, v207, v203, s94
    v_perm_b32 v122, v215, v211, s94
    v_perm_b32 v123, v223, v219, s94
    s_nop 1
    v_mfma_f32_16x16x32_bf16 v[152:155], v[100:103], v[120:123], v[152:155]
    v_perm_b32 v124, v199, v195, s95
    v_perm_b32 v125, v207, v203, s95
    v_perm_b32 v126, v215, v211, s95
    v_perm_b32 v127, v223, v219, s95
    s_nop 1
    v_mfma_f32_16x16x32_bf16 v[156:159], v[100:103], v[124:127], v[156:159]
    s_memrealtime s[8:9]
    s_waitcnt lgkmcnt(0)
    s_sub_u32 s8, s8, s30
    s_cmpk_ge_u32 s8, 2268
    s_nop 3
    s_cbranch_scc1 .ap_47
    s_waitcnt vmcnt(5)
    s_cmpk_ge_u32 s8, 2168
    s_cbranch_scc1 .ap_47
    s_waitcnt vmcnt(3)
    s_bitcmp1_b64 s[14:15], 61
    s_cbranch_scc0 1
    s_waitcnt vmcnt(2)
    s_cmpk_ge_u32 s8, 2048
    s_cbranch_scc1 .ap_47
    s_waitcnt vmcnt(1)
.ap_47:
    s_add_u32 s63, s69, 434176
    buffer_load_dwordx4 v[76:79], v1, s[44:47], s63 offen nt
    s_waitcnt vmcnt(6)
    v_perm_b32 v112, v228, v224, s94
    v_perm_b32 v113, v236, v232, s94
    v_perm_b32 v114, v244, v240, s94
    v_perm_b32 v115, v252, v248, s94
    s_nop 1
    v_mfma_f32_16x16x32_bf16 v[128:131], v[104:107], v[112:115], v[128:131]
    v_perm_b32 v116, v228, v224, s95
    v_perm_b32 v117, v236, v232, s95
    v_perm_b32 v118, v244, v240, s95
    v_perm_b32 v119, v252, v248, s95
    s_nop 1
    v_mfma_f32_16x16x32_bf16 v[132:135], v[104:107], v[116:119], v[132:135]
    v_perm_b32 v120, v229, v225, s94
    v_perm_b32 v121, v237, v233, s94
    v_perm_b32 v122, v245, v241, s94
    v_perm_b32 v123, v253, v249, s94
    s_nop 1
    v_mfma_f32_16x16x32_bf16 v[136:139], v[104:107], v[120:123], v[136:139]
    v_perm_b32 v124, v229, v225, s95
    v_perm_b32 v125, v237, v233, s95
    v_perm_b32 v126, v245, v241, s95
    v_perm_b32 v127, v253, v249, s95
    s_nop 1
    v_mfma_f32_16x16x32_bf16 v[140:143], v[104:107], v[124:127], v[140:143]
    v_perm_b32 v112, v230, v226, s94
    v_perm_b32 v113, v238, v234, s94
    v_perm_b32 v114, v246, v242, s94
    v_perm_b32 v115, v254, v250, s94
    s_nop 1
    v_mfma_f32_16x16x32_bf16 v[144:147], v[104:107], v[112:115], v[144:147]
    v_perm_b32 v116, v230, v226, s95
    v_perm_b32 v117, v238, v234, s95
    v_perm_b32 v118, v246, v242, s95
    v_perm_b32 v119, v254, v250, s95
    s_nop 1
    v_mfma_f32_16x16x32_bf16 v[148:151], v[104:107], v[116:119], v[148:151]
    v_perm_b32 v120, v231, v227, s94
    v_perm_b32 v121, v239, v235, s94
    v_perm_b32 v122, v247, v243, s94
    v_perm_b32 v123, v255, v251, s94
    s_nop 1
    v_mfma_f32_16x16x32_bf16 v[152:155], v[104:107], v[120:123], v[152:155]
    v_perm_b32 v124, v231, v227, s95
    v_perm_b32 v125, v239, v235, s95
    v_perm_b32 v126, v247, v243, s95
    v_perm_b32 v127, v255, v251, s95
    s_nop 1
    v_mfma_f32_16x16x32_bf16 v[156:159], v[104:107], v[124:127], v[156:159]
    s_memrealtime s[8:9]
    s_waitcnt lgkmcnt(0)
    s_sub_u32 s8, s8, s30
    s_cmpk_ge_u32 s8, 2300
    s_nop 3
    s_cbranch_scc1 .ap_48
    s_waitcnt vmcnt(5)
    s_cmpk_ge_u32 s8, 2200
    s_cbranch_scc1 .ap_48
    s_waitcnt vmcnt(3)
    s_bitcmp1_b64 s[14:15], 62
    s_cbranch_scc0 1
    s_waitcnt vmcnt(2)
    s_cmpk_ge_u32 s8, 2080
    s_cbranch_scc1 .ap_48
    s_waitcnt vmcnt(1)
.ap_48:
    s_add_u32 s63, s69, 442368
    buffer_load_dwordx4 v[84:87], v1, s[44:47], s63 offen nt
    s_memrealtime s[8:9]
    s_waitcnt lgkmcnt(0)
    s_sub_u32 s8, s8, s30
    s_cmpk_ge_u32 s8, 2332
    s_cbranch_scc1 .ap_49
    s_waitcnt vmcnt(5)
    s_cmpk_ge_u32 s8, 2232
    s_cbranch_scc1 .ap_49
    s_waitcnt vmcnt(3)
    s_bitcmp1_b64 s[14:15], 63
    s_cbranch_scc0 1
    s_waitcnt vmcnt(2)
    s_cmpk_ge_u32 s8, 2112
    s_cbranch_scc1 .ap_49
    s_waitcnt vmcnt(1)
.ap_49:
    s_add_u32 s63, s69, 450560
    buffer_load_dwordx4 v[92:95], v1, s[44:47], s63 offen nt
    s_setprio 0
    s_waitcnt vmcnt(6)
    v_perm_b32 v160, v44, v36, s94
    v_perm_b32 v164, v44, v36, s95
    v_perm_b32 v168, v45, v37, s94
    v_perm_b32 v172, v45, v37, s95
    v_perm_b32 v176, v46, v38, s94
    v_perm_b32 v180, v46, v38, s95
    v_perm_b32 v184, v47, v39, s94
    v_perm_b32 v188, v47, v39, s95
    s_waitcnt vmcnt(4)
    v_perm_b32 v161, v60, v52, s94
    v_perm_b32 v165, v60, v52, s95
    v_perm_b32 v169, v61, v53, s94
    v_perm_b32 v173, v61, v53, s95
    v_perm_b32 v177, v62, v54, s94
    v_perm_b32 v181, v62, v54, s95
    v_perm_b32 v185, v63, v55, s94
    v_perm_b32 v189, v63, v55, s95
    s_branch .Lsk_n1_6
.Lst_n1_6:
    s_branch .Lrt_n1_6
.Lsk_n1_6:
    s_waitcnt vmcnt(2)
    v_perm_b32 v162, v76, v68, s94
    v_perm_b32 v166, v76, v68, s95
    v_perm_b32 v170, v77, v69, s94
    v_perm_b32 v174, v77, v69, s95
    v_perm_b32 v178, v78, v70, s94
    v_perm_b32 v182, v78, v70, s95
    v_perm_b32 v186, v79, v71, s94
    v_perm_b32 v190, v79, v71, s95
    s_waitcnt vmcnt(0)
    s_cmp_lt_u32 s65, 8
    s_cbranch_scc1 .wol_50
    s_lshl_b32 s56, s3, 10
    s_add_u32 m0, s56, 24576
    s_add_u32 s56, s101, 221184
    s_mov_b64 exec, s[18:19]
    buffer_load_dwordx4 v6, s[48:51], s56 offen nt lds
    s_mov_b64 exec, -1
    s_lshl_b32 s56, s3, 10
    s_add_u32 m0, s56, 57344
    s_add_u32 s56, s101, 221312
    s_mov_b64 exec, s[18:19]
    buffer_load_dwordx4 v6, s[48:51], s56 offen nt lds
    s_mov_b64 exec, -1
    s_lshl_b32 s56, s3, 10
    s_add_u32 m0, s56, 90112
    s_add_u32 s56, s101, 221440
    s_mov_b64 exec, s[18:19]
    buffer_load_dwordx4 v6, s[48:51], s56 offen nt lds
    s_mov_b64 exec, -1
.wol_50:
    v_perm_b32 v163, v92, v84, s94
    v_perm_b32 v167, v92, v84, s95
    v_perm_b32 v171, v93, v85, s94
    v_mfma_f32_16x16x32_bf16 v[128:131], v[108:111], v[160:163], v[128:131]
    v_perm_b32 v175, v93, v85, s95
    v_mfma_f32_16x16x32_bf16 v[132:135], v[108:111], v[164:167], v[132:135]
    v_perm_b32 v179, v94, v86, s94
    v_mfma_f32_16x16x32_bf16 v[136:139], v[108:111], v[168:171], v[136:139]
    v_perm_b32 v183, v94, v86, s95
    v_mfma_f32_16x16x32_bf16 v[140:143], v[108:111], v[172:175], v[140:143]
    v_perm_b32 v187, v95, v87, s94
    v_mfma_f32_16x16x32_bf16 v[144:147], v[108:111], v[176:179], v[144:147]
    v_perm_b32 v191, v95, v87, s95
    v_mfma_f32_16x16x32_bf16 v[148:151], v[108:111], v[180:183], v[148:151]
    v_mfma_f32_16x16x32_bf16 v[152:155], v[108:111], v[184:187], v[152:155]
    v_mfma_f32_16x16x32_bf16 v[156:159], v[108:111], v[188:191], v[156:159]
    s_mov_b64 exec, 0xffff
    ds_write2_b32 v10, v128, v129 offset0:0 offset1:128
    ds_write2_b32 v10, v132, v133 offset0:1 offset1:129
    ds_write2_b32 v10, v136, v137 offset0:2 offset1:130
    ds_write2_b32 v10, v140, v141 offset0:3 offset1:131
    ds_write2_b32 v10, v144, v145 offset0:4 offset1:132
    ds_write2_b32 v10, v148, v149 offset0:5 offset1:133
    ds_write2_b32 v10, v152, v153 offset0:6 offset1:134
    ds_write2_b32 v10, v156, v157 offset0:7 offset1:135
    s_mov_b64 exec, -1
    s_waitcnt lgkmcnt(0)
    s_barrier
    s_cmp_lg_u32 s3, 7
    s_cbranch_scc1 .opub_51
    v_add_u32 v10, 147456, v2
    ds_read_b128 v[196:199], v10 offset:0
    ds_read_b128 v[200:203], v10 offset:1024
    ds_read_b128 v[204:207], v10 offset:2048
    ds_read_b128 v[208:211], v10 offset:3072
    ds_read_b128 v[212:215], v10 offset:4096
    ds_read_b128 v[216:219], v10 offset:5120
    ds_read_b128 v[220:223], v10 offset:6144
    ds_read_b128 v[224:227], v10 offset:7168
    v_lshrrev_b32 v11, 5, v0
    v_lshlrev_b32 v11, 13, v11
    v_and_b32 v12, 31, v0
    v_lshl_add_u32 v11, v12, 4, v11
    s_lshl4_add_u32 s56, s67, s66
    s_lshl1_add_u32 s56, s56, s68
    s_lshl_b32 s56, s56, 9
    s_add_u32 s56, s56, 0xa0000
    s_mov_b32 s60, 0x07060503
    s_mov_b32 s61, 0x07060502
    s_mov_b32 s62, 0x07060501
    v_mov_b32 v15, s34
    s_waitcnt lgkmcnt(6)
    v_pk_add_f32 v[196:197], v[196:197], v[200:201]
    v_pk_add_f32 v[198:199], v[198:199], v[202:203]
    s_waitcnt lgkmcnt(5)
    v_pk_add_f32 v[196:197], v[196:197], v[204:205]
    v_pk_add_f32 v[198:199], v[198:199], v[206:207]
    s_waitcnt lgkmcnt(4)
    v_pk_add_f32 v[196:197], v[196:197], v[208:209]
    v_pk_add_f32 v[198:199], v[198:199], v[210:211]
    s_waitcnt lgkmcnt(3)
    v_pk_add_f32 v[196:197], v[196:197], v[212:213]
    v_pk_add_f32 v[198:199], v[198:199], v[214:215]
    s_waitcnt lgkmcnt(2)
    v_pk_add_f32 v[196:197], v[196:197], v[216:217]
    v_pk_add_f32 v[198:199], v[198:199], v[218:219]
    s_waitcnt lgkmcnt(1)
    v_pk_add_f32 v[196:197], v[196:197], v[220:221]
    v_pk_add_f32 v[198:199], v[198:199], v[222:223]
    s_waitcnt lgkmcnt(0)
    v_pk_add_f32 v[196:197], v[196:197], v[224:225]
    v_pk_add_f32 v[198:199], v[198:199], v[226:227]
    v_perm_b32 v12, v196, v199, s60
    v_perm_b32 v13, v197, v199, s61
    v_perm_b32 v14, v198, v199, s62
    s_add_u32 s57, s56, 0x800000
    buffer_store_dwordx4 v[12:15], v11, s[36:39], s57 offen
    s_cmp_lg_u32 s0, 0
    s_nop 0
    s_cbranch_scc1 .nosl_52
    buffer_store_dwordx4 v[12:15], v11, s[36:39], s56 offen sc1
.nosl_52:
.opub_51:
    s_cmp_lt_u32 s65, 8
    s_nop 0
    s_cbranch_scc1 .Lexit
    v_mov_b32 v6, 0
    v_bfe_u32 v7, v0, 4, 1
    v_lshl_add_u32 v6, v7, 7, v6
    v_bfe_u32 v7, v0, 2, 2
    v_lshl_add_u32 v6, v7, 5, v6
    v_bfe_u32 v7, v0, 5, 1
    v_lshl_add_u32 v6, v7, 4, v6
    v_bfe_u32 v7, v0, 0, 2
    v_lshl_add_u32 v6, v7, 2, v6
    s_mul_i32 s56, s3, 528
    s_add_u32 s56, s56, 131072
    v_add_u32 v6, s56, v6
    s_lshl4_add_u32 s101, s99, s3
    s_lshl_b32 s101, s101, 10
    s_add_u32 s101, s101, 0xa0000
    v_add_u32 v5, 8192, v2
    s_cmp_ge_u32 s3, 6
    s_nop 0
    s_cbranch_scc1 .La_w67
    v_lshrrev_b32 v16, 4, v0
    v_bfe_u32 v17, v0, 2, 2
    v_lshl_add_u32 v7, v16, 3, v17
    v_lshlrev_b32 v7, 7, v7
    v_and_b32 v16, 1, v16
    v_lshrrev_b32 v17, 1, v17
    v_lshl_add_u32 v16, v16, 1, v17
    s_and_b32 s56, s3, 1
    s_lshl_b32 s56, s56, 1
    v_xor_b32 v16, s56, v16
    v_and_b32 v17, 3, v0
    v_lshl_add_u32 v7, v17, 3, v7
    s_lshr_b32 s56, s3, 1
    s_lshl_b32 s56, s56, 15
    v_add_u32 v7, s56, v7
    v_xor_b32 v17, 1, v16
    v_lshl_add_u32 v8, v17, 5, v7
    v_lshl_add_u32 v7, v16, 5, v7
    ds_read_b64_tr_b16 v[32:33], v7 offset:0
    ds_read_b64_tr_b16 v[34:35], v7 offset:512
    ds_read_b64_tr_b16 v[64:65], v8 offset:0
    ds_read_b64_tr_b16 v[66:67], v8 offset:512
    ds_read_b64_tr_b16 v[36:37], v7 offset:4096
    ds_read_b64_tr_b16 v[38:39], v7 offset:4608
    ds_read_b64_tr_b16 v[68:69], v8 offset:4096
    ds_read_b64_tr_b16 v[70:71], v8 offset:4608
    ds_read_b64_tr_b16 v[40:41], v7 offset:8192
    ds_read_b64_tr_b16 v[42:43], v7 offset:8704
    s_branch .Lsk_n1_7
.Lst_n1_7:
    s_branch .Lrt_n1_7
.Lsk_n1_7:
    ds_read_b64_tr_b16 v[72:73], v8 offset:8192
    ds_read_b64_tr_b16 v[74:75], v8 offset:8704
    ds_read_b64_tr_b16 v[44:45], v7 offset:12288
    ds_read_b64_tr_b16 v[46:47], v7 offset:12800
    ds_read_b64_tr_b16 v[76:77], v8 offset:12288
    ds_read_b64_tr_b16 v[78:79], v8 offset:12800
    ds_read_b64_tr_b16 v[48:49], v7 offset:16384
    ds_read_b64_tr_b16 v[50:51], v7 offset:16896
    ds_read_b64_tr_b16 v[80:81], v8 offset:16384
    ds_read_b64_tr_b16 v[82:83], v8 offset:16896
    ds_read_b64_tr_b16 v[52:53], v7 offset:20480
    ds_read_b64_tr_b16 v[54:55], v7 offset:20992
    ds_read_b64_tr_b16 v[84:85], v8 offset:20480
    ds_read_b64_tr_b16 v[86:87], v8 offset:20992
    s_mov_b32 s56, 131072
    v_bfe_u32 v9, v0, 1, 3
    v_mul_u32_u24 v9, 528, v9
    v_and_b32 v16, 48, v0
    v_lshl_add_u32 v9, v16, 1, v9
    v_and_b32 v16, 1, v0
    v_lshlrev_b32 v16, 4, v16
    v_add3_u32 v9, v9, v16, s56
    v_lshrrev_b32 v10, 4, v0
    v_and_b32 v16, 1, v0
    v_lshl_add_u32 v10, v10, 1, v16
    v_mul_u32_u24 v10, 36864, v10
    v_bfe_u32 v16, v0, 1, 3
    v_lshl_add_u32 v10, v16, 4, v10
    s_mul_i32 s59, s100, 3
    s_lshr_b32 s56, s3, 1
    s_add_u32 s59, s59, s56
    s_lshl4_add_u32 s59, s59, s99
    s_and_b32 s56, s3, 1
    s_lshl1_add_u32 s59, s59, s56
    s_lshl_b32 s59, s59, 7
    s_add_u32 s59, s59, 0xe0000
    v_mov_b32 v139, s34
    v_mov_b32 v140, 0x4444
    v_mov_b32 v141, 0xeeee
    v_cndmask_b32 v140, v140, v141, s[96:97]
    v_mov_b32 v128, 0
    v_mov_b32 v129, 0
    v_mov_b32 v130, 0
    v_mov_b32 v131, 0
    v_mov_b32 v132, 0
    v_mov_b32 v133, 0
    v_mov_b32 v134, 0
    v_mov_b32 v135, 0
    s_waitcnt vmcnt(0)
    s_barrier
    ds_read_b64_tr_b16 v[56:57], v7 offset:24576
    ds_read_b64_tr_b16 v[58:59], v7 offset:25088
    ds_read_b64_tr_b16 v[88:89], v8 offset:24576
    ds_read_b64_tr_b16 v[90:91], v8 offset:25088
    ds_read_b64_tr_b16 v[60:61], v7 offset:28672
    ds_read_b64_tr_b16 v[62:63], v7 offset:29184
    ds_read_b64_tr_b16 v[92:93], v8 offset:28672
    ds_read_b64_tr_b16 v[94:95], v8 offset:29184
    s_branch .La_poll
.La_w67:
    s_cmp_eq_u32 s3, 7
    s_cbranch_scc0 2
    s_waitcnt vmcnt(1)
    s_branch 1
    s_waitcnt vmcnt(0)
    s_barrier
.La_poll:
    s_mov_b32 s60, 0x04000c0c
    s_mov_b32 s61, 0x0706000c
    s_mov_b32 s69, 0
.gp_53:
    s_add_u32 s69, s69, 1
    s_and_b32 s56, s69, 0x41
    s_cmp_lg_u32 s56, 0x41
    s_cselect_b32 s56, 0, 0x800000
    s_xor_b32 s56, s56, s0
    s_add_u32 s58, s101, s56
    buffer_load_dwordx4 v[16:19], v2, s[36:39], s58 offen offset:0 sc1
    buffer_load_dwordx4 v[20:23], v5, s[36:39], s58 offen offset:0 sc1
    s_waitcnt vmcnt(0)
    v_cmp_eq_u32 vcc, s34, v19
    v_cmp_eq_u32 s[56:57], s34, v23
    s_and_b64 vcc, vcc, s[56:57]
    s_cmp_eq_u64 vcc, -1
    s_nop 2
    s_cbranch_scc1 .gpd_54
    s_sub_u32 s35, s35, 1
    s_cbranch_scc1 .Lexit
    s_branch .gp_53
.gpd_54:
    v_perm_b32 v19, v16, v17, s60
    v_perm_b32 v19, v19, v18, s61
    v_perm_b32 v23, v20, v21, s60
    v_perm_b32 v23, v23, v22, s61
    v_permlane32_swap_b32 v16, v18
    v_permlane32_swap_b32 v17, v19
    v_permlane32_swap_b32 v20, v22
    v_permlane32_swap_b32 v21, v23
    v_pk_add_f32 v[16:17], v[16:17], v[18:19]
    v_pk_add_f32 v[20:21], v[20:21], v[22:23]
    v_cvt_pk_bf16_f32 v16, v16, v17
    v_cvt_pk_bf16_f32 v20, v20, v21
    ds_write2_b32 v6, v16, v20 offset1:64
    s_mov_b32 s60, 0x07060503
    s_mov_b32 s61, 0x07060502
    s_mov_b32 s62, 0x07060501
    s_mov_b32 vcc_lo, 0x55555555
    s_mov_b32 vcc_hi, 0x55555555
    s_waitcnt lgkmcnt(0)
    s_barrier
    s_cmp_ge_u32 s3, 6
    s_cbranch_scc1 .Lexit
    ds_read_b128 v[96:99], v9 offset:0
    ds_read_b128 v[100:103], v9 offset:128
    ds_read_b128 v[104:107], v9 offset:256
    ds_read_b128 v[108:111], v9 offset:384
    s_waitcnt lgkmcnt(3)
    v_smfmac_f32_16x16x64_bf16 v[128:131], v[96:99], v[32:39], v140
    v_smfmac_f32_16x16x64_bf16 v[132:135], v[96:99], v[64:71], v140
    s_waitcnt lgkmcnt(2)
    v_smfmac_f32_16x16x64_bf16 v[128:131], v[100:103], v[40:47], v140
    v_smfmac_f32_16x16x64_bf16 v[132:135], v[100:103], v[72:79], v140
    s_waitcnt lgkmcnt(1)
    v_smfmac_f32_16x16x64_bf16 v[128:131], v[104:107], v[48:55], v140
    v_smfmac_f32_16x16x64_bf16 v[132:135], v[104:107], v[80:87], v140
    s_waitcnt lgkmcnt(0)
    v_smfmac_f32_16x16x64_bf16 v[128:131], v[108:111], v[56:63], v140
    v_smfmac_f32_16x16x64_bf16 v[132:135], v[108:111], v[88:95], v140
    s_nop 6
    v_add_f32 v128, v128, v129
    v_add_f32 v130, v130, v131
    v_add_f32 v132, v132, v133
    v_add_f32 v134, v134, v135
    s_not_b64 vcc, vcc
    v_cndmask_b32_dpp v129, v128, v130, vcc quad_perm:[1,0,3,2] row_mask:0xf bank_mask:0xf
    v_cndmask_b32_dpp v131, v132, v134, vcc quad_perm:[1,0,3,2] row_mask:0xf bank_mask:0xf
    s_not_b64 vcc, vcc
    v_cndmask_b32_dpp v128, v130, v128, vcc quad_perm:[1,0,3,2] row_mask:0xf bank_mask:0xf
    v_cndmask_b32_dpp v130, v134, v132, vcc quad_perm:[1,0,3,2] row_mask:0xf bank_mask:0xf
    v_perm_b32 v136, v128, v131, s60
    v_perm_b32 v137, v129, v131, s61
    v_perm_b32 v138, v130, v131, s62
    buffer_store_dwordx4 v[136:139], v10, s[36:39], s59 offen sc1
    s_nop 1
    s_branch .Lexit
.Lm:
    s_branch .Lsk_m0_0
.Lst_m0_0:
    s_branch .Lrt_m0_0
.Lsk_m0_0:
    s_cmp_lt_u32 s2, 54
    s_mov_b32 s14, 0xfdff7fdf
    s_cselect_b32 s14, 0x6b5ad6b5, s14
    s_mov_b32 s15, 0xff7fdff7
    s_cselect_b32 s15, 0x5ad6b5ad, s15
    s_add_u32 s30, s70, 0
    s_mov_b32 s31, s70
    v_bfe_u32 v16, v0, 1, 3
    v_mul_u32_u24 v16, 1312, v16
    v_lshrrev_b32 v12, 4, v0
    v_lshl_add_u32 v16, v12, 5, v16
    v_and_b32 v12, 1, v0
    v_lshl_add_u32 v16, v12, 4, v16
    v_add_u32 v16, 147456, v16
    s_mul_i32 s56, s3, 1312
    s_add_u32 s56, s56, 147456
    v_add_u32 v17, s56, v3
    v_add_u32 v18, s56, v4
    v_lshrrev_b32 v12, 4, v0
    v_bfe_u32 v13, v0, 1, 1
    v_lshl_add_u32 v12, v12, 1, v13
    v_bfe_u32 v13, v0, 2, 2
    v_lshl_add_u32 v20, v12, 3, v13
    v_lshlrev_b32 v20, 7, v20
    v_and_b32 v12, 3, v12
    v_lshrrev_b32 v13, 1, v13
    v_lshl_add_u32 v12, v12, 1, v13
    v_xor_b32 v12, s3, v12
    v_lshl_add_u32 v20, v12, 4, v20
    v_and_b32 v12, 1, v0
    v_lshl_add_u32 v20, v12, 3, v20
    v_bfe_u32 v23, v0, 1, 3
    v_mul_u32_u24 v23, 144, v23
    v_bfe_u32 v12, v0, 4, 1
    v_lshl_add_u32 v23, v12, 3, v23
    v_lshrrev_b32 v12, 5, v0
    v_lshl_add_u32 v23, v12, 2, v23
    v_and_b32 v12, 1, v0
    v_lshl_add_u32 v23, v12, 1, v23
    s_lshl_b32 s56, s3, 4
    s_add_u32 s56, s56, 157952
    v_add_u32 v23, s56, v23
    v_and_b32 v24, 15, v0
    v_lshlrev_b32 v24, 3, v24
    s_mul_i32 s56, s3, 144
    s_add_u32 s56, s56, 157952
    v_add_u32 v24, s56, v24
    v_add_u32 v21, 32768, v20
    s_lshl_b32 s100, s3, 10
    s_mov_b32 s99, s2
    s_cmp_ge_u32 s99, 18
    s_cbranch_scc1 .Lm_rel
    s_mul_i32 s58, s3, 1152
    s_mov_b32 s52, s24
    s_and_b32 s53, s25, 0xffff
    s_mov_b32 s54, 0x2400
    s_mov_b32 s55, 0x00020000
    buffer_load_dwordx2 v[246:247], v3, s[52:55], s58 offen
    buffer_load_dwordx2 v[248:249], v3, s[52:55], s58 offen offset:512
    buffer_load_dword v250, v4, s[52:55], s58 offen
    s_mov_b32 s48, s26
    s_and_b32 s49, s27, 0xffff
    s_mov_b32 s50, 0x3cc000
    s_mov_b32 s51, 0x00020000
    v_bfe_u32 v12, v0, 4, 1
    s_and_b32 s56, s3, 3
    s_lshl_b32 s56, s56, 1
    v_or_b32 v12, s56, v12
    v_and_b32 v19, 7, v0
    v_xor_b32 v12, v12, v19
    v_lshrrev_b32 v19, 3, v0
    v_mul_u32_u24 v19, 6912, v19
    v_lshl_add_u32 v19, v12, 4, v19
    s_mul_i32 s57, s3, 55296
    s_lshl_b32 s59, s99, 7
    s_add_u32 s57, s57, s59
    s_add_u32 m0, s100, 0
    s_add_u32 s56, s57, 0
    buffer_load_dwordx4 v19, s[48:51], s56 offen nt lds
    s_add_u32 m0, s100, 8192
    s_add_u32 s56, s57, 442368
    buffer_load_dwordx4 v19, s[48:51], s56 offen nt lds
    s_add_u32 m0, s100, 16384
    s_add_u32 s56, s57, 884736
    buffer_load_dwordx4 v19, s[48:51], s56 offen nt lds
    s_add_u32 m0, s100, 24576
    s_add_u32 s56, s57, 1327104
    buffer_load_dwordx4 v19, s[48:51], s56 offen nt lds
    s_add_u32 m0, s100, 32768
    s_add_u32 s56, s57, 1769472
    buffer_load_dwordx4 v19, s[48:51], s56 offen nt lds
    s_add_u32 m0, s100, 40960
    s_add_u32 s56, s57, 2211840
    buffer_load_dwordx4 v19, s[48:51], s56 offen nt lds
    s_add_u32 m0, s100, 49152
    s_add_u32 s56, s57, 2654208
    buffer_load_dwordx4 v19, s[48:51], s56 offen nt lds
    s_add_u32 m0, s100, 57344
    s_add_u32 s56, s57, 3096576
    buffer_load_dwordx4 v19, s[48:51], s56 offen nt lds
    s_add_u32 m0, s100, 65536
    s_add_u32 s56, s57, 3538944
    buffer_load_dwordx4 v19, s[48:51], s56 offen nt lds
    s_waitcnt lgkmcnt(0)
    s_add_u32 s34, s34, 1
    s_getreg_b32 s1, hwreg(HW_REG_XCC_ID)
    s_lshl_b32 s1, s1, 24
    s_add_u32 s1, s1, s34
    s_lshr_b32 s0, s2, 3
    s_lshl_b32 s63, s64, 8
    s_add_u32 s0, s0, s63
    s_lshl2_add_u32 s0, s0, 0x480000
    v_mov_b32 v30, s1
    s_cmp_eq_u32 s3, 0
    s_cselect_b64 exec, 1, 0
    buffer_store_dword v30, v2, s[36:39], s0 offen sc1
    s_mov_b64 exec, -1
    v_lshrrev_b32 v12, 4, v0
    v_mul_u32_u24 v12, 18432, v12
    v_and_b32 v13, 15, v0
    v_lshl_add_u32 v22, v13, 4, v12
    s_mul_i32 s57, s99, 57
    s_lshr_b32 s57, s57, 9
    s_mul_i32 s58, s57, 9
    s_sub_u32 s58, s99, s58
    s_mul_i32 s59, s57, 73728
    s_lshl_b32 s58, s58, 8
    s_add_u32 s59, s59, s58
    s_mul_i32 s58, s3, 2304
    s_add_u32 s59, s59, s58
    s_add_u32 s59, s59, 0x1000
    s_mov_b32 s58, 0
    s_cmp_eq_u32 s57, 1
    s_cselect_b32 s58, 1.0, s58
    s_cmp_eq_u32 s57, 4
    s_cselect_b32 s58, 1.0, s58
    s_waitcnt vmcnt(10)
    v_lshlrev_b32 v236, 16, v246
    v_and_b32 v237, 0xffff0000, v246
    v_max_f32 v236, 0xc2ae0000, v236
    v_min_f32 v242, 0x43000000, v236
    v_mul_f32 v238, 0xbfb8aa3b, v242
    v_fma_f32 v240, v242, s98, -v238
    v_fmac_f32 v240, 0xb2a57060, v242
    v_exp_f32 v238, v238
    v_mul_f32 v240, 0x3f317218, v240
    v_fmac_f32 v238, v238, v240
    v_add_f32 v238, 1.0, v238
    v_rcp_f32 v240, v238
    s_nop 0
    v_mul_f32 v242, v236, v240
    v_fma_f32 v238, -v242, v238, v236
    v_fma_f32 v236, v238, v240, v242
    v_max_f32 v237, 0xc2ae0000, v237
    v_min_f32 v243, 0x43000000, v237
    v_mul_f32 v239, 0xbfb8aa3b, v243
    v_fma_f32 v241, v243, s98, -v239
    v_fmac_f32 v241, 0xb2a57060, v243
    v_exp_f32 v239, v239
    v_mul_f32 v241, 0x3f317218, v241
    v_fmac_f32 v239, v239, v241
    v_add_f32 v239, 1.0, v239
    v_rcp_f32 v241, v239
    s_nop 0
    v_mul_f32 v243, v237, v241
    v_fma_f32 v239, -v243, v239, v237
    v_fma_f32 v237, v239, v241, v243
    s_branch .Lsk_m0_1
.Lst_m0_1:
    s_branch .Lrt_m0_1
.Lsk_m0_1:
    v_cvt_pk_bf16_f32 v246, v236, v237
    v_lshlrev_b32 v236, 16, v247
    v_and_b32 v237, 0xffff0000, v247
    v_max_f32 v236, 0xc2ae0000, v236
    v_min_f32 v242, 0x43000000, v236
    v_mul_f32 v238, 0xbfb8aa3b, v242
    v_fma_f32 v240, v242, s98, -v238
    v_fmac_f32 v240, 0xb2a57060, v242
    v_exp_f32 v238, v238
    v_mul_f32 v240, 0x3f317218, v240
    v_fmac_f32 v238, v238, v240
    v_add_f32 v238, 1.0, v238
    v_rcp_f32 v240, v238
    s_nop 0
    v_mul_f32 v242, v236, v240
    v_fma_f32 v238, -v242, v238, v236
    v_fma_f32 v236, v238, v240, v242
    v_max_f32 v237, 0xc2ae0000, v237
    v_min_f32 v243, 0x43000000, v237
    v_mul_f32 v239, 0xbfb8aa3b, v243
    v_fma_f32 v241, v243, s98, -v239
    v_fmac_f32 v241, 0xb2a57060, v243
    v_exp_f32 v239, v239
    v_mul_f32 v241, 0x3f317218, v241
    v_fmac_f32 v239, v239, v241
    v_add_f32 v239, 1.0, v239
    v_rcp_f32 v241, v239
    s_nop 0
    v_mul_f32 v243, v237, v241
    v_fma_f32 v239, -v243, v239, v237
    v_fma_f32 v237, v239, v241, v243
    v_cvt_pk_bf16_f32 v247, v236, v237
    v_lshlrev_b32 v236, 16, v248
    v_and_b32 v237, 0xffff0000, v248
    v_max_f32 v236, 0xc2ae0000, v236
    v_min_f32 v242, 0x43000000, v236
    v_mul_f32 v238, 0xbfb8aa3b, v242
    v_fma_f32 v240, v242, s98, -v238
    v_fmac_f32 v240, 0xb2a57060, v242
    v_exp_f32 v238, v238
    v_mul_f32 v240, 0x3f317218, v240
    v_fmac_f32 v238, v238, v240
    v_add_f32 v238, 1.0, v238
    v_rcp_f32 v240, v238
    s_nop 0
    v_mul_f32 v242, v236, v240
    v_fma_f32 v238, -v242, v238, v236
    v_fma_f32 v236, v238, v240, v242
    v_max_f32 v237, 0xc2ae0000, v237
    v_min_f32 v243, 0x43000000, v237
    v_mul_f32 v239, 0xbfb8aa3b, v243
    v_fma_f32 v241, v243, s98, -v239
    v_fmac_f32 v241, 0xb2a57060, v243
    v_exp_f32 v239, v239
    v_mul_f32 v241, 0x3f317218, v241
    v_fmac_f32 v239, v239, v241
    v_add_f32 v239, 1.0, v239
    v_rcp_f32 v241, v239
    s_nop 0
    v_mul_f32 v243, v237, v241
    v_fma_f32 v239, -v243, v239, v237
    v_fma_f32 v237, v239, v241, v243
    v_cvt_pk_bf16_f32 v248, v236, v237
    v_lshlrev_b32 v236, 16, v249
    v_and_b32 v237, 0xffff0000, v249
    v_max_f32 v236, 0xc2ae0000, v236
    v_min_f32 v242, 0x43000000, v236
    v_mul_f32 v238, 0xbfb8aa3b, v242
    v_fma_f32 v240, v242, s98, -v238
    v_fmac_f32 v240, 0xb2a57060, v242
    v_exp_f32 v238, v238
    v_mul_f32 v240, 0x3f317218, v240
    v_fmac_f32 v238, v238, v240
    v_add_f32 v238, 1.0, v238
    v_rcp_f32 v240, v238
    s_nop 0
    v_mul_f32 v242, v236, v240
    v_fma_f32 v238, -v242, v238, v236
    v_fma_f32 v236, v238, v240, v242
    v_max_f32 v237, 0xc2ae0000, v237
    v_min_f32 v243, 0x43000000, v237
    v_mul_f32 v239, 0xbfb8aa3b, v243
    v_fma_f32 v241, v243, s98, -v239
    v_fmac_f32 v241, 0xb2a57060, v243
    v_exp_f32 v239, v239
    v_mul_f32 v241, 0x3f317218, v241
    v_fmac_f32 v239, v239, v241
    v_add_f32 v239, 1.0, v239
    v_rcp_f32 v241, v239
    s_nop 0
    v_mul_f32 v243, v237, v241
    v_fma_f32 v239, -v243, v239, v237
    v_fma_f32 v237, v239, v241, v243
    v_cvt_pk_bf16_f32 v249, v236, v237
    v_lshlrev_b32 v236, 16, v250
    v_and_b32 v237, 0xffff0000, v250
    v_max_f32 v236, 0xc2ae0000, v236
    v_min_f32 v242, 0x43000000, v236
    v_mul_f32 v238, 0xbfb8aa3b, v242
    v_fma_f32 v240, v242, s98, -v238
    v_fmac_f32 v240, 0xb2a57060, v242
    v_exp_f32 v238, v238
    v_mul_f32 v240, 0x3f317218, v240
    v_fmac_f32 v238, v238, v240
    v_add_f32 v238, 1.0, v238
    v_rcp_f32 v240, v238
    s_nop 0
    v_mul_f32 v242, v236, v240
    v_fma_f32 v238, -v242, v238, v236
    v_fma_f32 v236, v238, v240, v242
    v_max_f32 v237, 0xc2ae0000, v237
    v_min_f32 v243, 0x43000000, v237
    v_mul_f32 v239, 0xbfb8aa3b, v243
    v_fma_f32 v241, v243, s98, -v239
    v_fmac_f32 v241, 0xb2a57060, v243
    v_exp_f32 v239, v239
    v_mul_f32 v241, 0x3f317218, v241
    v_fmac_f32 v239, v239, v241
    v_add_f32 v239, 1.0, v239
    v_rcp_f32 v241, v239
    s_nop 0
    v_mul_f32 v243, v237, v241
    v_fma_f32 v239, -v243, v239, v237
    v_fma_f32 v237, v239, v241, v243
    v_cvt_pk_bf16_f32 v250, v236, v237
    ds_write_b64 v17, v[246:247] offset:0
    ds_write_b64 v17, v[248:249] offset:512
    ds_write_b32 v18, v250 offset:0
    s_waitcnt vmcnt(1)
    s_waitcnt lgkmcnt(0)
    s_barrier
    ds_read_b64_tr_b16 v[160:161], v20 offset:0
    ds_read_b64_tr_b16 v[162:163], v20 offset:512
    ds_read_b64_tr_b16 v[164:165], v20 offset:8192
    ds_read_b64_tr_b16 v[166:167], v20 offset:8704
    ds_read_b64_tr_b16 v[168:169], v20 offset:16384
    ds_read_b64_tr_b16 v[170:171], v20 offset:16896
    ds_read_b64_tr_b16 v[172:173], v20 offset:24576
    ds_read_b64_tr_b16 v[174:175], v20 offset:25088
    ds_read_b64_tr_b16 v[176:177], v21 offset:0
    ds_read_b64_tr_b16 v[178:179], v21 offset:512
    ds_read_b64_tr_b16 v[180:181], v21 offset:8192
    ds_read_b64_tr_b16 v[182:183], v21 offset:8704
    ds_read_b64_tr_b16 v[184:185], v21 offset:16384
    ds_read_b64_tr_b16 v[186:187], v21 offset:16896
    ds_read_b64_tr_b16 v[188:189], v21 offset:24576
    ds_read_b64_tr_b16 v[190:191], v21 offset:25088
    ds_read_b64_tr_b16 v[192:193], v21 offset:32768
    ds_read_b64_tr_b16 v[194:195], v21 offset:33280
    ds_read_b128 v[196:199], v16 offset:0
    ds_read_b128 v[200:203], v16 offset:128
    ds_read_b128 v[204:207], v16 offset:256
    ds_read_b128 v[208:211], v16 offset:384
    ds_read_b128 v[212:215], v16 offset:512
    ds_read_b128 v[216:219], v16 offset:640
    ds_read_b128 v[220:223], v16 offset:768
    ds_read_b128 v[224:227], v16 offset:896
    ds_read_b128 v[228:231], v16 offset:1024
    s_waitcnt lgkmcnt(8)
    v_mfma_f32_16x16x32_bf16 v[232:235], v[160:163], v[196:199], 0
    s_waitcnt lgkmcnt(7)
    v_mfma_f32_16x16x32_bf16 v[232:235], v[164:167], v[200:203], v[232:235]
    s_waitcnt lgkmcnt(6)
    v_mfma_f32_16x16x32_bf16 v[232:235], v[168:171], v[204:207], v[232:235]
    s_branch .Lsk_m0_2
.Lst_m0_2:
    s_branch .Lrt_m0_2
.Lsk_m0_2:
    s_waitcnt lgkmcnt(5)
    v_mfma_f32_16x16x32_bf16 v[232:235], v[172:175], v[208:211], v[232:235]
    s_waitcnt lgkmcnt(4)
    v_mfma_f32_16x16x32_bf16 v[232:235], v[176:179], v[212:215], v[232:235]
    s_waitcnt lgkmcnt(3)
    v_mfma_f32_16x16x32_bf16 v[232:235], v[180:183], v[216:219], v[232:235]
    s_waitcnt lgkmcnt(2)
    v_mfma_f32_16x16x32_bf16 v[232:235], v[184:187], v[220:223], v[232:235]
    s_waitcnt lgkmcnt(1)
    v_mfma_f32_16x16x32_bf16 v[232:235], v[188:191], v[224:227], v[232:235]
    s_waitcnt lgkmcnt(0)
    v_mfma_f32_16x16x32_bf16 v[232:235], v[192:195], v[228:231], v[232:235]
    s_nop 7
    v_permlane32_swap_b32 v232, v234
    v_permlane32_swap_b32 v233, v235
    v_cndmask_b32 v233, v233, v234, s[96:97]
    v_cndmask_b32 v232, v232, v235, s[96:97]
    s_nop 1
    v_add_f32_dpp v236, v233, v232 quad_perm:[1,0,3,2] row_mask:0xf bank_mask:0xf
    v_cvt_pk_bf16_f32 v236, v236, v236
    v_lshlrev_b32 v236, 16, v236
    v_add_f32 v236, s58, v236
    v_cvt_pk_bf16_f32 v236, v236, v236
    ds_write_b16 v23, v236
    v_mov_b32 v243, s34
    s_waitcnt lgkmcnt(0)
    s_barrier
    ds_read2_b32 v[244:245], v24 offset1:1
    v_mov_b32 v241, s34
    s_waitcnt lgkmcnt(0)
    v_mov_b32 v240, v244
    v_mov_b32 v242, v245
    s_bfm_b64 exec, 32, 0
    buffer_store_dwordx4 v[240:243], v22, s[36:39], s59 offen sc1
    s_mov_b64 exec, -1
    s_add_u32 s63, s69, 32768
    buffer_load_dwordx4 v[96:99], v1, s[40:43], s63 offen nt
    s_add_u32 s63, s69, 40960
    buffer_load_dwordx4 v[100:103], v1, s[40:43], s63 offen nt
    s_add_u32 s63, s69, 49152
    buffer_load_dwordx4 v[128:131], v1, s[40:43], s63 offen nt
    s_add_u32 s63, s69, 57344
    buffer_load_dwordx4 v[132:135], v1, s[40:43], s63 offen nt
    s_waitcnt vmcnt(3)
    s_add_u32 s63, s69, 131072
    buffer_load_dwordx4 v[40:43], v1, s[40:43], s63 offen nt
    s_waitcnt vmcnt(3)
    s_add_u32 s63, s69, 139264
    buffer_load_dwordx4 v[44:47], v1, s[40:43], s63 offen nt
    s_waitcnt vmcnt(3)
    s_add_u32 s63, s69, 147456
    buffer_load_dwordx4 v[72:75], v1, s[40:43], s63 offen nt
    s_waitcnt vmcnt(3)
    s_add_u32 s63, s69, 155648
    buffer_load_dwordx4 v[76:79], v1, s[40:43], s63 offen nt
    s_waitcnt vmcnt(3)
    s_add_u32 s63, s69, 163840
    buffer_load_dwordx4 v[104:107], v1, s[40:43], s63 offen nt
    s_waitcnt vmcnt(3)
    s_add_u32 s63, s69, 172032
    buffer_load_dwordx4 v[108:111], v1, s[40:43], s63 offen nt
    s_waitcnt vmcnt(3)
    s_add_u32 s63, s69, 180224
    buffer_load_dwordx4 v[136:139], v1, s[40:43], s63 offen nt
    s_waitcnt vmcnt(3)
    s_add_u32 s63, s69, 188416
    buffer_load_dwordx4 v[140:143], v1, s[40:43], s63 offen nt
    s_waitcnt vmcnt(3)
    s_add_u32 s63, s69, 262144
    buffer_load_dwordx4 v[48:51], v1, s[40:43], s63 offen nt
    s_waitcnt vmcnt(3)
    s_add_u32 s63, s69, 270336
    buffer_load_dwordx4 v[52:55], v1, s[40:43], s63 offen nt
    s_branch .Le_done
.Lm_rel:
    s_waitcnt vmcnt(4)
    s_bitcmp1_b64 s[14:15], 4
    s_cbranch_scc0 1
    s_waitcnt vmcnt(3)
    s_add_u32 s63, s69, 32768
    buffer_load_dwordx4 v[96:99], v1, s[40:43], s63 offen nt
    s_waitcnt vmcnt(4)
    s_bitcmp1_b64 s[14:15], 5
    s_cbranch_scc0 1
    s_waitcnt vmcnt(3)
    s_add_u32 s63, s69, 40960
    buffer_load_dwordx4 v[100:103], v1, s[40:43], s63 offen nt
    s_waitcnt vmcnt(4)
    s_bitcmp1_b64 s[14:15], 6
    s_cbranch_scc0 1
    s_waitcnt vmcnt(3)
    s_add_u32 s63, s69, 49152
    buffer_load_dwordx4 v[128:131], v1, s[40:43], s63 offen nt
    s_waitcnt vmcnt(4)
    s_bitcmp1_b64 s[14:15], 7
    s_cbranch_scc0 1
    s_waitcnt vmcnt(2)
    s_add_u32 s63, s69, 57344
    buffer_load_dwordx4 v[132:135], v1, s[40:43], s63 offen nt
    s_waitcnt vmcnt(3)
    s_bitcmp1_b64 s[14:15], 8
    s_cbranch_scc0 1
    s_waitcnt vmcnt(2)
    s_add_u32 s63, s69, 131072
    buffer_load_dwordx4 v[40:43], v1, s[40:43], s63 offen nt
    s_waitcnt vmcnt(3)
    s_bitcmp1_b64 s[14:15], 9
    s_cbranch_scc0 1
    s_waitcnt vmcnt(2)
    s_add_u32 s63, s69, 139264
    buffer_load_dwordx4 v[44:47], v1, s[40:43], s63 offen nt
    s_waitcnt lgkmcnt(0)
    s_add_u32 s34, s34, 1
    s_getreg_b32 s1, hwreg(HW_REG_XCC_ID)
    s_lshl_b32 s1, s1, 24
    s_add_u32 s1, s1, s34
    s_lshr_b32 s0, s2, 3
    s_lshl_b32 s63, s64, 8
    s_add_u32 s0, s0, s63
    s_lshl2_add_u32 s0, s0, 0x480000
    v_mov_b32 v30, s1
    s_cmp_eq_u32 s3, 0
    s_cselect_b64 exec, 1, 0
    buffer_store_dword v30, v2, s[36:39], s0 offen sc1
    s_mov_b64 exec, -1
    s_cmp_lt_u32 s99, 54
    s_cbranch_scc1 .Lmr_part
    s_waitcnt vmcnt(4)
    s_bitcmp1_b64 s[14:15], 10
    s_cbranch_scc0 1
    s_waitcnt vmcnt(3)
    s_add_u32 s63, s69, 147456
    buffer_load_dwordx4 v[72:75], v1, s[40:43], s63 offen nt
    s_waitcnt vmcnt(4)
    s_bitcmp1_b64 s[14:15], 11
    s_cbranch_scc0 1
    s_waitcnt vmcnt(3)
    s_add_u32 s63, s69, 155648
    buffer_load_dwordx4 v[76:79], v1, s[40:43], s63 offen nt
    s_waitcnt vmcnt(4)
    s_bitcmp1_b64 s[14:15], 12
    s_cbranch_scc0 1
    s_waitcnt vmcnt(3)
    s_add_u32 s63, s69, 163840
    buffer_load_dwordx4 v[104:107], v1, s[40:43], s63 offen nt
    s_waitcnt vmcnt(4)
    s_bitcmp1_b64 s[14:15], 13
    s_cbranch_scc0 1
    s_waitcnt vmcnt(2)
    s_add_u32 s63, s69, 172032
    buffer_load_dwordx4 v[108:111], v1, s[40:43], s63 offen nt
    s_waitcnt vmcnt(3)
    s_bitcmp1_b64 s[14:15], 14
    s_cbranch_scc0 1
    s_waitcnt vmcnt(2)
    s_add_u32 s63, s69, 180224
    buffer_load_dwordx4 v[136:139], v1, s[40:43], s63 offen nt
    s_waitcnt vmcnt(3)
    s_bitcmp1_b64 s[14:15], 15
    s_cbranch_scc0 1
    s_waitcnt vmcnt(2)
    s_add_u32 s63, s69, 188416
    buffer_load_dwordx4 v[140:143], v1, s[40:43], s63 offen nt
    s_waitcnt vmcnt(3)
    s_bitcmp1_b64 s[14:15], 16
    s_cbranch_scc0 1
    s_waitcnt vmcnt(2)
    s_add_u32 s63, s69, 262144
    buffer_load_dwordx4 v[48:51], v1, s[40:43], s63 offen nt
    s_waitcnt vmcnt(3)
    s_bitcmp1_b64 s[14:15], 17
    s_cbranch_scc0 1
    s_waitcnt vmcnt(2)
    s_add_u32 s63, s69, 270336
    buffer_load_dwordx4 v[52:55], v1, s[40:43], s63 offen nt
    s_branch .Le_done
.Lmr_part:
    s_mul_i32 s58, s3, 1152
    s_mov_b32 s52, s24
    s_and_b32 s53, s25, 0xffff
    s_mov_b32 s54, 0x2400
    s_mov_b32 s55, 0x00020000
    buffer_load_dwordx2 v[246:247], v3, s[52:55], s58 offen
    buffer_load_dwordx2 v[248:249], v3, s[52:55], s58 offen offset:512
    buffer_load_dword v250, v4, s[52:55], s58 offen
    s_mov_b32 s48, s26
    s_and_b32 s49, s27, 0xffff
    s_mov_b32 s50, 0x3cc000
    s_mov_b32 s51, 0x00020000
    s_branch .Lsk_m0_3
.Lst_m0_3:
    s_branch .Lrt_m0_3
.Lsk_m0_3:
    v_bfe_u32 v12, v0, 4, 1
    s_and_b32 s56, s3, 3
    s_lshl_b32 s56, s56, 1
    v_or_b32 v12, s56, v12
    v_and_b32 v19, 7, v0
    v_xor_b32 v12, v12, v19
    v_lshrrev_b32 v19, 3, v0
    v_mul_u32_u24 v19, 6912, v19
    v_lshl_add_u32 v19, v12, 4, v19
    s_mul_i32 s57, s3, 55296
    s_lshl_b32 s59, s99, 7
    s_add_u32 s57, s57, s59
    s_add_u32 m0, s100, 0
    s_add_u32 s56, s57, 0
    buffer_load_dwordx4 v19, s[48:51], s56 offen nt lds
    s_add_u32 m0, s100, 8192
    s_add_u32 s56, s57, 442368
    buffer_load_dwordx4 v19, s[48:51], s56 offen nt lds
    s_add_u32 m0, s100, 16384
    s_add_u32 s56, s57, 884736
    buffer_load_dwordx4 v19, s[48:51], s56 offen nt lds
    s_add_u32 m0, s100, 24576
    s_add_u32 s56, s57, 1327104
    buffer_load_dwordx4 v19, s[48:51], s56 offen nt lds
    s_add_u32 m0, s100, 32768
    s_add_u32 s56, s57, 1769472
    buffer_load_dwordx4 v19, s[48:51], s56 offen nt lds
    s_add_u32 m0, s100, 40960
    s_add_u32 s56, s57, 2211840
    buffer_load_dwordx4 v19, s[48:51], s56 offen nt lds
    s_add_u32 m0, s100, 49152
    s_add_u32 s56, s57, 2654208
    buffer_load_dwordx4 v19, s[48:51], s56 offen nt lds
    s_add_u32 m0, s100, 57344
    s_add_u32 s56, s57, 3096576
    buffer_load_dwordx4 v19, s[48:51], s56 offen nt lds
    s_add_u32 m0, s100, 65536
    s_add_u32 s56, s57, 3538944
    buffer_load_dwordx4 v19, s[48:51], s56 offen nt lds
    v_lshrrev_b32 v12, 4, v0
    v_mul_u32_u24 v12, 18432, v12
    v_and_b32 v13, 15, v0
    v_lshl_add_u32 v22, v13, 4, v12
    s_mul_i32 s57, s99, 57
    s_lshr_b32 s57, s57, 9
    s_mul_i32 s58, s57, 9
    s_sub_u32 s58, s99, s58
    s_mul_i32 s59, s57, 73728
    s_lshl_b32 s58, s58, 8
    s_add_u32 s59, s59, s58
    s_mul_i32 s58, s3, 2304
    s_add_u32 s59, s59, s58
    s_add_u32 s59, s59, 0x1000
    s_mov_b32 s58, 0
    s_cmp_eq_u32 s57, 1
    s_cselect_b32 s58, 1.0, s58
    s_cmp_eq_u32 s57, 4
    s_cselect_b32 s58, 1.0, s58
    s_waitcnt vmcnt(9)
    v_lshlrev_b32 v236, 16, v246
    v_and_b32 v237, 0xffff0000, v246
    v_max_f32 v236, 0xc2ae0000, v236
    v_min_f32 v242, 0x43000000, v236
    v_mul_f32 v238, 0xbfb8aa3b, v242
    v_fma_f32 v240, v242, s98, -v238
    v_fmac_f32 v240, 0xb2a57060, v242
    v_exp_f32 v238, v238
    v_mul_f32 v240, 0x3f317218, v240
    v_fmac_f32 v238, v238, v240
    v_add_f32 v238, 1.0, v238
    v_rcp_f32 v240, v238
    s_nop 0
    v_mul_f32 v242, v236, v240
    v_fma_f32 v238, -v242, v238, v236
    v_fma_f32 v236, v238, v240, v242
    v_max_f32 v237, 0xc2ae0000, v237
    v_min_f32 v243, 0x43000000, v237
    v_mul_f32 v239, 0xbfb8aa3b, v243
    v_fma_f32 v241, v243, s98, -v239
    v_fmac_f32 v241, 0xb2a57060, v243
    v_exp_f32 v239, v239
    v_mul_f32 v241, 0x3f317218, v241
    v_fmac_f32 v239, v239, v241
    v_add_f32 v239, 1.0, v239
    v_rcp_f32 v241, v239
    s_nop 0
    v_mul_f32 v243, v237, v241
    v_fma_f32 v239, -v243, v239, v237
    v_fma_f32 v237, v239, v241, v243
    v_cvt_pk_bf16_f32 v246, v236, v237
    v_lshlrev_b32 v236, 16, v247
    v_and_b32 v237, 0xffff0000, v247
    v_max_f32 v236, 0xc2ae0000, v236
    v_min_f32 v242, 0x43000000, v236
    v_mul_f32 v238, 0xbfb8aa3b, v242
    v_fma_f32 v240, v242, s98, -v238
    v_fmac_f32 v240, 0xb2a57060, v242
    v_exp_f32 v238, v238
    v_mul_f32 v240, 0x3f317218, v240
    v_fmac_f32 v238, v238, v240
    v_add_f32 v238, 1.0, v238
    v_rcp_f32 v240, v238
    s_nop 0
    v_mul_f32 v242, v236, v240
    v_fma_f32 v238, -v242, v238, v236
    v_fma_f32 v236, v238, v240, v242
    v_max_f32 v237, 0xc2ae0000, v237
    v_min_f32 v243, 0x43000000, v237
    v_mul_f32 v239, 0xbfb8aa3b, v243
    v_fma_f32 v241, v243, s98, -v239
    v_fmac_f32 v241, 0xb2a57060, v243
    v_exp_f32 v239, v239
    v_mul_f32 v241, 0x3f317218, v241
    v_fmac_f32 v239, v239, v241
    v_add_f32 v239, 1.0, v239
    v_rcp_f32 v241, v239
    s_nop 0
    v_mul_f32 v243, v237, v241
    v_fma_f32 v239, -v243, v239, v237
    v_fma_f32 v237, v239, v241, v243
    v_cvt_pk_bf16_f32 v247, v236, v237
    v_lshlrev_b32 v236, 16, v248
    v_and_b32 v237, 0xffff0000, v248
    v_max_f32 v236, 0xc2ae0000, v236
    v_min_f32 v242, 0x43000000, v236
    v_mul_f32 v238, 0xbfb8aa3b, v242
    v_fma_f32 v240, v242, s98, -v238
    v_fmac_f32 v240, 0xb2a57060, v242
    v_exp_f32 v238, v238
    v_mul_f32 v240, 0x3f317218, v240
    v_fmac_f32 v238, v238, v240
    v_add_f32 v238, 1.0, v238
    v_rcp_f32 v240, v238
    s_nop 0
    v_mul_f32 v242, v236, v240
    v_fma_f32 v238, -v242, v238, v236
    v_fma_f32 v236, v238, v240, v242
    v_max_f32 v237, 0xc2ae0000, v237
    v_min_f32 v243, 0x43000000, v237
    v_mul_f32 v239, 0xbfb8aa3b, v243
    v_fma_f32 v241, v243, s98, -v239
    v_fmac_f32 v241, 0xb2a57060, v243
    v_exp_f32 v239, v239
    v_mul_f32 v241, 0x3f317218, v241
    v_fmac_f32 v239, v239, v241
    v_add_f32 v239, 1.0, v239
    v_rcp_f32 v241, v239
    s_nop 0
    v_mul_f32 v243, v237, v241
    v_fma_f32 v239, -v243, v239, v237
    v_fma_f32 v237, v239, v241, v243
    v_cvt_pk_bf16_f32 v248, v236, v237
    v_lshlrev_b32 v236, 16, v249
    v_and_b32 v237, 0xffff0000, v249
    v_max_f32 v236, 0xc2ae0000, v236
    v_min_f32 v242, 0x43000000, v236
    v_mul_f32 v238, 0xbfb8aa3b, v242
    v_fma_f32 v240, v242, s98, -v238
    v_fmac_f32 v240, 0xb2a57060, v242
    v_exp_f32 v238, v238
    v_mul_f32 v240, 0x3f317218, v240
    v_fmac_f32 v238, v238, v240
    v_add_f32 v238, 1.0, v238
    v_rcp_f32 v240, v238
    s_nop 0
    v_mul_f32 v242, v236, v240
    v_fma_f32 v238, -v242, v238, v236
    v_fma_f32 v236, v238, v240, v242
    v_max_f32 v237, 0xc2ae0000, v237
    v_min_f32 v243, 0x43000000, v237
    v_mul_f32 v239, 0xbfb8aa3b, v243
    s_branch .Lsk_m0_4
.Lst_m0_4:
    s_branch .Lrt_m0_4
.Lsk_m0_4:
    v_fma_f32 v241, v243, s98, -v239
    v_fmac_f32 v241, 0xb2a57060, v243
    v_exp_f32 v239, v239
    v_mul_f32 v241, 0x3f317218, v241
    v_fmac_f32 v239, v239, v241
    v_add_f32 v239, 1.0, v239
    v_rcp_f32 v241, v239
    s_nop 0
    v_mul_f32 v243, v237, v241
    v_fma_f32 v239, -v243, v239, v237
    v_fma_f32 v237, v239, v241, v243
    v_cvt_pk_bf16_f32 v249, v236, v237
    v_lshlrev_b32 v236, 16, v250
    v_and_b32 v237, 0xffff0000, v250
    v_max_f32 v236, 0xc2ae0000, v236
    v_min_f32 v242, 0x43000000, v236
    v_mul_f32 v238, 0xbfb8aa3b, v242
    v_fma_f32 v240, v242, s98, -v238
    v_fmac_f32 v240, 0xb2a57060, v242
    v_exp_f32 v238, v238
    v_mul_f32 v240, 0x3f317218, v240
    v_fmac_f32 v238, v238, v240
    v_add_f32 v238, 1.0, v238
    v_rcp_f32 v240, v238
    s_nop 0
    v_mul_f32 v242, v236, v240
    v_fma_f32 v238, -v242, v238, v236
    v_fma_f32 v236, v238, v240, v242
    v_max_f32 v237, 0xc2ae0000, v237
    v_min_f32 v243, 0x43000000, v237
    v_mul_f32 v239, 0xbfb8aa3b, v243
    v_fma_f32 v241, v243, s98, -v239
    v_fmac_f32 v241, 0xb2a57060, v243
    v_exp_f32 v239, v239
    v_mul_f32 v241, 0x3f317218, v241
    v_fmac_f32 v239, v239, v241
    v_add_f32 v239, 1.0, v239
    v_rcp_f32 v241, v239
    s_nop 0
    v_mul_f32 v243, v237, v241
    v_fma_f32 v239, -v243, v239, v237
    v_fma_f32 v237, v239, v241, v243
    v_cvt_pk_bf16_f32 v250, v236, v237
    ds_write_b64 v17, v[246:247] offset:0
    ds_write_b64 v17, v[248:249] offset:512
    ds_write_b32 v18, v250 offset:0
    s_waitcnt vmcnt(3)
    s_add_u32 s63, s69, 147456
    buffer_load_dwordx4 v[72:75], v1, s[40:43], s63 offen nt
    s_waitcnt vmcnt(3)
    s_add_u32 s63, s69, 155648
    buffer_load_dwordx4 v[76:79], v1, s[40:43], s63 offen nt
    s_waitcnt vmcnt(3)
    s_add_u32 s63, s69, 163840
    buffer_load_dwordx4 v[104:107], v1, s[40:43], s63 offen nt
    s_waitcnt vmcnt(3)
    s_add_u32 s63, s69, 172032
    buffer_load_dwordx4 v[108:111], v1, s[40:43], s63 offen nt
    s_waitcnt vmcnt(3)
    s_add_u32 s63, s69, 180224
    buffer_load_dwordx4 v[136:139], v1, s[40:43], s63 offen nt
    s_waitcnt vmcnt(3)
    s_add_u32 s63, s69, 188416
    buffer_load_dwordx4 v[140:143], v1, s[40:43], s63 offen nt
    s_waitcnt vmcnt(3)
    s_add_u32 s63, s69, 262144
    buffer_load_dwordx4 v[48:51], v1, s[40:43], s63 offen nt
    s_waitcnt vmcnt(3)
    s_add_u32 s63, s69, 270336
    buffer_load_dwordx4 v[52:55], v1, s[40:43], s63 offen nt
    s_waitcnt lgkmcnt(0)
    s_barrier
    ds_read_b64_tr_b16 v[160:161], v20 offset:0
    ds_read_b64_tr_b16 v[162:163], v20 offset:512
    ds_read_b64_tr_b16 v[164:165], v20 offset:8192
    ds_read_b64_tr_b16 v[166:167], v20 offset:8704
    ds_read_b64_tr_b16 v[168:169], v20 offset:16384
    ds_read_b64_tr_b16 v[170:171], v20 offset:16896
    ds_read_b64_tr_b16 v[172:173], v20 offset:24576
    ds_read_b64_tr_b16 v[174:175], v20 offset:25088
    ds_read_b64_tr_b16 v[176:177], v21 offset:0
    ds_read_b64_tr_b16 v[178:179], v21 offset:512
    ds_read_b64_tr_b16 v[180:181], v21 offset:8192
    ds_read_b64_tr_b16 v[182:183], v21 offset:8704
    ds_read_b64_tr_b16 v[184:185], v21 offset:16384
    ds_read_b64_tr_b16 v[186:187], v21 offset:16896
    ds_read_b64_tr_b16 v[188:189], v21 offset:24576
    ds_read_b64_tr_b16 v[190:191], v21 offset:25088
    ds_read_b64_tr_b16 v[192:193], v21 offset:32768
    ds_read_b64_tr_b16 v[194:195], v21 offset:33280
    ds_read_b128 v[196:199], v16 offset:0
    ds_read_b128 v[200:203], v16 offset:128
    ds_read_b128 v[204:207], v16 offset:256
    ds_read_b128 v[208:211], v16 offset:384
    ds_read_b128 v[212:215], v16 offset:512
    ds_read_b128 v[216:219], v16 offset:640
    ds_read_b128 v[220:223], v16 offset:768
    ds_read_b128 v[224:227], v16 offset:896
    ds_read_b128 v[228:231], v16 offset:1024
    s_waitcnt lgkmcnt(8)
    v_mfma_f32_16x16x32_bf16 v[232:235], v[160:163], v[196:199], 0
    s_waitcnt lgkmcnt(7)
    v_mfma_f32_16x16x32_bf16 v[232:235], v[164:167], v[200:203], v[232:235]
    s_waitcnt lgkmcnt(6)
    v_mfma_f32_16x16x32_bf16 v[232:235], v[168:171], v[204:207], v[232:235]
    s_waitcnt lgkmcnt(5)
    v_mfma_f32_16x16x32_bf16 v[232:235], v[172:175], v[208:211], v[232:235]
    s_waitcnt lgkmcnt(4)
    v_mfma_f32_16x16x32_bf16 v[232:235], v[176:179], v[212:215], v[232:235]
    s_waitcnt lgkmcnt(3)
    v_mfma_f32_16x16x32_bf16 v[232:235], v[180:183], v[216:219], v[232:235]
    s_waitcnt lgkmcnt(2)
    v_mfma_f32_16x16x32_bf16 v[232:235], v[184:187], v[220:223], v[232:235]
    s_waitcnt lgkmcnt(1)
    v_mfma_f32_16x16x32_bf16 v[232:235], v[188:191], v[224:227], v[232:235]
    s_waitcnt lgkmcnt(0)
    v_mfma_f32_16x16x32_bf16 v[232:235], v[192:195], v[228:231], v[232:235]
    s_nop 7
    v_permlane32_swap_b32 v232, v234
    v_permlane32_swap_b32 v233, v235
    v_cndmask_b32 v233, v233, v234, s[96:97]
    v_cndmask_b32 v232, v232, v235, s[96:97]
    s_nop 1
    v_add_f32_dpp v236, v233, v232 quad_perm:[1,0,3,2] row_mask:0xf bank_mask:0xf
    v_cvt_pk_bf16_f32 v236, v236, v236
    v_lshlrev_b32 v236, 16, v236
    v_add_f32 v236, s58, v236
    v_cvt_pk_bf16_f32 v236, v236, v236
    ds_write_b16 v23, v236
    v_mov_b32 v243, s34
    s_waitcnt lgkmcnt(0)
    s_barrier
    ds_read2_b32 v[244:245], v24 offset1:1
    v_mov_b32 v241, s34
    s_waitcnt lgkmcnt(0)
    v_mov_b32 v240, v244
    v_mov_b32 v242, v245
    s_bfm_b64 exec, 16, 0
    buffer_store_dwordx4 v[240:243], v22, s[36:39], s59 offen sc1
    s_mov_b64 exec, -1
.Le_done:
    v_and_b32 v8, 1, v0
    v_lshlrev_b32 v8, 8, v8
    v_and_b32 v9, 0x3c, v0
    v_lshl_add_u32 v9, v9, 2, v8
    v_add_u32 v7, v9, v8
    v_and_b32 v9, 0x3c, v0
    v_lshrrev_b32 v8, 4, v8
    v_and_b32 v9, 4, v0
    v_lshl_add_u32 v9, v9, 3, v8
    s_lshl_b32 s58, s66, 14
    s_lshl_b32 s59, s67, 10
    s_add_u32 s58, s58, s59
    s_add_u32 s58, s58, 0x70000
    s_lshl4_add_u32 s59, s66, s67
    s_lshl_b32 s59, s59, 7
    s_add_u32 s59, s59, 0x430000
    s_waitcnt vmcnt(3)
    s_bitcmp1_b64 s[14:15], 18
    s_cbranch_scc0 1
    s_waitcnt vmcnt(2)
    s_add_u32 s63, s69, 278528
    buffer_load_dwordx4 v[80:83], v1, s[40:43], s63 offen nt
    v_and_b32 v157, 7, v0
    v_lshlrev_b32 v157, 2, v157
    s_mov_b32 s63, 0x4a1000
    buffer_load_dword v156, v157, s[36:39], s63 offen
    s_cmp_eq_u32 s3, 0
    s_cbranch_scc1 .Lst_m1_0
    s_cmp_eq_u32 s3, 1
    s_cbranch_scc1 .Lst_m1_1
    s_cmp_eq_u32 s3, 2
    s_cbranch_scc1 .Lst_m1_2
    s_cmp_eq_u32 s3, 3
    s_cbranch_scc1 .Lst_m1_3
    s_cmp_eq_u32 s3, 4
    s_cbranch_scc1 .Lst_m1_4
    s_cmp_eq_u32 s3, 5
    s_cbranch_scc1 .Lst_m1_5
    s_cmp_eq_u32 s3, 6
    s_cbranch_scc1 .Lst_m1_6
    s_cmp_eq_u32 s3, 7
    s_cbranch_scc1 .Lst_m1_7
.Lrt_m1_0:
.Lrt_m1_1:
.Lrt_m1_2:
.Lrt_m1_3:
.Lrt_m1_4:
.Lrt_m1_5:
.Lrt_m1_6:
.Lrt_m1_7:
    s_memrealtime s[8:9]
    s_waitcnt lgkmcnt(0)
    s_sub_u32 s8, s8, s30
    s_cmpk_ge_u32 s8, 912
    s_cbranch_scc1 .ap_55
    s_waitcnt vmcnt(5)
    s_cmpk_ge_u32 s8, 812
    s_cbranch_scc1 .ap_55
    s_waitcnt vmcnt(4)
    s_bitcmp1_b64 s[14:15], 19
    s_cbranch_scc0 1
    s_waitcnt vmcnt(3)
    s_cmpk_ge_u32 s8, 692
    s_cbranch_scc1 .ap_55
    s_waitcnt vmcnt(2)
.ap_55:
    s_add_u32 s63, s69, 286720
    buffer_load_dwordx4 v[84:87], v1, s[40:43], s63 offen nt
    s_memrealtime s[8:9]
    s_waitcnt lgkmcnt(0)
    s_sub_u32 s8, s8, s30
    s_cmpk_ge_u32 s8, 957
    s_cbranch_scc1 .ap_56
    s_waitcnt vmcnt(6)
    s_cmpk_ge_u32 s8, 857
    s_cbranch_scc1 .ap_56
    s_waitcnt vmcnt(4)
    s_bitcmp1_b64 s[14:15], 20
    s_cbranch_scc0 1
    s_waitcnt vmcnt(3)
    s_cmpk_ge_u32 s8, 737
    s_cbranch_scc1 .ap_56
    s_waitcnt vmcnt(2)
.ap_56:
    s_add_u32 s63, s69, 294912
    buffer_load_dwordx4 v[112:115], v1, s[40:43], s63 offen nt
    s_memrealtime s[8:9]
    s_waitcnt lgkmcnt(0)
    s_sub_u32 s8, s8, s30
    s_cmpk_ge_u32 s8, 1002
    s_cbranch_scc1 .ap_57
    s_waitcnt vmcnt(6)
    s_cmpk_ge_u32 s8, 902
    s_cbranch_scc1 .ap_57
    s_waitcnt vmcnt(4)
    s_bitcmp1_b64 s[14:15], 21
    s_cbranch_scc0 1
    s_waitcnt vmcnt(3)
    s_cmpk_ge_u32 s8, 782
    s_cbranch_scc1 .ap_57
    s_waitcnt vmcnt(1)
.ap_57:
    s_add_u32 s63, s69, 303104
    buffer_load_dwordx4 v[116:119], v1, s[40:43], s63 offen nt
    s_memrealtime s[8:9]
    s_waitcnt lgkmcnt(0)
    s_sub_u32 s8, s8, s30
    s_cmpk_ge_u32 s8, 1048
    s_cbranch_scc1 .ap_58
    s_waitcnt vmcnt(6)
    s_cmpk_ge_u32 s8, 948
    s_cbranch_scc1 .ap_58
    s_waitcnt vmcnt(4)
    s_bitcmp1_b64 s[14:15], 22
    s_cbranch_scc0 1
    s_waitcnt vmcnt(2)
    s_cmpk_ge_u32 s8, 828
    s_cbranch_scc1 .ap_58
    s_waitcnt vmcnt(1)
.ap_58:
    s_add_u32 s63, s69, 311296
    buffer_load_dwordx4 v[144:147], v1, s[40:43], s63 offen nt
    s_waitcnt vmcnt(4)
    s_sub_u32 s63, s70, 300
    v_subrev_u32 v156, s63, v156
    v_mov_b32 v157, 600
    v_cmp_lt_u32 s[8:9], v156, v157
    v_add_u32_dpp v156, v156, v156 quad_perm:[1,0,3,2] row_mask:0xf bank_mask:0xf
    s_nop 1
    v_add_u32_dpp v156, v156, v156 quad_perm:[2,3,0,1] row_mask:0xf bank_mask:0xf
    s_nop 1
    v_add_u32_dpp v156, v156, v156 row_ror:4 row_mask:0xf bank_mask:0xf
    s_nop 0
    v_readfirstlane_b32 s63, v156
    s_cmp_eq_u64 s[8:9], -1
    s_nop 3
    s_cbranch_scc0 .et_59
    s_lshr_b32 s63, s63, 3
    s_sub_u32 s63, s63, 300
    s_add_u32 s30, s30, s63
    s_add_u32 s31, s31, s63
.et_59:
    s_memrealtime s[8:9]
    s_waitcnt lgkmcnt(0)
    s_sub_u32 s8, s8, s30
    s_cmpk_ge_u32 s8, 1093
    s_cbranch_scc1 .ap_60
    s_waitcnt vmcnt(4)
    s_cmpk_ge_u32 s8, 993
    s_cbranch_scc1 .ap_60
    s_waitcnt vmcnt(3)
    s_bitcmp1_b64 s[14:15], 23
    s_cbranch_scc0 1
    s_waitcnt vmcnt(2)
    s_cmpk_ge_u32 s8, 873
    s_cbranch_scc1 .ap_60
    s_waitcnt vmcnt(1)
.ap_60:
    s_add_u32 s63, s69, 319488
    buffer_load_dwordx4 v[148:151], v1, s[40:43], s63 offen nt
    s_memrealtime s[8:9]
    s_waitcnt lgkmcnt(0)
    s_sub_u32 s8, s8, s30
    s_cmpk_ge_u32 s8, 1138
    s_cbranch_scc1 .ap_61
    s_waitcnt vmcnt(5)
    s_cmpk_ge_u32 s8, 1038
    s_cbranch_scc1 .ap_61
    s_waitcnt vmcnt(3)
    s_bitcmp1_b64 s[14:15], 24
    s_cbranch_scc0 1
    s_waitcnt vmcnt(2)
    s_cmpk_ge_u32 s8, 918
    s_cbranch_scc1 .ap_61
    s_waitcnt vmcnt(1)
.ap_61:
    s_add_u32 s63, s69, 393216
    buffer_load_dwordx4 v[56:59], v1, s[40:43], s63 offen nt
    s_memrealtime s[8:9]
    s_waitcnt lgkmcnt(0)
    s_sub_u32 s8, s8, s30
    s_cmpk_ge_u32 s8, 1184
    s_cbranch_scc1 .ap_62
    s_waitcnt vmcnt(5)
    s_cmpk_ge_u32 s8, 1084
    s_cbranch_scc1 .ap_62
    s_waitcnt vmcnt(3)
    s_bitcmp1_b64 s[14:15], 25
    s_cbranch_scc0 1
    s_waitcnt vmcnt(2)
    s_cmpk_ge_u32 s8, 964
    s_cbranch_scc1 .ap_62
    s_waitcnt vmcnt(1)
.ap_62:
    s_add_u32 s63, s69, 401408
    buffer_load_dwordx4 v[60:63], v1, s[40:43], s63 offen nt
    s_memrealtime s[8:9]
    s_waitcnt lgkmcnt(0)
    s_sub_u32 s8, s8, s30
    s_cmpk_ge_u32 s8, 1211
    s_cbranch_scc1 .ap_63
    s_waitcnt vmcnt(5)
    s_cmpk_ge_u32 s8, 1111
    s_cbranch_scc1 .ap_63
    s_waitcnt vmcnt(3)
    s_bitcmp1_b64 s[14:15], 26
    s_cbranch_scc0 1
    s_waitcnt vmcnt(2)
    s_cmpk_ge_u32 s8, 991
    s_cbranch_scc1 .ap_63
    s_waitcnt vmcnt(1)
.ap_63:
    s_add_u32 s63, s69, 409600
    buffer_load_dwordx4 v[88:91], v1, s[40:43], s63 offen nt
    s_memrealtime s[8:9]
    s_waitcnt lgkmcnt(0)
    s_sub_u32 s8, s8, s30
    s_cmpk_ge_u32 s8, 1238
    s_cbranch_scc1 .ap_64
    s_waitcnt vmcnt(5)
    s_cmpk_ge_u32 s8, 1138
    s_cbranch_scc1 .ap_64
    s_waitcnt vmcnt(3)
    s_bitcmp1_b64 s[14:15], 27
    s_cbranch_scc0 1
    s_waitcnt vmcnt(2)
    s_cmpk_ge_u32 s8, 1018
    s_cbranch_scc1 .ap_64
    s_branch .Lsk_m1_0
.Lst_m1_0:
    s_branch .Lrt_m1_0
.Lsk_m1_0:
    s_waitcnt vmcnt(1)
.ap_64:
    s_add_u32 s63, s69, 417792
    buffer_load_dwordx4 v[92:95], v1, s[40:43], s63 offen nt
    s_memrealtime s[8:9]
    s_waitcnt vmcnt(8)
    s_waitcnt lgkmcnt(0)
    s_sub_u32 s8, s8, s30
    s_cmpk_ge_u32 s8, 1265
    s_cbranch_scc1 .ap_65
    s_waitcnt vmcnt(5)
    s_cmpk_ge_u32 s8, 1165
    s_cbranch_scc1 .ap_65
    s_waitcnt vmcnt(3)
    s_bitcmp1_b64 s[14:15], 28
    s_cbranch_scc0 1
    s_waitcnt vmcnt(2)
    s_cmpk_ge_u32 s8, 1045
    s_cbranch_scc1 .ap_65
    s_waitcnt vmcnt(1)
.ap_65:
    s_add_u32 s63, s69, 425984
    buffer_load_dwordx4 v[120:123], v1, s[40:43], s63 offen nt
    s_memrealtime s[8:9]
    s_waitcnt vmcnt(8)
    s_waitcnt lgkmcnt(0)
    s_sub_u32 s8, s8, s30
    s_cmpk_ge_u32 s8, 1292
    s_cbranch_scc1 .ap_66
    s_waitcnt vmcnt(5)
    s_cmpk_ge_u32 s8, 1192
    s_cbranch_scc1 .ap_66
    s_waitcnt vmcnt(3)
    s_bitcmp1_b64 s[14:15], 29
    s_cbranch_scc0 1
    s_waitcnt vmcnt(2)
    s_cmpk_ge_u32 s8, 1072
    s_cbranch_scc1 .ap_66
    s_waitcnt vmcnt(1)
.ap_66:
    s_add_u32 s63, s69, 434176
    buffer_load_dwordx4 v[124:127], v1, s[40:43], s63 offen nt
    s_memrealtime s[8:9]
    s_waitcnt vmcnt(8)
    s_waitcnt lgkmcnt(0)
    s_sub_u32 s8, s8, s30
    s_cmpk_ge_u32 s8, 1320
    s_cbranch_scc1 .ap_67
    s_waitcnt vmcnt(5)
    s_cmpk_ge_u32 s8, 1220
    s_cbranch_scc1 .ap_67
    s_waitcnt vmcnt(3)
    s_bitcmp1_b64 s[14:15], 30
    s_cbranch_scc0 1
    s_waitcnt vmcnt(2)
    s_cmpk_ge_u32 s8, 1100
    s_cbranch_scc1 .ap_67
    s_waitcnt vmcnt(1)
.ap_67:
    s_add_u32 s63, s69, 442368
    buffer_load_dwordx4 v[152:155], v1, s[40:43], s63 offen nt
    s_memrealtime s[8:9]
    s_waitcnt vmcnt(8)
    s_waitcnt lgkmcnt(0)
    s_sub_u32 s8, s8, s30
    s_cmpk_ge_u32 s8, 1347
    s_cbranch_scc1 .ap_68
    s_waitcnt vmcnt(5)
    s_cmpk_ge_u32 s8, 1247
    s_cbranch_scc1 .ap_68
    s_waitcnt vmcnt(3)
    s_bitcmp1_b64 s[14:15], 31
    s_cbranch_scc0 1
    s_waitcnt vmcnt(2)
    s_cmpk_ge_u32 s8, 1127
    s_cbranch_scc1 .ap_68
    s_waitcnt vmcnt(1)
.ap_68:
    s_add_u32 s63, s69, 450560
    buffer_load_dwordx4 v[156:159], v1, s[40:43], s63 offen nt
    s_memrealtime s[8:9]
    s_waitcnt vmcnt(8)
    s_waitcnt lgkmcnt(0)
    s_sub_u32 s8, s8, s30
    s_cmpk_ge_u32 s8, 1374
    s_cbranch_scc1 .ap_69
    s_waitcnt vmcnt(5)
    s_cmpk_ge_u32 s8, 1274
    s_cbranch_scc1 .ap_69
    s_waitcnt vmcnt(3)
    s_bitcmp1_b64 s[14:15], 32
    s_cbranch_scc0 1
    s_waitcnt vmcnt(2)
    s_cmpk_ge_u32 s8, 1154
    s_cbranch_scc1 .ap_69
    s_waitcnt vmcnt(1)
.ap_69:
    v_bfe_u32 v1, v0, 4, 2
    v_and_b32 v10, 0xf0, v2
    v_lshlrev_b32 v1, 2, v1
    v_bfe_u32 v1, s6, v1, 4
    v_lshl_add_u32 v1, v1, 8, v10
    s_add_u32 s63, s69, 0
    buffer_load_dwordx4 v[160:163], v1, s[44:47], s63 offen nt
    s_memrealtime s[8:9]
    s_waitcnt vmcnt(8)
    s_waitcnt lgkmcnt(0)
    s_sub_u32 s8, s8, s30
    s_cmpk_ge_u32 s8, 1401
    s_cbranch_scc1 .ap_70
    s_waitcnt vmcnt(5)
    s_cmpk_ge_u32 s8, 1301
    s_cbranch_scc1 .ap_70
    s_waitcnt vmcnt(3)
    s_bitcmp1_b64 s[14:15], 33
    s_cbranch_scc0 1
    s_waitcnt vmcnt(2)
    s_cmpk_ge_u32 s8, 1181
    s_cbranch_scc1 .ap_70
    s_waitcnt vmcnt(1)
.ap_70:
    s_add_u32 s63, s69, 8192
    buffer_load_dwordx4 v[164:167], v1, s[44:47], s63 offen nt
    s_memrealtime s[8:9]
    s_waitcnt vmcnt(8)
    s_waitcnt lgkmcnt(0)
    s_sub_u32 s8, s8, s30
    s_cmpk_ge_u32 s8, 1428
    s_cbranch_scc1 .ap_71
    s_waitcnt vmcnt(5)
    s_cmpk_ge_u32 s8, 1328
    s_cbranch_scc1 .ap_71
    s_waitcnt vmcnt(3)
    s_bitcmp1_b64 s[14:15], 34
    s_cbranch_scc0 1
    s_waitcnt vmcnt(2)
    s_cmpk_ge_u32 s8, 1208
    s_cbranch_scc1 .ap_71
    s_waitcnt vmcnt(1)
.ap_71:
    s_add_u32 s63, s69, 16384
    buffer_load_dwordx4 v[168:171], v1, s[44:47], s63 offen nt
    s_memrealtime s[8:9]
    s_waitcnt vmcnt(8)
    s_waitcnt lgkmcnt(0)
    s_sub_u32 s8, s8, s30
    s_cmpk_ge_u32 s8, 1456
    s_cbranch_scc1 .ap_72
    s_waitcnt vmcnt(5)
    s_cmpk_ge_u32 s8, 1356
    s_cbranch_scc1 .ap_72
    s_waitcnt vmcnt(3)
    s_bitcmp1_b64 s[14:15], 35
    s_cbranch_scc0 1
    s_waitcnt vmcnt(2)
    s_cmpk_ge_u32 s8, 1236
    s_cbranch_scc1 .ap_72
    s_waitcnt vmcnt(1)
.ap_72:
    s_add_u32 s63, s69, 24576
    buffer_load_dwordx4 v[172:175], v1, s[44:47], s63 offen nt
    buffer_load_dwordx4 v[16:19], v7, s[36:39], s58 offen offset:0 sc1
    buffer_load_dwordx4 v[20:23], v7, s[36:39], s58 offen offset:256 sc1
    s_memrealtime s[8:9]
    s_waitcnt vmcnt(8)
    s_waitcnt lgkmcnt(0)
    s_sub_u32 s8, s8, s30
    s_cmpk_ge_u32 s8, 1486
    s_cbranch_scc1 .ap_73
    s_waitcnt vmcnt(5)
    s_cmpk_ge_u32 s8, 1386
    s_cbranch_scc1 .ap_73
    s_waitcnt vmcnt(3)
    s_bitcmp1_b64 s[14:15], 36
    s_cbranch_scc0 1
    s_waitcnt vmcnt(2)
    s_cmpk_ge_u32 s8, 1266
    s_cbranch_scc1 .ap_73
    s_waitcnt vmcnt(1)
.ap_73:
    s_add_u32 s63, s69, 32768
    buffer_load_dwordx4 v[176:179], v1, s[44:47], s63 offen nt
    s_memrealtime s[8:9]
    s_waitcnt vmcnt(8)
    s_waitcnt lgkmcnt(0)
    s_sub_u32 s8, s8, s30
    s_cmpk_ge_u32 s8, 1516
    s_cbranch_scc1 .ap_74
    s_waitcnt vmcnt(5)
    s_cmpk_ge_u32 s8, 1416
    s_cbranch_scc1 .ap_74
    s_waitcnt vmcnt(3)
    s_bitcmp1_b64 s[14:15], 37
    s_cbranch_scc0 1
    s_waitcnt vmcnt(2)
    s_cmpk_ge_u32 s8, 1296
    s_cbranch_scc1 .ap_74
    s_waitcnt vmcnt(1)
.ap_74:
    s_add_u32 s63, s69, 40960
    buffer_load_dwordx4 v[180:183], v1, s[44:47], s63 offen nt
    s_memrealtime s[8:9]
    s_waitcnt vmcnt(8)
    s_waitcnt lgkmcnt(0)
    s_sub_u32 s8, s8, s30
    s_cmpk_ge_u32 s8, 1546
    s_cbranch_scc1 .ap_75
    s_waitcnt vmcnt(5)
    s_cmpk_ge_u32 s8, 1446
    s_cbranch_scc1 .ap_75
    s_waitcnt vmcnt(3)
    s_bitcmp1_b64 s[14:15], 38
    s_cbranch_scc0 1
    s_waitcnt vmcnt(2)
    s_cmpk_ge_u32 s8, 1326
    s_cbranch_scc1 .ap_75
    s_waitcnt vmcnt(1)
.ap_75:
    s_add_u32 s63, s69, 49152
    buffer_load_dwordx4 v[184:187], v1, s[44:47], s63 offen nt
    s_waitcnt vmcnt(3)
    s_branch .gpc_77
.gp_76:
    buffer_load_dwordx4 v[16:19], v7, s[36:39], s58 offen offset:0 sc1
    buffer_load_dwordx4 v[20:23], v7, s[36:39], s58 offen offset:256 sc1
    s_waitcnt vmcnt(0)
.gpc_77:
    v_min_u32 v10, v17, v19
    v_max_u32 v11, v17, v19
    v_min3_u32 v10, v10, v21, v23
    v_max3_u32 v11, v11, v21, v23
    v_cmp_eq_u32 vcc, s34, v10
    v_cmp_eq_u32 s[56:57], s34, v11
    s_and_b64 vcc, vcc, s[56:57]
    s_cmp_eq_u64 vcc, -1
    s_nop 2
    s_cbranch_scc1 .gpd_78
    s_sub_u32 s35, s35, 1
    s_branch .Lsk_m1_1
.Lst_m1_1:
    s_branch .Lrt_m1_1
.Lsk_m1_1:
    s_cbranch_scc1 .Lexit
    s_sleep 1
    s_branch .gp_76
.gpd_78:
    s_mov_b32 vcc_lo, 0xcccccccc
    s_mov_b32 vcc_hi, 0xcccccccc
    v_cndmask_b32_e64 v24, v16, 0, vcc
    v_cndmask_b32_e64 v25, v18, 0, vcc
    v_cndmask_b32_e64 v26, v20, 0, vcc
    v_cndmask_b32_e64 v27, v22, 0, vcc
    v_cndmask_b32_e32 v28, 0, v16, vcc
    v_cndmask_b32_e32 v29, 0, v18, vcc
    v_cndmask_b32_e32 v30, 0, v20, vcc
    v_cndmask_b32_e32 v31, 0, v22, vcc
    v_mfma_f32_16x16x32_bf16 v[16:19], v[32:35], v[24:27], 0
    v_mfma_f32_16x16x32_bf16 v[32:35], v[40:43], v[24:27], 0
    v_mfma_f32_16x16x32_bf16 v[16:19], v[36:39], v[28:31], v[16:19]
    v_mfma_f32_16x16x32_bf16 v[40:43], v[48:51], v[24:27], 0
    v_mfma_f32_16x16x32_bf16 v[32:35], v[44:47], v[28:31], v[32:35]
    v_mfma_f32_16x16x32_bf16 v[48:51], v[56:59], v[24:27], 0
    v_mfma_f32_16x16x32_bf16 v[40:43], v[52:55], v[28:31], v[40:43]
    v_mfma_f32_16x16x32_bf16 v[56:59], v[64:67], v[24:27], 0
    v_mfma_f32_16x16x32_bf16 v[48:51], v[60:63], v[28:31], v[48:51]
    s_nop 1
    v_add_f32_dpp v10, v17, v16 row_ror:12 row_mask:0xf bank_mask:0x1
    s_memrealtime s[8:9]
    s_waitcnt lgkmcnt(0)
    s_sub_u32 s8, s8, s30
    s_cmpk_ge_u32 s8, 1576
    s_nop 0
    s_cbranch_scc1 .ap_79
    s_waitcnt vmcnt(3)
    s_cmpk_ge_u32 s8, 1476
    s_cbranch_scc1 .ap_79
    s_waitcnt vmcnt(3)
    s_bitcmp1_b64 s[14:15], 39
    s_cbranch_scc0 1
    s_waitcnt vmcnt(2)
    s_cmpk_ge_u32 s8, 1356
    s_cbranch_scc1 .ap_79
    s_waitcnt vmcnt(1)
.ap_79:
    s_add_u32 s63, s69, 57344
    buffer_load_dwordx4 v[188:191], v1, s[44:47], s63 offen nt
    v_mfma_f32_16x16x32_bf16 v[64:67], v[72:75], v[24:27], 0
    v_mfma_f32_16x16x32_bf16 v[56:59], v[68:71], v[28:31], v[56:59]
    v_add_f32_dpp v11, v33, v32 row_ror:12 row_mask:0xf bank_mask:0x1
    v_add_f32_dpp v10, v18, v10 row_ror:8 row_mask:0xf bank_mask:0x1
    v_mfma_f32_16x16x32_bf16 v[72:75], v[80:83], v[24:27], 0
    v_mfma_f32_16x16x32_bf16 v[64:67], v[76:79], v[28:31], v[64:67]
    v_add_f32_dpp v12, v41, v40 row_ror:12 row_mask:0xf bank_mask:0x1
    v_add_f32_dpp v11, v34, v11 row_ror:8 row_mask:0xf bank_mask:0x1
    v_add_f32_dpp v10, v19, v10 row_ror:4 row_mask:0xf bank_mask:0x1
    v_mfma_f32_16x16x32_bf16 v[80:83], v[88:91], v[24:27], 0
    v_mfma_f32_16x16x32_bf16 v[72:75], v[84:87], v[28:31], v[72:75]
    v_add_f32_dpp v13, v49, v48 row_ror:12 row_mask:0xf bank_mask:0x1
    v_add_f32_dpp v12, v42, v12 row_ror:8 row_mask:0xf bank_mask:0x1
    v_add_f32_dpp v11, v35, v11 row_ror:4 row_mask:0xf bank_mask:0x1
    v_mfma_f32_16x16x32_bf16 v[88:91], v[96:99], v[24:27], 0
    v_mfma_f32_16x16x32_bf16 v[80:83], v[92:95], v[28:31], v[80:83]
    v_add_f32_dpp v10, v58, v57 row_ror:12 row_mask:0xf bank_mask:0x2
    v_add_f32_dpp v13, v50, v13 row_ror:8 row_mask:0xf bank_mask:0x1
    v_add_f32_dpp v12, v43, v12 row_ror:4 row_mask:0xf bank_mask:0x1
    s_memrealtime s[8:9]
    s_waitcnt lgkmcnt(0)
    s_sub_u32 s8, s8, s30
    s_cmpk_ge_u32 s8, 1606
    s_nop 0
    s_cbranch_scc1 .ap_80
    s_waitcnt vmcnt(4)
    s_cmpk_ge_u32 s8, 1506
    s_cbranch_scc1 .ap_80
    s_waitcnt vmcnt(3)
    s_bitcmp1_b64 s[14:15], 40
    s_cbranch_scc0 1
    s_waitcnt vmcnt(2)
    s_cmpk_ge_u32 s8, 1386
    s_cbranch_scc1 .ap_80
    s_waitcnt vmcnt(1)
.ap_80:
    s_add_u32 s63, s69, 131072
    buffer_load_dwordx4 v[192:195], v1, s[44:47], s63 offen nt
    v_mfma_f32_16x16x32_bf16 v[96:99], v[104:107], v[24:27], 0
    v_mfma_f32_16x16x32_bf16 v[88:91], v[100:103], v[28:31], v[88:91]
    v_add_f32_dpp v11, v66, v65 row_ror:12 row_mask:0xf bank_mask:0x2
    v_add_f32_dpp v10, v59, v10 row_ror:8 row_mask:0xf bank_mask:0x2
    v_add_f32_dpp v13, v51, v13 row_ror:4 row_mask:0xf bank_mask:0x1
    v_mfma_f32_16x16x32_bf16 v[104:107], v[112:115], v[24:27], 0
    v_mfma_f32_16x16x32_bf16 v[96:99], v[108:111], v[28:31], v[96:99]
    v_add_f32_dpp v12, v74, v73 row_ror:12 row_mask:0xf bank_mask:0x2
    v_add_f32_dpp v11, v67, v11 row_ror:8 row_mask:0xf bank_mask:0x2
    v_add_f32_dpp v10, v56, v10 row_ror:4 row_mask:0xf bank_mask:0x2
    v_mfma_f32_16x16x32_bf16 v[112:115], v[120:123], v[24:27], 0
    v_mfma_f32_16x16x32_bf16 v[104:107], v[116:119], v[28:31], v[104:107]
    v_add_f32_dpp v13, v82, v81 row_ror:12 row_mask:0xf bank_mask:0x2
    v_add_f32_dpp v12, v75, v12 row_ror:8 row_mask:0xf bank_mask:0x2
    v_add_f32_dpp v11, v64, v11 row_ror:4 row_mask:0xf bank_mask:0x2
    v_mfma_f32_16x16x32_bf16 v[120:123], v[128:131], v[24:27], 0
    v_mfma_f32_16x16x32_bf16 v[112:115], v[124:127], v[28:31], v[112:115]
    v_add_f32_dpp v10, v91, v90 row_ror:12 row_mask:0xf bank_mask:0x4
    v_add_f32_dpp v13, v83, v13 row_ror:8 row_mask:0xf bank_mask:0x2
    v_add_f32_dpp v12, v72, v12 row_ror:4 row_mask:0xf bank_mask:0x2
    s_memrealtime s[8:9]
    s_waitcnt lgkmcnt(0)
    s_sub_u32 s8, s8, s30
    s_cmpk_ge_u32 s8, 1636
    s_nop 0
    s_cbranch_scc1 .ap_81
    s_waitcnt vmcnt(5)
    s_cmpk_ge_u32 s8, 1536
    s_cbranch_scc1 .ap_81
    s_waitcnt vmcnt(3)
    s_bitcmp1_b64 s[14:15], 41
    s_cbranch_scc0 1
    s_waitcnt vmcnt(2)
    s_cmpk_ge_u32 s8, 1416
    s_cbranch_scc1 .ap_81
    s_waitcnt vmcnt(1)
.ap_81:
    s_add_u32 s63, s69, 139264
    buffer_load_dwordx4 v[196:199], v1, s[44:47], s63 offen nt
    v_mfma_f32_16x16x32_bf16 v[128:131], v[136:139], v[24:27], 0
    v_mfma_f32_16x16x32_bf16 v[120:123], v[132:135], v[28:31], v[120:123]
    v_add_f32_dpp v11, v99, v98 row_ror:12 row_mask:0xf bank_mask:0x4
    v_add_f32_dpp v10, v88, v10 row_ror:8 row_mask:0xf bank_mask:0x4
    v_add_f32_dpp v13, v80, v13 row_ror:4 row_mask:0xf bank_mask:0x2
    v_mfma_f32_16x16x32_bf16 v[136:139], v[144:147], v[24:27], 0
    v_mfma_f32_16x16x32_bf16 v[128:131], v[140:143], v[28:31], v[128:131]
    v_add_f32_dpp v12, v107, v106 row_ror:12 row_mask:0xf bank_mask:0x4
    v_add_f32_dpp v11, v96, v11 row_ror:8 row_mask:0xf bank_mask:0x4
    v_add_f32_dpp v10, v89, v10 row_ror:4 row_mask:0xf bank_mask:0x4
    v_mfma_f32_16x16x32_bf16 v[144:147], v[152:155], v[24:27], 0
    v_mfma_f32_16x16x32_bf16 v[136:139], v[148:151], v[28:31], v[136:139]
    v_add_f32_dpp v13, v115, v114 row_ror:12 row_mask:0xf bank_mask:0x4
    v_add_f32_dpp v12, v104, v12 row_ror:8 row_mask:0xf bank_mask:0x4
    v_add_f32_dpp v11, v97, v11 row_ror:4 row_mask:0xf bank_mask:0x4
    v_mfma_f32_16x16x32_bf16 v[144:147], v[156:159], v[28:31], v[144:147]
    v_add_f32_dpp v10, v120, v123 row_ror:12 row_mask:0xf bank_mask:0x8
    v_add_f32_dpp v13, v112, v13 row_ror:8 row_mask:0xf bank_mask:0x4
    v_add_f32_dpp v12, v105, v12 row_ror:4 row_mask:0xf bank_mask:0x4
    s_memrealtime s[8:9]
    s_waitcnt lgkmcnt(0)
    s_sub_u32 s8, s8, s30
    s_cmpk_ge_u32 s8, 1666
    s_nop 0
    s_cbranch_scc1 .ap_82
    s_waitcnt vmcnt(5)
    s_cmpk_ge_u32 s8, 1566
    s_cbranch_scc1 .ap_82
    s_waitcnt vmcnt(3)
    s_bitcmp1_b64 s[14:15], 42
    s_cbranch_scc0 1
    s_waitcnt vmcnt(2)
    s_cmpk_ge_u32 s8, 1446
    s_cbranch_scc1 .ap_82
    s_waitcnt vmcnt(1)
.ap_82:
    s_add_u32 s63, s69, 147456
    buffer_load_dwordx4 v[200:203], v1, s[44:47], s63 offen nt
    v_add_f32_dpp v11, v128, v131 row_ror:12 row_mask:0xf bank_mask:0x8
    v_add_f32_dpp v10, v121, v10 row_ror:8 row_mask:0xf bank_mask:0x8
    v_add_f32_dpp v13, v113, v13 row_ror:4 row_mask:0xf bank_mask:0x4
    v_add_f32_dpp v12, v136, v139 row_ror:12 row_mask:0xf bank_mask:0x8
    v_add_f32_dpp v11, v129, v11 row_ror:8 row_mask:0xf bank_mask:0x8
    v_add_f32_dpp v10, v122, v10 row_ror:4 row_mask:0xf bank_mask:0x8
    v_add_f32_dpp v13, v144, v147 row_ror:12 row_mask:0xf bank_mask:0x8
    v_add_f32_dpp v12, v137, v12 row_ror:8 row_mask:0xf bank_mask:0x8
    v_add_f32_dpp v11, v130, v11 row_ror:4 row_mask:0xf bank_mask:0x8
    v_add_f32_dpp v13, v145, v13 row_ror:8 row_mask:0xf bank_mask:0x8
    v_add_f32_dpp v12, v138, v12 row_ror:4 row_mask:0xf bank_mask:0x8
    s_memrealtime s[8:9]
    s_waitcnt lgkmcnt(0)
    s_sub_u32 s8, s8, s30
    s_cmpk_ge_u32 s8, 1696
    s_cbranch_scc1 .ap_83
    s_waitcnt vmcnt(5)
    s_cmpk_ge_u32 s8, 1596
    s_cbranch_scc1 .ap_83
    s_branch .Lsk_m1_2
.Lst_m1_2:
    s_branch .Lrt_m1_2
.Lsk_m1_2:
    s_waitcnt vmcnt(3)
    s_bitcmp1_b64 s[14:15], 43
    s_cbranch_scc0 1
    s_waitcnt vmcnt(2)
    s_cmpk_ge_u32 s8, 1476
    s_cbranch_scc1 .ap_83
    s_waitcnt vmcnt(1)
.ap_83:
    s_add_u32 s63, s69, 155648
    buffer_load_dwordx4 v[204:207], v1, s[44:47], s63 offen nt
    v_add_f32_dpp v13, v146, v13 row_ror:4 row_mask:0xf bank_mask:0x8
    s_mov_b32 s60, 0x3db504f3
    s_mov_b32 s61, 0x3db504f3
    v_cvt_pk_bf16_f32 v10, v10, v11
    v_and_b32 v11, 0xffff0000, v10
    v_lshlrev_b32 v10, 16, v10
    v_cvt_pk_bf16_f32 v12, v12, v13
    v_and_b32 v13, 0xffff0000, v12
    v_lshlrev_b32 v12, 16, v12
    v_pk_mul_f32 v[10:11], v[10:11], s[60:61]
    v_pk_mul_f32 v[12:13], v[12:13], s[60:61]
    v_cvt_pk_bf16_f32 v10, v10, v11
    v_and_b32 v11, 0xffff0000, v10
    v_lshlrev_b32 v10, 16, v10
    v_cvt_pk_bf16_f32 v12, v12, v13
    v_and_b32 v13, 0xffff0000, v12
    v_lshlrev_b32 v12, 16, v12
    v_max_f32 v14, v10, v11
    v_max3_f32 v14, v14, v12, v13
    s_mov_b32 s60, 0x3fb8aa3b
    v_mov_b32 v22, s34
    v_mov_b32 v23, s34
    v_max_f32_dpp v14, v14, v14 quad_perm:[2,3,0,1] row_mask:0xf bank_mask:0xf
    s_nop 1
    v_max_f32_dpp v14, v14, v14 row_ror:4 row_mask:0xf bank_mask:0xf
    s_nop 1
    v_max_f32_dpp v14, v14, v14 row_ror:8 row_mask:0xf bank_mask:0xf
    v_mov_b32 v15, v14
    s_nop 1
    v_permlane16_swap_b32 v15, v14
    v_max_f32 v14, v15, v14
    v_mov_b32 v15, v14
    s_nop 1
    v_permlane32_swap_b32 v15, v14
    v_max_f32 v14, v15, v14
    v_mul_f32 v15, 0xbfb8aa3b, v14
    v_fma_f32 v10, v10, s60, v15
    v_fma_f32 v11, v11, s60, v15
    v_fma_f32 v12, v12, s60, v15
    v_fma_f32 v13, v13, s60, v15
    v_exp_f32 v10, v10
    v_exp_f32 v11, v11
    v_exp_f32 v12, v12
    v_exp_f32 v13, v13
    v_mov_b32 v20, v14
    v_pk_add_f32 v[16:17], v[10:11], v[12:13]
    v_add_f32 v21, v16, v17
    s_lshl_b32 s60, s68, 5
    s_lshl_b32 s61, s3, 4
    s_add_u32 s61, s61, 159104
    v_add_u32 v16, s61, v3
    v_mov_b32 v17, 159232
    v_mov_b32 v18, 1
    s_add_u32 s60, s60, s59
    v_add_f32_dpp v21, v21, v21 quad_perm:[2,3,0,1] row_mask:0xf bank_mask:0xf
    s_nop 1
    v_add_f32_dpp v21, v21, v21 row_ror:4 row_mask:0xf bank_mask:0xf
    s_nop 1
    v_add_f32_dpp v21, v21, v21 row_ror:8 row_mask:0xf bank_mask:0xf
    v_mov_b32 v15, v21
    s_nop 1
    v_permlane16_swap_b32 v15, v21
    v_add_f32 v21, v15, v21
    v_mov_b32 v15, v21
    s_nop 1
    v_permlane32_swap_b32 v15, v21
    v_add_f32 v21, v15, v21
    s_mov_b64 exec, 3
    ds_write_b64 v16, v[20:21]
    s_mov_b64 exec, 1
    ds_add_rtn_u32 v18, v17, v18
    s_mov_b64 exec, -1
    v_and_b32 v16, 0x78, v3
    v_or_b32 v16, 159104, v16
    s_waitcnt lgkmcnt(0)
    v_readfirstlane_b32 s61, v18
    s_cmp_eq_u32 s61, 7
    s_nop 3
    s_cbranch_scc0 .mlc_84
    ds_read_b64 v[18:19], v16
    s_waitcnt lgkmcnt(0)
    v_mov_b32 v20, v18
    s_nop 1
    v_max_f32_dpp v20, v20, v20 quad_perm:[2,3,0,1] row_mask:0xf bank_mask:0xf
    s_nop 1
    v_max_f32_dpp v20, v20, v20 row_ror:4 row_mask:0xf bank_mask:0xf
    s_nop 1
    v_max_f32_dpp v20, v20, v20 row_ror:8 row_mask:0xf bank_mask:0xf
    v_sub_f32 v18, v18, v20
    v_mul_f32 v18, 0x3fb8aa3b, v18
    v_exp_f32 v18, v18
    s_nop 0
    v_mul_f32 v21, v18, v19
    s_nop 1
    v_add_f32_dpp v21, v21, v21 quad_perm:[2,3,0,1] row_mask:0xf bank_mask:0xf
    s_nop 1
    v_add_f32_dpp v21, v21, v21 row_ror:4 row_mask:0xf bank_mask:0xf
    s_nop 1
    v_add_f32_dpp v21, v21, v21 row_ror:8 row_mask:0xf bank_mask:0xf
    s_mov_b64 exec, 3
    buffer_store_dwordx4 v[20:23], v2, s[36:39], s60 offen sc1
    s_mov_b64 exec, -1
.mlc_84:
    s_memrealtime s[8:9]
    s_waitcnt lgkmcnt(0)
    s_sub_u32 s8, s8, s30
    s_cmpk_ge_u32 s8, 1726
    s_cbranch_scc1 .ap_85
    s_waitcnt vmcnt(5)
    s_cmpk_ge_u32 s8, 1626
    s_cbranch_scc1 .ap_85
    s_waitcnt vmcnt(3)
    s_bitcmp1_b64 s[14:15], 44
    s_cbranch_scc0 1
    s_waitcnt vmcnt(2)
    s_cmpk_ge_u32 s8, 1506
    s_cbranch_scc1 .ap_85
    s_waitcnt vmcnt(1)
.ap_85:
    s_add_u32 s63, s69, 163840
    buffer_load_dwordx4 v[208:211], v1, s[44:47], s63 offen nt
    s_cmp_eq_u32 s3, 0
    s_cbranch_scc1 .Lst_m2_0
    s_cmp_eq_u32 s3, 1
    s_cbranch_scc1 .Lst_m2_1
    s_cmp_eq_u32 s3, 2
    s_cbranch_scc1 .Lrt_m2_2
    s_cmp_eq_u32 s3, 3
    s_cbranch_scc1 .Lrt_m2_3
.Lrt_m2_0:
.Lrt_m2_1:
.Lrt_m2_2:
.Lrt_m2_3:
    v_mov_b32 v16, 0
    v_bfe_u32 v17, v0, 3, 1
    v_lshl_add_u32 v16, v17, 5, v16
    v_bfe_u32 v17, v0, 5, 1
    v_lshl_add_u32 v16, v17, 4, v16
    v_bfe_u32 v17, v0, 0, 3
    v_lshl_add_u32 v16, v17, 1, v16
    v_bfe_u32 v17, v0, 4, 1
    v_lshl_add_u32 v16, v17, 0, v16
    v_lshlrev_b32 v7, 1, v16
    v_and_b32 v8, 62, v16
    v_lshlrev_b32 v8, 2, v8
    s_mul_i32 s100, s3, 1152
    s_lshl_b32 s56, s65, 7
    s_add_u32 s100, s100, s56
    s_mov_b32 s52, s4
    s_and_b32 s53, s5, 0xffff
    s_mov_b32 s54, 0x2400
    s_mov_b32 s55, 0x00020000
    buffer_load_ushort v40, v7, s[52:55], s100 offen
    s_lshr_b32 s56, s64, 1
    s_and_b32 s57, s3, 3
    s_cmp_lg_u32 s56, s57
    s_cselect_b64 exec, 0, -1
    s_mov_b32 s48, s16
    s_and_b32 s49, s17, 0xffff
    s_mov_b32 s50, 0x480
    s_mov_b32 s51, 0x00020000
    buffer_load_dwordx2 v[48:49], v3, s[48:51], 0 offen
    buffer_load_dwordx2 v[50:51], v3, s[48:51], 0 offen offset:512
    buffer_load_dword v34, v4, s[48:51], 0 offen
    s_mov_b32 s48, s28
    s_and_b32 s49, s29, 0xffff
    s_mov_b32 s50, 0x2400
    s_mov_b32 s51, 0x00020000
    buffer_load_ushort v39, v7, s[48:51], s100 offen nt
    s_mov_b64 exec, -1
    s_memrealtime s[8:9]
    s_waitcnt vmcnt(13)
    s_waitcnt lgkmcnt(0)
    s_sub_u32 s8, s8, s30
    s_cmpk_ge_u32 s8, 1756
    s_cbranch_scc1 .ap_86
    s_waitcnt vmcnt(10)
    s_cmpk_ge_u32 s8, 1656
    s_cbranch_scc1 .ap_86
    s_waitcnt vmcnt(8)
    s_bitcmp1_b64 s[14:15], 45
    s_cbranch_scc0 1
    s_waitcnt vmcnt(7)
    s_cmpk_ge_u32 s8, 1536
    s_cbranch_scc1 .ap_86
    s_waitcnt vmcnt(6)
.ap_86:
    s_add_u32 s63, s69, 172032
    buffer_load_dwordx4 v[212:215], v1, s[44:47], s63 offen nt
    s_memrealtime s[8:9]
    s_waitcnt vmcnt(13)
    s_waitcnt lgkmcnt(0)
    s_sub_u32 s8, s8, s30
    s_cmpk_ge_u32 s8, 1788
    s_cbranch_scc1 .ap_87
    s_branch .Lsk_m1_3
.Lst_m1_3:
    s_branch .Lrt_m1_3
.Lsk_m1_3:
    s_waitcnt vmcnt(10)
    s_cmpk_ge_u32 s8, 1688
    s_cbranch_scc1 .ap_87
    s_waitcnt vmcnt(8)
    s_bitcmp1_b64 s[14:15], 46
    s_cbranch_scc0 1
    s_waitcnt vmcnt(7)
    s_cmpk_ge_u32 s8, 1568
    s_cbranch_scc1 .ap_87
    s_waitcnt vmcnt(6)
.ap_87:
    s_add_u32 s63, s69, 180224
    buffer_load_dwordx4 v[216:219], v1, s[44:47], s63 offen nt
    s_memrealtime s[8:9]
    s_waitcnt vmcnt(13)
    s_waitcnt lgkmcnt(0)
    s_sub_u32 s8, s8, s30
    s_cmpk_ge_u32 s8, 1820
    s_cbranch_scc1 .ap_88
    s_waitcnt vmcnt(10)
    s_cmpk_ge_u32 s8, 1720
    s_cbranch_scc1 .ap_88
    s_waitcnt vmcnt(8)
    s_bitcmp1_b64 s[14:15], 47
    s_cbranch_scc0 1
    s_waitcnt vmcnt(7)
    s_cmpk_ge_u32 s8, 1600
    s_cbranch_scc1 .ap_88
    s_waitcnt vmcnt(1)
.ap_88:
    s_add_u32 s63, s69, 188416
    buffer_load_dwordx4 v[220:223], v1, s[44:47], s63 offen nt
    s_memrealtime s[8:9]
    s_waitcnt vmcnt(13)
    s_waitcnt lgkmcnt(0)
    s_sub_u32 s8, s8, s30
    s_cmpk_ge_u32 s8, 1852
    s_cbranch_scc1 .ap_89
    s_waitcnt vmcnt(10)
    s_cmpk_ge_u32 s8, 1752
    s_cbranch_scc1 .ap_89
    s_waitcnt vmcnt(8)
    s_bitcmp1_b64 s[14:15], 48
    s_cbranch_scc0 1
    s_waitcnt vmcnt(2)
    s_cmpk_ge_u32 s8, 1632
    s_cbranch_scc1 .ap_89
    s_waitcnt vmcnt(1)
.ap_89:
    s_add_u32 s63, s69, 262144
    buffer_load_dwordx4 v[224:227], v1, s[44:47], s63 offen nt
    s_memrealtime s[8:9]
    s_waitcnt vmcnt(13)
    s_waitcnt lgkmcnt(0)
    s_sub_u32 s8, s8, s30
    s_cmpk_ge_u32 s8, 1884
    s_cbranch_scc1 .ap_90
    s_waitcnt vmcnt(10)
    s_cmpk_ge_u32 s8, 1784
    s_cbranch_scc1 .ap_90
    s_waitcnt vmcnt(3)
    s_bitcmp1_b64 s[14:15], 49
    s_cbranch_scc0 1
    s_waitcnt vmcnt(2)
    s_cmpk_ge_u32 s8, 1664
    s_cbranch_scc1 .ap_90
    s_waitcnt vmcnt(1)
.ap_90:
    s_add_u32 s63, s69, 270336
    buffer_load_dwordx4 v[228:231], v1, s[44:47], s63 offen nt
    s_memrealtime s[8:9]
    s_waitcnt vmcnt(13)
    s_waitcnt lgkmcnt(0)
    s_sub_u32 s8, s8, s30
    s_cmpk_ge_u32 s8, 1916
    s_cbranch_scc1 .ap_91
    s_waitcnt vmcnt(10)
    s_cmpk_ge_u32 s8, 1816
    s_cbranch_scc1 .ap_91
    s_waitcnt vmcnt(3)
    s_bitcmp1_b64 s[14:15], 50
    s_cbranch_scc0 1
    s_waitcnt vmcnt(2)
    s_cmpk_ge_u32 s8, 1696
    s_cbranch_scc1 .ap_91
    s_waitcnt vmcnt(1)
.ap_91:
    s_add_u32 s63, s69, 278528
    buffer_load_dwordx4 v[232:235], v1, s[44:47], s63 offen nt
    s_memrealtime s[8:9]
    s_waitcnt vmcnt(13)
    s_waitcnt lgkmcnt(0)
    s_sub_u32 s8, s8, s30
    s_cmpk_ge_u32 s8, 1948
    s_cbranch_scc1 .ap_92
    s_waitcnt vmcnt(5)
    s_cmpk_ge_u32 s8, 1848
    s_cbranch_scc1 .ap_92
    s_waitcnt vmcnt(3)
    s_bitcmp1_b64 s[14:15], 51
    s_cbranch_scc0 1
    s_waitcnt vmcnt(2)
    s_cmpk_ge_u32 s8, 1728
    s_cbranch_scc1 .ap_92
    s_waitcnt vmcnt(1)
.ap_92:
    s_add_u32 s63, s69, 286720
    buffer_load_dwordx4 v[236:239], v1, s[44:47], s63 offen nt
    s_memrealtime s[8:9]
    s_waitcnt vmcnt(13)
    s_waitcnt lgkmcnt(0)
    s_sub_u32 s8, s8, s30
    s_cmpk_ge_u32 s8, 1980
    s_cbranch_scc1 .ap_93
    s_waitcnt vmcnt(5)
    s_cmpk_ge_u32 s8, 1880
    s_cbranch_scc1 .ap_93
    s_waitcnt vmcnt(3)
    s_bitcmp1_b64 s[14:15], 52
    s_cbranch_scc0 1
    s_waitcnt vmcnt(2)
    s_cmpk_ge_u32 s8, 1760
    s_cbranch_scc1 .ap_93
    s_waitcnt vmcnt(1)
.ap_93:
    s_add_u32 s63, s69, 294912
    buffer_load_dwordx4 v[240:243], v1, s[44:47], s63 offen nt
    s_memrealtime s[8:9]
    s_waitcnt vmcnt(13)
    s_waitcnt lgkmcnt(0)
    s_sub_u32 s8, s8, s30
    s_cmpk_ge_u32 s8, 2012
    s_cbranch_scc1 .ap_94
    s_waitcnt vmcnt(5)
    s_cmpk_ge_u32 s8, 1912
    s_cbranch_scc1 .ap_94
    s_waitcnt vmcnt(3)
    s_bitcmp1_b64 s[14:15], 53
    s_cbranch_scc0 1
    s_waitcnt vmcnt(2)
    s_cmpk_ge_u32 s8, 1792
    s_cbranch_scc1 .ap_94
    s_waitcnt vmcnt(1)
.ap_94:
    s_add_u32 s63, s69, 303104
    buffer_load_dwordx4 v[244:247], v1, s[44:47], s63 offen nt
    s_and_b32 s0, s0, 0xffffff80
    s_sub_u32 s0, s0, 1024
    buffer_load_dword v28, v4, s[36:39], s0 offen sc1
    buffer_load_dwordx4 v[24:27], v9, s[36:39], s59 offen offset:0 sc1
    s_memrealtime s[8:9]
    s_waitcnt vmcnt(9)
    s_waitcnt lgkmcnt(0)
    s_sub_u32 s8, s8, s30
    s_cmpk_ge_u32 s8, 2044
    s_cbranch_scc1 .ap_95
    s_waitcnt vmcnt(6)
    s_cmpk_ge_u32 s8, 1944
    s_cbranch_scc1 .ap_95
    s_waitcnt vmcnt(4)
    s_bitcmp1_b64 s[14:15], 54
    s_cbranch_scc0 1
    s_waitcnt vmcnt(3)
    s_cmpk_ge_u32 s8, 1824
    s_cbranch_scc1 .ap_95
    s_waitcnt vmcnt(2)
.ap_95:
    s_add_u32 s63, s69, 311296
    buffer_load_dwordx4 v[248:251], v1, s[44:47], s63 offen nt
    s_memrealtime s[8:9]
    s_waitcnt vmcnt(9)
    s_waitcnt lgkmcnt(0)
    s_sub_u32 s8, s8, s30
    s_cmpk_ge_u32 s8, 2076
    s_cbranch_scc1 .ap_96
    s_waitcnt vmcnt(6)
    s_cmpk_ge_u32 s8, 1976
    s_cbranch_scc1 .ap_96
    s_waitcnt vmcnt(4)
    s_bitcmp1_b64 s[14:15], 55
    s_cbranch_scc0 1
    s_waitcnt vmcnt(3)
    s_cmpk_ge_u32 s8, 1856
    s_cbranch_scc1 .ap_96
    s_branch .Lsk_m1_4
.Lst_m1_4:
    s_branch .Lrt_m1_4
.Lsk_m1_4:
    s_waitcnt vmcnt(1)
.ap_96:
    s_add_u32 s63, s69, 319488
    buffer_load_dwordx4 v[252:255], v1, s[44:47], s63 offen nt
    s_memrealtime s[8:9]
    s_waitcnt vmcnt(9)
    s_waitcnt lgkmcnt(0)
    s_sub_u32 s8, s8, s30
    s_cmpk_ge_u32 s8, 2108
    s_cbranch_scc1 .ap_97
    s_waitcnt vmcnt(6)
    s_cmpk_ge_u32 s8, 2008
    s_cbranch_scc1 .ap_97
    s_waitcnt vmcnt(4)
    s_bitcmp1_b64 s[14:15], 56
    s_cbranch_scc0 1
    s_waitcnt vmcnt(2)
    s_cmpk_ge_u32 s8, 1888
    s_cbranch_scc1 .ap_97
    s_waitcnt vmcnt(1)
.ap_97:
    s_add_u32 s63, s69, 393216
    buffer_load_dwordx4 v[36:39], v1, s[44:47], s63 offen nt
    s_memrealtime s[8:9]
    s_waitcnt vmcnt(9)
    s_waitcnt lgkmcnt(0)
    s_sub_u32 s8, s8, s30
    s_cmpk_ge_u32 s8, 2140
    s_cbranch_scc1 .ap_98
    s_waitcnt vmcnt(6)
    s_cmpk_ge_u32 s8, 2040
    s_cbranch_scc1 .ap_98
    s_waitcnt vmcnt(3)
    s_bitcmp1_b64 s[14:15], 57
    s_cbranch_scc0 1
    s_waitcnt vmcnt(2)
    s_cmpk_ge_u32 s8, 1920
    s_cbranch_scc1 .ap_98
    s_waitcnt vmcnt(1)
.ap_98:
    s_add_u32 s63, s69, 401408
    buffer_load_dwordx4 v[44:47], v1, s[44:47], s63 offen nt
    s_memrealtime s[8:9]
    s_waitcnt vmcnt(9)
    s_waitcnt lgkmcnt(0)
    s_sub_u32 s8, s8, s30
    s_cmpk_ge_u32 s8, 2172
    s_cbranch_scc1 .ap_99
    s_waitcnt vmcnt(6)
    s_cmpk_ge_u32 s8, 2072
    s_cbranch_scc1 .ap_99
    s_waitcnt vmcnt(3)
    s_bitcmp1_b64 s[14:15], 58
    s_cbranch_scc0 1
    s_waitcnt vmcnt(2)
    s_cmpk_ge_u32 s8, 1952
    s_cbranch_scc1 .ap_99
    s_waitcnt vmcnt(1)
.ap_99:
    s_add_u32 s63, s69, 409600
    buffer_load_dwordx4 v[52:55], v1, s[44:47], s63 offen nt
    s_waitcnt vmcnt(5)
    s_branch .gpc_101
.gp_100:
    buffer_load_dwordx4 v[24:27], v9, s[36:39], s59 offen offset:0 sc1
    s_waitcnt vmcnt(0)
.gpc_101:
    v_cmp_eq_u32 vcc, s34, v26
    s_cmp_eq_u64 vcc, -1
    s_nop 3
    s_cbranch_scc1 .gpd_102
    s_sub_u32 s35, s35, 1
    s_cbranch_scc1 .Lexit
    s_sleep 1
    s_branch .gp_100
.gpd_102:
    v_cmp_eq_u32 vcc, s1, v28
    s_cmp_eq_u64 vcc, -1
    s_cselect_b32 s0, 0x800000, 0
    v_mov_b32 v16, v24
    s_nop 1
    v_max_f32_dpp v16, v16, v16 row_ror:4 row_mask:0xf bank_mask:0xf
    v_sub_f32 v17, v24, v16
    v_sub_f32 v18, v14, v16
    v_mul_f32 v17, 0x3fb8aa3b, v17
    v_mul_f32 v18, 0x3fb8aa3b, v18
    v_exp_f32 v17, v17
    v_exp_f32 v18, v18
    v_mul_f32 v17, v17, v25
    s_nop 1
    v_add_f32_dpp v17, v17, v17 row_ror:4 row_mask:0xf bank_mask:0xf
    v_rcp_f32 v19, v17
    s_nop 0
    v_fma_f32 v15, -v17, v19, 1.0
    v_fma_f32 v19, v15, v19, v19
    v_mul_f32 v18, v18, v19
    v_mul_f32 v10, v10, v18
    v_mul_f32 v11, v11, v18
    v_mul_f32 v12, v12, v18
    v_mul_f32 v13, v13, v18
    v_mov_b32_dpp v112, v10 quad_perm:[2,3,0,1] row_mask:0xf bank_mask:0xf
    v_mov_b32_dpp v113, v11 quad_perm:[2,3,0,1] row_mask:0xf bank_mask:0xf
    v_mov_b32_dpp v114, v12 quad_perm:[2,3,0,1] row_mask:0xf bank_mask:0xf
    v_mov_b32_dpp v115, v13 quad_perm:[2,3,0,1] row_mask:0xf bank_mask:0xf
    v_cvt_pk_bf16_f32 v96, v10, v112
    v_cvt_pk_bf16_f32 v100, v11, v113
    v_cvt_pk_bf16_f32 v104, v12, v114
    v_cvt_pk_bf16_f32 v108, v13, v115
    v_mov_b32_dpp v97, v96 row_ror:12 row_mask:0xf bank_mask:0xf
    v_mov_b32_dpp v101, v100 row_ror:12 row_mask:0xf bank_mask:0xf
    v_mov_b32_dpp v105, v104 row_ror:12 row_mask:0xf bank_mask:0xf
    v_mov_b32_dpp v109, v108 row_ror:12 row_mask:0xf bank_mask:0xf
    v_mov_b32_dpp v98, v96 row_ror:8 row_mask:0xf bank_mask:0xf
    v_mov_b32_dpp v102, v100 row_ror:8 row_mask:0xf bank_mask:0xf
    v_mov_b32_dpp v106, v104 row_ror:8 row_mask:0xf bank_mask:0xf
    v_mov_b32_dpp v110, v108 row_ror:8 row_mask:0xf bank_mask:0xf
    v_mov_b32_dpp v99, v96 row_ror:4 row_mask:0xf bank_mask:0xf
    v_mov_b32_dpp v103, v100 row_ror:4 row_mask:0xf bank_mask:0xf
    v_mov_b32_dpp v107, v104 row_ror:4 row_mask:0xf bank_mask:0xf
    v_mov_b32_dpp v111, v108 row_ror:4 row_mask:0xf bank_mask:0xf
    s_lshl_b32 s60, s3, 10
    s_add_u32 s60, s60, 147456
    v_lshlrev_b32 v10, 5, v0
    v_add_u32 v10, s60, v10
    s_memrealtime s[8:9]
    s_waitcnt lgkmcnt(0)
    s_sub_u32 s8, s8, s30
    s_cmpk_ge_u32 s8, 2204
    s_cbranch_scc1 .ap_103
    s_waitcnt vmcnt(5)
    s_cmpk_ge_u32 s8, 2104
    s_cbranch_scc1 .ap_103
    s_waitcnt vmcnt(3)
    s_bitcmp1_b64 s[14:15], 59
    s_cbranch_scc0 1
    s_waitcnt vmcnt(2)
    s_cmpk_ge_u32 s8, 1984
    s_cbranch_scc1 .ap_103
    s_waitcnt vmcnt(1)
.ap_103:
    s_add_u32 s63, s69, 417792
    buffer_load_dwordx4 v[60:63], v1, s[44:47], s63 offen nt
    v_perm_b32 v112, v164, v160, s94
    v_perm_b32 v113, v172, v168, s94
    v_perm_b32 v114, v180, v176, s94
    v_perm_b32 v115, v188, v184, s94
    s_nop 1
    v_mfma_f32_16x16x32_bf16 v[128:131], v[96:99], v[112:115], 0
    v_perm_b32 v116, v164, v160, s95
    v_perm_b32 v117, v172, v168, s95
    v_perm_b32 v118, v180, v176, s95
    v_perm_b32 v119, v188, v184, s95
    s_nop 1
    v_mfma_f32_16x16x32_bf16 v[132:135], v[96:99], v[116:119], 0
    v_perm_b32 v120, v165, v161, s94
    v_perm_b32 v121, v173, v169, s94
    v_perm_b32 v122, v181, v177, s94
    v_perm_b32 v123, v189, v185, s94
    s_nop 1
    v_mfma_f32_16x16x32_bf16 v[136:139], v[96:99], v[120:123], 0
    v_perm_b32 v124, v165, v161, s95
    v_perm_b32 v125, v173, v169, s95
    v_perm_b32 v126, v181, v177, s95
    v_perm_b32 v127, v189, v185, s95
    s_nop 1
    v_mfma_f32_16x16x32_bf16 v[140:143], v[96:99], v[124:127], 0
    v_perm_b32 v112, v166, v162, s94
    v_perm_b32 v113, v174, v170, s94
    v_perm_b32 v114, v182, v178, s94
    v_perm_b32 v115, v190, v186, s94
    s_nop 1
    v_mfma_f32_16x16x32_bf16 v[144:147], v[96:99], v[112:115], 0
    v_perm_b32 v116, v166, v162, s95
    v_perm_b32 v117, v174, v170, s95
    v_perm_b32 v118, v182, v178, s95
    v_perm_b32 v119, v190, v186, s95
    s_nop 1
    v_mfma_f32_16x16x32_bf16 v[148:151], v[96:99], v[116:119], 0
    v_perm_b32 v120, v167, v163, s94
    v_perm_b32 v121, v175, v171, s94
    v_perm_b32 v122, v183, v179, s94
    v_perm_b32 v123, v191, v187, s94
    s_nop 1
    v_mfma_f32_16x16x32_bf16 v[152:155], v[96:99], v[120:123], 0
    v_perm_b32 v124, v167, v163, s95
    v_perm_b32 v125, v175, v171, s95
    v_perm_b32 v126, v183, v179, s95
    v_perm_b32 v127, v191, v187, s95
    s_nop 1
    v_mfma_f32_16x16x32_bf16 v[156:159], v[96:99], v[124:127], 0
    s_memrealtime s[8:9]
    s_waitcnt lgkmcnt(0)
    s_sub_u32 s8, s8, s30
    s_cmpk_ge_u32 s8, 2236
    s_nop 3
    s_cbranch_scc1 .ap_104
    s_branch .Lsk_m1_5
.Lst_m1_5:
    s_branch .Lrt_m1_5
.Lsk_m1_5:
    s_waitcnt vmcnt(5)
    s_cmpk_ge_u32 s8, 2136
    s_cbranch_scc1 .ap_104
    s_waitcnt vmcnt(3)
    s_bitcmp1_b64 s[14:15], 60
    s_cbranch_scc0 1
    s_waitcnt vmcnt(2)
    s_cmpk_ge_u32 s8, 2016
    s_cbranch_scc1 .ap_104
    s_waitcnt vmcnt(1)
.ap_104:
    s_add_u32 s63, s69, 425984
    buffer_load_dwordx4 v[68:71], v1, s[44:47], s63 offen nt
    v_perm_b32 v112, v196, v192, s94
    v_perm_b32 v113, v204, v200, s94
    v_perm_b32 v114, v212, v208, s94
    v_perm_b32 v115, v220, v216, s94
    s_nop 1
    v_mfma_f32_16x16x32_bf16 v[128:131], v[100:103], v[112:115], v[128:131]
    v_perm_b32 v116, v196, v192, s95
    v_perm_b32 v117, v204, v200, s95
    v_perm_b32 v118, v212, v208, s95
    v_perm_b32 v119, v220, v216, s95
    s_nop 1
    v_mfma_f32_16x16x32_bf16 v[132:135], v[100:103], v[116:119], v[132:135]
    v_perm_b32 v120, v197, v193, s94
    v_perm_b32 v121, v205, v201, s94
    v_perm_b32 v122, v213, v209, s94
    v_perm_b32 v123, v221, v217, s94
    s_nop 1
    v_mfma_f32_16x16x32_bf16 v[136:139], v[100:103], v[120:123], v[136:139]
    v_perm_b32 v124, v197, v193, s95
    v_perm_b32 v125, v205, v201, s95
    v_perm_b32 v126, v213, v209, s95
    v_perm_b32 v127, v221, v217, s95
    s_nop 1
    v_mfma_f32_16x16x32_bf16 v[140:143], v[100:103], v[124:127], v[140:143]
    v_perm_b32 v112, v198, v194, s94
    v_perm_b32 v113, v206, v202, s94
    v_perm_b32 v114, v214, v210, s94
    v_perm_b32 v115, v222, v218, s94
    s_nop 1
    v_mfma_f32_16x16x32_bf16 v[144:147], v[100:103], v[112:115], v[144:147]
    v_perm_b32 v116, v198, v194, s95
    v_perm_b32 v117, v206, v202, s95
    v_perm_b32 v118, v214, v210, s95
    v_perm_b32 v119, v222, v218, s95
    s_nop 1
    v_mfma_f32_16x16x32_bf16 v[148:151], v[100:103], v[116:119], v[148:151]
    v_perm_b32 v120, v199, v195, s94
    v_perm_b32 v121, v207, v203, s94
    v_perm_b32 v122, v215, v211, s94
    v_perm_b32 v123, v223, v219, s94
    s_nop 1
    v_mfma_f32_16x16x32_bf16 v[152:155], v[100:103], v[120:123], v[152:155]
    v_perm_b32 v124, v199, v195, s95
    v_perm_b32 v125, v207, v203, s95
    v_perm_b32 v126, v215, v211, s95
    v_perm_b32 v127, v223, v219, s95
    s_nop 1
    v_mfma_f32_16x16x32_bf16 v[156:159], v[100:103], v[124:127], v[156:159]
    s_memrealtime s[8:9]
    s_waitcnt lgkmcnt(0)
    s_sub_u32 s8, s8, s30
    s_cmpk_ge_u32 s8, 2268
    s_nop 3
    s_cbranch_scc1 .ap_105
    s_waitcnt vmcnt(5)
    s_cmpk_ge_u32 s8, 2168
    s_cbranch_scc1 .ap_105
    s_waitcnt vmcnt(3)
    s_bitcmp1_b64 s[14:15], 61
    s_cbranch_scc0 1
    s_waitcnt vmcnt(2)
    s_cmpk_ge_u32 s8, 2048
    s_cbranch_scc1 .ap_105
    s_waitcnt vmcnt(1)
.ap_105:
    s_add_u32 s63, s69, 434176
    buffer_load_dwordx4 v[76:79], v1, s[44:47], s63 offen nt
    s_waitcnt vmcnt(6)
    v_perm_b32 v112, v228, v224, s94
    v_perm_b32 v113, v236, v232, s94
    v_perm_b32 v114, v244, v240, s94
    v_perm_b32 v115, v252, v248, s94
    s_nop 1
    v_mfma_f32_16x16x32_bf16 v[128:131], v[104:107], v[112:115], v[128:131]
    v_perm_b32 v116, v228, v224, s95
    v_perm_b32 v117, v236, v232, s95
    v_perm_b32 v118, v244, v240, s95
    v_perm_b32 v119, v252, v248, s95
    s_nop 1
    v_mfma_f32_16x16x32_bf16 v[132:135], v[104:107], v[116:119], v[132:135]
    v_perm_b32 v120, v229, v225, s94
    v_perm_b32 v121, v237, v233, s94
    v_perm_b32 v122, v245, v241, s94
    v_perm_b32 v123, v253, v249, s94
    s_nop 1
    v_mfma_f32_16x16x32_bf16 v[136:139], v[104:107], v[120:123], v[136:139]
    v_perm_b32 v124, v229, v225, s95
    v_perm_b32 v125, v237, v233, s95
    v_perm_b32 v126, v245, v241, s95
    v_perm_b32 v127, v253, v249, s95
    s_nop 1
    v_mfma_f32_16x16x32_bf16 v[140:143], v[104:107], v[124:127], v[140:143]
    v_perm_b32 v112, v230, v226, s94
    v_perm_b32 v113, v238, v234, s94
    v_perm_b32 v114, v246, v242, s94
    v_perm_b32 v115, v254, v250, s94
    s_nop 1
    v_mfma_f32_16x16x32_bf16 v[144:147], v[104:107], v[112:115], v[144:147]
    v_perm_b32 v116, v230, v226, s95
    v_perm_b32 v117, v238, v234, s95
    v_perm_b32 v118, v246, v242, s95
    v_perm_b32 v119, v254, v250, s95
    s_nop 1
    v_mfma_f32_16x16x32_bf16 v[148:151], v[104:107], v[116:119], v[148:151]
    v_perm_b32 v120, v231, v227, s94
    v_perm_b32 v121, v239, v235, s94
    v_perm_b32 v122, v247, v243, s94
    v_perm_b32 v123, v255, v251, s94
    s_nop 1
    v_mfma_f32_16x16x32_bf16 v[152:155], v[104:107], v[120:123], v[152:155]
    v_perm_b32 v124, v231, v227, s95
    v_perm_b32 v125, v239, v235, s95
    v_perm_b32 v126, v247, v243, s95
    v_perm_b32 v127, v255, v251, s95
    s_nop 1
    v_mfma_f32_16x16x32_bf16 v[156:159], v[104:107], v[124:127], v[156:159]
    s_memrealtime s[8:9]
    s_waitcnt lgkmcnt(0)
    s_sub_u32 s8, s8, s30
    s_cmpk_ge_u32 s8, 2300
    s_nop 3
    s_cbranch_scc1 .ap_106
    s_waitcnt vmcnt(5)
    s_cmpk_ge_u32 s8, 2200
    s_cbranch_scc1 .ap_106
    s_waitcnt vmcnt(3)
    s_bitcmp1_b64 s[14:15], 62
    s_cbranch_scc0 1
    s_waitcnt vmcnt(2)
    s_cmpk_ge_u32 s8, 2080
    s_cbranch_scc1 .ap_106
    s_waitcnt vmcnt(1)
.ap_106:
    s_add_u32 s63, s69, 442368
    buffer_load_dwordx4 v[84:87], v1, s[44:47], s63 offen nt
    s_memrealtime s[8:9]
    s_waitcnt lgkmcnt(0)
    s_sub_u32 s8, s8, s30
    s_cmpk_ge_u32 s8, 2332
    s_cbranch_scc1 .ap_107
    s_waitcnt vmcnt(5)
    s_cmpk_ge_u32 s8, 2232
    s_cbranch_scc1 .ap_107
    s_waitcnt vmcnt(3)
    s_bitcmp1_b64 s[14:15], 63
    s_cbranch_scc0 1
    s_waitcnt vmcnt(2)
    s_cmpk_ge_u32 s8, 2112
    s_cbranch_scc1 .ap_107
    s_waitcnt vmcnt(1)
.ap_107:
    s_add_u32 s63, s69, 450560
    buffer_load_dwordx4 v[92:95], v1, s[44:47], s63 offen nt
    s_setprio 0
    s_waitcnt vmcnt(6)
    v_perm_b32 v160, v44, v36, s94
    v_perm_b32 v164, v44, v36, s95
    v_perm_b32 v168, v45, v37, s94
    v_perm_b32 v172, v45, v37, s95
    v_perm_b32 v176, v46, v38, s94
    v_perm_b32 v180, v46, v38, s95
    v_perm_b32 v184, v47, v39, s94
    v_perm_b32 v188, v47, v39, s95
    s_branch .Lsk_m1_6
.Lst_m1_6:
    s_branch .Lrt_m1_6
.Lsk_m1_6:
    s_waitcnt vmcnt(4)
    v_perm_b32 v161, v60, v52, s94
    v_perm_b32 v165, v60, v52, s95
    v_perm_b32 v169, v61, v53, s94
    v_perm_b32 v173, v61, v53, s95
    v_perm_b32 v177, v62, v54, s94
    v_perm_b32 v181, v62, v54, s95
    v_perm_b32 v185, v63, v55, s94
    v_perm_b32 v189, v63, v55, s95
    s_waitcnt vmcnt(2)
    v_perm_b32 v162, v76, v68, s94
    v_perm_b32 v166, v76, v68, s95
    v_perm_b32 v170, v77, v69, s94
    v_perm_b32 v174, v77, v69, s95
    v_perm_b32 v178, v78, v70, s94
    v_perm_b32 v182, v78, v70, s95
    v_perm_b32 v186, v79, v71, s94
    v_perm_b32 v190, v79, v71, s95
    s_waitcnt vmcnt(0)
    v_perm_b32 v163, v92, v84, s94
    v_perm_b32 v167, v92, v84, s95
    v_perm_b32 v171, v93, v85, s94
    v_mfma_f32_16x16x32_bf16 v[128:131], v[108:111], v[160:163], v[128:131]
    v_perm_b32 v175, v93, v85, s95
    v_mfma_f32_16x16x32_bf16 v[132:135], v[108:111], v[164:167], v[132:135]
    v_perm_b32 v179, v94, v86, s94
    v_mfma_f32_16x16x32_bf16 v[136:139], v[108:111], v[168:171], v[136:139]
    v_perm_b32 v183, v94, v86, s95
    v_mfma_f32_16x16x32_bf16 v[140:143], v[108:111], v[172:175], v[140:143]
    v_perm_b32 v187, v95, v87, s94
    v_mfma_f32_16x16x32_bf16 v[144:147], v[108:111], v[176:179], v[144:147]
    v_perm_b32 v191, v95, v87, s95
    v_mfma_f32_16x16x32_bf16 v[148:151], v[108:111], v[180:183], v[148:151]
    v_mfma_f32_16x16x32_bf16 v[152:155], v[108:111], v[184:187], v[152:155]
    v_mfma_f32_16x16x32_bf16 v[156:159], v[108:111], v[188:191], v[156:159]
    s_mov_b64 exec, 0xffff
    ds_write2_b32 v10, v128, v129 offset0:0 offset1:128
    ds_write2_b32 v10, v132, v133 offset0:1 offset1:129
    ds_write2_b32 v10, v136, v137 offset0:2 offset1:130
    ds_write2_b32 v10, v140, v141 offset0:3 offset1:131
    ds_write2_b32 v10, v144, v145 offset0:4 offset1:132
    ds_write2_b32 v10, v148, v149 offset0:5 offset1:133
    ds_write2_b32 v10, v152, v153 offset0:6 offset1:134
    ds_write2_b32 v10, v156, v157 offset0:7 offset1:135
    s_mov_b64 exec, -1
    s_waitcnt lgkmcnt(0)
    s_barrier
    s_cmp_lg_u32 s3, 7
    s_cbranch_scc1 .opub_108
    v_add_u32 v10, 147456, v2
    ds_read_b128 v[196:199], v10 offset:0
    ds_read_b128 v[200:203], v10 offset:1024
    ds_read_b128 v[204:207], v10 offset:2048
    ds_read_b128 v[208:211], v10 offset:3072
    ds_read_b128 v[212:215], v10 offset:4096
    ds_read_b128 v[216:219], v10 offset:5120
    ds_read_b128 v[220:223], v10 offset:6144
    ds_read_b128 v[224:227], v10 offset:7168
    v_lshrrev_b32 v11, 5, v0
    v_lshlrev_b32 v11, 13, v11
    v_and_b32 v12, 31, v0
    v_lshl_add_u32 v11, v12, 4, v11
    s_lshl4_add_u32 s56, s67, s66
    s_lshl1_add_u32 s56, s56, s68
    s_lshl_b32 s56, s56, 9
    s_add_u32 s56, s56, 0xa0000
    s_mov_b32 s60, 0x07060503
    s_mov_b32 s61, 0x07060502
    s_mov_b32 s62, 0x07060501
    v_mov_b32 v15, s34
    s_waitcnt lgkmcnt(6)
    v_pk_add_f32 v[196:197], v[196:197], v[200:201]
    v_pk_add_f32 v[198:199], v[198:199], v[202:203]
    s_waitcnt lgkmcnt(5)
    v_pk_add_f32 v[196:197], v[196:197], v[204:205]
    v_pk_add_f32 v[198:199], v[198:199], v[206:207]
    s_waitcnt lgkmcnt(4)
    v_pk_add_f32 v[196:197], v[196:197], v[208:209]
    v_pk_add_f32 v[198:199], v[198:199], v[210:211]
    s_waitcnt lgkmcnt(3)
    v_pk_add_f32 v[196:197], v[196:197], v[212:213]
    v_pk_add_f32 v[198:199], v[198:199], v[214:215]
    s_waitcnt lgkmcnt(2)
    v_pk_add_f32 v[196:197], v[196:197], v[216:217]
    v_pk_add_f32 v[198:199], v[198:199], v[218:219]
    s_waitcnt lgkmcnt(1)
    v_pk_add_f32 v[196:197], v[196:197], v[220:221]
    v_pk_add_f32 v[198:199], v[198:199], v[222:223]
    s_waitcnt lgkmcnt(0)
    v_pk_add_f32 v[196:197], v[196:197], v[224:225]
    v_pk_add_f32 v[198:199], v[198:199], v[226:227]
    v_perm_b32 v12, v196, v199, s60
    v_perm_b32 v13, v197, v199, s61
    v_perm_b32 v14, v198, v199, s62
    s_add_u32 s57, s56, 0x800000
    buffer_store_dwordx4 v[12:15], v11, s[36:39], s57 offen
    s_cmp_lg_u32 s0, 0
    s_nop 0
    s_cbranch_scc1 .nosl_109
    buffer_store_dwordx4 v[12:15], v11, s[36:39], s56 offen sc1
.nosl_109:
.opub_108:
    s_and_b32 s58, s64, 0
    s_mul_i32 s58, s58, 18432
    s_mul_i32 s59, s3, 2304
    s_add_u32 s58, s58, s59
    s_add_u32 s62, s58, 0x37000
    s_add_u32 s63, s58, 0x49000
    s_mul_i32 s101, s64, 18432
    s_add_u32 s101, s101, s59
    s_add_u32 s101, s101, 0x170000
    s_lshl_b32 s56, s65, 8
    s_add_u32 s58, s58, s56
    s_add_u32 s58, s58, 0x25000
    s_add_u32 s99, s101, s56
    s_lshr_b32 s56, s64, 1
    s_and_b32 s57, s3, 3
    s_cmp_lg_u32 s56, s57
    s_cbranch_scc1 .Lr_ga
    s_add_u32 s59, s58, 73728
    s_add_u32 s60, s58, 147456
    s_add_u32 s61, s58, 221184
.gp_110:
    buffer_load_dwordx4 v[56:59], v2, s[36:39], s62 offen offset:0 sc1
    buffer_load_dwordx4 v[60:63], v2, s[36:39], s62 offen offset:1024 sc1
    buffer_load_dwordx2 v[64:65], v5, s[36:39], s62 offen offset:0 sc1
    buffer_load_dwordx4 v[66:69], v2, s[36:39], s63 offen offset:0 sc1
    buffer_load_dwordx4 v[70:73], v2, s[36:39], s63 offen offset:1024 sc1
    buffer_load_dwordx2 v[74:75], v5, s[36:39], s63 offen offset:0 sc1
    buffer_load_dwordx2 v[76:77], v8, s[36:39], s59 offen offset:0 sc1
    buffer_load_dwordx2 v[78:79], v8, s[36:39], s60 offen offset:0 sc1
    buffer_load_dwordx2 v[80:81], v8, s[36:39], s61 offen offset:0 sc1
    buffer_load_dwordx2 v[42:43], v8, s[36:39], s58 offen offset:0 sc1
    s_waitcnt vmcnt(0)
.gpc_111:
    v_min_u32 v24, v57, v59
    v_max_u32 v25, v57, v59
    v_min3_u32 v24, v24, v61, v63
    v_max3_u32 v25, v25, v61, v63
    v_min3_u32 v24, v24, v65, v67
    v_max3_u32 v25, v25, v65, v67
    v_min3_u32 v24, v24, v69, v71
    v_max3_u32 v25, v25, v69, v71
    v_min3_u32 v24, v24, v73, v75
    v_max3_u32 v25, v25, v73, v75
    v_min3_u32 v24, v24, v77, v79
    v_max3_u32 v25, v25, v77, v79
    v_min3_u32 v24, v24, v81, v43
    v_max3_u32 v25, v25, v81, v43
    v_cmp_eq_u32 vcc, s34, v24
    v_cmp_eq_u32 s[56:57], s34, v25
    s_and_b64 vcc, vcc, s[56:57]
    s_cmp_eq_u64 vcc, -1
    s_nop 2
    s_cbranch_scc1 .gpd_112
    s_sub_u32 s35, s35, 1
    s_cbranch_scc1 .Lexit
    s_sleep 2
    s_branch .gp_110
.gpd_112:
    v_and_b32 v57, 0xffff0000, v56
    s_branch .Lsk_m1_7
.Lst_m1_7:
    s_branch .Lrt_m1_7
.Lsk_m1_7:
    v_lshlrev_b32 v56, 16, v56
    v_and_b32 v67, 0xffff0000, v66
    v_lshlrev_b32 v66, 16, v66
    v_and_b32 v59, 0xffff0000, v58
    v_lshlrev_b32 v58, 16, v58
    v_and_b32 v69, 0xffff0000, v68
    v_lshlrev_b32 v68, 16, v68
    v_and_b32 v61, 0xffff0000, v60
    v_lshlrev_b32 v60, 16, v60
    v_and_b32 v71, 0xffff0000, v70
    v_lshlrev_b32 v70, 16, v70
    v_and_b32 v63, 0xffff0000, v62
    v_lshlrev_b32 v62, 16, v62
    v_and_b32 v73, 0xffff0000, v72
    v_lshlrev_b32 v72, 16, v72
    v_and_b32 v65, 0xffff0000, v64
    v_lshlrev_b32 v64, 16, v64
    v_and_b32 v75, 0xffff0000, v74
    v_lshlrev_b32 v74, 16, v74
    v_lshlrev_b32 v77, 16, v76
    v_and_b32 v76, 0xffff0000, v76
    s_mov_b32 vcc_lo, 0xffff0000
    s_mov_b32 vcc_hi, 0xffff0000
    v_cndmask_b32 v77, v77, v76, vcc
    v_lshlrev_b32 v79, 16, v78
    v_and_b32 v78, 0xffff0000, v78
    s_mov_b32 vcc_lo, 0xffff0000
    s_mov_b32 vcc_hi, 0xffff0000
    v_cndmask_b32 v79, v79, v78, vcc
    v_lshlrev_b32 v81, 16, v80
    v_and_b32 v80, 0xffff0000, v80
    s_mov_b32 vcc_lo, 0xffff0000
    s_mov_b32 vcc_hi, 0xffff0000
    v_cndmask_b32 v81, v81, v80, vcc
    s_nop 1
    s_branch .Lr_ga2
.Lr_ga:
.gp_113:
    buffer_load_dwordx2 v[42:43], v8, s[36:39], s58 offen offset:0 sc1
    s_waitcnt vmcnt(0)
.gpc_114:
    v_cmp_eq_u32 vcc, s34, v43
    s_cmp_eq_u64 vcc, -1
    s_nop 3
    s_cbranch_scc1 .gpd_115
    s_sub_u32 s35, s35, 1
    s_cbranch_scc1 .Lexit
    s_sleep 2
    s_branch .gp_113
.gpd_115:
.Lr_ga2:
    v_lshlrev_b32 v40, 16, v40
    v_lshlrev_b32 v41, 16, v42
    v_and_b32 v42, 0xffff0000, v42
    s_mov_b32 vcc_lo, 0xffff0000
    s_mov_b32 vcc_hi, 0xffff0000
    v_cndmask_b32 v41, v41, v42, vcc
    s_mul_i32 s59, s3, 9
    s_add_u32 s59, s59, s65
    s_lshl_b32 s59, s59, 12
    s_add_u32 s59, s59, 0xe0000
    s_mov_b32 s60, 0x04000c0c
    s_mov_b32 s61, 0x0706000c
    v_mov_b32 v45, s34
    v_mov_b32 v47, s34
.ip_116:
    buffer_load_dwordx4 v[16:19], v2, s[36:39], s59 offen offset:0 sc1
    buffer_load_dwordx4 v[20:23], v2, s[36:39], s59 offen offset:1024 sc1
    buffer_load_dwordx4 v[24:27], v2, s[36:39], s59 offen offset:2048 sc1
    buffer_load_dwordx4 v[28:31], v2, s[36:39], s59 offen offset:3072 sc1
    s_waitcnt vmcnt(3)
    v_mov_b32 v32, v19
    v_mov_b32 v33, v19
    v_perm_b32 v19, v16, v17, s60
    v_perm_b32 v19, v19, v18, s61
    s_waitcnt vmcnt(2)
    v_min_u32 v32, v32, v23
    v_max_u32 v33, v33, v23
    v_perm_b32 v23, v20, v21, s60
    v_perm_b32 v23, v23, v22, s61
    v_pk_add_f32 v[16:17], v[16:17], v[20:21]
    v_pk_add_f32 v[18:19], v[18:19], v[22:23]
    s_waitcnt vmcnt(1)
    v_min_u32 v32, v32, v27
    v_max_u32 v33, v33, v27
    v_perm_b32 v27, v24, v25, s60
    v_perm_b32 v27, v27, v26, s61
    v_pk_add_f32 v[16:17], v[16:17], v[24:25]
    v_pk_add_f32 v[18:19], v[18:19], v[26:27]
    s_waitcnt vmcnt(0)
    v_min_u32 v32, v32, v31
    v_max_u32 v33, v33, v31
    v_cmp_eq_u32 vcc, s34, v32
    v_cmp_eq_u32 s[56:57], s34, v33
    v_perm_b32 v31, v28, v29, s60
    v_perm_b32 v31, v31, v30, s61
    v_pk_add_f32 v[16:17], v[16:17], v[28:29]
    v_pk_add_f32 v[18:19], v[18:19], v[30:31]
    s_and_b64 vcc, vcc, s[56:57]
    s_cmp_eq_u64 vcc, -1
    s_cbranch_scc1 .ipd_117
    s_sub_u32 s35, s35, 1
    s_cbranch_scc0 .ip_116
    s_branch .Lexit
.ipd_117:
    v_permlane32_swap_b32 v16, v18
    v_permlane32_swap_b32 v17, v19
    v_pk_add_f32 v[16:17], v[16:17], v[18:19]
    s_nop 1
    v_permlane16_swap_b32 v16, v17
    v_add_f32 v16, v16, v17
    v_cvt_pk_bf16_f32 v16, v16, v16
    v_lshlrev_b32 v16, 16, v16
    v_mul_f32 v16, v16, v41
    v_cvt_pk_bf16_f32 v16, v16, v16
    v_lshlrev_b32 v16, 16, v16
    v_add_f32 v17, v16, v40
    v_add_f32 v16, v16, v40
    v_mov_b32 v40, v16
    s_nop 0
    v_permlane16_swap_b32 v16, v17
    v_cvt_pk_bf16_f32 v44, v16, v17
    s_mov_b32 exec_lo, 0xffff
    s_mov_b32 exec_hi, 0xffff
    s_add_u32 s57, s99, 0x800000
    buffer_store_dwordx2 v[44:45], v8, s[36:39], s57 offen
    s_cmp_lg_u32 s0, 0
    s_cbranch_scc1 .nosl_118
    buffer_store_dwordx2 v[44:45], v8, s[36:39], s99 offen sc1
.nosl_118:
    s_mov_b64 exec, -1
    s_lshr_b32 s56, s64, 1
    s_and_b32 s57, s3, 3
    s_cmp_lg_u32 s56, s57
    s_cbranch_scc1 .Lexit
    v_cvt_pk_bf16_f32 v40, v40, v40
    v_lshlrev_b32 v40, 16, v40
    s_mov_b32 s69, 0
.gp_119:
    s_add_u32 s69, s69, 1
    s_and_b32 s56, s69, 0x41
    s_cmp_lg_u32 s56, 0x41
    s_cselect_b32 s56, 0, 0x800000
    s_xor_b32 s56, s56, s0
    s_add_u32 s58, s101, s56
    buffer_load_dwordx4 v[84:87], v2, s[36:39], s58 offen offset:0 sc1
    buffer_load_dwordx4 v[88:91], v2, s[36:39], s58 offen offset:1024 sc1
    buffer_load_dwordx2 v[92:93], v5, s[36:39], s58 offen offset:0 sc1
    s_waitcnt vmcnt(0)
    v_min3_u32 v24, v85, v87, v89
    v_max3_u32 v25, v85, v87, v89
    v_min3_u32 v24, v24, v91, v93
    s_branch .Lsk_m2_0
.Lst_m2_0:
    s_branch .Lrt_m2_0
.Lsk_m2_0:
    v_max3_u32 v25, v25, v91, v93
    v_cmp_eq_u32 vcc, s34, v24
    v_cmp_eq_u32 s[56:57], s34, v25
    s_and_b64 vcc, vcc, s[56:57]
    s_cmp_eq_u64 vcc, -1
    s_nop 2
    s_cbranch_scc1 .gpd_120
    s_sub_u32 s35, s35, 1
    s_cbranch_scc1 .Lexit
    s_sleep 1
    s_branch .gp_119
.gpd_120:
    s_mov_b32 s56, 0x3f803f80
    v_dot2_f32_bf16 v104, v84, s56, 0
    v_dot2_f32_bf16 v105, v84, v84, 0
    v_dot2_f32_bf16 v104, v86, s56, v104
    v_dot2_f32_bf16 v105, v86, v86, v105
    v_dot2_f32_bf16 v104, v88, s56, v104
    v_dot2_f32_bf16 v105, v88, v88, v105
    v_dot2_f32_bf16 v104, v90, s56, v104
    v_dot2_f32_bf16 v105, v90, v90, v105
    s_mov_b64 exec, 0xffffffff
    v_dot2_f32_bf16 v104, v92, s56, v104
    v_dot2_f32_bf16 v105, v92, v92, v105
    s_mov_b64 exec, -1
    s_nop 1
    v_permlane32_swap_b32 v104, v105
    v_add_f32 v104, v104, v105
    v_mov_b32 v106, v104
    s_nop 1
    v_permlane16_swap_b32 v106, v104
    v_add_f32 v104, v106, v104
    v_and_b32 v95, 0xffff0000, v84
    v_lshlrev_b32 v94, 16, v84
    v_add_f32_dpp v104, v104, v104 row_ror:8 row_mask:0xf bank_mask:0xf
    v_and_b32 v97, 0xffff0000, v86
    v_lshlrev_b32 v96, 16, v86
    v_add_f32_dpp v104, v104, v104 row_ror:4 row_mask:0xf bank_mask:0xf
    v_and_b32 v99, 0xffff0000, v88
    v_lshlrev_b32 v98, 16, v88
    v_add_f32_dpp v104, v104, v104 quad_perm:[2,3,0,1] row_mask:0xf bank_mask:0xf
    v_and_b32 v101, 0xffff0000, v90
    v_lshlrev_b32 v100, 16, v90
    v_add_f32_dpp v104, v104, v104 quad_perm:[1,0,3,2] row_mask:0xf bank_mask:0xf
    v_mul_f32 v104, 0x3ae38e39, v104
    v_and_b32 v103, 0xffff0000, v92
    v_lshlrev_b32 v102, 16, v92
    v_readlane_b32 s56, v104, 0
    v_readlane_b32 s57, v104, 32
    s_nop 0
    v_mov_b32 v104, s56
    v_fma_f32 v105, -v104, v104, s57
    v_max_f32 v105, 0, v105
    v_cvt_pk_bf16_f32 v106, -v104, v105
    v_and_b32 v107, 0xffff0000, v106
    v_add_f32 v107, 0x3727c5ac, v107
    v_lshlrev_b32 v104, 16, v106
    v_cvt_pk_bf16_f32 v107, v107, v107
    v_lshlrev_b32 v107, 16, v107
    v_sqrt_f32 v107, v107
    v_mov_b32 v105, v104
    v_cvt_pk_bf16_f32 v107, v107, v107
    v_lshlrev_b32 v107, 16, v107
    v_rcp_f32 v106, v107
    v_rcp_f32 v107, v107
    v_pk_add_f32 v[94:95], v[94:95], v[104:105]
    v_pk_add_f32 v[96:97], v[96:97], v[104:105]
    v_pk_add_f32 v[98:99], v[98:99], v[104:105]
    v_pk_add_f32 v[100:101], v[100:101], v[104:105]
    v_pk_add_f32 v[102:103], v[102:103], v[104:105]
    v_cvt_pk_bf16_f32 v94, v94, v95
    v_and_b32 v95, 0xffff0000, v94
    v_lshlrev_b32 v94, 16, v94
    v_cvt_pk_bf16_f32 v96, v96, v97
    v_and_b32 v97, 0xffff0000, v96
    v_lshlrev_b32 v96, 16, v96
    v_cvt_pk_bf16_f32 v98, v98, v99
    v_and_b32 v99, 0xffff0000, v98
    v_lshlrev_b32 v98, 16, v98
    v_cvt_pk_bf16_f32 v100, v100, v101
    v_and_b32 v101, 0xffff0000, v100
    v_lshlrev_b32 v100, 16, v100
    v_cvt_pk_bf16_f32 v102, v102, v103
    v_and_b32 v103, 0xffff0000, v102
    v_lshlrev_b32 v102, 16, v102
    v_pk_mul_f32 v[94:95], v[94:95], v[106:107]
    v_pk_mul_f32 v[96:97], v[96:97], v[106:107]
    v_pk_mul_f32 v[98:99], v[98:99], v[106:107]
    v_pk_mul_f32 v[100:101], v[100:101], v[106:107]
    v_pk_mul_f32 v[102:103], v[102:103], v[106:107]
    v_cvt_pk_bf16_f32 v94, v94, v95
    v_and_b32 v95, 0xffff0000, v94
    v_lshlrev_b32 v94, 16, v94
    v_cvt_pk_bf16_f32 v96, v96, v97
    v_and_b32 v97, 0xffff0000, v96
    v_lshlrev_b32 v96, 16, v96
    v_cvt_pk_bf16_f32 v98, v98, v99
    v_and_b32 v99, 0xffff0000, v98
    v_lshlrev_b32 v98, 16, v98
    v_cvt_pk_bf16_f32 v100, v100, v101
    v_and_b32 v101, 0xffff0000, v100
    v_lshlrev_b32 v100, 16, v100
    v_cvt_pk_bf16_f32 v102, v102, v103
    v_and_b32 v103, 0xffff0000, v102
    v_lshlrev_b32 v102, 16, v102
    v_pk_mul_f32 v[94:95], v[94:95], v[66:67]
    v_pk_mul_f32 v[96:97], v[96:97], v[68:69]
    v_pk_mul_f32 v[98:99], v[98:99], v[70:71]
    v_pk_mul_f32 v[100:101], v[100:101], v[72:73]
    v_pk_mul_f32 v[102:103], v[102:103], v[74:75]
    v_cvt_pk_bf16_f32 v94, v94, v95
    v_and_b32 v95, 0xffff0000, v94
    v_lshlrev_b32 v94, 16, v94
    v_cvt_pk_bf16_f32 v96, v96, v97
    v_and_b32 v97, 0xffff0000, v96
    v_lshlrev_b32 v96, 16, v96
    v_cvt_pk_bf16_f32 v98, v98, v99
    v_and_b32 v99, 0xffff0000, v98
    v_lshlrev_b32 v98, 16, v98
    v_cvt_pk_bf16_f32 v100, v100, v101
    v_and_b32 v101, 0xffff0000, v100
    v_lshlrev_b32 v100, 16, v100
    v_cvt_pk_bf16_f32 v102, v102, v103
    v_and_b32 v103, 0xffff0000, v102
    v_lshlrev_b32 v102, 16, v102
    v_pk_add_f32 v[94:95], v[94:95], v[56:57]
    v_pk_add_f32 v[96:97], v[96:97], v[58:59]
    v_pk_add_f32 v[98:99], v[98:99], v[60:61]
    v_pk_add_f32 v[100:101], v[100:101], v[62:63]
    v_pk_add_f32 v[102:103], v[102:103], v[64:65]
    v_cvt_pk_bf16_f32 v110, v94, v95
    v_cvt_pk_bf16_f32 v111, v96, v97
    v_cvt_pk_bf16_f32 v112, v98, v99
    v_cvt_pk_bf16_f32 v113, v100, v101
    v_cvt_pk_bf16_f32 v114, v102, v103
    v_dot2_f32_bf16 v14, v110, v48, 0
    v_dot2_f32_bf16 v14, v111, v49, v14
    v_dot2_f32_bf16 v14, v112, v50, v14
    v_dot2_f32_bf16 v14, v113, v51, v14
    s_mov_b64 exec, 0xffffffff
    v_dot2_f32_bf16 v14, v114, v34, v14
    s_mov_b64 exec, -1
    s_nop 1
    v_mov_b32 v15, v14
    s_nop 1
    v_permlane32_swap_b32 v15, v14
    v_add_f32 v14, v15, v14
    v_mov_b32 v15, v14
    s_nop 1
    v_permlane16_swap_b32 v15, v14
    v_add_f32 v14, v15, v14
    s_nop 1
    v_add_f32_dpp v14, v14, v14 row_ror:8 row_mask:0xf bank_mask:0xf
    s_nop 1
    v_add_f32_dpp v14, v14, v14 row_ror:4 row_mask:0xf bank_mask:0xf
    s_nop 1
    v_add_f32_dpp v14, v14, v14 quad_perm:[2,3,0,1] row_mask:0xf bank_mask:0xf
    s_nop 1
    v_add_f32_dpp v14, v14, v14 quad_perm:[1,0,3,2] row_mask:0xf bank_mask:0xf
    v_cvt_pk_bf16_f32 v14, v14, v14
    v_lshlrev_b32 v14, 16, v14
    v_max_f32 v14, 0xc2ae0000, v14
    v_min_f32 v14, 0x43000000, v14
    v_mul_f32 v15, 0xbfb8aa3b, v14
    v_fma_f32 v16, v14, s98, -v15
    v_fmac_f32 v16, 0xb2a57060, v14
    v_exp_f32 v15, v15
    v_mul_f32 v16, 0x3f317218, v16
    s_branch .Lsk_m2_1
.Lst_m2_1:
    s_branch .Lrt_m2_1
.Lsk_m2_1:
    v_fmac_f32 v15, v15, v16
    v_add_f32 v15, 1.0, v15
    v_rcp_f32 v16, v15
    s_nop 0
    v_fma_f32 v15, -v15, v16, 1.0
    v_fma_f32 v14, v15, v16, v16
    v_cvt_pk_bf16_f32 v14, v14, v14
    v_lshlrev_b32 v14, 16, v14
    v_add_f32 v41, v40, v104
    v_cvt_pk_bf16_f32 v41, v41, v41
    v_lshlrev_b32 v41, 16, v41
    v_mul_f32 v41, v41, v106
    v_cvt_pk_bf16_f32 v41, v41, v41
    v_lshlrev_b32 v41, 16, v41
    v_mul_f32 v41, v41, v79
    v_cvt_pk_bf16_f32 v41, v41, v41
    v_lshlrev_b32 v41, 16, v41
    v_add_f32 v41, v41, v77
    v_cvt_pk_bf16_f32 v41, v41, v41
    v_lshlrev_b32 v41, 16, v41
    s_and_b32 s62, s64, 1
    s_lshl1_add_u32 s58, s65, s62
    s_lshl3_add_u32 s58, s58, s3
    s_mul_i32 s58, s58, 9216
    s_add_u32 s58, s58, 0x1a0000
    s_add_u32 s59, s58, 4096
    s_add_u32 s63, s58, 8192
    s_cmp_eq_u32 s62, 0
    s_mov_b32 s56, 0x00ff00ff
    s_cselect_b32 s62, s56, 0xff00ff00
    s_mov_b32 s60, 0x04000c0c
    s_mov_b32 s61, 0x0706000c
    s_mov_b32 s48, s28
    s_and_b32 s49, s29, 0xffff
    s_mov_b32 s50, 0x2400
    s_mov_b32 s51, 0x00020000
.ip_121:
    buffer_load_dwordx4 v[120:123], v2, s[36:39], s58 offen offset:0 sc1
    buffer_load_dwordx4 v[124:127], v2, s[36:39], s58 offen offset:1024 sc1
    buffer_load_dwordx4 v[128:131], v2, s[36:39], s58 offen offset:2048 sc1
    buffer_load_dwordx4 v[132:135], v2, s[36:39], s58 offen offset:3072 sc1
    buffer_load_dwordx4 v[136:139], v2, s[36:39], s59 offen offset:0 sc1
    buffer_load_dwordx4 v[140:143], v2, s[36:39], s59 offen offset:1024 sc1
    buffer_load_dwordx4 v[144:147], v2, s[36:39], s59 offen offset:2048 sc1
    buffer_load_dwordx4 v[148:151], v2, s[36:39], s59 offen offset:3072 sc1
    buffer_load_dwordx4 v[152:155], v2, s[36:39], s63 offen offset:0 sc1
    s_waitcnt vmcnt(8)
    v_mov_b32 v24, v123
    v_mov_b32 v25, v123
    v_perm_b32 v123, v120, v121, s60
    v_perm_b32 v123, v123, v122, s61
    s_waitcnt vmcnt(7)
    v_min_u32 v24, v24, v127
    v_max_u32 v25, v25, v127
    v_perm_b32 v127, v124, v125, s60
    v_perm_b32 v127, v127, v126, s61
    v_pk_add_f32 v[120:121], v[120:121], v[124:125]
    v_pk_add_f32 v[122:123], v[122:123], v[126:127]
    s_waitcnt vmcnt(6)
    v_min_u32 v24, v24, v131
    v_max_u32 v25, v25, v131
    v_perm_b32 v131, v128, v129, s60
    v_perm_b32 v131, v131, v130, s61
    v_pk_add_f32 v[120:121], v[120:121], v[128:129]
    v_pk_add_f32 v[122:123], v[122:123], v[130:131]
    s_waitcnt vmcnt(5)
    v_min_u32 v24, v24, v135
    v_max_u32 v25, v25, v135
    v_perm_b32 v135, v132, v133, s60
    v_perm_b32 v135, v135, v134, s61
    v_pk_add_f32 v[120:121], v[120:121], v[132:133]
    v_pk_add_f32 v[122:123], v[122:123], v[134:135]
    s_waitcnt vmcnt(4)
    v_min_u32 v24, v24, v139
    v_max_u32 v25, v25, v139
    v_perm_b32 v139, v136, v137, s60
    v_perm_b32 v139, v139, v138, s61
    v_pk_add_f32 v[120:121], v[120:121], v[136:137]
    v_pk_add_f32 v[122:123], v[122:123], v[138:139]
    s_waitcnt vmcnt(3)
    v_min_u32 v24, v24, v143
    v_max_u32 v25, v25, v143
    v_perm_b32 v143, v140, v141, s60
    v_perm_b32 v143, v143, v142, s61
    v_pk_add_f32 v[120:121], v[120:121], v[140:141]
    v_pk_add_f32 v[122:123], v[122:123], v[142:143]
    s_waitcnt vmcnt(2)
    v_min_u32 v24, v24, v147
    v_max_u32 v25, v25, v147
    v_perm_b32 v147, v144, v145, s60
    v_perm_b32 v147, v147, v146, s61
    v_pk_add_f32 v[120:121], v[120:121], v[144:145]
    v_pk_add_f32 v[122:123], v[122:123], v[146:147]
    s_waitcnt vmcnt(1)
    v_min_u32 v24, v24, v151
    v_max_u32 v25, v25, v151
    v_perm_b32 v151, v148, v149, s60
    v_perm_b32 v151, v151, v150, s61
    v_pk_add_f32 v[120:121], v[120:121], v[148:149]
    v_pk_add_f32 v[122:123], v[122:123], v[150:151]
    s_waitcnt vmcnt(0)
    v_min_u32 v24, v24, v155
    v_max_u32 v25, v25, v155
    v_cmp_eq_u32 vcc, s34, v24
    v_cmp_eq_u32 s[56:57], s34, v25
    v_perm_b32 v155, v152, v153, s60
    v_perm_b32 v155, v155, v154, s61
    v_pk_add_f32 v[120:121], v[120:121], v[152:153]
    v_pk_add_f32 v[122:123], v[122:123], v[154:155]
    s_and_b64 vcc, vcc, s[56:57]
    s_cmp_eq_u64 vcc, -1
    s_cbranch_scc1 .ipd_122
    s_sub_u32 s35, s35, 1
    s_cbranch_scc0 .ip_121
    s_branch .Lexit
.ipd_122:
    v_permlane32_swap_b32 v120, v122
    v_permlane32_swap_b32 v121, v123
    v_pk_add_f32 v[120:121], v[120:121], v[122:123]
    s_nop 1
    v_permlane16_swap_b32 v120, v121
    v_add_f32 v120, v120, v121
    s_nop 1
    v_add_f32_dpp v120, v120, v120 row_ror:8 row_mask:0xf bank_mask:0xf
    v_cvt_pk_bf16_f32 v120, v120, v120
    v_lshlrev_b32 v120, 16, v120
    v_mul_f32 v120, v120, v14
    v_cvt_pk_bf16_f32 v120, v120, v120
    v_lshlrev_b32 v120, 16, v120
    v_add_f32 v120, v120, v41
    v_cvt_pk_bf16_f32 v120, v120, v120
    v_lshlrev_b32 v120, 16, v120
    v_mul_f32 v120, v120, v81
    v_cvt_pk_bf16_f32 v120, v120, v120
    v_lshlrev_b32 v120, 16, v120
    v_add_f32 v120, v120, v40
    v_cvt_pk_bf16_f32 v120, v120, v120
    s_mov_b32 exec_lo, s62
    s_mov_b32 exec_hi, s62
    buffer_store_short v120, v7, s[48:51], s100 offen
    s_mov_b64 exec, -1
    s_or_b32 s56, s2, s3
    s_cmp_lg_u32 s56, 0
    s_cbranch_scc1 .Lexit
    v_mov_b32 v13, s34
    v_mov_b32 v12, 0
    s_mov_b64 exec, 1
    buffer_store_dword v13, v12, s[36:39], 0 offen
    s_mov_b64 exec, -1
    s_branch .Lexit
.Lbc:
    s_branch .Lsk_b0_0
.Lst_b0_0:
    s_branch .Lrt_b0_0
.Lsk_b0_0:
    s_sub_u32 s56, s65, 9
    s_mov_b32 s57, 0x63054210
    s_cmp_eq_u32 s65, 14
    s_cselect_b32 s56, s64, s56
    s_cselect_b32 s57, 0x37654210, s57
    s_cselect_b32 s99, 8, s64
    s_lshl_b32 s56, s56, 2
    s_lshr_b32 s56, s57, s56
    s_and_b32 s56, s56, 7
    s_cmp_eq_u32 s65, 17
    s_cselect_b32 s56, 7, s56
    s_lshl3_add_u32 s99, s99, s56
    s_and_b32 s56, s99, 7
    s_cmp_eq_u32 s56, 3
    s_mov_b32 s14, 0xb5b5b5b5
    s_cselect_b32 s14, 0x0, s14
    s_mov_b32 s15, 0xd6d6b6b6
    s_cselect_b32 s15, 0x0, s15
    s_cselect_b32 s30, -50, 0
    s_add_u32 s30, s30, 0
    s_add_u32 s30, s30, s70
    s_mov_b32 s31, s70
    s_mov_b32 s48, s18
    s_and_b32 s49, s19, 0xffff
    s_mov_b32 s50, 0x510000
    s_mov_b32 s51, 0x00020000
    s_mov_b32 s52, s20
    s_and_b32 s53, s21, 0xffff
    s_mov_b32 s54, 0x510000
    s_mov_b32 s55, 0x00020000
    v_bfe_u32 v12, v0, 4, 1
    s_and_b32 s56, s3, 3
    s_lshl_b32 s56, s56, 1
    v_or_b32 v12, s56, v12
    v_and_b32 v6, 7, v0
    v_xor_b32 v12, v12, v6
    v_lshrrev_b32 v6, 3, v0
    v_mul_u32_u24 v6, 9216, v6
    v_lshl_add_u32 v6, v12, 4, v6
    s_mul_i32 s100, s3, 73728
    s_lshl_b32 s56, s99, 7
    s_add_u32 s100, s100, s56
    s_lshl_b32 s101, s3, 10
    s_waitcnt lgkmcnt(0)
    s_add_u32 s34, s34, 1
    s_getreg_b32 s1, hwreg(HW_REG_XCC_ID)
    s_lshl_b32 s1, s1, 24
    s_add_u32 s1, s1, s34
    s_lshr_b32 s0, s2, 3
    s_lshl_b32 s63, s64, 8
    s_add_u32 s0, s0, s63
    s_lshl2_add_u32 s0, s0, 0x480000
    v_mov_b32 v30, s1
    s_cmp_eq_u32 s3, 0
    s_cselect_b64 exec, 1, 0
    buffer_store_dword v30, v2, s[36:39], s0 offen sc1
    s_mov_b64 exec, -1
    v_and_b32 v8, 1, v0
    v_lshlrev_b32 v8, 8, v8
    v_and_b32 v9, 0x3c, v0
    v_lshl_add_u32 v9, v9, 2, v8
    v_add_u32 v7, v9, v8
    v_and_b32 v9, 0x3c, v0
    v_lshrrev_b32 v8, 4, v8
    v_and_b32 v9, 4, v0
    v_lshl_add_u32 v9, v9, 3, v8
    s_lshl_b32 s58, s66, 14
    s_lshl_b32 s59, s67, 10
    s_add_u32 s58, s58, s59
    s_add_u32 s58, s58, 0x70000
    s_lshl4_add_u32 s59, s66, s67
    s_lshl_b32 s59, s59, 7
    s_add_u32 s59, s59, 0x430000
    s_bitcmp1_b64 s[14:15], 4
    s_cbranch_scc0 1
    s_waitcnt vmcnt(4)
    s_add_u32 s63, s69, 32768
    buffer_load_dwordx4 v[96:99], v1, s[40:43], s63 offen nt
    s_waitcnt vmcnt(6)
    s_add_u32 m0, s101, 0
    s_add_u32 s56, s100, 0
    buffer_load_dwordx4 v6, s[48:51], s56 offen nt lds
    s_waitcnt vmcnt(6)
    s_bitcmp1_b64 s[14:15], 5
    s_cbranch_scc0 1
    s_waitcnt vmcnt(4)
    s_add_u32 s63, s69, 40960
    buffer_load_dwordx4 v[100:103], v1, s[40:43], s63 offen nt
    s_waitcnt vmcnt(6)
    s_bitcmp1_b64 s[14:15], 6
    s_cbranch_scc0 1
    s_waitcnt vmcnt(2)
    s_add_u32 s63, s69, 49152
    buffer_load_dwordx4 v[128:131], v1, s[40:43], s63 offen nt
    s_cmp_eq_u32 s3, 0
    s_cbranch_scc1 .Lst_b1_0
    s_cmp_eq_u32 s3, 1
    s_cbranch_scc1 .Lst_b1_1
    s_cmp_eq_u32 s3, 2
    s_cbranch_scc1 .Lst_b1_2
    s_cmp_eq_u32 s3, 3
    s_cbranch_scc1 .Lst_b1_3
    s_cmp_eq_u32 s3, 4
    s_cbranch_scc1 .Lst_b1_4
    s_cmp_eq_u32 s3, 5
    s_cbranch_scc1 .Lst_b1_5
    s_cmp_eq_u32 s3, 6
    s_cbranch_scc1 .Lst_b1_6
    s_cmp_eq_u32 s3, 7
    s_cbranch_scc1 .Lst_b1_7
.Lrt_b1_0:
.Lrt_b1_1:
.Lrt_b1_2:
.Lrt_b1_3:
.Lrt_b1_4:
.Lrt_b1_5:
.Lrt_b1_6:
.Lrt_b1_7:
    s_waitcnt vmcnt(6)
    s_add_u32 m0, s101, 8192
    s_add_u32 s56, s100, 589824
    buffer_load_dwordx4 v6, s[48:51], s56 offen nt lds
    s_waitcnt vmcnt(4)
    s_bitcmp1_b64 s[14:15], 7
    s_cbranch_scc0 1
    s_waitcnt vmcnt(2)
    s_add_u32 s63, s69, 57344
    buffer_load_dwordx4 v[132:135], v1, s[40:43], s63 offen nt
    s_waitcnt vmcnt(4)
    s_bitcmp1_b64 s[14:15], 8
    s_cbranch_scc0 1
    s_waitcnt vmcnt(2)
    s_add_u32 s63, s69, 131072
    buffer_load_dwordx4 v[40:43], v1, s[40:43], s63 offen nt
    s_memrealtime s[8:9]
    s_waitcnt lgkmcnt(0)
    s_sub_u32 s8, s8, s30
    s_cmpk_ge_u32 s8, 437
    s_cbranch_scc1 .ap_123
    s_waitcnt vmcnt(5)
    s_cmpk_ge_u32 s8, 337
    s_cbranch_scc1 .ap_123
    s_waitcnt vmcnt(4)
    s_bitcmp1_b64 s[14:15], 9
    s_cbranch_scc0 1
    s_waitcnt vmcnt(2)
    s_cmpk_ge_u32 s8, 217
    s_cbranch_scc1 .ap_123
    s_waitcnt vmcnt(1)
.ap_123:
    s_add_u32 s63, s69, 139264
    buffer_load_dwordx4 v[44:47], v1, s[40:43], s63 offen nt
    s_memrealtime s[8:9]
    s_waitcnt lgkmcnt(0)
    s_sub_u32 s8, s8, s30
    s_cmpk_ge_u32 s8, 471
    s_cbranch_scc1 .ap_124
    s_waitcnt vmcnt(5)
    s_cmpk_ge_u32 s8, 371
    s_cbranch_scc1 .ap_124
    s_waitcnt vmcnt(4)
    s_bitcmp1_b64 s[14:15], 10
    s_cbranch_scc0 1
    s_waitcnt vmcnt(2)
    s_cmpk_ge_u32 s8, 251
    s_cbranch_scc1 .ap_124
    s_waitcnt vmcnt(1)
.ap_124:
    s_add_u32 s63, s69, 147456
    buffer_load_dwordx4 v[72:75], v1, s[40:43], s63 offen nt
    s_memrealtime s[8:9]
    s_waitcnt lgkmcnt(0)
    s_sub_u32 s8, s8, s30
    s_cmpk_ge_u32 s8, 505
    s_cbranch_scc1 .ap_125
    s_waitcnt vmcnt(5)
    s_cmpk_ge_u32 s8, 405
    s_cbranch_scc1 .ap_125
    s_waitcnt vmcnt(4)
    s_cmpk_ge_u32 s8, 285
    s_cbranch_scc1 .ap_125
    s_waitcnt vmcnt(1)
.ap_125:
    s_add_u32 m0, s101, 16384
    s_add_u32 s56, s100, 1179648
    buffer_load_dwordx4 v6, s[48:51], s56 offen nt lds
    s_memrealtime s[8:9]
    s_waitcnt lgkmcnt(0)
    s_sub_u32 s8, s8, s30
    s_cmpk_ge_u32 s8, 505
    s_cbranch_scc1 .ap_126
    s_waitcnt vmcnt(5)
    s_cmpk_ge_u32 s8, 405
    s_cbranch_scc1 .ap_126
    s_waitcnt vmcnt(4)
    s_bitcmp1_b64 s[14:15], 11
    s_cbranch_scc0 1
    s_waitcnt vmcnt(2)
    s_cmpk_ge_u32 s8, 285
    s_cbranch_scc1 .ap_126
    s_waitcnt vmcnt(1)
.ap_126:
    s_add_u32 s63, s69, 155648
    buffer_load_dwordx4 v[76:79], v1, s[40:43], s63 offen nt
    s_memrealtime s[8:9]
    s_waitcnt vmcnt(8)
    s_waitcnt lgkmcnt(0)
    s_sub_u32 s8, s8, s30
    s_cmpk_ge_u32 s8, 539
    s_cbranch_scc1 .ap_127
    s_waitcnt vmcnt(5)
    s_cmpk_ge_u32 s8, 439
    s_cbranch_scc1 .ap_127
    s_waitcnt vmcnt(4)
    s_bitcmp1_b64 s[14:15], 12
    s_cbranch_scc0 1
    s_waitcnt vmcnt(2)
    s_cmpk_ge_u32 s8, 319
    s_cbranch_scc1 .ap_127
    s_branch .Lsk_b0_1
.Lst_b0_1:
    s_branch .Lrt_b0_1
.Lsk_b0_1:
    s_waitcnt vmcnt(1)
.ap_127:
    s_add_u32 s63, s69, 163840
    buffer_load_dwordx4 v[104:107], v1, s[40:43], s63 offen nt
    v_and_b32 v157, 7, v0
    v_lshlrev_b32 v157, 2, v157
    s_mov_b32 s63, 0x4a1100
    buffer_load_dword v156, v157, s[36:39], s63 offen
    s_memrealtime s[8:9]
    s_waitcnt vmcnt(9)
    s_waitcnt lgkmcnt(0)
    s_sub_u32 s8, s8, s30
    s_cmpk_ge_u32 s8, 573
    s_cbranch_scc1 .ap_128
    s_waitcnt vmcnt(6)
    s_cmpk_ge_u32 s8, 473
    s_cbranch_scc1 .ap_128
    s_waitcnt vmcnt(5)
    s_bitcmp1_b64 s[14:15], 13
    s_cbranch_scc0 1
    s_waitcnt vmcnt(3)
    s_cmpk_ge_u32 s8, 353
    s_cbranch_scc1 .ap_128
    s_waitcnt vmcnt(2)
.ap_128:
    s_add_u32 s63, s69, 172032
    buffer_load_dwordx4 v[108:111], v1, s[40:43], s63 offen nt
    s_memrealtime s[8:9]
    s_waitcnt vmcnt(9)
    s_waitcnt lgkmcnt(0)
    s_sub_u32 s8, s8, s30
    s_cmpk_ge_u32 s8, 607
    s_cbranch_scc1 .ap_129
    s_waitcnt vmcnt(6)
    s_cmpk_ge_u32 s8, 507
    s_cbranch_scc1 .ap_129
    s_waitcnt vmcnt(5)
    s_bitcmp1_b64 s[14:15], 14
    s_cbranch_scc0 1
    s_waitcnt vmcnt(3)
    s_cmpk_ge_u32 s8, 387
    s_cbranch_scc1 .ap_129
    s_waitcnt vmcnt(2)
.ap_129:
    s_add_u32 s63, s69, 180224
    buffer_load_dwordx4 v[136:139], v1, s[40:43], s63 offen nt
    s_memrealtime s[8:9]
    s_waitcnt vmcnt(9)
    s_waitcnt lgkmcnt(0)
    s_sub_u32 s8, s8, s30
    s_cmpk_ge_u32 s8, 641
    s_cbranch_scc1 .ap_130
    s_waitcnt vmcnt(6)
    s_cmpk_ge_u32 s8, 541
    s_cbranch_scc1 .ap_130
    s_waitcnt vmcnt(5)
    s_cmpk_ge_u32 s8, 421
    s_cbranch_scc1 .ap_130
    s_waitcnt vmcnt(1)
.ap_130:
    s_add_u32 m0, s101, 24576
    s_add_u32 s56, s100, 1769472
    buffer_load_dwordx4 v6, s[48:51], s56 offen nt lds
    s_memrealtime s[8:9]
    s_waitcnt vmcnt(9)
    s_waitcnt lgkmcnt(0)
    s_sub_u32 s8, s8, s30
    s_cmpk_ge_u32 s8, 641
    s_cbranch_scc1 .ap_131
    s_waitcnt vmcnt(6)
    s_cmpk_ge_u32 s8, 541
    s_cbranch_scc1 .ap_131
    s_waitcnt vmcnt(5)
    s_bitcmp1_b64 s[14:15], 15
    s_cbranch_scc0 1
    s_waitcnt vmcnt(2)
    s_cmpk_ge_u32 s8, 421
    s_cbranch_scc1 .ap_131
    s_waitcnt vmcnt(1)
.ap_131:
    s_add_u32 s63, s69, 188416
    buffer_load_dwordx4 v[140:143], v1, s[40:43], s63 offen nt
    s_memrealtime s[8:9]
    s_waitcnt vmcnt(9)
    s_waitcnt lgkmcnt(0)
    s_sub_u32 s8, s8, s30
    s_cmpk_ge_u32 s8, 675
    s_cbranch_scc1 .ap_132
    s_waitcnt vmcnt(6)
    s_cmpk_ge_u32 s8, 575
    s_cbranch_scc1 .ap_132
    s_waitcnt vmcnt(5)
    s_bitcmp1_b64 s[14:15], 16
    s_cbranch_scc0 1
    s_waitcnt vmcnt(2)
    s_cmpk_ge_u32 s8, 455
    s_cbranch_scc1 .ap_132
    s_waitcnt vmcnt(1)
.ap_132:
    s_add_u32 s63, s69, 262144
    buffer_load_dwordx4 v[48:51], v1, s[40:43], s63 offen nt
    s_waitcnt vmcnt(5)
    s_sub_u32 s63, s70, 300
    v_subrev_u32 v156, s63, v156
    v_mov_b32 v157, 600
    v_cmp_lt_u32 s[8:9], v156, v157
    v_add_u32_dpp v156, v156, v156 quad_perm:[1,0,3,2] row_mask:0xf bank_mask:0xf
    s_nop 1
    v_add_u32_dpp v156, v156, v156 quad_perm:[2,3,0,1] row_mask:0xf bank_mask:0xf
    s_nop 1
    v_add_u32_dpp v156, v156, v156 row_ror:4 row_mask:0xf bank_mask:0xf
    s_nop 0
    v_readfirstlane_b32 s63, v156
    s_cmp_eq_u64 s[8:9], -1
    s_nop 3
    s_cbranch_scc0 .et_133
    s_lshr_b32 s63, s63, 3
    s_sub_u32 s63, s63, 300
    s_add_u32 s30, s30, s63
    s_add_u32 s31, s31, s63
.et_133:
    s_memrealtime s[8:9]
    s_waitcnt lgkmcnt(0)
    s_sub_u32 s8, s8, s30
    s_cmpk_ge_u32 s8, 709
    s_cbranch_scc1 .ap_134
    s_waitcnt vmcnt(5)
    s_cmpk_ge_u32 s8, 609
    s_cbranch_scc1 .ap_134
    s_waitcnt vmcnt(4)
    s_bitcmp1_b64 s[14:15], 17
    s_cbranch_scc0 1
    s_waitcnt vmcnt(2)
    s_cmpk_ge_u32 s8, 489
    s_cbranch_scc1 .ap_134
    s_waitcnt vmcnt(1)
.ap_134:
    s_add_u32 s63, s69, 270336
    buffer_load_dwordx4 v[52:55], v1, s[40:43], s63 offen nt
    s_memrealtime s[8:9]
    s_waitcnt lgkmcnt(0)
    s_sub_u32 s8, s8, s30
    s_cmpk_ge_u32 s8, 744
    s_cbranch_scc1 .ap_135
    s_waitcnt vmcnt(5)
    s_cmpk_ge_u32 s8, 644
    s_cbranch_scc1 .ap_135
    s_waitcnt vmcnt(4)
    s_bitcmp1_b64 s[14:15], 18
    s_cbranch_scc0 1
    s_waitcnt vmcnt(2)
    s_cmpk_ge_u32 s8, 524
    s_cbranch_scc1 .ap_135
    s_waitcnt vmcnt(1)
.ap_135:
    s_add_u32 s63, s69, 278528
    buffer_load_dwordx4 v[80:83], v1, s[40:43], s63 offen nt
    s_memrealtime s[8:9]
    s_waitcnt lgkmcnt(0)
    s_sub_u32 s8, s8, s30
    s_cmpk_ge_u32 s8, 779
    s_cbranch_scc1 .ap_136
    s_waitcnt vmcnt(5)
    s_cmpk_ge_u32 s8, 679
    s_cbranch_scc1 .ap_136
    s_waitcnt vmcnt(4)
    s_cmpk_ge_u32 s8, 559
    s_cbranch_scc1 .ap_136
    s_waitcnt vmcnt(1)
.ap_136:
    s_add_u32 m0, s101, 32768
    s_add_u32 s56, s100, 2359296
    buffer_load_dwordx4 v6, s[48:51], s56 offen nt lds
    s_memrealtime s[8:9]
    s_waitcnt lgkmcnt(0)
    s_sub_u32 s8, s8, s30
    s_cmpk_ge_u32 s8, 779
    s_cbranch_scc1 .ap_137
    s_waitcnt vmcnt(5)
    s_cmpk_ge_u32 s8, 679
    s_cbranch_scc1 .ap_137
    s_waitcnt vmcnt(4)
    s_bitcmp1_b64 s[14:15], 19
    s_cbranch_scc0 1
    s_waitcnt vmcnt(2)
    s_cmpk_ge_u32 s8, 559
    s_cbranch_scc1 .ap_137
    s_waitcnt vmcnt(1)
.ap_137:
    s_add_u32 s63, s69, 286720
    buffer_load_dwordx4 v[84:87], v1, s[40:43], s63 offen nt
    s_memrealtime s[8:9]
    s_waitcnt vmcnt(8)
    s_waitcnt lgkmcnt(0)
    s_sub_u32 s8, s8, s30
    s_cmpk_ge_u32 s8, 814
    s_cbranch_scc1 .ap_138
    s_waitcnt vmcnt(5)
    s_cmpk_ge_u32 s8, 714
    s_cbranch_scc1 .ap_138
    s_waitcnt vmcnt(4)
    s_bitcmp1_b64 s[14:15], 20
    s_cbranch_scc0 1
    s_waitcnt vmcnt(2)
    s_cmpk_ge_u32 s8, 594
    s_cbranch_scc1 .ap_138
    s_waitcnt vmcnt(1)
.ap_138:
    s_add_u32 s63, s69, 294912
    buffer_load_dwordx4 v[112:115], v1, s[40:43], s63 offen nt
    s_memrealtime s[8:9]
    s_waitcnt vmcnt(8)
    s_waitcnt lgkmcnt(0)
    s_sub_u32 s8, s8, s30
    s_cmpk_ge_u32 s8, 849
    s_cbranch_scc1 .ap_139
    s_waitcnt vmcnt(5)
    s_cmpk_ge_u32 s8, 749
    s_cbranch_scc1 .ap_139
    s_waitcnt vmcnt(4)
    s_bitcmp1_b64 s[14:15], 21
    s_cbranch_scc0 1
    s_waitcnt vmcnt(2)
    s_cmpk_ge_u32 s8, 629
    s_cbranch_scc1 .ap_139
    s_waitcnt vmcnt(1)
.ap_139:
    s_add_u32 s63, s69, 303104
    buffer_load_dwordx4 v[116:119], v1, s[40:43], s63 offen nt
    s_memrealtime s[8:9]
    s_waitcnt vmcnt(8)
    s_waitcnt lgkmcnt(0)
    s_sub_u32 s8, s8, s30
    s_cmpk_ge_u32 s8, 884
    s_cbranch_scc1 .ap_140
    s_waitcnt vmcnt(5)
    s_cmpk_ge_u32 s8, 784
    s_cbranch_scc1 .ap_140
    s_branch .Lsk_b0_2
.Lst_b0_2:
    s_branch .Lrt_b0_2
.Lsk_b0_2:
    s_waitcnt vmcnt(4)
    s_bitcmp1_b64 s[14:15], 22
    s_cbranch_scc0 1
    s_waitcnt vmcnt(2)
    s_cmpk_ge_u32 s8, 664
    s_cbranch_scc1 .ap_140
    s_waitcnt vmcnt(1)
.ap_140:
    s_add_u32 s63, s69, 311296
    buffer_load_dwordx4 v[144:147], v1, s[40:43], s63 offen nt
    s_memrealtime s[8:9]
    s_waitcnt vmcnt(8)
    s_waitcnt lgkmcnt(0)
    s_sub_u32 s8, s8, s30
    s_cmpk_ge_u32 s8, 919
    s_cbranch_scc1 .ap_141
    s_waitcnt vmcnt(5)
    s_cmpk_ge_u32 s8, 819
    s_cbranch_scc1 .ap_141
    s_waitcnt vmcnt(4)
    s_cmpk_ge_u32 s8, 699
    s_cbranch_scc1 .ap_141
    s_waitcnt vmcnt(1)
.ap_141:
    s_add_u32 m0, s101, 40960
    s_add_u32 s56, s100, 2949120
    buffer_load_dwordx4 v6, s[48:51], s56 offen nt lds
    s_memrealtime s[8:9]
    s_waitcnt vmcnt(8)
    s_waitcnt lgkmcnt(0)
    s_sub_u32 s8, s8, s30
    s_cmpk_ge_u32 s8, 919
    s_cbranch_scc1 .ap_142
    s_waitcnt vmcnt(5)
    s_cmpk_ge_u32 s8, 819
    s_cbranch_scc1 .ap_142
    s_waitcnt vmcnt(4)
    s_bitcmp1_b64 s[14:15], 23
    s_cbranch_scc0 1
    s_waitcnt vmcnt(2)
    s_cmpk_ge_u32 s8, 699
    s_cbranch_scc1 .ap_142
    s_waitcnt vmcnt(1)
.ap_142:
    s_add_u32 s63, s69, 319488
    buffer_load_dwordx4 v[148:151], v1, s[40:43], s63 offen nt
    s_memrealtime s[8:9]
    s_waitcnt vmcnt(8)
    s_waitcnt lgkmcnt(0)
    s_sub_u32 s8, s8, s30
    s_cmpk_ge_u32 s8, 954
    s_cbranch_scc1 .ap_143
    s_waitcnt vmcnt(5)
    s_cmpk_ge_u32 s8, 854
    s_cbranch_scc1 .ap_143
    s_waitcnt vmcnt(4)
    s_bitcmp1_b64 s[14:15], 24
    s_cbranch_scc0 1
    s_waitcnt vmcnt(2)
    s_cmpk_ge_u32 s8, 734
    s_cbranch_scc1 .ap_143
    s_waitcnt vmcnt(1)
.ap_143:
    s_add_u32 s63, s69, 393216
    buffer_load_dwordx4 v[56:59], v1, s[40:43], s63 offen nt
    s_memrealtime s[8:9]
    s_waitcnt vmcnt(8)
    s_waitcnt lgkmcnt(0)
    s_sub_u32 s8, s8, s30
    s_cmpk_ge_u32 s8, 990
    s_cbranch_scc1 .ap_144
    s_waitcnt vmcnt(5)
    s_cmpk_ge_u32 s8, 890
    s_cbranch_scc1 .ap_144
    s_waitcnt vmcnt(4)
    s_bitcmp1_b64 s[14:15], 25
    s_cbranch_scc0 1
    s_waitcnt vmcnt(2)
    s_cmpk_ge_u32 s8, 770
    s_cbranch_scc1 .ap_144
    s_waitcnt vmcnt(1)
.ap_144:
    s_add_u32 s63, s69, 401408
    buffer_load_dwordx4 v[60:63], v1, s[40:43], s63 offen nt
    s_memrealtime s[8:9]
    s_waitcnt vmcnt(8)
    s_waitcnt lgkmcnt(0)
    s_sub_u32 s8, s8, s30
    s_cmpk_ge_u32 s8, 1028
    s_cbranch_scc1 .ap_145
    s_waitcnt vmcnt(5)
    s_cmpk_ge_u32 s8, 928
    s_cbranch_scc1 .ap_145
    s_waitcnt vmcnt(4)
    s_bitcmp1_b64 s[14:15], 26
    s_cbranch_scc0 1
    s_waitcnt vmcnt(2)
    s_cmpk_ge_u32 s8, 808
    s_cbranch_scc1 .ap_145
    s_waitcnt vmcnt(1)
.ap_145:
    s_add_u32 s63, s69, 409600
    buffer_load_dwordx4 v[88:91], v1, s[40:43], s63 offen nt
    s_memrealtime s[8:9]
    s_waitcnt vmcnt(8)
    s_waitcnt lgkmcnt(0)
    s_sub_u32 s8, s8, s30
    s_cmpk_ge_u32 s8, 1067
    s_cbranch_scc1 .ap_146
    s_waitcnt vmcnt(5)
    s_cmpk_ge_u32 s8, 967
    s_cbranch_scc1 .ap_146
    s_waitcnt vmcnt(4)
    s_cmpk_ge_u32 s8, 847
    s_cbranch_scc1 .ap_146
    s_waitcnt vmcnt(1)
.ap_146:
    s_add_u32 m0, s101, 49152
    s_add_u32 s56, s100, 3538944
    buffer_load_dwordx4 v6, s[48:51], s56 offen nt lds
    s_memrealtime s[8:9]
    s_waitcnt vmcnt(8)
    s_waitcnt lgkmcnt(0)
    s_sub_u32 s8, s8, s30
    s_cmpk_ge_u32 s8, 1067
    s_cbranch_scc1 .ap_147
    s_waitcnt vmcnt(5)
    s_cmpk_ge_u32 s8, 967
    s_cbranch_scc1 .ap_147
    s_waitcnt vmcnt(4)
    s_bitcmp1_b64 s[14:15], 27
    s_cbranch_scc0 1
    s_waitcnt vmcnt(2)
    s_cmpk_ge_u32 s8, 847
    s_cbranch_scc1 .ap_147
    s_waitcnt vmcnt(1)
.ap_147:
    s_add_u32 s63, s69, 417792
    buffer_load_dwordx4 v[92:95], v1, s[40:43], s63 offen nt
    s_memrealtime s[8:9]
    s_waitcnt vmcnt(8)
    s_waitcnt lgkmcnt(0)
    s_sub_u32 s8, s8, s30
    s_cmpk_ge_u32 s8, 1106
    s_cbranch_scc1 .ap_148
    s_waitcnt vmcnt(5)
    s_cmpk_ge_u32 s8, 1006
    s_cbranch_scc1 .ap_148
    s_waitcnt vmcnt(4)
    s_bitcmp1_b64 s[14:15], 28
    s_cbranch_scc0 1
    s_waitcnt vmcnt(2)
    s_cmpk_ge_u32 s8, 886
    s_cbranch_scc1 .ap_148
    s_waitcnt vmcnt(1)
.ap_148:
    s_add_u32 s63, s69, 425984
    buffer_load_dwordx4 v[120:123], v1, s[40:43], s63 offen nt
    s_memrealtime s[8:9]
    s_waitcnt vmcnt(8)
    s_waitcnt lgkmcnt(0)
    s_sub_u32 s8, s8, s30
    s_cmpk_ge_u32 s8, 1145
    s_cbranch_scc1 .ap_149
    s_waitcnt vmcnt(5)
    s_cmpk_ge_u32 s8, 1045
    s_cbranch_scc1 .ap_149
    s_waitcnt vmcnt(4)
    s_bitcmp1_b64 s[14:15], 29
    s_cbranch_scc0 1
    s_waitcnt vmcnt(2)
    s_cmpk_ge_u32 s8, 925
    s_cbranch_scc1 .ap_149
    s_waitcnt vmcnt(1)
.ap_149:
    s_add_u32 s63, s69, 434176
    buffer_load_dwordx4 v[124:127], v1, s[40:43], s63 offen nt
    s_memrealtime s[8:9]
    s_waitcnt vmcnt(8)
    s_waitcnt lgkmcnt(0)
    s_sub_u32 s8, s8, s30
    s_cmpk_ge_u32 s8, 1184
    s_cbranch_scc1 .ap_150
    s_waitcnt vmcnt(5)
    s_cmpk_ge_u32 s8, 1084
    s_cbranch_scc1 .ap_150
    s_waitcnt vmcnt(4)
    s_bitcmp1_b64 s[14:15], 30
    s_cbranch_scc0 1
    s_waitcnt vmcnt(2)
    s_cmpk_ge_u32 s8, 964
    s_cbranch_scc1 .ap_150
    s_waitcnt vmcnt(1)
.ap_150:
    s_add_u32 s63, s69, 442368
    buffer_load_dwordx4 v[152:155], v1, s[40:43], s63 offen nt
    s_memrealtime s[8:9]
    s_waitcnt vmcnt(8)
    s_waitcnt lgkmcnt(0)
    s_sub_u32 s8, s8, s30
    s_cmpk_ge_u32 s8, 1223
    s_cbranch_scc1 .ap_151
    s_waitcnt vmcnt(5)
    s_cmpk_ge_u32 s8, 1123
    s_cbranch_scc1 .ap_151
    s_waitcnt vmcnt(4)
    s_cmpk_ge_u32 s8, 1003
    s_cbranch_scc1 .ap_151
    s_waitcnt vmcnt(1)
.ap_151:
    s_add_u32 m0, s101, 57344
    s_add_u32 s56, s100, 4128768
    buffer_load_dwordx4 v6, s[48:51], s56 offen nt lds
    s_memrealtime s[8:9]
    s_waitcnt vmcnt(8)
    s_waitcnt lgkmcnt(0)
    s_sub_u32 s8, s8, s30
    s_cmpk_ge_u32 s8, 1223
    s_cbranch_scc1 .ap_152
    s_waitcnt vmcnt(5)
    s_cmpk_ge_u32 s8, 1123
    s_cbranch_scc1 .ap_152
    s_waitcnt vmcnt(4)
    s_bitcmp1_b64 s[14:15], 31
    s_cbranch_scc0 1
    s_waitcnt vmcnt(2)
    s_cmpk_ge_u32 s8, 1003
    s_cbranch_scc1 .ap_152
    s_waitcnt vmcnt(1)
.ap_152:
    s_add_u32 s63, s69, 450560
    buffer_load_dwordx4 v[156:159], v1, s[40:43], s63 offen nt
    s_memrealtime s[8:9]
    s_waitcnt vmcnt(8)
    s_waitcnt lgkmcnt(0)
    s_sub_u32 s8, s8, s30
    s_cmpk_ge_u32 s8, 1262
    s_cbranch_scc1 .ap_153
    s_waitcnt vmcnt(5)
    s_cmpk_ge_u32 s8, 1162
    s_cbranch_scc1 .ap_153
    s_branch .Lsk_b0_3
.Lst_b0_3:
    s_branch .Lrt_b0_3
.Lsk_b0_3:
    s_waitcnt vmcnt(4)
    s_bitcmp1_b64 s[14:15], 32
    s_cbranch_scc0 1
    s_waitcnt vmcnt(2)
    s_cmpk_ge_u32 s8, 1042
    s_cbranch_scc1 .ap_153
    s_waitcnt vmcnt(1)
.ap_153:
    v_bfe_u32 v1, v0, 4, 2
    v_and_b32 v10, 0xf0, v2
    v_lshlrev_b32 v1, 2, v1
    v_bfe_u32 v1, s6, v1, 4
    v_lshl_add_u32 v1, v1, 8, v10
    s_add_u32 s63, s69, 0
    buffer_load_dwordx4 v[160:163], v1, s[44:47], s63 offen nt
    s_memrealtime s[8:9]
    s_waitcnt vmcnt(8)
    s_waitcnt lgkmcnt(0)
    s_sub_u32 s8, s8, s30
    s_cmpk_ge_u32 s8, 1298
    s_cbranch_scc1 .ap_154
    s_waitcnt vmcnt(5)
    s_cmpk_ge_u32 s8, 1198
    s_cbranch_scc1 .ap_154
    s_waitcnt vmcnt(4)
    s_bitcmp1_b64 s[14:15], 33
    s_cbranch_scc0 1
    s_waitcnt vmcnt(2)
    s_cmpk_ge_u32 s8, 1078
    s_cbranch_scc1 .ap_154
    s_waitcnt vmcnt(1)
.ap_154:
    s_add_u32 s63, s69, 8192
    buffer_load_dwordx4 v[164:167], v1, s[44:47], s63 offen nt
    s_memrealtime s[8:9]
    s_waitcnt vmcnt(8)
    s_waitcnt lgkmcnt(0)
    s_sub_u32 s8, s8, s30
    s_cmpk_ge_u32 s8, 1335
    s_cbranch_scc1 .ap_155
    s_waitcnt vmcnt(5)
    s_cmpk_ge_u32 s8, 1235
    s_cbranch_scc1 .ap_155
    s_waitcnt vmcnt(4)
    s_bitcmp1_b64 s[14:15], 34
    s_cbranch_scc0 1
    s_waitcnt vmcnt(2)
    s_cmpk_ge_u32 s8, 1115
    s_cbranch_scc1 .ap_155
    s_waitcnt vmcnt(1)
.ap_155:
    s_add_u32 s63, s69, 16384
    buffer_load_dwordx4 v[168:171], v1, s[44:47], s63 offen nt
    s_memrealtime s[8:9]
    s_waitcnt vmcnt(8)
    s_waitcnt lgkmcnt(0)
    s_sub_u32 s8, s8, s30
    s_cmpk_ge_u32 s8, 1371
    s_cbranch_scc1 .ap_156
    s_waitcnt vmcnt(5)
    s_cmpk_ge_u32 s8, 1271
    s_cbranch_scc1 .ap_156
    s_waitcnt vmcnt(4)
    s_cmpk_ge_u32 s8, 1151
    s_cbranch_scc1 .ap_156
    s_waitcnt vmcnt(1)
.ap_156:
    s_add_u32 m0, s101, 65536
    s_add_u32 s56, s100, 4718592
    buffer_load_dwordx4 v6, s[48:51], s56 offen nt lds
    s_memrealtime s[8:9]
    s_waitcnt vmcnt(8)
    s_waitcnt lgkmcnt(0)
    s_sub_u32 s8, s8, s30
    s_cmpk_ge_u32 s8, 1371
    s_cbranch_scc1 .ap_157
    s_waitcnt vmcnt(5)
    s_cmpk_ge_u32 s8, 1271
    s_cbranch_scc1 .ap_157
    s_waitcnt vmcnt(4)
    s_bitcmp1_b64 s[14:15], 35
    s_cbranch_scc0 1
    s_waitcnt vmcnt(2)
    s_cmpk_ge_u32 s8, 1151
    s_cbranch_scc1 .ap_157
    s_waitcnt vmcnt(1)
.ap_157:
    s_add_u32 s63, s69, 24576
    buffer_load_dwordx4 v[172:175], v1, s[44:47], s63 offen nt
    s_memrealtime s[8:9]
    s_waitcnt vmcnt(8)
    s_waitcnt lgkmcnt(0)
    s_sub_u32 s8, s8, s30
    s_cmpk_ge_u32 s8, 1408
    s_cbranch_scc1 .ap_158
    s_waitcnt vmcnt(5)
    s_cmpk_ge_u32 s8, 1308
    s_cbranch_scc1 .ap_158
    s_waitcnt vmcnt(4)
    s_bitcmp1_b64 s[14:15], 36
    s_cbranch_scc0 1
    s_waitcnt vmcnt(2)
    s_cmpk_ge_u32 s8, 1188
    s_cbranch_scc1 .ap_158
    s_waitcnt vmcnt(1)
.ap_158:
    s_add_u32 s63, s69, 32768
    buffer_load_dwordx4 v[176:179], v1, s[44:47], s63 offen nt
    buffer_load_dwordx4 v[16:19], v7, s[36:39], s58 offen offset:0 sc1
    buffer_load_dwordx4 v[20:23], v7, s[36:39], s58 offen offset:256 sc1
    s_memrealtime s[8:9]
    s_waitcnt vmcnt(8)
    s_waitcnt lgkmcnt(0)
    s_sub_u32 s8, s8, s30
    s_cmpk_ge_u32 s8, 1444
    s_cbranch_scc1 .ap_159
    s_waitcnt vmcnt(5)
    s_cmpk_ge_u32 s8, 1344
    s_cbranch_scc1 .ap_159
    s_waitcnt vmcnt(4)
    s_bitcmp1_b64 s[14:15], 37
    s_cbranch_scc0 1
    s_waitcnt vmcnt(2)
    s_cmpk_ge_u32 s8, 1224
    s_cbranch_scc1 .ap_159
    s_waitcnt vmcnt(1)
.ap_159:
    s_add_u32 s63, s69, 40960
    buffer_load_dwordx4 v[180:183], v1, s[44:47], s63 offen nt
    s_memrealtime s[8:9]
    s_waitcnt vmcnt(8)
    s_waitcnt lgkmcnt(0)
    s_sub_u32 s8, s8, s30
    s_cmpk_ge_u32 s8, 1481
    s_cbranch_scc1 .ap_160
    s_waitcnt vmcnt(5)
    s_cmpk_ge_u32 s8, 1381
    s_cbranch_scc1 .ap_160
    s_waitcnt vmcnt(4)
    s_bitcmp1_b64 s[14:15], 38
    s_cbranch_scc0 1
    s_waitcnt vmcnt(2)
    s_cmpk_ge_u32 s8, 1261
    s_cbranch_scc1 .ap_160
    s_waitcnt vmcnt(1)
.ap_160:
    s_add_u32 s63, s69, 49152
    buffer_load_dwordx4 v[184:187], v1, s[44:47], s63 offen nt
    s_memrealtime s[8:9]
    s_waitcnt vmcnt(8)
    s_waitcnt lgkmcnt(0)
    s_sub_u32 s8, s8, s30
    s_cmpk_ge_u32 s8, 1517
    s_cbranch_scc1 .ap_161
    s_waitcnt vmcnt(5)
    s_cmpk_ge_u32 s8, 1417
    s_cbranch_scc1 .ap_161
    s_waitcnt vmcnt(4)
    s_cmpk_ge_u32 s8, 1297
    s_cbranch_scc1 .ap_161
    s_waitcnt vmcnt(1)
.ap_161:
    s_add_u32 m0, s101, 73728
    s_add_u32 s56, s100, 0
    buffer_load_dwordx4 v6, s[52:55], s56 offen nt lds
    s_memrealtime s[8:9]
    s_waitcnt vmcnt(8)
    s_waitcnt lgkmcnt(0)
    s_sub_u32 s8, s8, s30
    s_cmpk_ge_u32 s8, 1517
    s_cbranch_scc1 .ap_162
    s_waitcnt vmcnt(5)
    s_cmpk_ge_u32 s8, 1417
    s_cbranch_scc1 .ap_162
    s_waitcnt vmcnt(4)
    s_bitcmp1_b64 s[14:15], 39
    s_cbranch_scc0 1
    s_waitcnt vmcnt(2)
    s_cmpk_ge_u32 s8, 1297
    s_cbranch_scc1 .ap_162
    s_waitcnt vmcnt(1)
.ap_162:
    s_add_u32 s63, s69, 57344
    buffer_load_dwordx4 v[188:191], v1, s[44:47], s63 offen nt
    s_memrealtime s[8:9]
    s_waitcnt vmcnt(8)
    s_waitcnt lgkmcnt(0)
    s_sub_u32 s8, s8, s30
    s_cmpk_ge_u32 s8, 1554
    s_cbranch_scc1 .ap_163
    s_waitcnt vmcnt(5)
    s_cmpk_ge_u32 s8, 1454
    s_cbranch_scc1 .ap_163
    s_waitcnt vmcnt(4)
    s_bitcmp1_b64 s[14:15], 40
    s_cbranch_scc0 1
    s_waitcnt vmcnt(2)
    s_cmpk_ge_u32 s8, 1334
    s_cbranch_scc1 .ap_163
    s_waitcnt vmcnt(1)
.ap_163:
    s_add_u32 s63, s69, 131072
    buffer_load_dwordx4 v[192:195], v1, s[44:47], s63 offen nt
    s_waitcnt vmcnt(5)
    s_branch .gpc_165
.gp_164:
    buffer_load_dwordx4 v[16:19], v7, s[36:39], s58 offen offset:0 sc1
    buffer_load_dwordx4 v[20:23], v7, s[36:39], s58 offen offset:256 sc1
    s_waitcnt vmcnt(0)
.gpc_165:
    v_min_u32 v10, v17, v19
    v_max_u32 v11, v17, v19
    v_min3_u32 v10, v10, v21, v23
    v_max3_u32 v11, v11, v21, v23
    v_cmp_eq_u32 vcc, s34, v10
    v_cmp_eq_u32 s[56:57], s34, v11
    s_and_b64 vcc, vcc, s[56:57]
    s_cmp_eq_u64 vcc, -1
    s_nop 2
    s_cbranch_scc1 .gpd_166
    s_sub_u32 s35, s35, 1
    s_cbranch_scc1 .Lexit
    s_sleep 1
    s_branch .gp_164
.gpd_166:
    s_mov_b32 vcc_lo, 0xcccccccc
    s_mov_b32 vcc_hi, 0xcccccccc
    v_cndmask_b32_e64 v24, v16, 0, vcc
    v_cndmask_b32_e64 v25, v18, 0, vcc
    v_cndmask_b32_e64 v26, v20, 0, vcc
    v_cndmask_b32_e64 v27, v22, 0, vcc
    v_cndmask_b32_e32 v28, 0, v16, vcc
    v_cndmask_b32_e32 v29, 0, v18, vcc
    s_branch .Lsk_b1_0
.Lst_b1_0:
    s_branch .Lrt_b1_0
.Lsk_b1_0:
    v_cndmask_b32_e32 v30, 0, v20, vcc
    v_cndmask_b32_e32 v31, 0, v22, vcc
    v_mfma_f32_16x16x32_bf16 v[16:19], v[32:35], v[24:27], 0
    v_mfma_f32_16x16x32_bf16 v[32:35], v[40:43], v[24:27], 0
    v_mfma_f32_16x16x32_bf16 v[16:19], v[36:39], v[28:31], v[16:19]
    v_mfma_f32_16x16x32_bf16 v[40:43], v[48:51], v[24:27], 0
    v_mfma_f32_16x16x32_bf16 v[32:35], v[44:47], v[28:31], v[32:35]
    v_mfma_f32_16x16x32_bf16 v[48:51], v[56:59], v[24:27], 0
    v_mfma_f32_16x16x32_bf16 v[40:43], v[52:55], v[28:31], v[40:43]
    v_mfma_f32_16x16x32_bf16 v[56:59], v[64:67], v[24:27], 0
    v_mfma_f32_16x16x32_bf16 v[48:51], v[60:63], v[28:31], v[48:51]
    s_nop 1
    v_add_f32_dpp v10, v17, v16 row_ror:12 row_mask:0xf bank_mask:0x1
    s_memrealtime s[8:9]
    s_waitcnt lgkmcnt(0)
    s_sub_u32 s8, s8, s30
    s_cmpk_ge_u32 s8, 1591
    s_nop 0
    s_cbranch_scc1 .ap_167
    s_waitcnt vmcnt(5)
    s_cmpk_ge_u32 s8, 1491
    s_cbranch_scc1 .ap_167
    s_waitcnt vmcnt(4)
    s_bitcmp1_b64 s[14:15], 41
    s_cbranch_scc0 1
    s_waitcnt vmcnt(2)
    s_cmpk_ge_u32 s8, 1371
    s_cbranch_scc1 .ap_167
    s_waitcnt vmcnt(1)
.ap_167:
    s_add_u32 s63, s69, 139264
    buffer_load_dwordx4 v[196:199], v1, s[44:47], s63 offen nt
    v_mfma_f32_16x16x32_bf16 v[64:67], v[72:75], v[24:27], 0
    v_mfma_f32_16x16x32_bf16 v[56:59], v[68:71], v[28:31], v[56:59]
    v_add_f32_dpp v11, v33, v32 row_ror:12 row_mask:0xf bank_mask:0x1
    v_add_f32_dpp v10, v18, v10 row_ror:8 row_mask:0xf bank_mask:0x1
    v_mfma_f32_16x16x32_bf16 v[72:75], v[80:83], v[24:27], 0
    v_mfma_f32_16x16x32_bf16 v[64:67], v[76:79], v[28:31], v[64:67]
    v_add_f32_dpp v12, v41, v40 row_ror:12 row_mask:0xf bank_mask:0x1
    v_add_f32_dpp v11, v34, v11 row_ror:8 row_mask:0xf bank_mask:0x1
    v_add_f32_dpp v10, v19, v10 row_ror:4 row_mask:0xf bank_mask:0x1
    v_mfma_f32_16x16x32_bf16 v[80:83], v[88:91], v[24:27], 0
    v_mfma_f32_16x16x32_bf16 v[72:75], v[84:87], v[28:31], v[72:75]
    v_add_f32_dpp v13, v49, v48 row_ror:12 row_mask:0xf bank_mask:0x1
    v_add_f32_dpp v12, v42, v12 row_ror:8 row_mask:0xf bank_mask:0x1
    v_add_f32_dpp v11, v35, v11 row_ror:4 row_mask:0xf bank_mask:0x1
    v_mfma_f32_16x16x32_bf16 v[88:91], v[96:99], v[24:27], 0
    v_mfma_f32_16x16x32_bf16 v[80:83], v[92:95], v[28:31], v[80:83]
    v_add_f32_dpp v10, v58, v57 row_ror:12 row_mask:0xf bank_mask:0x2
    v_add_f32_dpp v13, v50, v13 row_ror:8 row_mask:0xf bank_mask:0x1
    v_add_f32_dpp v12, v43, v12 row_ror:4 row_mask:0xf bank_mask:0x1
    s_memrealtime s[8:9]
    s_waitcnt lgkmcnt(0)
    s_sub_u32 s8, s8, s30
    s_cmpk_ge_u32 s8, 1602
    s_nop 0
    s_cbranch_scc1 .ap_168
    s_waitcnt vmcnt(5)
    s_cmpk_ge_u32 s8, 1502
    s_cbranch_scc1 .ap_168
    s_waitcnt vmcnt(4)
    s_bitcmp1_b64 s[14:15], 42
    s_cbranch_scc0 1
    s_waitcnt vmcnt(2)
    s_cmpk_ge_u32 s8, 1382
    s_cbranch_scc1 .ap_168
    s_waitcnt vmcnt(1)
.ap_168:
    s_add_u32 s63, s69, 147456
    buffer_load_dwordx4 v[200:203], v1, s[44:47], s63 offen nt
    s_memrealtime s[8:9]
    s_waitcnt lgkmcnt(0)
    s_sub_u32 s8, s8, s30
    s_cmpk_ge_u32 s8, 1613
    s_cbranch_scc1 .ap_169
    s_waitcnt vmcnt(5)
    s_cmpk_ge_u32 s8, 1513
    s_cbranch_scc1 .ap_169
    s_waitcnt vmcnt(4)
    s_cmpk_ge_u32 s8, 1393
    s_cbranch_scc1 .ap_169
    s_waitcnt vmcnt(1)
.ap_169:
    s_add_u32 m0, s101, 81920
    s_add_u32 s56, s100, 589824
    buffer_load_dwordx4 v6, s[52:55], s56 offen nt lds
    v_mfma_f32_16x16x32_bf16 v[96:99], v[104:107], v[24:27], 0
    v_mfma_f32_16x16x32_bf16 v[88:91], v[100:103], v[28:31], v[88:91]
    v_add_f32_dpp v11, v66, v65 row_ror:12 row_mask:0xf bank_mask:0x2
    v_add_f32_dpp v10, v59, v10 row_ror:8 row_mask:0xf bank_mask:0x2
    v_add_f32_dpp v13, v51, v13 row_ror:4 row_mask:0xf bank_mask:0x1
    v_mfma_f32_16x16x32_bf16 v[104:107], v[112:115], v[24:27], 0
    v_mfma_f32_16x16x32_bf16 v[96:99], v[108:111], v[28:31], v[96:99]
    v_add_f32_dpp v12, v74, v73 row_ror:12 row_mask:0xf bank_mask:0x2
    v_add_f32_dpp v11, v67, v11 row_ror:8 row_mask:0xf bank_mask:0x2
    v_add_f32_dpp v10, v56, v10 row_ror:4 row_mask:0xf bank_mask:0x2
    v_mfma_f32_16x16x32_bf16 v[112:115], v[120:123], v[24:27], 0
    v_mfma_f32_16x16x32_bf16 v[104:107], v[116:119], v[28:31], v[104:107]
    v_add_f32_dpp v13, v82, v81 row_ror:12 row_mask:0xf bank_mask:0x2
    v_add_f32_dpp v12, v75, v12 row_ror:8 row_mask:0xf bank_mask:0x2
    v_add_f32_dpp v11, v64, v11 row_ror:4 row_mask:0xf bank_mask:0x2
    v_mfma_f32_16x16x32_bf16 v[120:123], v[128:131], v[24:27], 0
    v_mfma_f32_16x16x32_bf16 v[112:115], v[124:127], v[28:31], v[112:115]
    v_add_f32_dpp v10, v91, v90 row_ror:12 row_mask:0xf bank_mask:0x4
    v_add_f32_dpp v13, v83, v13 row_ror:8 row_mask:0xf bank_mask:0x2
    v_add_f32_dpp v12, v72, v12 row_ror:4 row_mask:0xf bank_mask:0x2
    s_memrealtime s[8:9]
    s_waitcnt lgkmcnt(0)
    s_sub_u32 s8, s8, s30
    s_cmpk_ge_u32 s8, 1613
    s_nop 0
    s_cbranch_scc1 .ap_170
    s_waitcnt vmcnt(5)
    s_cmpk_ge_u32 s8, 1513
    s_cbranch_scc1 .ap_170
    s_waitcnt vmcnt(4)
    s_bitcmp1_b64 s[14:15], 43
    s_cbranch_scc0 1
    s_waitcnt vmcnt(2)
    s_cmpk_ge_u32 s8, 1393
    s_cbranch_scc1 .ap_170
    s_waitcnt vmcnt(1)
.ap_170:
    s_add_u32 s63, s69, 155648
    buffer_load_dwordx4 v[204:207], v1, s[44:47], s63 offen nt
    v_mfma_f32_16x16x32_bf16 v[128:131], v[136:139], v[24:27], 0
    v_mfma_f32_16x16x32_bf16 v[120:123], v[132:135], v[28:31], v[120:123]
    v_add_f32_dpp v11, v99, v98 row_ror:12 row_mask:0xf bank_mask:0x4
    v_add_f32_dpp v10, v88, v10 row_ror:8 row_mask:0xf bank_mask:0x4
    v_add_f32_dpp v13, v80, v13 row_ror:4 row_mask:0xf bank_mask:0x2
    v_mfma_f32_16x16x32_bf16 v[136:139], v[144:147], v[24:27], 0
    v_mfma_f32_16x16x32_bf16 v[128:131], v[140:143], v[28:31], v[128:131]
    v_add_f32_dpp v12, v107, v106 row_ror:12 row_mask:0xf bank_mask:0x4
    v_add_f32_dpp v11, v96, v11 row_ror:8 row_mask:0xf bank_mask:0x4
    v_add_f32_dpp v10, v89, v10 row_ror:4 row_mask:0xf bank_mask:0x4
    v_mfma_f32_16x16x32_bf16 v[144:147], v[152:155], v[24:27], 0
    v_mfma_f32_16x16x32_bf16 v[136:139], v[148:151], v[28:31], v[136:139]
    v_add_f32_dpp v13, v115, v114 row_ror:12 row_mask:0xf bank_mask:0x4
    v_add_f32_dpp v12, v104, v12 row_ror:8 row_mask:0xf bank_mask:0x4
    v_add_f32_dpp v11, v97, v11 row_ror:4 row_mask:0xf bank_mask:0x4
    v_mfma_f32_16x16x32_bf16 v[144:147], v[156:159], v[28:31], v[144:147]
    v_add_f32_dpp v10, v120, v123 row_ror:12 row_mask:0xf bank_mask:0x8
    v_add_f32_dpp v13, v112, v13 row_ror:8 row_mask:0xf bank_mask:0x4
    v_add_f32_dpp v12, v105, v12 row_ror:4 row_mask:0xf bank_mask:0x4
    s_memrealtime s[8:9]
    s_waitcnt vmcnt(8)
    s_waitcnt lgkmcnt(0)
    s_sub_u32 s8, s8, s30
    s_cmpk_ge_u32 s8, 1624
    s_cbranch_scc1 .ap_171
    s_waitcnt vmcnt(5)
    s_cmpk_ge_u32 s8, 1524
    s_cbranch_scc1 .ap_171
    s_waitcnt vmcnt(4)
    s_bitcmp1_b64 s[14:15], 44
    s_cbranch_scc0 1
    s_waitcnt vmcnt(2)
    s_cmpk_ge_u32 s8, 1404
    s_cbranch_scc1 .ap_171
    s_waitcnt vmcnt(1)
.ap_171:
    s_add_u32 s63, s69, 163840
    buffer_load_dwordx4 v[208:211], v1, s[44:47], s63 offen nt
    s_cmp_eq_u32 s3, 0
    s_cbranch_scc1 .Lst_b2_0
    s_cmp_eq_u32 s3, 1
    s_cbranch_scc1 .Lst_b2_1
    s_cmp_eq_u32 s3, 2
    s_cbranch_scc1 .Lst_b2_2
    s_cmp_eq_u32 s3, 3
    s_cbranch_scc1 .Lst_b2_3
.Lrt_b2_0:
.Lrt_b2_1:
.Lrt_b2_2:
.Lrt_b2_3:
    v_add_f32_dpp v11, v128, v131 row_ror:12 row_mask:0xf bank_mask:0x8
    v_add_f32_dpp v10, v121, v10 row_ror:8 row_mask:0xf bank_mask:0x8
    v_add_f32_dpp v13, v113, v13 row_ror:4 row_mask:0xf bank_mask:0x4
    v_add_f32_dpp v12, v136, v139 row_ror:12 row_mask:0xf bank_mask:0x8
    v_add_f32_dpp v11, v129, v11 row_ror:8 row_mask:0xf bank_mask:0x8
    v_add_f32_dpp v10, v122, v10 row_ror:4 row_mask:0xf bank_mask:0x8
    v_add_f32_dpp v13, v144, v147 row_ror:12 row_mask:0xf bank_mask:0x8
    v_add_f32_dpp v12, v137, v12 row_ror:8 row_mask:0xf bank_mask:0x8
    v_add_f32_dpp v11, v130, v11 row_ror:4 row_mask:0xf bank_mask:0x8
    v_add_f32_dpp v13, v145, v13 row_ror:8 row_mask:0xf bank_mask:0x8
    v_add_f32_dpp v12, v138, v12 row_ror:4 row_mask:0xf bank_mask:0x8
    s_branch .Lsk_b1_1
.Lst_b1_1:
    s_branch .Lrt_b1_1
.Lsk_b1_1:
    s_memrealtime s[8:9]
    s_waitcnt vmcnt(8)
    s_waitcnt lgkmcnt(0)
    s_sub_u32 s8, s8, s30
    s_cmpk_ge_u32 s8, 1636
    s_cbranch_scc1 .ap_172
    s_waitcnt vmcnt(5)
    s_cmpk_ge_u32 s8, 1536
    s_cbranch_scc1 .ap_172
    s_waitcnt vmcnt(4)
    s_bitcmp1_b64 s[14:15], 45
    s_cbranch_scc0 1
    s_waitcnt vmcnt(2)
    s_cmpk_ge_u32 s8, 1416
    s_cbranch_scc1 .ap_172
    s_waitcnt vmcnt(1)
.ap_172:
    s_add_u32 s63, s69, 172032
    buffer_load_dwordx4 v[212:215], v1, s[44:47], s63 offen nt
    v_add_f32_dpp v13, v146, v13 row_ror:4 row_mask:0xf bank_mask:0x8
    s_mov_b32 s60, 0x3db504f3
    s_mov_b32 s61, 0x3db504f3
    v_cvt_pk_bf16_f32 v10, v10, v11
    v_and_b32 v11, 0xffff0000, v10
    v_lshlrev_b32 v10, 16, v10
    v_cvt_pk_bf16_f32 v12, v12, v13
    v_and_b32 v13, 0xffff0000, v12
    v_lshlrev_b32 v12, 16, v12
    v_pk_mul_f32 v[10:11], v[10:11], s[60:61]
    v_pk_mul_f32 v[12:13], v[12:13], s[60:61]
    v_cvt_pk_bf16_f32 v10, v10, v11
    v_and_b32 v11, 0xffff0000, v10
    v_lshlrev_b32 v10, 16, v10
    v_cvt_pk_bf16_f32 v12, v12, v13
    v_and_b32 v13, 0xffff0000, v12
    v_lshlrev_b32 v12, 16, v12
    v_max_f32 v14, v10, v11
    v_max3_f32 v14, v14, v12, v13
    s_mov_b32 s60, 0x3fb8aa3b
    v_mov_b32 v22, s34
    v_mov_b32 v23, s34
    v_max_f32_dpp v14, v14, v14 quad_perm:[2,3,0,1] row_mask:0xf bank_mask:0xf
    s_nop 1
    v_max_f32_dpp v14, v14, v14 row_ror:4 row_mask:0xf bank_mask:0xf
    s_nop 1
    v_max_f32_dpp v14, v14, v14 row_ror:8 row_mask:0xf bank_mask:0xf
    v_mov_b32 v15, v14
    s_nop 1
    v_permlane16_swap_b32 v15, v14
    v_max_f32 v14, v15, v14
    v_mov_b32 v15, v14
    s_nop 1
    v_permlane32_swap_b32 v15, v14
    v_max_f32 v14, v15, v14
    v_mul_f32 v15, 0xbfb8aa3b, v14
    v_fma_f32 v10, v10, s60, v15
    v_fma_f32 v11, v11, s60, v15
    v_fma_f32 v12, v12, s60, v15
    v_fma_f32 v13, v13, s60, v15
    v_exp_f32 v10, v10
    v_exp_f32 v11, v11
    v_exp_f32 v12, v12
    v_exp_f32 v13, v13
    v_mov_b32 v20, v14
    v_pk_add_f32 v[16:17], v[10:11], v[12:13]
    v_add_f32 v21, v16, v17
    s_lshl_b32 s60, s68, 5
    s_lshl_b32 s61, s3, 4
    s_add_u32 s61, s61, 159104
    v_add_u32 v16, s61, v3
    v_mov_b32 v17, 159232
    v_mov_b32 v18, 1
    s_add_u32 s60, s60, s59
    v_add_f32_dpp v21, v21, v21 quad_perm:[2,3,0,1] row_mask:0xf bank_mask:0xf
    s_nop 1
    v_add_f32_dpp v21, v21, v21 row_ror:4 row_mask:0xf bank_mask:0xf
    s_nop 1
    v_add_f32_dpp v21, v21, v21 row_ror:8 row_mask:0xf bank_mask:0xf
    v_mov_b32 v15, v21
    s_nop 1
    v_permlane16_swap_b32 v15, v21
    v_add_f32 v21, v15, v21
    v_mov_b32 v15, v21
    s_nop 1
    v_permlane32_swap_b32 v15, v21
    v_add_f32 v21, v15, v21
    s_mov_b64 exec, 3
    ds_write_b64 v16, v[20:21]
    s_mov_b64 exec, 1
    ds_add_rtn_u32 v18, v17, v18
    s_mov_b64 exec, -1
    v_and_b32 v16, 0x78, v3
    v_or_b32 v16, 159104, v16
    s_waitcnt lgkmcnt(0)
    v_readfirstlane_b32 s61, v18
    s_cmp_eq_u32 s61, 7
    s_nop 3
    s_cbranch_scc0 .mlc_173
    ds_read_b64 v[18:19], v16
    s_waitcnt lgkmcnt(0)
    v_mov_b32 v20, v18
    s_nop 1
    v_max_f32_dpp v20, v20, v20 quad_perm:[2,3,0,1] row_mask:0xf bank_mask:0xf
    s_nop 1
    v_max_f32_dpp v20, v20, v20 row_ror:4 row_mask:0xf bank_mask:0xf
    s_nop 1
    v_max_f32_dpp v20, v20, v20 row_ror:8 row_mask:0xf bank_mask:0xf
    v_sub_f32 v18, v18, v20
    v_mul_f32 v18, 0x3fb8aa3b, v18
    v_exp_f32 v18, v18
    s_nop 0
    v_mul_f32 v21, v18, v19
    s_nop 1
    v_add_f32_dpp v21, v21, v21 quad_perm:[2,3,0,1] row_mask:0xf bank_mask:0xf
    s_nop 1
    v_add_f32_dpp v21, v21, v21 row_ror:4 row_mask:0xf bank_mask:0xf
    s_nop 1
    v_add_f32_dpp v21, v21, v21 row_ror:8 row_mask:0xf bank_mask:0xf
    s_mov_b64 exec, 3
    buffer_store_dwordx4 v[20:23], v2, s[36:39], s60 offen sc1
    s_mov_b64 exec, -1
.mlc_173:
    s_memrealtime s[8:9]
    s_waitcnt vmcnt(8)
    s_waitcnt lgkmcnt(0)
    s_sub_u32 s8, s8, s30
    s_cmpk_ge_u32 s8, 1668
    s_cbranch_scc1 .ap_174
    s_waitcnt vmcnt(5)
    s_cmpk_ge_u32 s8, 1568
    s_cbranch_scc1 .ap_174
    s_waitcnt vmcnt(4)
    s_bitcmp1_b64 s[14:15], 46
    s_cbranch_scc0 1
    s_waitcnt vmcnt(2)
    s_cmpk_ge_u32 s8, 1448
    s_cbranch_scc1 .ap_174
    s_waitcnt vmcnt(1)
.ap_174:
    s_add_u32 s63, s69, 180224
    buffer_load_dwordx4 v[216:219], v1, s[44:47], s63 offen nt
    s_memrealtime s[8:9]
    s_waitcnt vmcnt(8)
    s_waitcnt lgkmcnt(0)
    s_sub_u32 s8, s8, s30
    s_cmpk_ge_u32 s8, 1700
    s_cbranch_scc1 .ap_175
    s_waitcnt vmcnt(5)
    s_cmpk_ge_u32 s8, 1600
    s_cbranch_scc1 .ap_175
    s_waitcnt vmcnt(4)
    s_bitcmp1_b64 s[14:15], 47
    s_cbranch_scc0 1
    s_waitcnt vmcnt(2)
    s_cmpk_ge_u32 s8, 1480
    s_cbranch_scc1 .ap_175
    s_waitcnt vmcnt(1)
.ap_175:
    s_add_u32 s63, s69, 188416
    s_branch .Lsk_b1_2
.Lst_b1_2:
    s_branch .Lrt_b1_2
.Lsk_b1_2:
    buffer_load_dwordx4 v[220:223], v1, s[44:47], s63 offen nt
    s_and_b32 s56, s64, 0
    s_mul_i32 s56, s56, 18432
    s_mul_i32 s57, s3, 2304
    s_add_u32 s56, s56, s57
    s_add_u32 s56, s56, 0x37000
    buffer_load_dwordx4 v[32:35], v2, s[36:39], s56 offen offset:0 sc1
    buffer_load_dwordx4 v[40:43], v2, s[36:39], s56 offen offset:1024 sc1
    buffer_load_dwordx2 v[48:49], v5, s[36:39], s56 offen offset:0 sc1
    s_memrealtime s[8:9]
    s_waitcnt vmcnt(11)
    s_waitcnt lgkmcnt(0)
    s_sub_u32 s8, s8, s30
    s_cmpk_ge_u32 s8, 1732
    s_cbranch_scc1 .ap_176
    s_waitcnt vmcnt(8)
    s_cmpk_ge_u32 s8, 1632
    s_cbranch_scc1 .ap_176
    s_waitcnt vmcnt(7)
    s_bitcmp1_b64 s[14:15], 48
    s_cbranch_scc0 1
    s_waitcnt vmcnt(5)
    s_cmpk_ge_u32 s8, 1512
    s_cbranch_scc1 .ap_176
    s_waitcnt vmcnt(4)
.ap_176:
    s_add_u32 s63, s69, 262144
    buffer_load_dwordx4 v[224:227], v1, s[44:47], s63 offen nt
    s_memrealtime s[8:9]
    s_waitcnt vmcnt(11)
    s_waitcnt lgkmcnt(0)
    s_sub_u32 s8, s8, s30
    s_cmpk_ge_u32 s8, 1764
    s_cbranch_scc1 .ap_177
    s_waitcnt vmcnt(8)
    s_cmpk_ge_u32 s8, 1664
    s_cbranch_scc1 .ap_177
    s_waitcnt vmcnt(7)
    s_bitcmp1_b64 s[14:15], 49
    s_cbranch_scc0 1
    s_waitcnt vmcnt(5)
    s_cmpk_ge_u32 s8, 1544
    s_cbranch_scc1 .ap_177
    s_waitcnt vmcnt(4)
.ap_177:
    s_add_u32 s63, s69, 270336
    buffer_load_dwordx4 v[228:231], v1, s[44:47], s63 offen nt
    s_and_b32 s56, s64, 0
    s_mul_i32 s56, s56, 18432
    s_mul_i32 s57, s3, 2304
    s_add_u32 s56, s56, s57
    s_add_u32 s56, s56, 0x49000
    buffer_load_dwordx4 v[56:59], v2, s[36:39], s56 offen offset:0 sc1
    buffer_load_dwordx4 v[64:67], v2, s[36:39], s56 offen offset:1024 sc1
    buffer_load_dwordx2 v[72:73], v5, s[36:39], s56 offen offset:0 sc1
    s_memrealtime s[8:9]
    s_waitcnt vmcnt(14)
    s_waitcnt lgkmcnt(0)
    s_sub_u32 s8, s8, s30
    s_cmpk_ge_u32 s8, 1796
    s_cbranch_scc1 .ap_178
    s_waitcnt vmcnt(11)
    s_cmpk_ge_u32 s8, 1696
    s_cbranch_scc1 .ap_178
    s_waitcnt vmcnt(10)
    s_bitcmp1_b64 s[14:15], 50
    s_cbranch_scc0 1
    s_waitcnt vmcnt(8)
    s_cmpk_ge_u32 s8, 1576
    s_cbranch_scc1 .ap_178
    s_waitcnt vmcnt(4)
.ap_178:
    s_add_u32 s63, s69, 278528
    buffer_load_dwordx4 v[232:235], v1, s[44:47], s63 offen nt
    s_memrealtime s[8:9]
    s_waitcnt vmcnt(14)
    s_waitcnt lgkmcnt(0)
    s_sub_u32 s8, s8, s30
    s_cmpk_ge_u32 s8, 1828
    s_cbranch_scc1 .ap_179
    s_waitcnt vmcnt(11)
    s_cmpk_ge_u32 s8, 1728
    s_cbranch_scc1 .ap_179
    s_waitcnt vmcnt(10)
    s_bitcmp1_b64 s[14:15], 51
    s_cbranch_scc0 1
    s_waitcnt vmcnt(5)
    s_cmpk_ge_u32 s8, 1608
    s_cbranch_scc1 .ap_179
    s_waitcnt vmcnt(4)
.ap_179:
    s_add_u32 s63, s69, 286720
    buffer_load_dwordx4 v[236:239], v1, s[44:47], s63 offen nt
    s_memrealtime s[8:9]
    s_waitcnt vmcnt(14)
    s_waitcnt lgkmcnt(0)
    s_sub_u32 s8, s8, s30
    s_cmpk_ge_u32 s8, 1860
    s_cbranch_scc1 .ap_180
    s_waitcnt vmcnt(11)
    s_cmpk_ge_u32 s8, 1760
    s_cbranch_scc1 .ap_180
    s_waitcnt vmcnt(10)
    s_bitcmp1_b64 s[14:15], 52
    s_cbranch_scc0 1
    s_waitcnt vmcnt(5)
    s_cmpk_ge_u32 s8, 1640
    s_cbranch_scc1 .ap_180
    s_waitcnt vmcnt(1)
.ap_180:
    s_add_u32 s63, s69, 294912
    buffer_load_dwordx4 v[240:243], v1, s[44:47], s63 offen nt
    s_memrealtime s[8:9]
    s_waitcnt vmcnt(14)
    s_waitcnt lgkmcnt(0)
    s_sub_u32 s8, s8, s30
    s_cmpk_ge_u32 s8, 1892
    s_cbranch_scc1 .ap_181
    s_waitcnt vmcnt(11)
    s_cmpk_ge_u32 s8, 1792
    s_cbranch_scc1 .ap_181
    s_waitcnt vmcnt(7)
    s_bitcmp1_b64 s[14:15], 53
    s_cbranch_scc0 1
    s_waitcnt vmcnt(2)
    s_cmpk_ge_u32 s8, 1672
    s_cbranch_scc1 .ap_181
    s_waitcnt vmcnt(1)
.ap_181:
    s_add_u32 s63, s69, 303104
    buffer_load_dwordx4 v[244:247], v1, s[44:47], s63 offen nt
    s_and_b32 s0, s0, 0xffffff80
    s_sub_u32 s0, s0, 1024
    buffer_load_dword v28, v4, s[36:39], s0 offen sc1
    buffer_load_dwordx4 v[24:27], v9, s[36:39], s59 offen offset:0 sc1
    s_memrealtime s[8:9]
    s_waitcnt vmcnt(15)
    s_waitcnt lgkmcnt(0)
    s_sub_u32 s8, s8, s30
    s_cmpk_ge_u32 s8, 1924
    s_cbranch_scc1 .ap_182
    s_waitcnt vmcnt(9)
    s_cmpk_ge_u32 s8, 1824
    s_cbranch_scc1 .ap_182
    s_waitcnt vmcnt(5)
    s_bitcmp1_b64 s[14:15], 54
    s_cbranch_scc0 1
    s_waitcnt vmcnt(3)
    s_cmpk_ge_u32 s8, 1704
    s_cbranch_scc1 .ap_182
    s_waitcnt vmcnt(2)
.ap_182:
    s_add_u32 s63, s69, 311296
    buffer_load_dwordx4 v[248:251], v1, s[44:47], s63 offen nt
    s_memrealtime s[8:9]
    s_waitcnt vmcnt(15)
    s_waitcnt lgkmcnt(0)
    s_sub_u32 s8, s8, s30
    s_cmpk_ge_u32 s8, 1956
    s_cbranch_scc1 .ap_183
    s_waitcnt vmcnt(6)
    s_cmpk_ge_u32 s8, 1856
    s_cbranch_scc1 .ap_183
    s_waitcnt vmcnt(5)
    s_bitcmp1_b64 s[14:15], 55
    s_cbranch_scc0 1
    s_waitcnt vmcnt(3)
    s_cmpk_ge_u32 s8, 1736
    s_cbranch_scc1 .ap_183
    s_waitcnt vmcnt(1)
.ap_183:
    s_add_u32 s63, s69, 319488
    buffer_load_dwordx4 v[252:255], v1, s[44:47], s63 offen nt
    s_memrealtime s[8:9]
    s_waitcnt vmcnt(12)
    s_waitcnt lgkmcnt(0)
    s_sub_u32 s8, s8, s30
    s_cmpk_ge_u32 s8, 1988
    s_cbranch_scc1 .ap_184
    s_waitcnt vmcnt(6)
    s_cmpk_ge_u32 s8, 1888
    s_cbranch_scc1 .ap_184
    s_waitcnt vmcnt(5)
    s_bitcmp1_b64 s[14:15], 56
    s_cbranch_scc0 1
    s_waitcnt vmcnt(2)
    s_cmpk_ge_u32 s8, 1768
    s_cbranch_scc1 .ap_184
    s_waitcnt vmcnt(1)
.ap_184:
    s_add_u32 s63, s69, 393216
    buffer_load_dwordx4 v[36:39], v1, s[44:47], s63 offen nt
    s_memrealtime s[8:9]
    s_waitcnt vmcnt(12)
    s_waitcnt lgkmcnt(0)
    s_sub_u32 s8, s8, s30
    s_cmpk_ge_u32 s8, 2020
    s_cbranch_scc1 .ap_185
    s_waitcnt vmcnt(6)
    s_cmpk_ge_u32 s8, 1920
    s_cbranch_scc1 .ap_185
    s_waitcnt vmcnt(5)
    s_bitcmp1_b64 s[14:15], 57
    s_cbranch_scc0 1
    s_waitcnt vmcnt(2)
    s_cmpk_ge_u32 s8, 1800
    s_cbranch_scc1 .ap_185
    s_waitcnt vmcnt(1)
.ap_185:
    s_add_u32 s63, s69, 401408
    buffer_load_dwordx4 v[44:47], v1, s[44:47], s63 offen nt
    s_memrealtime s[8:9]
    s_waitcnt vmcnt(9)
    s_waitcnt lgkmcnt(0)
    s_sub_u32 s8, s8, s30
    s_cmpk_ge_u32 s8, 2052
    s_cbranch_scc1 .ap_186
    s_waitcnt vmcnt(6)
    s_cmpk_ge_u32 s8, 1952
    s_cbranch_scc1 .ap_186
    s_waitcnt vmcnt(4)
    s_bitcmp1_b64 s[14:15], 58
    s_cbranch_scc0 1
    s_waitcnt vmcnt(2)
    s_cmpk_ge_u32 s8, 1832
    s_cbranch_scc1 .ap_186
    s_waitcnt vmcnt(1)
.ap_186:
    s_add_u32 s63, s69, 409600
    buffer_load_dwordx4 v[52:55], v1, s[44:47], s63 offen nt
    s_branch .Lsk_b1_3
.Lst_b1_3:
    s_branch .Lrt_b1_3
.Lsk_b1_3:
    s_waitcnt vmcnt(5)
    s_branch .gpc_188
.gp_187:
    buffer_load_dwordx4 v[24:27], v9, s[36:39], s59 offen offset:0 sc1
    s_waitcnt vmcnt(0)
.gpc_188:
    v_cmp_eq_u32 vcc, s34, v26
    s_cmp_eq_u64 vcc, -1
    s_nop 3
    s_cbranch_scc1 .gpd_189
    s_sub_u32 s35, s35, 1
    s_cbranch_scc1 .Lexit
    s_sleep 1
    s_branch .gp_187
.gpd_189:
    v_cmp_eq_u32 vcc, s1, v28
    s_cmp_eq_u64 vcc, -1
    s_cselect_b32 s0, 0x800000, 0
    v_mov_b32 v16, v24
    s_nop 1
    v_max_f32_dpp v16, v16, v16 row_ror:4 row_mask:0xf bank_mask:0xf
    v_sub_f32 v17, v24, v16
    v_sub_f32 v18, v14, v16
    v_mul_f32 v17, 0x3fb8aa3b, v17
    v_mul_f32 v18, 0x3fb8aa3b, v18
    v_exp_f32 v17, v17
    v_exp_f32 v18, v18
    v_mul_f32 v17, v17, v25
    s_nop 1
    v_add_f32_dpp v17, v17, v17 row_ror:4 row_mask:0xf bank_mask:0xf
    v_rcp_f32 v19, v17
    s_nop 0
    v_fma_f32 v15, -v17, v19, 1.0
    v_fma_f32 v19, v15, v19, v19
    v_mul_f32 v18, v18, v19
    v_mul_f32 v10, v10, v18
    v_mul_f32 v11, v11, v18
    v_mul_f32 v12, v12, v18
    v_mul_f32 v13, v13, v18
    v_mov_b32_dpp v112, v10 quad_perm:[2,3,0,1] row_mask:0xf bank_mask:0xf
    v_mov_b32_dpp v113, v11 quad_perm:[2,3,0,1] row_mask:0xf bank_mask:0xf
    v_mov_b32_dpp v114, v12 quad_perm:[2,3,0,1] row_mask:0xf bank_mask:0xf
    v_mov_b32_dpp v115, v13 quad_perm:[2,3,0,1] row_mask:0xf bank_mask:0xf
    v_cvt_pk_bf16_f32 v96, v10, v112
    v_cvt_pk_bf16_f32 v100, v11, v113
    v_cvt_pk_bf16_f32 v104, v12, v114
    v_cvt_pk_bf16_f32 v108, v13, v115
    v_mov_b32_dpp v97, v96 row_ror:12 row_mask:0xf bank_mask:0xf
    v_mov_b32_dpp v101, v100 row_ror:12 row_mask:0xf bank_mask:0xf
    v_mov_b32_dpp v105, v104 row_ror:12 row_mask:0xf bank_mask:0xf
    v_mov_b32_dpp v109, v108 row_ror:12 row_mask:0xf bank_mask:0xf
    v_mov_b32_dpp v98, v96 row_ror:8 row_mask:0xf bank_mask:0xf
    v_mov_b32_dpp v102, v100 row_ror:8 row_mask:0xf bank_mask:0xf
    v_mov_b32_dpp v106, v104 row_ror:8 row_mask:0xf bank_mask:0xf
    v_mov_b32_dpp v110, v108 row_ror:8 row_mask:0xf bank_mask:0xf
    v_mov_b32_dpp v99, v96 row_ror:4 row_mask:0xf bank_mask:0xf
    v_mov_b32_dpp v103, v100 row_ror:4 row_mask:0xf bank_mask:0xf
    v_mov_b32_dpp v107, v104 row_ror:4 row_mask:0xf bank_mask:0xf
    v_mov_b32_dpp v111, v108 row_ror:4 row_mask:0xf bank_mask:0xf
    s_lshl_b32 s60, s3, 10
    s_add_u32 s60, s60, 147456
    v_lshlrev_b32 v10, 5, v0
    v_add_u32 v10, s60, v10
    s_memrealtime s[8:9]
    s_waitcnt lgkmcnt(0)
    s_sub_u32 s8, s8, s30
    s_cmpk_ge_u32 s8, 2084
    s_cbranch_scc1 .ap_190
    s_waitcnt vmcnt(5)
    s_cmpk_ge_u32 s8, 1984
    s_cbranch_scc1 .ap_190
    s_waitcnt vmcnt(4)
    s_bitcmp1_b64 s[14:15], 59
    s_cbranch_scc0 1
    s_waitcnt vmcnt(2)
    s_cmpk_ge_u32 s8, 1864
    s_cbranch_scc1 .ap_190
    s_waitcnt vmcnt(1)
.ap_190:
    s_add_u32 s63, s69, 417792
    buffer_load_dwordx4 v[60:63], v1, s[44:47], s63 offen nt
    v_perm_b32 v112, v164, v160, s94
    v_perm_b32 v113, v172, v168, s94
    v_perm_b32 v114, v180, v176, s94
    v_perm_b32 v115, v188, v184, s94
    s_nop 1
    v_mfma_f32_16x16x32_bf16 v[128:131], v[96:99], v[112:115], 0
    v_perm_b32 v116, v164, v160, s95
    v_perm_b32 v117, v172, v168, s95
    v_perm_b32 v118, v180, v176, s95
    v_perm_b32 v119, v188, v184, s95
    s_nop 1
    v_mfma_f32_16x16x32_bf16 v[132:135], v[96:99], v[116:119], 0
    v_perm_b32 v120, v165, v161, s94
    v_perm_b32 v121, v173, v169, s94
    v_perm_b32 v122, v181, v177, s94
    v_perm_b32 v123, v189, v185, s94
    s_nop 1
    v_mfma_f32_16x16x32_bf16 v[136:139], v[96:99], v[120:123], 0
    v_perm_b32 v124, v165, v161, s95
    v_perm_b32 v125, v173, v169, s95
    v_perm_b32 v126, v181, v177, s95
    v_perm_b32 v127, v189, v185, s95
    s_nop 1
    v_mfma_f32_16x16x32_bf16 v[140:143], v[96:99], v[124:127], 0
    v_perm_b32 v112, v166, v162, s94
    v_perm_b32 v113, v174, v170, s94
    v_perm_b32 v114, v182, v178, s94
    v_perm_b32 v115, v190, v186, s94
    s_nop 1
    v_mfma_f32_16x16x32_bf16 v[144:147], v[96:99], v[112:115], 0
    v_perm_b32 v116, v166, v162, s95
    v_perm_b32 v117, v174, v170, s95
    v_perm_b32 v118, v182, v178, s95
    v_perm_b32 v119, v190, v186, s95
    s_nop 1
    v_mfma_f32_16x16x32_bf16 v[148:151], v[96:99], v[116:119], 0
    v_perm_b32 v120, v167, v163, s94
    v_perm_b32 v121, v175, v171, s94
    v_perm_b32 v122, v183, v179, s94
    v_perm_b32 v123, v191, v187, s94
    s_nop 1
    v_mfma_f32_16x16x32_bf16 v[152:155], v[96:99], v[120:123], 0
    v_perm_b32 v124, v167, v163, s95
    v_perm_b32 v125, v175, v171, s95
    v_perm_b32 v126, v183, v179, s95
    v_perm_b32 v127, v191, v187, s95
    s_nop 1
    v_mfma_f32_16x16x32_bf16 v[156:159], v[96:99], v[124:127], 0
    s_memrealtime s[8:9]
    s_waitcnt lgkmcnt(0)
    s_sub_u32 s8, s8, s30
    s_cmpk_ge_u32 s8, 2116
    s_nop 3
    s_cbranch_scc1 .ap_191
    s_waitcnt vmcnt(5)
    s_cmpk_ge_u32 s8, 2016
    s_cbranch_scc1 .ap_191
    s_waitcnt vmcnt(4)
    s_bitcmp1_b64 s[14:15], 60
    s_cbranch_scc0 1
    s_waitcnt vmcnt(2)
    s_cmpk_ge_u32 s8, 1896
    s_cbranch_scc1 .ap_191
    s_waitcnt vmcnt(1)
.ap_191:
    s_add_u32 s63, s69, 425984
    buffer_load_dwordx4 v[68:71], v1, s[44:47], s63 offen nt
    v_perm_b32 v112, v196, v192, s94
    v_perm_b32 v113, v204, v200, s94
    v_perm_b32 v114, v212, v208, s94
    v_perm_b32 v115, v220, v216, s94
    s_nop 1
    v_mfma_f32_16x16x32_bf16 v[128:131], v[100:103], v[112:115], v[128:131]
    v_perm_b32 v116, v196, v192, s95
    v_perm_b32 v117, v204, v200, s95
    v_perm_b32 v118, v212, v208, s95
    v_perm_b32 v119, v220, v216, s95
    s_nop 1
    v_mfma_f32_16x16x32_bf16 v[132:135], v[100:103], v[116:119], v[132:135]
    v_perm_b32 v120, v197, v193, s94
    v_perm_b32 v121, v205, v201, s94
    v_perm_b32 v122, v213, v209, s94
    v_perm_b32 v123, v221, v217, s94
    s_nop 1
    v_mfma_f32_16x16x32_bf16 v[136:139], v[100:103], v[120:123], v[136:139]
    v_perm_b32 v124, v197, v193, s95
    v_perm_b32 v125, v205, v201, s95
    v_perm_b32 v126, v213, v209, s95
    v_perm_b32 v127, v221, v217, s95
    s_nop 1
    v_mfma_f32_16x16x32_bf16 v[140:143], v[100:103], v[124:127], v[140:143]
    v_perm_b32 v112, v198, v194, s94
    v_perm_b32 v113, v206, v202, s94
    v_perm_b32 v114, v214, v210, s94
    v_perm_b32 v115, v222, v218, s94
    s_branch .Lsk_b1_4
.Lst_b1_4:
    s_branch .Lrt_b1_4
.Lsk_b1_4:
    s_nop 1
    v_mfma_f32_16x16x32_bf16 v[144:147], v[100:103], v[112:115], v[144:147]
    v_perm_b32 v116, v198, v194, s95
    v_perm_b32 v117, v206, v202, s95
    v_perm_b32 v118, v214, v210, s95
    v_perm_b32 v119, v222, v218, s95
    s_nop 1
    v_mfma_f32_16x16x32_bf16 v[148:151], v[100:103], v[116:119], v[148:151]
    v_perm_b32 v120, v199, v195, s94
    v_perm_b32 v121, v207, v203, s94
    v_perm_b32 v122, v215, v211, s94
    v_perm_b32 v123, v223, v219, s94
    s_nop 1
    v_mfma_f32_16x16x32_bf16 v[152:155], v[100:103], v[120:123], v[152:155]
    v_perm_b32 v124, v199, v195, s95
    v_perm_b32 v125, v207, v203, s95
    v_perm_b32 v126, v215, v211, s95
    v_perm_b32 v127, v223, v219, s95
    s_nop 1
    v_mfma_f32_16x16x32_bf16 v[156:159], v[100:103], v[124:127], v[156:159]
    s_memrealtime s[8:9]
    s_waitcnt lgkmcnt(0)
    s_sub_u32 s8, s8, s30
    s_cmpk_ge_u32 s8, 2148
    s_nop 3
    s_cbranch_scc1 .ap_192
    s_waitcnt vmcnt(5)
    s_cmpk_ge_u32 s8, 2048
    s_cbranch_scc1 .ap_192
    s_waitcnt vmcnt(4)
    s_bitcmp1_b64 s[14:15], 61
    s_cbranch_scc0 1
    s_waitcnt vmcnt(2)
    s_cmpk_ge_u32 s8, 1928
    s_cbranch_scc1 .ap_192
    s_waitcnt vmcnt(1)
.ap_192:
    s_add_u32 s63, s69, 434176
    buffer_load_dwordx4 v[76:79], v1, s[44:47], s63 offen nt
    s_waitcnt vmcnt(6)
    v_perm_b32 v112, v228, v224, s94
    v_perm_b32 v113, v236, v232, s94
    v_perm_b32 v114, v244, v240, s94
    v_perm_b32 v115, v252, v248, s94
    s_nop 1
    v_mfma_f32_16x16x32_bf16 v[128:131], v[104:107], v[112:115], v[128:131]
    v_perm_b32 v116, v228, v224, s95
    v_perm_b32 v117, v236, v232, s95
    v_perm_b32 v118, v244, v240, s95
    v_perm_b32 v119, v252, v248, s95
    s_nop 1
    v_mfma_f32_16x16x32_bf16 v[132:135], v[104:107], v[116:119], v[132:135]
    v_perm_b32 v120, v229, v225, s94
    v_perm_b32 v121, v237, v233, s94
    v_perm_b32 v122, v245, v241, s94
    v_perm_b32 v123, v253, v249, s94
    s_nop 1
    v_mfma_f32_16x16x32_bf16 v[136:139], v[104:107], v[120:123], v[136:139]
    v_perm_b32 v124, v229, v225, s95
    v_perm_b32 v125, v237, v233, s95
    v_perm_b32 v126, v245, v241, s95
    v_perm_b32 v127, v253, v249, s95
    s_nop 1
    v_mfma_f32_16x16x32_bf16 v[140:143], v[104:107], v[124:127], v[140:143]
    v_perm_b32 v112, v230, v226, s94
    v_perm_b32 v113, v238, v234, s94
    v_perm_b32 v114, v246, v242, s94
    v_perm_b32 v115, v254, v250, s94
    s_nop 1
    v_mfma_f32_16x16x32_bf16 v[144:147], v[104:107], v[112:115], v[144:147]
    v_perm_b32 v116, v230, v226, s95
    v_perm_b32 v117, v238, v234, s95
    v_perm_b32 v118, v246, v242, s95
    v_perm_b32 v119, v254, v250, s95
    s_nop 1
    v_mfma_f32_16x16x32_bf16 v[148:151], v[104:107], v[116:119], v[148:151]
    v_perm_b32 v120, v231, v227, s94
    v_perm_b32 v121, v239, v235, s94
    v_perm_b32 v122, v247, v243, s94
    v_perm_b32 v123, v255, v251, s94
    s_nop 1
    v_mfma_f32_16x16x32_bf16 v[152:155], v[104:107], v[120:123], v[152:155]
    v_perm_b32 v124, v231, v227, s95
    v_perm_b32 v125, v239, v235, s95
    v_perm_b32 v126, v247, v243, s95
    v_perm_b32 v127, v255, v251, s95
    s_nop 1
    v_mfma_f32_16x16x32_bf16 v[156:159], v[104:107], v[124:127], v[156:159]
    s_memrealtime s[8:9]
    s_waitcnt lgkmcnt(0)
    s_sub_u32 s8, s8, s30
    s_cmpk_ge_u32 s8, 2180
    s_nop 3
    s_cbranch_scc1 .ap_193
    s_waitcnt vmcnt(5)
    s_cmpk_ge_u32 s8, 2080
    s_cbranch_scc1 .ap_193
    s_waitcnt vmcnt(4)
    s_bitcmp1_b64 s[14:15], 62
    s_cbranch_scc0 1
    s_waitcnt vmcnt(2)
    s_cmpk_ge_u32 s8, 1960
    s_cbranch_scc1 .ap_193
    s_waitcnt vmcnt(1)
.ap_193:
    s_add_u32 s63, s69, 442368
    buffer_load_dwordx4 v[84:87], v1, s[44:47], s63 offen nt
    s_memrealtime s[8:9]
    s_waitcnt lgkmcnt(0)
    s_sub_u32 s8, s8, s30
    s_cmpk_ge_u32 s8, 2212
    s_cbranch_scc1 .ap_194
    s_waitcnt vmcnt(5)
    s_cmpk_ge_u32 s8, 2112
    s_cbranch_scc1 .ap_194
    s_waitcnt vmcnt(4)
    s_bitcmp1_b64 s[14:15], 63
    s_cbranch_scc0 1
    s_waitcnt vmcnt(2)
    s_cmpk_ge_u32 s8, 1992
    s_cbranch_scc1 .ap_194
    s_waitcnt vmcnt(1)
.ap_194:
    s_add_u32 s63, s69, 450560
    buffer_load_dwordx4 v[92:95], v1, s[44:47], s63 offen nt
    s_setprio 0
    s_waitcnt vmcnt(6)
    v_perm_b32 v160, v44, v36, s94
    v_perm_b32 v164, v44, v36, s95
    v_perm_b32 v168, v45, v37, s94
    v_perm_b32 v172, v45, v37, s95
    v_perm_b32 v176, v46, v38, s94
    v_perm_b32 v180, v46, v38, s95
    v_perm_b32 v184, v47, v39, s94
    v_perm_b32 v188, v47, v39, s95
    s_waitcnt vmcnt(4)
    v_perm_b32 v161, v60, v52, s94
    v_perm_b32 v165, v60, v52, s95
    v_perm_b32 v169, v61, v53, s94
    v_perm_b32 v173, v61, v53, s95
    v_perm_b32 v177, v62, v54, s94
    v_perm_b32 v181, v62, v54, s95
    v_perm_b32 v185, v63, v55, s94
    v_perm_b32 v189, v63, v55, s95
    s_waitcnt vmcnt(2)
    v_perm_b32 v162, v76, v68, s94
    v_perm_b32 v166, v76, v68, s95
    v_perm_b32 v170, v77, v69, s94
    v_perm_b32 v174, v77, v69, s95
    v_perm_b32 v178, v78, v70, s94
    v_perm_b32 v182, v78, v70, s95
    v_perm_b32 v186, v79, v71, s94
    v_perm_b32 v190, v79, v71, s95
    s_branch .Lsk_b1_5
    .fill 31, 4, 0xbf800000
.Lst_b1_5:
    s_branch .Lrt_b1_5
.Lsk_b1_5:
    s_waitcnt vmcnt(0)
    s_add_u32 m0, s101, 90112
    s_add_u32 s56, s100, 1179648
    buffer_load_dwordx4 v6, s[52:55], s56 offen nt lds
    s_add_u32 m0, s101, 98304
    s_add_u32 s56, s100, 1769472
    buffer_load_dwordx4 v6, s[52:55], s56 offen nt lds
    s_add_u32 m0, s101, 106496
    s_add_u32 s56, s100, 2359296
    buffer_load_dwordx4 v6, s[52:55], s56 offen nt lds
    s_add_u32 m0, s101, 114688
    s_add_u32 s56, s100, 2949120
    buffer_load_dwordx4 v6, s[52:55], s56 offen nt lds
    v_perm_b32 v163, v92, v84, s94
    v_perm_b32 v167, v92, v84, s95
    v_perm_b32 v171, v93, v85, s94
    v_mfma_f32_16x16x32_bf16 v[128:131], v[108:111], v[160:163], v[128:131]
    v_perm_b32 v175, v93, v85, s95
    v_mfma_f32_16x16x32_bf16 v[132:135], v[108:111], v[164:167], v[132:135]
    v_perm_b32 v179, v94, v86, s94
    v_mfma_f32_16x16x32_bf16 v[136:139], v[108:111], v[168:171], v[136:139]
    v_perm_b32 v183, v94, v86, s95
    v_mfma_f32_16x16x32_bf16 v[140:143], v[108:111], v[172:175], v[140:143]
    v_perm_b32 v187, v95, v87, s94
    v_mfma_f32_16x16x32_bf16 v[144:147], v[108:111], v[176:179], v[144:147]
    v_perm_b32 v191, v95, v87, s95
    v_mfma_f32_16x16x32_bf16 v[148:151], v[108:111], v[180:183], v[148:151]
    v_mfma_f32_16x16x32_bf16 v[152:155], v[108:111], v[184:187], v[152:155]
    v_mfma_f32_16x16x32_bf16 v[156:159], v[108:111], v[188:191], v[156:159]
    s_mov_b64 exec, 0xffff
    ds_write2_b32 v10, v128, v129 offset0:0 offset1:128
    ds_write2_b32 v10, v132, v133 offset0:1 offset1:129
    ds_write2_b32 v10, v136, v137 offset0:2 offset1:130
    ds_write2_b32 v10, v140, v141 offset0:3 offset1:131
    ds_write2_b32 v10, v144, v145 offset0:4 offset1:132
    ds_write2_b32 v10, v148, v149 offset0:5 offset1:133
    ds_write2_b32 v10, v152, v153 offset0:6 offset1:134
    ds_write2_b32 v10, v156, v157 offset0:7 offset1:135
    s_mov_b64 exec, -1
    s_waitcnt lgkmcnt(0)
    s_barrier
    s_cmp_lg_u32 s3, 7
    s_cbranch_scc1 .opub_195
    v_add_u32 v10, 147456, v2
    ds_read_b128 v[196:199], v10 offset:0
    ds_read_b128 v[200:203], v10 offset:1024
    ds_read_b128 v[204:207], v10 offset:2048
    ds_read_b128 v[208:211], v10 offset:3072
    ds_read_b128 v[212:215], v10 offset:4096
    ds_read_b128 v[216:219], v10 offset:5120
    ds_read_b128 v[220:223], v10 offset:6144
    ds_read_b128 v[224:227], v10 offset:7168
    v_lshrrev_b32 v11, 5, v0
    v_lshlrev_b32 v11, 13, v11
    v_and_b32 v12, 31, v0
    v_lshl_add_u32 v11, v12, 4, v11
    s_lshl4_add_u32 s56, s67, s66
    s_lshl1_add_u32 s56, s56, s68
    s_lshl_b32 s56, s56, 9
    s_add_u32 s56, s56, 0xa0000
    s_mov_b32 s60, 0x07060503
    s_mov_b32 s61, 0x07060502
    s_mov_b32 s62, 0x07060501
    v_mov_b32 v15, s34
    s_waitcnt lgkmcnt(6)
    v_pk_add_f32 v[196:197], v[196:197], v[200:201]
    v_pk_add_f32 v[198:199], v[198:199], v[202:203]
    s_waitcnt lgkmcnt(5)
    v_pk_add_f32 v[196:197], v[196:197], v[204:205]
    v_pk_add_f32 v[198:199], v[198:199], v[206:207]
    s_waitcnt lgkmcnt(4)
    v_pk_add_f32 v[196:197], v[196:197], v[208:209]
    v_pk_add_f32 v[198:199], v[198:199], v[210:211]
    s_waitcnt lgkmcnt(3)
    v_pk_add_f32 v[196:197], v[196:197], v[212:213]
    v_pk_add_f32 v[198:199], v[198:199], v[214:215]
    s_waitcnt lgkmcnt(2)
    v_pk_add_f32 v[196:197], v[196:197], v[216:217]
    v_pk_add_f32 v[198:199], v[198:199], v[218:219]
    s_waitcnt lgkmcnt(1)
    v_pk_add_f32 v[196:197], v[196:197], v[220:221]
    v_pk_add_f32 v[198:199], v[198:199], v[222:223]
    s_waitcnt lgkmcnt(0)
    v_pk_add_f32 v[196:197], v[196:197], v[224:225]
    v_pk_add_f32 v[198:199], v[198:199], v[226:227]
    v_perm_b32 v12, v196, v199, s60
    v_perm_b32 v13, v197, v199, s61
    v_perm_b32 v14, v198, v199, s62
    s_add_u32 s57, s56, 0x800000
    buffer_store_dwordx4 v[12:15], v11, s[36:39], s57 offen
    s_cmp_lg_u32 s0, 0
    s_nop 0
    s_cbranch_scc1 .nosl_196
    buffer_store_dwordx4 v[12:15], v11, s[36:39], s56 offen sc1
.nosl_196:
.opub_195:
    s_mov_b32 s61, s101
    v_lshrrev_b32 v25, 4, v0
    v_bfe_u32 v26, v0, 1, 1
    v_lshl_add_u32 v25, v25, 1, v26
    v_bfe_u32 v26, v0, 2, 2
    v_lshl_add_u32 v19, v25, 3, v26
    v_lshlrev_b32 v19, 7, v19
    v_and_b32 v25, 3, v25
    v_lshrrev_b32 v26, 1, v26
    v_lshl_add_u32 v25, v25, 1, v26
    v_xor_b32 v25, s3, v25
    v_lshl_add_u32 v19, v25, 4, v19
    v_and_b32 v25, 1, v0
    v_lshl_add_u32 v19, v25, 3, v19
    v_add_u32 v20, 32768, v19
    ds_read_b64_tr_b16 v[160:161], v19 offset:0
    ds_read_b64_tr_b16 v[162:163], v19 offset:512
    ds_read_b64_tr_b16 v[168:169], v19 offset:8192
    ds_read_b64_tr_b16 v[170:171], v19 offset:8704
    ds_read_b64_tr_b16 v[176:177], v19 offset:16384
    ds_read_b64_tr_b16 v[178:179], v19 offset:16896
    ds_read_b64_tr_b16 v[184:185], v19 offset:24576
    ds_read_b64_tr_b16 v[186:187], v19 offset:25088
    ds_read_b64_tr_b16 v[192:193], v20 offset:0
    s_branch .Lsk_b1_6
.Lst_b1_6:
    s_branch .Lrt_b1_6
.Lsk_b1_6:
    ds_read_b64_tr_b16 v[194:195], v20 offset:512
    ds_read_b64_tr_b16 v[200:201], v20 offset:8192
    ds_read_b64_tr_b16 v[202:203], v20 offset:8704
    ds_read_b64_tr_b16 v[208:209], v20 offset:16384
    ds_read_b64_tr_b16 v[210:211], v20 offset:16896
    ds_read_b64_tr_b16 v[216:217], v20 offset:24576
    ds_read_b64_tr_b16 v[218:219], v20 offset:25088
    ds_read_b64_tr_b16 v[224:225], v20 offset:32768
    ds_read_b64_tr_b16 v[226:227], v20 offset:33280
    v_add_u32 v19, 73728, v19
    v_add_u32 v20, 73728, v20
    s_mov_b32 s48, s22
    s_and_b32 s49, s23, 0xffff
    s_mov_b32 s50, 0x510000
    s_mov_b32 s51, 0x00020000
    s_mul_i32 s69, s99, 73728
    s_mul_i32 s56, s3, 9216
    s_add_u32 s69, s69, s56
    v_bfe_u32 v25, v0, 4, 1
    s_and_b32 s56, s3, 1
    s_lshl_b32 s56, s56, 2
    v_lshl_or_b32 v25, v25, 1, s56
    v_and_b32 v26, 7, v0
    v_xor_b32 v25, v25, v26
    v_lshrrev_b32 v26, 3, v0
    v_mul_u32_u24 v26, 1152, v26
    v_lshl_add_u32 v24, v25, 4, v26
    s_and_b32 s58, s64, 0
    s_mul_i32 s58, s58, 18432
    s_mul_i32 s59, s3, 2304
    s_add_u32 s58, s58, s59
    s_add_u32 s62, s58, 0x37000
    s_add_u32 s63, s58, 0x49000
    s_mul_i32 s101, s64, 18432
    s_add_u32 s101, s101, s59
    s_add_u32 s101, s101, 0x170000
    s_waitcnt lgkmcnt(0)
    s_barrier
    s_add_u32 m0, s61, 122880
    s_add_u32 s56, s100, 3538944
    buffer_load_dwordx4 v6, s[52:55], s56 offen nt lds
    s_add_u32 m0, s61, 131072
    s_add_u32 s56, s100, 4128768
    buffer_load_dwordx4 v6, s[52:55], s56 offen nt lds
    s_add_u32 m0, s61, 139264
    s_add_u32 s56, s100, 4718592
    buffer_load_dwordx4 v6, s[52:55], s56 offen nt lds
    s_add_u32 m0, s61, 0
    s_nop 0
    buffer_load_dwordx4 v24, s[48:51], s69 offen offset:0 nt lds
    s_add_u32 m0, s61, 8064
    s_nop 0
    buffer_load_dwordx4 v24, s[48:51], s69 offen offset:128 nt lds
    s_add_u32 m0, s61, 16128
    s_nop 0
    buffer_load_dwordx4 v24, s[48:51], s69 offen offset:256 nt lds
    s_add_u32 m0, s61, 24192
    s_nop 0
    buffer_load_dwordx4 v24, s[48:51], s69 offen offset:384 nt lds
    s_add_u32 m0, s61, 32256
    s_nop 0
    buffer_load_dwordx4 v24, s[48:51], s69 offen offset:512 nt lds
    s_add_u32 m0, s61, 40320
    s_nop 0
    buffer_load_dwordx4 v24, s[48:51], s69 offen offset:640 nt lds
    s_add_u32 m0, s61, 48384
    s_nop 0
    buffer_load_dwordx4 v24, s[48:51], s69 offen offset:768 nt lds
    s_add_u32 m0, s61, 56448
    s_nop 0
    buffer_load_dwordx4 v24, s[48:51], s69 offen offset:896 nt lds
    s_add_u32 m0, s61, 64512
    s_nop 0
    buffer_load_dwordx4 v24, s[48:51], s69 offen offset:1024 nt lds
    v_bfe_u32 v16, v0, 1, 3
    v_mul_u32_u24 v16, 1312, v16
    v_lshrrev_b32 v25, 4, v0
    v_lshl_add_u32 v16, v25, 5, v16
    v_and_b32 v25, 1, v0
    v_lshl_add_u32 v16, v25, 4, v16
    v_add_u32 v16, 147456, v16
    s_mul_i32 s56, s3, 1312
    s_add_u32 s56, s56, 147456
    v_add_u32 v17, s56, v3
    v_add_u32 v18, s56, v4
    v_bfe_u32 v21, v0, 1, 3
    v_mul_u32_u24 v21, 144, v21
    v_bfe_u32 v25, v0, 4, 1
    v_lshl_add_u32 v21, v25, 3, v21
    v_lshrrev_b32 v25, 5, v0
    v_lshl_add_u32 v21, v25, 2, v21
    v_and_b32 v25, 1, v0
    v_lshl_add_u32 v21, v25, 1, v21
    s_lshl_b32 s56, s3, 4
    s_add_u32 s56, s56, 157952
    v_add_u32 v21, s56, v21
    v_and_b32 v22, 15, v0
    v_lshlrev_b32 v22, 3, v22
    s_mul_i32 s56, s3, 144
    s_add_u32 s56, s56, 157952
    v_add_u32 v22, s56, v22
    s_mul_i32 s56, s3, 1312
    s_add_u32 s56, s56, 147456
    v_mov_b32 v17, s56
    v_bfe_u32 v25, v0, 4, 2
    v_lshl_add_u32 v17, v25, 7, v17
    v_bfe_u32 v25, v0, 1, 1
    v_lshl_add_u32 v17, v25, 6, v17
    v_bfe_u32 v25, v0, 3, 1
    v_lshl_add_u32 v17, v25, 5, v17
    v_bfe_u32 v25, v0, 2, 1
    v_lshl_add_u32 v17, v25, 3, v17
    v_bfe_u32 v25, v0, 0, 1
    v_lshl_add_u32 v17, v25, 2, v17
    s_add_u32 s56, s56, 1024
    v_mov_b32 v18, s56
    v_bfe_u32 v25, v0, 2, 1
    v_lshl_add_u32 v18, v25, 6, v18
    v_bfe_u32 v25, v0, 4, 1
    v_lshl_add_u32 v18, v25, 5, v18
    v_bfe_u32 v25, v0, 0, 1
    v_lshl_add_u32 v18, v25, 4, v18
    v_bfe_u32 v25, v0, 3, 1
    v_lshl_add_u32 v18, v25, 3, v18
    v_bfe_u32 v25, v0, 1, 1
    v_lshl_add_u32 v18, v25, 2, v18
    v_lshrrev_b32 v25, 3, v0
    v_mul_u32_u24 v21, 144, v25
    v_and_b32 v25, 7, v0
    v_lshl_add_u32 v21, v25, 1, v21
    s_lshl_b32 s56, s3, 4
    v_lshrrev_b32 v25, 3, v0
    v_mul_u32_u24 v26, 144, v25
    v_mov_b32 v21, v26
    v_bfe_u32 v25, v0, 1, 1
    v_lshl_add_u32 v21, v25, 4, v21
    v_bfe_u32 v25, v0, 2, 1
    v_lshl_add_u32 v21, v25, 2, v21
    v_bfe_u32 v25, v0, 0, 1
    v_lshl_add_u32 v21, v25, 1, v21
    s_and_b32 s57, s3, 1
    s_lshl_b32 s57, s57, 3
    s_sub_u32 s56, s56, s57
    s_add_u32 s56, s56, 157952
    v_add_u32 v21, s56, v21
    v_mov_b32 v156, 0x4444
    v_mov_b32 v25, 0xeeee
    v_cndmask_b32 v156, v156, v25, s[96:97]
    v_mov_b32 v152, 0
    v_mov_b32 v153, 0
    v_mov_b32 v154, 0
    v_mov_b32 v155, 0
    v_mov_b32 v232, 0
    v_mov_b32 v233, 0
    v_mov_b32 v234, 0
    v_mov_b32 v235, 0
    v_mov_b32 v236, 0
    v_mov_b32 v237, 0
    v_mov_b32 v238, 0
    v_mov_b32 v239, 0
    v_mov_b32 v240, 0
    v_mov_b32 v241, 0
    v_mov_b32 v242, 0
    v_mov_b32 v243, 0
    v_mov_b32 v244, 0
    v_mov_b32 v245, 0
    s_branch .Lsk_b1_7
.Lst_b1_7:
    s_branch .Lrt_b1_7
.Lsk_b1_7:
    v_mov_b32 v246, 0
    v_mov_b32 v247, 0
    v_mov_b32 v248, 0
    v_mov_b32 v249, 0
    v_mov_b32 v250, 0
    v_mov_b32 v251, 0
    v_mov_b32 v252, 0
    v_mov_b32 v253, 0
    v_mov_b32 v254, 0
    v_mov_b32 v255, 0
    s_mov_b32 s56, 157952
    v_bfe_u32 v22, v0, 1, 3
    v_mul_u32_u24 v22, 144, v22
    v_and_b32 v25, 48, v0
    v_lshl_add_u32 v22, v25, 1, v22
    v_and_b32 v25, 1, v0
    v_lshlrev_b32 v25, 4, v25
    v_add3_u32 v22, v22, v25, s56
    v_lshrrev_b32 v23, 4, v0
    v_and_b32 v25, 1, v0
    v_lshl_add_u32 v23, v23, 1, v25
    v_mul_u32_u24 v23, 9216, v23
    v_bfe_u32 v25, v0, 1, 3
    v_lshl_add_u32 v23, v25, 4, v23
    v_lshrrev_b32 v25, 4, v0
    v_bfe_u32 v26, v0, 2, 2
    v_lshl_add_u32 v28, v25, 3, v26
    v_lshlrev_b32 v28, 7, v28
    v_and_b32 v25, 1, v25
    v_lshrrev_b32 v26, 1, v26
    v_lshl_add_u32 v25, v25, 1, v26
    s_and_b32 s56, s3, 1
    s_lshl_b32 s56, s56, 1
    v_xor_b32 v25, s56, v25
    v_and_b32 v26, 3, v0
    v_lshl_add_u32 v28, v26, 3, v28
    s_lshr_b32 s56, s3, 1
    s_lshl_b32 s56, s56, 13
    v_add_u32 v28, s56, v28
    v_xor_b32 v26, 1, v25
    v_lshl_add_u32 v29, v26, 5, v28
    v_lshl_add_u32 v28, v25, 5, v28
    v_add_u32 v30, 0x10000, v28
    v_add_u32 v31, 0x10000, v29
    s_mul_i32 s59, s3, 73728
    s_lshl_b32 s56, s99, 7
    s_add_u32 s59, s59, s56
    s_add_u32 s59, s59, 0x1a0000
    s_add_u32 s99, s59, 589824
    s_add_u32 s100, s59, 1179648
    s_branch .gpc_198
.gp_197:
    buffer_load_dwordx4 v[32:35], v2, s[36:39], s62 offen offset:0 sc1
    buffer_load_dwordx4 v[40:43], v2, s[36:39], s62 offen offset:1024 sc1
    buffer_load_dwordx2 v[48:49], v5, s[36:39], s62 offen offset:0 sc1
    buffer_load_dwordx4 v[56:59], v2, s[36:39], s63 offen offset:0 sc1
    buffer_load_dwordx4 v[64:67], v2, s[36:39], s63 offen offset:1024 sc1
    buffer_load_dwordx2 v[72:73], v5, s[36:39], s63 offen offset:0 sc1
    s_waitcnt vmcnt(0)
.gpc_198:
    v_min_u32 v25, v33, v35
    v_max_u32 v26, v33, v35
    v_min3_u32 v25, v25, v41, v43
    v_max3_u32 v26, v26, v41, v43
    v_min3_u32 v25, v25, v49, v57
    v_max3_u32 v26, v26, v49, v57
    v_min3_u32 v25, v25, v59, v65
    v_max3_u32 v26, v26, v59, v65
    v_min3_u32 v25, v25, v67, v73
    v_max3_u32 v26, v26, v67, v73
    v_cmp_eq_u32 vcc, s34, v25
    v_cmp_eq_u32 s[56:57], s34, v26
    s_and_b64 vcc, vcc, s[56:57]
    s_cmp_eq_u64 vcc, -1
    s_nop 2
    s_cbranch_scc1 .gpd_199
    s_sub_u32 s35, s35, 1
    s_cbranch_scc1 .Lexit
    s_sleep 2
    s_branch .gp_197
.gpd_199:
    v_lshlrev_b32 v78, 16, v32
    v_and_b32 v79, 0xffff0000, v32
    v_lshlrev_b32 v88, 16, v56
    v_and_b32 v89, 0xffff0000, v56
    v_lshlrev_b32 v80, 16, v34
    v_and_b32 v81, 0xffff0000, v34
    v_lshlrev_b32 v90, 16, v58
    v_and_b32 v91, 0xffff0000, v58
    v_lshlrev_b32 v82, 16, v40
    v_and_b32 v83, 0xffff0000, v40
    v_lshlrev_b32 v92, 16, v64
    v_and_b32 v93, 0xffff0000, v64
    v_lshlrev_b32 v84, 16, v42
    v_and_b32 v85, 0xffff0000, v42
    v_lshlrev_b32 v94, 16, v66
    v_and_b32 v95, 0xffff0000, v66
    v_lshlrev_b32 v86, 16, v48
    v_and_b32 v87, 0xffff0000, v48
    v_lshlrev_b32 v96, 16, v72
    v_and_b32 v97, 0xffff0000, v72
    s_waitcnt vmcnt(9)
    s_barrier
    ds_read_b64_tr_b16 v[164:165], v19 offset:0
    ds_read_b64_tr_b16 v[166:167], v19 offset:512
    ds_read_b64_tr_b16 v[172:173], v19 offset:8192
    ds_read_b64_tr_b16 v[174:175], v19 offset:8704
    ds_read_b64_tr_b16 v[180:181], v19 offset:16384
    ds_read_b64_tr_b16 v[182:183], v19 offset:16896
    ds_read_b64_tr_b16 v[188:189], v19 offset:24576
    ds_read_b64_tr_b16 v[190:191], v19 offset:25088
    ds_read_b64_tr_b16 v[196:197], v20 offset:0
    ds_read_b64_tr_b16 v[198:199], v20 offset:512
    ds_read_b64_tr_b16 v[204:205], v20 offset:8192
    ds_read_b64_tr_b16 v[206:207], v20 offset:8704
    ds_read_b64_tr_b16 v[212:213], v20 offset:16384
    ds_read_b64_tr_b16 v[214:215], v20 offset:16896
    ds_read_b64_tr_b16 v[220:221], v20 offset:24576
    ds_read_b64_tr_b16 v[222:223], v20 offset:25088
    ds_read_b64_tr_b16 v[228:229], v20 offset:32768
    ds_read_b64_tr_b16 v[230:231], v20 offset:33280
    s_waitcnt lgkmcnt(0)
    v_mov_b32 v8, v160
    v_mov_b32 v9, v161
    v_mov_b32 v10, v162
    v_mov_b32 v11, v163
    v_mov_b32_dpp v160, v164 row_ror:8 row_mask:0xf bank_mask:0xc
    v_mov_b32_dpp v161, v165 row_ror:8 row_mask:0xf bank_mask:0xc
    v_mov_b32_dpp v162, v166 row_ror:8 row_mask:0xf bank_mask:0xc
    v_mov_b32_dpp v163, v167 row_ror:8 row_mask:0xf bank_mask:0xc
    v_mov_b32_dpp v164, v8 row_ror:8 row_mask:0xf bank_mask:0x3
    v_mov_b32_dpp v165, v9 row_ror:8 row_mask:0xf bank_mask:0x3
    v_mov_b32_dpp v166, v10 row_ror:8 row_mask:0xf bank_mask:0x3
    v_mov_b32_dpp v167, v11 row_ror:8 row_mask:0xf bank_mask:0x3
    v_mov_b32 v8, v168
    v_mov_b32 v9, v169
    v_mov_b32 v10, v170
    v_mov_b32 v11, v171
    v_mov_b32_dpp v168, v172 row_ror:8 row_mask:0xf bank_mask:0xc
    v_mov_b32_dpp v169, v173 row_ror:8 row_mask:0xf bank_mask:0xc
    v_mov_b32_dpp v170, v174 row_ror:8 row_mask:0xf bank_mask:0xc
    v_mov_b32_dpp v171, v175 row_ror:8 row_mask:0xf bank_mask:0xc
    v_mov_b32_dpp v172, v8 row_ror:8 row_mask:0xf bank_mask:0x3
    v_mov_b32_dpp v173, v9 row_ror:8 row_mask:0xf bank_mask:0x3
    v_mov_b32_dpp v174, v10 row_ror:8 row_mask:0xf bank_mask:0x3
    v_mov_b32_dpp v175, v11 row_ror:8 row_mask:0xf bank_mask:0x3
    v_mov_b32 v8, v176
    v_mov_b32 v9, v177
    v_mov_b32 v10, v178
    v_mov_b32 v11, v179
    v_mov_b32_dpp v176, v180 row_ror:8 row_mask:0xf bank_mask:0xc
    v_mov_b32_dpp v177, v181 row_ror:8 row_mask:0xf bank_mask:0xc
    v_mov_b32_dpp v178, v182 row_ror:8 row_mask:0xf bank_mask:0xc
    v_mov_b32_dpp v179, v183 row_ror:8 row_mask:0xf bank_mask:0xc
    v_mov_b32_dpp v180, v8 row_ror:8 row_mask:0xf bank_mask:0x3
    v_mov_b32_dpp v181, v9 row_ror:8 row_mask:0xf bank_mask:0x3
    v_mov_b32_dpp v182, v10 row_ror:8 row_mask:0xf bank_mask:0x3
    v_mov_b32_dpp v183, v11 row_ror:8 row_mask:0xf bank_mask:0x3
    v_mov_b32 v8, v184
    v_mov_b32 v9, v185
    v_mov_b32 v10, v186
    v_mov_b32 v11, v187
    v_mov_b32_dpp v184, v188 row_ror:8 row_mask:0xf bank_mask:0xc
    v_mov_b32_dpp v185, v189 row_ror:8 row_mask:0xf bank_mask:0xc
    v_mov_b32_dpp v186, v190 row_ror:8 row_mask:0xf bank_mask:0xc
    v_mov_b32_dpp v187, v191 row_ror:8 row_mask:0xf bank_mask:0xc
    v_mov_b32_dpp v188, v8 row_ror:8 row_mask:0xf bank_mask:0x3
    v_mov_b32_dpp v189, v9 row_ror:8 row_mask:0xf bank_mask:0x3
    v_mov_b32_dpp v190, v10 row_ror:8 row_mask:0xf bank_mask:0x3
    v_mov_b32_dpp v191, v11 row_ror:8 row_mask:0xf bank_mask:0x3
    v_mov_b32 v8, v192
    v_mov_b32 v9, v193
    v_mov_b32 v10, v194
    v_mov_b32 v11, v195
    v_mov_b32_dpp v192, v196 row_ror:8 row_mask:0xf bank_mask:0xc
    v_mov_b32_dpp v193, v197 row_ror:8 row_mask:0xf bank_mask:0xc
    s_branch .Lsk_b2_0
.Lst_b2_0:
    s_branch .Lrt_b2_0
.Lsk_b2_0:
    v_mov_b32_dpp v194, v198 row_ror:8 row_mask:0xf bank_mask:0xc
    v_mov_b32_dpp v195, v199 row_ror:8 row_mask:0xf bank_mask:0xc
    v_mov_b32_dpp v196, v8 row_ror:8 row_mask:0xf bank_mask:0x3
    v_mov_b32_dpp v197, v9 row_ror:8 row_mask:0xf bank_mask:0x3
    v_mov_b32_dpp v198, v10 row_ror:8 row_mask:0xf bank_mask:0x3
    v_mov_b32_dpp v199, v11 row_ror:8 row_mask:0xf bank_mask:0x3
    v_mov_b32 v8, v200
    v_mov_b32 v9, v201
    v_mov_b32 v10, v202
    v_mov_b32 v11, v203
    v_mov_b32_dpp v200, v204 row_ror:8 row_mask:0xf bank_mask:0xc
    v_mov_b32_dpp v201, v205 row_ror:8 row_mask:0xf bank_mask:0xc
    v_mov_b32_dpp v202, v206 row_ror:8 row_mask:0xf bank_mask:0xc
    v_mov_b32_dpp v203, v207 row_ror:8 row_mask:0xf bank_mask:0xc
    v_mov_b32_dpp v204, v8 row_ror:8 row_mask:0xf bank_mask:0x3
    v_mov_b32_dpp v205, v9 row_ror:8 row_mask:0xf bank_mask:0x3
    v_mov_b32_dpp v206, v10 row_ror:8 row_mask:0xf bank_mask:0x3
    v_mov_b32_dpp v207, v11 row_ror:8 row_mask:0xf bank_mask:0x3
    v_mov_b32 v8, v208
    v_mov_b32 v9, v209
    v_mov_b32 v10, v210
    v_mov_b32 v11, v211
    v_mov_b32_dpp v208, v212 row_ror:8 row_mask:0xf bank_mask:0xc
    v_mov_b32_dpp v209, v213 row_ror:8 row_mask:0xf bank_mask:0xc
    v_mov_b32_dpp v210, v214 row_ror:8 row_mask:0xf bank_mask:0xc
    v_mov_b32_dpp v211, v215 row_ror:8 row_mask:0xf bank_mask:0xc
    v_mov_b32_dpp v212, v8 row_ror:8 row_mask:0xf bank_mask:0x3
    v_mov_b32_dpp v213, v9 row_ror:8 row_mask:0xf bank_mask:0x3
    v_mov_b32_dpp v214, v10 row_ror:8 row_mask:0xf bank_mask:0x3
    v_mov_b32_dpp v215, v11 row_ror:8 row_mask:0xf bank_mask:0x3
    v_mov_b32 v8, v216
    v_mov_b32 v9, v217
    v_mov_b32 v10, v218
    v_mov_b32 v11, v219
    v_mov_b32_dpp v216, v220 row_ror:8 row_mask:0xf bank_mask:0xc
    v_mov_b32_dpp v217, v221 row_ror:8 row_mask:0xf bank_mask:0xc
    v_mov_b32_dpp v218, v222 row_ror:8 row_mask:0xf bank_mask:0xc
    v_mov_b32_dpp v219, v223 row_ror:8 row_mask:0xf bank_mask:0xc
    v_mov_b32_dpp v220, v8 row_ror:8 row_mask:0xf bank_mask:0x3
    v_mov_b32_dpp v221, v9 row_ror:8 row_mask:0xf bank_mask:0x3
    v_mov_b32_dpp v222, v10 row_ror:8 row_mask:0xf bank_mask:0x3
    v_mov_b32_dpp v223, v11 row_ror:8 row_mask:0xf bank_mask:0x3
    v_mov_b32 v8, v224
    v_mov_b32 v9, v225
    v_mov_b32 v10, v226
    v_mov_b32 v11, v227
    v_mov_b32_dpp v224, v228 row_ror:8 row_mask:0xf bank_mask:0xc
    v_mov_b32_dpp v225, v229 row_ror:8 row_mask:0xf bank_mask:0xc
    v_mov_b32_dpp v226, v230 row_ror:8 row_mask:0xf bank_mask:0xc
    v_mov_b32_dpp v227, v231 row_ror:8 row_mask:0xf bank_mask:0xc
    v_mov_b32_dpp v228, v8 row_ror:8 row_mask:0xf bank_mask:0x3
    v_mov_b32_dpp v229, v9 row_ror:8 row_mask:0xf bank_mask:0x3
    v_mov_b32_dpp v230, v10 row_ror:8 row_mask:0xf bank_mask:0x3
    v_mov_b32_dpp v231, v11 row_ror:8 row_mask:0xf bank_mask:0x3
    s_waitcnt vmcnt(0)
    s_barrier
    ds_read_b64_tr_b16 v[104:105], v28 offset:0
    ds_read_b64_tr_b16 v[106:107], v28 offset:512
    ds_read_b64_tr_b16 v[112:113], v29 offset:0
    ds_read_b64_tr_b16 v[114:115], v29 offset:512
    ds_read_b64_tr_b16 v[108:109], v28 offset:4096
    ds_read_b64_tr_b16 v[110:111], v28 offset:4608
    ds_read_b64_tr_b16 v[116:117], v29 offset:4096
    ds_read_b64_tr_b16 v[118:119], v29 offset:4608
    ds_read_b64_tr_b16 v[120:121], v28 offset:32768
    ds_read_b64_tr_b16 v[122:123], v28 offset:33280
    ds_read_b64_tr_b16 v[128:129], v29 offset:32768
    ds_read_b64_tr_b16 v[130:131], v29 offset:33280
    ds_read_b64_tr_b16 v[124:125], v28 offset:36864
    ds_read_b64_tr_b16 v[126:127], v28 offset:37376
    ds_read_b64_tr_b16 v[132:133], v29 offset:36864
    ds_read_b64_tr_b16 v[134:135], v29 offset:37376
    s_cmp_ge_u32 s3, 2
    s_cbranch_scc1 .Lbc_nodn3
    ds_read_b64_tr_b16 v[136:137], v30 offset:0
    ds_read_b64_tr_b16 v[138:139], v30 offset:512
    ds_read_b64_tr_b16 v[144:145], v31 offset:0
    ds_read_b64_tr_b16 v[146:147], v31 offset:512
    ds_read_b64_tr_b16 v[140:141], v30 offset:4096
    ds_read_b64_tr_b16 v[142:143], v30 offset:4608
    ds_read_b64_tr_b16 v[148:149], v31 offset:4096
    ds_read_b64_tr_b16 v[150:151], v31 offset:4608
.Lbc_nodn3:
    s_branch .Lsk_b2_1
    .fill 125, 4, 0xbf800000
.Lst_b2_1:
    s_branch .Lrt_b2_1
.Lsk_b2_1:
    s_mov_b32 s69, 0
.gp_200:
    s_add_u32 s69, s69, 1
    s_and_b32 s56, s69, 0x41
    s_cmp_lg_u32 s56, 0x41
    s_cselect_b32 s56, 0, 0x800000
    s_xor_b32 s56, s56, s0
    s_add_u32 s58, s101, s56
    buffer_load_dwordx4 v[68:71], v2, s[36:39], s58 offen offset:0 sc1
    buffer_load_dwordx4 v[72:75], v2, s[36:39], s58 offen offset:1024 sc1
    buffer_load_dwordx2 v[76:77], v5, s[36:39], s58 offen offset:0 sc1
    s_waitcnt vmcnt(0)
    v_min3_u32 v25, v69, v71, v73
    v_max3_u32 v26, v69, v71, v73
    v_min3_u32 v25, v25, v75, v77
    v_max3_u32 v26, v26, v75, v77
    v_cmp_eq_u32 vcc, s34, v25
    v_cmp_eq_u32 s[56:57], s34, v26
    s_and_b64 vcc, vcc, s[56:57]
    s_cmp_eq_u64 vcc, -1
    s_nop 2
    s_cbranch_scc1 .gpd_201
    s_sub_u32 s35, s35, 1
    s_cbranch_scc1 .Lexit
    s_branch .gp_200
.gpd_201:
    s_mov_b32 s56, 0x3f803f80
    v_dot2_f32_bf16 v98, v68, s56, 0
    v_dot2_f32_bf16 v99, v68, v68, 0
    v_dot2_f32_bf16 v98, v70, s56, v98
    v_dot2_f32_bf16 v99, v70, v70, v99
    v_dot2_f32_bf16 v98, v72, s56, v98
    v_dot2_f32_bf16 v99, v72, v72, v99
    v_dot2_f32_bf16 v98, v74, s56, v98
    v_dot2_f32_bf16 v99, v74, v74, v99
    s_mov_b64 exec, 0xffffffff
    v_dot2_f32_bf16 v98, v76, s56, v98
    v_dot2_f32_bf16 v99, v76, v76, v99
    s_mov_b64 exec, -1
    s_nop 1
    v_permlane32_swap_b32 v98, v99
    v_add_f32 v98, v98, v99
    v_mov_b32 v100, v98
    s_nop 1
    v_permlane16_swap_b32 v100, v98
    v_add_f32 v98, v100, v98
    v_and_b32 v69, 0xffff0000, v68
    v_lshlrev_b32 v68, 16, v68
    v_add_f32_dpp v98, v98, v98 row_ror:8 row_mask:0xf bank_mask:0xf
    v_and_b32 v71, 0xffff0000, v70
    v_lshlrev_b32 v70, 16, v70
    v_add_f32_dpp v98, v98, v98 row_ror:4 row_mask:0xf bank_mask:0xf
    v_and_b32 v73, 0xffff0000, v72
    v_lshlrev_b32 v72, 16, v72
    v_add_f32_dpp v98, v98, v98 quad_perm:[2,3,0,1] row_mask:0xf bank_mask:0xf
    v_and_b32 v75, 0xffff0000, v74
    v_lshlrev_b32 v74, 16, v74
    v_add_f32_dpp v98, v98, v98 quad_perm:[1,0,3,2] row_mask:0xf bank_mask:0xf
    v_mul_f32 v98, 0x3ae38e39, v98
    v_and_b32 v77, 0xffff0000, v76
    v_lshlrev_b32 v76, 16, v76
    v_readlane_b32 s56, v98, 0
    v_readlane_b32 s57, v98, 32
    s_nop 0
    v_mov_b32 v98, s56
    v_fma_f32 v99, -v98, v98, s57
    v_max_f32 v99, 0, v99
    v_cvt_pk_bf16_f32 v100, -v98, v99
    v_and_b32 v101, 0xffff0000, v100
    v_add_f32 v101, 0x3727c5ac, v101
    v_lshlrev_b32 v98, 16, v100
    v_cvt_pk_bf16_f32 v101, v101, v101
    v_lshlrev_b32 v101, 16, v101
    v_sqrt_f32 v101, v101
    v_mov_b32 v99, v98
    v_cvt_pk_bf16_f32 v101, v101, v101
    v_lshlrev_b32 v101, 16, v101
    v_rcp_f32 v100, v101
    v_rcp_f32 v101, v101
    v_pk_add_f32 v[68:69], v[68:69], v[98:99]
    v_pk_add_f32 v[70:71], v[70:71], v[98:99]
    v_pk_add_f32 v[72:73], v[72:73], v[98:99]
    v_pk_add_f32 v[74:75], v[74:75], v[98:99]
    v_pk_add_f32 v[76:77], v[76:77], v[98:99]
    v_cvt_pk_bf16_f32 v68, v68, v69
    v_and_b32 v69, 0xffff0000, v68
    v_lshlrev_b32 v68, 16, v68
    v_cvt_pk_bf16_f32 v70, v70, v71
    v_and_b32 v71, 0xffff0000, v70
    v_lshlrev_b32 v70, 16, v70
    v_cvt_pk_bf16_f32 v72, v72, v73
    v_and_b32 v73, 0xffff0000, v72
    v_lshlrev_b32 v72, 16, v72
    v_cvt_pk_bf16_f32 v74, v74, v75
    v_and_b32 v75, 0xffff0000, v74
    v_lshlrev_b32 v74, 16, v74
    v_cvt_pk_bf16_f32 v76, v76, v77
    v_and_b32 v77, 0xffff0000, v76
    v_lshlrev_b32 v76, 16, v76
    v_pk_mul_f32 v[68:69], v[68:69], v[100:101]
    v_pk_mul_f32 v[70:71], v[70:71], v[100:101]
    v_pk_mul_f32 v[72:73], v[72:73], v[100:101]
    v_pk_mul_f32 v[74:75], v[74:75], v[100:101]
    v_pk_mul_f32 v[76:77], v[76:77], v[100:101]
    v_cvt_pk_bf16_f32 v68, v68, v69
    v_and_b32 v69, 0xffff0000, v68
    v_lshlrev_b32 v68, 16, v68
    v_cvt_pk_bf16_f32 v70, v70, v71
    v_and_b32 v71, 0xffff0000, v70
    v_lshlrev_b32 v70, 16, v70
    v_cvt_pk_bf16_f32 v72, v72, v73
    v_and_b32 v73, 0xffff0000, v72
    v_lshlrev_b32 v72, 16, v72
    v_cvt_pk_bf16_f32 v74, v74, v75
    v_and_b32 v75, 0xffff0000, v74
    v_lshlrev_b32 v74, 16, v74
    v_cvt_pk_bf16_f32 v76, v76, v77
    v_and_b32 v77, 0xffff0000, v76
    v_lshlrev_b32 v76, 16, v76
    v_pk_mul_f32 v[68:69], v[68:69], v[88:89]
    v_pk_mul_f32 v[70:71], v[70:71], v[90:91]
    v_pk_mul_f32 v[72:73], v[72:73], v[92:93]
    v_pk_mul_f32 v[74:75], v[74:75], v[94:95]
    v_pk_mul_f32 v[76:77], v[76:77], v[96:97]
    v_cvt_pk_bf16_f32 v68, v68, v69
    v_and_b32 v69, 0xffff0000, v68
    v_lshlrev_b32 v68, 16, v68
    v_cvt_pk_bf16_f32 v70, v70, v71
    v_and_b32 v71, 0xffff0000, v70
    s_branch .Lsk_b2_2
.Lst_b2_2:
    s_branch .Lrt_b2_2
.Lsk_b2_2:
    v_lshlrev_b32 v70, 16, v70
    v_cvt_pk_bf16_f32 v72, v72, v73
    v_and_b32 v73, 0xffff0000, v72
    v_lshlrev_b32 v72, 16, v72
    v_cvt_pk_bf16_f32 v74, v74, v75
    v_and_b32 v75, 0xffff0000, v74
    v_lshlrev_b32 v74, 16, v74
    v_cvt_pk_bf16_f32 v76, v76, v77
    v_and_b32 v77, 0xffff0000, v76
    v_lshlrev_b32 v76, 16, v76
    v_pk_add_f32 v[68:69], v[68:69], v[78:79]
    v_pk_add_f32 v[70:71], v[70:71], v[80:81]
    v_pk_add_f32 v[72:73], v[72:73], v[82:83]
    v_pk_add_f32 v[74:75], v[74:75], v[84:85]
    v_pk_add_f32 v[76:77], v[76:77], v[86:87]
    v_cvt_pk_bf16_f32 v8, v68, v69
    v_cvt_pk_bf16_f32 v9, v70, v71
    v_cvt_pk_bf16_f32 v10, v72, v73
    v_cvt_pk_bf16_f32 v11, v74, v75
    v_cvt_pk_bf16_f32 v12, v76, v77
    ds_write2_b32 v17, v8, v9 offset0:0 offset1:4
    ds_write2_b32 v17, v10, v11 offset0:128 offset1:132
    ds_write_b32 v18, v12
    s_waitcnt lgkmcnt(0)
    s_barrier
    ds_read_b128 v[32:35], v16 offset:0
    ds_read_b128 v[36:39], v16 offset:128
    ds_read_b128 v[40:43], v16 offset:256
    ds_read_b128 v[44:47], v16 offset:384
    ds_read_b128 v[48:51], v16 offset:512
    ds_read_b128 v[52:55], v16 offset:640
    ds_read_b128 v[56:59], v16 offset:768
    ds_read_b128 v[60:63], v16 offset:896
    ds_read_b128 v[64:67], v16 offset:1024
    s_waitcnt lgkmcnt(8)
    v_smfmac_f32_16x16x64_bf16 v[152:155], v[32:35], v[160:167], v156
    s_waitcnt lgkmcnt(7)
    v_smfmac_f32_16x16x64_bf16 v[152:155], v[36:39], v[168:175], v156
    s_waitcnt lgkmcnt(6)
    v_smfmac_f32_16x16x64_bf16 v[152:155], v[40:43], v[176:183], v156
    s_waitcnt lgkmcnt(5)
    v_smfmac_f32_16x16x64_bf16 v[152:155], v[44:47], v[184:191], v156
    s_waitcnt lgkmcnt(4)
    v_smfmac_f32_16x16x64_bf16 v[152:155], v[48:51], v[192:199], v156
    s_waitcnt lgkmcnt(3)
    v_smfmac_f32_16x16x64_bf16 v[152:155], v[52:55], v[200:207], v156
    s_waitcnt lgkmcnt(2)
    v_smfmac_f32_16x16x64_bf16 v[152:155], v[56:59], v[208:215], v156
    s_waitcnt lgkmcnt(1)
    v_smfmac_f32_16x16x64_bf16 v[152:155], v[60:63], v[216:223], v156
    s_waitcnt lgkmcnt(0)
    v_smfmac_f32_16x16x64_bf16 v[152:155], v[64:67], v[224:231], v156
    s_nop 7
    v_add_f32 v12, v152, v153
    v_add_f32 v13, v154, v155
    v_cvt_pk_bf16_f32 v13, v12, v13
    v_lshlrev_b32 v12, 16, v13
    v_and_b32 v14, 0xffff0000, v13
    v_mov_b32 v13, v14
    s_nop 0
    v_mov_b32_dpp v14, v12 row_ror:8 row_mask:0xf bank_mask:0x3
    v_mov_b32_dpp v12, v13 row_ror:8 row_mask:0xf bank_mask:0xc
    v_max_f32 v12, 0xc2ae0000, v12
    v_min_f32 v27, 0x43000000, v12
    v_mul_f32 v25, 0xbfb8aa3b, v27
    v_fma_f32 v26, v27, s98, -v25
    v_fmac_f32 v26, 0xb2a57060, v27
    v_exp_f32 v25, v25
    v_mul_f32 v26, 0x3f317218, v26
    v_fmac_f32 v25, v25, v26
    v_add_f32 v25, 1.0, v25
    v_rcp_f32 v26, v25
    s_nop 0
    v_mul_f32 v27, v12, v26
    v_fma_f32 v25, -v27, v25, v12
    v_fma_f32 v12, v25, v26, v27
    v_cvt_pk_bf16_f32 v12, v12, v12
    v_lshlrev_b32 v12, 16, v12
    v_mul_f32 v12, v12, v14
    v_cvt_pk_bf16_f32 v12, v12, v12
    ds_write_b16 v21, v12
    s_mov_b32 s60, 0x07060503
    s_mov_b32 s61, 0x07060502
    s_mov_b32 s62, 0x07060501
    s_mov_b32 vcc_lo, 0x55555555
    s_mov_b32 vcc_hi, 0x55555555
    v_mov_b32 v59, s34
    v_mov_b32 v63, s34
    v_mov_b32 v67, s34
    s_branch .Lsk_b2_3
    .fill 123, 4, 0xbf800000
.Lst_b2_3:
    s_branch .Lrt_b2_3
.Lsk_b2_3:
    s_cmp_ge_u32 s3, 2
    s_waitcnt lgkmcnt(0)
    s_barrier
    ds_read_b128 v[8:11], v22
    s_waitcnt lgkmcnt(0)
    v_smfmac_f32_16x16x64_bf16 v[232:235], v[8:11], v[104:111], v156
    v_smfmac_f32_16x16x64_bf16 v[236:239], v[8:11], v[112:119], v156
    v_smfmac_f32_16x16x64_bf16 v[240:243], v[8:11], v[120:127], v156
    v_smfmac_f32_16x16x64_bf16 v[244:247], v[8:11], v[128:135], v156
    s_cbranch_scc0 .Lbc_three
    s_nop 4
    v_add_f32 v232, v232, v233
    v_add_f32 v234, v234, v235
    v_add_f32 v236, v236, v237
    v_add_f32 v238, v238, v239
    s_not_b64 vcc, vcc
    v_cndmask_b32_dpp v233, v232, v234, vcc quad_perm:[1,0,3,2] row_mask:0xf bank_mask:0xf
    v_cndmask_b32_dpp v235, v236, v238, vcc quad_perm:[1,0,3,2] row_mask:0xf bank_mask:0xf
    s_not_b64 vcc, vcc
    v_cndmask_b32_dpp v232, v234, v232, vcc quad_perm:[1,0,3,2] row_mask:0xf bank_mask:0xf
    v_cndmask_b32_dpp v234, v238, v236, vcc quad_perm:[1,0,3,2] row_mask:0xf bank_mask:0xf
    v_perm_b32 v56, v232, v235, s60
    v_perm_b32 v57, v233, v235, s61
    v_perm_b32 v58, v234, v235, s62
    buffer_store_dwordx4 v[56:59], v23, s[36:39], s59 offen sc1
    v_add_f32 v240, v240, v241
    v_add_f32 v242, v242, v243
    v_add_f32 v244, v244, v245
    v_add_f32 v246, v246, v247
    s_not_b64 vcc, vcc
    v_cndmask_b32_dpp v241, v240, v242, vcc quad_perm:[1,0,3,2] row_mask:0xf bank_mask:0xf
    v_cndmask_b32_dpp v243, v244, v246, vcc quad_perm:[1,0,3,2] row_mask:0xf bank_mask:0xf
    s_not_b64 vcc, vcc
    v_cndmask_b32_dpp v240, v242, v240, vcc quad_perm:[1,0,3,2] row_mask:0xf bank_mask:0xf
    v_cndmask_b32_dpp v242, v246, v244, vcc quad_perm:[1,0,3,2] row_mask:0xf bank_mask:0xf
    v_perm_b32 v60, v240, v243, s60
    v_perm_b32 v61, v241, v243, s61
    v_perm_b32 v62, v242, v243, s62
    buffer_store_dwordx4 v[60:63], v23, s[36:39], s99 offen sc1
    s_nop 1
    s_branch .Lexit
.Lbc_three:
    v_smfmac_f32_16x16x64_bf16 v[248:251], v[8:11], v[136:143], v156
    v_smfmac_f32_16x16x64_bf16 v[252:255], v[8:11], v[144:151], v156
    s_nop 3
    v_add_f32 v232, v232, v233
    v_add_f32 v234, v234, v235
    v_add_f32 v236, v236, v237
    v_add_f32 v238, v238, v239
    s_not_b64 vcc, vcc
    v_cndmask_b32_dpp v233, v232, v234, vcc quad_perm:[1,0,3,2] row_mask:0xf bank_mask:0xf
    v_cndmask_b32_dpp v235, v236, v238, vcc quad_perm:[1,0,3,2] row_mask:0xf bank_mask:0xf
    s_not_b64 vcc, vcc
    v_cndmask_b32_dpp v232, v234, v232, vcc quad_perm:[1,0,3,2] row_mask:0xf bank_mask:0xf
    v_cndmask_b32_dpp v234, v238, v236, vcc quad_perm:[1,0,3,2] row_mask:0xf bank_mask:0xf
    v_perm_b32 v56, v232, v235, s60
    v_perm_b32 v57, v233, v235, s61
    v_perm_b32 v58, v234, v235, s62
    buffer_store_dwordx4 v[56:59], v23, s[36:39], s59 offen sc1
    v_add_f32 v240, v240, v241
    v_add_f32 v242, v242, v243
    v_add_f32 v244, v244, v245
    v_add_f32 v246, v246, v247
    s_not_b64 vcc, vcc
    v_cndmask_b32_dpp v241, v240, v242, vcc quad_perm:[1,0,3,2] row_mask:0xf bank_mask:0xf
    v_cndmask_b32_dpp v243, v244, v246, vcc quad_perm:[1,0,3,2] row_mask:0xf bank_mask:0xf
    s_not_b64 vcc, vcc
    v_cndmask_b32_dpp v240, v242, v240, vcc quad_perm:[1,0,3,2] row_mask:0xf bank_mask:0xf
    v_cndmask_b32_dpp v242, v246, v244, vcc quad_perm:[1,0,3,2] row_mask:0xf bank_mask:0xf
    v_perm_b32 v60, v240, v243, s60
    v_perm_b32 v61, v241, v243, s61
    v_perm_b32 v62, v242, v243, s62
    buffer_store_dwordx4 v[60:63], v23, s[36:39], s99 offen sc1
    v_add_f32 v248, v248, v249
    v_add_f32 v250, v250, v251
    v_add_f32 v252, v252, v253
    v_add_f32 v254, v254, v255
    s_not_b64 vcc, vcc
    v_cndmask_b32_dpp v249, v248, v250, vcc quad_perm:[1,0,3,2] row_mask:0xf bank_mask:0xf
    v_cndmask_b32_dpp v251, v252, v254, vcc quad_perm:[1,0,3,2] row_mask:0xf bank_mask:0xf
    s_not_b64 vcc, vcc
    v_cndmask_b32_dpp v248, v250, v248, vcc quad_perm:[1,0,3,2] row_mask:0xf bank_mask:0xf
    v_cndmask_b32_dpp v250, v254, v252, vcc quad_perm:[1,0,3,2] row_mask:0xf bank_mask:0xf
    v_perm_b32 v64, v248, v251, s60
    v_perm_b32 v65, v249, v251, s61
    v_perm_b32 v66, v250, v251, s62
    buffer_store_dwordx4 v[64:67], v23, s[36:39], s100 offen sc1
.Lexit:
.Lend:
s_endpgm
.section .rodata,"a"
.p2align 6
.amdhsa_kernel adaLN_cond__sliding_block_cached__moe_arch_mod__decode_kernel
  .amdhsa_next_free_vgpr 256
  .amdhsa_next_free_sgpr 102
  .amdhsa_accum_offset 256
  .amdhsa_group_segment_fixed_size 0
  .amdhsa_kernarg_size 120
  .amdhsa_user_sgpr_count 2
  .amdhsa_user_sgpr_kernarg_segment_ptr 1
  .amdhsa_system_sgpr_workgroup_id_x 1
.end_amdhsa_kernel
```

```asm
; @launch grid=(256,1,1) block=(512,1,1) lds=159360
.amdgcn_target "amdgcn-amd-amdhsa--gfx950"
.text
.p2align 12
.globl adaLN_cond__sliding_block_cached__moe_arch_mod__decode_kernel
.p2align 8
.type adaLN_cond__sliding_block_cached__moe_arch_mod__decode_kernel,@function
adaLN_cond__sliding_block_cached__moe_arch_mod__decode_kernel:
    s_cmp_ge_u32 s2, 256
    s_cbranch_scc1 .Lend
    s_load_dwordx16 s[4:19], s[0:1], 0
    s_load_dwordx8 s[20:27], s[0:1], 64
    s_load_dwordx4 s[28:31], s[0:1], 96
    s_load_dwordx2 s[32:33], s[0:1], 112
    s_memrealtime s[70:71]
    v_lshrrev_b32 v1, 6, v0
    v_and_b32 v0, 63, v0
    v_readfirstlane_b32 s3, v1
    s_cmp_lt_u32 s3, 4
    s_nop 3
    s_cbranch_scc1 .Ltw_done
    s_cmp_lt_u32 s2, 72
    s_cbranch_scc1 .Ltw_m
    s_cmp_lt_u32 s2, 144
    s_cbranch_scc1 .Ltw_b
    s_cmp_lt_u32 s2, 208
    s_cbranch_scc1 .Ltw_q
    s_cmp_eq_u32 s3, 4
    s_cbranch_scc1 .Lst_a0_0
    s_cmp_eq_u32 s3, 5
    s_cbranch_scc1 .Lst_a0_1
.Lrt_a0_0:
.Lrt_a0_1:
    s_branch .Ltw_done
.Ltw_m:
    s_cmp_eq_u32 s3, 4
    s_cbranch_scc1 .Lst_m0_0
    s_cmp_eq_u32 s3, 5
    s_cbranch_scc1 .Lst_m0_1
.Lrt_m0_1:
    s_cmp_eq_u32 s3, 6
    s_cbranch_scc1 .Lst_m0_2
.Lrt_m0_2:
    s_cmp_eq_u32 s3, 7
    s_cbranch_scc1 .Lst_m0_3
    s_cmp_eq_u32 s3, 5
    s_cbranch_scc1 .Lst_m0_4
    s_cmp_eq_u32 s3, 6
    s_cbranch_scc1 .Lrt_m0_5
.Lrt_m0_0:
.Lrt_m0_3:
.Lrt_m0_4:
.Lrt_m0_5:
    s_branch .Ltw_done
.Ltw_b:
    s_cmp_eq_u32 s3, 4
    s_cbranch_scc1 .Lst_b0_0
    s_cmp_eq_u32 s3, 5
    s_cbranch_scc1 .Lst_b0_1
    s_cmp_eq_u32 s3, 6
    s_cbranch_scc1 .Lst_b0_2
    s_cmp_eq_u32 s3, 7
    s_cbranch_scc1 .Lst_b0_3
.Lrt_b0_0:
.Lrt_b0_1:
.Lrt_b0_2:
.Lrt_b0_3:
    s_branch .Ltw_done
.Ltw_q:
    s_cmp_eq_u32 s3, 4
    s_cbranch_scc1 .Lst_q0_0
    s_cmp_eq_u32 s3, 5
    s_cbranch_scc1 .Lst_q0_1
    s_cmp_eq_u32 s3, 6
    s_cbranch_scc1 .Lst_q0_2
    s_cmp_eq_u32 s3, 7
    s_cbranch_scc1 .Lst_q0_3
.Lrt_q0_0:
.Lrt_q0_1:
.Lrt_q0_2:
.Lrt_q0_3:
.Ltw_done:
    s_mov_b32 s35, 0x3ffff
    s_mov_b32 s98, 0xbfb8aa3b
    s_mov_b32 s94, 0x05040100
    s_mov_b32 s95, 0x07060302
    s_mov_b32 s96, 0xaaaaaaaa
    s_mov_b32 s97, 0xaaaaaaaa
    s_and_b32 s64, s2, 7
    s_lshr_b32 s65, s2, 3
    s_mov_b32 s58, 0x2554433
    s_mov_b32 s59, 0x2877661
    s_cmp_ge_u32 s65, 16
    s_cselect_b32 s58, 0xbb1aa998, s58
    s_cselect_b32 s59, 0xffeeddcc, s59
    s_lshl_b32 s57, s65, 2
    s_lshr_b64 s[58:59], s[58:59], s57
    s_lshl1_add_u32 s59, s64, 1
    s_mul_i32 s58, s58, s59
    s_add_u32 s58, s58, s64
    s_add_u32 s58, s58, s59
    s_and_b32 s66, s58, 7
    s_bfe_u32 s67, s58, 0x10003
    s_lshl1_add_u32 s67, s64, s67
    s_lshr_b32 s68, 0xaab5d42a, s65
    s_and_b32 s68, s68, 1
    s_movk_i32 s60, 0x7651
    s_cselect_b32 s60, 0x4320, s60
    s_lshl4_add_u32 s69, s66, s67
    s_lshl_b32 s69, s69, 21
    s_cmp_eq_u32 s64, 7
    s_cselect_b32 s58, 0x4040, 0
    s_or_b32 s58, s58, 0x208180
    s_bitcmp1_b32 s58, s65
    s_cselect_b32 s60, s60, 0x3210
    s_and_b32 s57, s3, 1
    s_and_b32 s59, s3, 6
    s_cmpk_eq_u32 s60, 0x3210
    s_cselect_b32 s57, s68, s57
    s_cselect_b32 s59, s3, s59
    s_lshl_b32 s57, s57, 16
    s_lshl_b32 s59, s59, 10
    s_add_u32 s69, s69, s57
    s_add_u32 s69, s69, s59
    s_add_u32 s69, s69, 0x180000
    v_bfe_u32 v1, v0, 2, 2
    v_lshlrev_b32 v1, 2, v1
    v_bfe_u32 v1, s60, v1, 4
    v_lshrrev_b32 v2, 4, v0
    v_lshl_add_u32 v1, v1, 2, v2
    v_and_b32 v2, 3, v0
    v_lshl_add_u32 v1, v1, 2, v2
    v_lshlrev_b32 v1, 4, v1
    v_lshlrev_b32 v2, 4, v0
    v_lshlrev_b32 v3, 3, v0
    v_and_b32 v4, 31, v0
    v_lshlrev_b32 v4, 2, v4
    v_add_u32 v4, 1024, v4
    v_lshlrev_b32 v5, 1, v4
    s_waitcnt lgkmcnt(0)
    s_load_dword s34, s[32:33], 0
    s_mov_b32 s40, s6
    s_and_b32 s41, s7, 0xffff
    s_mov_b32 s42, 0x10000000
    s_mov_b32 s43, 0x00020000
    s_mov_b32 s6, s60
    s_add_u32 s63, s69, 0
    buffer_load_dwordx4 v[32:35], v1, s[40:43], s63 offen nt
    s_add_u32 s63, s69, 8192
    buffer_load_dwordx4 v[36:39], v1, s[40:43], s63 offen nt
    s_add_u32 s63, s69, 16384
    buffer_load_dwordx4 v[64:67], v1, s[40:43], s63 offen nt
    s_add_u32 s63, s69, 24576
    buffer_load_dwordx4 v[68:71], v1, s[40:43], s63 offen nt
.Lnokpre:
    s_mov_b32 s44, s8
    s_and_b32 s45, s9, 0xffff
    s_mov_b32 s46, 0x10000000
    s_mov_b32 s47, 0x00020000
    s_cmp_eq_u32 s3, 0
    s_cselect_b64 exec, 1, 0
    buffer_load_dword v255, v2, s[44:47], s69 offen nt
    s_mov_b64 exec, -1
    s_mov_b32 s36, s32
    s_and_b32 s37, s33, 0xffff
    s_mov_b32 s38, 0x40000000
    s_mov_b32 s39, 0x00020000
    s_lshl3_add_u32 s56, s3, s2
    s_cmp_lt_u32 s56, 8
    s_cbranch_scc0 .Let_no
    s_lshl2_add_u32 s56, s2, 0x4a1000
    v_lshlrev_b32 v6, 8, v0
    v_mov_b32 v7, s70
    s_mov_b64 exec, 3
    buffer_store_dword v7, v6, s[36:39], s56 offen sc1
    s_mov_b64 exec, -1
.Let_no:
    v_mov_b32 v6, 159232
    v_mov_b32 v7, 0
    ds_write_b32 v6, v7
    s_waitcnt lgkmcnt(0)
    s_barrier
    s_cmp_lt_u32 s3, 4
    s_cbranch_scc1 1
    s_setprio 1
    s_cmp_lt_u32 s65, 9
    s_cbranch_scc1 .Lm
    s_cmp_lt_u32 s65, 18
    s_cbranch_scc1 .Lbc
    s_sub_u32 s65, s65, 18
    s_cmp_ge_u32 s65, 8
    s_cbranch_scc1 .La_early
    s_cmp_eq_u32 s65, 3
    s_mov_b32 s14, 0xb55aab55
    s_cselect_b32 s14, 0x8421084, s14
    s_mov_b32 s15, 0x5aab55aa
    s_cselect_b32 s15, 0x42108421, s15
    s_add_u32 s30, s70, 0
    s_mov_b32 s31, s70
    v_bfe_u32 v16, v0, 1, 3
    v_mul_u32_u24 v16, 1312, v16
    v_lshrrev_b32 v12, 4, v0
    v_lshl_add_u32 v16, v12, 5, v16
    v_and_b32 v12, 1, v0
    v_lshl_add_u32 v16, v12, 4, v16
    v_add_u32 v16, 147456, v16
    s_mul_i32 s56, s3, 1312
    s_add_u32 s56, s56, 147456
    v_add_u32 v17, s56, v3
    v_add_u32 v18, s56, v4
    v_lshrrev_b32 v12, 4, v0
    v_bfe_u32 v13, v0, 1, 1
    v_lshl_add_u32 v12, v12, 1, v13
    v_bfe_u32 v13, v0, 2, 2
    v_lshl_add_u32 v20, v12, 3, v13
    v_lshlrev_b32 v20, 7, v20
    v_and_b32 v12, 3, v12
    v_lshrrev_b32 v13, 1, v13
    v_lshl_add_u32 v12, v12, 1, v13
    v_xor_b32 v12, s3, v12
    v_lshl_add_u32 v20, v12, 4, v20
    v_and_b32 v12, 1, v0
    v_lshl_add_u32 v20, v12, 3, v20
    v_bfe_u32 v23, v0, 1, 3
    v_mul_u32_u24 v23, 144, v23
    v_bfe_u32 v12, v0, 4, 1
    v_lshl_add_u32 v23, v12, 3, v23
    s_branch .Lsk_q0_0
.Lst_q0_0:
    s_branch .Lrt_q0_0
.Lsk_q0_0:
    v_lshrrev_b32 v12, 5, v0
    v_lshl_add_u32 v23, v12, 2, v23
    v_and_b32 v12, 1, v0
    v_lshl_add_u32 v23, v12, 1, v23
    s_lshl_b32 s56, s3, 4
    s_add_u32 s56, s56, 157952
    v_add_u32 v23, s56, v23
    v_and_b32 v24, 15, v0
    v_lshlrev_b32 v24, 3, v24
    s_mul_i32 s56, s3, 144
    s_add_u32 s56, s56, 157952
    v_add_u32 v24, s56, v24
    v_add_u32 v21, 32768, v20
    s_lshl_b32 s100, s3, 10
    s_mul_i32 s58, s3, 1152
    s_mov_b32 s52, s4
    s_and_b32 s53, s5, 0xffff
    s_mov_b32 s54, 0x2400
    s_mov_b32 s55, 0x00020000
    buffer_load_dwordx2 v[246:247], v3, s[52:55], s58 offen
    buffer_load_dwordx2 v[248:249], v3, s[52:55], s58 offen offset:512
    buffer_load_dword v250, v4, s[52:55], s58 offen
    s_mov_b32 s48, s10
    s_and_b32 s49, s11, 0xffff
    s_mov_b32 s50, 0x480000
    s_mov_b32 s51, 0x00020000
    v_bfe_u32 v12, v0, 4, 1
    s_and_b32 s56, s3, 3
    s_lshl_b32 s56, s56, 1
    v_or_b32 v12, s56, v12
    v_and_b32 v19, 7, v0
    v_xor_b32 v12, v12, v19
    v_lshrrev_b32 v19, 3, v0
    v_mul_u32_u24 v19, 8192, v19
    v_lshl_add_u32 v19, v12, 4, v19
    s_lshl3_add_u32 s101, s64, s65
    s_lshl_b32 s57, s3, 16
    s_lshl_b32 s59, s101, 7
    s_add_u32 s57, s57, s59
    s_mov_b32 s99, s57
    s_add_u32 m0, s100, 0
    s_add_u32 s56, s99, 0
    buffer_load_dwordx4 v19, s[48:51], s56 offen nt lds
    s_add_u32 s63, s69, 32768
    buffer_load_dwordx4 v[96:99], v1, s[40:43], s63 offen nt
    s_waitcnt lgkmcnt(0)
    s_add_u32 s34, s34, 1
    s_getreg_b32 s1, hwreg(HW_REG_XCC_ID)
    s_lshl_b32 s1, s1, 24
    s_add_u32 s1, s1, s34
    s_lshr_b32 s0, s2, 3
    s_lshl_b32 s63, s64, 8
    s_add_u32 s0, s0, s63
    s_lshl2_add_u32 s0, s0, 0x480000
    v_mov_b32 v30, s1
    s_cmp_eq_u32 s3, 0
    s_cselect_b64 exec, 1, 0
    buffer_store_dword v30, v2, s[36:39], s0 offen sc1
    s_mov_b64 exec, -1
    s_and_b32 s58, s101, 1
    s_lshl_b32 s101, s101, 8
    s_lshl_b32 s58, s58, 7
    s_sub_u32 s101, s101, s58
    s_lshl_b32 s58, s3, 14
    s_add_u32 s101, s101, s58
    s_add_u32 s101, s101, 0x70000
    s_and_b32 s58, s64, 0
    s_mul_i32 s58, s58, 18432
    s_mul_i32 s59, s3, 2304
    s_add_u32 s58, s58, s59
    s_add_u32 s58, s58, 0x1000
    s_add_u32 s59, s58, 73728
    s_waitcnt vmcnt(5)
    s_add_u32 m0, s100, 8192
    s_add_u32 s56, s99, 524288
    buffer_load_dwordx4 v19, s[48:51], s56 offen nt lds
    s_waitcnt vmcnt(5)
    s_add_u32 s63, s69, 40960
    buffer_load_dwordx4 v[100:103], v1, s[40:43], s63 offen nt
    s_waitcnt vmcnt(5)
    s_add_u32 m0, s100, 16384
    s_add_u32 s56, s99, 1048576
    buffer_load_dwordx4 v19, s[48:51], s56 offen nt lds
    s_waitcnt vmcnt(5)
    s_add_u32 s63, s69, 49152
    buffer_load_dwordx4 v[128:131], v1, s[40:43], s63 offen nt
    v_lshlrev_b32 v236, 16, v246
    v_and_b32 v237, 0xffff0000, v246
    v_lshlrev_b32 v238, 16, v247
    v_and_b32 v239, 0xffff0000, v247
    v_lshlrev_b32 v240, 16, v248
    v_and_b32 v241, 0xffff0000, v248
    v_lshlrev_b32 v242, 16, v249
    v_and_b32 v243, 0xffff0000, v249
    v_lshlrev_b32 v244, 16, v250
    v_and_b32 v245, 0xffff0000, v250
    s_mov_b32 s56, 0x3f803f80
    v_dot2_f32_bf16 v10, v246, s56, 0
    v_dot2_f32_bf16 v11, v246, v246, 0
    v_dot2_f32_bf16 v10, v247, s56, v10
    v_dot2_f32_bf16 v11, v247, v247, v11
    v_dot2_f32_bf16 v10, v248, s56, v10
    v_dot2_f32_bf16 v11, v248, v248, v11
    v_dot2_f32_bf16 v10, v249, s56, v10
    v_dot2_f32_bf16 v11, v249, v249, v11
    s_mov_b64 exec, 0xffffffff
    v_dot2_f32_bf16 v10, v250, s56, v10
    v_dot2_f32_bf16 v11, v250, v250, v11
    s_mov_b64 exec, -1
    s_nop 1
    v_permlane32_swap_b32 v10, v11
    v_add_f32 v10, v10, v11
    v_mov_b32 v12, v10
    s_nop 1
    v_permlane16_swap_b32 v12, v10
    v_add_f32 v10, v12, v10
    s_nop 1
    v_add_f32_dpp v10, v10, v10 row_ror:8 row_mask:0xf bank_mask:0xf
    s_nop 1
    v_add_f32_dpp v10, v10, v10 row_ror:4 row_mask:0xf bank_mask:0xf
    s_nop 1
    v_add_f32_dpp v10, v10, v10 quad_perm:[2,3,0,1] row_mask:0xf bank_mask:0xf
    s_nop 1
    v_add_f32_dpp v10, v10, v10 quad_perm:[1,0,3,2] row_mask:0xf bank_mask:0xf
    v_mul_f32 v10, 0x3ae38e39, v10
    s_nop 0
    v_readlane_b32 s56, v10, 0
    v_readlane_b32 s57, v10, 32
    s_nop 0
    v_mov_b32 v10, s56
    v_fma_f32 v11, -v10, v10, s57
    v_max_f32 v11, 0, v11
    v_cvt_pk_bf16_f32 v12, -v10, v11
    v_and_b32 v13, 0xffff0000, v12
    v_add_f32 v13, 0x3727c5ac, v13
    v_lshlrev_b32 v10, 16, v12
    v_cvt_pk_bf16_f32 v13, v13, v13
    v_lshlrev_b32 v13, 16, v13
    v_sqrt_f32 v13, v13
    v_mov_b32 v11, v10
    v_cvt_pk_bf16_f32 v13, v13, v13
    v_lshlrev_b32 v13, 16, v13
    v_rcp_f32 v12, v13
    v_rcp_f32 v13, v13
    v_pk_add_f32 v[236:237], v[236:237], v[10:11]
    v_pk_add_f32 v[238:239], v[238:239], v[10:11]
    v_pk_add_f32 v[240:241], v[240:241], v[10:11]
    v_pk_add_f32 v[242:243], v[242:243], v[10:11]
    v_pk_add_f32 v[244:245], v[244:245], v[10:11]
    v_cvt_pk_bf16_f32 v236, v236, v237
    v_and_b32 v237, 0xffff0000, v236
    v_lshlrev_b32 v236, 16, v236
    v_cvt_pk_bf16_f32 v238, v238, v239
    v_and_b32 v239, 0xffff0000, v238
    v_lshlrev_b32 v238, 16, v238
    v_cvt_pk_bf16_f32 v240, v240, v241
    v_and_b32 v241, 0xffff0000, v240
    v_lshlrev_b32 v240, 16, v240
    v_cvt_pk_bf16_f32 v242, v242, v243
    v_and_b32 v243, 0xffff0000, v242
    v_lshlrev_b32 v242, 16, v242
    v_cvt_pk_bf16_f32 v244, v244, v245
    v_and_b32 v245, 0xffff0000, v244
    v_lshlrev_b32 v244, 16, v244
    v_pk_mul_f32 v[236:237], v[236:237], v[12:13]
    v_pk_mul_f32 v[238:239], v[238:239], v[12:13]
    v_pk_mul_f32 v[240:241], v[240:241], v[12:13]
    v_pk_mul_f32 v[242:243], v[242:243], v[12:13]
    v_pk_mul_f32 v[244:245], v[244:245], v[12:13]
    v_cvt_pk_bf16_f32 v236, v236, v237
    v_and_b32 v237, 0xffff0000, v236
    v_lshlrev_b32 v236, 16, v236
    v_cvt_pk_bf16_f32 v238, v238, v239
    v_and_b32 v239, 0xffff0000, v238
    v_lshlrev_b32 v238, 16, v238
    v_cvt_pk_bf16_f32 v240, v240, v241
    v_and_b32 v241, 0xffff0000, v240
    v_lshlrev_b32 v240, 16, v240
    v_cvt_pk_bf16_f32 v242, v242, v243
    v_and_b32 v243, 0xffff0000, v242
    v_lshlrev_b32 v242, 16, v242
    v_cvt_pk_bf16_f32 v244, v244, v245
    v_and_b32 v245, 0xffff0000, v244
    v_lshlrev_b32 v244, 16, v244
    s_branch .Lsk_q0_1
.Lst_q0_1:
    s_branch .Lrt_q0_1
.Lsk_q0_1:
    s_waitcnt vmcnt(5)
    s_add_u32 m0, s100, 24576
    s_add_u32 s56, s99, 1572864
    buffer_load_dwordx4 v19, s[48:51], s56 offen nt lds
    s_waitcnt vmcnt(4)
    s_add_u32 s63, s69, 57344
    buffer_load_dwordx4 v[132:135], v1, s[40:43], s63 offen nt
    s_waitcnt vmcnt(4)
    s_add_u32 m0, s100, 32768
    s_add_u32 s56, s99, 2097152
    buffer_load_dwordx4 v19, s[48:51], s56 offen nt lds
    s_waitcnt vmcnt(4)
    s_add_u32 s63, s69, 131072
    buffer_load_dwordx4 v[40:43], v1, s[40:43], s63 offen nt
    s_waitcnt vmcnt(4)
    s_add_u32 m0, s100, 40960
    s_add_u32 s56, s99, 2621440
    buffer_load_dwordx4 v19, s[48:51], s56 offen nt lds
    s_waitcnt vmcnt(4)
    s_add_u32 s63, s69, 139264
    buffer_load_dwordx4 v[44:47], v1, s[40:43], s63 offen nt
    s_waitcnt vmcnt(4)
    s_add_u32 m0, s100, 49152
    s_add_u32 s56, s99, 3145728
    buffer_load_dwordx4 v19, s[48:51], s56 offen nt lds
    s_waitcnt vmcnt(4)
    s_add_u32 s63, s69, 147456
    buffer_load_dwordx4 v[72:75], v1, s[40:43], s63 offen nt
    s_waitcnt vmcnt(4)
    s_add_u32 m0, s100, 57344
    s_add_u32 s56, s99, 3670016
    buffer_load_dwordx4 v19, s[48:51], s56 offen nt lds
    s_waitcnt vmcnt(4)
    s_add_u32 s63, s69, 155648
    buffer_load_dwordx4 v[76:79], v1, s[40:43], s63 offen nt
    s_waitcnt vmcnt(4)
    s_add_u32 m0, s100, 65536
    s_add_u32 s56, s99, 4194304
    buffer_load_dwordx4 v19, s[48:51], s56 offen nt lds
    s_waitcnt vmcnt(4)
    s_add_u32 s63, s69, 163840
    buffer_load_dwordx4 v[104:107], v1, s[40:43], s63 offen nt
    s_waitcnt vmcnt(4)
    s_add_u32 s63, s69, 172032
    buffer_load_dwordx4 v[108:111], v1, s[40:43], s63 offen nt
    s_waitcnt vmcnt(4)
    s_add_u32 s63, s69, 180224
    buffer_load_dwordx4 v[136:139], v1, s[40:43], s63 offen nt
    s_waitcnt vmcnt(4)
    s_add_u32 s63, s69, 188416
    buffer_load_dwordx4 v[140:143], v1, s[40:43], s63 offen nt
    s_waitcnt vmcnt(4)
    s_add_u32 s63, s69, 262144
    buffer_load_dwordx4 v[48:51], v1, s[40:43], s63 offen nt
    s_waitcnt vmcnt(4)
    s_add_u32 s63, s69, 270336
    buffer_load_dwordx4 v[52:55], v1, s[40:43], s63 offen nt
    s_and_b32 s12, s0, 0xffffff80
    s_sub_u32 s12, s12, 1024
    buffer_load_dword v28, v4, s[36:39], s12 offen sc1
    buffer_load_dwordx4 v[196:199], v2, s[36:39], s58 offen offset:0 sc1
    buffer_load_dwordx4 v[200:203], v2, s[36:39], s58 offen offset:1024 sc1
    buffer_load_dwordx2 v[204:205], v5, s[36:39], s58 offen offset:0 sc1
    buffer_load_dwordx4 v[206:209], v2, s[36:39], s59 offen offset:0 sc1
    buffer_load_dwordx4 v[210:213], v2, s[36:39], s59 offen offset:1024 sc1
    buffer_load_dwordx2 v[214:215], v5, s[36:39], s59 offen offset:0 sc1
    s_add_u32 s63, s69, 278528
    buffer_load_dwordx4 v[80:83], v1, s[40:43], s63 offen nt
    s_add_u32 s63, s69, 286720
    buffer_load_dwordx4 v[84:87], v1, s[40:43], s63 offen nt
    s_add_u32 s63, s69, 294912
    buffer_load_dwordx4 v[112:115], v1, s[40:43], s63 offen nt
    s_barrier
    ds_read_b64_tr_b16 v[160:161], v20 offset:0
    ds_read_b64_tr_b16 v[162:163], v20 offset:512
    ds_read_b64_tr_b16 v[164:165], v20 offset:8192
    ds_read_b64_tr_b16 v[166:167], v20 offset:8704
    ds_read_b64_tr_b16 v[168:169], v20 offset:16384
    ds_read_b64_tr_b16 v[170:171], v20 offset:16896
    ds_read_b64_tr_b16 v[172:173], v20 offset:24576
    ds_read_b64_tr_b16 v[174:175], v20 offset:25088
    ds_read_b64_tr_b16 v[176:177], v21 offset:0
    ds_read_b64_tr_b16 v[178:179], v21 offset:512
    ds_read_b64_tr_b16 v[180:181], v21 offset:8192
    ds_read_b64_tr_b16 v[182:183], v21 offset:8704
    ds_read_b64_tr_b16 v[184:185], v21 offset:16384
    ds_read_b64_tr_b16 v[186:187], v21 offset:16896
    ds_read_b64_tr_b16 v[188:189], v21 offset:24576
    ds_read_b64_tr_b16 v[190:191], v21 offset:25088
    ds_read_b64_tr_b16 v[192:193], v21 offset:32768
    ds_read_b64_tr_b16 v[194:195], v21 offset:33280
    s_add_u32 s63, s69, 303104
    buffer_load_dwordx4 v[116:119], v1, s[40:43], s63 offen nt
    s_waitcnt vmcnt(4)
    s_branch .gpc_2
.gp_1:
    buffer_load_dwordx4 v[196:199], v2, s[36:39], s58 offen offset:0 sc1
    buffer_load_dwordx4 v[200:203], v2, s[36:39], s58 offen offset:1024 sc1
    buffer_load_dwordx2 v[204:205], v5, s[36:39], s58 offen offset:0 sc1
    buffer_load_dwordx4 v[206:209], v2, s[36:39], s59 offen offset:0 sc1
    buffer_load_dwordx4 v[210:213], v2, s[36:39], s59 offen offset:1024 sc1
    buffer_load_dwordx2 v[214:215], v5, s[36:39], s59 offen offset:0 sc1
    s_waitcnt vmcnt(0)
.gpc_2:
    v_min_u32 v10, v197, v199
    v_max_u32 v11, v197, v199
    v_min3_u32 v10, v10, v201, v203
    v_max3_u32 v11, v11, v201, v203
    v_min3_u32 v10, v10, v205, v207
    v_max3_u32 v11, v11, v205, v207
    v_min3_u32 v10, v10, v209, v211
    v_max3_u32 v11, v11, v209, v211
    v_min3_u32 v10, v10, v213, v215
    v_max3_u32 v11, v11, v213, v215
    v_cmp_eq_u32 vcc, s34, v10
    v_cmp_eq_u32 s[56:57], s34, v11
    s_and_b64 vcc, vcc, s[56:57]
    s_cmp_eq_u64 vcc, -1
    s_nop 2
    s_cbranch_scc1 .gpd_3
    s_sub_u32 s35, s35, 1
    s_cbranch_scc1 .Lexit
    s_branch .gp_1
.gpd_3:
    s_add_u32 s63, s69, 311296
    buffer_load_dwordx4 v[144:147], v1, s[40:43], s63 offen nt
    v_and_b32 v207, 0xffff0000, v206
    v_lshlrev_b32 v206, 16, v206
    v_and_b32 v209, 0xffff0000, v208
    v_lshlrev_b32 v208, 16, v208
    v_and_b32 v211, 0xffff0000, v210
    v_lshlrev_b32 v210, 16, v210
    v_and_b32 v213, 0xffff0000, v212
    v_lshlrev_b32 v212, 16, v212
    v_and_b32 v215, 0xffff0000, v214
    v_lshlrev_b32 v214, 16, v214
    v_and_b32 v197, 0xffff0000, v196
    v_lshlrev_b32 v196, 16, v196
    v_and_b32 v199, 0xffff0000, v198
    v_lshlrev_b32 v198, 16, v198
    v_and_b32 v201, 0xffff0000, v200
    v_lshlrev_b32 v200, 16, v200
    v_and_b32 v203, 0xffff0000, v202
    v_lshlrev_b32 v202, 16, v202
    v_and_b32 v205, 0xffff0000, v204
    v_lshlrev_b32 v204, 16, v204
    v_pk_mul_f32 v[236:237], v[236:237], v[206:207]
    v_pk_mul_f32 v[238:239], v[238:239], v[208:209]
    v_pk_mul_f32 v[240:241], v[240:241], v[210:211]
    v_pk_mul_f32 v[242:243], v[242:243], v[212:213]
    v_pk_mul_f32 v[244:245], v[244:245], v[214:215]
    v_cvt_pk_bf16_f32 v236, v236, v237
    s_branch .Lsk_q0_2
.Lst_q0_2:
    s_branch .Lrt_q0_2
.Lsk_q0_2:
    v_and_b32 v237, 0xffff0000, v236
    v_lshlrev_b32 v236, 16, v236
    v_cvt_pk_bf16_f32 v238, v238, v239
    v_and_b32 v239, 0xffff0000, v238
    v_lshlrev_b32 v238, 16, v238
    v_cvt_pk_bf16_f32 v240, v240, v241
    v_and_b32 v241, 0xffff0000, v240
    v_lshlrev_b32 v240, 16, v240
    v_cvt_pk_bf16_f32 v242, v242, v243
    s_branch .Lsk_q0_3
.Lst_q0_3:
    s_branch .Lrt_q0_3
.Lsk_q0_3:
    v_and_b32 v243, 0xffff0000, v242
    v_lshlrev_b32 v242, 16, v242
    v_cvt_pk_bf16_f32 v244, v244, v245
    v_and_b32 v245, 0xffff0000, v244
    v_lshlrev_b32 v244, 16, v244
    v_pk_add_f32 v[236:237], v[236:237], v[196:197]
    v_pk_add_f32 v[238:239], v[238:239], v[198:199]
    v_pk_add_f32 v[240:241], v[240:241], v[200:201]
    v_pk_add_f32 v[242:243], v[242:243], v[202:203]
    v_pk_add_f32 v[244:245], v[244:245], v[204:205]
    v_cvt_pk_bf16_f32 v246, v236, v237
    v_cvt_pk_bf16_f32 v247, v238, v239
    v_cvt_pk_bf16_f32 v248, v240, v241
    v_cvt_pk_bf16_f32 v249, v242, v243
    v_cvt_pk_bf16_f32 v250, v244, v245
    ds_write_b64 v17, v[246:247] offset:0
    ds_write_b64 v17, v[248:249] offset:512
    ds_write_b32 v18, v250 offset:0
    s_add_u32 s63, s69, 319488
    buffer_load_dwordx4 v[148:151], v1, s[40:43], s63 offen nt
    s_waitcnt lgkmcnt(0)
    s_barrier
    s_add_u32 s63, s69, 393216
    buffer_load_dwordx4 v[56:59], v1, s[40:43], s63 offen nt
    ds_read_b128 v[196:199], v16 offset:0
    ds_read_b128 v[200:203], v16 offset:128
    ds_read_b128 v[204:207], v16 offset:256
    ds_read_b128 v[208:211], v16 offset:384
    ds_read_b128 v[212:215], v16 offset:512
    ds_read_b128 v[216:219], v16 offset:640
    ds_read_b128 v[220:223], v16 offset:768
    ds_read_b128 v[224:227], v16 offset:896
    ds_read_b128 v[228:231], v16 offset:1024
    s_waitcnt lgkmcnt(8)
    v_mfma_f32_16x16x32_bf16 v[232:235], v[160:163], v[196:199], 0
    s_waitcnt lgkmcnt(7)
    v_mfma_f32_16x16x32_bf16 v[232:235], v[164:167], v[200:203], v[232:235]
    s_waitcnt lgkmcnt(6)
    v_mfma_f32_16x16x32_bf16 v[232:235], v[168:171], v[204:207], v[232:235]
    s_waitcnt lgkmcnt(5)
    v_mfma_f32_16x16x32_bf16 v[232:235], v[172:175], v[208:211], v[232:235]
    s_waitcnt lgkmcnt(4)
    v_mfma_f32_16x16x32_bf16 v[232:235], v[176:179], v[212:215], v[232:235]
    s_waitcnt lgkmcnt(3)
    v_mfma_f32_16x16x32_bf16 v[232:235], v[180:183], v[216:219], v[232:235]
    s_waitcnt lgkmcnt(2)
    v_mfma_f32_16x16x32_bf16 v[232:235], v[184:187], v[220:223], v[232:235]
    s_waitcnt lgkmcnt(1)
    v_mfma_f32_16x16x32_bf16 v[232:235], v[188:191], v[224:227], v[232:235]
    s_waitcnt lgkmcnt(0)
    v_mfma_f32_16x16x32_bf16 v[232:235], v[192:195], v[228:231], v[232:235]
    s_nop 7
    v_permlane32_swap_b32 v232, v234
    v_permlane32_swap_b32 v233, v235
    v_cndmask_b32 v233, v233, v234, s[96:97]
    v_cndmask_b32 v232, v232, v235, s[96:97]
    s_nop 1
    v_add_f32_dpp v236, v233, v232 quad_perm:[1,0,3,2] row_mask:0xf bank_mask:0xf
    v_and_b32 v12, 1, v0
    v_lshlrev_b32 v12, 8, v12
    v_bfe_u32 v13, v0, 1, 3
    v_lshl_add_u32 v12, v13, 4, v12
    v_cvt_pk_bf16_f32 v236, v236, v236
    ds_write_b16 v23, v236
    v_mov_b32 v243, s34
    s_waitcnt lgkmcnt(0)
    s_barrier
    ds_read2_b32 v[244:245], v24 offset1:1
    v_mov_b32 v241, s34
    s_waitcnt lgkmcnt(0)
    v_mov_b32 v240, v244
    v_mov_b32 v242, v245
    v_cmp_eq_u32 vcc, s1, v28
    s_add_u32 s57, s101, 0x800000
    s_cmp_eq_u64 vcc, -1
    s_mov_b64 exec, 0xffff
    buffer_store_dwordx4 v[240:243], v12, s[36:39], s57 offen
    s_nop 1
    s_cbranch_scc1 .lq_4
    s_mov_b64 exec, 0xffff
    buffer_store_dwordx4 v[240:243], v12, s[36:39], s101 offen sc1
.lq_4:
    s_mov_b64 exec, -1
    s_mov_b64 s[18:19], 0
    v_mov_b32 v6, 0
    s_waitcnt vmcnt(3)
    s_bitcmp1_b64 s[14:15], 25
    s_cbranch_scc0 1
    s_waitcnt vmcnt(2)
    s_add_u32 s63, s69, 401408
    buffer_load_dwordx4 v[60:63], v1, s[40:43], s63 offen nt
    s_branch .Ln_att
.La_early:
    s_branch .Lsk_a0_0
.Lst_a0_0:
    s_branch .Lrt_a0_0
.Lsk_a0_0:
    s_mov_b32 s14, 0x6ddb76dd
    s_mov_b32 s15, 0xdb76ddb7
    s_add_u32 s30, s70, -55
    s_mov_b32 s31, s70
    s_cmp_ge_u32 s65, 11
    s_cselect_b32 s99, 1, 0
    s_mul_i32 s57, s99, 3
    s_sub_u32 s100, s65, s57
    s_sub_u32 s100, s100, 8
    s_lshl1_add_u32 s99, s64, s99
    s_mov_b32 s48, s12
    s_and_b32 s49, s13, 0xffff
    s_mov_b32 s50, 0x480000
    s_mov_b32 s51, 0x00020000
    v_bfe_u32 v12, v0, 4, 1
    s_and_b32 s56, s3, 1
    s_lshl_b32 s56, s56, 2
    v_lshl_or_b32 v12, v12, 1, s56
    v_and_b32 v13, 7, v0
    v_xor_b32 v12, v12, v13
    v_lshrrev_b32 v13, 3, v0
    v_mul_u32_u24 v13, 1152, v13
    v_lshl_add_u32 v6, v12, 4, v13
    s_mul_i32 s101, s99, 294912
    s_mul_i32 s56, s100, 384
    s_add_u32 s101, s101, s56
    s_mul_i32 s56, s3, 9216
    s_add_u32 s101, s101, s56
    s_lshl_b32 s57, s3, 10
    s_waitcnt vmcnt(4)
    s_add_u32 m0, s57, 0
    s_add_u32 s56, s101, 0
    buffer_load_dwordx4 v6, s[48:51], s56 offen nt lds
    s_waitcnt vmcnt(4)
    s_add_u32 m0, s57, 32768
    s_add_u32 s56, s101, 128
    buffer_load_dwordx4 v6, s[48:51], s56 offen nt lds
    s_waitcnt vmcnt(4)
    s_bitcmp1_b64 s[14:15], 4
    s_cbranch_scc0 1
    s_waitcnt vmcnt(3)
    s_add_u32 s63, s69, 32768
    buffer_load_dwordx4 v[96:99], v1, s[40:43], s63 offen nt
    s_waitcnt vmcnt(4)
    s_waitcnt lgkmcnt(0)
    s_add_u32 s34, s34, 1
    s_getreg_b32 s1, hwreg(HW_REG_XCC_ID)
    s_lshl_b32 s1, s1, 24
    s_add_u32 s1, s1, s34
    s_lshr_b32 s0, s2, 3
    s_lshl_b32 s63, s64, 8
    s_add_u32 s0, s0, s63
    s_lshl2_add_u32 s0, s0, 0x480000
    v_mov_b32 v30, s1
    s_cmp_eq_u32 s3, 0
    s_cselect_b64 exec, 1, 0
    buffer_store_dword v30, v2, s[36:39], s0 offen sc1
    s_mov_b64 exec, -1
    s_bitcmp1_b64 s[14:15], 5
    s_cbranch_scc0 1
    s_waitcnt vmcnt(3)
    s_add_u32 s63, s69, 40960
    buffer_load_dwordx4 v[100:103], v1, s[40:43], s63 offen nt
    s_waitcnt vmcnt(4)
    s_add_u32 m0, s57, 65536
    s_add_u32 s56, s101, 256
    buffer_load_dwordx4 v6, s[48:51], s56 offen nt lds
    s_waitcnt vmcnt(4)
    s_bitcmp1_b64 s[14:15], 6
    s_cbranch_scc0 1
    s_waitcnt vmcnt(3)
    s_add_u32 s63, s69, 49152
    buffer_load_dwordx4 v[128:131], v1, s[40:43], s63 offen nt
    s_waitcnt vmcnt(4)
    s_bitcmp1_b64 s[14:15], 7
    s_cbranch_scc0 1
    s_waitcnt vmcnt(2)
    s_add_u32 s63, s69, 57344
    buffer_load_dwordx4 v[132:135], v1, s[40:43], s63 offen nt
    s_waitcnt vmcnt(3)
    s_add_u32 m0, s57, 8192
    s_add_u32 s56, s101, 73728
    buffer_load_dwordx4 v6, s[48:51], s56 offen nt lds
    s_waitcnt vmcnt(3)
    s_bitcmp1_b64 s[14:15], 8
    s_cbranch_scc0 1
    s_waitcnt vmcnt(2)
    s_add_u32 s63, s69, 131072
    buffer_load_dwordx4 v[40:43], v1, s[40:43], s63 offen nt
    s_waitcnt vmcnt(3)
    s_bitcmp1_b64 s[14:15], 9
    s_cbranch_scc0 1
    s_waitcnt vmcnt(2)
    s_add_u32 s63, s69, 139264
    buffer_load_dwordx4 v[44:47], v1, s[40:43], s63 offen nt
    s_waitcnt vmcnt(3)
    s_add_u32 m0, s57, 40960
    s_add_u32 s56, s101, 73856
    buffer_load_dwordx4 v6, s[48:51], s56 offen nt lds
    s_waitcnt vmcnt(3)
    s_bitcmp1_b64 s[14:15], 10
    s_cbranch_scc0 1
    s_waitcnt vmcnt(2)
    s_add_u32 s63, s69, 147456
    buffer_load_dwordx4 v[72:75], v1, s[40:43], s63 offen nt
    s_waitcnt vmcnt(3)
    s_bitcmp1_b64 s[14:15], 11
    s_cbranch_scc0 1
    s_waitcnt vmcnt(2)
    s_add_u32 s63, s69, 155648
    buffer_load_dwordx4 v[76:79], v1, s[40:43], s63 offen nt
    s_waitcnt vmcnt(3)
    s_add_u32 m0, s57, 73728
    s_add_u32 s56, s101, 73984
    buffer_load_dwordx4 v6, s[48:51], s56 offen nt lds
    s_waitcnt vmcnt(3)
    s_bitcmp1_b64 s[14:15], 12
    s_cbranch_scc0 1
    s_waitcnt vmcnt(2)
    s_add_u32 s63, s69, 163840
    buffer_load_dwordx4 v[104:107], v1, s[40:43], s63 offen nt
    s_waitcnt vmcnt(3)
    s_bitcmp1_b64 s[14:15], 13
    s_cbranch_scc0 1
    s_waitcnt vmcnt(2)
    s_add_u32 s63, s69, 172032
    buffer_load_dwordx4 v[108:111], v1, s[40:43], s63 offen nt
    s_waitcnt vmcnt(3)
    s_add_u32 m0, s57, 16384
    s_add_u32 s56, s101, 147456
    buffer_load_dwordx4 v6, s[48:51], s56 offen nt lds
    s_waitcnt vmcnt(3)
    s_bitcmp1_b64 s[14:15], 14
    s_cbranch_scc0 1
    s_waitcnt vmcnt(2)
    s_add_u32 s63, s69, 180224
    buffer_load_dwordx4 v[136:139], v1, s[40:43], s63 offen nt
    s_waitcnt vmcnt(3)
    s_bitcmp1_b64 s[14:15], 15
    s_cbranch_scc0 1
    s_waitcnt vmcnt(2)
    s_add_u32 s63, s69, 188416
    buffer_load_dwordx4 v[140:143], v1, s[40:43], s63 offen nt
    s_waitcnt vmcnt(3)
    s_add_u32 m0, s57, 49152
    s_add_u32 s56, s101, 147584
    buffer_load_dwordx4 v6, s[48:51], s56 offen nt lds
    s_waitcnt vmcnt(3)
    s_bitcmp1_b64 s[14:15], 16
    s_cbranch_scc0 1
    s_waitcnt vmcnt(2)
    s_add_u32 s63, s69, 262144
    buffer_load_dwordx4 v[48:51], v1, s[40:43], s63 offen nt
    s_waitcnt vmcnt(3)
    s_bitcmp1_b64 s[14:15], 17
    s_cbranch_scc0 1
    s_waitcnt vmcnt(2)
    s_add_u32 s63, s69, 270336
    buffer_load_dwordx4 v[52:55], v1, s[40:43], s63 offen nt
    s_waitcnt vmcnt(3)
    s_add_u32 m0, s57, 81920
    s_add_u32 s56, s101, 147712
    buffer_load_dwordx4 v6, s[48:51], s56 offen nt lds
    s_waitcnt vmcnt(3)
    s_bitcmp1_b64 s[14:15], 18
    s_cbranch_scc0 1
    s_waitcnt vmcnt(2)
    s_add_u32 s63, s69, 278528
    buffer_load_dwordx4 v[80:83], v1, s[40:43], s63 offen nt
    s_waitcnt vmcnt(3)
    s_bitcmp1_b64 s[14:15], 19
    s_cbranch_scc0 1
    s_waitcnt vmcnt(2)
    s_add_u32 s63, s69, 286720
    buffer_load_dwordx4 v[84:87], v1, s[40:43], s63 offen nt
    s_waitcnt vmcnt(3)
    s_bitcmp1_b64 s[14:15], 20
    s_cbranch_scc0 1
    s_waitcnt vmcnt(2)
    s_add_u32 s63, s69, 294912
    buffer_load_dwordx4 v[112:115], v1, s[40:43], s63 offen nt
    s_waitcnt vmcnt(3)
    s_bitcmp1_b64 s[14:15], 21
    s_cbranch_scc0 1
    s_waitcnt vmcnt(2)
    s_add_u32 s63, s69, 303104
    buffer_load_dwordx4 v[116:119], v1, s[40:43], s63 offen nt
    s_waitcnt vmcnt(3)
    s_bitcmp1_b64 s[14:15], 22
    s_cbranch_scc0 1
    s_waitcnt vmcnt(2)
    s_add_u32 s63, s69, 311296
    buffer_load_dwordx4 v[144:147], v1, s[40:43], s63 offen nt
    s_branch .Lsk_a0_1
.Lst_a0_1:
    s_branch .Lrt_a0_1
.Lsk_a0_1:
    s_waitcnt vmcnt(3)
    s_bitcmp1_b64 s[14:15], 23
    s_cbranch_scc0 1
    s_waitcnt vmcnt(2)
    s_add_u32 s63, s69, 319488
    buffer_load_dwordx4 v[148:151], v1, s[40:43], s63 offen nt
    s_waitcnt vmcnt(3)
    s_bitcmp1_b64 s[14:15], 24
    s_cbranch_scc0 1
    s_waitcnt vmcnt(2)
    s_add_u32 s63, s69, 393216
    buffer_load_dwordx4 v[56:59], v1, s[40:43], s63 offen nt
    s_waitcnt vmcnt(3)
    s_bitcmp1_b64 s[14:15], 25
    s_cbranch_scc0 1
    s_waitcnt vmcnt(2)
    s_add_u32 s63, s69, 401408
    buffer_load_dwordx4 v[60:63], v1, s[40:43], s63 offen nt
    s_mov_b64 s[18:19], -1
.Ln_att:
    v_and_b32 v8, 1, v0
    v_lshlrev_b32 v8, 8, v8
    v_and_b32 v9, 0x3c, v0
    v_lshl_add_u32 v9, v9, 2, v8
    v_add_u32 v7, v9, v8
    v_and_b32 v9, 0x3c, v0
    v_lshrrev_b32 v8, 4, v8
    v_and_b32 v9, 4, v0
    v_lshl_add_u32 v9, v9, 3, v8
    s_lshl_b32 s58, s66, 14
    s_lshl_b32 s59, s67, 10
    s_add_u32 s58, s58, s59
    s_add_u32 s58, s58, 0x70000
    s_lshl4_add_u32 s59, s66, s67
    s_lshl_b32 s59, s59, 7
    s_add_u32 s59, s59, 0x430000
    s_memrealtime s[8:9]
    s_waitcnt vmcnt(8)
    s_waitcnt lgkmcnt(0)
    s_sub_u32 s8, s8, s30
    s_cmpk_ge_u32 s8, 1207
    s_cbranch_scc1 .ap_5
    s_waitcnt vmcnt(5)
    s_cmpk_ge_u32 s8, 1107
    s_cbranch_scc1 .ap_5
    s_waitcnt vmcnt(3)
    s_bitcmp1_b64 s[14:15], 26
    s_cbranch_scc0 1
    s_waitcnt vmcnt(2)
    s_cmpk_ge_u32 s8, 987
    s_cbranch_scc1 .ap_5
    s_waitcnt vmcnt(1)
.ap_5:
    s_add_u32 s63, s69, 409600
    buffer_load_dwordx4 v[88:91], v1, s[40:43], s63 offen nt
    v_and_b32 v157, 7, v0
    v_lshlrev_b32 v157, 2, v157
    s_mov_b32 s63, 0x4a1000
    buffer_load_dword v156, v157, s[36:39], s63 offen
    s_cmp_eq_u32 s3, 0
    s_cbranch_scc1 .Lst_n1_0
.Lrt_n1_0:
    s_cmp_eq_u32 s3, 1
    s_cbranch_scc1 .Lst_n1_1
    s_cmp_eq_u32 s3, 2
    s_cbranch_scc1 .Lst_n1_2
    s_cmp_eq_u32 s3, 3
    s_cbranch_scc1 .Lst_n1_3
    s_cmp_eq_u32 s3, 4
    s_cbranch_scc1 .Lst_n1_4
    s_cmp_eq_u32 s3, 5
    s_cbranch_scc1 .Lst_n1_5
    s_cmp_eq_u32 s3, 6
    s_cbranch_scc1 .Lst_n1_6
    s_cmp_eq_u32 s3, 7
    s_cbranch_scc1 .Lst_n1_7
    s_cmp_eq_u32 s3, 0
    s_cbranch_scc1 .Lrt_n1_8
.Lrt_n1_1:
.Lrt_n1_2:
.Lrt_n1_3:
.Lrt_n1_4:
.Lrt_n1_5:
.Lrt_n1_6:
.Lrt_n1_7:
.Lrt_n1_8:
    s_memrealtime s[8:9]
    s_waitcnt vmcnt(9)
    s_waitcnt lgkmcnt(0)
    s_sub_u32 s8, s8, s30
    s_cmpk_ge_u32 s8, 1234
    s_cbranch_scc1 .ap_6
    s_waitcnt vmcnt(6)
    s_cmpk_ge_u32 s8, 1134
    s_cbranch_scc1 .ap_6
    s_waitcnt vmcnt(4)
    s_bitcmp1_b64 s[14:15], 27
    s_cbranch_scc0 1
    s_waitcnt vmcnt(3)
    s_cmpk_ge_u32 s8, 1014
    s_cbranch_scc1 .ap_6
    s_waitcnt vmcnt(2)
.ap_6:
    s_add_u32 s63, s69, 417792
    buffer_load_dwordx4 v[92:95], v1, s[40:43], s63 offen nt
    s_memrealtime s[8:9]
    s_waitcnt vmcnt(9)
    s_waitcnt lgkmcnt(0)
    s_sub_u32 s8, s8, s30
    s_cmpk_ge_u32 s8, 1261
    s_cbranch_scc1 .ap_7
    s_waitcnt vmcnt(6)
    s_cmpk_ge_u32 s8, 1161
    s_cbranch_scc1 .ap_7
    s_waitcnt vmcnt(4)
    s_bitcmp1_b64 s[14:15], 28
    s_cbranch_scc0 1
    s_waitcnt vmcnt(3)
    s_cmpk_ge_u32 s8, 1041
    s_cbranch_scc1 .ap_7
    s_waitcnt vmcnt(2)
.ap_7:
    s_add_u32 s63, s69, 425984
    buffer_load_dwordx4 v[120:123], v1, s[40:43], s63 offen nt
    s_memrealtime s[8:9]
    s_waitcnt vmcnt(9)
    s_waitcnt lgkmcnt(0)
    s_sub_u32 s8, s8, s30
    s_cmpk_ge_u32 s8, 1288
    s_cbranch_scc1 .ap_8
    s_waitcnt vmcnt(6)
    s_cmpk_ge_u32 s8, 1188
    s_cbranch_scc1 .ap_8
    s_waitcnt vmcnt(4)
    s_bitcmp1_b64 s[14:15], 29
    s_cbranch_scc0 1
    s_waitcnt vmcnt(3)
    s_cmpk_ge_u32 s8, 1068
    s_cbranch_scc1 .ap_8
    s_waitcnt vmcnt(1)
.ap_8:
    s_add_u32 s63, s69, 434176
    buffer_load_dwordx4 v[124:127], v1, s[40:43], s63 offen nt
    s_memrealtime s[8:9]
    s_waitcnt vmcnt(9)
    s_waitcnt lgkmcnt(0)
    s_sub_u32 s8, s8, s30
    s_cmpk_ge_u32 s8, 1315
    s_cbranch_scc1 .ap_9
    s_waitcnt vmcnt(6)
    s_cmpk_ge_u32 s8, 1215
    s_cbranch_scc1 .ap_9
    s_waitcnt vmcnt(4)
    s_bitcmp1_b64 s[14:15], 30
    s_cbranch_scc0 1
    s_waitcnt vmcnt(2)
    s_cmpk_ge_u32 s8, 1095
    s_cbranch_scc1 .ap_9
    s_waitcnt vmcnt(1)
.ap_9:
    s_add_u32 s63, s69, 442368
    buffer_load_dwordx4 v[152:155], v1, s[40:43], s63 offen nt
    s_waitcnt vmcnt(4)
    s_sub_u32 s63, s70, 300
    v_subrev_u32 v156, s63, v156
    v_mov_b32 v157, 600
    v_cmp_lt_u32 s[8:9], v156, v157
    v_add_u32_dpp v156, v156, v156 quad_perm:[1,0,3,2] row_mask:0xf bank_mask:0xf
    s_nop 1
    v_add_u32_dpp v156, v156, v156 quad_perm:[2,3,0,1] row_mask:0xf bank_mask:0xf
    s_nop 1
    v_add_u32_dpp v156, v156, v156 row_ror:4 row_mask:0xf bank_mask:0xf
    s_nop 0
    v_readfirstlane_b32 s63, v156
    s_cmp_eq_u64 s[8:9], -1
    s_nop 3
    s_cbranch_scc0 .et_10
    s_lshr_b32 s63, s63, 3
    s_sub_u32 s63, s63, 300
    s_add_u32 s30, s30, s63
    s_add_u32 s31, s31, s63
.et_10:
    s_and_b32 s0, s0, 0xffffff80
    s_sub_u32 s0, s0, 1024
    buffer_load_dword v28, v4, s[36:39], s0 offen sc1
    s_memrealtime s[8:9]
    s_waitcnt lgkmcnt(0)
    s_sub_u32 s8, s8, s30
    s_cmpk_ge_u32 s8, 1342
    s_cbranch_scc1 .ap_11
    s_waitcnt vmcnt(5)
    s_cmpk_ge_u32 s8, 1242
    s_cbranch_scc1 .ap_11
    s_waitcnt vmcnt(4)
    s_bitcmp1_b64 s[14:15], 31
    s_cbranch_scc0 1
    s_waitcnt vmcnt(3)
    s_cmpk_ge_u32 s8, 1122
    s_cbranch_scc1 .ap_11
    s_waitcnt vmcnt(2)
.ap_11:
    s_add_u32 s63, s69, 450560
    buffer_load_dwordx4 v[156:159], v1, s[40:43], s63 offen nt
    s_memrealtime s[8:9]
    s_waitcnt lgkmcnt(0)
    s_sub_u32 s8, s8, s30
    s_cmpk_ge_u32 s8, 1369
    s_cbranch_scc1 .ap_12
    s_waitcnt vmcnt(6)
    s_cmpk_ge_u32 s8, 1269
    s_cbranch_scc1 .ap_12
    s_waitcnt vmcnt(4)
    s_bitcmp1_b64 s[14:15], 32
    s_cbranch_scc0 1
    s_waitcnt vmcnt(3)
    s_cmpk_ge_u32 s8, 1149
    s_cbranch_scc1 .ap_12
    s_waitcnt vmcnt(2)
.ap_12:
    v_bfe_u32 v1, v0, 4, 2
    v_and_b32 v10, 0xf0, v2
    v_lshlrev_b32 v1, 2, v1
    v_bfe_u32 v1, s6, v1, 4
    v_lshl_add_u32 v1, v1, 8, v10
    s_add_u32 s63, s69, 0
    buffer_load_dwordx4 v[160:163], v1, s[44:47], s63 offen nt
    s_memrealtime s[8:9]
    s_waitcnt lgkmcnt(0)
    s_sub_u32 s8, s8, s30
    s_cmpk_ge_u32 s8, 1396
    s_cbranch_scc1 .ap_13
    s_waitcnt vmcnt(6)
    s_cmpk_ge_u32 s8, 1296
    s_cbranch_scc1 .ap_13
    s_waitcnt vmcnt(4)
    s_bitcmp1_b64 s[14:15], 33
    s_cbranch_scc0 1
    s_waitcnt vmcnt(3)
    s_cmpk_ge_u32 s8, 1176
    s_cbranch_scc1 .ap_13
    s_waitcnt vmcnt(1)
.ap_13:
    s_add_u32 s63, s69, 8192
    buffer_load_dwordx4 v[164:167], v1, s[44:47], s63 offen nt
    s_memrealtime s[8:9]
    s_waitcnt lgkmcnt(0)
    s_sub_u32 s8, s8, s30
    s_cmpk_ge_u32 s8, 1423
    s_cbranch_scc1 .ap_14
    s_waitcnt vmcnt(6)
    s_cmpk_ge_u32 s8, 1323
    s_cbranch_scc1 .ap_14
    s_branch .Lsk_n1_0
.Lst_n1_0:
    s_branch .Lrt_n1_0
.Lsk_n1_0:
    s_waitcnt vmcnt(4)
    s_bitcmp1_b64 s[14:15], 34
    s_cbranch_scc0 1
    s_waitcnt vmcnt(2)
    s_cmpk_ge_u32 s8, 1203
    s_cbranch_scc1 .ap_14
    s_waitcnt vmcnt(1)
.ap_14:
    s_add_u32 s63, s69, 16384
    buffer_load_dwordx4 v[168:171], v1, s[44:47], s63 offen nt
    s_memrealtime s[8:9]
    s_waitcnt lgkmcnt(0)
    s_sub_u32 s8, s8, s30
    s_cmpk_ge_u32 s8, 1450
    s_cbranch_scc1 .ap_15
    s_waitcnt vmcnt(6)
    s_cmpk_ge_u32 s8, 1350
    s_cbranch_scc1 .ap_15
    s_waitcnt vmcnt(3)
    s_bitcmp1_b64 s[14:15], 35
    s_cbranch_scc0 1
    s_waitcnt vmcnt(2)
    s_cmpk_ge_u32 s8, 1230
    s_cbranch_scc1 .ap_15
    s_waitcnt vmcnt(1)
.ap_15:
    s_add_u32 s63, s69, 24576
    buffer_load_dwordx4 v[172:175], v1, s[44:47], s63 offen nt
    s_waitcnt vmcnt(5)
    v_cmp_eq_u32 vcc, s1, v28
    s_cmp_eq_u64 vcc, -1
    s_cselect_b32 s0, 0x800000, 0
    s_add_u32 s58, s58, s0
    buffer_load_dwordx4 v[16:19], v7, s[36:39], s58 offen offset:0 sc1
    buffer_load_dwordx4 v[20:23], v7, s[36:39], s58 offen offset:256 sc1
    s_memrealtime s[8:9]
    s_waitcnt lgkmcnt(0)
    s_sub_u32 s8, s8, s30
    s_cmpk_ge_u32 s8, 1479
    s_cbranch_scc1 .ap_16
    s_waitcnt vmcnt(5)
    s_cmpk_ge_u32 s8, 1379
    s_cbranch_scc1 .ap_16
    s_waitcnt vmcnt(3)
    s_bitcmp1_b64 s[14:15], 36
    s_cbranch_scc0 1
    s_waitcnt vmcnt(2)
    s_cmpk_ge_u32 s8, 1259
    s_cbranch_scc1 .ap_16
    s_waitcnt vmcnt(1)
.ap_16:
    s_add_u32 s63, s69, 32768
    buffer_load_dwordx4 v[176:179], v1, s[44:47], s63 offen nt
    s_memrealtime s[8:9]
    s_waitcnt lgkmcnt(0)
    s_sub_u32 s8, s8, s30
    s_cmpk_ge_u32 s8, 1509
    s_cbranch_scc1 .ap_17
    s_waitcnt vmcnt(5)
    s_cmpk_ge_u32 s8, 1409
    s_cbranch_scc1 .ap_17
    s_waitcnt vmcnt(3)
    s_bitcmp1_b64 s[14:15], 37
    s_cbranch_scc0 1
    s_waitcnt vmcnt(2)
    s_cmpk_ge_u32 s8, 1289
    s_cbranch_scc1 .ap_17
    s_waitcnt vmcnt(1)
.ap_17:
    s_add_u32 s63, s69, 40960
    buffer_load_dwordx4 v[180:183], v1, s[44:47], s63 offen nt
    s_memrealtime s[8:9]
    s_waitcnt vmcnt(8)
    s_waitcnt lgkmcnt(0)
    s_sub_u32 s8, s8, s30
    s_cmpk_ge_u32 s8, 1539
    s_cbranch_scc1 .ap_18
    s_waitcnt vmcnt(5)
    s_cmpk_ge_u32 s8, 1439
    s_cbranch_scc1 .ap_18
    s_waitcnt vmcnt(3)
    s_bitcmp1_b64 s[14:15], 38
    s_cbranch_scc0 1
    s_waitcnt vmcnt(2)
    s_cmpk_ge_u32 s8, 1319
    s_cbranch_scc1 .ap_18
    s_waitcnt vmcnt(1)
.ap_18:
    s_add_u32 s63, s69, 49152
    buffer_load_dwordx4 v[184:187], v1, s[44:47], s63 offen nt
    s_waitcnt vmcnt(3)
    s_branch .gpc_20
.gp_19:
    s_xor_b32 s58, s58, 0x800000
    buffer_load_dwordx4 v[16:19], v7, s[36:39], s58 offen offset:0 sc1
    buffer_load_dwordx4 v[20:23], v7, s[36:39], s58 offen offset:256 sc1
    s_waitcnt vmcnt(0)
.gpc_20:
    v_min_u32 v10, v17, v19
    v_max_u32 v11, v17, v19
    v_min3_u32 v10, v10, v21, v23
    v_max3_u32 v11, v11, v21, v23
    v_cmp_eq_u32 vcc, s34, v10
    v_cmp_eq_u32 s[56:57], s34, v11
    s_and_b64 vcc, vcc, s[56:57]
    s_cmp_eq_u64 vcc, -1
    s_nop 2
    s_cbranch_scc1 .gpd_21
    s_sub_u32 s35, s35, 1
    s_cbranch_scc1 .Lexit
    s_sleep 1
    s_branch .gp_19
.gpd_21:
    s_mov_b32 vcc_lo, 0xcccccccc
    s_mov_b32 vcc_hi, 0xcccccccc
    v_cndmask_b32_e64 v24, v16, 0, vcc
    v_cndmask_b32_e64 v25, v18, 0, vcc
    v_cndmask_b32_e64 v26, v20, 0, vcc
    v_cndmask_b32_e64 v27, v22, 0, vcc
    v_cndmask_b32_e32 v28, 0, v16, vcc
    v_cndmask_b32_e32 v29, 0, v18, vcc
    v_cndmask_b32_e32 v30, 0, v20, vcc
    v_cndmask_b32_e32 v31, 0, v22, vcc
    v_mfma_f32_16x16x32_bf16 v[16:19], v[32:35], v[24:27], 0
    v_mfma_f32_16x16x32_bf16 v[32:35], v[40:43], v[24:27], 0
    v_mfma_f32_16x16x32_bf16 v[16:19], v[36:39], v[28:31], v[16:19]
    v_mfma_f32_16x16x32_bf16 v[40:43], v[48:51], v[24:27], 0
    v_mfma_f32_16x16x32_bf16 v[32:35], v[44:47], v[28:31], v[32:35]
    v_mfma_f32_16x16x32_bf16 v[48:51], v[56:59], v[24:27], 0
    v_mfma_f32_16x16x32_bf16 v[40:43], v[52:55], v[28:31], v[40:43]
    v_mfma_f32_16x16x32_bf16 v[56:59], v[64:67], v[24:27], 0
    v_mfma_f32_16x16x32_bf16 v[48:51], v[60:63], v[28:31], v[48:51]
    s_nop 1
    v_add_f32_dpp v10, v17, v16 row_ror:12 row_mask:0xf bank_mask:0x1
    s_memrealtime s[8:9]
    s_waitcnt lgkmcnt(0)
    s_sub_u32 s8, s8, s30
    s_cmpk_ge_u32 s8, 1569
    s_nop 0
    s_cbranch_scc1 .ap_22
    s_waitcnt vmcnt(3)
    s_cmpk_ge_u32 s8, 1469
    s_cbranch_scc1 .ap_22
    s_waitcnt vmcnt(3)
    s_bitcmp1_b64 s[14:15], 39
    s_cbranch_scc0 1
    s_waitcnt vmcnt(2)
    s_cmpk_ge_u32 s8, 1349
    s_cbranch_scc1 .ap_22
    s_waitcnt vmcnt(1)
.ap_22:
    s_add_u32 s63, s69, 57344
    buffer_load_dwordx4 v[188:191], v1, s[44:47], s63 offen nt
    v_mfma_f32_16x16x32_bf16 v[64:67], v[72:75], v[24:27], 0
    v_mfma_f32_16x16x32_bf16 v[56:59], v[68:71], v[28:31], v[56:59]
    v_add_f32_dpp v11, v33, v32 row_ror:12 row_mask:0xf bank_mask:0x1
    v_add_f32_dpp v10, v18, v10 row_ror:8 row_mask:0xf bank_mask:0x1
    v_mfma_f32_16x16x32_bf16 v[72:75], v[80:83], v[24:27], 0
    v_mfma_f32_16x16x32_bf16 v[64:67], v[76:79], v[28:31], v[64:67]
    v_add_f32_dpp v12, v41, v40 row_ror:12 row_mask:0xf bank_mask:0x1
    v_add_f32_dpp v11, v34, v11 row_ror:8 row_mask:0xf bank_mask:0x1
    v_add_f32_dpp v10, v19, v10 row_ror:4 row_mask:0xf bank_mask:0x1
    v_mfma_f32_16x16x32_bf16 v[80:83], v[88:91], v[24:27], 0
    v_mfma_f32_16x16x32_bf16 v[72:75], v[84:87], v[28:31], v[72:75]
    v_add_f32_dpp v13, v49, v48 row_ror:12 row_mask:0xf bank_mask:0x1
    v_add_f32_dpp v12, v42, v12 row_ror:8 row_mask:0xf bank_mask:0x1
    v_add_f32_dpp v11, v35, v11 row_ror:4 row_mask:0xf bank_mask:0x1
    v_mfma_f32_16x16x32_bf16 v[88:91], v[96:99], v[24:27], 0
    v_mfma_f32_16x16x32_bf16 v[80:83], v[92:95], v[28:31], v[80:83]
    v_add_f32_dpp v10, v58, v57 row_ror:12 row_mask:0xf bank_mask:0x2
    v_add_f32_dpp v13, v50, v13 row_ror:8 row_mask:0xf bank_mask:0x1
    v_add_f32_dpp v12, v43, v12 row_ror:4 row_mask:0xf bank_mask:0x1
    s_memrealtime s[8:9]
    s_waitcnt lgkmcnt(0)
    s_sub_u32 s8, s8, s30
    s_cmpk_ge_u32 s8, 1599
    s_nop 0
    s_cbranch_scc1 .ap_23
    s_waitcnt vmcnt(4)
    s_cmpk_ge_u32 s8, 1499
    s_cbranch_scc1 .ap_23
    s_waitcnt vmcnt(3)
    s_bitcmp1_b64 s[14:15], 40
    s_cbranch_scc0 1
    s_waitcnt vmcnt(2)
    s_cmpk_ge_u32 s8, 1379
    s_cbranch_scc1 .ap_23
    s_waitcnt vmcnt(1)
.ap_23:
    s_add_u32 s63, s69, 131072
    buffer_load_dwordx4 v[192:195], v1, s[44:47], s63 offen nt
    v_mfma_f32_16x16x32_bf16 v[96:99], v[104:107], v[24:27], 0
    v_mfma_f32_16x16x32_bf16 v[88:91], v[100:103], v[28:31], v[88:91]
    v_add_f32_dpp v11, v66, v65 row_ror:12 row_mask:0xf bank_mask:0x2
    v_add_f32_dpp v10, v59, v10 row_ror:8 row_mask:0xf bank_mask:0x2
    v_add_f32_dpp v13, v51, v13 row_ror:4 row_mask:0xf bank_mask:0x1
    v_mfma_f32_16x16x32_bf16 v[104:107], v[112:115], v[24:27], 0
    v_mfma_f32_16x16x32_bf16 v[96:99], v[108:111], v[28:31], v[96:99]
    v_add_f32_dpp v12, v74, v73 row_ror:12 row_mask:0xf bank_mask:0x2
    v_add_f32_dpp v11, v67, v11 row_ror:8 row_mask:0xf bank_mask:0x2
    v_add_f32_dpp v10, v56, v10 row_ror:4 row_mask:0xf bank_mask:0x2
    v_mfma_f32_16x16x32_bf16 v[112:115], v[120:123], v[24:27], 0
    v_mfma_f32_16x16x32_bf16 v[104:107], v[116:119], v[28:31], v[104:107]
    s_branch .Lsk_n1_1
.Lst_n1_1:
    s_branch .Lrt_n1_1
.Lsk_n1_1:
    v_add_f32_dpp v13, v82, v81 row_ror:12 row_mask:0xf bank_mask:0x2
    v_add_f32_dpp v12, v75, v12 row_ror:8 row_mask:0xf bank_mask:0x2
    v_add_f32_dpp v11, v64, v11 row_ror:4 row_mask:0xf bank_mask:0x2
    v_mfma_f32_16x16x32_bf16 v[120:123], v[128:131], v[24:27], 0
    v_mfma_f32_16x16x32_bf16 v[112:115], v[124:127], v[28:31], v[112:115]
    v_add_f32_dpp v10, v91, v90 row_ror:12 row_mask:0xf bank_mask:0x4
    v_add_f32_dpp v13, v83, v13 row_ror:8 row_mask:0xf bank_mask:0x2
    v_add_f32_dpp v12, v72, v12 row_ror:4 row_mask:0xf bank_mask:0x2
    s_memrealtime s[8:9]
    s_waitcnt lgkmcnt(0)
    s_sub_u32 s8, s8, s30
    s_cmpk_ge_u32 s8, 1629
    s_nop 0
    s_cbranch_scc1 .ap_24
    s_waitcnt vmcnt(5)
    s_cmpk_ge_u32 s8, 1529
    s_cbranch_scc1 .ap_24
    s_waitcnt vmcnt(3)
    s_bitcmp1_b64 s[14:15], 41
    s_cbranch_scc0 1
    s_waitcnt vmcnt(2)
    s_cmpk_ge_u32 s8, 1409
    s_cbranch_scc1 .ap_24
    s_waitcnt vmcnt(1)
.ap_24:
    s_add_u32 s63, s69, 139264
    buffer_load_dwordx4 v[196:199], v1, s[44:47], s63 offen nt
    v_mfma_f32_16x16x32_bf16 v[128:131], v[136:139], v[24:27], 0
    v_mfma_f32_16x16x32_bf16 v[120:123], v[132:135], v[28:31], v[120:123]
    v_add_f32_dpp v11, v99, v98 row_ror:12 row_mask:0xf bank_mask:0x4
    v_add_f32_dpp v10, v88, v10 row_ror:8 row_mask:0xf bank_mask:0x4
    v_add_f32_dpp v13, v80, v13 row_ror:4 row_mask:0xf bank_mask:0x2
    s_branch .Lsk_n1_2
.Lst_n1_2:
    s_branch .Lrt_n1_2
.Lsk_n1_2:
    v_mfma_f32_16x16x32_bf16 v[136:139], v[144:147], v[24:27], 0
    v_mfma_f32_16x16x32_bf16 v[128:131], v[140:143], v[28:31], v[128:131]
    v_add_f32_dpp v12, v107, v106 row_ror:12 row_mask:0xf bank_mask:0x4
    v_add_f32_dpp v11, v96, v11 row_ror:8 row_mask:0xf bank_mask:0x4
    v_add_f32_dpp v10, v89, v10 row_ror:4 row_mask:0xf bank_mask:0x4
    v_mfma_f32_16x16x32_bf16 v[144:147], v[152:155], v[24:27], 0
    v_mfma_f32_16x16x32_bf16 v[136:139], v[148:151], v[28:31], v[136:139]
    v_add_f32_dpp v13, v115, v114 row_ror:12 row_mask:0xf bank_mask:0x4
    v_add_f32_dpp v12, v104, v12 row_ror:8 row_mask:0xf bank_mask:0x4
    v_add_f32_dpp v11, v97, v11 row_ror:4 row_mask:0xf bank_mask:0x4
    v_mfma_f32_16x16x32_bf16 v[144:147], v[156:159], v[28:31], v[144:147]
    v_add_f32_dpp v10, v120, v123 row_ror:12 row_mask:0xf bank_mask:0x8
    v_add_f32_dpp v13, v112, v13 row_ror:8 row_mask:0xf bank_mask:0x4
    v_add_f32_dpp v12, v105, v12 row_ror:4 row_mask:0xf bank_mask:0x4
    s_memrealtime s[8:9]
    s_waitcnt lgkmcnt(0)
    s_sub_u32 s8, s8, s30
    s_cmpk_ge_u32 s8, 1659
    s_nop 0
    s_cbranch_scc1 .ap_25
    s_waitcnt vmcnt(5)
    s_cmpk_ge_u32 s8, 1559
    s_cbranch_scc1 .ap_25
    s_waitcnt vmcnt(3)
    s_bitcmp1_b64 s[14:15], 42
    s_cbranch_scc0 1
    s_waitcnt vmcnt(2)
    s_cmpk_ge_u32 s8, 1439
    s_cbranch_scc1 .ap_25
    s_waitcnt vmcnt(1)
.ap_25:
    s_add_u32 s63, s69, 147456
    buffer_load_dwordx4 v[200:203], v1, s[44:47], s63 offen nt
    v_add_f32_dpp v11, v128, v131 row_ror:12 row_mask:0xf bank_mask:0x8
    v_add_f32_dpp v10, v121, v10 row_ror:8 row_mask:0xf bank_mask:0x8
    v_add_f32_dpp v13, v113, v13 row_ror:4 row_mask:0xf bank_mask:0x4
    v_add_f32_dpp v12, v136, v139 row_ror:12 row_mask:0xf bank_mask:0x8
    v_add_f32_dpp v11, v129, v11 row_ror:8 row_mask:0xf bank_mask:0x8
    v_add_f32_dpp v10, v122, v10 row_ror:4 row_mask:0xf bank_mask:0x8
    v_add_f32_dpp v13, v144, v147 row_ror:12 row_mask:0xf bank_mask:0x8
    v_add_f32_dpp v12, v137, v12 row_ror:8 row_mask:0xf bank_mask:0x8
    v_add_f32_dpp v11, v130, v11 row_ror:4 row_mask:0xf bank_mask:0x8
    v_add_f32_dpp v13, v145, v13 row_ror:8 row_mask:0xf bank_mask:0x8
    v_add_f32_dpp v12, v138, v12 row_ror:4 row_mask:0xf bank_mask:0x8
    s_memrealtime s[8:9]
    s_waitcnt lgkmcnt(0)
    s_sub_u32 s8, s8, s30
    s_cmpk_ge_u32 s8, 1689
    s_cbranch_scc1 .ap_26
    s_waitcnt vmcnt(5)
    s_cmpk_ge_u32 s8, 1589
    s_cbranch_scc1 .ap_26
    s_waitcnt vmcnt(3)
    s_bitcmp1_b64 s[14:15], 43
    s_cbranch_scc0 1
    s_waitcnt vmcnt(2)
    s_cmpk_ge_u32 s8, 1469
    s_cbranch_scc1 .ap_26
    s_waitcnt vmcnt(1)
.ap_26:
    s_add_u32 s63, s69, 155648
    buffer_load_dwordx4 v[204:207], v1, s[44:47], s63 offen nt
    v_add_f32_dpp v13, v146, v13 row_ror:4 row_mask:0xf bank_mask:0x8
    s_mov_b32 s60, 0x3db504f3
    s_mov_b32 s61, 0x3db504f3
    v_cvt_pk_bf16_f32 v10, v10, v11
    v_and_b32 v11, 0xffff0000, v10
    v_lshlrev_b32 v10, 16, v10
    v_cvt_pk_bf16_f32 v12, v12, v13
    v_and_b32 v13, 0xffff0000, v12
    v_lshlrev_b32 v12, 16, v12
    v_pk_mul_f32 v[10:11], v[10:11], s[60:61]
    v_pk_mul_f32 v[12:13], v[12:13], s[60:61]
    v_cvt_pk_bf16_f32 v10, v10, v11
    v_and_b32 v11, 0xffff0000, v10
    v_lshlrev_b32 v10, 16, v10
    v_cvt_pk_bf16_f32 v12, v12, v13
    v_and_b32 v13, 0xffff0000, v12
    v_lshlrev_b32 v12, 16, v12
    v_max_f32 v14, v10, v11
    v_max3_f32 v14, v14, v12, v13
    s_mov_b32 s60, 0x3fb8aa3b
    v_mov_b32 v22, s34
    v_mov_b32 v23, s34
    v_max_f32_dpp v14, v14, v14 quad_perm:[2,3,0,1] row_mask:0xf bank_mask:0xf
    s_nop 1
    v_max_f32_dpp v14, v14, v14 row_ror:4 row_mask:0xf bank_mask:0xf
    s_nop 1
    v_max_f32_dpp v14, v14, v14 row_ror:8 row_mask:0xf bank_mask:0xf
    v_mov_b32 v15, v14
    s_nop 1
    v_permlane16_swap_b32 v15, v14
    v_max_f32 v14, v15, v14
    v_mov_b32 v15, v14
    s_nop 1
    v_permlane32_swap_b32 v15, v14
    v_max_f32 v14, v15, v14
    v_mul_f32 v15, 0xbfb8aa3b, v14
    v_fma_f32 v10, v10, s60, v15
    v_fma_f32 v11, v11, s60, v15
    v_fma_f32 v12, v12, s60, v15
    v_fma_f32 v13, v13, s60, v15
    v_exp_f32 v10, v10
    v_exp_f32 v11, v11
    v_exp_f32 v12, v12
    v_exp_f32 v13, v13
    v_mov_b32 v20, v14
    v_pk_add_f32 v[16:17], v[10:11], v[12:13]
    v_add_f32 v21, v16, v17
    s_lshl_b32 s60, s68, 5
    s_lshl_b32 s61, s3, 4
    s_add_u32 s61, s61, 159104
    v_add_u32 v16, s61, v3
    v_mov_b32 v17, 159232
    v_mov_b32 v18, 1
    s_add_u32 s60, s60, s59
    v_add_f32_dpp v21, v21, v21 quad_perm:[2,3,0,1] row_mask:0xf bank_mask:0xf
    s_nop 1
    v_add_f32_dpp v21, v21, v21 row_ror:4 row_mask:0xf bank_mask:0xf
    s_nop 1
    v_add_f32_dpp v21, v21, v21 row_ror:8 row_mask:0xf bank_mask:0xf
    v_mov_b32 v15, v21
    s_nop 1
    v_permlane16_swap_b32 v15, v21
    v_add_f32 v21, v15, v21
    v_mov_b32 v15, v21
    s_nop 1
    v_permlane32_swap_b32 v15, v21
    v_add_f32 v21, v15, v21
    s_mov_b64 exec, 3
    ds_write_b64 v16, v[20:21]
    s_mov_b64 exec, 1
    ds_add_rtn_u32 v18, v17, v18
    s_mov_b64 exec, -1
    v_and_b32 v16, 0x78, v3
    v_or_b32 v16, 159104, v16
    s_waitcnt lgkmcnt(0)
    v_readfirstlane_b32 s61, v18
    s_cmp_eq_u32 s61, 7
    s_nop 3
    s_cbranch_scc0 .mlc_27
    ds_read_b64 v[18:19], v16
    s_waitcnt lgkmcnt(0)
    v_mov_b32 v20, v18
    s_nop 1
    v_max_f32_dpp v20, v20, v20 quad_perm:[2,3,0,1] row_mask:0xf bank_mask:0xf
    s_nop 1
    v_max_f32_dpp v20, v20, v20 row_ror:4 row_mask:0xf bank_mask:0xf
    s_nop 1
    v_max_f32_dpp v20, v20, v20 row_ror:8 row_mask:0xf bank_mask:0xf
    v_sub_f32 v18, v18, v20
    v_mul_f32 v18, 0x3fb8aa3b, v18
    v_exp_f32 v18, v18
    s_nop 0
    v_mul_f32 v21, v18, v19
    s_nop 1
    v_add_f32_dpp v21, v21, v21 quad_perm:[2,3,0,1] row_mask:0xf bank_mask:0xf
    s_nop 1
    v_add_f32_dpp v21, v21, v21 row_ror:4 row_mask:0xf bank_mask:0xf
    s_nop 1
    v_add_f32_dpp v21, v21, v21 row_ror:8 row_mask:0xf bank_mask:0xf
    s_mov_b64 exec, 3
    s_add_u32 s57, s60, 0x800000
    buffer_store_dwordx4 v[20:23], v2, s[36:39], s57 offen
    s_cmp_lg_u32 s0, 0
    s_nop 0
    s_cbranch_scc1 .nosl_28
    buffer_store_dwordx4 v[20:23], v2, s[36:39], s60 offen sc1
.nosl_28:
    s_mov_b64 exec, -1
.mlc_27:
    s_add_u32 s59, s59, s0
    s_memrealtime s[8:9]
    s_waitcnt lgkmcnt(0)
    s_sub_u32 s8, s8, s30
    s_cmpk_ge_u32 s8, 1719
    s_cbranch_scc1 .ap_29
    s_waitcnt vmcnt(5)
    s_cmpk_ge_u32 s8, 1619
    s_cbranch_scc1 .ap_29
    s_waitcnt vmcnt(3)
    s_bitcmp1_b64 s[14:15], 44
    s_cbranch_scc0 1
    s_waitcnt vmcnt(2)
    s_cmpk_ge_u32 s8, 1499
    s_cbranch_scc1 .ap_29
    s_waitcnt vmcnt(1)
.ap_29:
    s_add_u32 s63, s69, 163840
    buffer_load_dwordx4 v[208:211], v1, s[44:47], s63 offen nt
    s_memrealtime s[8:9]
    s_waitcnt vmcnt(8)
    s_waitcnt lgkmcnt(0)
    s_sub_u32 s8, s8, s30
    s_cmpk_ge_u32 s8, 1749
    s_cbranch_scc1 .ap_30
    s_branch .Lsk_n1_3
.Lst_n1_3:
    s_branch .Lrt_n1_3
.Lsk_n1_3:
    s_waitcnt vmcnt(5)
    s_cmpk_ge_u32 s8, 1649
    s_cbranch_scc1 .ap_30
    s_waitcnt vmcnt(3)
    s_bitcmp1_b64 s[14:15], 45
    s_cbranch_scc0 1
    s_waitcnt vmcnt(2)
    s_cmpk_ge_u32 s8, 1529
    s_cbranch_scc1 .ap_30
    s_waitcnt vmcnt(1)
.ap_30:
    s_add_u32 s63, s69, 172032
    buffer_load_dwordx4 v[212:215], v1, s[44:47], s63 offen nt
    s_memrealtime s[8:9]
    s_waitcnt vmcnt(8)
    s_waitcnt lgkmcnt(0)
    s_sub_u32 s8, s8, s30
    s_cmpk_ge_u32 s8, 1780
    s_cbranch_scc1 .ap_31
    s_waitcnt vmcnt(5)
    s_cmpk_ge_u32 s8, 1680
    s_cbranch_scc1 .ap_31
    s_waitcnt vmcnt(3)
    s_bitcmp1_b64 s[14:15], 46
    s_cbranch_scc0 1
    s_waitcnt vmcnt(2)
    s_cmpk_ge_u32 s8, 1560
    s_cbranch_scc1 .ap_31
    s_waitcnt vmcnt(1)
.ap_31:
    s_add_u32 s63, s69, 180224
    buffer_load_dwordx4 v[216:219], v1, s[44:47], s63 offen nt
    s_memrealtime s[8:9]
    s_waitcnt vmcnt(8)
    s_waitcnt lgkmcnt(0)
    s_sub_u32 s8, s8, s30
    s_cmpk_ge_u32 s8, 1812
    s_cbranch_scc1 .ap_32
    s_waitcnt vmcnt(5)
    s_cmpk_ge_u32 s8, 1712
    s_cbranch_scc1 .ap_32
    s_waitcnt vmcnt(3)
    s_bitcmp1_b64 s[14:15], 47
    s_cbranch_scc0 1
    s_waitcnt vmcnt(2)
    s_cmpk_ge_u32 s8, 1592
    s_cbranch_scc1 .ap_32
    s_waitcnt vmcnt(1)
.ap_32:
    s_add_u32 s63, s69, 188416
    buffer_load_dwordx4 v[220:223], v1, s[44:47], s63 offen nt
    s_memrealtime s[8:9]
    s_waitcnt vmcnt(8)
    s_waitcnt lgkmcnt(0)
    s_sub_u32 s8, s8, s30
    s_cmpk_ge_u32 s8, 1844
    s_cbranch_scc1 .ap_33
    s_waitcnt vmcnt(5)
    s_cmpk_ge_u32 s8, 1744
    s_cbranch_scc1 .ap_33
    s_waitcnt vmcnt(3)
    s_bitcmp1_b64 s[14:15], 48
    s_cbranch_scc0 1
    s_waitcnt vmcnt(2)
    s_cmpk_ge_u32 s8, 1624
    s_cbranch_scc1 .ap_33
    s_waitcnt vmcnt(1)
.ap_33:
    s_add_u32 s63, s69, 262144
    buffer_load_dwordx4 v[224:227], v1, s[44:47], s63 offen nt
    s_memrealtime s[8:9]
    s_waitcnt vmcnt(8)
    s_waitcnt lgkmcnt(0)
    s_sub_u32 s8, s8, s30
    s_cmpk_ge_u32 s8, 1876
    s_cbranch_scc1 .ap_34
    s_waitcnt vmcnt(5)
    s_cmpk_ge_u32 s8, 1776
    s_cbranch_scc1 .ap_34
    s_waitcnt vmcnt(3)
    s_bitcmp1_b64 s[14:15], 49
    s_cbranch_scc0 1
    s_waitcnt vmcnt(2)
    s_cmpk_ge_u32 s8, 1656
    s_cbranch_scc1 .ap_34
    s_waitcnt vmcnt(1)
.ap_34:
    s_add_u32 s63, s69, 270336
    buffer_load_dwordx4 v[228:231], v1, s[44:47], s63 offen nt
    s_memrealtime s[8:9]
    s_waitcnt vmcnt(8)
    s_waitcnt lgkmcnt(0)
    s_sub_u32 s8, s8, s30
    s_cmpk_ge_u32 s8, 1908
    s_cbranch_scc1 .ap_35
    s_waitcnt vmcnt(5)
    s_cmpk_ge_u32 s8, 1808
    s_cbranch_scc1 .ap_35
    s_waitcnt vmcnt(3)
    s_bitcmp1_b64 s[14:15], 50
    s_cbranch_scc0 1
    s_waitcnt vmcnt(2)
    s_cmpk_ge_u32 s8, 1688
    s_cbranch_scc1 .ap_35
    s_waitcnt vmcnt(1)
.ap_35:
    s_add_u32 s63, s69, 278528
    buffer_load_dwordx4 v[232:235], v1, s[44:47], s63 offen nt
    s_memrealtime s[8:9]
    s_waitcnt vmcnt(8)
    s_waitcnt lgkmcnt(0)
    s_sub_u32 s8, s8, s30
    s_cmpk_ge_u32 s8, 1939
    s_cbranch_scc1 .ap_36
    s_waitcnt vmcnt(5)
    s_cmpk_ge_u32 s8, 1839
    s_cbranch_scc1 .ap_36
    s_waitcnt vmcnt(3)
    s_bitcmp1_b64 s[14:15], 51
    s_cbranch_scc0 1
    s_waitcnt vmcnt(2)
    s_cmpk_ge_u32 s8, 1719
    s_cbranch_scc1 .ap_36
    s_waitcnt vmcnt(1)
.ap_36:
    s_add_u32 s63, s69, 286720
    buffer_load_dwordx4 v[236:239], v1, s[44:47], s63 offen nt
    s_memrealtime s[8:9]
    s_waitcnt vmcnt(8)
    s_waitcnt lgkmcnt(0)
    s_sub_u32 s8, s8, s30
    s_cmpk_ge_u32 s8, 1971
    s_cbranch_scc1 .ap_37
    s_waitcnt vmcnt(5)
    s_cmpk_ge_u32 s8, 1871
    s_cbranch_scc1 .ap_37
    s_waitcnt vmcnt(3)
    s_bitcmp1_b64 s[14:15], 52
    s_cbranch_scc0 1
    s_waitcnt vmcnt(2)
    s_cmpk_ge_u32 s8, 1751
    s_cbranch_scc1 .ap_37
    s_waitcnt vmcnt(1)
.ap_37:
    s_add_u32 s63, s69, 294912
    buffer_load_dwordx4 v[240:243], v1, s[44:47], s63 offen nt
    s_memrealtime s[8:9]
    s_waitcnt vmcnt(8)
    s_waitcnt lgkmcnt(0)
    s_sub_u32 s8, s8, s30
    s_cmpk_ge_u32 s8, 2003
    s_cbranch_scc1 .ap_38
    s_waitcnt vmcnt(5)
    s_cmpk_ge_u32 s8, 1903
    s_cbranch_scc1 .ap_38
    s_waitcnt vmcnt(3)
    s_bitcmp1_b64 s[14:15], 53
    s_cbranch_scc0 1
    s_waitcnt vmcnt(2)
    s_cmpk_ge_u32 s8, 1783
    s_cbranch_scc1 .ap_38
    s_waitcnt vmcnt(1)
.ap_38:
    s_add_u32 s63, s69, 303104
    buffer_load_dwordx4 v[244:247], v1, s[44:47], s63 offen nt
    buffer_load_dwordx4 v[24:27], v9, s[36:39], s59 offen offset:0 sc1
    s_memrealtime s[8:9]
    s_waitcnt vmcnt(8)
    s_waitcnt lgkmcnt(0)
    s_sub_u32 s8, s8, s30
    s_cmpk_ge_u32 s8, 2035
    s_cbranch_scc1 .ap_39
    s_waitcnt vmcnt(5)
    s_cmpk_ge_u32 s8, 1935
    s_cbranch_scc1 .ap_39
    s_waitcnt vmcnt(3)
    s_bitcmp1_b64 s[14:15], 54
    s_cbranch_scc0 1
    s_waitcnt vmcnt(2)
    s_cmpk_ge_u32 s8, 1815
    s_cbranch_scc1 .ap_39
    s_waitcnt vmcnt(1)
.ap_39:
    s_add_u32 s63, s69, 311296
    buffer_load_dwordx4 v[248:251], v1, s[44:47], s63 offen nt
    s_memrealtime s[8:9]
    s_waitcnt vmcnt(8)
    s_waitcnt lgkmcnt(0)
    s_sub_u32 s8, s8, s30
    s_cmpk_ge_u32 s8, 2067
    s_cbranch_scc1 .ap_40
    s_waitcnt vmcnt(5)
    s_cmpk_ge_u32 s8, 1967
    s_cbranch_scc1 .ap_40
    s_waitcnt vmcnt(3)
    s_bitcmp1_b64 s[14:15], 55
    s_cbranch_scc0 1
    s_waitcnt vmcnt(2)
    s_cmpk_ge_u32 s8, 1847
    s_cbranch_scc1 .ap_40
    s_waitcnt vmcnt(1)
.ap_40:
    s_add_u32 s63, s69, 319488
    buffer_load_dwordx4 v[252:255], v1, s[44:47], s63 offen nt
    s_memrealtime s[8:9]
    s_waitcnt vmcnt(8)
    s_waitcnt lgkmcnt(0)
    s_sub_u32 s8, s8, s30
    s_cmpk_ge_u32 s8, 2098
    s_cbranch_scc1 .ap_41
    s_waitcnt vmcnt(5)
    s_cmpk_ge_u32 s8, 1998
    s_cbranch_scc1 .ap_41
    s_waitcnt vmcnt(3)
    s_bitcmp1_b64 s[14:15], 56
    s_cbranch_scc0 1
    s_waitcnt vmcnt(2)
    s_cmpk_ge_u32 s8, 1878
    s_cbranch_scc1 .ap_41
    s_waitcnt vmcnt(1)
.ap_41:
    s_add_u32 s63, s69, 393216
    buffer_load_dwordx4 v[36:39], v1, s[44:47], s63 offen nt
    s_memrealtime s[8:9]
    s_waitcnt vmcnt(8)
    s_waitcnt lgkmcnt(0)
    s_sub_u32 s8, s8, s30
    s_cmpk_ge_u32 s8, 2130
    s_cbranch_scc1 .ap_42
    s_waitcnt vmcnt(5)
    s_cmpk_ge_u32 s8, 2030
    s_cbranch_scc1 .ap_42
    s_waitcnt vmcnt(3)
    s_bitcmp1_b64 s[14:15], 57
    s_cbranch_scc0 1
    s_waitcnt vmcnt(2)
    s_cmpk_ge_u32 s8, 1910
    s_cbranch_scc1 .ap_42
    s_waitcnt vmcnt(1)
.ap_42:
    s_add_u32 s63, s69, 401408
    buffer_load_dwordx4 v[44:47], v1, s[44:47], s63 offen nt
    s_memrealtime s[8:9]
    s_branch .Lsk_n1_4
.Lst_n1_4:
    s_branch .Lrt_n1_4
.Lsk_n1_4:
    s_waitcnt vmcnt(8)
    s_waitcnt lgkmcnt(0)
    s_sub_u32 s8, s8, s30
    s_cmpk_ge_u32 s8, 2162
    s_cbranch_scc1 .ap_43
    s_waitcnt vmcnt(5)
    s_cmpk_ge_u32 s8, 2062
    s_cbranch_scc1 .ap_43
    s_waitcnt vmcnt(3)
    s_bitcmp1_b64 s[14:15], 58
    s_cbranch_scc0 1
    s_waitcnt vmcnt(2)
    s_cmpk_ge_u32 s8, 1942
    s_cbranch_scc1 .ap_43
    s_waitcnt vmcnt(1)
.ap_43:
    s_add_u32 s63, s69, 409600
    buffer_load_dwordx4 v[52:55], v1, s[44:47], s63 offen nt
    s_waitcnt vmcnt(5)
    s_branch .gpc_45
.gp_44:
    s_xor_b32 s59, s59, 0x800000
    buffer_load_dwordx4 v[24:27], v9, s[36:39], s59 offen offset:0 sc1
    s_waitcnt vmcnt(0)
.gpc_45:
    v_cmp_eq_u32 vcc, s34, v26
    s_cmp_eq_u64 vcc, -1
    s_nop 3
    s_cbranch_scc1 .gpd_46
    s_sub_u32 s35, s35, 1
    s_cbranch_scc1 .Lexit
    s_sleep 1
    s_branch .gp_44
.gpd_46:
    v_mov_b32 v16, v24
    s_nop 1
    v_max_f32_dpp v16, v16, v16 row_ror:4 row_mask:0xf bank_mask:0xf
    v_sub_f32 v17, v24, v16
    v_sub_f32 v18, v14, v16
    v_mul_f32 v17, 0x3fb8aa3b, v17
    v_mul_f32 v18, 0x3fb8aa3b, v18
    v_exp_f32 v17, v17
    v_exp_f32 v18, v18
    v_mul_f32 v17, v17, v25
    s_nop 1
    v_add_f32_dpp v17, v17, v17 row_ror:4 row_mask:0xf bank_mask:0xf
    v_rcp_f32 v19, v17
    s_nop 0
    v_fma_f32 v15, -v17, v19, 1.0
    v_fma_f32 v19, v15, v19, v19
    v_mul_f32 v18, v18, v19
    v_mul_f32 v10, v10, v18
    v_mul_f32 v11, v11, v18
    v_mul_f32 v12, v12, v18
    v_mul_f32 v13, v13, v18
    v_mov_b32_dpp v112, v10 quad_perm:[2,3,0,1] row_mask:0xf bank_mask:0xf
    v_mov_b32_dpp v113, v11 quad_perm:[2,3,0,1] row_mask:0xf bank_mask:0xf
    v_mov_b32_dpp v114, v12 quad_perm:[2,3,0,1] row_mask:0xf bank_mask:0xf
    v_mov_b32_dpp v115, v13 quad_perm:[2,3,0,1] row_mask:0xf bank_mask:0xf
    v_cvt_pk_bf16_f32 v96, v10, v112
    v_cvt_pk_bf16_f32 v100, v11, v113
    v_cvt_pk_bf16_f32 v104, v12, v114
    v_cvt_pk_bf16_f32 v108, v13, v115
    v_mov_b32_dpp v97, v96 row_ror:12 row_mask:0xf bank_mask:0xf
    v_mov_b32_dpp v101, v100 row_ror:12 row_mask:0xf bank_mask:0xf
    v_mov_b32_dpp v105, v104 row_ror:12 row_mask:0xf bank_mask:0xf
    v_mov_b32_dpp v109, v108 row_ror:12 row_mask:0xf bank_mask:0xf
    v_mov_b32_dpp v98, v96 row_ror:8 row_mask:0xf bank_mask:0xf
    v_mov_b32_dpp v102, v100 row_ror:8 row_mask:0xf bank_mask:0xf
    v_mov_b32_dpp v106, v104 row_ror:8 row_mask:0xf bank_mask:0xf
    v_mov_b32_dpp v110, v108 row_ror:8 row_mask:0xf bank_mask:0xf
    v_mov_b32_dpp v99, v96 row_ror:4 row_mask:0xf bank_mask:0xf
    v_mov_b32_dpp v103, v100 row_ror:4 row_mask:0xf bank_mask:0xf
    v_mov_b32_dpp v107, v104 row_ror:4 row_mask:0xf bank_mask:0xf
    v_mov_b32_dpp v111, v108 row_ror:4 row_mask:0xf bank_mask:0xf
    s_lshl_b32 s60, s3, 10
    s_add_u32 s60, s60, 147456
    v_lshlrev_b32 v10, 5, v0
    v_add_u32 v10, s60, v10
    s_memrealtime s[8:9]
    s_waitcnt lgkmcnt(0)
    s_sub_u32 s8, s8, s30
    s_cmpk_ge_u32 s8, 2194
    s_cbranch_scc1 .ap_47
    s_waitcnt vmcnt(5)
    s_cmpk_ge_u32 s8, 2094
    s_cbranch_scc1 .ap_47
    s_waitcnt vmcnt(3)
    s_bitcmp1_b64 s[14:15], 59
    s_cbranch_scc0 1
    s_waitcnt vmcnt(2)
    s_cmpk_ge_u32 s8, 1974
    s_cbranch_scc1 .ap_47
    s_waitcnt vmcnt(1)
.ap_47:
    s_add_u32 s63, s69, 417792
    buffer_load_dwordx4 v[60:63], v1, s[44:47], s63 offen nt
    v_perm_b32 v112, v164, v160, s94
    v_perm_b32 v113, v172, v168, s94
    v_perm_b32 v114, v180, v176, s94
    v_perm_b32 v115, v188, v184, s94
    s_nop 1
    v_mfma_f32_16x16x32_bf16 v[128:131], v[96:99], v[112:115], 0
    v_perm_b32 v116, v164, v160, s95
    v_perm_b32 v117, v172, v168, s95
    v_perm_b32 v118, v180, v176, s95
    v_perm_b32 v119, v188, v184, s95
    s_nop 1
    v_mfma_f32_16x16x32_bf16 v[132:135], v[96:99], v[116:119], 0
    v_perm_b32 v120, v165, v161, s94
    v_perm_b32 v121, v173, v169, s94
    v_perm_b32 v122, v181, v177, s94
    v_perm_b32 v123, v189, v185, s94
    s_nop 1
    v_mfma_f32_16x16x32_bf16 v[136:139], v[96:99], v[120:123], 0
    v_perm_b32 v124, v165, v161, s95
    v_perm_b32 v125, v173, v169, s95
    v_perm_b32 v126, v181, v177, s95
    v_perm_b32 v127, v189, v185, s95
    s_nop 1
    v_mfma_f32_16x16x32_bf16 v[140:143], v[96:99], v[124:127], 0
    v_perm_b32 v112, v166, v162, s94
    v_perm_b32 v113, v174, v170, s94
    v_perm_b32 v114, v182, v178, s94
    v_perm_b32 v115, v190, v186, s94
    s_nop 1
    v_mfma_f32_16x16x32_bf16 v[144:147], v[96:99], v[112:115], 0
    v_perm_b32 v116, v166, v162, s95
    v_perm_b32 v117, v174, v170, s95
    v_perm_b32 v118, v182, v178, s95
    v_perm_b32 v119, v190, v186, s95
    s_nop 1
    v_mfma_f32_16x16x32_bf16 v[148:151], v[96:99], v[116:119], 0
    v_perm_b32 v120, v167, v163, s94
    v_perm_b32 v121, v175, v171, s94
    v_perm_b32 v122, v183, v179, s94
    v_perm_b32 v123, v191, v187, s94
    s_nop 1
    v_mfma_f32_16x16x32_bf16 v[152:155], v[96:99], v[120:123], 0
    v_perm_b32 v124, v167, v163, s95
    v_perm_b32 v125, v175, v171, s95
    v_perm_b32 v126, v183, v179, s95
    v_perm_b32 v127, v191, v187, s95
    s_nop 1
    v_mfma_f32_16x16x32_bf16 v[156:159], v[96:99], v[124:127], 0
    s_memrealtime s[8:9]
    s_waitcnt lgkmcnt(0)
    s_sub_u32 s8, s8, s30
    s_cmpk_ge_u32 s8, 2226
    s_nop 3
    s_cbranch_scc1 .ap_48
    s_waitcnt vmcnt(5)
    s_cmpk_ge_u32 s8, 2126
    s_cbranch_scc1 .ap_48
    s_waitcnt vmcnt(3)
    s_bitcmp1_b64 s[14:15], 60
    s_cbranch_scc0 1
    s_waitcnt vmcnt(2)
    s_cmpk_ge_u32 s8, 2006
    s_cbranch_scc1 .ap_48
    s_waitcnt vmcnt(1)
.ap_48:
    s_add_u32 s63, s69, 425984
    buffer_load_dwordx4 v[68:71], v1, s[44:47], s63 offen nt
    v_perm_b32 v112, v196, v192, s94
    v_perm_b32 v113, v204, v200, s94
    v_perm_b32 v114, v212, v208, s94
    v_perm_b32 v115, v220, v216, s94
    s_nop 1
    v_mfma_f32_16x16x32_bf16 v[128:131], v[100:103], v[112:115], v[128:131]
    v_perm_b32 v116, v196, v192, s95
    v_perm_b32 v117, v204, v200, s95
    v_perm_b32 v118, v212, v208, s95
    v_perm_b32 v119, v220, v216, s95
    s_nop 1
    v_mfma_f32_16x16x32_bf16 v[132:135], v[100:103], v[116:119], v[132:135]
    v_perm_b32 v120, v197, v193, s94
    v_perm_b32 v121, v205, v201, s94
    v_perm_b32 v122, v213, v209, s94
    v_perm_b32 v123, v221, v217, s94
    s_nop 1
    v_mfma_f32_16x16x32_bf16 v[136:139], v[100:103], v[120:123], v[136:139]
    v_perm_b32 v124, v197, v193, s95
    s_branch .Lsk_n1_5
.Lst_n1_5:
    s_branch .Lrt_n1_5
.Lsk_n1_5:
    v_perm_b32 v125, v205, v201, s95
    v_perm_b32 v126, v213, v209, s95
    v_perm_b32 v127, v221, v217, s95
    s_nop 1
    v_mfma_f32_16x16x32_bf16 v[140:143], v[100:103], v[124:127], v[140:143]
    v_perm_b32 v112, v198, v194, s94
    v_perm_b32 v113, v206, v202, s94
    v_perm_b32 v114, v214, v210, s94
    v_perm_b32 v115, v222, v218, s94
    s_nop 1
    v_mfma_f32_16x16x32_bf16 v[144:147], v[100:103], v[112:115], v[144:147]
    v_perm_b32 v116, v198, v194, s95
    v_perm_b32 v117, v206, v202, s95
    v_perm_b32 v118, v214, v210, s95
    v_perm_b32 v119, v222, v218, s95
    s_nop 1
    v_mfma_f32_16x16x32_bf16 v[148:151], v[100:103], v[116:119], v[148:151]
    v_perm_b32 v120, v199, v195, s94
    v_perm_b32 v121, v207, v203, s94
    v_perm_b32 v122, v215, v211, s94
    v_perm_b32 v123, v223, v219, s94
    s_nop 1
    v_mfma_f32_16x16x32_bf16 v[152:155], v[100:103], v[120:123], v[152:155]
    v_perm_b32 v124, v199, v195, s95
    v_perm_b32 v125, v207, v203, s95
    v_perm_b32 v126, v215, v211, s95
    v_perm_b32 v127, v223, v219, s95
    s_nop 1
    v_mfma_f32_16x16x32_bf16 v[156:159], v[100:103], v[124:127], v[156:159]
    s_memrealtime s[8:9]
    s_waitcnt lgkmcnt(0)
    s_sub_u32 s8, s8, s30
    s_cmpk_ge_u32 s8, 2257
    s_nop 3
    s_cbranch_scc1 .ap_49
    s_waitcnt vmcnt(5)
    s_cmpk_ge_u32 s8, 2157
    s_cbranch_scc1 .ap_49
    s_waitcnt vmcnt(3)
    s_bitcmp1_b64 s[14:15], 61
    s_cbranch_scc0 1
    s_waitcnt vmcnt(2)
    s_cmpk_ge_u32 s8, 2037
    s_cbranch_scc1 .ap_49
    s_waitcnt vmcnt(1)
.ap_49:
    s_add_u32 s63, s69, 434176
    buffer_load_dwordx4 v[76:79], v1, s[44:47], s63 offen nt
    s_waitcnt vmcnt(6)
    v_perm_b32 v112, v228, v224, s94
    v_perm_b32 v113, v236, v232, s94
    v_perm_b32 v114, v244, v240, s94
    v_perm_b32 v115, v252, v248, s94
    s_nop 1
    v_mfma_f32_16x16x32_bf16 v[128:131], v[104:107], v[112:115], v[128:131]
    v_perm_b32 v116, v228, v224, s95
    v_perm_b32 v117, v236, v232, s95
    v_perm_b32 v118, v244, v240, s95
    v_perm_b32 v119, v252, v248, s95
    s_nop 1
    v_mfma_f32_16x16x32_bf16 v[132:135], v[104:107], v[116:119], v[132:135]
    v_perm_b32 v120, v229, v225, s94
    v_perm_b32 v121, v237, v233, s94
    v_perm_b32 v122, v245, v241, s94
    v_perm_b32 v123, v253, v249, s94
    s_nop 1
    v_mfma_f32_16x16x32_bf16 v[136:139], v[104:107], v[120:123], v[136:139]
    v_perm_b32 v124, v229, v225, s95
    v_perm_b32 v125, v237, v233, s95
    v_perm_b32 v126, v245, v241, s95
    v_perm_b32 v127, v253, v249, s95
    s_nop 1
    v_mfma_f32_16x16x32_bf16 v[140:143], v[104:107], v[124:127], v[140:143]
    v_perm_b32 v112, v230, v226, s94
    v_perm_b32 v113, v238, v234, s94
    v_perm_b32 v114, v246, v242, s94
    v_perm_b32 v115, v254, v250, s94
    s_nop 1
    v_mfma_f32_16x16x32_bf16 v[144:147], v[104:107], v[112:115], v[144:147]
    v_perm_b32 v116, v230, v226, s95
    v_perm_b32 v117, v238, v234, s95
    v_perm_b32 v118, v246, v242, s95
    v_perm_b32 v119, v254, v250, s95
    s_nop 1
    v_mfma_f32_16x16x32_bf16 v[148:151], v[104:107], v[116:119], v[148:151]
    v_perm_b32 v120, v231, v227, s94
    v_perm_b32 v121, v239, v235, s94
    v_perm_b32 v122, v247, v243, s94
    v_perm_b32 v123, v255, v251, s94
    s_nop 1
    v_mfma_f32_16x16x32_bf16 v[152:155], v[104:107], v[120:123], v[152:155]
    v_perm_b32 v124, v231, v227, s95
    v_perm_b32 v125, v239, v235, s95
    v_perm_b32 v126, v247, v243, s95
    v_perm_b32 v127, v255, v251, s95
    s_nop 1
    v_mfma_f32_16x16x32_bf16 v[156:159], v[104:107], v[124:127], v[156:159]
    s_memrealtime s[8:9]
    s_waitcnt lgkmcnt(0)
    s_sub_u32 s8, s8, s30
    s_cmpk_ge_u32 s8, 2289
    s_nop 3
    s_cbranch_scc1 .ap_50
    s_waitcnt vmcnt(5)
    s_cmpk_ge_u32 s8, 2189
    s_cbranch_scc1 .ap_50
    s_waitcnt vmcnt(3)
    s_bitcmp1_b64 s[14:15], 62
    s_cbranch_scc0 1
    s_waitcnt vmcnt(2)
    s_cmpk_ge_u32 s8, 2069
    s_cbranch_scc1 .ap_50
    s_waitcnt vmcnt(1)
.ap_50:
    s_add_u32 s63, s69, 442368
    buffer_load_dwordx4 v[84:87], v1, s[44:47], s63 offen nt
    s_memrealtime s[8:9]
    s_waitcnt lgkmcnt(0)
    s_sub_u32 s8, s8, s30
    s_cmpk_ge_u32 s8, 2321
    s_cbranch_scc1 .ap_51
    s_waitcnt vmcnt(5)
    s_cmpk_ge_u32 s8, 2221
    s_cbranch_scc1 .ap_51
    s_waitcnt vmcnt(3)
    s_bitcmp1_b64 s[14:15], 63
    s_cbranch_scc0 1
    s_waitcnt vmcnt(2)
    s_cmpk_ge_u32 s8, 2101
    s_cbranch_scc1 .ap_51
    s_waitcnt vmcnt(1)
.ap_51:
    s_add_u32 s63, s69, 450560
    buffer_load_dwordx4 v[92:95], v1, s[44:47], s63 offen nt
    s_setprio 0
    s_branch .Lsk_n1_6
.Lst_n1_6:
    s_branch .Lrt_n1_6
.Lsk_n1_6:
    s_waitcnt vmcnt(6)
    v_perm_b32 v160, v44, v36, s94
    v_perm_b32 v164, v44, v36, s95
    v_perm_b32 v168, v45, v37, s94
    v_perm_b32 v172, v45, v37, s95
    v_perm_b32 v176, v46, v38, s94
    v_perm_b32 v180, v46, v38, s95
    v_perm_b32 v184, v47, v39, s94
    v_perm_b32 v188, v47, v39, s95
    s_waitcnt vmcnt(4)
    v_perm_b32 v161, v60, v52, s94
    v_perm_b32 v165, v60, v52, s95
    v_perm_b32 v169, v61, v53, s94
    v_perm_b32 v173, v61, v53, s95
    v_perm_b32 v177, v62, v54, s94
    v_perm_b32 v181, v62, v54, s95
    v_perm_b32 v185, v63, v55, s94
    v_perm_b32 v189, v63, v55, s95
    s_waitcnt vmcnt(2)
    v_perm_b32 v162, v76, v68, s94
    v_perm_b32 v166, v76, v68, s95
    v_perm_b32 v170, v77, v69, s94
    v_perm_b32 v174, v77, v69, s95
    v_perm_b32 v178, v78, v70, s94
    v_perm_b32 v182, v78, v70, s95
    v_perm_b32 v186, v79, v71, s94
    v_perm_b32 v190, v79, v71, s95
    s_waitcnt vmcnt(0)
    s_cmp_lt_u32 s65, 8
    s_cbranch_scc1 .wol_52
    s_lshl_b32 s56, s3, 10
    s_add_u32 m0, s56, 24576
    s_add_u32 s56, s101, 221184
    s_mov_b64 exec, s[18:19]
    buffer_load_dwordx4 v6, s[48:51], s56 offen nt lds
    s_mov_b64 exec, -1
    s_lshl_b32 s56, s3, 10
    s_add_u32 m0, s56, 57344
    s_add_u32 s56, s101, 221312
    s_mov_b64 exec, s[18:19]
    buffer_load_dwordx4 v6, s[48:51], s56 offen nt lds
    s_mov_b64 exec, -1
    s_lshl_b32 s56, s3, 10
    s_add_u32 m0, s56, 90112
    s_add_u32 s56, s101, 221440
    s_mov_b64 exec, s[18:19]
    buffer_load_dwordx4 v6, s[48:51], s56 offen nt lds
    s_mov_b64 exec, -1
.wol_52:
    v_perm_b32 v163, v92, v84, s94
    v_perm_b32 v167, v92, v84, s95
    v_perm_b32 v171, v93, v85, s94
    v_mfma_f32_16x16x32_bf16 v[128:131], v[108:111], v[160:163], v[128:131]
    v_perm_b32 v175, v93, v85, s95
    v_mfma_f32_16x16x32_bf16 v[132:135], v[108:111], v[164:167], v[132:135]
    v_perm_b32 v179, v94, v86, s94
    v_mfma_f32_16x16x32_bf16 v[136:139], v[108:111], v[168:171], v[136:139]
    v_perm_b32 v183, v94, v86, s95
    v_mfma_f32_16x16x32_bf16 v[140:143], v[108:111], v[172:175], v[140:143]
    v_perm_b32 v187, v95, v87, s94
    v_mfma_f32_16x16x32_bf16 v[144:147], v[108:111], v[176:179], v[144:147]
    v_perm_b32 v191, v95, v87, s95
    v_mfma_f32_16x16x32_bf16 v[148:151], v[108:111], v[180:183], v[148:151]
    v_mfma_f32_16x16x32_bf16 v[152:155], v[108:111], v[184:187], v[152:155]
    v_mfma_f32_16x16x32_bf16 v[156:159], v[108:111], v[188:191], v[156:159]
    s_mov_b64 exec, 0xffff
    ds_write2_b32 v10, v128, v129 offset0:0 offset1:128
    ds_write2_b32 v10, v132, v133 offset0:1 offset1:129
    ds_write2_b32 v10, v136, v137 offset0:2 offset1:130
    ds_write2_b32 v10, v140, v141 offset0:3 offset1:131
    ds_write2_b32 v10, v144, v145 offset0:4 offset1:132
    ds_write2_b32 v10, v148, v149 offset0:5 offset1:133
    ds_write2_b32 v10, v152, v153 offset0:6 offset1:134
    ds_write2_b32 v10, v156, v157 offset0:7 offset1:135
    s_mov_b64 exec, -1
    s_waitcnt lgkmcnt(0)
    s_barrier
    s_cmp_lg_u32 s3, 7
    s_cbranch_scc1 .opub_53
    v_add_u32 v10, 147456, v2
    ds_read_b128 v[196:199], v10 offset:0
    ds_read_b128 v[200:203], v10 offset:1024
    ds_read_b128 v[204:207], v10 offset:2048
    ds_read_b128 v[208:211], v10 offset:3072
    ds_read_b128 v[212:215], v10 offset:4096
    ds_read_b128 v[216:219], v10 offset:5120
    ds_read_b128 v[220:223], v10 offset:6144
    ds_read_b128 v[224:227], v10 offset:7168
    v_lshrrev_b32 v11, 5, v0
    v_lshlrev_b32 v11, 13, v11
    v_and_b32 v12, 31, v0
    v_lshl_add_u32 v11, v12, 4, v11
    s_lshl4_add_u32 s56, s67, s66
    s_lshl1_add_u32 s56, s56, s68
    s_lshl_b32 s56, s56, 9
    s_add_u32 s56, s56, 0xa0000
    s_mov_b32 s60, 0x07060503
    s_mov_b32 s61, 0x07060502
    s_mov_b32 s62, 0x07060501
    v_mov_b32 v15, s34
    s_waitcnt lgkmcnt(6)
    v_pk_add_f32 v[196:197], v[196:197], v[200:201]
    v_pk_add_f32 v[198:199], v[198:199], v[202:203]
    s_waitcnt lgkmcnt(5)
    v_pk_add_f32 v[196:197], v[196:197], v[204:205]
    v_pk_add_f32 v[198:199], v[198:199], v[206:207]
    s_waitcnt lgkmcnt(4)
    v_pk_add_f32 v[196:197], v[196:197], v[208:209]
    v_pk_add_f32 v[198:199], v[198:199], v[210:211]
    s_waitcnt lgkmcnt(3)
    v_pk_add_f32 v[196:197], v[196:197], v[212:213]
    v_pk_add_f32 v[198:199], v[198:199], v[214:215]
    s_waitcnt lgkmcnt(2)
    v_pk_add_f32 v[196:197], v[196:197], v[216:217]
    v_pk_add_f32 v[198:199], v[198:199], v[218:219]
    s_waitcnt lgkmcnt(1)
    v_pk_add_f32 v[196:197], v[196:197], v[220:221]
    v_pk_add_f32 v[198:199], v[198:199], v[222:223]
    s_waitcnt lgkmcnt(0)
    v_pk_add_f32 v[196:197], v[196:197], v[224:225]
    v_pk_add_f32 v[198:199], v[198:199], v[226:227]
    v_perm_b32 v12, v196, v199, s60
    v_perm_b32 v13, v197, v199, s61
    v_perm_b32 v14, v198, v199, s62
    s_add_u32 s57, s56, 0x800000
    buffer_store_dwordx4 v[12:15], v11, s[36:39], s57 offen
    s_cmp_lg_u32 s0, 0
    s_nop 0
    s_cbranch_scc1 .nosl_54
    buffer_store_dwordx4 v[12:15], v11, s[36:39], s56 offen sc1
.nosl_54:
.opub_53:
    s_cmp_lt_u32 s65, 8
    s_nop 0
    s_cbranch_scc1 .Lexit
    v_mov_b32 v6, 0
    v_bfe_u32 v7, v0, 4, 1
    v_lshl_add_u32 v6, v7, 7, v6
    v_bfe_u32 v7, v0, 2, 2
    v_lshl_add_u32 v6, v7, 5, v6
    v_bfe_u32 v7, v0, 5, 1
    v_lshl_add_u32 v6, v7, 4, v6
    v_bfe_u32 v7, v0, 0, 2
    v_lshl_add_u32 v6, v7, 2, v6
    s_mul_i32 s56, s3, 528
    s_add_u32 s56, s56, 131072
    v_add_u32 v6, s56, v6
    s_lshl4_add_u32 s101, s99, s3
    s_lshl_b32 s101, s101, 10
    s_add_u32 s101, s101, 0xa0000
    v_add_u32 v5, 8192, v2
    s_cmp_ge_u32 s3, 6
    s_nop 0
    s_cbranch_scc1 .La_w67
    v_lshrrev_b32 v16, 4, v0
    v_bfe_u32 v17, v0, 2, 2
    v_lshl_add_u32 v7, v16, 3, v17
    v_lshlrev_b32 v7, 7, v7
    v_and_b32 v16, 1, v16
    v_lshrrev_b32 v17, 1, v17
    v_lshl_add_u32 v16, v16, 1, v17
    s_and_b32 s56, s3, 1
    s_lshl_b32 s56, s56, 1
    v_xor_b32 v16, s56, v16
    v_and_b32 v17, 3, v0
    v_lshl_add_u32 v7, v17, 3, v7
    s_branch .Lsk_n1_7
.Lst_n1_7:
    s_branch .Lrt_n1_7
.Lsk_n1_7:
    s_lshr_b32 s56, s3, 1
    s_lshl_b32 s56, s56, 15
    v_add_u32 v7, s56, v7
    v_xor_b32 v17, 1, v16
    v_lshl_add_u32 v8, v17, 5, v7
    v_lshl_add_u32 v7, v16, 5, v7
    ds_read_b64_tr_b16 v[32:33], v7 offset:0
    ds_read_b64_tr_b16 v[34:35], v7 offset:512
    ds_read_b64_tr_b16 v[64:65], v8 offset:0
    ds_read_b64_tr_b16 v[66:67], v8 offset:512
    ds_read_b64_tr_b16 v[36:37], v7 offset:4096
    ds_read_b64_tr_b16 v[38:39], v7 offset:4608
    ds_read_b64_tr_b16 v[68:69], v8 offset:4096
    ds_read_b64_tr_b16 v[70:71], v8 offset:4608
    ds_read_b64_tr_b16 v[40:41], v7 offset:8192
    ds_read_b64_tr_b16 v[42:43], v7 offset:8704
    ds_read_b64_tr_b16 v[72:73], v8 offset:8192
    ds_read_b64_tr_b16 v[74:75], v8 offset:8704
    ds_read_b64_tr_b16 v[44:45], v7 offset:12288
    ds_read_b64_tr_b16 v[46:47], v7 offset:12800
    ds_read_b64_tr_b16 v[76:77], v8 offset:12288
    ds_read_b64_tr_b16 v[78:79], v8 offset:12800
    ds_read_b64_tr_b16 v[48:49], v7 offset:16384
    ds_read_b64_tr_b16 v[50:51], v7 offset:16896
    ds_read_b64_tr_b16 v[80:81], v8 offset:16384
    ds_read_b64_tr_b16 v[82:83], v8 offset:16896
    ds_read_b64_tr_b16 v[52:53], v7 offset:20480
    ds_read_b64_tr_b16 v[54:55], v7 offset:20992
    ds_read_b64_tr_b16 v[84:85], v8 offset:20480
    ds_read_b64_tr_b16 v[86:87], v8 offset:20992
    s_mov_b32 s56, 131072
    v_bfe_u32 v9, v0, 1, 3
    v_mul_u32_u24 v9, 528, v9
    v_and_b32 v16, 48, v0
    v_lshl_add_u32 v9, v16, 1, v9
    v_and_b32 v16, 1, v0
    v_lshlrev_b32 v16, 4, v16
    v_add3_u32 v9, v9, v16, s56
    v_lshrrev_b32 v10, 4, v0
    v_and_b32 v16, 1, v0
    v_lshl_add_u32 v10, v10, 1, v16
    v_mul_u32_u24 v10, 36864, v10
    v_bfe_u32 v16, v0, 1, 3
    v_lshl_add_u32 v10, v16, 4, v10
    s_mul_i32 s59, s100, 3
    s_lshr_b32 s56, s3, 1
    s_add_u32 s59, s59, s56
    s_lshl4_add_u32 s59, s59, s99
    s_and_b32 s56, s3, 1
    s_lshl1_add_u32 s59, s59, s56
    s_lshl_b32 s59, s59, 7
    s_add_u32 s59, s59, 0xe0000
    v_mov_b32 v139, s34
    v_mov_b32 v140, 0x4444
    v_mov_b32 v141, 0xeeee
    v_cndmask_b32 v140, v140, v141, s[96:97]
    v_mov_b32 v128, 0
    v_mov_b32 v129, 0
    v_mov_b32 v130, 0
    v_mov_b32 v131, 0
    v_mov_b32 v132, 0
    v_mov_b32 v133, 0
    v_mov_b32 v134, 0
    v_mov_b32 v135, 0
    s_waitcnt vmcnt(0)
    s_barrier
    ds_read_b64_tr_b16 v[56:57], v7 offset:24576
    ds_read_b64_tr_b16 v[58:59], v7 offset:25088
    ds_read_b64_tr_b16 v[88:89], v8 offset:24576
    ds_read_b64_tr_b16 v[90:91], v8 offset:25088
    ds_read_b64_tr_b16 v[60:61], v7 offset:28672
    ds_read_b64_tr_b16 v[62:63], v7 offset:29184
    ds_read_b64_tr_b16 v[92:93], v8 offset:28672
    ds_read_b64_tr_b16 v[94:95], v8 offset:29184
    s_branch .La_poll
.La_w67:
    s_cmp_eq_u32 s3, 7
    s_cbranch_scc0 2
    s_waitcnt vmcnt(1)
    s_branch 1
    s_waitcnt vmcnt(0)
    s_barrier
.La_poll:
    s_mov_b32 s60, 0x04000c0c
    s_mov_b32 s61, 0x0706000c
    s_mov_b32 s69, 0
.gp_55:
    s_add_u32 s69, s69, 1
    s_and_b32 s56, s69, 0x41
    s_cmp_lg_u32 s56, 0x41
    s_cselect_b32 s56, 0, 0x800000
    s_xor_b32 s56, s56, s0
    s_add_u32 s58, s101, s56
    buffer_load_dwordx4 v[16:19], v2, s[36:39], s58 offen offset:0 sc1
    buffer_load_dwordx4 v[20:23], v5, s[36:39], s58 offen offset:0 sc1
    s_waitcnt vmcnt(0)
    v_cmp_eq_u32 vcc, s34, v19
    v_cmp_eq_u32 s[56:57], s34, v23
    s_and_b64 vcc, vcc, s[56:57]
    s_cmp_eq_u64 vcc, -1
    s_nop 2
    s_cbranch_scc1 .gpd_56
    s_sub_u32 s35, s35, 1
    s_cbranch_scc1 .Lexit
    s_branch .gp_55
.gpd_56:
    v_perm_b32 v19, v16, v17, s60
    v_perm_b32 v19, v19, v18, s61
    v_perm_b32 v23, v20, v21, s60
    v_perm_b32 v23, v23, v22, s61
    v_permlane32_swap_b32 v16, v18
    v_permlane32_swap_b32 v17, v19
    v_permlane32_swap_b32 v20, v22
    v_permlane32_swap_b32 v21, v23
    v_pk_add_f32 v[16:17], v[16:17], v[18:19]
    v_pk_add_f32 v[20:21], v[20:21], v[22:23]
    v_cvt_pk_bf16_f32 v16, v16, v17
    v_cvt_pk_bf16_f32 v20, v20, v21
    ds_write2_b32 v6, v16, v20 offset1:64
    s_mov_b32 s60, 0x07060503
    s_mov_b32 s61, 0x07060502
    s_mov_b32 s62, 0x07060501
    s_mov_b32 vcc_lo, 0x55555555
    s_mov_b32 vcc_hi, 0x55555555
    s_waitcnt lgkmcnt(0)
    s_barrier
    s_cmp_ge_u32 s3, 6
    s_cbranch_scc1 .Lexit
    ds_read_b128 v[96:99], v9 offset:0
    ds_read_b128 v[100:103], v9 offset:128
    ds_read_b128 v[104:107], v9 offset:256
    ds_read_b128 v[108:111], v9 offset:384
    s_waitcnt lgkmcnt(3)
    v_smfmac_f32_16x16x64_bf16 v[128:131], v[96:99], v[32:39], v140
    v_smfmac_f32_16x16x64_bf16 v[132:135], v[96:99], v[64:71], v140
    s_waitcnt lgkmcnt(2)
    v_smfmac_f32_16x16x64_bf16 v[128:131], v[100:103], v[40:47], v140
    v_smfmac_f32_16x16x64_bf16 v[132:135], v[100:103], v[72:79], v140
    s_waitcnt lgkmcnt(1)
    v_smfmac_f32_16x16x64_bf16 v[128:131], v[104:107], v[48:55], v140
    v_smfmac_f32_16x16x64_bf16 v[132:135], v[104:107], v[80:87], v140
    s_waitcnt lgkmcnt(0)
    v_smfmac_f32_16x16x64_bf16 v[128:131], v[108:111], v[56:63], v140
    v_smfmac_f32_16x16x64_bf16 v[132:135], v[108:111], v[88:95], v140
    s_nop 6
    v_add_f32 v128, v128, v129
    v_add_f32 v130, v130, v131
    v_add_f32 v132, v132, v133
    v_add_f32 v134, v134, v135
    s_not_b64 vcc, vcc
    v_cndmask_b32_dpp v129, v128, v130, vcc quad_perm:[1,0,3,2] row_mask:0xf bank_mask:0xf
    v_cndmask_b32_dpp v131, v132, v134, vcc quad_perm:[1,0,3,2] row_mask:0xf bank_mask:0xf
    s_not_b64 vcc, vcc
    v_cndmask_b32_dpp v128, v130, v128, vcc quad_perm:[1,0,3,2] row_mask:0xf bank_mask:0xf
    v_cndmask_b32_dpp v130, v134, v132, vcc quad_perm:[1,0,3,2] row_mask:0xf bank_mask:0xf
    v_perm_b32 v136, v128, v131, s60
    v_perm_b32 v137, v129, v131, s61
    v_perm_b32 v138, v130, v131, s62
    buffer_store_dwordx4 v[136:139], v10, s[36:39], s59 offen sc1
    s_nop 1
    s_branch .Lexit
.Lm:
    s_branch .Lsk_m0_0
.Lst_m0_0:
    s_branch .Lrt_m0_0
.Lsk_m0_0:
    s_cmp_lt_u32 s2, 54
    s_mov_b32 s14, 0xfdff7fdf
    s_cselect_b32 s14, 0x6b5ad6b5, s14
    s_mov_b32 s15, 0xff7fdff7
    s_cselect_b32 s15, 0x5ad6b5ad, s15
    s_add_u32 s30, s70, 0
    s_mov_b32 s31, s70
    v_bfe_u32 v16, v0, 1, 3
    v_mul_u32_u24 v16, 1312, v16
    v_lshrrev_b32 v12, 4, v0
    v_lshl_add_u32 v16, v12, 5, v16
    v_and_b32 v12, 1, v0
    v_lshl_add_u32 v16, v12, 4, v16
    v_add_u32 v16, 147456, v16
    s_mul_i32 s56, s3, 1312
    s_add_u32 s56, s56, 147456
    v_add_u32 v17, s56, v3
    v_add_u32 v18, s56, v4
    v_lshrrev_b32 v12, 4, v0
    v_bfe_u32 v13, v0, 1, 1
    v_lshl_add_u32 v12, v12, 1, v13
    v_bfe_u32 v13, v0, 2, 2
    v_lshl_add_u32 v20, v12, 3, v13
    v_lshlrev_b32 v20, 7, v20
    v_and_b32 v12, 3, v12
    v_lshrrev_b32 v13, 1, v13
    v_lshl_add_u32 v12, v12, 1, v13
    v_xor_b32 v12, s3, v12
    v_lshl_add_u32 v20, v12, 4, v20
    v_and_b32 v12, 1, v0
    v_lshl_add_u32 v20, v12, 3, v20
    v_bfe_u32 v23, v0, 1, 3
    v_mul_u32_u24 v23, 144, v23
    v_bfe_u32 v12, v0, 4, 1
    v_lshl_add_u32 v23, v12, 3, v23
    v_lshrrev_b32 v12, 5, v0
    v_lshl_add_u32 v23, v12, 2, v23
    v_and_b32 v12, 1, v0
    v_lshl_add_u32 v23, v12, 1, v23
    s_lshl_b32 s56, s3, 4
    s_add_u32 s56, s56, 157952
    v_add_u32 v23, s56, v23
    v_and_b32 v24, 15, v0
    v_lshlrev_b32 v24, 3, v24
    s_mul_i32 s56, s3, 144
    s_add_u32 s56, s56, 157952
    v_add_u32 v24, s56, v24
    v_add_u32 v21, 32768, v20
    s_lshl_b32 s100, s3, 10
    s_mov_b32 s99, s2
    s_cmp_ge_u32 s99, 18
    s_cbranch_scc1 .Lm_rel
    s_mul_i32 s58, s3, 1152
    s_mov_b32 s52, s24
    s_and_b32 s53, s25, 0xffff
    s_mov_b32 s54, 0x2400
    s_mov_b32 s55, 0x00020000
    buffer_load_dwordx2 v[246:247], v3, s[52:55], s58 offen
    buffer_load_dwordx2 v[248:249], v3, s[52:55], s58 offen offset:512
    buffer_load_dword v250, v4, s[52:55], s58 offen
    s_mov_b32 s48, s26
    s_and_b32 s49, s27, 0xffff
    s_mov_b32 s50, 0x3cc000
    s_mov_b32 s51, 0x00020000
    v_bfe_u32 v12, v0, 4, 1
    s_and_b32 s56, s3, 3
    s_lshl_b32 s56, s56, 1
    v_or_b32 v12, s56, v12
    v_and_b32 v19, 7, v0
    v_xor_b32 v12, v12, v19
    v_lshrrev_b32 v19, 3, v0
    v_mul_u32_u24 v19, 6912, v19
    v_lshl_add_u32 v19, v12, 4, v19
    s_mul_i32 s57, s3, 55296
    s_lshl_b32 s59, s99, 7
    s_add_u32 s57, s57, s59
    s_add_u32 m0, s100, 0
    s_add_u32 s56, s57, 0
    buffer_load_dwordx4 v19, s[48:51], s56 offen nt lds
    s_add_u32 m0, s100, 8192
    s_add_u32 s56, s57, 442368
    buffer_load_dwordx4 v19, s[48:51], s56 offen nt lds
    s_add_u32 m0, s100, 16384
    s_add_u32 s56, s57, 884736
    buffer_load_dwordx4 v19, s[48:51], s56 offen nt lds
    s_add_u32 m0, s100, 24576
    s_add_u32 s56, s57, 1327104
    buffer_load_dwordx4 v19, s[48:51], s56 offen nt lds
    s_add_u32 m0, s100, 32768
    s_add_u32 s56, s57, 1769472
    buffer_load_dwordx4 v19, s[48:51], s56 offen nt lds
    s_add_u32 m0, s100, 40960
    s_add_u32 s56, s57, 2211840
    buffer_load_dwordx4 v19, s[48:51], s56 offen nt lds
    s_add_u32 m0, s100, 49152
    s_add_u32 s56, s57, 2654208
    buffer_load_dwordx4 v19, s[48:51], s56 offen nt lds
    s_add_u32 m0, s100, 57344
    s_add_u32 s56, s57, 3096576
    buffer_load_dwordx4 v19, s[48:51], s56 offen nt lds
    s_add_u32 m0, s100, 65536
    s_add_u32 s56, s57, 3538944
    buffer_load_dwordx4 v19, s[48:51], s56 offen nt lds
    s_waitcnt lgkmcnt(0)
    s_add_u32 s34, s34, 1
    s_getreg_b32 s1, hwreg(HW_REG_XCC_ID)
    s_lshl_b32 s1, s1, 24
    s_add_u32 s1, s1, s34
    s_lshr_b32 s0, s2, 3
    s_lshl_b32 s63, s64, 8
    s_add_u32 s0, s0, s63
    s_lshl2_add_u32 s0, s0, 0x480000
    v_mov_b32 v30, s1
    s_cmp_eq_u32 s3, 0
    s_cselect_b64 exec, 1, 0
    buffer_store_dword v30, v2, s[36:39], s0 offen sc1
    s_mov_b64 exec, -1
    v_lshrrev_b32 v12, 4, v0
    v_mul_u32_u24 v12, 18432, v12
    v_and_b32 v13, 15, v0
    v_lshl_add_u32 v22, v13, 4, v12
    s_mul_i32 s57, s99, 57
    s_lshr_b32 s57, s57, 9
    s_mul_i32 s58, s57, 9
    s_sub_u32 s58, s99, s58
    s_mul_i32 s59, s57, 73728
    s_lshl_b32 s58, s58, 8
    s_add_u32 s59, s59, s58
    s_mul_i32 s58, s3, 2304
    s_add_u32 s59, s59, s58
    s_add_u32 s59, s59, 0x1000
    s_mov_b32 s58, 0
    s_cmp_eq_u32 s57, 1
    s_cselect_b32 s58, 1.0, s58
    s_cmp_eq_u32 s57, 4
    s_cselect_b32 s58, 1.0, s58
    s_waitcnt vmcnt(10)
    v_lshlrev_b32 v236, 16, v246
    v_and_b32 v237, 0xffff0000, v246
    v_max_f32 v236, 0xc2ae0000, v236
    v_min_f32 v242, 0x43000000, v236
    v_mul_f32 v238, 0xbfb8aa3b, v242
    v_fma_f32 v240, v242, s98, -v238
    v_fmac_f32 v240, 0xb2a57060, v242
    v_exp_f32 v238, v238
    v_mul_f32 v240, 0x3f317218, v240
    v_fmac_f32 v238, v238, v240
    v_add_f32 v238, 1.0, v238
    v_rcp_f32 v240, v238
    s_nop 0
    v_mul_f32 v242, v236, v240
    v_fma_f32 v238, -v242, v238, v236
    v_fma_f32 v236, v238, v240, v242
    v_max_f32 v237, 0xc2ae0000, v237
    v_min_f32 v243, 0x43000000, v237
    v_mul_f32 v239, 0xbfb8aa3b, v243
    v_fma_f32 v241, v243, s98, -v239
    v_fmac_f32 v241, 0xb2a57060, v243
    v_exp_f32 v239, v239
    v_mul_f32 v241, 0x3f317218, v241
    v_fmac_f32 v239, v239, v241
    v_add_f32 v239, 1.0, v239
    v_rcp_f32 v241, v239
    s_nop 0
    v_mul_f32 v243, v237, v241
    v_fma_f32 v239, -v243, v239, v237
    v_fma_f32 v237, v239, v241, v243
    v_cvt_pk_bf16_f32 v246, v236, v237
    v_lshlrev_b32 v236, 16, v247
    s_branch .Lsk_m0_1
.Lst_m0_1:
    s_branch .Lrt_m0_1
.Lsk_m0_1:
    v_and_b32 v237, 0xffff0000, v247
    v_max_f32 v236, 0xc2ae0000, v236
    v_min_f32 v242, 0x43000000, v236
    v_mul_f32 v238, 0xbfb8aa3b, v242
    v_fma_f32 v240, v242, s98, -v238
    v_fmac_f32 v240, 0xb2a57060, v242
    v_exp_f32 v238, v238
    v_mul_f32 v240, 0x3f317218, v240
    v_fmac_f32 v238, v238, v240
    v_add_f32 v238, 1.0, v238
    v_rcp_f32 v240, v238
    s_nop 0
    v_mul_f32 v242, v236, v240
    v_fma_f32 v238, -v242, v238, v236
    v_fma_f32 v236, v238, v240, v242
    v_max_f32 v237, 0xc2ae0000, v237
    v_min_f32 v243, 0x43000000, v237
    v_mul_f32 v239, 0xbfb8aa3b, v243
    v_fma_f32 v241, v243, s98, -v239
    v_fmac_f32 v241, 0xb2a57060, v243
    v_exp_f32 v239, v239
    v_mul_f32 v241, 0x3f317218, v241
    v_fmac_f32 v239, v239, v241
    v_add_f32 v239, 1.0, v239
    v_rcp_f32 v241, v239
    s_nop 0
    v_mul_f32 v243, v237, v241
    v_fma_f32 v239, -v243, v239, v237
    v_fma_f32 v237, v239, v241, v243
    v_cvt_pk_bf16_f32 v247, v236, v237
    v_lshlrev_b32 v236, 16, v248
    v_and_b32 v237, 0xffff0000, v248
    v_max_f32 v236, 0xc2ae0000, v236
    v_min_f32 v242, 0x43000000, v236
    v_mul_f32 v238, 0xbfb8aa3b, v242
    v_fma_f32 v240, v242, s98, -v238
    v_fmac_f32 v240, 0xb2a57060, v242
    v_exp_f32 v238, v238
    v_mul_f32 v240, 0x3f317218, v240
    v_fmac_f32 v238, v238, v240
    v_add_f32 v238, 1.0, v238
    v_rcp_f32 v240, v238
    s_nop 0
    v_mul_f32 v242, v236, v240
    v_fma_f32 v238, -v242, v238, v236
    v_fma_f32 v236, v238, v240, v242
    v_max_f32 v237, 0xc2ae0000, v237
    v_min_f32 v243, 0x43000000, v237
    v_mul_f32 v239, 0xbfb8aa3b, v243
    v_fma_f32 v241, v243, s98, -v239
    v_fmac_f32 v241, 0xb2a57060, v243
    v_exp_f32 v239, v239
    v_mul_f32 v241, 0x3f317218, v241
    v_fmac_f32 v239, v239, v241
    v_add_f32 v239, 1.0, v239
    v_rcp_f32 v241, v239
    s_nop 0
    v_mul_f32 v243, v237, v241
    v_fma_f32 v239, -v243, v239, v237
    v_fma_f32 v237, v239, v241, v243
    v_cvt_pk_bf16_f32 v248, v236, v237
    v_lshlrev_b32 v236, 16, v249
    v_and_b32 v237, 0xffff0000, v249
    v_max_f32 v236, 0xc2ae0000, v236
    v_min_f32 v242, 0x43000000, v236
    v_mul_f32 v238, 0xbfb8aa3b, v242
    v_fma_f32 v240, v242, s98, -v238
    v_fmac_f32 v240, 0xb2a57060, v242
    v_exp_f32 v238, v238
    v_mul_f32 v240, 0x3f317218, v240
    v_fmac_f32 v238, v238, v240
    v_add_f32 v238, 1.0, v238
    v_rcp_f32 v240, v238
    s_nop 0
    v_mul_f32 v242, v236, v240
    v_fma_f32 v238, -v242, v238, v236
    v_fma_f32 v236, v238, v240, v242
    v_max_f32 v237, 0xc2ae0000, v237
    v_min_f32 v243, 0x43000000, v237
    v_mul_f32 v239, 0xbfb8aa3b, v243
    v_fma_f32 v241, v243, s98, -v239
    v_fmac_f32 v241, 0xb2a57060, v243
    v_exp_f32 v239, v239
    v_mul_f32 v241, 0x3f317218, v241
    v_fmac_f32 v239, v239, v241
    v_add_f32 v239, 1.0, v239
    v_rcp_f32 v241, v239
    s_nop 0
    v_mul_f32 v243, v237, v241
    v_fma_f32 v239, -v243, v239, v237
    v_fma_f32 v237, v239, v241, v243
    v_cvt_pk_bf16_f32 v249, v236, v237
    v_lshlrev_b32 v236, 16, v250
    v_and_b32 v237, 0xffff0000, v250
    v_max_f32 v236, 0xc2ae0000, v236
    v_min_f32 v242, 0x43000000, v236
    v_mul_f32 v238, 0xbfb8aa3b, v242
    v_fma_f32 v240, v242, s98, -v238
    v_fmac_f32 v240, 0xb2a57060, v242
    v_exp_f32 v238, v238
    v_mul_f32 v240, 0x3f317218, v240
    v_fmac_f32 v238, v238, v240
    v_add_f32 v238, 1.0, v238
    v_rcp_f32 v240, v238
    s_nop 0
    v_mul_f32 v242, v236, v240
    v_fma_f32 v238, -v242, v238, v236
    v_fma_f32 v236, v238, v240, v242
    v_max_f32 v237, 0xc2ae0000, v237
    v_min_f32 v243, 0x43000000, v237
    v_mul_f32 v239, 0xbfb8aa3b, v243
    v_fma_f32 v241, v243, s98, -v239
    v_fmac_f32 v241, 0xb2a57060, v243
    v_exp_f32 v239, v239
    v_mul_f32 v241, 0x3f317218, v241
    v_fmac_f32 v239, v239, v241
    v_add_f32 v239, 1.0, v239
    v_rcp_f32 v241, v239
    s_nop 0
    v_mul_f32 v243, v237, v241
    v_fma_f32 v239, -v243, v239, v237
    v_fma_f32 v237, v239, v241, v243
    v_cvt_pk_bf16_f32 v250, v236, v237
    ds_write_b64 v17, v[246:247] offset:0
    ds_write_b64 v17, v[248:249] offset:512
    ds_write_b32 v18, v250 offset:0
    s_waitcnt vmcnt(1)
    s_waitcnt lgkmcnt(0)
    s_barrier
    ds_read_b64_tr_b16 v[160:161], v20 offset:0
    ds_read_b64_tr_b16 v[162:163], v20 offset:512
    ds_read_b64_tr_b16 v[164:165], v20 offset:8192
    ds_read_b64_tr_b16 v[166:167], v20 offset:8704
    ds_read_b64_tr_b16 v[168:169], v20 offset:16384
    ds_read_b64_tr_b16 v[170:171], v20 offset:16896
    ds_read_b64_tr_b16 v[172:173], v20 offset:24576
    ds_read_b64_tr_b16 v[174:175], v20 offset:25088
    ds_read_b64_tr_b16 v[176:177], v21 offset:0
    ds_read_b64_tr_b16 v[178:179], v21 offset:512
    ds_read_b64_tr_b16 v[180:181], v21 offset:8192
    ds_read_b64_tr_b16 v[182:183], v21 offset:8704
    ds_read_b64_tr_b16 v[184:185], v21 offset:16384
    ds_read_b64_tr_b16 v[186:187], v21 offset:16896
    ds_read_b64_tr_b16 v[188:189], v21 offset:24576
    ds_read_b64_tr_b16 v[190:191], v21 offset:25088
    ds_read_b64_tr_b16 v[192:193], v21 offset:32768
    s_branch .Lsk_m0_2
.Lst_m0_2:
    s_branch .Lrt_m0_2
.Lsk_m0_2:
    ds_read_b64_tr_b16 v[194:195], v21 offset:33280
    ds_read_b128 v[196:199], v16 offset:0
    ds_read_b128 v[200:203], v16 offset:128
    ds_read_b128 v[204:207], v16 offset:256
    ds_read_b128 v[208:211], v16 offset:384
    ds_read_b128 v[212:215], v16 offset:512
    ds_read_b128 v[216:219], v16 offset:640
    ds_read_b128 v[220:223], v16 offset:768
    ds_read_b128 v[224:227], v16 offset:896
    ds_read_b128 v[228:231], v16 offset:1024
    s_waitcnt lgkmcnt(8)
    v_mfma_f32_16x16x32_bf16 v[232:235], v[160:163], v[196:199], 0
    s_waitcnt lgkmcnt(7)
    v_mfma_f32_16x16x32_bf16 v[232:235], v[164:167], v[200:203], v[232:235]
    s_waitcnt lgkmcnt(6)
    v_mfma_f32_16x16x32_bf16 v[232:235], v[168:171], v[204:207], v[232:235]
    s_waitcnt lgkmcnt(5)
    v_mfma_f32_16x16x32_bf16 v[232:235], v[172:175], v[208:211], v[232:235]
    s_waitcnt lgkmcnt(4)
    v_mfma_f32_16x16x32_bf16 v[232:235], v[176:179], v[212:215], v[232:235]
    s_waitcnt lgkmcnt(3)
    v_mfma_f32_16x16x32_bf16 v[232:235], v[180:183], v[216:219], v[232:235]
    s_waitcnt lgkmcnt(2)
    v_mfma_f32_16x16x32_bf16 v[232:235], v[184:187], v[220:223], v[232:235]
    s_waitcnt lgkmcnt(1)
    v_mfma_f32_16x16x32_bf16 v[232:235], v[188:191], v[224:227], v[232:235]
    s_waitcnt lgkmcnt(0)
    v_mfma_f32_16x16x32_bf16 v[232:235], v[192:195], v[228:231], v[232:235]
    s_nop 7
    v_permlane32_swap_b32 v232, v234
    v_permlane32_swap_b32 v233, v235
    v_cndmask_b32 v233, v233, v234, s[96:97]
    v_cndmask_b32 v232, v232, v235, s[96:97]
    s_nop 1
    v_add_f32_dpp v236, v233, v232 quad_perm:[1,0,3,2] row_mask:0xf bank_mask:0xf
    v_cvt_pk_bf16_f32 v236, v236, v236
    v_lshlrev_b32 v236, 16, v236
    v_add_f32 v236, s58, v236
    v_cvt_pk_bf16_f32 v236, v236, v236
    ds_write_b16 v23, v236
    v_mov_b32 v243, s34
    s_waitcnt lgkmcnt(0)
    s_barrier
    ds_read2_b32 v[244:245], v24 offset1:1
    v_mov_b32 v241, s34
    s_waitcnt lgkmcnt(0)
    v_mov_b32 v240, v244
    v_mov_b32 v242, v245
    s_bfm_b64 exec, 16, 0
    buffer_store_dwordx4 v[240:243], v22, s[36:39], s59 offen sc1
    s_mov_b64 exec, -1
    s_add_u32 s63, s69, 32768
    buffer_load_dwordx4 v[96:99], v1, s[40:43], s63 offen nt
    s_add_u32 s63, s69, 40960
    buffer_load_dwordx4 v[100:103], v1, s[40:43], s63 offen nt
    s_add_u32 s63, s69, 49152
    buffer_load_dwordx4 v[128:131], v1, s[40:43], s63 offen nt
    s_add_u32 s63, s69, 57344
    buffer_load_dwordx4 v[132:135], v1, s[40:43], s63 offen nt
    s_waitcnt vmcnt(3)
    s_add_u32 s63, s69, 131072
    buffer_load_dwordx4 v[40:43], v1, s[40:43], s63 offen nt
    s_waitcnt vmcnt(3)
    s_add_u32 s63, s69, 139264
    buffer_load_dwordx4 v[44:47], v1, s[40:43], s63 offen nt
    s_waitcnt vmcnt(3)
    s_add_u32 s63, s69, 147456
    buffer_load_dwordx4 v[72:75], v1, s[40:43], s63 offen nt
    s_waitcnt vmcnt(3)
    s_add_u32 s63, s69, 155648
    buffer_load_dwordx4 v[76:79], v1, s[40:43], s63 offen nt
    s_waitcnt vmcnt(3)
    s_add_u32 s63, s69, 163840
    buffer_load_dwordx4 v[104:107], v1, s[40:43], s63 offen nt
    s_waitcnt vmcnt(3)
    s_add_u32 s63, s69, 172032
    buffer_load_dwordx4 v[108:111], v1, s[40:43], s63 offen nt
    s_waitcnt vmcnt(3)
    s_add_u32 s63, s69, 180224
    buffer_load_dwordx4 v[136:139], v1, s[40:43], s63 offen nt
    s_waitcnt vmcnt(3)
    s_add_u32 s63, s69, 188416
    buffer_load_dwordx4 v[140:143], v1, s[40:43], s63 offen nt
    s_waitcnt vmcnt(3)
    s_add_u32 s63, s69, 262144
    buffer_load_dwordx4 v[48:51], v1, s[40:43], s63 offen nt
    s_waitcnt vmcnt(3)
    s_add_u32 s63, s69, 270336
    buffer_load_dwordx4 v[52:55], v1, s[40:43], s63 offen nt
    s_branch .Le_done
.Lm_rel:
    s_waitcnt vmcnt(4)
    s_bitcmp1_b64 s[14:15], 4
    s_cbranch_scc0 1
    s_waitcnt vmcnt(3)
    s_add_u32 s63, s69, 32768
    buffer_load_dwordx4 v[96:99], v1, s[40:43], s63 offen nt
    s_waitcnt vmcnt(4)
    s_bitcmp1_b64 s[14:15], 5
    s_cbranch_scc0 1
    s_waitcnt vmcnt(3)
    s_add_u32 s63, s69, 40960
    buffer_load_dwordx4 v[100:103], v1, s[40:43], s63 offen nt
    s_waitcnt vmcnt(4)
    s_bitcmp1_b64 s[14:15], 6
    s_cbranch_scc0 1
    s_waitcnt vmcnt(3)
    s_add_u32 s63, s69, 49152
    buffer_load_dwordx4 v[128:131], v1, s[40:43], s63 offen nt
    s_waitcnt vmcnt(4)
    s_bitcmp1_b64 s[14:15], 7
    s_cbranch_scc0 1
    s_waitcnt vmcnt(2)
    s_add_u32 s63, s69, 57344
    buffer_load_dwordx4 v[132:135], v1, s[40:43], s63 offen nt
    s_waitcnt vmcnt(3)
    s_bitcmp1_b64 s[14:15], 8
    s_cbranch_scc0 1
    s_waitcnt vmcnt(2)
    s_add_u32 s63, s69, 131072
    buffer_load_dwordx4 v[40:43], v1, s[40:43], s63 offen nt
    s_waitcnt vmcnt(3)
    s_bitcmp1_b64 s[14:15], 9
    s_cbranch_scc0 1
    s_waitcnt vmcnt(2)
    s_add_u32 s63, s69, 139264
    buffer_load_dwordx4 v[44:47], v1, s[40:43], s63 offen nt
    s_waitcnt lgkmcnt(0)
    s_add_u32 s34, s34, 1
    s_getreg_b32 s1, hwreg(HW_REG_XCC_ID)
    s_lshl_b32 s1, s1, 24
    s_add_u32 s1, s1, s34
    s_lshr_b32 s0, s2, 3
    s_lshl_b32 s63, s64, 8
    s_add_u32 s0, s0, s63
    s_lshl2_add_u32 s0, s0, 0x480000
    v_mov_b32 v30, s1
    s_cmp_eq_u32 s3, 0
    s_cselect_b64 exec, 1, 0
    buffer_store_dword v30, v2, s[36:39], s0 offen sc1
    s_mov_b64 exec, -1
    s_cmp_lt_u32 s99, 54
    s_cbranch_scc1 .Lmr_part
    s_waitcnt vmcnt(4)
    s_bitcmp1_b64 s[14:15], 10
    s_cbranch_scc0 1
    s_waitcnt vmcnt(3)
    s_add_u32 s63, s69, 147456
    buffer_load_dwordx4 v[72:75], v1, s[40:43], s63 offen nt
    s_waitcnt vmcnt(4)
    s_bitcmp1_b64 s[14:15], 11
    s_cbranch_scc0 1
    s_waitcnt vmcnt(3)
    s_add_u32 s63, s69, 155648
    buffer_load_dwordx4 v[76:79], v1, s[40:43], s63 offen nt
    s_waitcnt vmcnt(4)
    s_bitcmp1_b64 s[14:15], 12
    s_cbranch_scc0 1
    s_waitcnt vmcnt(3)
    s_add_u32 s63, s69, 163840
    buffer_load_dwordx4 v[104:107], v1, s[40:43], s63 offen nt
    s_waitcnt vmcnt(4)
    s_bitcmp1_b64 s[14:15], 13
    s_cbranch_scc0 1
    s_waitcnt vmcnt(2)
    s_add_u32 s63, s69, 172032
    buffer_load_dwordx4 v[108:111], v1, s[40:43], s63 offen nt
    s_waitcnt vmcnt(3)
    s_bitcmp1_b64 s[14:15], 14
    s_cbranch_scc0 1
    s_waitcnt vmcnt(2)
    s_add_u32 s63, s69, 180224
    buffer_load_dwordx4 v[136:139], v1, s[40:43], s63 offen nt
    s_waitcnt vmcnt(3)
    s_bitcmp1_b64 s[14:15], 15
    s_cbranch_scc0 1
    s_waitcnt vmcnt(2)
    s_add_u32 s63, s69, 188416
    buffer_load_dwordx4 v[140:143], v1, s[40:43], s63 offen nt
    s_waitcnt vmcnt(3)
    s_bitcmp1_b64 s[14:15], 16
    s_cbranch_scc0 1
    s_waitcnt vmcnt(2)
    s_add_u32 s63, s69, 262144
    buffer_load_dwordx4 v[48:51], v1, s[40:43], s63 offen nt
    s_waitcnt vmcnt(3)
    s_bitcmp1_b64 s[14:15], 17
    s_cbranch_scc0 1
    s_waitcnt vmcnt(2)
    s_branch .Lsk_m0_3
.Lst_m0_3:
    s_branch .Lrt_m0_3
.Lsk_m0_3:
    s_add_u32 s63, s69, 270336
    buffer_load_dwordx4 v[52:55], v1, s[40:43], s63 offen nt
    s_branch .Le_done
.Lmr_part:
    s_mul_i32 s58, s3, 1152
    s_mov_b32 s52, s24
    s_and_b32 s53, s25, 0xffff
    s_mov_b32 s54, 0x2400
    s_mov_b32 s55, 0x00020000
    buffer_load_dwordx2 v[246:247], v3, s[52:55], s58 offen
    buffer_load_dwordx2 v[248:249], v3, s[52:55], s58 offen offset:512
    buffer_load_dword v250, v4, s[52:55], s58 offen
    s_mov_b32 s48, s26
    s_and_b32 s49, s27, 0xffff
    s_mov_b32 s50, 0x3cc000
    s_mov_b32 s51, 0x00020000
    v_bfe_u32 v12, v0, 4, 1
    s_and_b32 s56, s3, 3
    s_lshl_b32 s56, s56, 1
    v_or_b32 v12, s56, v12
    v_and_b32 v19, 7, v0
    v_xor_b32 v12, v12, v19
    v_lshrrev_b32 v19, 3, v0
    v_mul_u32_u24 v19, 6912, v19
    v_lshl_add_u32 v19, v12, 4, v19
    s_mul_i32 s57, s3, 55296
    s_lshl_b32 s59, s99, 7
    s_add_u32 s57, s57, s59
    s_add_u32 m0, s100, 0
    s_add_u32 s56, s57, 0
    buffer_load_dwordx4 v19, s[48:51], s56 offen nt lds
    s_add_u32 m0, s100, 8192
    s_add_u32 s56, s57, 442368
    buffer_load_dwordx4 v19, s[48:51], s56 offen nt lds
    s_add_u32 m0, s100, 16384
    s_add_u32 s56, s57, 884736
    buffer_load_dwordx4 v19, s[48:51], s56 offen nt lds
    s_add_u32 m0, s100, 24576
    s_add_u32 s56, s57, 1327104
    buffer_load_dwordx4 v19, s[48:51], s56 offen nt lds
    s_add_u32 m0, s100, 32768
    s_add_u32 s56, s57, 1769472
    buffer_load_dwordx4 v19, s[48:51], s56 offen nt lds
    s_add_u32 m0, s100, 40960
    s_add_u32 s56, s57, 2211840
    buffer_load_dwordx4 v19, s[48:51], s56 offen nt lds
    s_add_u32 m0, s100, 49152
    s_add_u32 s56, s57, 2654208
    buffer_load_dwordx4 v19, s[48:51], s56 offen nt lds
    s_add_u32 m0, s100, 57344
    s_add_u32 s56, s57, 3096576
    buffer_load_dwordx4 v19, s[48:51], s56 offen nt lds
    s_add_u32 m0, s100, 65536
    s_add_u32 s56, s57, 3538944
    buffer_load_dwordx4 v19, s[48:51], s56 offen nt lds
    v_lshrrev_b32 v12, 4, v0
    v_mul_u32_u24 v12, 18432, v12
    v_and_b32 v13, 15, v0
    v_lshl_add_u32 v22, v13, 4, v12
    s_mul_i32 s57, s99, 57
    s_lshr_b32 s57, s57, 9
    s_mul_i32 s58, s57, 9
    s_sub_u32 s58, s99, s58
    s_mul_i32 s59, s57, 73728
    s_lshl_b32 s58, s58, 8
    s_add_u32 s59, s59, s58
    s_mul_i32 s58, s3, 2304
    s_add_u32 s59, s59, s58
    s_add_u32 s59, s59, 0x1000
    s_mov_b32 s58, 0
    s_cmp_eq_u32 s57, 1
    s_cselect_b32 s58, 1.0, s58
    s_cmp_eq_u32 s57, 4
    s_cselect_b32 s58, 1.0, s58
    s_waitcnt vmcnt(9)
    v_lshlrev_b32 v236, 16, v246
    v_and_b32 v237, 0xffff0000, v246
    v_max_f32 v236, 0xc2ae0000, v236
    v_min_f32 v242, 0x43000000, v236
    v_mul_f32 v238, 0xbfb8aa3b, v242
    v_fma_f32 v240, v242, s98, -v238
    v_fmac_f32 v240, 0xb2a57060, v242
    v_exp_f32 v238, v238
    v_mul_f32 v240, 0x3f317218, v240
    v_fmac_f32 v238, v238, v240
    v_add_f32 v238, 1.0, v238
    v_rcp_f32 v240, v238
    s_nop 0
    v_mul_f32 v242, v236, v240
    v_fma_f32 v238, -v242, v238, v236
    v_fma_f32 v236, v238, v240, v242
    v_max_f32 v237, 0xc2ae0000, v237
    v_min_f32 v243, 0x43000000, v237
    v_mul_f32 v239, 0xbfb8aa3b, v243
    v_fma_f32 v241, v243, s98, -v239
    v_fmac_f32 v241, 0xb2a57060, v243
    v_exp_f32 v239, v239
    v_mul_f32 v241, 0x3f317218, v241
    v_fmac_f32 v239, v239, v241
    v_add_f32 v239, 1.0, v239
    v_rcp_f32 v241, v239
    s_nop 0
    v_mul_f32 v243, v237, v241
    v_fma_f32 v239, -v243, v239, v237
    v_fma_f32 v237, v239, v241, v243
    v_cvt_pk_bf16_f32 v246, v236, v237
    v_lshlrev_b32 v236, 16, v247
    v_and_b32 v237, 0xffff0000, v247
    v_max_f32 v236, 0xc2ae0000, v236
    v_min_f32 v242, 0x43000000, v236
    v_mul_f32 v238, 0xbfb8aa3b, v242
    v_fma_f32 v240, v242, s98, -v238
    v_fmac_f32 v240, 0xb2a57060, v242
    v_exp_f32 v238, v238
    v_mul_f32 v240, 0x3f317218, v240
    v_fmac_f32 v238, v238, v240
    v_add_f32 v238, 1.0, v238
    v_rcp_f32 v240, v238
    s_nop 0
    v_mul_f32 v242, v236, v240
    v_fma_f32 v238, -v242, v238, v236
    v_fma_f32 v236, v238, v240, v242
    v_max_f32 v237, 0xc2ae0000, v237
    v_min_f32 v243, 0x43000000, v237
    v_mul_f32 v239, 0xbfb8aa3b, v243
    v_fma_f32 v241, v243, s98, -v239
    v_fmac_f32 v241, 0xb2a57060, v243
    v_exp_f32 v239, v239
    v_mul_f32 v241, 0x3f317218, v241
    v_fmac_f32 v239, v239, v241
    v_add_f32 v239, 1.0, v239
    v_rcp_f32 v241, v239
    s_nop 0
    v_mul_f32 v243, v237, v241
    v_fma_f32 v239, -v243, v239, v237
    v_fma_f32 v237, v239, v241, v243
    v_cvt_pk_bf16_f32 v247, v236, v237
    v_lshlrev_b32 v236, 16, v248
    v_and_b32 v237, 0xffff0000, v248
    v_max_f32 v236, 0xc2ae0000, v236
    v_min_f32 v242, 0x43000000, v236
    v_mul_f32 v238, 0xbfb8aa3b, v242
    v_fma_f32 v240, v242, s98, -v238
    v_fmac_f32 v240, 0xb2a57060, v242
    v_exp_f32 v238, v238
    v_mul_f32 v240, 0x3f317218, v240
    v_fmac_f32 v238, v238, v240
    v_add_f32 v238, 1.0, v238
    v_rcp_f32 v240, v238
    s_nop 0
    v_mul_f32 v242, v236, v240
    v_fma_f32 v238, -v242, v238, v236
    v_fma_f32 v236, v238, v240, v242
    v_max_f32 v237, 0xc2ae0000, v237
    v_min_f32 v243, 0x43000000, v237
    v_mul_f32 v239, 0xbfb8aa3b, v243
    v_fma_f32 v241, v243, s98, -v239
    v_fmac_f32 v241, 0xb2a57060, v243
    v_exp_f32 v239, v239
    v_mul_f32 v241, 0x3f317218, v241
    v_fmac_f32 v239, v239, v241
    v_add_f32 v239, 1.0, v239
    v_rcp_f32 v241, v239
    s_nop 0
    v_mul_f32 v243, v237, v241
    v_fma_f32 v239, -v243, v239, v237
    v_fma_f32 v237, v239, v241, v243
    v_cvt_pk_bf16_f32 v248, v236, v237
    v_lshlrev_b32 v236, 16, v249
    v_and_b32 v237, 0xffff0000, v249
    s_branch .Lsk_m0_4
.Lst_m0_4:
    s_branch .Lrt_m0_4
.Lsk_m0_4:
    v_max_f32 v236, 0xc2ae0000, v236
    v_min_f32 v242, 0x43000000, v236
    v_mul_f32 v238, 0xbfb8aa3b, v242
    v_fma_f32 v240, v242, s98, -v238
    v_fmac_f32 v240, 0xb2a57060, v242
    v_exp_f32 v238, v238
    v_mul_f32 v240, 0x3f317218, v240
    v_fmac_f32 v238, v238, v240
    v_add_f32 v238, 1.0, v238
    v_rcp_f32 v240, v238
    s_nop 0
    v_mul_f32 v242, v236, v240
    v_fma_f32 v238, -v242, v238, v236
    v_fma_f32 v236, v238, v240, v242
    v_max_f32 v237, 0xc2ae0000, v237
    v_min_f32 v243, 0x43000000, v237
    v_mul_f32 v239, 0xbfb8aa3b, v243
    v_fma_f32 v241, v243, s98, -v239
    v_fmac_f32 v241, 0xb2a57060, v243
    v_exp_f32 v239, v239
    v_mul_f32 v241, 0x3f317218, v241
    v_fmac_f32 v239, v239, v241
    v_add_f32 v239, 1.0, v239
    v_rcp_f32 v241, v239
    s_nop 0
    v_mul_f32 v243, v237, v241
    v_fma_f32 v239, -v243, v239, v237
    v_fma_f32 v237, v239, v241, v243
    v_cvt_pk_bf16_f32 v249, v236, v237
    v_lshlrev_b32 v236, 16, v250
    v_and_b32 v237, 0xffff0000, v250
    v_max_f32 v236, 0xc2ae0000, v236
    v_min_f32 v242, 0x43000000, v236
    v_mul_f32 v238, 0xbfb8aa3b, v242
    v_fma_f32 v240, v242, s98, -v238
    v_fmac_f32 v240, 0xb2a57060, v242
    v_exp_f32 v238, v238
    v_mul_f32 v240, 0x3f317218, v240
    v_fmac_f32 v238, v238, v240
    v_add_f32 v238, 1.0, v238
    v_rcp_f32 v240, v238
    s_nop 0
    v_mul_f32 v242, v236, v240
    v_fma_f32 v238, -v242, v238, v236
    v_fma_f32 v236, v238, v240, v242
    v_max_f32 v237, 0xc2ae0000, v237
    v_min_f32 v243, 0x43000000, v237
    v_mul_f32 v239, 0xbfb8aa3b, v243
    v_fma_f32 v241, v243, s98, -v239
    v_fmac_f32 v241, 0xb2a57060, v243
    v_exp_f32 v239, v239
    v_mul_f32 v241, 0x3f317218, v241
    v_fmac_f32 v239, v239, v241
    v_add_f32 v239, 1.0, v239
    v_rcp_f32 v241, v239
    s_nop 0
    v_mul_f32 v243, v237, v241
    v_fma_f32 v239, -v243, v239, v237
    v_fma_f32 v237, v239, v241, v243
    v_cvt_pk_bf16_f32 v250, v236, v237
    ds_write_b64 v17, v[246:247] offset:0
    ds_write_b64 v17, v[248:249] offset:512
    ds_write_b32 v18, v250 offset:0
    s_waitcnt vmcnt(3)
    s_add_u32 s63, s69, 147456
    buffer_load_dwordx4 v[72:75], v1, s[40:43], s63 offen nt
    s_waitcnt vmcnt(3)
    s_add_u32 s63, s69, 155648
    buffer_load_dwordx4 v[76:79], v1, s[40:43], s63 offen nt
    s_waitcnt vmcnt(3)
    s_add_u32 s63, s69, 163840
    buffer_load_dwordx4 v[104:107], v1, s[40:43], s63 offen nt
    s_waitcnt vmcnt(3)
    s_add_u32 s63, s69, 172032
    buffer_load_dwordx4 v[108:111], v1, s[40:43], s63 offen nt
    s_waitcnt vmcnt(3)
    s_add_u32 s63, s69, 180224
    buffer_load_dwordx4 v[136:139], v1, s[40:43], s63 offen nt
    s_waitcnt vmcnt(3)
    s_add_u32 s63, s69, 188416
    buffer_load_dwordx4 v[140:143], v1, s[40:43], s63 offen nt
    s_waitcnt vmcnt(3)
    s_add_u32 s63, s69, 262144
    buffer_load_dwordx4 v[48:51], v1, s[40:43], s63 offen nt
    s_waitcnt vmcnt(3)
    s_add_u32 s63, s69, 270336
    buffer_load_dwordx4 v[52:55], v1, s[40:43], s63 offen nt
    s_waitcnt lgkmcnt(0)
    s_barrier
    ds_read_b64_tr_b16 v[160:161], v20 offset:0
    ds_read_b64_tr_b16 v[162:163], v20 offset:512
    ds_read_b64_tr_b16 v[164:165], v20 offset:8192
    ds_read_b64_tr_b16 v[166:167], v20 offset:8704
    ds_read_b64_tr_b16 v[168:169], v20 offset:16384
    ds_read_b64_tr_b16 v[170:171], v20 offset:16896
    ds_read_b64_tr_b16 v[172:173], v20 offset:24576
    ds_read_b64_tr_b16 v[174:175], v20 offset:25088
    ds_read_b64_tr_b16 v[176:177], v21 offset:0
    ds_read_b64_tr_b16 v[178:179], v21 offset:512
    ds_read_b64_tr_b16 v[180:181], v21 offset:8192
    ds_read_b64_tr_b16 v[182:183], v21 offset:8704
    ds_read_b64_tr_b16 v[184:185], v21 offset:16384
    ds_read_b64_tr_b16 v[186:187], v21 offset:16896
    ds_read_b64_tr_b16 v[188:189], v21 offset:24576
    ds_read_b64_tr_b16 v[190:191], v21 offset:25088
    ds_read_b64_tr_b16 v[192:193], v21 offset:32768
    ds_read_b64_tr_b16 v[194:195], v21 offset:33280
    ds_read_b128 v[196:199], v16 offset:0
    ds_read_b128 v[200:203], v16 offset:128
    ds_read_b128 v[204:207], v16 offset:256
    ds_read_b128 v[208:211], v16 offset:384
    ds_read_b128 v[212:215], v16 offset:512
    ds_read_b128 v[216:219], v16 offset:640
    ds_read_b128 v[220:223], v16 offset:768
    ds_read_b128 v[224:227], v16 offset:896
    ds_read_b128 v[228:231], v16 offset:1024
    s_waitcnt lgkmcnt(8)
    v_mfma_f32_16x16x32_bf16 v[232:235], v[160:163], v[196:199], 0
    s_waitcnt lgkmcnt(7)
    v_mfma_f32_16x16x32_bf16 v[232:235], v[164:167], v[200:203], v[232:235]
    s_waitcnt lgkmcnt(6)
    v_mfma_f32_16x16x32_bf16 v[232:235], v[168:171], v[204:207], v[232:235]
    s_waitcnt lgkmcnt(5)
    v_mfma_f32_16x16x32_bf16 v[232:235], v[172:175], v[208:211], v[232:235]
    s_waitcnt lgkmcnt(4)
    v_mfma_f32_16x16x32_bf16 v[232:235], v[176:179], v[212:215], v[232:235]
    s_waitcnt lgkmcnt(3)
    v_mfma_f32_16x16x32_bf16 v[232:235], v[180:183], v[216:219], v[232:235]
    s_waitcnt lgkmcnt(2)
    v_mfma_f32_16x16x32_bf16 v[232:235], v[184:187], v[220:223], v[232:235]
    s_waitcnt lgkmcnt(1)
    v_mfma_f32_16x16x32_bf16 v[232:235], v[188:191], v[224:227], v[232:235]
    s_waitcnt lgkmcnt(0)
    v_mfma_f32_16x16x32_bf16 v[232:235], v[192:195], v[228:231], v[232:235]
    s_nop 7
    v_permlane32_swap_b32 v232, v234
    v_permlane32_swap_b32 v233, v235
    v_cndmask_b32 v233, v233, v234, s[96:97]
    v_cndmask_b32 v232, v232, v235, s[96:97]
    s_nop 1
    v_add_f32_dpp v236, v233, v232 quad_perm:[1,0,3,2] row_mask:0xf bank_mask:0xf
    v_cvt_pk_bf16_f32 v236, v236, v236
    v_lshlrev_b32 v236, 16, v236
    v_add_f32 v236, s58, v236
    v_cvt_pk_bf16_f32 v236, v236, v236
    ds_write_b16 v23, v236
    v_mov_b32 v243, s34
    s_waitcnt lgkmcnt(0)
    s_barrier
    ds_read2_b32 v[244:245], v24 offset1:1
    v_mov_b32 v241, s34
    s_waitcnt lgkmcnt(0)
    v_mov_b32 v240, v244
    v_mov_b32 v242, v245
    s_bfm_b64 exec, 16, 0
    buffer_store_dwordx4 v[240:243], v22, s[36:39], s59 offen sc1
    s_mov_b64 exec, -1
.Le_done:
    v_and_b32 v8, 1, v0
    v_lshlrev_b32 v8, 8, v8
    v_and_b32 v9, 0x3c, v0
    v_lshl_add_u32 v9, v9, 2, v8
    v_add_u32 v7, v9, v8
    v_and_b32 v9, 0x3c, v0
    v_lshrrev_b32 v8, 4, v8
    v_and_b32 v9, 4, v0
    v_lshl_add_u32 v9, v9, 3, v8
    s_lshl_b32 s58, s66, 14
    s_lshl_b32 s59, s67, 10
    s_add_u32 s58, s58, s59
    s_add_u32 s58, s58, 0x70000
    s_lshl4_add_u32 s59, s66, s67
    s_lshl_b32 s59, s59, 7
    s_add_u32 s59, s59, 0x430000
    s_waitcnt vmcnt(3)
    s_bitcmp1_b64 s[14:15], 18
    s_cbranch_scc0 1
    s_waitcnt vmcnt(2)
    s_add_u32 s63, s69, 278528
    buffer_load_dwordx4 v[80:83], v1, s[40:43], s63 offen nt
    v_and_b32 v157, 7, v0
    v_lshlrev_b32 v157, 2, v157
    s_mov_b32 s63, 0x4a1000
    buffer_load_dword v156, v157, s[36:39], s63 offen
    s_cmp_eq_u32 s3, 0
    s_cbranch_scc1 .Lst_m1_0
    s_cmp_eq_u32 s3, 1
    s_cbranch_scc1 .Lst_m1_1
    s_cmp_eq_u32 s3, 2
    s_cbranch_scc1 .Lst_m1_2
    s_cmp_eq_u32 s3, 3
    s_cbranch_scc1 .Lst_m1_3
    s_cmp_eq_u32 s3, 4
    s_cbranch_scc1 .Lst_m1_4
    s_cmp_eq_u32 s3, 5
    s_cbranch_scc1 .Lst_m1_5
    s_cmp_eq_u32 s3, 6
    s_cbranch_scc1 .Lst_m1_6
    s_cmp_eq_u32 s3, 7
    s_cbranch_scc1 .Lst_m1_7
.Lrt_m1_0:
.Lrt_m1_1:
.Lrt_m1_2:
.Lrt_m1_3:
.Lrt_m1_4:
.Lrt_m1_5:
.Lrt_m1_6:
.Lrt_m1_7:
    s_memrealtime s[8:9]
    s_waitcnt lgkmcnt(0)
    s_sub_u32 s8, s8, s30
    s_cmpk_ge_u32 s8, 909
    s_cbranch_scc1 .ap_57
    s_waitcnt vmcnt(5)
    s_cmpk_ge_u32 s8, 809
    s_cbranch_scc1 .ap_57
    s_waitcnt vmcnt(4)
    s_bitcmp1_b64 s[14:15], 19
    s_cbranch_scc0 1
    s_waitcnt vmcnt(3)
    s_cmpk_ge_u32 s8, 689
    s_cbranch_scc1 .ap_57
    s_waitcnt vmcnt(2)
.ap_57:
    s_add_u32 s63, s69, 286720
    buffer_load_dwordx4 v[84:87], v1, s[40:43], s63 offen nt
    s_memrealtime s[8:9]
    s_waitcnt lgkmcnt(0)
    s_sub_u32 s8, s8, s30
    s_cmpk_ge_u32 s8, 954
    s_cbranch_scc1 .ap_58
    s_waitcnt vmcnt(6)
    s_cmpk_ge_u32 s8, 854
    s_cbranch_scc1 .ap_58
    s_waitcnt vmcnt(4)
    s_bitcmp1_b64 s[14:15], 20
    s_cbranch_scc0 1
    s_waitcnt vmcnt(3)
    s_cmpk_ge_u32 s8, 734
    s_cbranch_scc1 .ap_58
    s_waitcnt vmcnt(2)
.ap_58:
    s_add_u32 s63, s69, 294912
    buffer_load_dwordx4 v[112:115], v1, s[40:43], s63 offen nt
    s_memrealtime s[8:9]
    s_waitcnt lgkmcnt(0)
    s_sub_u32 s8, s8, s30
    s_cmpk_ge_u32 s8, 999
    s_cbranch_scc1 .ap_59
    s_waitcnt vmcnt(6)
    s_cmpk_ge_u32 s8, 899
    s_cbranch_scc1 .ap_59
    s_waitcnt vmcnt(4)
    s_bitcmp1_b64 s[14:15], 21
    s_cbranch_scc0 1
    s_waitcnt vmcnt(3)
    s_cmpk_ge_u32 s8, 779
    s_cbranch_scc1 .ap_59
    s_waitcnt vmcnt(1)
.ap_59:
    s_add_u32 s63, s69, 303104
    buffer_load_dwordx4 v[116:119], v1, s[40:43], s63 offen nt
    s_memrealtime s[8:9]
    s_waitcnt lgkmcnt(0)
    s_sub_u32 s8, s8, s30
    s_cmpk_ge_u32 s8, 1044
    s_cbranch_scc1 .ap_60
    s_waitcnt vmcnt(6)
    s_cmpk_ge_u32 s8, 944
    s_cbranch_scc1 .ap_60
    s_waitcnt vmcnt(4)
    s_bitcmp1_b64 s[14:15], 22
    s_cbranch_scc0 1
    s_waitcnt vmcnt(2)
    s_cmpk_ge_u32 s8, 824
    s_cbranch_scc1 .ap_60
    s_waitcnt vmcnt(1)
.ap_60:
    s_add_u32 s63, s69, 311296
    buffer_load_dwordx4 v[144:147], v1, s[40:43], s63 offen nt
    s_waitcnt vmcnt(4)
    s_sub_u32 s63, s70, 300
    v_subrev_u32 v156, s63, v156
    v_mov_b32 v157, 600
    v_cmp_lt_u32 s[8:9], v156, v157
    v_add_u32_dpp v156, v156, v156 quad_perm:[1,0,3,2] row_mask:0xf bank_mask:0xf
    s_nop 1
    v_add_u32_dpp v156, v156, v156 quad_perm:[2,3,0,1] row_mask:0xf bank_mask:0xf
    s_nop 1
    v_add_u32_dpp v156, v156, v156 row_ror:4 row_mask:0xf bank_mask:0xf
    s_nop 0
    v_readfirstlane_b32 s63, v156
    s_cmp_eq_u64 s[8:9], -1
    s_nop 3
    s_cbranch_scc0 .et_61
    s_lshr_b32 s63, s63, 3
    s_sub_u32 s63, s63, 300
    s_add_u32 s30, s30, s63
    s_add_u32 s31, s31, s63
.et_61:
    s_memrealtime s[8:9]
    s_waitcnt lgkmcnt(0)
    s_sub_u32 s8, s8, s30
    s_cmpk_ge_u32 s8, 1089
    s_cbranch_scc1 .ap_62
    s_waitcnt vmcnt(4)
    s_cmpk_ge_u32 s8, 989
    s_cbranch_scc1 .ap_62
    s_waitcnt vmcnt(3)
    s_bitcmp1_b64 s[14:15], 23
    s_cbranch_scc0 1
    s_waitcnt vmcnt(2)
    s_cmpk_ge_u32 s8, 869
    s_cbranch_scc1 .ap_62
    s_waitcnt vmcnt(1)
.ap_62:
    s_add_u32 s63, s69, 319488
    buffer_load_dwordx4 v[148:151], v1, s[40:43], s63 offen nt
    s_memrealtime s[8:9]
    s_waitcnt lgkmcnt(0)
    s_sub_u32 s8, s8, s30
    s_cmpk_ge_u32 s8, 1134
    s_cbranch_scc1 .ap_63
    s_waitcnt vmcnt(5)
    s_cmpk_ge_u32 s8, 1034
    s_cbranch_scc1 .ap_63
    s_waitcnt vmcnt(3)
    s_bitcmp1_b64 s[14:15], 24
    s_cbranch_scc0 1
    s_waitcnt vmcnt(2)
    s_cmpk_ge_u32 s8, 914
    s_cbranch_scc1 .ap_63
    s_waitcnt vmcnt(1)
.ap_63:
    s_add_u32 s63, s69, 393216
    buffer_load_dwordx4 v[56:59], v1, s[40:43], s63 offen nt
    s_memrealtime s[8:9]
    s_waitcnt lgkmcnt(0)
    s_sub_u32 s8, s8, s30
    s_cmpk_ge_u32 s8, 1180
    s_cbranch_scc1 .ap_64
    s_waitcnt vmcnt(5)
    s_cmpk_ge_u32 s8, 1080
    s_cbranch_scc1 .ap_64
    s_waitcnt vmcnt(3)
    s_bitcmp1_b64 s[14:15], 25
    s_cbranch_scc0 1
    s_waitcnt vmcnt(2)
    s_cmpk_ge_u32 s8, 960
    s_cbranch_scc1 .ap_64
    s_waitcnt vmcnt(1)
.ap_64:
    s_add_u32 s63, s69, 401408
    buffer_load_dwordx4 v[60:63], v1, s[40:43], s63 offen nt
    s_memrealtime s[8:9]
    s_waitcnt lgkmcnt(0)
    s_sub_u32 s8, s8, s30
    s_cmpk_ge_u32 s8, 1207
    s_cbranch_scc1 .ap_65
    s_branch .Lsk_m1_0
.Lst_m1_0:
    s_branch .Lrt_m1_0
.Lsk_m1_0:
    s_waitcnt vmcnt(5)
    s_cmpk_ge_u32 s8, 1107
    s_cbranch_scc1 .ap_65
    s_waitcnt vmcnt(3)
    s_bitcmp1_b64 s[14:15], 26
    s_cbranch_scc0 1
    s_waitcnt vmcnt(2)
    s_cmpk_ge_u32 s8, 987
    s_cbranch_scc1 .ap_65
    s_waitcnt vmcnt(1)
.ap_65:
    s_add_u32 s63, s69, 409600
    buffer_load_dwordx4 v[88:91], v1, s[40:43], s63 offen nt
    s_memrealtime s[8:9]
    s_waitcnt lgkmcnt(0)
    s_sub_u32 s8, s8, s30
    s_cmpk_ge_u32 s8, 1234
    s_cbranch_scc1 .ap_66
    s_waitcnt vmcnt(5)
    s_cmpk_ge_u32 s8, 1134
    s_cbranch_scc1 .ap_66
    s_waitcnt vmcnt(3)
    s_bitcmp1_b64 s[14:15], 27
    s_cbranch_scc0 1
    s_waitcnt vmcnt(2)
    s_cmpk_ge_u32 s8, 1014
    s_cbranch_scc1 .ap_66
    s_waitcnt vmcnt(1)
.ap_66:
    s_add_u32 s63, s69, 417792
    buffer_load_dwordx4 v[92:95], v1, s[40:43], s63 offen nt
    s_memrealtime s[8:9]
    s_waitcnt vmcnt(8)
    s_waitcnt lgkmcnt(0)
    s_sub_u32 s8, s8, s30
    s_cmpk_ge_u32 s8, 1261
    s_cbranch_scc1 .ap_67
    s_waitcnt vmcnt(5)
    s_cmpk_ge_u32 s8, 1161
    s_cbranch_scc1 .ap_67
    s_waitcnt vmcnt(3)
    s_bitcmp1_b64 s[14:15], 28
    s_cbranch_scc0 1
    s_waitcnt vmcnt(2)
    s_cmpk_ge_u32 s8, 1041
    s_cbranch_scc1 .ap_67
    s_waitcnt vmcnt(1)
.ap_67:
    s_add_u32 s63, s69, 425984
    buffer_load_dwordx4 v[120:123], v1, s[40:43], s63 offen nt
    s_memrealtime s[8:9]
    s_waitcnt vmcnt(8)
    s_waitcnt lgkmcnt(0)
    s_sub_u32 s8, s8, s30
    s_cmpk_ge_u32 s8, 1288
    s_cbranch_scc1 .ap_68
    s_waitcnt vmcnt(5)
    s_cmpk_ge_u32 s8, 1188
    s_cbranch_scc1 .ap_68
    s_waitcnt vmcnt(3)
    s_bitcmp1_b64 s[14:15], 29
    s_cbranch_scc0 1
    s_waitcnt vmcnt(2)
    s_cmpk_ge_u32 s8, 1068
    s_cbranch_scc1 .ap_68
    s_waitcnt vmcnt(1)
.ap_68:
    s_add_u32 s63, s69, 434176
    buffer_load_dwordx4 v[124:127], v1, s[40:43], s63 offen nt
    s_memrealtime s[8:9]
    s_waitcnt vmcnt(8)
    s_waitcnt lgkmcnt(0)
    s_sub_u32 s8, s8, s30
    s_cmpk_ge_u32 s8, 1315
    s_cbranch_scc1 .ap_69
    s_waitcnt vmcnt(5)
    s_cmpk_ge_u32 s8, 1215
    s_cbranch_scc1 .ap_69
    s_waitcnt vmcnt(3)
    s_bitcmp1_b64 s[14:15], 30
    s_cbranch_scc0 1
    s_waitcnt vmcnt(2)
    s_cmpk_ge_u32 s8, 1095
    s_cbranch_scc1 .ap_69
    s_waitcnt vmcnt(1)
.ap_69:
    s_add_u32 s63, s69, 442368
    buffer_load_dwordx4 v[152:155], v1, s[40:43], s63 offen nt
    s_and_b32 s0, s0, 0xffffff80
    s_sub_u32 s0, s0, 1024
    buffer_load_dword v28, v4, s[36:39], s0 offen sc1
    s_memrealtime s[8:9]
    s_waitcnt vmcnt(9)
    s_waitcnt lgkmcnt(0)
    s_sub_u32 s8, s8, s30
    s_cmpk_ge_u32 s8, 1342
    s_cbranch_scc1 .ap_70
    s_waitcnt vmcnt(6)
    s_cmpk_ge_u32 s8, 1242
    s_cbranch_scc1 .ap_70
    s_waitcnt vmcnt(4)
    s_bitcmp1_b64 s[14:15], 31
    s_cbranch_scc0 1
    s_waitcnt vmcnt(3)
    s_cmpk_ge_u32 s8, 1122
    s_cbranch_scc1 .ap_70
    s_waitcnt vmcnt(2)
.ap_70:
    s_add_u32 s63, s69, 450560
    buffer_load_dwordx4 v[156:159], v1, s[40:43], s63 offen nt
    s_memrealtime s[8:9]
    s_waitcnt vmcnt(9)
    s_waitcnt lgkmcnt(0)
    s_sub_u32 s8, s8, s30
    s_cmpk_ge_u32 s8, 1369
    s_cbranch_scc1 .ap_71
    s_waitcnt vmcnt(6)
    s_cmpk_ge_u32 s8, 1269
    s_cbranch_scc1 .ap_71
    s_waitcnt vmcnt(4)
    s_bitcmp1_b64 s[14:15], 32
    s_cbranch_scc0 1
    s_waitcnt vmcnt(3)
    s_cmpk_ge_u32 s8, 1149
    s_cbranch_scc1 .ap_71
    s_waitcnt vmcnt(2)
.ap_71:
    v_bfe_u32 v1, v0, 4, 2
    v_and_b32 v10, 0xf0, v2
    v_lshlrev_b32 v1, 2, v1
    v_bfe_u32 v1, s6, v1, 4
    v_lshl_add_u32 v1, v1, 8, v10
    s_add_u32 s63, s69, 0
    buffer_load_dwordx4 v[160:163], v1, s[44:47], s63 offen nt
    s_memrealtime s[8:9]
    s_waitcnt vmcnt(9)
    s_waitcnt lgkmcnt(0)
    s_sub_u32 s8, s8, s30
    s_cmpk_ge_u32 s8, 1396
    s_cbranch_scc1 .ap_72
    s_waitcnt vmcnt(6)
    s_cmpk_ge_u32 s8, 1296
    s_cbranch_scc1 .ap_72
    s_waitcnt vmcnt(4)
    s_bitcmp1_b64 s[14:15], 33
    s_cbranch_scc0 1
    s_waitcnt vmcnt(3)
    s_cmpk_ge_u32 s8, 1176
    s_cbranch_scc1 .ap_72
    s_waitcnt vmcnt(1)
.ap_72:
    s_add_u32 s63, s69, 8192
    buffer_load_dwordx4 v[164:167], v1, s[44:47], s63 offen nt
    s_memrealtime s[8:9]
    s_waitcnt vmcnt(9)
    s_waitcnt lgkmcnt(0)
    s_sub_u32 s8, s8, s30
    s_cmpk_ge_u32 s8, 1423
    s_cbranch_scc1 .ap_73
    s_waitcnt vmcnt(6)
    s_cmpk_ge_u32 s8, 1323
    s_cbranch_scc1 .ap_73
    s_waitcnt vmcnt(4)
    s_bitcmp1_b64 s[14:15], 34
    s_cbranch_scc0 1
    s_waitcnt vmcnt(2)
    s_cmpk_ge_u32 s8, 1203
    s_cbranch_scc1 .ap_73
    s_waitcnt vmcnt(1)
.ap_73:
    s_add_u32 s63, s69, 16384
    buffer_load_dwordx4 v[168:171], v1, s[44:47], s63 offen nt
    s_memrealtime s[8:9]
    s_waitcnt vmcnt(9)
    s_waitcnt lgkmcnt(0)
    s_sub_u32 s8, s8, s30
    s_cmpk_ge_u32 s8, 1450
    s_cbranch_scc1 .ap_74
    s_waitcnt vmcnt(6)
    s_cmpk_ge_u32 s8, 1350
    s_cbranch_scc1 .ap_74
    s_waitcnt vmcnt(3)
    s_bitcmp1_b64 s[14:15], 35
    s_cbranch_scc0 1
    s_waitcnt vmcnt(2)
    s_cmpk_ge_u32 s8, 1230
    s_cbranch_scc1 .ap_74
    s_waitcnt vmcnt(1)
.ap_74:
    s_add_u32 s63, s69, 24576
    buffer_load_dwordx4 v[172:175], v1, s[44:47], s63 offen nt
    s_waitcnt vmcnt(5)
    v_cmp_eq_u32 vcc, s1, v28
    s_cmp_eq_u64 vcc, -1
    s_cselect_b32 s0, 0x800000, 0
    s_add_u32 s58, s58, s0
    buffer_load_dwordx4 v[16:19], v7, s[36:39], s58 offen offset:0 sc1
    buffer_load_dwordx4 v[20:23], v7, s[36:39], s58 offen offset:256 sc1
    s_memrealtime s[8:9]
    s_waitcnt lgkmcnt(0)
    s_sub_u32 s8, s8, s30
    s_cmpk_ge_u32 s8, 1479
    s_cbranch_scc1 .ap_75
    s_waitcnt vmcnt(5)
    s_cmpk_ge_u32 s8, 1379
    s_cbranch_scc1 .ap_75
    s_waitcnt vmcnt(3)
    s_bitcmp1_b64 s[14:15], 36
    s_cbranch_scc0 1
    s_waitcnt vmcnt(2)
    s_cmpk_ge_u32 s8, 1259
    s_cbranch_scc1 .ap_75
    s_waitcnt vmcnt(1)
.ap_75:
    s_add_u32 s63, s69, 32768
    buffer_load_dwordx4 v[176:179], v1, s[44:47], s63 offen nt
    s_memrealtime s[8:9]
    s_waitcnt lgkmcnt(0)
    s_sub_u32 s8, s8, s30
    s_cmpk_ge_u32 s8, 1509
    s_cbranch_scc1 .ap_76
    s_waitcnt vmcnt(5)
    s_cmpk_ge_u32 s8, 1409
    s_cbranch_scc1 .ap_76
    s_waitcnt vmcnt(3)
    s_bitcmp1_b64 s[14:15], 37
    s_cbranch_scc0 1
    s_waitcnt vmcnt(2)
    s_cmpk_ge_u32 s8, 1289
    s_cbranch_scc1 .ap_76
    s_waitcnt vmcnt(1)
.ap_76:
    s_add_u32 s63, s69, 40960
    buffer_load_dwordx4 v[180:183], v1, s[44:47], s63 offen nt
    s_memrealtime s[8:9]
    s_waitcnt vmcnt(8)
    s_waitcnt lgkmcnt(0)
    s_sub_u32 s8, s8, s30
    s_cmpk_ge_u32 s8, 1539
    s_cbranch_scc1 .ap_77
    s_branch .Lsk_m1_1
.Lst_m1_1:
    s_branch .Lrt_m1_1
.Lsk_m1_1:
    s_waitcnt vmcnt(5)
    s_cmpk_ge_u32 s8, 1439
    s_cbranch_scc1 .ap_77
    s_waitcnt vmcnt(3)
    s_bitcmp1_b64 s[14:15], 38
    s_cbranch_scc0 1
    s_waitcnt vmcnt(2)
    s_cmpk_ge_u32 s8, 1319
    s_cbranch_scc1 .ap_77
    s_waitcnt vmcnt(1)
.ap_77:
    s_add_u32 s63, s69, 49152
    buffer_load_dwordx4 v[184:187], v1, s[44:47], s63 offen nt
    s_waitcnt vmcnt(3)
    s_branch .gpc_79
.gp_78:
    s_xor_b32 s58, s58, 0x800000
    buffer_load_dwordx4 v[16:19], v7, s[36:39], s58 offen offset:0 sc1
    buffer_load_dwordx4 v[20:23], v7, s[36:39], s58 offen offset:256 sc1
    s_waitcnt vmcnt(0)
.gpc_79:
    v_min_u32 v10, v17, v19
    v_max_u32 v11, v17, v19
    v_min3_u32 v10, v10, v21, v23
    v_max3_u32 v11, v11, v21, v23
    v_cmp_eq_u32 vcc, s34, v10
    v_cmp_eq_u32 s[56:57], s34, v11
    s_and_b64 vcc, vcc, s[56:57]
    s_cmp_eq_u64 vcc, -1
    s_nop 2
    s_cbranch_scc1 .gpd_80
    s_sub_u32 s35, s35, 1
    s_cbranch_scc1 .Lexit
    s_sleep 1
    s_branch .gp_78
.gpd_80:
    s_mov_b32 vcc_lo, 0xcccccccc
    s_mov_b32 vcc_hi, 0xcccccccc
    v_cndmask_b32_e64 v24, v16, 0, vcc
    v_cndmask_b32_e64 v25, v18, 0, vcc
    v_cndmask_b32_e64 v26, v20, 0, vcc
    v_cndmask_b32_e64 v27, v22, 0, vcc
    v_cndmask_b32_e32 v28, 0, v16, vcc
    v_cndmask_b32_e32 v29, 0, v18, vcc
    v_cndmask_b32_e32 v30, 0, v20, vcc
    v_cndmask_b32_e32 v31, 0, v22, vcc
    v_mfma_f32_16x16x32_bf16 v[16:19], v[32:35], v[24:27], 0
    v_mfma_f32_16x16x32_bf16 v[32:35], v[40:43], v[24:27], 0
    v_mfma_f32_16x16x32_bf16 v[16:19], v[36:39], v[28:31], v[16:19]
    v_mfma_f32_16x16x32_bf16 v[40:43], v[48:51], v[24:27], 0
    v_mfma_f32_16x16x32_bf16 v[32:35], v[44:47], v[28:31], v[32:35]
    v_mfma_f32_16x16x32_bf16 v[48:51], v[56:59], v[24:27], 0
    v_mfma_f32_16x16x32_bf16 v[40:43], v[52:55], v[28:31], v[40:43]
    v_mfma_f32_16x16x32_bf16 v[56:59], v[64:67], v[24:27], 0
    v_mfma_f32_16x16x32_bf16 v[48:51], v[60:63], v[28:31], v[48:51]
    s_nop 1
    v_add_f32_dpp v10, v17, v16 row_ror:12 row_mask:0xf bank_mask:0x1
    s_memrealtime s[8:9]
    s_waitcnt lgkmcnt(0)
    s_sub_u32 s8, s8, s30
    s_cmpk_ge_u32 s8, 1569
    s_nop 0
    s_cbranch_scc1 .ap_81
    s_waitcnt vmcnt(3)
    s_cmpk_ge_u32 s8, 1469
    s_cbranch_scc1 .ap_81
    s_waitcnt vmcnt(3)
    s_bitcmp1_b64 s[14:15], 39
    s_cbranch_scc0 1
    s_waitcnt vmcnt(2)
    s_cmpk_ge_u32 s8, 1349
    s_cbranch_scc1 .ap_81
    s_waitcnt vmcnt(1)
.ap_81:
    s_add_u32 s63, s69, 57344
    buffer_load_dwordx4 v[188:191], v1, s[44:47], s63 offen nt
    v_mfma_f32_16x16x32_bf16 v[64:67], v[72:75], v[24:27], 0
    v_mfma_f32_16x16x32_bf16 v[56:59], v[68:71], v[28:31], v[56:59]
    v_add_f32_dpp v11, v33, v32 row_ror:12 row_mask:0xf bank_mask:0x1
    v_add_f32_dpp v10, v18, v10 row_ror:8 row_mask:0xf bank_mask:0x1
    v_mfma_f32_16x16x32_bf16 v[72:75], v[80:83], v[24:27], 0
    v_mfma_f32_16x16x32_bf16 v[64:67], v[76:79], v[28:31], v[64:67]
    v_add_f32_dpp v12, v41, v40 row_ror:12 row_mask:0xf bank_mask:0x1
    v_add_f32_dpp v11, v34, v11 row_ror:8 row_mask:0xf bank_mask:0x1
    v_add_f32_dpp v10, v19, v10 row_ror:4 row_mask:0xf bank_mask:0x1
    v_mfma_f32_16x16x32_bf16 v[80:83], v[88:91], v[24:27], 0
    v_mfma_f32_16x16x32_bf16 v[72:75], v[84:87], v[28:31], v[72:75]
    v_add_f32_dpp v13, v49, v48 row_ror:12 row_mask:0xf bank_mask:0x1
    v_add_f32_dpp v12, v42, v12 row_ror:8 row_mask:0xf bank_mask:0x1
    v_add_f32_dpp v11, v35, v11 row_ror:4 row_mask:0xf bank_mask:0x1
    v_mfma_f32_16x16x32_bf16 v[88:91], v[96:99], v[24:27], 0
    v_mfma_f32_16x16x32_bf16 v[80:83], v[92:95], v[28:31], v[80:83]
    v_add_f32_dpp v10, v58, v57 row_ror:12 row_mask:0xf bank_mask:0x2
    v_add_f32_dpp v13, v50, v13 row_ror:8 row_mask:0xf bank_mask:0x1
    v_add_f32_dpp v12, v43, v12 row_ror:4 row_mask:0xf bank_mask:0x1
    s_memrealtime s[8:9]
    s_waitcnt lgkmcnt(0)
    s_sub_u32 s8, s8, s30
    s_cmpk_ge_u32 s8, 1599
    s_nop 0
    s_cbranch_scc1 .ap_82
    s_waitcnt vmcnt(4)
    s_cmpk_ge_u32 s8, 1499
    s_cbranch_scc1 .ap_82
    s_waitcnt vmcnt(3)
    s_bitcmp1_b64 s[14:15], 40
    s_cbranch_scc0 1
    s_waitcnt vmcnt(2)
    s_cmpk_ge_u32 s8, 1379
    s_cbranch_scc1 .ap_82
    s_waitcnt vmcnt(1)
.ap_82:
    s_add_u32 s63, s69, 131072
    buffer_load_dwordx4 v[192:195], v1, s[44:47], s63 offen nt
    v_mfma_f32_16x16x32_bf16 v[96:99], v[104:107], v[24:27], 0
    v_mfma_f32_16x16x32_bf16 v[88:91], v[100:103], v[28:31], v[88:91]
    v_add_f32_dpp v11, v66, v65 row_ror:12 row_mask:0xf bank_mask:0x2
    v_add_f32_dpp v10, v59, v10 row_ror:8 row_mask:0xf bank_mask:0x2
    v_add_f32_dpp v13, v51, v13 row_ror:4 row_mask:0xf bank_mask:0x1
    v_mfma_f32_16x16x32_bf16 v[104:107], v[112:115], v[24:27], 0
    v_mfma_f32_16x16x32_bf16 v[96:99], v[108:111], v[28:31], v[96:99]
    v_add_f32_dpp v12, v74, v73 row_ror:12 row_mask:0xf bank_mask:0x2
    v_add_f32_dpp v11, v67, v11 row_ror:8 row_mask:0xf bank_mask:0x2
    v_add_f32_dpp v10, v56, v10 row_ror:4 row_mask:0xf bank_mask:0x2
    v_mfma_f32_16x16x32_bf16 v[112:115], v[120:123], v[24:27], 0
    v_mfma_f32_16x16x32_bf16 v[104:107], v[116:119], v[28:31], v[104:107]
    v_add_f32_dpp v13, v82, v81 row_ror:12 row_mask:0xf bank_mask:0x2
    v_add_f32_dpp v12, v75, v12 row_ror:8 row_mask:0xf bank_mask:0x2
    v_add_f32_dpp v11, v64, v11 row_ror:4 row_mask:0xf bank_mask:0x2
    v_mfma_f32_16x16x32_bf16 v[120:123], v[128:131], v[24:27], 0
    v_mfma_f32_16x16x32_bf16 v[112:115], v[124:127], v[28:31], v[112:115]
    v_add_f32_dpp v10, v91, v90 row_ror:12 row_mask:0xf bank_mask:0x4
    v_add_f32_dpp v13, v83, v13 row_ror:8 row_mask:0xf bank_mask:0x2
    v_add_f32_dpp v12, v72, v12 row_ror:4 row_mask:0xf bank_mask:0x2
    s_memrealtime s[8:9]
    s_waitcnt lgkmcnt(0)
    s_sub_u32 s8, s8, s30
    s_cmpk_ge_u32 s8, 1629
    s_nop 0
    s_cbranch_scc1 .ap_83
    s_waitcnt vmcnt(5)
    s_cmpk_ge_u32 s8, 1529
    s_cbranch_scc1 .ap_83
    s_waitcnt vmcnt(3)
    s_bitcmp1_b64 s[14:15], 41
    s_cbranch_scc0 1
    s_waitcnt vmcnt(2)
    s_cmpk_ge_u32 s8, 1409
    s_cbranch_scc1 .ap_83
    s_waitcnt vmcnt(1)
.ap_83:
    s_add_u32 s63, s69, 139264
    buffer_load_dwordx4 v[196:199], v1, s[44:47], s63 offen nt
    v_mfma_f32_16x16x32_bf16 v[128:131], v[136:139], v[24:27], 0
    v_mfma_f32_16x16x32_bf16 v[120:123], v[132:135], v[28:31], v[120:123]
    v_add_f32_dpp v11, v99, v98 row_ror:12 row_mask:0xf bank_mask:0x4
    v_add_f32_dpp v10, v88, v10 row_ror:8 row_mask:0xf bank_mask:0x4
    v_add_f32_dpp v13, v80, v13 row_ror:4 row_mask:0xf bank_mask:0x2
    v_mfma_f32_16x16x32_bf16 v[136:139], v[144:147], v[24:27], 0
    v_mfma_f32_16x16x32_bf16 v[128:131], v[140:143], v[28:31], v[128:131]
    v_add_f32_dpp v12, v107, v106 row_ror:12 row_mask:0xf bank_mask:0x4
    v_add_f32_dpp v11, v96, v11 row_ror:8 row_mask:0xf bank_mask:0x4
    v_add_f32_dpp v10, v89, v10 row_ror:4 row_mask:0xf bank_mask:0x4
    v_mfma_f32_16x16x32_bf16 v[144:147], v[152:155], v[24:27], 0
    v_mfma_f32_16x16x32_bf16 v[136:139], v[148:151], v[28:31], v[136:139]
    v_add_f32_dpp v13, v115, v114 row_ror:12 row_mask:0xf bank_mask:0x4
    v_add_f32_dpp v12, v104, v12 row_ror:8 row_mask:0xf bank_mask:0x4
    v_add_f32_dpp v11, v97, v11 row_ror:4 row_mask:0xf bank_mask:0x4
    v_mfma_f32_16x16x32_bf16 v[144:147], v[156:159], v[28:31], v[144:147]
    v_add_f32_dpp v10, v120, v123 row_ror:12 row_mask:0xf bank_mask:0x8
    v_add_f32_dpp v13, v112, v13 row_ror:8 row_mask:0xf bank_mask:0x4
    v_add_f32_dpp v12, v105, v12 row_ror:4 row_mask:0xf bank_mask:0x4
    s_memrealtime s[8:9]
    s_waitcnt lgkmcnt(0)
    s_sub_u32 s8, s8, s30
    s_cmpk_ge_u32 s8, 1659
    s_nop 0
    s_cbranch_scc1 .ap_84
    s_waitcnt vmcnt(5)
    s_cmpk_ge_u32 s8, 1559
    s_cbranch_scc1 .ap_84
    s_waitcnt vmcnt(3)
    s_bitcmp1_b64 s[14:15], 42
    s_cbranch_scc0 1
    s_waitcnt vmcnt(2)
    s_cmpk_ge_u32 s8, 1439
    s_cbranch_scc1 .ap_84
    s_branch .Lsk_m1_2
.Lst_m1_2:
    s_branch .Lrt_m1_2
.Lsk_m1_2:
    s_waitcnt vmcnt(1)
.ap_84:
    s_add_u32 s63, s69, 147456
    buffer_load_dwordx4 v[200:203], v1, s[44:47], s63 offen nt
    v_add_f32_dpp v11, v128, v131 row_ror:12 row_mask:0xf bank_mask:0x8
    v_add_f32_dpp v10, v121, v10 row_ror:8 row_mask:0xf bank_mask:0x8
    v_add_f32_dpp v13, v113, v13 row_ror:4 row_mask:0xf bank_mask:0x4
    v_add_f32_dpp v12, v136, v139 row_ror:12 row_mask:0xf bank_mask:0x8
    v_add_f32_dpp v11, v129, v11 row_ror:8 row_mask:0xf bank_mask:0x8
    v_add_f32_dpp v10, v122, v10 row_ror:4 row_mask:0xf bank_mask:0x8
    v_add_f32_dpp v13, v144, v147 row_ror:12 row_mask:0xf bank_mask:0x8
    v_add_f32_dpp v12, v137, v12 row_ror:8 row_mask:0xf bank_mask:0x8
    v_add_f32_dpp v11, v130, v11 row_ror:4 row_mask:0xf bank_mask:0x8
    v_add_f32_dpp v13, v145, v13 row_ror:8 row_mask:0xf bank_mask:0x8
    v_add_f32_dpp v12, v138, v12 row_ror:4 row_mask:0xf bank_mask:0x8
    s_memrealtime s[8:9]
    s_waitcnt lgkmcnt(0)
    s_sub_u32 s8, s8, s30
    s_cmpk_ge_u32 s8, 1689
    s_cbranch_scc1 .ap_85
    s_waitcnt vmcnt(5)
    s_cmpk_ge_u32 s8, 1589
    s_cbranch_scc1 .ap_85
    s_waitcnt vmcnt(3)
    s_bitcmp1_b64 s[14:15], 43
    s_cbranch_scc0 1
    s_waitcnt vmcnt(2)
    s_cmpk_ge_u32 s8, 1469
    s_cbranch_scc1 .ap_85
    s_waitcnt vmcnt(1)
.ap_85:
    s_add_u32 s63, s69, 155648
    buffer_load_dwordx4 v[204:207], v1, s[44:47], s63 offen nt
    v_add_f32_dpp v13, v146, v13 row_ror:4 row_mask:0xf bank_mask:0x8
    s_mov_b32 s60, 0x3db504f3
    s_mov_b32 s61, 0x3db504f3
    v_cvt_pk_bf16_f32 v10, v10, v11
    v_and_b32 v11, 0xffff0000, v10
    v_lshlrev_b32 v10, 16, v10
    v_cvt_pk_bf16_f32 v12, v12, v13
    v_and_b32 v13, 0xffff0000, v12
    v_lshlrev_b32 v12, 16, v12
    v_pk_mul_f32 v[10:11], v[10:11], s[60:61]
    v_pk_mul_f32 v[12:13], v[12:13], s[60:61]
    v_cvt_pk_bf16_f32 v10, v10, v11
    v_and_b32 v11, 0xffff0000, v10
    v_lshlrev_b32 v10, 16, v10
    v_cvt_pk_bf16_f32 v12, v12, v13
    v_and_b32 v13, 0xffff0000, v12
    v_lshlrev_b32 v12, 16, v12
    v_max_f32 v14, v10, v11
    v_max3_f32 v14, v14, v12, v13
    s_mov_b32 s60, 0x3fb8aa3b
    v_mov_b32 v22, s34
    v_mov_b32 v23, s34
    v_max_f32_dpp v14, v14, v14 quad_perm:[2,3,0,1] row_mask:0xf bank_mask:0xf
    s_nop 1
    v_max_f32_dpp v14, v14, v14 row_ror:4 row_mask:0xf bank_mask:0xf
    s_nop 1
    v_max_f32_dpp v14, v14, v14 row_ror:8 row_mask:0xf bank_mask:0xf
    v_mov_b32 v15, v14
    s_nop 1
    v_permlane16_swap_b32 v15, v14
    v_max_f32 v14, v15, v14
    v_mov_b32 v15, v14
    s_nop 1
    v_permlane32_swap_b32 v15, v14
    v_max_f32 v14, v15, v14
    v_mul_f32 v15, 0xbfb8aa3b, v14
    v_fma_f32 v10, v10, s60, v15
    v_fma_f32 v11, v11, s60, v15
    v_fma_f32 v12, v12, s60, v15
    v_fma_f32 v13, v13, s60, v15
    v_exp_f32 v10, v10
    v_exp_f32 v11, v11
    v_exp_f32 v12, v12
    v_exp_f32 v13, v13
    v_mov_b32 v20, v14
    v_pk_add_f32 v[16:17], v[10:11], v[12:13]
    v_add_f32 v21, v16, v17
    s_lshl_b32 s60, s68, 5
    s_lshl_b32 s61, s3, 4
    s_add_u32 s61, s61, 159104
    v_add_u32 v16, s61, v3
    v_mov_b32 v17, 159232
    v_mov_b32 v18, 1
    s_add_u32 s60, s60, s59
    v_add_f32_dpp v21, v21, v21 quad_perm:[2,3,0,1] row_mask:0xf bank_mask:0xf
    s_nop 1
    v_add_f32_dpp v21, v21, v21 row_ror:4 row_mask:0xf bank_mask:0xf
    s_nop 1
    v_add_f32_dpp v21, v21, v21 row_ror:8 row_mask:0xf bank_mask:0xf
    v_mov_b32 v15, v21
    s_nop 1
    v_permlane16_swap_b32 v15, v21
    v_add_f32 v21, v15, v21
    v_mov_b32 v15, v21
    s_nop 1
    v_permlane32_swap_b32 v15, v21
    v_add_f32 v21, v15, v21
    s_mov_b64 exec, 3
    ds_write_b64 v16, v[20:21]
    s_mov_b64 exec, 1
    ds_add_rtn_u32 v18, v17, v18
    s_mov_b64 exec, -1
    v_and_b32 v16, 0x78, v3
    v_or_b32 v16, 159104, v16
    s_waitcnt lgkmcnt(0)
    v_readfirstlane_b32 s61, v18
    s_cmp_eq_u32 s61, 7
    s_nop 3
    s_cbranch_scc0 .mlc_86
    ds_read_b64 v[18:19], v16
    s_waitcnt lgkmcnt(0)
    v_mov_b32 v20, v18
    s_nop 1
    v_max_f32_dpp v20, v20, v20 quad_perm:[2,3,0,1] row_mask:0xf bank_mask:0xf
    s_nop 1
    v_max_f32_dpp v20, v20, v20 row_ror:4 row_mask:0xf bank_mask:0xf
    s_nop 1
    v_max_f32_dpp v20, v20, v20 row_ror:8 row_mask:0xf bank_mask:0xf
    v_sub_f32 v18, v18, v20
    v_mul_f32 v18, 0x3fb8aa3b, v18
    v_exp_f32 v18, v18
    s_nop 0
    v_mul_f32 v21, v18, v19
    s_nop 1
    v_add_f32_dpp v21, v21, v21 quad_perm:[2,3,0,1] row_mask:0xf bank_mask:0xf
    s_nop 1
    v_add_f32_dpp v21, v21, v21 row_ror:4 row_mask:0xf bank_mask:0xf
    s_nop 1
    v_add_f32_dpp v21, v21, v21 row_ror:8 row_mask:0xf bank_mask:0xf
    s_mov_b64 exec, 3
    s_add_u32 s57, s60, 0x800000
    buffer_store_dwordx4 v[20:23], v2, s[36:39], s57 offen
    s_cmp_lg_u32 s0, 0
    s_nop 0
    s_cbranch_scc1 .nosl_87
    buffer_store_dwordx4 v[20:23], v2, s[36:39], s60 offen sc1
.nosl_87:
    s_mov_b64 exec, -1
.mlc_86:
    s_add_u32 s59, s59, s0
    s_memrealtime s[8:9]
    s_waitcnt lgkmcnt(0)
    s_sub_u32 s8, s8, s30
    s_cmpk_ge_u32 s8, 1719
    s_cbranch_scc1 .ap_88
    s_waitcnt vmcnt(5)
    s_cmpk_ge_u32 s8, 1619
    s_cbranch_scc1 .ap_88
    s_waitcnt vmcnt(3)
    s_bitcmp1_b64 s[14:15], 44
    s_cbranch_scc0 1
    s_waitcnt vmcnt(2)
    s_cmpk_ge_u32 s8, 1499
    s_cbranch_scc1 .ap_88
    s_waitcnt vmcnt(1)
.ap_88:
    s_add_u32 s63, s69, 163840
    buffer_load_dwordx4 v[208:211], v1, s[44:47], s63 offen nt
    s_cmp_eq_u32 s3, 0
    s_cbranch_scc1 .Lst_m2_0
    s_cmp_eq_u32 s3, 1
    s_cbranch_scc1 .Lst_m2_1
    s_cmp_eq_u32 s3, 2
    s_cbranch_scc1 .Lst_m2_2
    s_cmp_eq_u32 s3, 3
    s_cbranch_scc1 .Lrt_m2_3
.Lrt_m2_0:
.Lrt_m2_1:
.Lrt_m2_2:
.Lrt_m2_3:
    v_mov_b32 v16, 0
    v_bfe_u32 v17, v0, 3, 1
    v_lshl_add_u32 v16, v17, 5, v16
    v_bfe_u32 v17, v0, 5, 1
    v_lshl_add_u32 v16, v17, 4, v16
    v_bfe_u32 v17, v0, 0, 3
    v_lshl_add_u32 v16, v17, 1, v16
    v_bfe_u32 v17, v0, 4, 1
    v_lshl_add_u32 v16, v17, 0, v16
    v_lshlrev_b32 v7, 1, v16
    v_and_b32 v8, 62, v16
    v_lshlrev_b32 v8, 2, v8
    s_mul_i32 s100, s3, 1152
    s_lshl_b32 s56, s65, 7
    s_add_u32 s100, s100, s56
    s_mov_b32 s52, s4
    s_and_b32 s53, s5, 0xffff
    s_mov_b32 s54, 0x2400
    s_mov_b32 s55, 0x00020000
    buffer_load_ushort v40, v7, s[52:55], s100 offen
    s_lshr_b32 s56, s64, 1
    s_and_b32 s57, s3, 3
    s_cmp_lg_u32 s56, s57
    s_cselect_b64 exec, 0, -1
    s_mov_b32 s48, s16
    s_branch .Lsk_m1_3
.Lst_m1_3:
    s_branch .Lrt_m1_3
.Lsk_m1_3:
    s_and_b32 s49, s17, 0xffff
    s_mov_b32 s50, 0x480
    s_mov_b32 s51, 0x00020000
    buffer_load_dwordx2 v[48:49], v3, s[48:51], 0 offen
    buffer_load_dwordx2 v[50:51], v3, s[48:51], 0 offen offset:512
    buffer_load_dword v34, v4, s[48:51], 0 offen
    s_mov_b32 s48, s28
    s_and_b32 s49, s29, 0xffff
    s_mov_b32 s50, 0x2400
    s_mov_b32 s51, 0x00020000
    buffer_load_ushort v39, v7, s[48:51], s100 offen nt
    s_mov_b64 exec, -1
    s_memrealtime s[8:9]
    s_waitcnt vmcnt(13)
    s_waitcnt lgkmcnt(0)
    s_sub_u32 s8, s8, s30
    s_cmpk_ge_u32 s8, 1749
    s_cbranch_scc1 .ap_89
    s_waitcnt vmcnt(10)
    s_cmpk_ge_u32 s8, 1649
    s_cbranch_scc1 .ap_89
    s_waitcnt vmcnt(8)
    s_bitcmp1_b64 s[14:15], 45
    s_cbranch_scc0 1
    s_waitcnt vmcnt(7)
    s_cmpk_ge_u32 s8, 1529
    s_cbranch_scc1 .ap_89
    s_waitcnt vmcnt(6)
.ap_89:
    s_add_u32 s63, s69, 172032
    buffer_load_dwordx4 v[212:215], v1, s[44:47], s63 offen nt
    s_memrealtime s[8:9]
    s_waitcnt vmcnt(13)
    s_waitcnt lgkmcnt(0)
    s_sub_u32 s8, s8, s30
    s_cmpk_ge_u32 s8, 1780
    s_cbranch_scc1 .ap_90
    s_waitcnt vmcnt(10)
    s_cmpk_ge_u32 s8, 1680
    s_cbranch_scc1 .ap_90
    s_waitcnt vmcnt(8)
    s_bitcmp1_b64 s[14:15], 46
    s_cbranch_scc0 1
    s_waitcnt vmcnt(7)
    s_cmpk_ge_u32 s8, 1560
    s_cbranch_scc1 .ap_90
    s_waitcnt vmcnt(6)
.ap_90:
    s_add_u32 s63, s69, 180224
    buffer_load_dwordx4 v[216:219], v1, s[44:47], s63 offen nt
    s_memrealtime s[8:9]
    s_waitcnt vmcnt(13)
    s_waitcnt lgkmcnt(0)
    s_sub_u32 s8, s8, s30
    s_cmpk_ge_u32 s8, 1812
    s_cbranch_scc1 .ap_91
    s_waitcnt vmcnt(10)
    s_cmpk_ge_u32 s8, 1712
    s_cbranch_scc1 .ap_91
    s_waitcnt vmcnt(8)
    s_bitcmp1_b64 s[14:15], 47
    s_cbranch_scc0 1
    s_waitcnt vmcnt(7)
    s_cmpk_ge_u32 s8, 1592
    s_cbranch_scc1 .ap_91
    s_waitcnt vmcnt(1)
.ap_91:
    s_add_u32 s63, s69, 188416
    buffer_load_dwordx4 v[220:223], v1, s[44:47], s63 offen nt
    s_memrealtime s[8:9]
    s_waitcnt vmcnt(13)
    s_waitcnt lgkmcnt(0)
    s_sub_u32 s8, s8, s30
    s_cmpk_ge_u32 s8, 1844
    s_cbranch_scc1 .ap_92
    s_waitcnt vmcnt(10)
    s_cmpk_ge_u32 s8, 1744
    s_cbranch_scc1 .ap_92
    s_waitcnt vmcnt(8)
    s_bitcmp1_b64 s[14:15], 48
    s_cbranch_scc0 1
    s_waitcnt vmcnt(2)
    s_cmpk_ge_u32 s8, 1624
    s_cbranch_scc1 .ap_92
    s_waitcnt vmcnt(1)
.ap_92:
    s_add_u32 s63, s69, 262144
    buffer_load_dwordx4 v[224:227], v1, s[44:47], s63 offen nt
    s_memrealtime s[8:9]
    s_waitcnt vmcnt(13)
    s_waitcnt lgkmcnt(0)
    s_sub_u32 s8, s8, s30
    s_cmpk_ge_u32 s8, 1876
    s_cbranch_scc1 .ap_93
    s_waitcnt vmcnt(10)
    s_cmpk_ge_u32 s8, 1776
    s_cbranch_scc1 .ap_93
    s_waitcnt vmcnt(3)
    s_bitcmp1_b64 s[14:15], 49
    s_cbranch_scc0 1
    s_waitcnt vmcnt(2)
    s_cmpk_ge_u32 s8, 1656
    s_cbranch_scc1 .ap_93
    s_waitcnt vmcnt(1)
.ap_93:
    s_add_u32 s63, s69, 270336
    buffer_load_dwordx4 v[228:231], v1, s[44:47], s63 offen nt
    s_memrealtime s[8:9]
    s_waitcnt vmcnt(13)
    s_waitcnt lgkmcnt(0)
    s_sub_u32 s8, s8, s30
    s_cmpk_ge_u32 s8, 1908
    s_cbranch_scc1 .ap_94
    s_waitcnt vmcnt(10)
    s_cmpk_ge_u32 s8, 1808
    s_cbranch_scc1 .ap_94
    s_waitcnt vmcnt(3)
    s_bitcmp1_b64 s[14:15], 50
    s_cbranch_scc0 1
    s_waitcnt vmcnt(2)
    s_cmpk_ge_u32 s8, 1688
    s_cbranch_scc1 .ap_94
    s_waitcnt vmcnt(1)
.ap_94:
    s_add_u32 s63, s69, 278528
    buffer_load_dwordx4 v[232:235], v1, s[44:47], s63 offen nt
    s_memrealtime s[8:9]
    s_waitcnt vmcnt(13)
    s_waitcnt lgkmcnt(0)
    s_sub_u32 s8, s8, s30
    s_cmpk_ge_u32 s8, 1939
    s_cbranch_scc1 .ap_95
    s_waitcnt vmcnt(5)
    s_cmpk_ge_u32 s8, 1839
    s_cbranch_scc1 .ap_95
    s_waitcnt vmcnt(3)
    s_bitcmp1_b64 s[14:15], 51
    s_cbranch_scc0 1
    s_waitcnt vmcnt(2)
    s_cmpk_ge_u32 s8, 1719
    s_cbranch_scc1 .ap_95
    s_waitcnt vmcnt(1)
.ap_95:
    s_add_u32 s63, s69, 286720
    buffer_load_dwordx4 v[236:239], v1, s[44:47], s63 offen nt
    s_memrealtime s[8:9]
    s_waitcnt vmcnt(13)
    s_waitcnt lgkmcnt(0)
    s_sub_u32 s8, s8, s30
    s_cmpk_ge_u32 s8, 1971
    s_cbranch_scc1 .ap_96
    s_waitcnt vmcnt(5)
    s_cmpk_ge_u32 s8, 1871
    s_cbranch_scc1 .ap_96
    s_waitcnt vmcnt(3)
    s_bitcmp1_b64 s[14:15], 52
    s_cbranch_scc0 1
    s_waitcnt vmcnt(2)
    s_cmpk_ge_u32 s8, 1751
    s_cbranch_scc1 .ap_96
    s_waitcnt vmcnt(1)
.ap_96:
    s_add_u32 s63, s69, 294912
    buffer_load_dwordx4 v[240:243], v1, s[44:47], s63 offen nt
    s_memrealtime s[8:9]
    s_waitcnt vmcnt(13)
    s_waitcnt lgkmcnt(0)
    s_sub_u32 s8, s8, s30
    s_cmpk_ge_u32 s8, 2003
    s_cbranch_scc1 .ap_97
    s_waitcnt vmcnt(5)
    s_cmpk_ge_u32 s8, 1903
    s_cbranch_scc1 .ap_97
    s_waitcnt vmcnt(3)
    s_bitcmp1_b64 s[14:15], 53
    s_cbranch_scc0 1
    s_waitcnt vmcnt(2)
    s_cmpk_ge_u32 s8, 1783
    s_cbranch_scc1 .ap_97
    s_branch .Lsk_m1_4
.Lst_m1_4:
    s_branch .Lrt_m1_4
.Lsk_m1_4:
    s_waitcnt vmcnt(1)
.ap_97:
    s_add_u32 s63, s69, 303104
    buffer_load_dwordx4 v[244:247], v1, s[44:47], s63 offen nt
    buffer_load_dwordx4 v[24:27], v9, s[36:39], s59 offen offset:0 sc1
    s_memrealtime s[8:9]
    s_waitcnt vmcnt(8)
    s_waitcnt lgkmcnt(0)
    s_sub_u32 s8, s8, s30
    s_cmpk_ge_u32 s8, 2035
    s_cbranch_scc1 .ap_98
    s_waitcnt vmcnt(5)
    s_cmpk_ge_u32 s8, 1935
    s_cbranch_scc1 .ap_98
    s_waitcnt vmcnt(3)
    s_bitcmp1_b64 s[14:15], 54
    s_cbranch_scc0 1
    s_waitcnt vmcnt(2)
    s_cmpk_ge_u32 s8, 1815
    s_cbranch_scc1 .ap_98
    s_waitcnt vmcnt(1)
.ap_98:
    s_add_u32 s63, s69, 311296
    buffer_load_dwordx4 v[248:251], v1, s[44:47], s63 offen nt
    s_memrealtime s[8:9]
    s_waitcnt vmcnt(8)
    s_waitcnt lgkmcnt(0)
    s_sub_u32 s8, s8, s30
    s_cmpk_ge_u32 s8, 2067
    s_cbranch_scc1 .ap_99
    s_waitcnt vmcnt(5)
    s_cmpk_ge_u32 s8, 1967
    s_cbranch_scc1 .ap_99
    s_waitcnt vmcnt(3)
    s_bitcmp1_b64 s[14:15], 55
    s_cbranch_scc0 1
    s_waitcnt vmcnt(2)
    s_cmpk_ge_u32 s8, 1847
    s_cbranch_scc1 .ap_99
    s_waitcnt vmcnt(1)
.ap_99:
    s_add_u32 s63, s69, 319488
    buffer_load_dwordx4 v[252:255], v1, s[44:47], s63 offen nt
    s_memrealtime s[8:9]
    s_waitcnt vmcnt(8)
    s_waitcnt lgkmcnt(0)
    s_sub_u32 s8, s8, s30
    s_cmpk_ge_u32 s8, 2098
    s_cbranch_scc1 .ap_100
    s_waitcnt vmcnt(5)
    s_cmpk_ge_u32 s8, 1998
    s_cbranch_scc1 .ap_100
    s_waitcnt vmcnt(3)
    s_bitcmp1_b64 s[14:15], 56
    s_cbranch_scc0 1
    s_waitcnt vmcnt(2)
    s_cmpk_ge_u32 s8, 1878
    s_cbranch_scc1 .ap_100
    s_waitcnt vmcnt(1)
.ap_100:
    s_add_u32 s63, s69, 393216
    buffer_load_dwordx4 v[36:39], v1, s[44:47], s63 offen nt
    s_memrealtime s[8:9]
    s_waitcnt vmcnt(8)
    s_waitcnt lgkmcnt(0)
    s_sub_u32 s8, s8, s30
    s_cmpk_ge_u32 s8, 2130
    s_cbranch_scc1 .ap_101
    s_waitcnt vmcnt(5)
    s_cmpk_ge_u32 s8, 2030
    s_cbranch_scc1 .ap_101
    s_waitcnt vmcnt(3)
    s_bitcmp1_b64 s[14:15], 57
    s_cbranch_scc0 1
    s_waitcnt vmcnt(2)
    s_cmpk_ge_u32 s8, 1910
    s_cbranch_scc1 .ap_101
    s_waitcnt vmcnt(1)
.ap_101:
    s_add_u32 s63, s69, 401408
    buffer_load_dwordx4 v[44:47], v1, s[44:47], s63 offen nt
    s_memrealtime s[8:9]
    s_waitcnt vmcnt(8)
    s_waitcnt lgkmcnt(0)
    s_sub_u32 s8, s8, s30
    s_cmpk_ge_u32 s8, 2162
    s_cbranch_scc1 .ap_102
    s_waitcnt vmcnt(5)
    s_cmpk_ge_u32 s8, 2062
    s_cbranch_scc1 .ap_102
    s_waitcnt vmcnt(3)
    s_bitcmp1_b64 s[14:15], 58
    s_cbranch_scc0 1
    s_waitcnt vmcnt(2)
    s_cmpk_ge_u32 s8, 1942
    s_cbranch_scc1 .ap_102
    s_waitcnt vmcnt(1)
.ap_102:
    s_add_u32 s63, s69, 409600
    buffer_load_dwordx4 v[52:55], v1, s[44:47], s63 offen nt
    s_waitcnt vmcnt(5)
    s_branch .gpc_104
.gp_103:
    s_xor_b32 s59, s59, 0x800000
    buffer_load_dwordx4 v[24:27], v9, s[36:39], s59 offen offset:0 sc1
    s_waitcnt vmcnt(0)
.gpc_104:
    v_cmp_eq_u32 vcc, s34, v26
    s_cmp_eq_u64 vcc, -1
    s_nop 3
    s_cbranch_scc1 .gpd_105
    s_sub_u32 s35, s35, 1
    s_cbranch_scc1 .Lexit
    s_sleep 1
    s_branch .gp_103
.gpd_105:
    v_mov_b32 v16, v24
    s_nop 1
    v_max_f32_dpp v16, v16, v16 row_ror:4 row_mask:0xf bank_mask:0xf
    v_sub_f32 v17, v24, v16
    v_sub_f32 v18, v14, v16
    v_mul_f32 v17, 0x3fb8aa3b, v17
    v_mul_f32 v18, 0x3fb8aa3b, v18
    v_exp_f32 v17, v17
    v_exp_f32 v18, v18
    v_mul_f32 v17, v17, v25
    s_nop 1
    v_add_f32_dpp v17, v17, v17 row_ror:4 row_mask:0xf bank_mask:0xf
    v_rcp_f32 v19, v17
    s_nop 0
    v_fma_f32 v15, -v17, v19, 1.0
    v_fma_f32 v19, v15, v19, v19
    v_mul_f32 v18, v18, v19
    v_mul_f32 v10, v10, v18
    v_mul_f32 v11, v11, v18
    v_mul_f32 v12, v12, v18
    v_mul_f32 v13, v13, v18
    v_mov_b32_dpp v112, v10 quad_perm:[2,3,0,1] row_mask:0xf bank_mask:0xf
    v_mov_b32_dpp v113, v11 quad_perm:[2,3,0,1] row_mask:0xf bank_mask:0xf
    v_mov_b32_dpp v114, v12 quad_perm:[2,3,0,1] row_mask:0xf bank_mask:0xf
    v_mov_b32_dpp v115, v13 quad_perm:[2,3,0,1] row_mask:0xf bank_mask:0xf
    v_cvt_pk_bf16_f32 v96, v10, v112
    v_cvt_pk_bf16_f32 v100, v11, v113
    v_cvt_pk_bf16_f32 v104, v12, v114
    v_cvt_pk_bf16_f32 v108, v13, v115
    v_mov_b32_dpp v97, v96 row_ror:12 row_mask:0xf bank_mask:0xf
    v_mov_b32_dpp v101, v100 row_ror:12 row_mask:0xf bank_mask:0xf
    v_mov_b32_dpp v105, v104 row_ror:12 row_mask:0xf bank_mask:0xf
    v_mov_b32_dpp v109, v108 row_ror:12 row_mask:0xf bank_mask:0xf
    v_mov_b32_dpp v98, v96 row_ror:8 row_mask:0xf bank_mask:0xf
    v_mov_b32_dpp v102, v100 row_ror:8 row_mask:0xf bank_mask:0xf
    v_mov_b32_dpp v106, v104 row_ror:8 row_mask:0xf bank_mask:0xf
    v_mov_b32_dpp v110, v108 row_ror:8 row_mask:0xf bank_mask:0xf
    v_mov_b32_dpp v99, v96 row_ror:4 row_mask:0xf bank_mask:0xf
    v_mov_b32_dpp v103, v100 row_ror:4 row_mask:0xf bank_mask:0xf
    v_mov_b32_dpp v107, v104 row_ror:4 row_mask:0xf bank_mask:0xf
    v_mov_b32_dpp v111, v108 row_ror:4 row_mask:0xf bank_mask:0xf
    s_lshl_b32 s60, s3, 10
    s_add_u32 s60, s60, 147456
    v_lshlrev_b32 v10, 5, v0
    v_add_u32 v10, s60, v10
    s_memrealtime s[8:9]
    s_waitcnt lgkmcnt(0)
    s_sub_u32 s8, s8, s30
    s_cmpk_ge_u32 s8, 2194
    s_cbranch_scc1 .ap_106
    s_waitcnt vmcnt(5)
    s_cmpk_ge_u32 s8, 2094
    s_cbranch_scc1 .ap_106
    s_waitcnt vmcnt(3)
    s_bitcmp1_b64 s[14:15], 59
    s_cbranch_scc0 1
    s_waitcnt vmcnt(2)
    s_cmpk_ge_u32 s8, 1974
    s_cbranch_scc1 .ap_106
    s_waitcnt vmcnt(1)
.ap_106:
    s_add_u32 s63, s69, 417792
    buffer_load_dwordx4 v[60:63], v1, s[44:47], s63 offen nt
    v_perm_b32 v112, v164, v160, s94
    v_perm_b32 v113, v172, v168, s94
    v_perm_b32 v114, v180, v176, s94
    v_perm_b32 v115, v188, v184, s94
    s_nop 1
    v_mfma_f32_16x16x32_bf16 v[128:131], v[96:99], v[112:115], 0
    v_perm_b32 v116, v164, v160, s95
    v_perm_b32 v117, v172, v168, s95
    v_perm_b32 v118, v180, v176, s95
    v_perm_b32 v119, v188, v184, s95
    s_nop 1
    v_mfma_f32_16x16x32_bf16 v[132:135], v[96:99], v[116:119], 0
    v_perm_b32 v120, v165, v161, s94
    v_perm_b32 v121, v173, v169, s94
    v_perm_b32 v122, v181, v177, s94
    v_perm_b32 v123, v189, v185, s94
    s_nop 1
    v_mfma_f32_16x16x32_bf16 v[136:139], v[96:99], v[120:123], 0
    v_perm_b32 v124, v165, v161, s95
    v_perm_b32 v125, v173, v169, s95
    v_perm_b32 v126, v181, v177, s95
    v_perm_b32 v127, v189, v185, s95
    s_nop 1
    v_mfma_f32_16x16x32_bf16 v[140:143], v[96:99], v[124:127], 0
    v_perm_b32 v112, v166, v162, s94
    v_perm_b32 v113, v174, v170, s94
    v_perm_b32 v114, v182, v178, s94
    v_perm_b32 v115, v190, v186, s94
    s_branch .Lsk_m1_5
.Lst_m1_5:
    s_branch .Lrt_m1_5
.Lsk_m1_5:
    s_nop 1
    v_mfma_f32_16x16x32_bf16 v[144:147], v[96:99], v[112:115], 0
    v_perm_b32 v116, v166, v162, s95
    v_perm_b32 v117, v174, v170, s95
    v_perm_b32 v118, v182, v178, s95
    v_perm_b32 v119, v190, v186, s95
    s_nop 1
    v_mfma_f32_16x16x32_bf16 v[148:151], v[96:99], v[116:119], 0
    v_perm_b32 v120, v167, v163, s94
    v_perm_b32 v121, v175, v171, s94
    v_perm_b32 v122, v183, v179, s94
    v_perm_b32 v123, v191, v187, s94
    s_nop 1
    v_mfma_f32_16x16x32_bf16 v[152:155], v[96:99], v[120:123], 0
    v_perm_b32 v124, v167, v163, s95
    v_perm_b32 v125, v175, v171, s95
    v_perm_b32 v126, v183, v179, s95
    v_perm_b32 v127, v191, v187, s95
    s_nop 1
    v_mfma_f32_16x16x32_bf16 v[156:159], v[96:99], v[124:127], 0
    s_memrealtime s[8:9]
    s_waitcnt lgkmcnt(0)
    s_sub_u32 s8, s8, s30
    s_cmpk_ge_u32 s8, 2226
    s_nop 3
    s_cbranch_scc1 .ap_107
    s_waitcnt vmcnt(5)
    s_cmpk_ge_u32 s8, 2126
    s_cbranch_scc1 .ap_107
    s_waitcnt vmcnt(3)
    s_bitcmp1_b64 s[14:15], 60
    s_cbranch_scc0 1
    s_waitcnt vmcnt(2)
    s_cmpk_ge_u32 s8, 2006
    s_cbranch_scc1 .ap_107
    s_waitcnt vmcnt(1)
.ap_107:
    s_add_u32 s63, s69, 425984
    buffer_load_dwordx4 v[68:71], v1, s[44:47], s63 offen nt
    v_perm_b32 v112, v196, v192, s94
    v_perm_b32 v113, v204, v200, s94
    v_perm_b32 v114, v212, v208, s94
    v_perm_b32 v115, v220, v216, s94
    s_nop 1
    v_mfma_f32_16x16x32_bf16 v[128:131], v[100:103], v[112:115], v[128:131]
    v_perm_b32 v116, v196, v192, s95
    v_perm_b32 v117, v204, v200, s95
    v_perm_b32 v118, v212, v208, s95
    v_perm_b32 v119, v220, v216, s95
    s_nop 1
    v_mfma_f32_16x16x32_bf16 v[132:135], v[100:103], v[116:119], v[132:135]
    v_perm_b32 v120, v197, v193, s94
    v_perm_b32 v121, v205, v201, s94
    v_perm_b32 v122, v213, v209, s94
    v_perm_b32 v123, v221, v217, s94
    s_nop 1
    v_mfma_f32_16x16x32_bf16 v[136:139], v[100:103], v[120:123], v[136:139]
    v_perm_b32 v124, v197, v193, s95
    v_perm_b32 v125, v205, v201, s95
    v_perm_b32 v126, v213, v209, s95
    v_perm_b32 v127, v221, v217, s95
    s_nop 1
    v_mfma_f32_16x16x32_bf16 v[140:143], v[100:103], v[124:127], v[140:143]
    v_perm_b32 v112, v198, v194, s94
    v_perm_b32 v113, v206, v202, s94
    v_perm_b32 v114, v214, v210, s94
    v_perm_b32 v115, v222, v218, s94
    s_nop 1
    v_mfma_f32_16x16x32_bf16 v[144:147], v[100:103], v[112:115], v[144:147]
    v_perm_b32 v116, v198, v194, s95
    v_perm_b32 v117, v206, v202, s95
    v_perm_b32 v118, v214, v210, s95
    v_perm_b32 v119, v222, v218, s95
    s_nop 1
    v_mfma_f32_16x16x32_bf16 v[148:151], v[100:103], v[116:119], v[148:151]
    v_perm_b32 v120, v199, v195, s94
    v_perm_b32 v121, v207, v203, s94
    v_perm_b32 v122, v215, v211, s94
    v_perm_b32 v123, v223, v219, s94
    s_nop 1
    v_mfma_f32_16x16x32_bf16 v[152:155], v[100:103], v[120:123], v[152:155]
    v_perm_b32 v124, v199, v195, s95
    v_perm_b32 v125, v207, v203, s95
    v_perm_b32 v126, v215, v211, s95
    v_perm_b32 v127, v223, v219, s95
    s_nop 1
    v_mfma_f32_16x16x32_bf16 v[156:159], v[100:103], v[124:127], v[156:159]
    s_memrealtime s[8:9]
    s_waitcnt lgkmcnt(0)
    s_sub_u32 s8, s8, s30
    s_cmpk_ge_u32 s8, 2257
    s_nop 3
    s_cbranch_scc1 .ap_108
    s_waitcnt vmcnt(5)
    s_cmpk_ge_u32 s8, 2157
    s_cbranch_scc1 .ap_108
    s_waitcnt vmcnt(3)
    s_bitcmp1_b64 s[14:15], 61
    s_cbranch_scc0 1
    s_waitcnt vmcnt(2)
    s_cmpk_ge_u32 s8, 2037
    s_cbranch_scc1 .ap_108
    s_waitcnt vmcnt(1)
.ap_108:
    s_add_u32 s63, s69, 434176
    buffer_load_dwordx4 v[76:79], v1, s[44:47], s63 offen nt
    s_waitcnt vmcnt(6)
    v_perm_b32 v112, v228, v224, s94
    v_perm_b32 v113, v236, v232, s94
    v_perm_b32 v114, v244, v240, s94
    v_perm_b32 v115, v252, v248, s94
    s_nop 1
    v_mfma_f32_16x16x32_bf16 v[128:131], v[104:107], v[112:115], v[128:131]
    v_perm_b32 v116, v228, v224, s95
    v_perm_b32 v117, v236, v232, s95
    v_perm_b32 v118, v244, v240, s95
    v_perm_b32 v119, v252, v248, s95
    s_nop 1
    v_mfma_f32_16x16x32_bf16 v[132:135], v[104:107], v[116:119], v[132:135]
    v_perm_b32 v120, v229, v225, s94
    v_perm_b32 v121, v237, v233, s94
    v_perm_b32 v122, v245, v241, s94
    v_perm_b32 v123, v253, v249, s94
    s_nop 1
    v_mfma_f32_16x16x32_bf16 v[136:139], v[104:107], v[120:123], v[136:139]
    v_perm_b32 v124, v229, v225, s95
    v_perm_b32 v125, v237, v233, s95
    v_perm_b32 v126, v245, v241, s95
    v_perm_b32 v127, v253, v249, s95
    s_nop 1
    v_mfma_f32_16x16x32_bf16 v[140:143], v[104:107], v[124:127], v[140:143]
    v_perm_b32 v112, v230, v226, s94
    v_perm_b32 v113, v238, v234, s94
    v_perm_b32 v114, v246, v242, s94
    v_perm_b32 v115, v254, v250, s94
    s_nop 1
    v_mfma_f32_16x16x32_bf16 v[144:147], v[104:107], v[112:115], v[144:147]
    v_perm_b32 v116, v230, v226, s95
    v_perm_b32 v117, v238, v234, s95
    v_perm_b32 v118, v246, v242, s95
    v_perm_b32 v119, v254, v250, s95
    s_nop 1
    v_mfma_f32_16x16x32_bf16 v[148:151], v[104:107], v[116:119], v[148:151]
    v_perm_b32 v120, v231, v227, s94
    v_perm_b32 v121, v239, v235, s94
    v_perm_b32 v122, v247, v243, s94
    v_perm_b32 v123, v255, v251, s94
    s_nop 1
    v_mfma_f32_16x16x32_bf16 v[152:155], v[104:107], v[120:123], v[152:155]
    v_perm_b32 v124, v231, v227, s95
    v_perm_b32 v125, v239, v235, s95
    v_perm_b32 v126, v247, v243, s95
    v_perm_b32 v127, v255, v251, s95
    s_nop 1
    v_mfma_f32_16x16x32_bf16 v[156:159], v[104:107], v[124:127], v[156:159]
    s_memrealtime s[8:9]
    s_waitcnt lgkmcnt(0)
    s_sub_u32 s8, s8, s30
    s_cmpk_ge_u32 s8, 2289
    s_nop 3
    s_cbranch_scc1 .ap_109
    s_waitcnt vmcnt(5)
    s_cmpk_ge_u32 s8, 2189
    s_cbranch_scc1 .ap_109
    s_waitcnt vmcnt(3)
    s_bitcmp1_b64 s[14:15], 62
    s_cbranch_scc0 1
    s_waitcnt vmcnt(2)
    s_cmpk_ge_u32 s8, 2069
    s_cbranch_scc1 .ap_109
    s_branch .Lsk_m1_6
.Lst_m1_6:
    s_branch .Lrt_m1_6
.Lsk_m1_6:
    s_waitcnt vmcnt(1)
.ap_109:
    s_add_u32 s63, s69, 442368
    buffer_load_dwordx4 v[84:87], v1, s[44:47], s63 offen nt
    s_memrealtime s[8:9]
    s_waitcnt lgkmcnt(0)
    s_sub_u32 s8, s8, s30
    s_cmpk_ge_u32 s8, 2321
    s_cbranch_scc1 .ap_110
    s_waitcnt vmcnt(5)
    s_cmpk_ge_u32 s8, 2221
    s_cbranch_scc1 .ap_110
    s_waitcnt vmcnt(3)
    s_bitcmp1_b64 s[14:15], 63
    s_cbranch_scc0 1
    s_waitcnt vmcnt(2)
    s_cmpk_ge_u32 s8, 2101
    s_cbranch_scc1 .ap_110
    s_waitcnt vmcnt(1)
.ap_110:
    s_add_u32 s63, s69, 450560
    buffer_load_dwordx4 v[92:95], v1, s[44:47], s63 offen nt
    s_setprio 0
    s_waitcnt vmcnt(6)
    v_perm_b32 v160, v44, v36, s94
    v_perm_b32 v164, v44, v36, s95
    v_perm_b32 v168, v45, v37, s94
    v_perm_b32 v172, v45, v37, s95
    v_perm_b32 v176, v46, v38, s94
    v_perm_b32 v180, v46, v38, s95
    v_perm_b32 v184, v47, v39, s94
    v_perm_b32 v188, v47, v39, s95
    s_waitcnt vmcnt(4)
    v_perm_b32 v161, v60, v52, s94
    v_perm_b32 v165, v60, v52, s95
    v_perm_b32 v169, v61, v53, s94
    v_perm_b32 v173, v61, v53, s95
    v_perm_b32 v177, v62, v54, s94
    v_perm_b32 v181, v62, v54, s95
    v_perm_b32 v185, v63, v55, s94
    v_perm_b32 v189, v63, v55, s95
    s_waitcnt vmcnt(2)
    v_perm_b32 v162, v76, v68, s94
    v_perm_b32 v166, v76, v68, s95
    v_perm_b32 v170, v77, v69, s94
    v_perm_b32 v174, v77, v69, s95
    v_perm_b32 v178, v78, v70, s94
    v_perm_b32 v182, v78, v70, s95
    v_perm_b32 v186, v79, v71, s94
    v_perm_b32 v190, v79, v71, s95
    s_waitcnt vmcnt(0)
    v_perm_b32 v163, v92, v84, s94
    v_perm_b32 v167, v92, v84, s95
    v_perm_b32 v171, v93, v85, s94
    v_mfma_f32_16x16x32_bf16 v[128:131], v[108:111], v[160:163], v[128:131]
    v_perm_b32 v175, v93, v85, s95
    v_mfma_f32_16x16x32_bf16 v[132:135], v[108:111], v[164:167], v[132:135]
    v_perm_b32 v179, v94, v86, s94
    v_mfma_f32_16x16x32_bf16 v[136:139], v[108:111], v[168:171], v[136:139]
    v_perm_b32 v183, v94, v86, s95
    v_mfma_f32_16x16x32_bf16 v[140:143], v[108:111], v[172:175], v[140:143]
    v_perm_b32 v187, v95, v87, s94
    v_mfma_f32_16x16x32_bf16 v[144:147], v[108:111], v[176:179], v[144:147]
    v_perm_b32 v191, v95, v87, s95
    v_mfma_f32_16x16x32_bf16 v[148:151], v[108:111], v[180:183], v[148:151]
    v_mfma_f32_16x16x32_bf16 v[152:155], v[108:111], v[184:187], v[152:155]
    v_mfma_f32_16x16x32_bf16 v[156:159], v[108:111], v[188:191], v[156:159]
    s_mov_b64 exec, 0xffff
    ds_write2_b32 v10, v128, v129 offset0:0 offset1:128
    ds_write2_b32 v10, v132, v133 offset0:1 offset1:129
    ds_write2_b32 v10, v136, v137 offset0:2 offset1:130
    ds_write2_b32 v10, v140, v141 offset0:3 offset1:131
    ds_write2_b32 v10, v144, v145 offset0:4 offset1:132
    ds_write2_b32 v10, v148, v149 offset0:5 offset1:133
    ds_write2_b32 v10, v152, v153 offset0:6 offset1:134
    ds_write2_b32 v10, v156, v157 offset0:7 offset1:135
    s_mov_b64 exec, -1
    s_waitcnt lgkmcnt(0)
    s_barrier
    s_cmp_lg_u32 s3, 7
    s_cbranch_scc1 .opub_111
    v_add_u32 v10, 147456, v2
    ds_read_b128 v[196:199], v10 offset:0
    ds_read_b128 v[200:203], v10 offset:1024
    ds_read_b128 v[204:207], v10 offset:2048
    ds_read_b128 v[208:211], v10 offset:3072
    ds_read_b128 v[212:215], v10 offset:4096
    ds_read_b128 v[216:219], v10 offset:5120
    ds_read_b128 v[220:223], v10 offset:6144
    ds_read_b128 v[224:227], v10 offset:7168
    v_lshrrev_b32 v11, 5, v0
    v_lshlrev_b32 v11, 13, v11
    v_and_b32 v12, 31, v0
    v_lshl_add_u32 v11, v12, 4, v11
    s_lshl4_add_u32 s56, s67, s66
    s_lshl1_add_u32 s56, s56, s68
    s_lshl_b32 s56, s56, 9
    s_add_u32 s56, s56, 0xa0000
    s_mov_b32 s60, 0x07060503
    s_mov_b32 s61, 0x07060502
    s_mov_b32 s62, 0x07060501
    v_mov_b32 v15, s34
    s_waitcnt lgkmcnt(6)
    v_pk_add_f32 v[196:197], v[196:197], v[200:201]
    v_pk_add_f32 v[198:199], v[198:199], v[202:203]
    s_waitcnt lgkmcnt(5)
    v_pk_add_f32 v[196:197], v[196:197], v[204:205]
    v_pk_add_f32 v[198:199], v[198:199], v[206:207]
    s_waitcnt lgkmcnt(4)
    v_pk_add_f32 v[196:197], v[196:197], v[208:209]
    v_pk_add_f32 v[198:199], v[198:199], v[210:211]
    s_waitcnt lgkmcnt(3)
    v_pk_add_f32 v[196:197], v[196:197], v[212:213]
    v_pk_add_f32 v[198:199], v[198:199], v[214:215]
    s_waitcnt lgkmcnt(2)
    v_pk_add_f32 v[196:197], v[196:197], v[216:217]
    v_pk_add_f32 v[198:199], v[198:199], v[218:219]
    s_waitcnt lgkmcnt(1)
    v_pk_add_f32 v[196:197], v[196:197], v[220:221]
    v_pk_add_f32 v[198:199], v[198:199], v[222:223]
    s_waitcnt lgkmcnt(0)
    v_pk_add_f32 v[196:197], v[196:197], v[224:225]
    v_pk_add_f32 v[198:199], v[198:199], v[226:227]
    v_perm_b32 v12, v196, v199, s60
    v_perm_b32 v13, v197, v199, s61
    v_perm_b32 v14, v198, v199, s62
    s_add_u32 s57, s56, 0x800000
    buffer_store_dwordx4 v[12:15], v11, s[36:39], s57 offen
    s_cmp_lg_u32 s0, 0
    s_nop 0
    s_cbranch_scc1 .nosl_112
    buffer_store_dwordx4 v[12:15], v11, s[36:39], s56 offen sc1
.nosl_112:
.opub_111:
    s_and_b32 s58, s64, 0
    s_mul_i32 s58, s58, 18432
    s_mul_i32 s59, s3, 2304
    s_add_u32 s58, s58, s59
    s_add_u32 s62, s58, 0x37000
    s_add_u32 s63, s58, 0x49000
    s_mul_i32 s101, s64, 18432
    s_add_u32 s101, s101, s59
    s_add_u32 s101, s101, 0x170000
    s_lshl_b32 s56, s65, 8
    s_add_u32 s58, s58, s56
    s_add_u32 s58, s58, 0x25000
    s_add_u32 s99, s101, s56
    s_lshr_b32 s56, s64, 1
    s_and_b32 s57, s3, 3
    s_cmp_lg_u32 s56, s57
    s_cbranch_scc1 .Lr_ga
    s_add_u32 s59, s58, 73728
    s_add_u32 s60, s58, 147456
    s_add_u32 s61, s58, 221184
.gp_113:
    buffer_load_dwordx4 v[56:59], v2, s[36:39], s62 offen offset:0 sc1
    buffer_load_dwordx4 v[60:63], v2, s[36:39], s62 offen offset:1024 sc1
    buffer_load_dwordx2 v[64:65], v5, s[36:39], s62 offen offset:0 sc1
    buffer_load_dwordx4 v[66:69], v2, s[36:39], s63 offen offset:0 sc1
    buffer_load_dwordx4 v[70:73], v2, s[36:39], s63 offen offset:1024 sc1
    buffer_load_dwordx2 v[74:75], v5, s[36:39], s63 offen offset:0 sc1
    buffer_load_dwordx2 v[76:77], v8, s[36:39], s59 offen offset:0 sc1
    buffer_load_dwordx2 v[78:79], v8, s[36:39], s60 offen offset:0 sc1
    buffer_load_dwordx2 v[80:81], v8, s[36:39], s61 offen offset:0 sc1
    buffer_load_dwordx2 v[42:43], v8, s[36:39], s58 offen offset:0 sc1
    s_branch .Lsk_m1_7
.Lst_m1_7:
    s_branch .Lrt_m1_7
.Lsk_m1_7:
    s_waitcnt vmcnt(0)
.gpc_114:
    v_min_u32 v24, v57, v59
    v_max_u32 v25, v57, v59
    v_min3_u32 v24, v24, v61, v63
    v_max3_u32 v25, v25, v61, v63
    v_min3_u32 v24, v24, v65, v67
    v_max3_u32 v25, v25, v65, v67
    v_min3_u32 v24, v24, v69, v71
    v_max3_u32 v25, v25, v69, v71
    v_min3_u32 v24, v24, v73, v75
    v_max3_u32 v25, v25, v73, v75
    v_min3_u32 v24, v24, v77, v79
    v_max3_u32 v25, v25, v77, v79
    v_min3_u32 v24, v24, v81, v43
    v_max3_u32 v25, v25, v81, v43
    v_cmp_eq_u32 vcc, s34, v24
    v_cmp_eq_u32 s[56:57], s34, v25
    s_and_b64 vcc, vcc, s[56:57]
    s_cmp_eq_u64 vcc, -1
    s_nop 2
    s_cbranch_scc1 .gpd_115
    s_sub_u32 s35, s35, 1
    s_cbranch_scc1 .Lexit
    s_sleep 2
    s_branch .gp_113
.gpd_115:
    v_and_b32 v57, 0xffff0000, v56
    v_lshlrev_b32 v56, 16, v56
    v_and_b32 v67, 0xffff0000, v66
    v_lshlrev_b32 v66, 16, v66
    v_and_b32 v59, 0xffff0000, v58
    v_lshlrev_b32 v58, 16, v58
    v_and_b32 v69, 0xffff0000, v68
    v_lshlrev_b32 v68, 16, v68
    v_and_b32 v61, 0xffff0000, v60
    v_lshlrev_b32 v60, 16, v60
    v_and_b32 v71, 0xffff0000, v70
    v_lshlrev_b32 v70, 16, v70
    v_and_b32 v63, 0xffff0000, v62
    v_lshlrev_b32 v62, 16, v62
    v_and_b32 v73, 0xffff0000, v72
    v_lshlrev_b32 v72, 16, v72
    v_and_b32 v65, 0xffff0000, v64
    v_lshlrev_b32 v64, 16, v64
    v_and_b32 v75, 0xffff0000, v74
    v_lshlrev_b32 v74, 16, v74
    v_lshlrev_b32 v77, 16, v76
    v_and_b32 v76, 0xffff0000, v76
    s_mov_b32 vcc_lo, 0xffff0000
    s_mov_b32 vcc_hi, 0xffff0000
    v_cndmask_b32 v77, v77, v76, vcc
    v_lshlrev_b32 v79, 16, v78
    v_and_b32 v78, 0xffff0000, v78
    s_mov_b32 vcc_lo, 0xffff0000
    s_mov_b32 vcc_hi, 0xffff0000
    v_cndmask_b32 v79, v79, v78, vcc
    v_lshlrev_b32 v81, 16, v80
    v_and_b32 v80, 0xffff0000, v80
    s_mov_b32 vcc_lo, 0xffff0000
    s_mov_b32 vcc_hi, 0xffff0000
    v_cndmask_b32 v81, v81, v80, vcc
    s_nop 1
    s_branch .Lr_ga2
.Lr_ga:
.gp_116:
    buffer_load_dwordx2 v[42:43], v8, s[36:39], s58 offen offset:0 sc1
    s_waitcnt vmcnt(0)
.gpc_117:
    v_cmp_eq_u32 vcc, s34, v43
    s_cmp_eq_u64 vcc, -1
    s_nop 3
    s_cbranch_scc1 .gpd_118
    s_sub_u32 s35, s35, 1
    s_cbranch_scc1 .Lexit
    s_sleep 2
    s_branch .gp_116
.gpd_118:
.Lr_ga2:
    v_lshlrev_b32 v40, 16, v40
    v_lshlrev_b32 v41, 16, v42
    v_and_b32 v42, 0xffff0000, v42
    s_mov_b32 vcc_lo, 0xffff0000
    s_mov_b32 vcc_hi, 0xffff0000
    v_cndmask_b32 v41, v41, v42, vcc
    s_mul_i32 s59, s3, 9
    s_add_u32 s59, s59, s65
    s_lshl_b32 s59, s59, 12
    s_add_u32 s59, s59, 0xe0000
    s_mov_b32 s60, 0x04000c0c
    s_mov_b32 s61, 0x0706000c
    v_mov_b32 v45, s34
    v_mov_b32 v47, s34
.ip_119:
    s_branch .Lsk_m2_0
    .fill 81, 4, 0xbf800000
.Lst_m2_0:
    s_branch .Lrt_m2_0
.Lsk_m2_0:
    buffer_load_dwordx4 v[16:19], v2, s[36:39], s59 offen offset:0 sc1
    buffer_load_dwordx4 v[20:23], v2, s[36:39], s59 offen offset:1024 sc1
    buffer_load_dwordx4 v[24:27], v2, s[36:39], s59 offen offset:2048 sc1
    buffer_load_dwordx4 v[28:31], v2, s[36:39], s59 offen offset:3072 sc1
    s_waitcnt vmcnt(3)
    v_mov_b32 v32, v19
    v_mov_b32 v33, v19
    v_perm_b32 v19, v16, v17, s60
    v_perm_b32 v19, v19, v18, s61
    s_waitcnt vmcnt(2)
    v_min_u32 v32, v32, v23
    v_max_u32 v33, v33, v23
    v_perm_b32 v23, v20, v21, s60
    v_perm_b32 v23, v23, v22, s61
    v_pk_add_f32 v[16:17], v[16:17], v[20:21]
    v_pk_add_f32 v[18:19], v[18:19], v[22:23]
    s_waitcnt vmcnt(1)
    v_min_u32 v32, v32, v27
    v_max_u32 v33, v33, v27
    v_perm_b32 v27, v24, v25, s60
    v_perm_b32 v27, v27, v26, s61
    v_pk_add_f32 v[16:17], v[16:17], v[24:25]
    v_pk_add_f32 v[18:19], v[18:19], v[26:27]
    s_waitcnt vmcnt(0)
    v_min_u32 v32, v32, v31
    v_max_u32 v33, v33, v31
    v_cmp_eq_u32 vcc, s34, v32
    v_cmp_eq_u32 s[56:57], s34, v33
    v_perm_b32 v31, v28, v29, s60
    v_perm_b32 v31, v31, v30, s61
    v_pk_add_f32 v[16:17], v[16:17], v[28:29]
    v_pk_add_f32 v[18:19], v[18:19], v[30:31]
    s_and_b64 vcc, vcc, s[56:57]
    s_cmp_eq_u64 vcc, -1
    s_cbranch_scc1 .ipd_120
    s_sub_u32 s35, s35, 1
    s_cbranch_scc0 .ip_119
    s_branch .Lexit
.ipd_120:
    v_permlane32_swap_b32 v16, v18
    v_permlane32_swap_b32 v17, v19
    v_pk_add_f32 v[16:17], v[16:17], v[18:19]
    s_nop 1
    v_permlane16_swap_b32 v16, v17
    v_add_f32 v16, v16, v17
    v_cvt_pk_bf16_f32 v16, v16, v16
    v_lshlrev_b32 v16, 16, v16
    v_mul_f32 v16, v16, v41
    v_cvt_pk_bf16_f32 v16, v16, v16
    v_lshlrev_b32 v16, 16, v16
    v_add_f32 v17, v16, v40
    v_add_f32 v16, v16, v40
    v_mov_b32 v40, v16
    s_nop 0
    v_permlane16_swap_b32 v16, v17
    v_cvt_pk_bf16_f32 v44, v16, v17
    s_mov_b32 exec_lo, 0xffff
    s_mov_b32 exec_hi, 0xffff
    s_add_u32 s57, s99, 0x800000
    buffer_store_dwordx2 v[44:45], v8, s[36:39], s57 offen
    s_cmp_lg_u32 s0, 0
    s_cbranch_scc1 .nosl_121
    buffer_store_dwordx2 v[44:45], v8, s[36:39], s99 offen sc1
.nosl_121:
    s_mov_b64 exec, -1
    s_lshr_b32 s56, s64, 1
    s_and_b32 s57, s3, 3
    s_cmp_lg_u32 s56, s57
    s_cbranch_scc1 .Lexit
    v_cvt_pk_bf16_f32 v40, v40, v40
    v_lshlrev_b32 v40, 16, v40
    s_mov_b32 s69, 0
.gp_122:
    s_add_u32 s69, s69, 1
    s_and_b32 s56, s69, 0x41
    s_cmp_lg_u32 s56, 0x41
    s_cselect_b32 s56, 0, 0x800000
    s_xor_b32 s56, s56, s0
    s_add_u32 s58, s101, s56
    buffer_load_dwordx4 v[84:87], v2, s[36:39], s58 offen offset:0 sc1
    buffer_load_dwordx4 v[88:91], v2, s[36:39], s58 offen offset:1024 sc1
    buffer_load_dwordx2 v[92:93], v5, s[36:39], s58 offen offset:0 sc1
    s_waitcnt vmcnt(0)
    v_min3_u32 v24, v85, v87, v89
    v_max3_u32 v25, v85, v87, v89
    v_min3_u32 v24, v24, v91, v93
    v_max3_u32 v25, v25, v91, v93
    v_cmp_eq_u32 vcc, s34, v24
    v_cmp_eq_u32 s[56:57], s34, v25
    s_and_b64 vcc, vcc, s[56:57]
    s_cmp_eq_u64 vcc, -1
    s_nop 2
    s_cbranch_scc1 .gpd_123
    s_sub_u32 s35, s35, 1
    s_cbranch_scc1 .Lexit
    s_sleep 1
    s_branch .gp_122
.gpd_123:
    s_mov_b32 s56, 0x3f803f80
    v_dot2_f32_bf16 v104, v84, s56, 0
    v_dot2_f32_bf16 v105, v84, v84, 0
    v_dot2_f32_bf16 v104, v86, s56, v104
    v_dot2_f32_bf16 v105, v86, v86, v105
    v_dot2_f32_bf16 v104, v88, s56, v104
    v_dot2_f32_bf16 v105, v88, v88, v105
    v_dot2_f32_bf16 v104, v90, s56, v104
    v_dot2_f32_bf16 v105, v90, v90, v105
    s_mov_b64 exec, 0xffffffff
    v_dot2_f32_bf16 v104, v92, s56, v104
    v_dot2_f32_bf16 v105, v92, v92, v105
    s_mov_b64 exec, -1
    s_nop 1
    v_permlane32_swap_b32 v104, v105
    v_add_f32 v104, v104, v105
    v_mov_b32 v106, v104
    s_nop 1
    v_permlane16_swap_b32 v106, v104
    v_add_f32 v104, v106, v104
    v_and_b32 v95, 0xffff0000, v84
    v_lshlrev_b32 v94, 16, v84
    v_add_f32_dpp v104, v104, v104 row_ror:8 row_mask:0xf bank_mask:0xf
    v_and_b32 v97, 0xffff0000, v86
    v_lshlrev_b32 v96, 16, v86
    v_add_f32_dpp v104, v104, v104 row_ror:4 row_mask:0xf bank_mask:0xf
    v_and_b32 v99, 0xffff0000, v88
    v_lshlrev_b32 v98, 16, v88
    v_add_f32_dpp v104, v104, v104 quad_perm:[2,3,0,1] row_mask:0xf bank_mask:0xf
    v_and_b32 v101, 0xffff0000, v90
    v_lshlrev_b32 v100, 16, v90
    v_add_f32_dpp v104, v104, v104 quad_perm:[1,0,3,2] row_mask:0xf bank_mask:0xf
    v_mul_f32 v104, 0x3ae38e39, v104
    v_and_b32 v103, 0xffff0000, v92
    v_lshlrev_b32 v102, 16, v92
    v_readlane_b32 s56, v104, 0
    v_readlane_b32 s57, v104, 32
    s_nop 0
    v_mov_b32 v104, s56
    v_fma_f32 v105, -v104, v104, s57
    v_max_f32 v105, 0, v105
    v_cvt_pk_bf16_f32 v106, -v104, v105
    v_and_b32 v107, 0xffff0000, v106
    v_add_f32 v107, 0x3727c5ac, v107
    v_lshlrev_b32 v104, 16, v106
    v_cvt_pk_bf16_f32 v107, v107, v107
    v_lshlrev_b32 v107, 16, v107
    v_sqrt_f32 v107, v107
    v_mov_b32 v105, v104
    v_cvt_pk_bf16_f32 v107, v107, v107
    v_lshlrev_b32 v107, 16, v107
    v_rcp_f32 v106, v107
    v_rcp_f32 v107, v107
    v_pk_add_f32 v[94:95], v[94:95], v[104:105]
    v_pk_add_f32 v[96:97], v[96:97], v[104:105]
    v_pk_add_f32 v[98:99], v[98:99], v[104:105]
    v_pk_add_f32 v[100:101], v[100:101], v[104:105]
    v_pk_add_f32 v[102:103], v[102:103], v[104:105]
    v_cvt_pk_bf16_f32 v94, v94, v95
    v_and_b32 v95, 0xffff0000, v94
    v_lshlrev_b32 v94, 16, v94
    v_cvt_pk_bf16_f32 v96, v96, v97
    v_and_b32 v97, 0xffff0000, v96
    v_lshlrev_b32 v96, 16, v96
    v_cvt_pk_bf16_f32 v98, v98, v99
    v_and_b32 v99, 0xffff0000, v98
    v_lshlrev_b32 v98, 16, v98
    v_cvt_pk_bf16_f32 v100, v100, v101
    v_and_b32 v101, 0xffff0000, v100
    v_lshlrev_b32 v100, 16, v100
    v_cvt_pk_bf16_f32 v102, v102, v103
    v_and_b32 v103, 0xffff0000, v102
    v_lshlrev_b32 v102, 16, v102
    v_pk_mul_f32 v[94:95], v[94:95], v[106:107]
    v_pk_mul_f32 v[96:97], v[96:97], v[106:107]
    v_pk_mul_f32 v[98:99], v[98:99], v[106:107]
    v_pk_mul_f32 v[100:101], v[100:101], v[106:107]
    v_pk_mul_f32 v[102:103], v[102:103], v[106:107]
    v_cvt_pk_bf16_f32 v94, v94, v95
    v_and_b32 v95, 0xffff0000, v94
    v_lshlrev_b32 v94, 16, v94
    v_cvt_pk_bf16_f32 v96, v96, v97
    v_and_b32 v97, 0xffff0000, v96
    s_branch .Lsk_m2_1
.Lst_m2_1:
    s_branch .Lrt_m2_1
.Lsk_m2_1:
    v_lshlrev_b32 v96, 16, v96
    v_cvt_pk_bf16_f32 v98, v98, v99
    v_and_b32 v99, 0xffff0000, v98
    v_lshlrev_b32 v98, 16, v98
    v_cvt_pk_bf16_f32 v100, v100, v101
    v_and_b32 v101, 0xffff0000, v100
    v_lshlrev_b32 v100, 16, v100
    v_cvt_pk_bf16_f32 v102, v102, v103
    v_and_b32 v103, 0xffff0000, v102
    v_lshlrev_b32 v102, 16, v102
    v_pk_mul_f32 v[94:95], v[94:95], v[66:67]
    v_pk_mul_f32 v[96:97], v[96:97], v[68:69]
    v_pk_mul_f32 v[98:99], v[98:99], v[70:71]
    v_pk_mul_f32 v[100:101], v[100:101], v[72:73]
    v_pk_mul_f32 v[102:103], v[102:103], v[74:75]
    v_cvt_pk_bf16_f32 v94, v94, v95
    v_and_b32 v95, 0xffff0000, v94
    v_lshlrev_b32 v94, 16, v94
    v_cvt_pk_bf16_f32 v96, v96, v97
    v_and_b32 v97, 0xffff0000, v96
    v_lshlrev_b32 v96, 16, v96
    v_cvt_pk_bf16_f32 v98, v98, v99
    v_and_b32 v99, 0xffff0000, v98
    v_lshlrev_b32 v98, 16, v98
    v_cvt_pk_bf16_f32 v100, v100, v101
    v_and_b32 v101, 0xffff0000, v100
    v_lshlrev_b32 v100, 16, v100
    v_cvt_pk_bf16_f32 v102, v102, v103
    v_and_b32 v103, 0xffff0000, v102
    v_lshlrev_b32 v102, 16, v102
    v_pk_add_f32 v[94:95], v[94:95], v[56:57]
    v_pk_add_f32 v[96:97], v[96:97], v[58:59]
    v_pk_add_f32 v[98:99], v[98:99], v[60:61]
    v_pk_add_f32 v[100:101], v[100:101], v[62:63]
    v_pk_add_f32 v[102:103], v[102:103], v[64:65]
    v_cvt_pk_bf16_f32 v110, v94, v95
    v_cvt_pk_bf16_f32 v111, v96, v97
    v_cvt_pk_bf16_f32 v112, v98, v99
    v_cvt_pk_bf16_f32 v113, v100, v101
    v_cvt_pk_bf16_f32 v114, v102, v103
    v_dot2_f32_bf16 v14, v110, v48, 0
    v_dot2_f32_bf16 v14, v111, v49, v14
    v_dot2_f32_bf16 v14, v112, v50, v14
    v_dot2_f32_bf16 v14, v113, v51, v14
    s_mov_b64 exec, 0xffffffff
    v_dot2_f32_bf16 v14, v114, v34, v14
    s_mov_b64 exec, -1
    s_nop 1
    v_mov_b32 v15, v14
    s_nop 1
    v_permlane32_swap_b32 v15, v14
    v_add_f32 v14, v15, v14
    v_mov_b32 v15, v14
    s_nop 1
    v_permlane16_swap_b32 v15, v14
    v_add_f32 v14, v15, v14
    s_nop 1
    v_add_f32_dpp v14, v14, v14 row_ror:8 row_mask:0xf bank_mask:0xf
    s_nop 1
    v_add_f32_dpp v14, v14, v14 row_ror:4 row_mask:0xf bank_mask:0xf
    s_nop 1
    v_add_f32_dpp v14, v14, v14 quad_perm:[2,3,0,1] row_mask:0xf bank_mask:0xf
    s_nop 1
    v_add_f32_dpp v14, v14, v14 quad_perm:[1,0,3,2] row_mask:0xf bank_mask:0xf
    v_cvt_pk_bf16_f32 v14, v14, v14
    v_lshlrev_b32 v14, 16, v14
    v_max_f32 v14, 0xc2ae0000, v14
    v_min_f32 v14, 0x43000000, v14
    v_mul_f32 v15, 0xbfb8aa3b, v14
    v_fma_f32 v16, v14, s98, -v15
    v_fmac_f32 v16, 0xb2a57060, v14
    v_exp_f32 v15, v15
    v_mul_f32 v16, 0x3f317218, v16
    v_fmac_f32 v15, v15, v16
    v_add_f32 v15, 1.0, v15
    v_rcp_f32 v16, v15
    s_nop 0
    v_fma_f32 v15, -v15, v16, 1.0
    v_fma_f32 v14, v15, v16, v16
    v_cvt_pk_bf16_f32 v14, v14, v14
    v_lshlrev_b32 v14, 16, v14
    v_add_f32 v41, v40, v104
    v_cvt_pk_bf16_f32 v41, v41, v41
    v_lshlrev_b32 v41, 16, v41
    v_mul_f32 v41, v41, v106
    v_cvt_pk_bf16_f32 v41, v41, v41
    v_lshlrev_b32 v41, 16, v41
    v_mul_f32 v41, v41, v79
    v_cvt_pk_bf16_f32 v41, v41, v41
    v_lshlrev_b32 v41, 16, v41
    v_add_f32 v41, v41, v77
    v_cvt_pk_bf16_f32 v41, v41, v41
    v_lshlrev_b32 v41, 16, v41
    s_and_b32 s62, s64, 1
    s_lshl1_add_u32 s58, s65, s62
    s_lshl3_add_u32 s58, s58, s3
    s_mul_i32 s58, s58, 9216
    s_add_u32 s58, s58, 0x1a0000
    s_add_u32 s59, s58, 4096
    s_add_u32 s63, s58, 8192
    s_cmp_eq_u32 s62, 0
    s_mov_b32 s56, 0x00ff00ff
    s_cselect_b32 s62, s56, 0xff00ff00
    s_mov_b32 s60, 0x04000c0c
    s_mov_b32 s61, 0x0706000c
    s_mov_b32 s48, s28
    s_and_b32 s49, s29, 0xffff
    s_mov_b32 s50, 0x2400
    s_mov_b32 s51, 0x00020000
.ip_124:
    s_branch .Lsk_m2_2
    .fill 94, 4, 0xbf800000
.Lst_m2_2:
    s_branch .Lrt_m2_2
.Lsk_m2_2:
    buffer_load_dwordx4 v[120:123], v2, s[36:39], s58 offen offset:0 sc1
    buffer_load_dwordx4 v[124:127], v2, s[36:39], s58 offen offset:1024 sc1
    buffer_load_dwordx4 v[128:131], v2, s[36:39], s58 offen offset:2048 sc1
    buffer_load_dwordx4 v[132:135], v2, s[36:39], s58 offen offset:3072 sc1
    buffer_load_dwordx4 v[136:139], v2, s[36:39], s59 offen offset:0 sc1
    buffer_load_dwordx4 v[140:143], v2, s[36:39], s59 offen offset:1024 sc1
    buffer_load_dwordx4 v[144:147], v2, s[36:39], s59 offen offset:2048 sc1
    buffer_load_dwordx4 v[148:151], v2, s[36:39], s59 offen offset:3072 sc1
    buffer_load_dwordx4 v[152:155], v2, s[36:39], s63 offen offset:0 sc1
    s_waitcnt vmcnt(8)
    v_mov_b32 v24, v123
    v_mov_b32 v25, v123
    v_perm_b32 v123, v120, v121, s60
    v_perm_b32 v123, v123, v122, s61
    s_waitcnt vmcnt(7)
    v_min_u32 v24, v24, v127
    v_max_u32 v25, v25, v127
    v_perm_b32 v127, v124, v125, s60
    v_perm_b32 v127, v127, v126, s61
    v_pk_add_f32 v[120:121], v[120:121], v[124:125]
    v_pk_add_f32 v[122:123], v[122:123], v[126:127]
    s_waitcnt vmcnt(6)
    v_min_u32 v24, v24, v131
    v_max_u32 v25, v25, v131
    v_perm_b32 v131, v128, v129, s60
    v_perm_b32 v131, v131, v130, s61
    v_pk_add_f32 v[120:121], v[120:121], v[128:129]
    v_pk_add_f32 v[122:123], v[122:123], v[130:131]
    s_waitcnt vmcnt(5)
    v_min_u32 v24, v24, v135
    v_max_u32 v25, v25, v135
    v_perm_b32 v135, v132, v133, s60
    v_perm_b32 v135, v135, v134, s61
    v_pk_add_f32 v[120:121], v[120:121], v[132:133]
    v_pk_add_f32 v[122:123], v[122:123], v[134:135]
    s_waitcnt vmcnt(4)
    v_min_u32 v24, v24, v139
    v_max_u32 v25, v25, v139
    v_perm_b32 v139, v136, v137, s60
    v_perm_b32 v139, v139, v138, s61
    v_pk_add_f32 v[120:121], v[120:121], v[136:137]
    v_pk_add_f32 v[122:123], v[122:123], v[138:139]
    s_waitcnt vmcnt(3)
    v_min_u32 v24, v24, v143
    v_max_u32 v25, v25, v143
    v_perm_b32 v143, v140, v141, s60
    v_perm_b32 v143, v143, v142, s61
    v_pk_add_f32 v[120:121], v[120:121], v[140:141]
    v_pk_add_f32 v[122:123], v[122:123], v[142:143]
    s_waitcnt vmcnt(2)
    v_min_u32 v24, v24, v147
    v_max_u32 v25, v25, v147
    v_perm_b32 v147, v144, v145, s60
    v_perm_b32 v147, v147, v146, s61
    v_pk_add_f32 v[120:121], v[120:121], v[144:145]
    v_pk_add_f32 v[122:123], v[122:123], v[146:147]
    s_waitcnt vmcnt(1)
    v_min_u32 v24, v24, v151
    v_max_u32 v25, v25, v151
    v_perm_b32 v151, v148, v149, s60
    v_perm_b32 v151, v151, v150, s61
    v_pk_add_f32 v[120:121], v[120:121], v[148:149]
    v_pk_add_f32 v[122:123], v[122:123], v[150:151]
    s_waitcnt vmcnt(0)
    v_min_u32 v24, v24, v155
    v_max_u32 v25, v25, v155
    v_cmp_eq_u32 vcc, s34, v24
    v_cmp_eq_u32 s[56:57], s34, v25
    v_perm_b32 v155, v152, v153, s60
    v_perm_b32 v155, v155, v154, s61
    v_pk_add_f32 v[120:121], v[120:121], v[152:153]
    v_pk_add_f32 v[122:123], v[122:123], v[154:155]
    s_and_b64 vcc, vcc, s[56:57]
    s_cmp_eq_u64 vcc, -1
    s_cbranch_scc1 .ipd_125
    s_sub_u32 s35, s35, 1
    s_cbranch_scc0 .ip_124
    s_branch .Lexit
.ipd_125:
    v_permlane32_swap_b32 v120, v122
    v_permlane32_swap_b32 v121, v123
    v_pk_add_f32 v[120:121], v[120:121], v[122:123]
    s_nop 1
    v_permlane16_swap_b32 v120, v121
    v_add_f32 v120, v120, v121
    s_nop 1
    v_add_f32_dpp v120, v120, v120 row_ror:8 row_mask:0xf bank_mask:0xf
    v_cvt_pk_bf16_f32 v120, v120, v120
    v_lshlrev_b32 v120, 16, v120
    v_mul_f32 v120, v120, v14
    v_cvt_pk_bf16_f32 v120, v120, v120
    v_lshlrev_b32 v120, 16, v120
    v_add_f32 v120, v120, v41
    v_cvt_pk_bf16_f32 v120, v120, v120
    v_lshlrev_b32 v120, 16, v120
    v_mul_f32 v120, v120, v81
    v_cvt_pk_bf16_f32 v120, v120, v120
    v_lshlrev_b32 v120, 16, v120
    v_add_f32 v120, v120, v40
    v_cvt_pk_bf16_f32 v120, v120, v120
    s_mov_b32 exec_lo, s62
    s_mov_b32 exec_hi, s62
    buffer_store_short v120, v7, s[48:51], s100 offen
    s_mov_b64 exec, -1
    s_or_b32 s56, s2, s3
    s_cmp_lg_u32 s56, 0
    s_cbranch_scc1 .Lexit
    v_mov_b32 v13, s34
    v_mov_b32 v12, 0
    s_mov_b64 exec, 1
    buffer_store_dword v13, v12, s[36:39], 0 offen
    s_mov_b64 exec, -1
    s_branch .Lexit
.Lbc:
    s_branch .Lsk_b0_0
.Lst_b0_0:
    s_branch .Lrt_b0_0
.Lsk_b0_0:
    s_sub_u32 s56, s65, 9
    s_mov_b32 s57, 0x63054210
    s_cmp_eq_u32 s65, 14
    s_cselect_b32 s56, s64, s56
    s_cselect_b32 s57, 0x37654210, s57
    s_cselect_b32 s99, 8, s64
    s_lshl_b32 s56, s56, 2
    s_lshr_b32 s56, s57, s56
    s_and_b32 s56, s56, 7
    s_cmp_eq_u32 s65, 17
    s_cselect_b32 s56, 7, s56
    s_lshl3_add_u32 s99, s99, s56
    s_and_b32 s56, s99, 7
    s_cmp_eq_u32 s56, 3
    s_mov_b32 s14, 0xb5b5b5b5
    s_cselect_b32 s14, 0x0, s14
    s_mov_b32 s15, 0xd6d6b6b6
    s_cselect_b32 s15, 0x0, s15
    s_cselect_b32 s30, -50, 0
    s_add_u32 s30, s30, 0
    s_add_u32 s30, s30, s70
    s_mov_b32 s31, s70
    s_mov_b32 s48, s18
    s_and_b32 s49, s19, 0xffff
    s_mov_b32 s50, 0x510000
    s_mov_b32 s51, 0x00020000
    s_mov_b32 s52, s20
    s_and_b32 s53, s21, 0xffff
    s_mov_b32 s54, 0x510000
    s_mov_b32 s55, 0x00020000
    v_bfe_u32 v12, v0, 4, 1
    s_and_b32 s56, s3, 3
    s_lshl_b32 s56, s56, 1
    v_or_b32 v12, s56, v12
    v_and_b32 v6, 7, v0
    v_xor_b32 v12, v12, v6
    v_lshrrev_b32 v6, 3, v0
    v_mul_u32_u24 v6, 9216, v6
    v_lshl_add_u32 v6, v12, 4, v6
    s_mul_i32 s100, s3, 73728
    s_lshl_b32 s56, s99, 7
    s_add_u32 s100, s100, s56
    s_lshl_b32 s101, s3, 10
    s_waitcnt lgkmcnt(0)
    s_add_u32 s34, s34, 1
    s_getreg_b32 s1, hwreg(HW_REG_XCC_ID)
    s_lshl_b32 s1, s1, 24
    s_add_u32 s1, s1, s34
    s_lshr_b32 s0, s2, 3
    s_lshl_b32 s63, s64, 8
    s_add_u32 s0, s0, s63
    s_lshl2_add_u32 s0, s0, 0x480000
    v_mov_b32 v30, s1
    s_cmp_eq_u32 s3, 0
    s_cselect_b64 exec, 1, 0
    buffer_store_dword v30, v2, s[36:39], s0 offen sc1
    s_mov_b64 exec, -1
    v_and_b32 v8, 1, v0
    v_lshlrev_b32 v8, 8, v8
    v_and_b32 v9, 0x3c, v0
    v_lshl_add_u32 v9, v9, 2, v8
    v_add_u32 v7, v9, v8
    v_and_b32 v9, 0x3c, v0
    v_lshrrev_b32 v8, 4, v8
    v_and_b32 v9, 4, v0
    v_lshl_add_u32 v9, v9, 3, v8
    s_lshl_b32 s58, s66, 14
    s_lshl_b32 s59, s67, 10
    s_add_u32 s58, s58, s59
    s_add_u32 s58, s58, 0x70000
    s_lshl4_add_u32 s59, s66, s67
    s_lshl_b32 s59, s59, 7
    s_add_u32 s59, s59, 0x430000
    s_bitcmp1_b64 s[14:15], 4
    s_cbranch_scc0 1
    s_waitcnt vmcnt(4)
    s_add_u32 s63, s69, 32768
    buffer_load_dwordx4 v[96:99], v1, s[40:43], s63 offen nt
    s_waitcnt vmcnt(6)
    s_add_u32 m0, s101, 0
    s_add_u32 s56, s100, 0
    buffer_load_dwordx4 v6, s[48:51], s56 offen nt lds
    s_waitcnt vmcnt(6)
    s_bitcmp1_b64 s[14:15], 5
    s_cbranch_scc0 1
    s_waitcnt vmcnt(4)
    s_add_u32 s63, s69, 40960
    buffer_load_dwordx4 v[100:103], v1, s[40:43], s63 offen nt
    s_waitcnt vmcnt(6)
    s_bitcmp1_b64 s[14:15], 6
    s_cbranch_scc0 1
    s_waitcnt vmcnt(2)
    s_add_u32 s63, s69, 49152
    buffer_load_dwordx4 v[128:131], v1, s[40:43], s63 offen nt
    s_cmp_eq_u32 s3, 0
    s_cbranch_scc1 .Lst_b1_0
    s_cmp_eq_u32 s3, 1
    s_cbranch_scc1 .Lst_b1_1
    s_cmp_eq_u32 s3, 2
    s_cbranch_scc1 .Lst_b1_2
    s_cmp_eq_u32 s3, 3
    s_cbranch_scc1 .Lst_b1_3
    s_cmp_eq_u32 s3, 4
    s_cbranch_scc1 .Lst_b1_4
    s_cmp_eq_u32 s3, 5
    s_cbranch_scc1 .Lst_b1_5
    s_cmp_eq_u32 s3, 6
    s_cbranch_scc1 .Lst_b1_6
    s_cmp_eq_u32 s3, 7
    s_cbranch_scc1 .Lst_b1_7
.Lrt_b1_0:
.Lrt_b1_1:
.Lrt_b1_2:
.Lrt_b1_3:
.Lrt_b1_4:
.Lrt_b1_5:
.Lrt_b1_6:
.Lrt_b1_7:
    s_waitcnt vmcnt(6)
    s_add_u32 m0, s101, 8192
    s_add_u32 s56, s100, 589824
    buffer_load_dwordx4 v6, s[48:51], s56 offen nt lds
    s_waitcnt vmcnt(4)
    s_bitcmp1_b64 s[14:15], 7
    s_cbranch_scc0 1
    s_waitcnt vmcnt(2)
    s_add_u32 s63, s69, 57344
    buffer_load_dwordx4 v[132:135], v1, s[40:43], s63 offen nt
    s_waitcnt vmcnt(4)
    s_bitcmp1_b64 s[14:15], 8
    s_cbranch_scc0 1
    s_waitcnt vmcnt(2)
    s_add_u32 s63, s69, 131072
    buffer_load_dwordx4 v[40:43], v1, s[40:43], s63 offen nt
    s_memrealtime s[8:9]
    s_waitcnt lgkmcnt(0)
    s_sub_u32 s8, s8, s30
    s_cmpk_ge_u32 s8, 436
    s_cbranch_scc1 .ap_126
    s_waitcnt vmcnt(5)
    s_cmpk_ge_u32 s8, 336
    s_cbranch_scc1 .ap_126
    s_waitcnt vmcnt(4)
    s_bitcmp1_b64 s[14:15], 9
    s_cbranch_scc0 1
    s_waitcnt vmcnt(2)
    s_cmpk_ge_u32 s8, 216
    s_cbranch_scc1 .ap_126
    s_waitcnt vmcnt(1)
.ap_126:
    s_add_u32 s63, s69, 139264
    buffer_load_dwordx4 v[44:47], v1, s[40:43], s63 offen nt
    s_memrealtime s[8:9]
    s_waitcnt lgkmcnt(0)
    s_sub_u32 s8, s8, s30
    s_cmpk_ge_u32 s8, 469
    s_cbranch_scc1 .ap_127
    s_waitcnt vmcnt(5)
    s_cmpk_ge_u32 s8, 369
    s_cbranch_scc1 .ap_127
    s_waitcnt vmcnt(4)
    s_bitcmp1_b64 s[14:15], 10
    s_cbranch_scc0 1
    s_waitcnt vmcnt(2)
    s_cmpk_ge_u32 s8, 249
    s_cbranch_scc1 .ap_127
    s_waitcnt vmcnt(1)
.ap_127:
    s_add_u32 s63, s69, 147456
    buffer_load_dwordx4 v[72:75], v1, s[40:43], s63 offen nt
    s_memrealtime s[8:9]
    s_waitcnt lgkmcnt(0)
    s_sub_u32 s8, s8, s30
    s_cmpk_ge_u32 s8, 503
    s_cbranch_scc1 .ap_128
    s_waitcnt vmcnt(5)
    s_cmpk_ge_u32 s8, 403
    s_cbranch_scc1 .ap_128
    s_waitcnt vmcnt(4)
    s_cmpk_ge_u32 s8, 283
    s_cbranch_scc1 .ap_128
    s_waitcnt vmcnt(1)
.ap_128:
    s_add_u32 m0, s101, 16384
    s_add_u32 s56, s100, 1179648
    buffer_load_dwordx4 v6, s[48:51], s56 offen nt lds
    s_memrealtime s[8:9]
    s_waitcnt lgkmcnt(0)
    s_sub_u32 s8, s8, s30
    s_cmpk_ge_u32 s8, 503
    s_cbranch_scc1 .ap_129
    s_waitcnt vmcnt(5)
    s_cmpk_ge_u32 s8, 403
    s_cbranch_scc1 .ap_129
    s_waitcnt vmcnt(4)
    s_bitcmp1_b64 s[14:15], 11
    s_cbranch_scc0 1
    s_waitcnt vmcnt(2)
    s_cmpk_ge_u32 s8, 283
    s_cbranch_scc1 .ap_129
    s_waitcnt vmcnt(1)
.ap_129:
    s_add_u32 s63, s69, 155648
    buffer_load_dwordx4 v[76:79], v1, s[40:43], s63 offen nt
    s_memrealtime s[8:9]
    s_waitcnt vmcnt(8)
    s_waitcnt lgkmcnt(0)
    s_sub_u32 s8, s8, s30
    s_cmpk_ge_u32 s8, 537
    s_cbranch_scc1 .ap_130
    s_waitcnt vmcnt(5)
    s_cmpk_ge_u32 s8, 437
    s_cbranch_scc1 .ap_130
    s_waitcnt vmcnt(4)
    s_bitcmp1_b64 s[14:15], 12
    s_cbranch_scc0 1
    s_waitcnt vmcnt(2)
    s_cmpk_ge_u32 s8, 317
    s_cbranch_scc1 .ap_130
    s_waitcnt vmcnt(1)
.ap_130:
    s_add_u32 s63, s69, 163840
    buffer_load_dwordx4 v[104:107], v1, s[40:43], s63 offen nt
    v_and_b32 v157, 7, v0
    v_lshlrev_b32 v157, 2, v157
    s_mov_b32 s63, 0x4a1100
    buffer_load_dword v156, v157, s[36:39], s63 offen
    s_branch .Lsk_b0_1
.Lst_b0_1:
    s_branch .Lrt_b0_1
.Lsk_b0_1:
    s_memrealtime s[8:9]
    s_waitcnt vmcnt(9)
    s_waitcnt lgkmcnt(0)
    s_sub_u32 s8, s8, s30
    s_cmpk_ge_u32 s8, 571
    s_cbranch_scc1 .ap_131
    s_waitcnt vmcnt(6)
    s_cmpk_ge_u32 s8, 471
    s_cbranch_scc1 .ap_131
    s_waitcnt vmcnt(5)
    s_bitcmp1_b64 s[14:15], 13
    s_cbranch_scc0 1
    s_waitcnt vmcnt(3)
    s_cmpk_ge_u32 s8, 351
    s_cbranch_scc1 .ap_131
    s_waitcnt vmcnt(2)
.ap_131:
    s_add_u32 s63, s69, 172032
    buffer_load_dwordx4 v[108:111], v1, s[40:43], s63 offen nt
    s_memrealtime s[8:9]
    s_waitcnt vmcnt(9)
    s_waitcnt lgkmcnt(0)
    s_sub_u32 s8, s8, s30
    s_cmpk_ge_u32 s8, 605
    s_cbranch_scc1 .ap_132
    s_waitcnt vmcnt(6)
    s_cmpk_ge_u32 s8, 505
    s_cbranch_scc1 .ap_132
    s_waitcnt vmcnt(5)
    s_bitcmp1_b64 s[14:15], 14
    s_cbranch_scc0 1
    s_waitcnt vmcnt(3)
    s_cmpk_ge_u32 s8, 385
    s_cbranch_scc1 .ap_132
    s_waitcnt vmcnt(2)
.ap_132:
    s_add_u32 s63, s69, 180224
    buffer_load_dwordx4 v[136:139], v1, s[40:43], s63 offen nt
    s_branch .Lsk_b0_2
.Lst_b0_2:
    s_branch .Lrt_b0_2
.Lsk_b0_2:
    s_memrealtime s[8:9]
    s_waitcnt vmcnt(9)
    s_waitcnt lgkmcnt(0)
    s_sub_u32 s8, s8, s30
    s_cmpk_ge_u32 s8, 639
    s_cbranch_scc1 .ap_133
    s_waitcnt vmcnt(6)
    s_cmpk_ge_u32 s8, 539
    s_cbranch_scc1 .ap_133
    s_waitcnt vmcnt(5)
    s_cmpk_ge_u32 s8, 419
    s_cbranch_scc1 .ap_133
    s_waitcnt vmcnt(1)
.ap_133:
    s_add_u32 m0, s101, 24576
    s_add_u32 s56, s100, 1769472
    buffer_load_dwordx4 v6, s[48:51], s56 offen nt lds
    s_memrealtime s[8:9]
    s_waitcnt vmcnt(9)
    s_waitcnt lgkmcnt(0)
    s_sub_u32 s8, s8, s30
    s_cmpk_ge_u32 s8, 639
    s_cbranch_scc1 .ap_134
    s_waitcnt vmcnt(6)
    s_cmpk_ge_u32 s8, 539
    s_cbranch_scc1 .ap_134
    s_waitcnt vmcnt(5)
    s_bitcmp1_b64 s[14:15], 15
    s_cbranch_scc0 1
    s_waitcnt vmcnt(2)
    s_cmpk_ge_u32 s8, 419
    s_cbranch_scc1 .ap_134
    s_waitcnt vmcnt(1)
.ap_134:
    s_add_u32 s63, s69, 188416
    buffer_load_dwordx4 v[140:143], v1, s[40:43], s63 offen nt
    s_memrealtime s[8:9]
    s_waitcnt vmcnt(9)
    s_waitcnt lgkmcnt(0)
    s_sub_u32 s8, s8, s30
    s_cmpk_ge_u32 s8, 673
    s_cbranch_scc1 .ap_135
    s_waitcnt vmcnt(6)
    s_cmpk_ge_u32 s8, 573
    s_cbranch_scc1 .ap_135
    s_waitcnt vmcnt(5)
    s_bitcmp1_b64 s[14:15], 16
    s_cbranch_scc0 1
    s_waitcnt vmcnt(2)
    s_cmpk_ge_u32 s8, 453
    s_cbranch_scc1 .ap_135
    s_waitcnt vmcnt(1)
.ap_135:
    s_add_u32 s63, s69, 262144
    buffer_load_dwordx4 v[48:51], v1, s[40:43], s63 offen nt
    s_waitcnt vmcnt(5)
    s_sub_u32 s63, s70, 300
    v_subrev_u32 v156, s63, v156
    v_mov_b32 v157, 600
    v_cmp_lt_u32 s[8:9], v156, v157
    v_add_u32_dpp v156, v156, v156 quad_perm:[1,0,3,2] row_mask:0xf bank_mask:0xf
    s_nop 1
    v_add_u32_dpp v156, v156, v156 quad_perm:[2,3,0,1] row_mask:0xf bank_mask:0xf
    s_nop 1
    v_add_u32_dpp v156, v156, v156 row_ror:4 row_mask:0xf bank_mask:0xf
    s_nop 0
    v_readfirstlane_b32 s63, v156
    s_cmp_eq_u64 s[8:9], -1
    s_nop 3
    s_cbranch_scc0 .et_136
    s_lshr_b32 s63, s63, 3
    s_sub_u32 s63, s63, 300
    s_add_u32 s30, s30, s63
    s_add_u32 s31, s31, s63
.et_136:
    s_memrealtime s[8:9]
    s_waitcnt lgkmcnt(0)
    s_sub_u32 s8, s8, s30
    s_cmpk_ge_u32 s8, 707
    s_cbranch_scc1 .ap_137
    s_waitcnt vmcnt(5)
    s_cmpk_ge_u32 s8, 607
    s_cbranch_scc1 .ap_137
    s_waitcnt vmcnt(4)
    s_bitcmp1_b64 s[14:15], 17
    s_cbranch_scc0 1
    s_waitcnt vmcnt(2)
    s_cmpk_ge_u32 s8, 487
    s_cbranch_scc1 .ap_137
    s_waitcnt vmcnt(1)
.ap_137:
    s_add_u32 s63, s69, 270336
    buffer_load_dwordx4 v[52:55], v1, s[40:43], s63 offen nt
    s_memrealtime s[8:9]
    s_waitcnt lgkmcnt(0)
    s_sub_u32 s8, s8, s30
    s_cmpk_ge_u32 s8, 742
    s_cbranch_scc1 .ap_138
    s_waitcnt vmcnt(5)
    s_cmpk_ge_u32 s8, 642
    s_cbranch_scc1 .ap_138
    s_waitcnt vmcnt(4)
    s_bitcmp1_b64 s[14:15], 18
    s_cbranch_scc0 1
    s_waitcnt vmcnt(2)
    s_cmpk_ge_u32 s8, 522
    s_cbranch_scc1 .ap_138
    s_waitcnt vmcnt(1)
.ap_138:
    s_add_u32 s63, s69, 278528
    buffer_load_dwordx4 v[80:83], v1, s[40:43], s63 offen nt
    s_memrealtime s[8:9]
    s_waitcnt lgkmcnt(0)
    s_sub_u32 s8, s8, s30
    s_cmpk_ge_u32 s8, 777
    s_cbranch_scc1 .ap_139
    s_waitcnt vmcnt(5)
    s_cmpk_ge_u32 s8, 677
    s_cbranch_scc1 .ap_139
    s_waitcnt vmcnt(4)
    s_cmpk_ge_u32 s8, 557
    s_cbranch_scc1 .ap_139
    s_waitcnt vmcnt(1)
.ap_139:
    s_add_u32 m0, s101, 32768
    s_add_u32 s56, s100, 2359296
    buffer_load_dwordx4 v6, s[48:51], s56 offen nt lds
    s_memrealtime s[8:9]
    s_waitcnt lgkmcnt(0)
    s_sub_u32 s8, s8, s30
    s_cmpk_ge_u32 s8, 777
    s_cbranch_scc1 .ap_140
    s_waitcnt vmcnt(5)
    s_cmpk_ge_u32 s8, 677
    s_cbranch_scc1 .ap_140
    s_waitcnt vmcnt(4)
    s_bitcmp1_b64 s[14:15], 19
    s_cbranch_scc0 1
    s_waitcnt vmcnt(2)
    s_cmpk_ge_u32 s8, 557
    s_cbranch_scc1 .ap_140
    s_waitcnt vmcnt(1)
.ap_140:
    s_add_u32 s63, s69, 286720
    buffer_load_dwordx4 v[84:87], v1, s[40:43], s63 offen nt
    s_memrealtime s[8:9]
    s_waitcnt vmcnt(8)
    s_waitcnt lgkmcnt(0)
    s_sub_u32 s8, s8, s30
    s_cmpk_ge_u32 s8, 812
    s_cbranch_scc1 .ap_141
    s_waitcnt vmcnt(5)
    s_cmpk_ge_u32 s8, 712
    s_cbranch_scc1 .ap_141
    s_waitcnt vmcnt(4)
    s_bitcmp1_b64 s[14:15], 20
    s_cbranch_scc0 1
    s_waitcnt vmcnt(2)
    s_cmpk_ge_u32 s8, 592
    s_cbranch_scc1 .ap_141
    s_waitcnt vmcnt(1)
.ap_141:
    s_add_u32 s63, s69, 294912
    buffer_load_dwordx4 v[112:115], v1, s[40:43], s63 offen nt
    s_memrealtime s[8:9]
    s_waitcnt vmcnt(8)
    s_waitcnt lgkmcnt(0)
    s_sub_u32 s8, s8, s30
    s_cmpk_ge_u32 s8, 847
    s_cbranch_scc1 .ap_142
    s_waitcnt vmcnt(5)
    s_cmpk_ge_u32 s8, 747
    s_cbranch_scc1 .ap_142
    s_waitcnt vmcnt(4)
    s_bitcmp1_b64 s[14:15], 21
    s_cbranch_scc0 1
    s_waitcnt vmcnt(2)
    s_cmpk_ge_u32 s8, 627
    s_cbranch_scc1 .ap_142
    s_waitcnt vmcnt(1)
.ap_142:
    s_add_u32 s63, s69, 303104
    buffer_load_dwordx4 v[116:119], v1, s[40:43], s63 offen nt
    s_memrealtime s[8:9]
    s_waitcnt vmcnt(8)
    s_waitcnt lgkmcnt(0)
    s_sub_u32 s8, s8, s30
    s_cmpk_ge_u32 s8, 882
    s_cbranch_scc1 .ap_143
    s_waitcnt vmcnt(5)
    s_cmpk_ge_u32 s8, 782
    s_cbranch_scc1 .ap_143
    s_waitcnt vmcnt(4)
    s_bitcmp1_b64 s[14:15], 22
    s_cbranch_scc0 1
    s_waitcnt vmcnt(2)
    s_cmpk_ge_u32 s8, 662
    s_cbranch_scc1 .ap_143
    s_waitcnt vmcnt(1)
.ap_143:
    s_add_u32 s63, s69, 311296
    buffer_load_dwordx4 v[144:147], v1, s[40:43], s63 offen nt
    s_memrealtime s[8:9]
    s_waitcnt vmcnt(8)
    s_waitcnt lgkmcnt(0)
    s_sub_u32 s8, s8, s30
    s_cmpk_ge_u32 s8, 917
    s_cbranch_scc1 .ap_144
    s_waitcnt vmcnt(5)
    s_cmpk_ge_u32 s8, 817
    s_cbranch_scc1 .ap_144
    s_waitcnt vmcnt(4)
    s_cmpk_ge_u32 s8, 697
    s_cbranch_scc1 .ap_144
    s_waitcnt vmcnt(1)
.ap_144:
    s_add_u32 m0, s101, 40960
    s_add_u32 s56, s100, 2949120
    buffer_load_dwordx4 v6, s[48:51], s56 offen nt lds
    s_memrealtime s[8:9]
    s_waitcnt vmcnt(8)
    s_waitcnt lgkmcnt(0)
    s_sub_u32 s8, s8, s30
    s_cmpk_ge_u32 s8, 917
    s_cbranch_scc1 .ap_145
    s_waitcnt vmcnt(5)
    s_cmpk_ge_u32 s8, 817
    s_cbranch_scc1 .ap_145
    s_waitcnt vmcnt(4)
    s_bitcmp1_b64 s[14:15], 23
    s_cbranch_scc0 1
    s_waitcnt vmcnt(2)
    s_cmpk_ge_u32 s8, 697
    s_cbranch_scc1 .ap_145
    s_waitcnt vmcnt(1)
.ap_145:
    s_add_u32 s63, s69, 319488
    buffer_load_dwordx4 v[148:151], v1, s[40:43], s63 offen nt
    s_branch .Lsk_b0_3
.Lst_b0_3:
    s_branch .Lrt_b0_3
.Lsk_b0_3:
    s_memrealtime s[8:9]
    s_waitcnt vmcnt(8)
    s_waitcnt lgkmcnt(0)
    s_sub_u32 s8, s8, s30
    s_cmpk_ge_u32 s8, 952
    s_cbranch_scc1 .ap_146
    s_waitcnt vmcnt(5)
    s_cmpk_ge_u32 s8, 852
    s_cbranch_scc1 .ap_146
    s_waitcnt vmcnt(4)
    s_bitcmp1_b64 s[14:15], 24
    s_cbranch_scc0 1
    s_waitcnt vmcnt(2)
    s_cmpk_ge_u32 s8, 732
    s_cbranch_scc1 .ap_146
    s_waitcnt vmcnt(1)
.ap_146:
    s_add_u32 s63, s69, 393216
    buffer_load_dwordx4 v[56:59], v1, s[40:43], s63 offen nt
    s_memrealtime s[8:9]
    s_waitcnt vmcnt(8)
    s_waitcnt lgkmcnt(0)
    s_sub_u32 s8, s8, s30
    s_cmpk_ge_u32 s8, 987
    s_cbranch_scc1 .ap_147
    s_waitcnt vmcnt(5)
    s_cmpk_ge_u32 s8, 887
    s_cbranch_scc1 .ap_147
    s_waitcnt vmcnt(4)
    s_bitcmp1_b64 s[14:15], 25
    s_cbranch_scc0 1
    s_waitcnt vmcnt(2)
    s_cmpk_ge_u32 s8, 767
    s_cbranch_scc1 .ap_147
    s_waitcnt vmcnt(1)
.ap_147:
    s_add_u32 s63, s69, 401408
    buffer_load_dwordx4 v[60:63], v1, s[40:43], s63 offen nt
    s_memrealtime s[8:9]
    s_waitcnt vmcnt(8)
    s_waitcnt lgkmcnt(0)
    s_sub_u32 s8, s8, s30
    s_cmpk_ge_u32 s8, 1025
    s_cbranch_scc1 .ap_148
    s_waitcnt vmcnt(5)
    s_cmpk_ge_u32 s8, 925
    s_cbranch_scc1 .ap_148
    s_waitcnt vmcnt(4)
    s_bitcmp1_b64 s[14:15], 26
    s_cbranch_scc0 1
    s_waitcnt vmcnt(2)
    s_cmpk_ge_u32 s8, 805
    s_cbranch_scc1 .ap_148
    s_waitcnt vmcnt(1)
.ap_148:
    s_add_u32 s63, s69, 409600
    buffer_load_dwordx4 v[88:91], v1, s[40:43], s63 offen nt
    s_memrealtime s[8:9]
    s_waitcnt vmcnt(8)
    s_waitcnt lgkmcnt(0)
    s_sub_u32 s8, s8, s30
    s_cmpk_ge_u32 s8, 1064
    s_cbranch_scc1 .ap_149
    s_waitcnt vmcnt(5)
    s_cmpk_ge_u32 s8, 964
    s_cbranch_scc1 .ap_149
    s_waitcnt vmcnt(4)
    s_cmpk_ge_u32 s8, 844
    s_cbranch_scc1 .ap_149
    s_waitcnt vmcnt(1)
.ap_149:
    s_add_u32 m0, s101, 49152
    s_add_u32 s56, s100, 3538944
    buffer_load_dwordx4 v6, s[48:51], s56 offen nt lds
    s_memrealtime s[8:9]
    s_waitcnt vmcnt(8)
    s_waitcnt lgkmcnt(0)
    s_sub_u32 s8, s8, s30
    s_cmpk_ge_u32 s8, 1064
    s_cbranch_scc1 .ap_150
    s_waitcnt vmcnt(5)
    s_cmpk_ge_u32 s8, 964
    s_cbranch_scc1 .ap_150
    s_waitcnt vmcnt(4)
    s_bitcmp1_b64 s[14:15], 27
    s_cbranch_scc0 1
    s_waitcnt vmcnt(2)
    s_cmpk_ge_u32 s8, 844
    s_cbranch_scc1 .ap_150
    s_waitcnt vmcnt(1)
.ap_150:
    s_add_u32 s63, s69, 417792
    buffer_load_dwordx4 v[92:95], v1, s[40:43], s63 offen nt
    s_memrealtime s[8:9]
    s_waitcnt vmcnt(8)
    s_waitcnt lgkmcnt(0)
    s_sub_u32 s8, s8, s30
    s_cmpk_ge_u32 s8, 1102
    s_cbranch_scc1 .ap_151
    s_waitcnt vmcnt(5)
    s_cmpk_ge_u32 s8, 1002
    s_cbranch_scc1 .ap_151
    s_waitcnt vmcnt(4)
    s_bitcmp1_b64 s[14:15], 28
    s_cbranch_scc0 1
    s_waitcnt vmcnt(2)
    s_cmpk_ge_u32 s8, 882
    s_cbranch_scc1 .ap_151
    s_waitcnt vmcnt(1)
.ap_151:
    s_add_u32 s63, s69, 425984
    buffer_load_dwordx4 v[120:123], v1, s[40:43], s63 offen nt
    s_memrealtime s[8:9]
    s_waitcnt vmcnt(8)
    s_waitcnt lgkmcnt(0)
    s_sub_u32 s8, s8, s30
    s_cmpk_ge_u32 s8, 1141
    s_cbranch_scc1 .ap_152
    s_waitcnt vmcnt(5)
    s_cmpk_ge_u32 s8, 1041
    s_cbranch_scc1 .ap_152
    s_waitcnt vmcnt(4)
    s_bitcmp1_b64 s[14:15], 29
    s_cbranch_scc0 1
    s_waitcnt vmcnt(2)
    s_cmpk_ge_u32 s8, 921
    s_cbranch_scc1 .ap_152
    s_waitcnt vmcnt(1)
.ap_152:
    s_add_u32 s63, s69, 434176
    buffer_load_dwordx4 v[124:127], v1, s[40:43], s63 offen nt
    s_memrealtime s[8:9]
    s_waitcnt vmcnt(8)
    s_waitcnt lgkmcnt(0)
    s_sub_u32 s8, s8, s30
    s_cmpk_ge_u32 s8, 1179
    s_cbranch_scc1 .ap_153
    s_waitcnt vmcnt(5)
    s_cmpk_ge_u32 s8, 1079
    s_cbranch_scc1 .ap_153
    s_waitcnt vmcnt(4)
    s_bitcmp1_b64 s[14:15], 30
    s_cbranch_scc0 1
    s_waitcnt vmcnt(2)
    s_cmpk_ge_u32 s8, 959
    s_cbranch_scc1 .ap_153
    s_waitcnt vmcnt(1)
.ap_153:
    s_add_u32 s63, s69, 442368
    buffer_load_dwordx4 v[152:155], v1, s[40:43], s63 offen nt
    s_memrealtime s[8:9]
    s_waitcnt vmcnt(8)
    s_waitcnt lgkmcnt(0)
    s_sub_u32 s8, s8, s30
    s_cmpk_ge_u32 s8, 1218
    s_cbranch_scc1 .ap_154
    s_waitcnt vmcnt(5)
    s_cmpk_ge_u32 s8, 1118
    s_cbranch_scc1 .ap_154
    s_waitcnt vmcnt(4)
    s_cmpk_ge_u32 s8, 998
    s_cbranch_scc1 .ap_154
    s_waitcnt vmcnt(1)
.ap_154:
    s_add_u32 m0, s101, 57344
    s_add_u32 s56, s100, 4128768
    buffer_load_dwordx4 v6, s[48:51], s56 offen nt lds
    s_and_b32 s0, s0, 0xffffff80
    s_sub_u32 s0, s0, 1024
    buffer_load_dword v28, v4, s[36:39], s0 offen sc1
    s_memrealtime s[8:9]
    s_waitcnt vmcnt(9)
    s_waitcnt lgkmcnt(0)
    s_sub_u32 s8, s8, s30
    s_cmpk_ge_u32 s8, 1218
    s_cbranch_scc1 .ap_155
    s_waitcnt vmcnt(6)
    s_cmpk_ge_u32 s8, 1118
    s_cbranch_scc1 .ap_155
    s_waitcnt vmcnt(5)
    s_bitcmp1_b64 s[14:15], 31
    s_cbranch_scc0 1
    s_waitcnt vmcnt(3)
    s_cmpk_ge_u32 s8, 998
    s_cbranch_scc1 .ap_155
    s_waitcnt vmcnt(2)
.ap_155:
    s_add_u32 s63, s69, 450560
    buffer_load_dwordx4 v[156:159], v1, s[40:43], s63 offen nt
    s_memrealtime s[8:9]
    s_waitcnt vmcnt(9)
    s_waitcnt lgkmcnt(0)
    s_sub_u32 s8, s8, s30
    s_cmpk_ge_u32 s8, 1257
    s_cbranch_scc1 .ap_156
    s_waitcnt vmcnt(6)
    s_cmpk_ge_u32 s8, 1157
    s_cbranch_scc1 .ap_156
    s_waitcnt vmcnt(5)
    s_bitcmp1_b64 s[14:15], 32
    s_cbranch_scc0 1
    s_waitcnt vmcnt(3)
    s_cmpk_ge_u32 s8, 1037
    s_cbranch_scc1 .ap_156
    s_waitcnt vmcnt(2)
.ap_156:
    v_bfe_u32 v1, v0, 4, 2
    v_and_b32 v10, 0xf0, v2
    v_lshlrev_b32 v1, 2, v1
    v_bfe_u32 v1, s6, v1, 4
    v_lshl_add_u32 v1, v1, 8, v10
    s_add_u32 s63, s69, 0
    buffer_load_dwordx4 v[160:163], v1, s[44:47], s63 offen nt
    s_memrealtime s[8:9]
    s_waitcnt vmcnt(9)
    s_waitcnt lgkmcnt(0)
    s_sub_u32 s8, s8, s30
    s_cmpk_ge_u32 s8, 1293
    s_cbranch_scc1 .ap_157
    s_waitcnt vmcnt(6)
    s_cmpk_ge_u32 s8, 1193
    s_cbranch_scc1 .ap_157
    s_waitcnt vmcnt(5)
    s_bitcmp1_b64 s[14:15], 33
    s_cbranch_scc0 1
    s_waitcnt vmcnt(3)
    s_cmpk_ge_u32 s8, 1073
    s_cbranch_scc1 .ap_157
    s_waitcnt vmcnt(1)
.ap_157:
    s_add_u32 s63, s69, 8192
    buffer_load_dwordx4 v[164:167], v1, s[44:47], s63 offen nt
    s_memrealtime s[8:9]
    s_waitcnt vmcnt(9)
    s_waitcnt lgkmcnt(0)
    s_sub_u32 s8, s8, s30
    s_cmpk_ge_u32 s8, 1329
    s_cbranch_scc1 .ap_158
    s_branch .Lsk_b1_0
.Lst_b1_0:
    s_branch .Lrt_b1_0
.Lsk_b1_0:
    s_waitcnt vmcnt(6)
    s_cmpk_ge_u32 s8, 1229
    s_cbranch_scc1 .ap_158
    s_waitcnt vmcnt(5)
    s_bitcmp1_b64 s[14:15], 34
    s_cbranch_scc0 1
    s_waitcnt vmcnt(2)
    s_cmpk_ge_u32 s8, 1109
    s_cbranch_scc1 .ap_158
    s_waitcnt vmcnt(1)
.ap_158:
    s_add_u32 s63, s69, 16384
    buffer_load_dwordx4 v[168:171], v1, s[44:47], s63 offen nt
    s_memrealtime s[8:9]
    s_waitcnt vmcnt(9)
    s_waitcnt lgkmcnt(0)
    s_sub_u32 s8, s8, s30
    s_cmpk_ge_u32 s8, 1366
    s_cbranch_scc1 .ap_159
    s_waitcnt vmcnt(6)
    s_cmpk_ge_u32 s8, 1266
    s_cbranch_scc1 .ap_159
    s_waitcnt vmcnt(5)
    s_cmpk_ge_u32 s8, 1146
    s_cbranch_scc1 .ap_159
    s_waitcnt vmcnt(1)
.ap_159:
    s_add_u32 m0, s101, 65536
    s_add_u32 s56, s100, 4718592
    buffer_load_dwordx4 v6, s[48:51], s56 offen nt lds
    s_memrealtime s[8:9]
    s_waitcnt vmcnt(9)
    s_waitcnt lgkmcnt(0)
    s_sub_u32 s8, s8, s30
    s_cmpk_ge_u32 s8, 1366
    s_cbranch_scc1 .ap_160
    s_waitcnt vmcnt(6)
    s_cmpk_ge_u32 s8, 1266
    s_cbranch_scc1 .ap_160
    s_waitcnt vmcnt(4)
    s_bitcmp1_b64 s[14:15], 35
    s_cbranch_scc0 1
    s_waitcnt vmcnt(2)
    s_cmpk_ge_u32 s8, 1146
    s_cbranch_scc1 .ap_160
    s_waitcnt vmcnt(1)
.ap_160:
    s_add_u32 s63, s69, 24576
    buffer_load_dwordx4 v[172:175], v1, s[44:47], s63 offen nt
    s_memrealtime s[8:9]
    s_waitcnt vmcnt(9)
    s_waitcnt lgkmcnt(0)
    s_sub_u32 s8, s8, s30
    s_cmpk_ge_u32 s8, 1402
    s_cbranch_scc1 .ap_161
    s_waitcnt vmcnt(5)
    s_cmpk_ge_u32 s8, 1302
    s_cbranch_scc1 .ap_161
    s_waitcnt vmcnt(4)
    s_bitcmp1_b64 s[14:15], 36
    s_cbranch_scc0 1
    s_waitcnt vmcnt(2)
    s_cmpk_ge_u32 s8, 1182
    s_cbranch_scc1 .ap_161
    s_waitcnt vmcnt(1)
.ap_161:
    s_add_u32 s63, s69, 32768
    buffer_load_dwordx4 v[176:179], v1, s[44:47], s63 offen nt
    s_waitcnt vmcnt(7)
    v_cmp_eq_u32 vcc, s1, v28
    s_cmp_eq_u64 vcc, -1
    s_cselect_b32 s0, 0x800000, 0
    s_add_u32 s58, s58, s0
    buffer_load_dwordx4 v[16:19], v7, s[36:39], s58 offen offset:0 sc1
    buffer_load_dwordx4 v[20:23], v7, s[36:39], s58 offen offset:256 sc1
    s_memrealtime s[8:9]
    s_waitcnt vmcnt(8)
    s_waitcnt lgkmcnt(0)
    s_sub_u32 s8, s8, s30
    s_cmpk_ge_u32 s8, 1439
    s_cbranch_scc1 .ap_162
    s_waitcnt vmcnt(5)
    s_cmpk_ge_u32 s8, 1339
    s_cbranch_scc1 .ap_162
    s_waitcnt vmcnt(4)
    s_bitcmp1_b64 s[14:15], 37
    s_cbranch_scc0 1
    s_waitcnt vmcnt(2)
    s_cmpk_ge_u32 s8, 1219
    s_cbranch_scc1 .ap_162
    s_waitcnt vmcnt(1)
.ap_162:
    s_add_u32 s63, s69, 40960
    buffer_load_dwordx4 v[180:183], v1, s[44:47], s63 offen nt
    s_memrealtime s[8:9]
    s_waitcnt vmcnt(8)
    s_waitcnt lgkmcnt(0)
    s_sub_u32 s8, s8, s30
    s_cmpk_ge_u32 s8, 1475
    s_cbranch_scc1 .ap_163
    s_waitcnt vmcnt(5)
    s_cmpk_ge_u32 s8, 1375
    s_cbranch_scc1 .ap_163
    s_waitcnt vmcnt(4)
    s_bitcmp1_b64 s[14:15], 38
    s_cbranch_scc0 1
    s_waitcnt vmcnt(2)
    s_cmpk_ge_u32 s8, 1255
    s_cbranch_scc1 .ap_163
    s_waitcnt vmcnt(1)
.ap_163:
    s_add_u32 s63, s69, 49152
    buffer_load_dwordx4 v[184:187], v1, s[44:47], s63 offen nt
    s_memrealtime s[8:9]
    s_waitcnt vmcnt(8)
    s_waitcnt lgkmcnt(0)
    s_sub_u32 s8, s8, s30
    s_cmpk_ge_u32 s8, 1512
    s_cbranch_scc1 .ap_164
    s_waitcnt vmcnt(5)
    s_cmpk_ge_u32 s8, 1412
    s_cbranch_scc1 .ap_164
    s_waitcnt vmcnt(4)
    s_cmpk_ge_u32 s8, 1292
    s_cbranch_scc1 .ap_164
    s_waitcnt vmcnt(1)
.ap_164:
    s_add_u32 m0, s101, 73728
    s_add_u32 s56, s100, 0
    buffer_load_dwordx4 v6, s[52:55], s56 offen nt lds
    s_memrealtime s[8:9]
    s_waitcnt vmcnt(8)
    s_waitcnt lgkmcnt(0)
    s_sub_u32 s8, s8, s30
    s_cmpk_ge_u32 s8, 1512
    s_cbranch_scc1 .ap_165
    s_waitcnt vmcnt(5)
    s_cmpk_ge_u32 s8, 1412
    s_cbranch_scc1 .ap_165
    s_waitcnt vmcnt(4)
    s_bitcmp1_b64 s[14:15], 39
    s_cbranch_scc0 1
    s_waitcnt vmcnt(2)
    s_cmpk_ge_u32 s8, 1292
    s_cbranch_scc1 .ap_165
    s_waitcnt vmcnt(1)
.ap_165:
    s_add_u32 s63, s69, 57344
    buffer_load_dwordx4 v[188:191], v1, s[44:47], s63 offen nt
    s_memrealtime s[8:9]
    s_waitcnt vmcnt(8)
    s_waitcnt lgkmcnt(0)
    s_sub_u32 s8, s8, s30
    s_cmpk_ge_u32 s8, 1548
    s_cbranch_scc1 .ap_166
    s_waitcnt vmcnt(5)
    s_cmpk_ge_u32 s8, 1448
    s_cbranch_scc1 .ap_166
    s_waitcnt vmcnt(4)
    s_bitcmp1_b64 s[14:15], 40
    s_cbranch_scc0 1
    s_waitcnt vmcnt(2)
    s_cmpk_ge_u32 s8, 1328
    s_cbranch_scc1 .ap_166
    s_waitcnt vmcnt(1)
.ap_166:
    s_add_u32 s63, s69, 131072
    buffer_load_dwordx4 v[192:195], v1, s[44:47], s63 offen nt
    s_waitcnt vmcnt(5)
    s_branch .gpc_168
.gp_167:
    s_xor_b32 s58, s58, 0x800000
    buffer_load_dwordx4 v[16:19], v7, s[36:39], s58 offen offset:0 sc1
    buffer_load_dwordx4 v[20:23], v7, s[36:39], s58 offen offset:256 sc1
    s_waitcnt vmcnt(0)
.gpc_168:
    v_min_u32 v10, v17, v19
    v_max_u32 v11, v17, v19
    v_min3_u32 v10, v10, v21, v23
    v_max3_u32 v11, v11, v21, v23
    v_cmp_eq_u32 vcc, s34, v10
    v_cmp_eq_u32 s[56:57], s34, v11
    s_and_b64 vcc, vcc, s[56:57]
    s_cmp_eq_u64 vcc, -1
    s_nop 2
    s_cbranch_scc1 .gpd_169
    s_sub_u32 s35, s35, 1
    s_cbranch_scc1 .Lexit
    s_sleep 1
    s_branch .gp_167
.gpd_169:
    s_mov_b32 vcc_lo, 0xcccccccc
    s_mov_b32 vcc_hi, 0xcccccccc
    v_cndmask_b32_e64 v24, v16, 0, vcc
    v_cndmask_b32_e64 v25, v18, 0, vcc
    v_cndmask_b32_e64 v26, v20, 0, vcc
    v_cndmask_b32_e64 v27, v22, 0, vcc
    v_cndmask_b32_e32 v28, 0, v16, vcc
    v_cndmask_b32_e32 v29, 0, v18, vcc
    v_cndmask_b32_e32 v30, 0, v20, vcc
    v_cndmask_b32_e32 v31, 0, v22, vcc
    v_mfma_f32_16x16x32_bf16 v[16:19], v[32:35], v[24:27], 0
    v_mfma_f32_16x16x32_bf16 v[32:35], v[40:43], v[24:27], 0
    v_mfma_f32_16x16x32_bf16 v[16:19], v[36:39], v[28:31], v[16:19]
    v_mfma_f32_16x16x32_bf16 v[40:43], v[48:51], v[24:27], 0
    v_mfma_f32_16x16x32_bf16 v[32:35], v[44:47], v[28:31], v[32:35]
    v_mfma_f32_16x16x32_bf16 v[48:51], v[56:59], v[24:27], 0
    v_mfma_f32_16x16x32_bf16 v[40:43], v[52:55], v[28:31], v[40:43]
    v_mfma_f32_16x16x32_bf16 v[56:59], v[64:67], v[24:27], 0
    v_mfma_f32_16x16x32_bf16 v[48:51], v[60:63], v[28:31], v[48:51]
    s_nop 1
    v_add_f32_dpp v10, v17, v16 row_ror:12 row_mask:0xf bank_mask:0x1
    s_memrealtime s[8:9]
    s_waitcnt lgkmcnt(0)
    s_sub_u32 s8, s8, s30
    s_cmpk_ge_u32 s8, 1585
    s_nop 0
    s_cbranch_scc1 .ap_170
    s_waitcnt vmcnt(5)
    s_cmpk_ge_u32 s8, 1485
    s_cbranch_scc1 .ap_170
    s_waitcnt vmcnt(4)
    s_bitcmp1_b64 s[14:15], 41
    s_cbranch_scc0 1
    s_waitcnt vmcnt(2)
    s_cmpk_ge_u32 s8, 1365
    s_cbranch_scc1 .ap_170
    s_branch .Lsk_b1_1
.Lst_b1_1:
    s_branch .Lrt_b1_1
.Lsk_b1_1:
    s_waitcnt vmcnt(1)
.ap_170:
    s_add_u32 s63, s69, 139264
    buffer_load_dwordx4 v[196:199], v1, s[44:47], s63 offen nt
    v_mfma_f32_16x16x32_bf16 v[64:67], v[72:75], v[24:27], 0
    v_mfma_f32_16x16x32_bf16 v[56:59], v[68:71], v[28:31], v[56:59]
    v_add_f32_dpp v11, v33, v32 row_ror:12 row_mask:0xf bank_mask:0x1
    v_add_f32_dpp v10, v18, v10 row_ror:8 row_mask:0xf bank_mask:0x1
    v_mfma_f32_16x16x32_bf16 v[72:75], v[80:83], v[24:27], 0
    v_mfma_f32_16x16x32_bf16 v[64:67], v[76:79], v[28:31], v[64:67]
    v_add_f32_dpp v12, v41, v40 row_ror:12 row_mask:0xf bank_mask:0x1
    v_add_f32_dpp v11, v34, v11 row_ror:8 row_mask:0xf bank_mask:0x1
    v_add_f32_dpp v10, v19, v10 row_ror:4 row_mask:0xf bank_mask:0x1
    v_mfma_f32_16x16x32_bf16 v[80:83], v[88:91], v[24:27], 0
    v_mfma_f32_16x16x32_bf16 v[72:75], v[84:87], v[28:31], v[72:75]
    v_add_f32_dpp v13, v49, v48 row_ror:12 row_mask:0xf bank_mask:0x1
    v_add_f32_dpp v12, v42, v12 row_ror:8 row_mask:0xf bank_mask:0x1
    v_add_f32_dpp v11, v35, v11 row_ror:4 row_mask:0xf bank_mask:0x1
    v_mfma_f32_16x16x32_bf16 v[88:91], v[96:99], v[24:27], 0
    v_mfma_f32_16x16x32_bf16 v[80:83], v[92:95], v[28:31], v[80:83]
    v_add_f32_dpp v10, v58, v57 row_ror:12 row_mask:0xf bank_mask:0x2
    v_add_f32_dpp v13, v50, v13 row_ror:8 row_mask:0xf bank_mask:0x1
    v_add_f32_dpp v12, v43, v12 row_ror:4 row_mask:0xf bank_mask:0x1
    s_memrealtime s[8:9]
    s_waitcnt lgkmcnt(0)
    s_sub_u32 s8, s8, s30
    s_cmpk_ge_u32 s8, 1596
    s_nop 0
    s_cbranch_scc1 .ap_171
    s_waitcnt vmcnt(5)
    s_cmpk_ge_u32 s8, 1496
    s_cbranch_scc1 .ap_171
    s_waitcnt vmcnt(4)
    s_bitcmp1_b64 s[14:15], 42
    s_cbranch_scc0 1
    s_waitcnt vmcnt(2)
    s_cmpk_ge_u32 s8, 1376
    s_cbranch_scc1 .ap_171
    s_waitcnt vmcnt(1)
.ap_171:
    s_add_u32 s63, s69, 147456
    buffer_load_dwordx4 v[200:203], v1, s[44:47], s63 offen nt
    s_memrealtime s[8:9]
    s_waitcnt lgkmcnt(0)
    s_sub_u32 s8, s8, s30
    s_cmpk_ge_u32 s8, 1607
    s_cbranch_scc1 .ap_172
    s_waitcnt vmcnt(5)
    s_cmpk_ge_u32 s8, 1507
    s_cbranch_scc1 .ap_172
    s_waitcnt vmcnt(4)
    s_cmpk_ge_u32 s8, 1387
    s_cbranch_scc1 .ap_172
    s_waitcnt vmcnt(1)
.ap_172:
    s_add_u32 m0, s101, 81920
    s_add_u32 s56, s100, 589824
    buffer_load_dwordx4 v6, s[52:55], s56 offen nt lds
    v_mfma_f32_16x16x32_bf16 v[96:99], v[104:107], v[24:27], 0
    v_mfma_f32_16x16x32_bf16 v[88:91], v[100:103], v[28:31], v[88:91]
    v_add_f32_dpp v11, v66, v65 row_ror:12 row_mask:0xf bank_mask:0x2
    v_add_f32_dpp v10, v59, v10 row_ror:8 row_mask:0xf bank_mask:0x2
    v_add_f32_dpp v13, v51, v13 row_ror:4 row_mask:0xf bank_mask:0x1
    v_mfma_f32_16x16x32_bf16 v[104:107], v[112:115], v[24:27], 0
    v_mfma_f32_16x16x32_bf16 v[96:99], v[108:111], v[28:31], v[96:99]
    v_add_f32_dpp v12, v74, v73 row_ror:12 row_mask:0xf bank_mask:0x2
    v_add_f32_dpp v11, v67, v11 row_ror:8 row_mask:0xf bank_mask:0x2
    v_add_f32_dpp v10, v56, v10 row_ror:4 row_mask:0xf bank_mask:0x2
    v_mfma_f32_16x16x32_bf16 v[112:115], v[120:123], v[24:27], 0
    v_mfma_f32_16x16x32_bf16 v[104:107], v[116:119], v[28:31], v[104:107]
    v_add_f32_dpp v13, v82, v81 row_ror:12 row_mask:0xf bank_mask:0x2
    v_add_f32_dpp v12, v75, v12 row_ror:8 row_mask:0xf bank_mask:0x2
    v_add_f32_dpp v11, v64, v11 row_ror:4 row_mask:0xf bank_mask:0x2
    v_mfma_f32_16x16x32_bf16 v[120:123], v[128:131], v[24:27], 0
    v_mfma_f32_16x16x32_bf16 v[112:115], v[124:127], v[28:31], v[112:115]
    v_add_f32_dpp v10, v91, v90 row_ror:12 row_mask:0xf bank_mask:0x4
    v_add_f32_dpp v13, v83, v13 row_ror:8 row_mask:0xf bank_mask:0x2
    v_add_f32_dpp v12, v72, v12 row_ror:4 row_mask:0xf bank_mask:0x2
    s_memrealtime s[8:9]
    s_waitcnt lgkmcnt(0)
    s_sub_u32 s8, s8, s30
    s_cmpk_ge_u32 s8, 1607
    s_nop 0
    s_cbranch_scc1 .ap_173
    s_waitcnt vmcnt(5)
    s_cmpk_ge_u32 s8, 1507
    s_cbranch_scc1 .ap_173
    s_waitcnt vmcnt(4)
    s_bitcmp1_b64 s[14:15], 43
    s_cbranch_scc0 1
    s_waitcnt vmcnt(2)
    s_cmpk_ge_u32 s8, 1387
    s_cbranch_scc1 .ap_173
    s_waitcnt vmcnt(1)
.ap_173:
    s_add_u32 s63, s69, 155648
    buffer_load_dwordx4 v[204:207], v1, s[44:47], s63 offen nt
    v_mfma_f32_16x16x32_bf16 v[128:131], v[136:139], v[24:27], 0
    v_mfma_f32_16x16x32_bf16 v[120:123], v[132:135], v[28:31], v[120:123]
    v_add_f32_dpp v11, v99, v98 row_ror:12 row_mask:0xf bank_mask:0x4
    v_add_f32_dpp v10, v88, v10 row_ror:8 row_mask:0xf bank_mask:0x4
    v_add_f32_dpp v13, v80, v13 row_ror:4 row_mask:0xf bank_mask:0x2
    v_mfma_f32_16x16x32_bf16 v[136:139], v[144:147], v[24:27], 0
    v_mfma_f32_16x16x32_bf16 v[128:131], v[140:143], v[28:31], v[128:131]
    v_add_f32_dpp v12, v107, v106 row_ror:12 row_mask:0xf bank_mask:0x4
    v_add_f32_dpp v11, v96, v11 row_ror:8 row_mask:0xf bank_mask:0x4
    v_add_f32_dpp v10, v89, v10 row_ror:4 row_mask:0xf bank_mask:0x4
    v_mfma_f32_16x16x32_bf16 v[144:147], v[152:155], v[24:27], 0
    v_mfma_f32_16x16x32_bf16 v[136:139], v[148:151], v[28:31], v[136:139]
    v_add_f32_dpp v13, v115, v114 row_ror:12 row_mask:0xf bank_mask:0x4
    v_add_f32_dpp v12, v104, v12 row_ror:8 row_mask:0xf bank_mask:0x4
    v_add_f32_dpp v11, v97, v11 row_ror:4 row_mask:0xf bank_mask:0x4
    v_mfma_f32_16x16x32_bf16 v[144:147], v[156:159], v[28:31], v[144:147]
    v_add_f32_dpp v10, v120, v123 row_ror:12 row_mask:0xf bank_mask:0x8
    v_add_f32_dpp v13, v112, v13 row_ror:8 row_mask:0xf bank_mask:0x4
    v_add_f32_dpp v12, v105, v12 row_ror:4 row_mask:0xf bank_mask:0x4
    s_memrealtime s[8:9]
    s_waitcnt vmcnt(8)
    s_waitcnt lgkmcnt(0)
    s_sub_u32 s8, s8, s30
    s_cmpk_ge_u32 s8, 1618
    s_cbranch_scc1 .ap_174
    s_waitcnt vmcnt(5)
    s_cmpk_ge_u32 s8, 1518
    s_cbranch_scc1 .ap_174
    s_waitcnt vmcnt(4)
    s_bitcmp1_b64 s[14:15], 44
    s_cbranch_scc0 1
    s_waitcnt vmcnt(2)
    s_cmpk_ge_u32 s8, 1398
    s_cbranch_scc1 .ap_174
    s_waitcnt vmcnt(1)
.ap_174:
    s_add_u32 s63, s69, 163840
    buffer_load_dwordx4 v[208:211], v1, s[44:47], s63 offen nt
    s_cmp_eq_u32 s3, 0
    s_cbranch_scc1 .Lst_b2_0
    s_cmp_eq_u32 s3, 1
    s_branch .Lsk_b1_2
.Lst_b1_2:
    s_branch .Lrt_b1_2
.Lsk_b1_2:
    s_cbranch_scc1 .Lst_b2_1
    s_cmp_eq_u32 s3, 2
    s_cbranch_scc1 .Lst_b2_2
    s_cmp_eq_u32 s3, 3
    s_cbranch_scc1 .Lst_b2_3
.Lrt_b2_0:
.Lrt_b2_1:
.Lrt_b2_2:
.Lrt_b2_3:
    v_add_f32_dpp v11, v128, v131 row_ror:12 row_mask:0xf bank_mask:0x8
    v_add_f32_dpp v10, v121, v10 row_ror:8 row_mask:0xf bank_mask:0x8
    v_add_f32_dpp v13, v113, v13 row_ror:4 row_mask:0xf bank_mask:0x4
    v_add_f32_dpp v12, v136, v139 row_ror:12 row_mask:0xf bank_mask:0x8
    v_add_f32_dpp v11, v129, v11 row_ror:8 row_mask:0xf bank_mask:0x8
    v_add_f32_dpp v10, v122, v10 row_ror:4 row_mask:0xf bank_mask:0x8
    v_add_f32_dpp v13, v144, v147 row_ror:12 row_mask:0xf bank_mask:0x8
    v_add_f32_dpp v12, v137, v12 row_ror:8 row_mask:0xf bank_mask:0x8
    v_add_f32_dpp v11, v130, v11 row_ror:4 row_mask:0xf bank_mask:0x8
    v_add_f32_dpp v13, v145, v13 row_ror:8 row_mask:0xf bank_mask:0x8
    v_add_f32_dpp v12, v138, v12 row_ror:4 row_mask:0xf bank_mask:0x8
    s_memrealtime s[8:9]
    s_waitcnt vmcnt(8)
    s_waitcnt lgkmcnt(0)
    s_sub_u32 s8, s8, s30
    s_cmpk_ge_u32 s8, 1629
    s_cbranch_scc1 .ap_175
    s_waitcnt vmcnt(5)
    s_cmpk_ge_u32 s8, 1529
    s_cbranch_scc1 .ap_175
    s_waitcnt vmcnt(4)
    s_bitcmp1_b64 s[14:15], 45
    s_cbranch_scc0 1
    s_waitcnt vmcnt(2)
    s_cmpk_ge_u32 s8, 1409
    s_cbranch_scc1 .ap_175
    s_waitcnt vmcnt(1)
.ap_175:
    s_add_u32 s63, s69, 172032
    buffer_load_dwordx4 v[212:215], v1, s[44:47], s63 offen nt
    v_add_f32_dpp v13, v146, v13 row_ror:4 row_mask:0xf bank_mask:0x8
    s_mov_b32 s60, 0x3db504f3
    s_mov_b32 s61, 0x3db504f3
    v_cvt_pk_bf16_f32 v10, v10, v11
    v_and_b32 v11, 0xffff0000, v10
    v_lshlrev_b32 v10, 16, v10
    v_cvt_pk_bf16_f32 v12, v12, v13
    v_and_b32 v13, 0xffff0000, v12
    v_lshlrev_b32 v12, 16, v12
    v_pk_mul_f32 v[10:11], v[10:11], s[60:61]
    v_pk_mul_f32 v[12:13], v[12:13], s[60:61]
    v_cvt_pk_bf16_f32 v10, v10, v11
    v_and_b32 v11, 0xffff0000, v10
    v_lshlrev_b32 v10, 16, v10
    v_cvt_pk_bf16_f32 v12, v12, v13
    v_and_b32 v13, 0xffff0000, v12
    v_lshlrev_b32 v12, 16, v12
    v_max_f32 v14, v10, v11
    v_max3_f32 v14, v14, v12, v13
    s_mov_b32 s60, 0x3fb8aa3b
    v_mov_b32 v22, s34
    v_mov_b32 v23, s34
    v_max_f32_dpp v14, v14, v14 quad_perm:[2,3,0,1] row_mask:0xf bank_mask:0xf
    s_nop 1
    v_max_f32_dpp v14, v14, v14 row_ror:4 row_mask:0xf bank_mask:0xf
    s_nop 1
    v_max_f32_dpp v14, v14, v14 row_ror:8 row_mask:0xf bank_mask:0xf
    v_mov_b32 v15, v14
    s_nop 1
    v_permlane16_swap_b32 v15, v14
    v_max_f32 v14, v15, v14
    v_mov_b32 v15, v14
    s_nop 1
    v_permlane32_swap_b32 v15, v14
    v_max_f32 v14, v15, v14
    v_mul_f32 v15, 0xbfb8aa3b, v14
    v_fma_f32 v10, v10, s60, v15
    v_fma_f32 v11, v11, s60, v15
    v_fma_f32 v12, v12, s60, v15
    v_fma_f32 v13, v13, s60, v15
    v_exp_f32 v10, v10
    v_exp_f32 v11, v11
    v_exp_f32 v12, v12
    v_exp_f32 v13, v13
    v_mov_b32 v20, v14
    v_pk_add_f32 v[16:17], v[10:11], v[12:13]
    v_add_f32 v21, v16, v17
    s_lshl_b32 s60, s68, 5
    s_lshl_b32 s61, s3, 4
    s_add_u32 s61, s61, 159104
    v_add_u32 v16, s61, v3
    v_mov_b32 v17, 159232
    v_mov_b32 v18, 1
    s_add_u32 s60, s60, s59
    v_add_f32_dpp v21, v21, v21 quad_perm:[2,3,0,1] row_mask:0xf bank_mask:0xf
    s_nop 1
    v_add_f32_dpp v21, v21, v21 row_ror:4 row_mask:0xf bank_mask:0xf
    s_nop 1
    v_add_f32_dpp v21, v21, v21 row_ror:8 row_mask:0xf bank_mask:0xf
    v_mov_b32 v15, v21
    s_nop 1
    v_permlane16_swap_b32 v15, v21
    v_add_f32 v21, v15, v21
    v_mov_b32 v15, v21
    s_nop 1
    v_permlane32_swap_b32 v15, v21
    v_add_f32 v21, v15, v21
    s_mov_b64 exec, 3
    ds_write_b64 v16, v[20:21]
    s_mov_b64 exec, 1
    ds_add_rtn_u32 v18, v17, v18
    s_mov_b64 exec, -1
    v_and_b32 v16, 0x78, v3
    v_or_b32 v16, 159104, v16
    s_waitcnt lgkmcnt(0)
    v_readfirstlane_b32 s61, v18
    s_cmp_eq_u32 s61, 7
    s_nop 3
    s_cbranch_scc0 .mlc_176
    ds_read_b64 v[18:19], v16
    s_waitcnt lgkmcnt(0)
    v_mov_b32 v20, v18
    s_nop 1
    v_max_f32_dpp v20, v20, v20 quad_perm:[2,3,0,1] row_mask:0xf bank_mask:0xf
    s_nop 1
    v_max_f32_dpp v20, v20, v20 row_ror:4 row_mask:0xf bank_mask:0xf
    s_nop 1
    v_max_f32_dpp v20, v20, v20 row_ror:8 row_mask:0xf bank_mask:0xf
    v_sub_f32 v18, v18, v20
    v_mul_f32 v18, 0x3fb8aa3b, v18
    v_exp_f32 v18, v18
    s_nop 0
    v_mul_f32 v21, v18, v19
    s_nop 1
    v_add_f32_dpp v21, v21, v21 quad_perm:[2,3,0,1] row_mask:0xf bank_mask:0xf
    s_nop 1
    v_add_f32_dpp v21, v21, v21 row_ror:4 row_mask:0xf bank_mask:0xf
    s_nop 1
    v_add_f32_dpp v21, v21, v21 row_ror:8 row_mask:0xf bank_mask:0xf
    s_mov_b64 exec, 3
    s_add_u32 s57, s60, 0x800000
    buffer_store_dwordx4 v[20:23], v2, s[36:39], s57 offen
    s_cmp_lg_u32 s0, 0
    s_nop 0
    s_cbranch_scc1 .nosl_177
    buffer_store_dwordx4 v[20:23], v2, s[36:39], s60 offen sc1
.nosl_177:
    s_mov_b64 exec, -1
.mlc_176:
    s_add_u32 s59, s59, s0
    s_memrealtime s[8:9]
    s_waitcnt vmcnt(8)
    s_waitcnt lgkmcnt(0)
    s_sub_u32 s8, s8, s30
    s_cmpk_ge_u32 s8, 1660
    s_cbranch_scc1 .ap_178
    s_waitcnt vmcnt(5)
    s_cmpk_ge_u32 s8, 1560
    s_cbranch_scc1 .ap_178
    s_waitcnt vmcnt(4)
    s_bitcmp1_b64 s[14:15], 46
    s_cbranch_scc0 1
    s_waitcnt vmcnt(2)
    s_cmpk_ge_u32 s8, 1440
    s_cbranch_scc1 .ap_178
    s_waitcnt vmcnt(1)
.ap_178:
    s_add_u32 s63, s69, 180224
    buffer_load_dwordx4 v[216:219], v1, s[44:47], s63 offen nt
    s_memrealtime s[8:9]
    s_waitcnt vmcnt(8)
    s_waitcnt lgkmcnt(0)
    s_sub_u32 s8, s8, s30
    s_cmpk_ge_u32 s8, 1692
    s_cbranch_scc1 .ap_179
    s_waitcnt vmcnt(5)
    s_cmpk_ge_u32 s8, 1592
    s_cbranch_scc1 .ap_179
    s_waitcnt vmcnt(4)
    s_bitcmp1_b64 s[14:15], 47
    s_cbranch_scc0 1
    s_waitcnt vmcnt(2)
    s_cmpk_ge_u32 s8, 1472
    s_cbranch_scc1 .ap_179
    s_waitcnt vmcnt(1)
.ap_179:
    s_add_u32 s63, s69, 188416
    buffer_load_dwordx4 v[220:223], v1, s[44:47], s63 offen nt
    s_and_b32 s56, s64, 0
    s_mul_i32 s56, s56, 18432
    s_mul_i32 s57, s3, 2304
    s_add_u32 s56, s56, s57
    s_add_u32 s56, s56, 0x37000
    buffer_load_dwordx4 v[32:35], v2, s[36:39], s56 offen offset:0 sc1
    buffer_load_dwordx4 v[40:43], v2, s[36:39], s56 offen offset:1024 sc1
    buffer_load_dwordx2 v[48:49], v5, s[36:39], s56 offen offset:0 sc1
    s_memrealtime s[8:9]
    s_waitcnt vmcnt(11)
    s_waitcnt lgkmcnt(0)
    s_sub_u32 s8, s8, s30
    s_cmpk_ge_u32 s8, 1724
    s_cbranch_scc1 .ap_180
    s_waitcnt vmcnt(8)
    s_cmpk_ge_u32 s8, 1624
    s_cbranch_scc1 .ap_180
    s_waitcnt vmcnt(7)
    s_bitcmp1_b64 s[14:15], 48
    s_cbranch_scc0 1
    s_waitcnt vmcnt(5)
    s_cmpk_ge_u32 s8, 1504
    s_cbranch_scc1 .ap_180
    s_branch .Lsk_b1_3
.Lst_b1_3:
    s_branch .Lrt_b1_3
.Lsk_b1_3:
    s_waitcnt vmcnt(4)
.ap_180:
    s_add_u32 s63, s69, 262144
    buffer_load_dwordx4 v[224:227], v1, s[44:47], s63 offen nt
    s_memrealtime s[8:9]
    s_waitcnt vmcnt(11)
    s_waitcnt lgkmcnt(0)
    s_sub_u32 s8, s8, s30
    s_cmpk_ge_u32 s8, 1756
    s_cbranch_scc1 .ap_181
    s_waitcnt vmcnt(8)
    s_cmpk_ge_u32 s8, 1656
    s_cbranch_scc1 .ap_181
    s_waitcnt vmcnt(7)
    s_bitcmp1_b64 s[14:15], 49
    s_cbranch_scc0 1
    s_waitcnt vmcnt(5)
    s_cmpk_ge_u32 s8, 1536
    s_cbranch_scc1 .ap_181
    s_waitcnt vmcnt(4)
.ap_181:
    s_add_u32 s63, s69, 270336
    buffer_load_dwordx4 v[228:231], v1, s[44:47], s63 offen nt
    s_and_b32 s56, s64, 0
    s_mul_i32 s56, s56, 18432
    s_mul_i32 s57, s3, 2304
    s_add_u32 s56, s56, s57
    s_add_u32 s56, s56, 0x49000
    buffer_load_dwordx4 v[56:59], v2, s[36:39], s56 offen offset:0 sc1
    buffer_load_dwordx4 v[64:67], v2, s[36:39], s56 offen offset:1024 sc1
    buffer_load_dwordx2 v[72:73], v5, s[36:39], s56 offen offset:0 sc1
    s_memrealtime s[8:9]
    s_waitcnt vmcnt(14)
    s_waitcnt lgkmcnt(0)
    s_sub_u32 s8, s8, s30
    s_cmpk_ge_u32 s8, 1788
    s_cbranch_scc1 .ap_182
    s_waitcnt vmcnt(11)
    s_cmpk_ge_u32 s8, 1688
    s_cbranch_scc1 .ap_182
    s_waitcnt vmcnt(10)
    s_bitcmp1_b64 s[14:15], 50
    s_cbranch_scc0 1
    s_waitcnt vmcnt(8)
    s_cmpk_ge_u32 s8, 1568
    s_cbranch_scc1 .ap_182
    s_waitcnt vmcnt(4)
.ap_182:
    s_add_u32 s63, s69, 278528
    buffer_load_dwordx4 v[232:235], v1, s[44:47], s63 offen nt
    s_memrealtime s[8:9]
    s_waitcnt vmcnt(14)
    s_waitcnt lgkmcnt(0)
    s_sub_u32 s8, s8, s30
    s_cmpk_ge_u32 s8, 1819
    s_cbranch_scc1 .ap_183
    s_waitcnt vmcnt(11)
    s_cmpk_ge_u32 s8, 1719
    s_cbranch_scc1 .ap_183
    s_waitcnt vmcnt(10)
    s_bitcmp1_b64 s[14:15], 51
    s_cbranch_scc0 1
    s_waitcnt vmcnt(5)
    s_cmpk_ge_u32 s8, 1599
    s_cbranch_scc1 .ap_183
    s_waitcnt vmcnt(4)
.ap_183:
    s_add_u32 s63, s69, 286720
    buffer_load_dwordx4 v[236:239], v1, s[44:47], s63 offen nt
    s_memrealtime s[8:9]
    s_waitcnt vmcnt(14)
    s_waitcnt lgkmcnt(0)
    s_sub_u32 s8, s8, s30
    s_cmpk_ge_u32 s8, 1851
    s_cbranch_scc1 .ap_184
    s_waitcnt vmcnt(11)
    s_cmpk_ge_u32 s8, 1751
    s_cbranch_scc1 .ap_184
    s_waitcnt vmcnt(10)
    s_bitcmp1_b64 s[14:15], 52
    s_cbranch_scc0 1
    s_waitcnt vmcnt(5)
    s_cmpk_ge_u32 s8, 1631
    s_cbranch_scc1 .ap_184
    s_waitcnt vmcnt(1)
.ap_184:
    s_add_u32 s63, s69, 294912
    buffer_load_dwordx4 v[240:243], v1, s[44:47], s63 offen nt
    s_memrealtime s[8:9]
    s_waitcnt vmcnt(14)
    s_waitcnt lgkmcnt(0)
    s_sub_u32 s8, s8, s30
    s_cmpk_ge_u32 s8, 1883
    s_cbranch_scc1 .ap_185
    s_waitcnt vmcnt(11)
    s_cmpk_ge_u32 s8, 1783
    s_cbranch_scc1 .ap_185
    s_waitcnt vmcnt(7)
    s_bitcmp1_b64 s[14:15], 53
    s_cbranch_scc0 1
    s_waitcnt vmcnt(2)
    s_cmpk_ge_u32 s8, 1663
    s_cbranch_scc1 .ap_185
    s_waitcnt vmcnt(1)
.ap_185:
    s_add_u32 s63, s69, 303104
    buffer_load_dwordx4 v[244:247], v1, s[44:47], s63 offen nt
    buffer_load_dwordx4 v[24:27], v9, s[36:39], s59 offen offset:0 sc1
    s_memrealtime s[8:9]
    s_waitcnt vmcnt(14)
    s_waitcnt lgkmcnt(0)
    s_sub_u32 s8, s8, s30
    s_cmpk_ge_u32 s8, 1915
    s_cbranch_scc1 .ap_186
    s_waitcnt vmcnt(8)
    s_cmpk_ge_u32 s8, 1815
    s_cbranch_scc1 .ap_186
    s_waitcnt vmcnt(4)
    s_bitcmp1_b64 s[14:15], 54
    s_cbranch_scc0 1
    s_waitcnt vmcnt(2)
    s_cmpk_ge_u32 s8, 1695
    s_cbranch_scc1 .ap_186
    s_waitcnt vmcnt(1)
.ap_186:
    s_add_u32 s63, s69, 311296
    buffer_load_dwordx4 v[248:251], v1, s[44:47], s63 offen nt
    s_memrealtime s[8:9]
    s_waitcnt vmcnt(14)
    s_waitcnt lgkmcnt(0)
    s_sub_u32 s8, s8, s30
    s_cmpk_ge_u32 s8, 1947
    s_cbranch_scc1 .ap_187
    s_waitcnt vmcnt(5)
    s_cmpk_ge_u32 s8, 1847
    s_cbranch_scc1 .ap_187
    s_waitcnt vmcnt(4)
    s_bitcmp1_b64 s[14:15], 55
    s_cbranch_scc0 1
    s_waitcnt vmcnt(2)
    s_cmpk_ge_u32 s8, 1727
    s_cbranch_scc1 .ap_187
    s_waitcnt vmcnt(1)
.ap_187:
    s_add_u32 s63, s69, 319488
    buffer_load_dwordx4 v[252:255], v1, s[44:47], s63 offen nt
    s_memrealtime s[8:9]
    s_waitcnt vmcnt(11)
    s_waitcnt lgkmcnt(0)
    s_sub_u32 s8, s8, s30
    s_cmpk_ge_u32 s8, 1978
    s_cbranch_scc1 .ap_188
    s_waitcnt vmcnt(5)
    s_cmpk_ge_u32 s8, 1878
    s_cbranch_scc1 .ap_188
    s_waitcnt vmcnt(4)
    s_bitcmp1_b64 s[14:15], 56
    s_cbranch_scc0 1
    s_waitcnt vmcnt(2)
    s_cmpk_ge_u32 s8, 1758
    s_cbranch_scc1 .ap_188
    s_waitcnt vmcnt(1)
.ap_188:
    s_add_u32 s63, s69, 393216
    buffer_load_dwordx4 v[36:39], v1, s[44:47], s63 offen nt
    s_memrealtime s[8:9]
    s_waitcnt vmcnt(11)
    s_waitcnt lgkmcnt(0)
    s_sub_u32 s8, s8, s30
    s_cmpk_ge_u32 s8, 2010
    s_cbranch_scc1 .ap_189
    s_waitcnt vmcnt(5)
    s_cmpk_ge_u32 s8, 1910
    s_cbranch_scc1 .ap_189
    s_waitcnt vmcnt(4)
    s_bitcmp1_b64 s[14:15], 57
    s_cbranch_scc0 1
    s_waitcnt vmcnt(2)
    s_cmpk_ge_u32 s8, 1790
    s_cbranch_scc1 .ap_189
    s_waitcnt vmcnt(1)
.ap_189:
    s_add_u32 s63, s69, 401408
    buffer_load_dwordx4 v[44:47], v1, s[44:47], s63 offen nt
    s_memrealtime s[8:9]
    s_waitcnt vmcnt(8)
    s_waitcnt lgkmcnt(0)
    s_sub_u32 s8, s8, s30
    s_cmpk_ge_u32 s8, 2042
    s_cbranch_scc1 .ap_190
    s_waitcnt vmcnt(5)
    s_cmpk_ge_u32 s8, 1942
    s_cbranch_scc1 .ap_190
    s_waitcnt vmcnt(4)
    s_bitcmp1_b64 s[14:15], 58
    s_cbranch_scc0 1
    s_waitcnt vmcnt(2)
    s_cmpk_ge_u32 s8, 1822
    s_cbranch_scc1 .ap_190
    s_waitcnt vmcnt(1)
.ap_190:
    s_add_u32 s63, s69, 409600
    buffer_load_dwordx4 v[52:55], v1, s[44:47], s63 offen nt
    s_waitcnt vmcnt(5)
    s_branch .gpc_192
.gp_191:
    s_xor_b32 s59, s59, 0x800000
    buffer_load_dwordx4 v[24:27], v9, s[36:39], s59 offen offset:0 sc1
    s_waitcnt vmcnt(0)
.gpc_192:
    v_cmp_eq_u32 vcc, s34, v26
    s_cmp_eq_u64 vcc, -1
    s_nop 3
    s_cbranch_scc1 .gpd_193
    s_sub_u32 s35, s35, 1
    s_cbranch_scc1 .Lexit
    s_sleep 1
    s_branch .gp_191
.gpd_193:
    v_mov_b32 v16, v24
    s_nop 1
    v_max_f32_dpp v16, v16, v16 row_ror:4 row_mask:0xf bank_mask:0xf
    v_sub_f32 v17, v24, v16
    v_sub_f32 v18, v14, v16
    v_mul_f32 v17, 0x3fb8aa3b, v17
    v_mul_f32 v18, 0x3fb8aa3b, v18
    v_exp_f32 v17, v17
    v_exp_f32 v18, v18
    v_mul_f32 v17, v17, v25
    s_nop 1
    v_add_f32_dpp v17, v17, v17 row_ror:4 row_mask:0xf bank_mask:0xf
    v_rcp_f32 v19, v17
    s_nop 0
    v_fma_f32 v15, -v17, v19, 1.0
    v_fma_f32 v19, v15, v19, v19
    s_branch .Lsk_b1_4
.Lst_b1_4:
    s_branch .Lrt_b1_4
.Lsk_b1_4:
    v_mul_f32 v18, v18, v19
    v_mul_f32 v10, v10, v18
    v_mul_f32 v11, v11, v18
    v_mul_f32 v12, v12, v18
    v_mul_f32 v13, v13, v18
    v_mov_b32_dpp v112, v10 quad_perm:[2,3,0,1] row_mask:0xf bank_mask:0xf
    v_mov_b32_dpp v113, v11 quad_perm:[2,3,0,1] row_mask:0xf bank_mask:0xf
    v_mov_b32_dpp v114, v12 quad_perm:[2,3,0,1] row_mask:0xf bank_mask:0xf
    v_mov_b32_dpp v115, v13 quad_perm:[2,3,0,1] row_mask:0xf bank_mask:0xf
    v_cvt_pk_bf16_f32 v96, v10, v112
    v_cvt_pk_bf16_f32 v100, v11, v113
    v_cvt_pk_bf16_f32 v104, v12, v114
    v_cvt_pk_bf16_f32 v108, v13, v115
    v_mov_b32_dpp v97, v96 row_ror:12 row_mask:0xf bank_mask:0xf
    v_mov_b32_dpp v101, v100 row_ror:12 row_mask:0xf bank_mask:0xf
    v_mov_b32_dpp v105, v104 row_ror:12 row_mask:0xf bank_mask:0xf
    v_mov_b32_dpp v109, v108 row_ror:12 row_mask:0xf bank_mask:0xf
    v_mov_b32_dpp v98, v96 row_ror:8 row_mask:0xf bank_mask:0xf
    v_mov_b32_dpp v102, v100 row_ror:8 row_mask:0xf bank_mask:0xf
    v_mov_b32_dpp v106, v104 row_ror:8 row_mask:0xf bank_mask:0xf
    v_mov_b32_dpp v110, v108 row_ror:8 row_mask:0xf bank_mask:0xf
    v_mov_b32_dpp v99, v96 row_ror:4 row_mask:0xf bank_mask:0xf
    v_mov_b32_dpp v103, v100 row_ror:4 row_mask:0xf bank_mask:0xf
    v_mov_b32_dpp v107, v104 row_ror:4 row_mask:0xf bank_mask:0xf
    v_mov_b32_dpp v111, v108 row_ror:4 row_mask:0xf bank_mask:0xf
    s_lshl_b32 s60, s3, 10
    s_add_u32 s60, s60, 147456
    v_lshlrev_b32 v10, 5, v0
    v_add_u32 v10, s60, v10
    s_memrealtime s[8:9]
    s_waitcnt lgkmcnt(0)
    s_sub_u32 s8, s8, s30
    s_cmpk_ge_u32 s8, 2074
    s_cbranch_scc1 .ap_194
    s_waitcnt vmcnt(5)
    s_cmpk_ge_u32 s8, 1974
    s_cbranch_scc1 .ap_194
    s_waitcnt vmcnt(4)
    s_bitcmp1_b64 s[14:15], 59
    s_cbranch_scc0 1
    s_waitcnt vmcnt(2)
    s_cmpk_ge_u32 s8, 1854
    s_cbranch_scc1 .ap_194
    s_waitcnt vmcnt(1)
.ap_194:
    s_add_u32 s63, s69, 417792
    buffer_load_dwordx4 v[60:63], v1, s[44:47], s63 offen nt
    v_perm_b32 v112, v164, v160, s94
    v_perm_b32 v113, v172, v168, s94
    v_perm_b32 v114, v180, v176, s94
    v_perm_b32 v115, v188, v184, s94
    s_nop 1
    v_mfma_f32_16x16x32_bf16 v[128:131], v[96:99], v[112:115], 0
    v_perm_b32 v116, v164, v160, s95
    v_perm_b32 v117, v172, v168, s95
    v_perm_b32 v118, v180, v176, s95
    v_perm_b32 v119, v188, v184, s95
    s_nop 1
    v_mfma_f32_16x16x32_bf16 v[132:135], v[96:99], v[116:119], 0
    v_perm_b32 v120, v165, v161, s94
    v_perm_b32 v121, v173, v169, s94
    v_perm_b32 v122, v181, v177, s94
    v_perm_b32 v123, v189, v185, s94
    s_nop 1
    v_mfma_f32_16x16x32_bf16 v[136:139], v[96:99], v[120:123], 0
    v_perm_b32 v124, v165, v161, s95
    v_perm_b32 v125, v173, v169, s95
    v_perm_b32 v126, v181, v177, s95
    v_perm_b32 v127, v189, v185, s95
    s_nop 1
    v_mfma_f32_16x16x32_bf16 v[140:143], v[96:99], v[124:127], 0
    v_perm_b32 v112, v166, v162, s94
    v_perm_b32 v113, v174, v170, s94
    v_perm_b32 v114, v182, v178, s94
    v_perm_b32 v115, v190, v186, s94
    s_nop 1
    v_mfma_f32_16x16x32_bf16 v[144:147], v[96:99], v[112:115], 0
    v_perm_b32 v116, v166, v162, s95
    v_perm_b32 v117, v174, v170, s95
    v_perm_b32 v118, v182, v178, s95
    v_perm_b32 v119, v190, v186, s95
    s_nop 1
    v_mfma_f32_16x16x32_bf16 v[148:151], v[96:99], v[116:119], 0
    v_perm_b32 v120, v167, v163, s94
    v_perm_b32 v121, v175, v171, s94
    v_perm_b32 v122, v183, v179, s94
    v_perm_b32 v123, v191, v187, s94
    s_nop 1
    v_mfma_f32_16x16x32_bf16 v[152:155], v[96:99], v[120:123], 0
    v_perm_b32 v124, v167, v163, s95
    v_perm_b32 v125, v175, v171, s95
    v_perm_b32 v126, v183, v179, s95
    v_perm_b32 v127, v191, v187, s95
    s_nop 1
    v_mfma_f32_16x16x32_bf16 v[156:159], v[96:99], v[124:127], 0
    s_memrealtime s[8:9]
    s_waitcnt lgkmcnt(0)
    s_sub_u32 s8, s8, s30
    s_cmpk_ge_u32 s8, 2106
    s_nop 3
    s_cbranch_scc1 .ap_195
    s_waitcnt vmcnt(5)
    s_cmpk_ge_u32 s8, 2006
    s_cbranch_scc1 .ap_195
    s_waitcnt vmcnt(4)
    s_bitcmp1_b64 s[14:15], 60
    s_cbranch_scc0 1
    s_waitcnt vmcnt(2)
    s_cmpk_ge_u32 s8, 1886
    s_cbranch_scc1 .ap_195
    s_waitcnt vmcnt(1)
.ap_195:
    s_add_u32 s63, s69, 425984
    buffer_load_dwordx4 v[68:71], v1, s[44:47], s63 offen nt
    v_perm_b32 v112, v196, v192, s94
    v_perm_b32 v113, v204, v200, s94
    v_perm_b32 v114, v212, v208, s94
    v_perm_b32 v115, v220, v216, s94
    s_nop 1
    v_mfma_f32_16x16x32_bf16 v[128:131], v[100:103], v[112:115], v[128:131]
    v_perm_b32 v116, v196, v192, s95
    v_perm_b32 v117, v204, v200, s95
    v_perm_b32 v118, v212, v208, s95
    v_perm_b32 v119, v220, v216, s95
    s_nop 1
    v_mfma_f32_16x16x32_bf16 v[132:135], v[100:103], v[116:119], v[132:135]
    v_perm_b32 v120, v197, v193, s94
    v_perm_b32 v121, v205, v201, s94
    v_perm_b32 v122, v213, v209, s94
    v_perm_b32 v123, v221, v217, s94
    s_nop 1
    v_mfma_f32_16x16x32_bf16 v[136:139], v[100:103], v[120:123], v[136:139]
    v_perm_b32 v124, v197, v193, s95
    v_perm_b32 v125, v205, v201, s95
    v_perm_b32 v126, v213, v209, s95
    v_perm_b32 v127, v221, v217, s95
    s_nop 1
    v_mfma_f32_16x16x32_bf16 v[140:143], v[100:103], v[124:127], v[140:143]
    v_perm_b32 v112, v198, v194, s94
    v_perm_b32 v113, v206, v202, s94
    v_perm_b32 v114, v214, v210, s94
    v_perm_b32 v115, v222, v218, s94
    s_nop 1
    v_mfma_f32_16x16x32_bf16 v[144:147], v[100:103], v[112:115], v[144:147]
    v_perm_b32 v116, v198, v194, s95
    v_perm_b32 v117, v206, v202, s95
    v_perm_b32 v118, v214, v210, s95
    v_perm_b32 v119, v222, v218, s95
    s_nop 1
    v_mfma_f32_16x16x32_bf16 v[148:151], v[100:103], v[116:119], v[148:151]
    v_perm_b32 v120, v199, v195, s94
    v_perm_b32 v121, v207, v203, s94
    v_perm_b32 v122, v215, v211, s94
    v_perm_b32 v123, v223, v219, s94
    s_nop 1
    v_mfma_f32_16x16x32_bf16 v[152:155], v[100:103], v[120:123], v[152:155]
    v_perm_b32 v124, v199, v195, s95
    v_perm_b32 v125, v207, v203, s95
    v_perm_b32 v126, v215, v211, s95
    v_perm_b32 v127, v223, v219, s95
    s_nop 1
    v_mfma_f32_16x16x32_bf16 v[156:159], v[100:103], v[124:127], v[156:159]
    s_memrealtime s[8:9]
    s_waitcnt lgkmcnt(0)
    s_sub_u32 s8, s8, s30
    s_cmpk_ge_u32 s8, 2137
    s_nop 3
    s_cbranch_scc1 .ap_196
    s_branch .Lsk_b1_5
.Lst_b1_5:
    s_branch .Lrt_b1_5
.Lsk_b1_5:
    s_waitcnt vmcnt(5)
    s_cmpk_ge_u32 s8, 2037
    s_cbranch_scc1 .ap_196
    s_waitcnt vmcnt(4)
    s_bitcmp1_b64 s[14:15], 61
    s_cbranch_scc0 1
    s_waitcnt vmcnt(2)
    s_cmpk_ge_u32 s8, 1917
    s_cbranch_scc1 .ap_196
    s_waitcnt vmcnt(1)
.ap_196:
    s_add_u32 s63, s69, 434176
    buffer_load_dwordx4 v[76:79], v1, s[44:47], s63 offen nt
    s_waitcnt vmcnt(6)
    v_perm_b32 v112, v228, v224, s94
    v_perm_b32 v113, v236, v232, s94
    v_perm_b32 v114, v244, v240, s94
    v_perm_b32 v115, v252, v248, s94
    s_nop 1
    v_mfma_f32_16x16x32_bf16 v[128:131], v[104:107], v[112:115], v[128:131]
    v_perm_b32 v116, v228, v224, s95
    v_perm_b32 v117, v236, v232, s95
    v_perm_b32 v118, v244, v240, s95
    v_perm_b32 v119, v252, v248, s95
    s_nop 1
    v_mfma_f32_16x16x32_bf16 v[132:135], v[104:107], v[116:119], v[132:135]
    v_perm_b32 v120, v229, v225, s94
    v_perm_b32 v121, v237, v233, s94
    v_perm_b32 v122, v245, v241, s94
    v_perm_b32 v123, v253, v249, s94
    s_nop 1
    v_mfma_f32_16x16x32_bf16 v[136:139], v[104:107], v[120:123], v[136:139]
    v_perm_b32 v124, v229, v225, s95
    v_perm_b32 v125, v237, v233, s95
    v_perm_b32 v126, v245, v241, s95
    v_perm_b32 v127, v253, v249, s95
    s_nop 1
    v_mfma_f32_16x16x32_bf16 v[140:143], v[104:107], v[124:127], v[140:143]
    v_perm_b32 v112, v230, v226, s94
    v_perm_b32 v113, v238, v234, s94
    v_perm_b32 v114, v246, v242, s94
    v_perm_b32 v115, v254, v250, s94
    s_nop 1
    v_mfma_f32_16x16x32_bf16 v[144:147], v[104:107], v[112:115], v[144:147]
    v_perm_b32 v116, v230, v226, s95
    v_perm_b32 v117, v238, v234, s95
    v_perm_b32 v118, v246, v242, s95
    v_perm_b32 v119, v254, v250, s95
    s_nop 1
    v_mfma_f32_16x16x32_bf16 v[148:151], v[104:107], v[116:119], v[148:151]
    v_perm_b32 v120, v231, v227, s94
    v_perm_b32 v121, v239, v235, s94
    v_perm_b32 v122, v247, v243, s94
    v_perm_b32 v123, v255, v251, s94
    s_nop 1
    v_mfma_f32_16x16x32_bf16 v[152:155], v[104:107], v[120:123], v[152:155]
    v_perm_b32 v124, v231, v227, s95
    v_perm_b32 v125, v239, v235, s95
    v_perm_b32 v126, v247, v243, s95
    v_perm_b32 v127, v255, v251, s95
    s_nop 1
    v_mfma_f32_16x16x32_bf16 v[156:159], v[104:107], v[124:127], v[156:159]
    s_memrealtime s[8:9]
    s_waitcnt lgkmcnt(0)
    s_sub_u32 s8, s8, s30
    s_cmpk_ge_u32 s8, 2169
    s_nop 3
    s_cbranch_scc1 .ap_197
    s_waitcnt vmcnt(5)
    s_cmpk_ge_u32 s8, 2069
    s_cbranch_scc1 .ap_197
    s_waitcnt vmcnt(4)
    s_bitcmp1_b64 s[14:15], 62
    s_cbranch_scc0 1
    s_waitcnt vmcnt(2)
    s_cmpk_ge_u32 s8, 1949
    s_cbranch_scc1 .ap_197
    s_waitcnt vmcnt(1)
.ap_197:
    s_add_u32 s63, s69, 442368
    buffer_load_dwordx4 v[84:87], v1, s[44:47], s63 offen nt
    s_memrealtime s[8:9]
    s_waitcnt lgkmcnt(0)
    s_sub_u32 s8, s8, s30
    s_cmpk_ge_u32 s8, 2201
    s_cbranch_scc1 .ap_198
    s_waitcnt vmcnt(5)
    s_cmpk_ge_u32 s8, 2101
    s_cbranch_scc1 .ap_198
    s_waitcnt vmcnt(4)
    s_bitcmp1_b64 s[14:15], 63
    s_cbranch_scc0 1
    s_waitcnt vmcnt(2)
    s_cmpk_ge_u32 s8, 1981
    s_cbranch_scc1 .ap_198
    s_waitcnt vmcnt(1)
.ap_198:
    s_add_u32 s63, s69, 450560
    buffer_load_dwordx4 v[92:95], v1, s[44:47], s63 offen nt
    s_setprio 0
    s_waitcnt vmcnt(6)
    v_perm_b32 v160, v44, v36, s94
    v_perm_b32 v164, v44, v36, s95
    v_perm_b32 v168, v45, v37, s94
    v_perm_b32 v172, v45, v37, s95
    v_perm_b32 v176, v46, v38, s94
    v_perm_b32 v180, v46, v38, s95
    v_perm_b32 v184, v47, v39, s94
    v_perm_b32 v188, v47, v39, s95
    s_waitcnt vmcnt(4)
    v_perm_b32 v161, v60, v52, s94
    v_perm_b32 v165, v60, v52, s95
    v_perm_b32 v169, v61, v53, s94
    v_perm_b32 v173, v61, v53, s95
    v_perm_b32 v177, v62, v54, s94
    v_perm_b32 v181, v62, v54, s95
    v_perm_b32 v185, v63, v55, s94
    v_perm_b32 v189, v63, v55, s95
    s_waitcnt vmcnt(2)
    v_perm_b32 v162, v76, v68, s94
    v_perm_b32 v166, v76, v68, s95
    v_perm_b32 v170, v77, v69, s94
    v_perm_b32 v174, v77, v69, s95
    v_perm_b32 v178, v78, v70, s94
    v_perm_b32 v182, v78, v70, s95
    v_perm_b32 v186, v79, v71, s94
    v_perm_b32 v190, v79, v71, s95
    s_branch .Lsk_b1_6
    .fill 6, 4, 0xbf800000
.Lst_b1_6:
    s_branch .Lrt_b1_6
.Lsk_b1_6:
    s_waitcnt vmcnt(0)
    s_add_u32 m0, s101, 90112
    s_add_u32 s56, s100, 1179648
    buffer_load_dwordx4 v6, s[52:55], s56 offen nt lds
    s_add_u32 m0, s101, 98304
    s_add_u32 s56, s100, 1769472
    buffer_load_dwordx4 v6, s[52:55], s56 offen nt lds
    s_add_u32 m0, s101, 106496
    s_add_u32 s56, s100, 2359296
    buffer_load_dwordx4 v6, s[52:55], s56 offen nt lds
    s_add_u32 m0, s101, 114688
    s_add_u32 s56, s100, 2949120
    buffer_load_dwordx4 v6, s[52:55], s56 offen nt lds
    v_perm_b32 v163, v92, v84, s94
    v_perm_b32 v167, v92, v84, s95
    v_perm_b32 v171, v93, v85, s94
    v_mfma_f32_16x16x32_bf16 v[128:131], v[108:111], v[160:163], v[128:131]
    v_perm_b32 v175, v93, v85, s95
    v_mfma_f32_16x16x32_bf16 v[132:135], v[108:111], v[164:167], v[132:135]
    v_perm_b32 v179, v94, v86, s94
    v_mfma_f32_16x16x32_bf16 v[136:139], v[108:111], v[168:171], v[136:139]
    v_perm_b32 v183, v94, v86, s95
    v_mfma_f32_16x16x32_bf16 v[140:143], v[108:111], v[172:175], v[140:143]
    v_perm_b32 v187, v95, v87, s94
    v_mfma_f32_16x16x32_bf16 v[144:147], v[108:111], v[176:179], v[144:147]
    v_perm_b32 v191, v95, v87, s95
    v_mfma_f32_16x16x32_bf16 v[148:151], v[108:111], v[180:183], v[148:151]
    v_mfma_f32_16x16x32_bf16 v[152:155], v[108:111], v[184:187], v[152:155]
    v_mfma_f32_16x16x32_bf16 v[156:159], v[108:111], v[188:191], v[156:159]
    s_mov_b64 exec, 0xffff
    ds_write2_b32 v10, v128, v129 offset0:0 offset1:128
    ds_write2_b32 v10, v132, v133 offset0:1 offset1:129
    ds_write2_b32 v10, v136, v137 offset0:2 offset1:130
    ds_write2_b32 v10, v140, v141 offset0:3 offset1:131
    ds_write2_b32 v10, v144, v145 offset0:4 offset1:132
    ds_write2_b32 v10, v148, v149 offset0:5 offset1:133
    ds_write2_b32 v10, v152, v153 offset0:6 offset1:134
    ds_write2_b32 v10, v156, v157 offset0:7 offset1:135
    s_mov_b64 exec, -1
    s_waitcnt lgkmcnt(0)
    s_barrier
    s_cmp_lg_u32 s3, 7
    s_cbranch_scc1 .opub_199
    v_add_u32 v10, 147456, v2
    ds_read_b128 v[196:199], v10 offset:0
    ds_read_b128 v[200:203], v10 offset:1024
    ds_read_b128 v[204:207], v10 offset:2048
    ds_read_b128 v[208:211], v10 offset:3072
    ds_read_b128 v[212:215], v10 offset:4096
    ds_read_b128 v[216:219], v10 offset:5120
    ds_read_b128 v[220:223], v10 offset:6144
    ds_read_b128 v[224:227], v10 offset:7168
    v_lshrrev_b32 v11, 5, v0
    v_lshlrev_b32 v11, 13, v11
    v_and_b32 v12, 31, v0
    v_lshl_add_u32 v11, v12, 4, v11
    s_lshl4_add_u32 s56, s67, s66
    s_lshl1_add_u32 s56, s56, s68
    s_lshl_b32 s56, s56, 9
    s_add_u32 s56, s56, 0xa0000
    s_mov_b32 s60, 0x07060503
    s_mov_b32 s61, 0x07060502
    s_mov_b32 s62, 0x07060501
    v_mov_b32 v15, s34
    s_waitcnt lgkmcnt(6)
    v_pk_add_f32 v[196:197], v[196:197], v[200:201]
    v_pk_add_f32 v[198:199], v[198:199], v[202:203]
    s_waitcnt lgkmcnt(5)
    v_pk_add_f32 v[196:197], v[196:197], v[204:205]
    v_pk_add_f32 v[198:199], v[198:199], v[206:207]
    s_waitcnt lgkmcnt(4)
    v_pk_add_f32 v[196:197], v[196:197], v[208:209]
    v_pk_add_f32 v[198:199], v[198:199], v[210:211]
    s_waitcnt lgkmcnt(3)
    v_pk_add_f32 v[196:197], v[196:197], v[212:213]
    v_pk_add_f32 v[198:199], v[198:199], v[214:215]
    s_waitcnt lgkmcnt(2)
    v_pk_add_f32 v[196:197], v[196:197], v[216:217]
    v_pk_add_f32 v[198:199], v[198:199], v[218:219]
    s_waitcnt lgkmcnt(1)
    v_pk_add_f32 v[196:197], v[196:197], v[220:221]
    v_pk_add_f32 v[198:199], v[198:199], v[222:223]
    s_waitcnt lgkmcnt(0)
    v_pk_add_f32 v[196:197], v[196:197], v[224:225]
    v_pk_add_f32 v[198:199], v[198:199], v[226:227]
    v_perm_b32 v12, v196, v199, s60
    v_perm_b32 v13, v197, v199, s61
    v_perm_b32 v14, v198, v199, s62
    s_add_u32 s57, s56, 0x800000
    buffer_store_dwordx4 v[12:15], v11, s[36:39], s57 offen
    s_cmp_lg_u32 s0, 0
    s_nop 0
    s_cbranch_scc1 .nosl_200
    buffer_store_dwordx4 v[12:15], v11, s[36:39], s56 offen sc1
.nosl_200:
.opub_199:
    s_mov_b32 s61, s101
    v_lshrrev_b32 v25, 4, v0
    v_bfe_u32 v26, v0, 1, 1
    v_lshl_add_u32 v25, v25, 1, v26
    v_bfe_u32 v26, v0, 2, 2
    v_lshl_add_u32 v19, v25, 3, v26
    v_lshlrev_b32 v19, 7, v19
    v_and_b32 v25, 3, v25
    v_lshrrev_b32 v26, 1, v26
    v_lshl_add_u32 v25, v25, 1, v26
    v_xor_b32 v25, s3, v25
    v_lshl_add_u32 v19, v25, 4, v19
    v_and_b32 v25, 1, v0
    v_lshl_add_u32 v19, v25, 3, v19
    v_add_u32 v20, 32768, v19
    ds_read_b64_tr_b16 v[160:161], v19 offset:0
    ds_read_b64_tr_b16 v[162:163], v19 offset:512
    ds_read_b64_tr_b16 v[168:169], v19 offset:8192
    ds_read_b64_tr_b16 v[170:171], v19 offset:8704
    ds_read_b64_tr_b16 v[176:177], v19 offset:16384
    ds_read_b64_tr_b16 v[178:179], v19 offset:16896
    ds_read_b64_tr_b16 v[184:185], v19 offset:24576
    ds_read_b64_tr_b16 v[186:187], v19 offset:25088
    ds_read_b64_tr_b16 v[192:193], v20 offset:0
    ds_read_b64_tr_b16 v[194:195], v20 offset:512
    ds_read_b64_tr_b16 v[200:201], v20 offset:8192
    ds_read_b64_tr_b16 v[202:203], v20 offset:8704
    ds_read_b64_tr_b16 v[208:209], v20 offset:16384
    ds_read_b64_tr_b16 v[210:211], v20 offset:16896
    ds_read_b64_tr_b16 v[216:217], v20 offset:24576
    ds_read_b64_tr_b16 v[218:219], v20 offset:25088
    ds_read_b64_tr_b16 v[224:225], v20 offset:32768
    ds_read_b64_tr_b16 v[226:227], v20 offset:33280
    v_add_u32 v19, 73728, v19
    v_add_u32 v20, 73728, v20
    s_mov_b32 s48, s22
    s_and_b32 s49, s23, 0xffff
    s_mov_b32 s50, 0x510000
    s_mov_b32 s51, 0x00020000
    s_mul_i32 s69, s99, 73728
    s_mul_i32 s56, s3, 9216
    s_add_u32 s69, s69, s56
    v_bfe_u32 v25, v0, 4, 1
    s_and_b32 s56, s3, 1
    s_lshl_b32 s56, s56, 2
    v_lshl_or_b32 v25, v25, 1, s56
    v_and_b32 v26, 7, v0
    v_xor_b32 v25, v25, v26
    v_lshrrev_b32 v26, 3, v0
    v_mul_u32_u24 v26, 1152, v26
    v_lshl_add_u32 v24, v25, 4, v26
    s_and_b32 s58, s64, 0
    s_mul_i32 s58, s58, 18432
    s_mul_i32 s59, s3, 2304
    s_add_u32 s58, s58, s59
    s_add_u32 s62, s58, 0x37000
    s_add_u32 s63, s58, 0x49000
    s_mul_i32 s101, s64, 18432
    s_add_u32 s101, s101, s59
    s_add_u32 s101, s101, 0x170000
    s_waitcnt lgkmcnt(0)
    s_barrier
    s_branch .Lsk_b1_7
.Lst_b1_7:
    s_branch .Lrt_b1_7
.Lsk_b1_7:
    s_add_u32 m0, s61, 122880
    s_add_u32 s56, s100, 3538944
    buffer_load_dwordx4 v6, s[52:55], s56 offen nt lds
    s_add_u32 m0, s61, 131072
    s_add_u32 s56, s100, 4128768
    buffer_load_dwordx4 v6, s[52:55], s56 offen nt lds
    s_add_u32 m0, s61, 139264
    s_add_u32 s56, s100, 4718592
    buffer_load_dwordx4 v6, s[52:55], s56 offen nt lds
    s_add_u32 m0, s61, 0
    s_nop 0
    buffer_load_dwordx4 v24, s[48:51], s69 offen offset:0 nt lds
    s_add_u32 m0, s61, 8064
    s_nop 0
    buffer_load_dwordx4 v24, s[48:51], s69 offen offset:128 nt lds
    s_add_u32 m0, s61, 16128
    s_nop 0
    buffer_load_dwordx4 v24, s[48:51], s69 offen offset:256 nt lds
    s_add_u32 m0, s61, 24192
    s_nop 0
    buffer_load_dwordx4 v24, s[48:51], s69 offen offset:384 nt lds
    s_add_u32 m0, s61, 32256
    s_nop 0
    buffer_load_dwordx4 v24, s[48:51], s69 offen offset:512 nt lds
    s_add_u32 m0, s61, 40320
    s_nop 0
    buffer_load_dwordx4 v24, s[48:51], s69 offen offset:640 nt lds
    s_add_u32 m0, s61, 48384
    s_nop 0
    buffer_load_dwordx4 v24, s[48:51], s69 offen offset:768 nt lds
    s_add_u32 m0, s61, 56448
    s_nop 0
    buffer_load_dwordx4 v24, s[48:51], s69 offen offset:896 nt lds
    s_add_u32 m0, s61, 64512
    s_nop 0
    buffer_load_dwordx4 v24, s[48:51], s69 offen offset:1024 nt lds
    v_bfe_u32 v16, v0, 1, 3
    v_mul_u32_u24 v16, 1312, v16
    v_lshrrev_b32 v25, 4, v0
    v_lshl_add_u32 v16, v25, 5, v16
    v_and_b32 v25, 1, v0
    v_lshl_add_u32 v16, v25, 4, v16
    v_add_u32 v16, 147456, v16
    s_mul_i32 s56, s3, 1312
    s_add_u32 s56, s56, 147456
    v_add_u32 v17, s56, v3
    v_add_u32 v18, s56, v4
    v_bfe_u32 v21, v0, 1, 3
    v_mul_u32_u24 v21, 144, v21
    v_bfe_u32 v25, v0, 4, 1
    v_lshl_add_u32 v21, v25, 3, v21
    v_lshrrev_b32 v25, 5, v0
    v_lshl_add_u32 v21, v25, 2, v21
    v_and_b32 v25, 1, v0
    v_lshl_add_u32 v21, v25, 1, v21
    s_lshl_b32 s56, s3, 4
    s_add_u32 s56, s56, 157952
    v_add_u32 v21, s56, v21
    v_and_b32 v22, 15, v0
    v_lshlrev_b32 v22, 3, v22
    s_mul_i32 s56, s3, 144
    s_add_u32 s56, s56, 157952
    v_add_u32 v22, s56, v22
    s_mul_i32 s56, s3, 1312
    s_add_u32 s56, s56, 147456
    v_mov_b32 v17, s56
    v_bfe_u32 v25, v0, 4, 2
    v_lshl_add_u32 v17, v25, 7, v17
    v_bfe_u32 v25, v0, 1, 1
    v_lshl_add_u32 v17, v25, 6, v17
    v_bfe_u32 v25, v0, 3, 1
    v_lshl_add_u32 v17, v25, 5, v17
    v_bfe_u32 v25, v0, 2, 1
    v_lshl_add_u32 v17, v25, 3, v17
    v_bfe_u32 v25, v0, 0, 1
    v_lshl_add_u32 v17, v25, 2, v17
    s_add_u32 s56, s56, 1024
    v_mov_b32 v18, s56
    v_bfe_u32 v25, v0, 2, 1
    v_lshl_add_u32 v18, v25, 6, v18
    v_bfe_u32 v25, v0, 4, 1
    v_lshl_add_u32 v18, v25, 5, v18
    v_bfe_u32 v25, v0, 0, 1
    v_lshl_add_u32 v18, v25, 4, v18
    v_bfe_u32 v25, v0, 3, 1
    v_lshl_add_u32 v18, v25, 3, v18
    v_bfe_u32 v25, v0, 1, 1
    v_lshl_add_u32 v18, v25, 2, v18
    v_lshrrev_b32 v25, 3, v0
    v_mul_u32_u24 v21, 144, v25
    v_and_b32 v25, 7, v0
    v_lshl_add_u32 v21, v25, 1, v21
    s_lshl_b32 s56, s3, 4
    v_lshrrev_b32 v25, 3, v0
    v_mul_u32_u24 v26, 144, v25
    v_mov_b32 v21, v26
    v_bfe_u32 v25, v0, 1, 1
    v_lshl_add_u32 v21, v25, 4, v21
    v_bfe_u32 v25, v0, 2, 1
    v_lshl_add_u32 v21, v25, 2, v21
    v_bfe_u32 v25, v0, 0, 1
    v_lshl_add_u32 v21, v25, 1, v21
    s_and_b32 s57, s3, 1
    s_lshl_b32 s57, s57, 3
    s_sub_u32 s56, s56, s57
    s_add_u32 s56, s56, 157952
    v_add_u32 v21, s56, v21
    v_mov_b32 v156, 0x4444
    v_mov_b32 v25, 0xeeee
    v_cndmask_b32 v156, v156, v25, s[96:97]
    v_mov_b32 v152, 0
    v_mov_b32 v153, 0
    v_mov_b32 v154, 0
    v_mov_b32 v155, 0
    v_mov_b32 v232, 0
    v_mov_b32 v233, 0
    v_mov_b32 v234, 0
    v_mov_b32 v235, 0
    v_mov_b32 v236, 0
    v_mov_b32 v237, 0
    v_mov_b32 v238, 0
    v_mov_b32 v239, 0
    v_mov_b32 v240, 0
    v_mov_b32 v241, 0
    v_mov_b32 v242, 0
    v_mov_b32 v243, 0
    v_mov_b32 v244, 0
    v_mov_b32 v245, 0
    v_mov_b32 v246, 0
    v_mov_b32 v247, 0
    v_mov_b32 v248, 0
    v_mov_b32 v249, 0
    v_mov_b32 v250, 0
    v_mov_b32 v251, 0
    v_mov_b32 v252, 0
    v_mov_b32 v253, 0
    v_mov_b32 v254, 0
    v_mov_b32 v255, 0
    s_mov_b32 s56, 157952
    v_bfe_u32 v22, v0, 1, 3
    v_mul_u32_u24 v22, 144, v22
    v_and_b32 v25, 48, v0
    v_lshl_add_u32 v22, v25, 1, v22
    v_and_b32 v25, 1, v0
    v_lshlrev_b32 v25, 4, v25
    v_add3_u32 v22, v22, v25, s56
    v_lshrrev_b32 v23, 4, v0
    v_and_b32 v25, 1, v0
    v_lshl_add_u32 v23, v23, 1, v25
    v_mul_u32_u24 v23, 9216, v23
    v_bfe_u32 v25, v0, 1, 3
    v_lshl_add_u32 v23, v25, 4, v23
    v_lshrrev_b32 v25, 4, v0
    v_bfe_u32 v26, v0, 2, 2
    v_lshl_add_u32 v28, v25, 3, v26
    v_lshlrev_b32 v28, 7, v28
    v_and_b32 v25, 1, v25
    v_lshrrev_b32 v26, 1, v26
    v_lshl_add_u32 v25, v25, 1, v26
    s_and_b32 s56, s3, 1
    s_lshl_b32 s56, s56, 1
    v_xor_b32 v25, s56, v25
    v_and_b32 v26, 3, v0
    v_lshl_add_u32 v28, v26, 3, v28
    s_lshr_b32 s56, s3, 1
    s_lshl_b32 s56, s56, 13
    v_add_u32 v28, s56, v28
    v_xor_b32 v26, 1, v25
    v_lshl_add_u32 v29, v26, 5, v28
    v_lshl_add_u32 v28, v25, 5, v28
    v_add_u32 v30, 0x10000, v28
    v_add_u32 v31, 0x10000, v29
    s_mul_i32 s59, s3, 73728
    s_lshl_b32 s56, s99, 7
    s_branch .Lsk_b2_0
.Lst_b2_0:
    s_branch .Lrt_b2_0
.Lsk_b2_0:
    s_add_u32 s59, s59, s56
    s_add_u32 s59, s59, 0x1a0000
    s_add_u32 s99, s59, 589824
    s_add_u32 s100, s59, 1179648
    s_branch .gpc_202
.gp_201:
    buffer_load_dwordx4 v[32:35], v2, s[36:39], s62 offen offset:0 sc1
    buffer_load_dwordx4 v[40:43], v2, s[36:39], s62 offen offset:1024 sc1
    buffer_load_dwordx2 v[48:49], v5, s[36:39], s62 offen offset:0 sc1
    buffer_load_dwordx4 v[56:59], v2, s[36:39], s63 offen offset:0 sc1
    buffer_load_dwordx4 v[64:67], v2, s[36:39], s63 offen offset:1024 sc1
    buffer_load_dwordx2 v[72:73], v5, s[36:39], s63 offen offset:0 sc1
    s_waitcnt vmcnt(0)
.gpc_202:
    v_min_u32 v25, v33, v35
    v_max_u32 v26, v33, v35
    v_min3_u32 v25, v25, v41, v43
    v_max3_u32 v26, v26, v41, v43
    v_min3_u32 v25, v25, v49, v57
    v_max3_u32 v26, v26, v49, v57
    v_min3_u32 v25, v25, v59, v65
    v_max3_u32 v26, v26, v59, v65
    v_min3_u32 v25, v25, v67, v73
    v_max3_u32 v26, v26, v67, v73
    v_cmp_eq_u32 vcc, s34, v25
    v_cmp_eq_u32 s[56:57], s34, v26
    s_and_b64 vcc, vcc, s[56:57]
    s_cmp_eq_u64 vcc, -1
    s_nop 2
    s_cbranch_scc1 .gpd_203
    s_sub_u32 s35, s35, 1
    s_cbranch_scc1 .Lexit
    s_sleep 2
    s_branch .gp_201
.gpd_203:
    v_lshlrev_b32 v78, 16, v32
    v_and_b32 v79, 0xffff0000, v32
    v_lshlrev_b32 v88, 16, v56
    v_and_b32 v89, 0xffff0000, v56
    v_lshlrev_b32 v80, 16, v34
    v_and_b32 v81, 0xffff0000, v34
    v_lshlrev_b32 v90, 16, v58
    v_and_b32 v91, 0xffff0000, v58
    v_lshlrev_b32 v82, 16, v40
    v_and_b32 v83, 0xffff0000, v40
    v_lshlrev_b32 v92, 16, v64
    v_and_b32 v93, 0xffff0000, v64
    v_lshlrev_b32 v84, 16, v42
    v_and_b32 v85, 0xffff0000, v42
    v_lshlrev_b32 v94, 16, v66
    v_and_b32 v95, 0xffff0000, v66
    v_lshlrev_b32 v86, 16, v48
    v_and_b32 v87, 0xffff0000, v48
    v_lshlrev_b32 v96, 16, v72
    v_and_b32 v97, 0xffff0000, v72
    s_waitcnt vmcnt(9)
    s_barrier
    ds_read_b64_tr_b16 v[164:165], v19 offset:0
    ds_read_b64_tr_b16 v[166:167], v19 offset:512
    ds_read_b64_tr_b16 v[172:173], v19 offset:8192
    ds_read_b64_tr_b16 v[174:175], v19 offset:8704
    ds_read_b64_tr_b16 v[180:181], v19 offset:16384
    ds_read_b64_tr_b16 v[182:183], v19 offset:16896
    ds_read_b64_tr_b16 v[188:189], v19 offset:24576
    ds_read_b64_tr_b16 v[190:191], v19 offset:25088
    ds_read_b64_tr_b16 v[196:197], v20 offset:0
    ds_read_b64_tr_b16 v[198:199], v20 offset:512
    ds_read_b64_tr_b16 v[204:205], v20 offset:8192
    ds_read_b64_tr_b16 v[206:207], v20 offset:8704
    ds_read_b64_tr_b16 v[212:213], v20 offset:16384
    ds_read_b64_tr_b16 v[214:215], v20 offset:16896
    ds_read_b64_tr_b16 v[220:221], v20 offset:24576
    ds_read_b64_tr_b16 v[222:223], v20 offset:25088
    ds_read_b64_tr_b16 v[228:229], v20 offset:32768
    ds_read_b64_tr_b16 v[230:231], v20 offset:33280
    s_waitcnt lgkmcnt(0)
    v_mov_b32 v8, v160
    v_mov_b32 v9, v161
    v_mov_b32 v10, v162
    v_mov_b32 v11, v163
    v_mov_b32_dpp v160, v164 row_ror:8 row_mask:0xf bank_mask:0xc
    v_mov_b32_dpp v161, v165 row_ror:8 row_mask:0xf bank_mask:0xc
    v_mov_b32_dpp v162, v166 row_ror:8 row_mask:0xf bank_mask:0xc
    v_mov_b32_dpp v163, v167 row_ror:8 row_mask:0xf bank_mask:0xc
    v_mov_b32_dpp v164, v8 row_ror:8 row_mask:0xf bank_mask:0x3
    v_mov_b32_dpp v165, v9 row_ror:8 row_mask:0xf bank_mask:0x3
    v_mov_b32_dpp v166, v10 row_ror:8 row_mask:0xf bank_mask:0x3
    v_mov_b32_dpp v167, v11 row_ror:8 row_mask:0xf bank_mask:0x3
    v_mov_b32 v8, v168
    v_mov_b32 v9, v169
    v_mov_b32 v10, v170
    v_mov_b32 v11, v171
    v_mov_b32_dpp v168, v172 row_ror:8 row_mask:0xf bank_mask:0xc
    v_mov_b32_dpp v169, v173 row_ror:8 row_mask:0xf bank_mask:0xc
    v_mov_b32_dpp v170, v174 row_ror:8 row_mask:0xf bank_mask:0xc
    v_mov_b32_dpp v171, v175 row_ror:8 row_mask:0xf bank_mask:0xc
    v_mov_b32_dpp v172, v8 row_ror:8 row_mask:0xf bank_mask:0x3
    v_mov_b32_dpp v173, v9 row_ror:8 row_mask:0xf bank_mask:0x3
    v_mov_b32_dpp v174, v10 row_ror:8 row_mask:0xf bank_mask:0x3
    v_mov_b32_dpp v175, v11 row_ror:8 row_mask:0xf bank_mask:0x3
    v_mov_b32 v8, v176
    v_mov_b32 v9, v177
    v_mov_b32 v10, v178
    v_mov_b32 v11, v179
    v_mov_b32_dpp v176, v180 row_ror:8 row_mask:0xf bank_mask:0xc
    v_mov_b32_dpp v177, v181 row_ror:8 row_mask:0xf bank_mask:0xc
    v_mov_b32_dpp v178, v182 row_ror:8 row_mask:0xf bank_mask:0xc
    v_mov_b32_dpp v179, v183 row_ror:8 row_mask:0xf bank_mask:0xc
    v_mov_b32_dpp v180, v8 row_ror:8 row_mask:0xf bank_mask:0x3
    v_mov_b32_dpp v181, v9 row_ror:8 row_mask:0xf bank_mask:0x3
    v_mov_b32_dpp v182, v10 row_ror:8 row_mask:0xf bank_mask:0x3
    v_mov_b32_dpp v183, v11 row_ror:8 row_mask:0xf bank_mask:0x3
    v_mov_b32 v8, v184
    v_mov_b32 v9, v185
    v_mov_b32 v10, v186
    v_mov_b32 v11, v187
    v_mov_b32_dpp v184, v188 row_ror:8 row_mask:0xf bank_mask:0xc
    v_mov_b32_dpp v185, v189 row_ror:8 row_mask:0xf bank_mask:0xc
    v_mov_b32_dpp v186, v190 row_ror:8 row_mask:0xf bank_mask:0xc
    v_mov_b32_dpp v187, v191 row_ror:8 row_mask:0xf bank_mask:0xc
    v_mov_b32_dpp v188, v8 row_ror:8 row_mask:0xf bank_mask:0x3
    v_mov_b32_dpp v189, v9 row_ror:8 row_mask:0xf bank_mask:0x3
    v_mov_b32_dpp v190, v10 row_ror:8 row_mask:0xf bank_mask:0x3
    v_mov_b32_dpp v191, v11 row_ror:8 row_mask:0xf bank_mask:0x3
    v_mov_b32 v8, v192
    v_mov_b32 v9, v193
    v_mov_b32 v10, v194
    v_mov_b32 v11, v195
    v_mov_b32_dpp v192, v196 row_ror:8 row_mask:0xf bank_mask:0xc
    v_mov_b32_dpp v193, v197 row_ror:8 row_mask:0xf bank_mask:0xc
    v_mov_b32_dpp v194, v198 row_ror:8 row_mask:0xf bank_mask:0xc
    v_mov_b32_dpp v195, v199 row_ror:8 row_mask:0xf bank_mask:0xc
    v_mov_b32_dpp v196, v8 row_ror:8 row_mask:0xf bank_mask:0x3
    v_mov_b32_dpp v197, v9 row_ror:8 row_mask:0xf bank_mask:0x3
    v_mov_b32_dpp v198, v10 row_ror:8 row_mask:0xf bank_mask:0x3
    v_mov_b32_dpp v199, v11 row_ror:8 row_mask:0xf bank_mask:0x3
    v_mov_b32 v8, v200
    v_mov_b32 v9, v201
    v_mov_b32 v10, v202
    v_mov_b32 v11, v203
    v_mov_b32_dpp v200, v204 row_ror:8 row_mask:0xf bank_mask:0xc
    v_mov_b32_dpp v201, v205 row_ror:8 row_mask:0xf bank_mask:0xc
    v_mov_b32_dpp v202, v206 row_ror:8 row_mask:0xf bank_mask:0xc
    v_mov_b32_dpp v203, v207 row_ror:8 row_mask:0xf bank_mask:0xc
    v_mov_b32_dpp v204, v8 row_ror:8 row_mask:0xf bank_mask:0x3
    v_mov_b32_dpp v205, v9 row_ror:8 row_mask:0xf bank_mask:0x3
    v_mov_b32_dpp v206, v10 row_ror:8 row_mask:0xf bank_mask:0x3
    v_mov_b32_dpp v207, v11 row_ror:8 row_mask:0xf bank_mask:0x3
    v_mov_b32 v8, v208
    v_mov_b32 v9, v209
    v_mov_b32 v10, v210
    v_mov_b32 v11, v211
    v_mov_b32_dpp v208, v212 row_ror:8 row_mask:0xf bank_mask:0xc
    v_mov_b32_dpp v209, v213 row_ror:8 row_mask:0xf bank_mask:0xc
    v_mov_b32_dpp v210, v214 row_ror:8 row_mask:0xf bank_mask:0xc
    v_mov_b32_dpp v211, v215 row_ror:8 row_mask:0xf bank_mask:0xc
    v_mov_b32_dpp v212, v8 row_ror:8 row_mask:0xf bank_mask:0x3
    v_mov_b32_dpp v213, v9 row_ror:8 row_mask:0xf bank_mask:0x3
    v_mov_b32_dpp v214, v10 row_ror:8 row_mask:0xf bank_mask:0x3
    v_mov_b32_dpp v215, v11 row_ror:8 row_mask:0xf bank_mask:0x3
    v_mov_b32 v8, v216
    v_mov_b32 v9, v217
    v_mov_b32 v10, v218
    v_mov_b32 v11, v219
    v_mov_b32_dpp v216, v220 row_ror:8 row_mask:0xf bank_mask:0xc
    v_mov_b32_dpp v217, v221 row_ror:8 row_mask:0xf bank_mask:0xc
    v_mov_b32_dpp v218, v222 row_ror:8 row_mask:0xf bank_mask:0xc
    v_mov_b32_dpp v219, v223 row_ror:8 row_mask:0xf bank_mask:0xc
    s_branch .Lsk_b2_1
.Lst_b2_1:
    s_branch .Lrt_b2_1
.Lsk_b2_1:
    v_mov_b32_dpp v220, v8 row_ror:8 row_mask:0xf bank_mask:0x3
    v_mov_b32_dpp v221, v9 row_ror:8 row_mask:0xf bank_mask:0x3
    v_mov_b32_dpp v222, v10 row_ror:8 row_mask:0xf bank_mask:0x3
    v_mov_b32_dpp v223, v11 row_ror:8 row_mask:0xf bank_mask:0x3
    v_mov_b32 v8, v224
    v_mov_b32 v9, v225
    v_mov_b32 v10, v226
    v_mov_b32 v11, v227
    v_mov_b32_dpp v224, v228 row_ror:8 row_mask:0xf bank_mask:0xc
    v_mov_b32_dpp v225, v229 row_ror:8 row_mask:0xf bank_mask:0xc
    v_mov_b32_dpp v226, v230 row_ror:8 row_mask:0xf bank_mask:0xc
    v_mov_b32_dpp v227, v231 row_ror:8 row_mask:0xf bank_mask:0xc
    v_mov_b32_dpp v228, v8 row_ror:8 row_mask:0xf bank_mask:0x3
    v_mov_b32_dpp v229, v9 row_ror:8 row_mask:0xf bank_mask:0x3
    v_mov_b32_dpp v230, v10 row_ror:8 row_mask:0xf bank_mask:0x3
    v_mov_b32_dpp v231, v11 row_ror:8 row_mask:0xf bank_mask:0x3
    s_waitcnt vmcnt(0)
    s_barrier
    ds_read_b64_tr_b16 v[104:105], v28 offset:0
    ds_read_b64_tr_b16 v[106:107], v28 offset:512
    ds_read_b64_tr_b16 v[112:113], v29 offset:0
    ds_read_b64_tr_b16 v[114:115], v29 offset:512
    ds_read_b64_tr_b16 v[108:109], v28 offset:4096
    ds_read_b64_tr_b16 v[110:111], v28 offset:4608
    ds_read_b64_tr_b16 v[116:117], v29 offset:4096
    ds_read_b64_tr_b16 v[118:119], v29 offset:4608
    ds_read_b64_tr_b16 v[120:121], v28 offset:32768
    ds_read_b64_tr_b16 v[122:123], v28 offset:33280
    ds_read_b64_tr_b16 v[128:129], v29 offset:32768
    ds_read_b64_tr_b16 v[130:131], v29 offset:33280
    ds_read_b64_tr_b16 v[124:125], v28 offset:36864
    ds_read_b64_tr_b16 v[126:127], v28 offset:37376
    ds_read_b64_tr_b16 v[132:133], v29 offset:36864
    ds_read_b64_tr_b16 v[134:135], v29 offset:37376
    s_cmp_ge_u32 s3, 2
    s_cbranch_scc1 .Lbc_nodn3
    ds_read_b64_tr_b16 v[136:137], v30 offset:0
    ds_read_b64_tr_b16 v[138:139], v30 offset:512
    ds_read_b64_tr_b16 v[144:145], v31 offset:0
    ds_read_b64_tr_b16 v[146:147], v31 offset:512
    ds_read_b64_tr_b16 v[140:141], v30 offset:4096
    ds_read_b64_tr_b16 v[142:143], v30 offset:4608
    ds_read_b64_tr_b16 v[148:149], v31 offset:4096
    ds_read_b64_tr_b16 v[150:151], v31 offset:4608
.Lbc_nodn3:
    s_branch .Lsk_b2_2
    .fill 125, 4, 0xbf800000
.Lst_b2_2:
    s_branch .Lrt_b2_2
.Lsk_b2_2:
    s_mov_b32 s69, 0
.gp_204:
    s_add_u32 s69, s69, 1
    s_and_b32 s56, s69, 0x41
    s_cmp_lg_u32 s56, 0x41
    s_cselect_b32 s56, 0, 0x800000
    s_xor_b32 s56, s56, s0
    s_add_u32 s58, s101, s56
    buffer_load_dwordx4 v[68:71], v2, s[36:39], s58 offen offset:0 sc1
    buffer_load_dwordx4 v[72:75], v2, s[36:39], s58 offen offset:1024 sc1
    buffer_load_dwordx2 v[76:77], v5, s[36:39], s58 offen offset:0 sc1
    s_waitcnt vmcnt(0)
    v_min3_u32 v25, v69, v71, v73
    v_max3_u32 v26, v69, v71, v73
    v_min3_u32 v25, v25, v75, v77
    v_max3_u32 v26, v26, v75, v77
    v_cmp_eq_u32 vcc, s34, v25
    v_cmp_eq_u32 s[56:57], s34, v26
    s_and_b64 vcc, vcc, s[56:57]
    s_cmp_eq_u64 vcc, -1
    s_nop 2
    s_cbranch_scc1 .gpd_205
    s_sub_u32 s35, s35, 1
    s_cbranch_scc1 .Lexit
    s_branch .gp_204
.gpd_205:
    s_mov_b32 s56, 0x3f803f80
    v_dot2_f32_bf16 v98, v68, s56, 0
    v_dot2_f32_bf16 v99, v68, v68, 0
    v_dot2_f32_bf16 v98, v70, s56, v98
    v_dot2_f32_bf16 v99, v70, v70, v99
    v_dot2_f32_bf16 v98, v72, s56, v98
    v_dot2_f32_bf16 v99, v72, v72, v99
    v_dot2_f32_bf16 v98, v74, s56, v98
    v_dot2_f32_bf16 v99, v74, v74, v99
    s_mov_b64 exec, 0xffffffff
    v_dot2_f32_bf16 v98, v76, s56, v98
    v_dot2_f32_bf16 v99, v76, v76, v99
    s_mov_b64 exec, -1
    s_nop 1
    v_permlane32_swap_b32 v98, v99
    v_add_f32 v98, v98, v99
    v_mov_b32 v100, v98
    s_nop 1
    v_permlane16_swap_b32 v100, v98
    v_add_f32 v98, v100, v98
    v_and_b32 v69, 0xffff0000, v68
    v_lshlrev_b32 v68, 16, v68
    v_add_f32_dpp v98, v98, v98 row_ror:8 row_mask:0xf bank_mask:0xf
    v_and_b32 v71, 0xffff0000, v70
    v_lshlrev_b32 v70, 16, v70
    v_add_f32_dpp v98, v98, v98 row_ror:4 row_mask:0xf bank_mask:0xf
    v_and_b32 v73, 0xffff0000, v72
    v_lshlrev_b32 v72, 16, v72
    v_add_f32_dpp v98, v98, v98 quad_perm:[2,3,0,1] row_mask:0xf bank_mask:0xf
    v_and_b32 v75, 0xffff0000, v74
    v_lshlrev_b32 v74, 16, v74
    v_add_f32_dpp v98, v98, v98 quad_perm:[1,0,3,2] row_mask:0xf bank_mask:0xf
    v_mul_f32 v98, 0x3ae38e39, v98
    v_and_b32 v77, 0xffff0000, v76
    v_lshlrev_b32 v76, 16, v76
    v_readlane_b32 s56, v98, 0
    v_readlane_b32 s57, v98, 32
    s_nop 0
    v_mov_b32 v98, s56
    v_fma_f32 v99, -v98, v98, s57
    v_max_f32 v99, 0, v99
    v_cvt_pk_bf16_f32 v100, -v98, v99
    v_and_b32 v101, 0xffff0000, v100
    v_add_f32 v101, 0x3727c5ac, v101
    v_lshlrev_b32 v98, 16, v100
    v_cvt_pk_bf16_f32 v101, v101, v101
    v_lshlrev_b32 v101, 16, v101
    v_sqrt_f32 v101, v101
    v_mov_b32 v99, v98
    v_cvt_pk_bf16_f32 v101, v101, v101
    v_lshlrev_b32 v101, 16, v101
    v_rcp_f32 v100, v101
    v_rcp_f32 v101, v101
    v_pk_add_f32 v[68:69], v[68:69], v[98:99]
    v_pk_add_f32 v[70:71], v[70:71], v[98:99]
    v_pk_add_f32 v[72:73], v[72:73], v[98:99]
    v_pk_add_f32 v[74:75], v[74:75], v[98:99]
    v_pk_add_f32 v[76:77], v[76:77], v[98:99]
    v_cvt_pk_bf16_f32 v68, v68, v69
    v_and_b32 v69, 0xffff0000, v68
    v_lshlrev_b32 v68, 16, v68
    v_cvt_pk_bf16_f32 v70, v70, v71
    v_and_b32 v71, 0xffff0000, v70
    v_lshlrev_b32 v70, 16, v70
    v_cvt_pk_bf16_f32 v72, v72, v73
    v_and_b32 v73, 0xffff0000, v72
    v_lshlrev_b32 v72, 16, v72
    v_cvt_pk_bf16_f32 v74, v74, v75
    v_and_b32 v75, 0xffff0000, v74
    v_lshlrev_b32 v74, 16, v74
    v_cvt_pk_bf16_f32 v76, v76, v77
    v_and_b32 v77, 0xffff0000, v76
    v_lshlrev_b32 v76, 16, v76
    v_pk_mul_f32 v[68:69], v[68:69], v[100:101]
    v_pk_mul_f32 v[70:71], v[70:71], v[100:101]
    v_pk_mul_f32 v[72:73], v[72:73], v[100:101]
    v_pk_mul_f32 v[74:75], v[74:75], v[100:101]
    v_pk_mul_f32 v[76:77], v[76:77], v[100:101]
    v_cvt_pk_bf16_f32 v68, v68, v69
    v_and_b32 v69, 0xffff0000, v68
    v_lshlrev_b32 v68, 16, v68
    v_cvt_pk_bf16_f32 v70, v70, v71
    v_and_b32 v71, 0xffff0000, v70
    v_lshlrev_b32 v70, 16, v70
    v_cvt_pk_bf16_f32 v72, v72, v73
    v_and_b32 v73, 0xffff0000, v72
    v_lshlrev_b32 v72, 16, v72
    v_cvt_pk_bf16_f32 v74, v74, v75
    v_and_b32 v75, 0xffff0000, v74
    v_lshlrev_b32 v74, 16, v74
    v_cvt_pk_bf16_f32 v76, v76, v77
    v_and_b32 v77, 0xffff0000, v76
    v_lshlrev_b32 v76, 16, v76
    v_pk_mul_f32 v[68:69], v[68:69], v[88:89]
    v_pk_mul_f32 v[70:71], v[70:71], v[90:91]
    v_pk_mul_f32 v[72:73], v[72:73], v[92:93]
    v_pk_mul_f32 v[74:75], v[74:75], v[94:95]
    v_pk_mul_f32 v[76:77], v[76:77], v[96:97]
    v_cvt_pk_bf16_f32 v68, v68, v69
    v_and_b32 v69, 0xffff0000, v68
    v_lshlrev_b32 v68, 16, v68
    v_cvt_pk_bf16_f32 v70, v70, v71
    v_and_b32 v71, 0xffff0000, v70
    v_lshlrev_b32 v70, 16, v70
    v_cvt_pk_bf16_f32 v72, v72, v73
    v_and_b32 v73, 0xffff0000, v72
    v_lshlrev_b32 v72, 16, v72
    v_cvt_pk_bf16_f32 v74, v74, v75
    v_and_b32 v75, 0xffff0000, v74
    v_lshlrev_b32 v74, 16, v74
    v_cvt_pk_bf16_f32 v76, v76, v77
    v_and_b32 v77, 0xffff0000, v76
    v_lshlrev_b32 v76, 16, v76
    v_pk_add_f32 v[68:69], v[68:69], v[78:79]
    v_pk_add_f32 v[70:71], v[70:71], v[80:81]
    v_pk_add_f32 v[72:73], v[72:73], v[82:83]
    v_pk_add_f32 v[74:75], v[74:75], v[84:85]
    v_pk_add_f32 v[76:77], v[76:77], v[86:87]
    v_cvt_pk_bf16_f32 v8, v68, v69
    v_cvt_pk_bf16_f32 v9, v70, v71
    v_cvt_pk_bf16_f32 v10, v72, v73
    v_cvt_pk_bf16_f32 v11, v74, v75
    v_cvt_pk_bf16_f32 v12, v76, v77
    ds_write2_b32 v17, v8, v9 offset0:0 offset1:4
    ds_write2_b32 v17, v10, v11 offset0:128 offset1:132
    ds_write_b32 v18, v12
    s_branch .Lsk_b2_3
    .fill 21, 4, 0xbf800000
.Lst_b2_3:
    s_branch .Lrt_b2_3
.Lsk_b2_3:
    s_waitcnt lgkmcnt(0)
    s_barrier
    ds_read_b128 v[32:35], v16 offset:0
    ds_read_b128 v[36:39], v16 offset:128
    ds_read_b128 v[40:43], v16 offset:256
    ds_read_b128 v[44:47], v16 offset:384
    ds_read_b128 v[48:51], v16 offset:512
    ds_read_b128 v[52:55], v16 offset:640
    ds_read_b128 v[56:59], v16 offset:768
    ds_read_b128 v[60:63], v16 offset:896
    ds_read_b128 v[64:67], v16 offset:1024
    s_waitcnt lgkmcnt(8)
    v_smfmac_f32_16x16x64_bf16 v[152:155], v[32:35], v[160:167], v156
    s_waitcnt lgkmcnt(7)
    v_smfmac_f32_16x16x64_bf16 v[152:155], v[36:39], v[168:175], v156
    s_waitcnt lgkmcnt(6)
    v_smfmac_f32_16x16x64_bf16 v[152:155], v[40:43], v[176:183], v156
    s_waitcnt lgkmcnt(5)
    v_smfmac_f32_16x16x64_bf16 v[152:155], v[44:47], v[184:191], v156
    s_waitcnt lgkmcnt(4)
    v_smfmac_f32_16x16x64_bf16 v[152:155], v[48:51], v[192:199], v156
    s_waitcnt lgkmcnt(3)
    v_smfmac_f32_16x16x64_bf16 v[152:155], v[52:55], v[200:207], v156
    s_waitcnt lgkmcnt(2)
    v_smfmac_f32_16x16x64_bf16 v[152:155], v[56:59], v[208:215], v156
    s_waitcnt lgkmcnt(1)
    v_smfmac_f32_16x16x64_bf16 v[152:155], v[60:63], v[216:223], v156
    s_waitcnt lgkmcnt(0)
    v_smfmac_f32_16x16x64_bf16 v[152:155], v[64:67], v[224:231], v156
    s_nop 7
    v_add_f32 v12, v152, v153
    v_add_f32 v13, v154, v155
    v_cvt_pk_bf16_f32 v13, v12, v13
    v_lshlrev_b32 v12, 16, v13
    v_and_b32 v14, 0xffff0000, v13
    v_mov_b32 v13, v14
    s_nop 0
    v_mov_b32_dpp v14, v12 row_ror:8 row_mask:0xf bank_mask:0x3
    v_mov_b32_dpp v12, v13 row_ror:8 row_mask:0xf bank_mask:0xc
    v_max_f32 v12, 0xc2ae0000, v12
    v_min_f32 v27, 0x43000000, v12
    v_mul_f32 v25, 0xbfb8aa3b, v27
    v_fma_f32 v26, v27, s98, -v25
    v_fmac_f32 v26, 0xb2a57060, v27
    v_exp_f32 v25, v25
    v_mul_f32 v26, 0x3f317218, v26
    v_fmac_f32 v25, v25, v26
    v_add_f32 v25, 1.0, v25
    v_rcp_f32 v26, v25
    s_nop 0
    v_mul_f32 v27, v12, v26
    v_fma_f32 v25, -v27, v25, v12
    v_fma_f32 v12, v25, v26, v27
    v_cvt_pk_bf16_f32 v12, v12, v12
    v_lshlrev_b32 v12, 16, v12
    v_mul_f32 v12, v12, v14
    v_cvt_pk_bf16_f32 v12, v12, v12
    ds_write_b16 v21, v12
    s_mov_b32 s60, 0x07060503
    s_mov_b32 s61, 0x07060502
    s_mov_b32 s62, 0x07060501
    s_mov_b32 vcc_lo, 0x55555555
    s_mov_b32 vcc_hi, 0x55555555
    v_mov_b32 v59, s34
    v_mov_b32 v63, s34
    v_mov_b32 v67, s34
    s_cmp_ge_u32 s3, 2
    s_waitcnt lgkmcnt(0)
    s_barrier
    ds_read_b128 v[8:11], v22
    s_waitcnt lgkmcnt(0)
    v_smfmac_f32_16x16x64_bf16 v[232:235], v[8:11], v[104:111], v156
    v_smfmac_f32_16x16x64_bf16 v[236:239], v[8:11], v[112:119], v156
    v_smfmac_f32_16x16x64_bf16 v[240:243], v[8:11], v[120:127], v156
    v_smfmac_f32_16x16x64_bf16 v[244:247], v[8:11], v[128:135], v156
    s_cbranch_scc0 .Lbc_three
    s_nop 4
    v_add_f32 v232, v232, v233
    v_add_f32 v234, v234, v235
    v_add_f32 v236, v236, v237
    v_add_f32 v238, v238, v239
    s_not_b64 vcc, vcc
    v_cndmask_b32_dpp v233, v232, v234, vcc quad_perm:[1,0,3,2] row_mask:0xf bank_mask:0xf
    v_cndmask_b32_dpp v235, v236, v238, vcc quad_perm:[1,0,3,2] row_mask:0xf bank_mask:0xf
    s_not_b64 vcc, vcc
    v_cndmask_b32_dpp v232, v234, v232, vcc quad_perm:[1,0,3,2] row_mask:0xf bank_mask:0xf
    v_cndmask_b32_dpp v234, v238, v236, vcc quad_perm:[1,0,3,2] row_mask:0xf bank_mask:0xf
    v_perm_b32 v56, v232, v235, s60
    v_perm_b32 v57, v233, v235, s61
    v_perm_b32 v58, v234, v235, s62
    buffer_store_dwordx4 v[56:59], v23, s[36:39], s59 offen sc1
    v_add_f32 v240, v240, v241
    v_add_f32 v242, v242, v243
    v_add_f32 v244, v244, v245
    v_add_f32 v246, v246, v247
    s_not_b64 vcc, vcc
    v_cndmask_b32_dpp v241, v240, v242, vcc quad_perm:[1,0,3,2] row_mask:0xf bank_mask:0xf
    v_cndmask_b32_dpp v243, v244, v246, vcc quad_perm:[1,0,3,2] row_mask:0xf bank_mask:0xf
    s_not_b64 vcc, vcc
    v_cndmask_b32_dpp v240, v242, v240, vcc quad_perm:[1,0,3,2] row_mask:0xf bank_mask:0xf
    v_cndmask_b32_dpp v242, v246, v244, vcc quad_perm:[1,0,3,2] row_mask:0xf bank_mask:0xf
    v_perm_b32 v60, v240, v243, s60
    v_perm_b32 v61, v241, v243, s61
    v_perm_b32 v62, v242, v243, s62
    buffer_store_dwordx4 v[60:63], v23, s[36:39], s99 offen sc1
    s_nop 1
    s_branch .Lexit
.Lbc_three:
    v_smfmac_f32_16x16x64_bf16 v[248:251], v[8:11], v[136:143], v156
    v_smfmac_f32_16x16x64_bf16 v[252:255], v[8:11], v[144:151], v156
    s_nop 3
    v_add_f32 v232, v232, v233
    v_add_f32 v234, v234, v235
    v_add_f32 v236, v236, v237
    v_add_f32 v238, v238, v239
    s_not_b64 vcc, vcc
    v_cndmask_b32_dpp v233, v232, v234, vcc quad_perm:[1,0,3,2] row_mask:0xf bank_mask:0xf
    v_cndmask_b32_dpp v235, v236, v238, vcc quad_perm:[1,0,3,2] row_mask:0xf bank_mask:0xf
    s_not_b64 vcc, vcc
    v_cndmask_b32_dpp v232, v234, v232, vcc quad_perm:[1,0,3,2] row_mask:0xf bank_mask:0xf
    v_cndmask_b32_dpp v234, v238, v236, vcc quad_perm:[1,0,3,2] row_mask:0xf bank_mask:0xf
    v_perm_b32 v56, v232, v235, s60
    v_perm_b32 v57, v233, v235, s61
    v_perm_b32 v58, v234, v235, s62
    buffer_store_dwordx4 v[56:59], v23, s[36:39], s59 offen sc1
    v_add_f32 v240, v240, v241
    v_add_f32 v242, v242, v243
    v_add_f32 v244, v244, v245
    v_add_f32 v246, v246, v247
    s_not_b64 vcc, vcc
    v_cndmask_b32_dpp v241, v240, v242, vcc quad_perm:[1,0,3,2] row_mask:0xf bank_mask:0xf
    v_cndmask_b32_dpp v243, v244, v246, vcc quad_perm:[1,0,3,2] row_mask:0xf bank_mask:0xf
    s_not_b64 vcc, vcc
    v_cndmask_b32_dpp v240, v242, v240, vcc quad_perm:[1,0,3,2] row_mask:0xf bank_mask:0xf
    v_cndmask_b32_dpp v242, v246, v244, vcc quad_perm:[1,0,3,2] row_mask:0xf bank_mask:0xf
    v_perm_b32 v60, v240, v243, s60
    v_perm_b32 v61, v241, v243, s61
    v_perm_b32 v62, v242, v243, s62
    buffer_store_dwordx4 v[60:63], v23, s[36:39], s99 offen sc1
    v_add_f32 v248, v248, v249
    v_add_f32 v250, v250, v251
    v_add_f32 v252, v252, v253
    v_add_f32 v254, v254, v255
    s_not_b64 vcc, vcc
    v_cndmask_b32_dpp v249, v248, v250, vcc quad_perm:[1,0,3,2] row_mask:0xf bank_mask:0xf
    v_cndmask_b32_dpp v251, v252, v254, vcc quad_perm:[1,0,3,2] row_mask:0xf bank_mask:0xf
    s_not_b64 vcc, vcc
    v_cndmask_b32_dpp v248, v250, v248, vcc quad_perm:[1,0,3,2] row_mask:0xf bank_mask:0xf
    v_cndmask_b32_dpp v250, v254, v252, vcc quad_perm:[1,0,3,2] row_mask:0xf bank_mask:0xf
    v_perm_b32 v64, v248, v251, s60
    v_perm_b32 v65, v249, v251, s61
    v_perm_b32 v66, v250, v251, s62
    buffer_store_dwordx4 v[64:67], v23, s[36:39], s100 offen sc1
.Lexit:
.Lend:
s_endpgm
.section .rodata,"a"
.p2align 6
.amdhsa_kernel adaLN_cond__sliding_block_cached__moe_arch_mod__decode_kernel
  .amdhsa_next_free_vgpr 256
  .amdhsa_next_free_sgpr 102
  .amdhsa_accum_offset 256
  .amdhsa_group_segment_fixed_size 0
  .amdhsa_kernarg_size 120
  .amdhsa_user_sgpr_count 2
  .amdhsa_user_sgpr_kernarg_segment_ptr 1
  .amdhsa_system_sgpr_workgroup_id_x 1
.end_amdhsa_kernel
```

```asm
; @launch grid=(256,1,1) block=(512,1,1) lds=159360
.amdgcn_target "amdgcn-amd-amdhsa--gfx950"
.text
.p2align 12
.globl adaLN_cond__sliding_block_cached__moe_arch_mod__decode_kernel
.p2align 8
.type adaLN_cond__sliding_block_cached__moe_arch_mod__decode_kernel,@function
adaLN_cond__sliding_block_cached__moe_arch_mod__decode_kernel:
    s_cmp_ge_u32 s2, 256
    s_cbranch_scc1 .Lend
    s_load_dwordx16 s[4:19], s[0:1], 0
    s_load_dwordx8 s[20:27], s[0:1], 64
    s_load_dwordx4 s[28:31], s[0:1], 96
    s_load_dwordx2 s[32:33], s[0:1], 112
    s_memrealtime s[70:71]
    v_lshrrev_b32 v1, 6, v0
    v_and_b32 v0, 63, v0
    v_readfirstlane_b32 s3, v1
    s_cmp_lt_u32 s3, 4
    s_nop 3
    s_cbranch_scc1 .Ltw_done
    s_cmp_lt_u32 s2, 72
    s_cbranch_scc1 .Ltw_m
    s_cmp_lt_u32 s2, 144
    s_cbranch_scc1 .Ltw_b
    s_cmp_lt_u32 s2, 208
    s_cbranch_scc1 .Ltw_q
    s_cmp_eq_u32 s3, 4
    s_cbranch_scc1 .Lst_a0_0
    s_cmp_eq_u32 s3, 5
    s_cbranch_scc1 .Lst_a0_1
.Lrt_a0_0:
.Lrt_a0_1:
    s_branch .Ltw_done
.Ltw_m:
    s_cmp_eq_u32 s3, 4
    s_cbranch_scc1 .Lst_m0_0
    s_cmp_eq_u32 s3, 5
    s_cbranch_scc1 .Lst_m0_1
.Lrt_m0_1:
    s_cmp_eq_u32 s3, 6
    s_cbranch_scc1 .Lst_m0_2
.Lrt_m0_2:
    s_cmp_eq_u32 s3, 7
    s_cbranch_scc1 .Lst_m0_3
    s_cmp_eq_u32 s3, 5
    s_cbranch_scc1 .Lst_m0_4
    s_cmp_eq_u32 s3, 6
    s_cbranch_scc1 .Lrt_m0_5
.Lrt_m0_0:
.Lrt_m0_3:
.Lrt_m0_4:
.Lrt_m0_5:
    s_branch .Ltw_done
.Ltw_b:
    s_cmp_eq_u32 s3, 4
    s_cbranch_scc1 .Lst_b0_0
    s_cmp_eq_u32 s3, 5
    s_cbranch_scc1 .Lst_b0_1
    s_cmp_eq_u32 s3, 6
    s_cbranch_scc1 .Lst_b0_2
    s_cmp_eq_u32 s3, 7
    s_cbranch_scc1 .Lst_b0_3
.Lrt_b0_0:
.Lrt_b0_1:
.Lrt_b0_2:
.Lrt_b0_3:
    s_branch .Ltw_done
.Ltw_q:
    s_cmp_eq_u32 s3, 4
    s_cbranch_scc1 .Lst_q0_0
    s_cmp_eq_u32 s3, 5
    s_cbranch_scc1 .Lst_q0_1
    s_cmp_eq_u32 s3, 6
    s_cbranch_scc1 .Lst_q0_2
    s_cmp_eq_u32 s3, 7
    s_cbranch_scc1 .Lst_q0_3
.Lrt_q0_0:
.Lrt_q0_1:
.Lrt_q0_2:
.Lrt_q0_3:
.Ltw_done:
    s_mov_b32 s35, 0x3ffff
    s_mov_b32 s98, 0xbfb8aa3b
    s_mov_b32 s94, 0x05040100
    s_mov_b32 s95, 0x07060302
    s_mov_b32 s96, 0xaaaaaaaa
    s_mov_b32 s97, 0xaaaaaaaa
    s_and_b32 s64, s2, 7
    s_lshr_b32 s65, s2, 3
    s_mov_b32 s58, 0x2554433
    s_mov_b32 s59, 0x2877661
    s_cmp_ge_u32 s65, 16
    s_cselect_b32 s58, 0xbb1aa998, s58
    s_cselect_b32 s59, 0xffeeddcc, s59
    s_lshl_b32 s57, s65, 2
    s_lshr_b64 s[58:59], s[58:59], s57
    s_lshl1_add_u32 s59, s64, 1
    s_mul_i32 s58, s58, s59
    s_add_u32 s58, s58, s64
    s_add_u32 s58, s58, s59
    s_and_b32 s66, s58, 7
    s_bfe_u32 s67, s58, 0x10003
    s_lshl1_add_u32 s67, s64, s67
    s_lshr_b32 s68, 0xaab5d42a, s65
    s_and_b32 s68, s68, 1
    s_movk_i32 s60, 0x7651
    s_cselect_b32 s60, 0x4320, s60
    s_lshl4_add_u32 s69, s66, s67
    s_lshl_b32 s69, s69, 21
    s_cmp_eq_u32 s64, 7
    s_cselect_b32 s58, 0x4040, 0
    s_or_b32 s58, s58, 0x208180
    s_bitcmp1_b32 s58, s65
    s_cselect_b32 s60, s60, 0x3210
    s_and_b32 s57, s3, 1
    s_and_b32 s59, s3, 6
    s_cmpk_eq_u32 s60, 0x3210
    s_cselect_b32 s57, s68, s57
    s_cselect_b32 s59, s3, s59
    s_lshl_b32 s57, s57, 16
    s_lshl_b32 s59, s59, 10
    s_add_u32 s69, s69, s57
    s_add_u32 s69, s69, s59
    s_add_u32 s69, s69, 0x180000
    v_bfe_u32 v1, v0, 2, 2
    v_lshlrev_b32 v1, 2, v1
    v_bfe_u32 v1, s60, v1, 4
    v_lshrrev_b32 v2, 4, v0
    v_lshl_add_u32 v1, v1, 2, v2
    v_and_b32 v2, 3, v0
    v_lshl_add_u32 v1, v1, 2, v2
    v_lshlrev_b32 v1, 4, v1
    v_lshlrev_b32 v2, 4, v0
    v_lshlrev_b32 v3, 3, v0
    v_and_b32 v4, 31, v0
    v_lshlrev_b32 v4, 2, v4
    v_add_u32 v4, 1024, v4
    v_lshlrev_b32 v5, 1, v4
    s_waitcnt lgkmcnt(0)
    s_load_dword s34, s[32:33], 0
    s_mov_b32 s40, s6
    s_and_b32 s41, s7, 0xffff
    s_mov_b32 s42, 0x10000000
    s_mov_b32 s43, 0x00020000
    s_mov_b32 s6, s60
    s_add_u32 s63, s69, 0
    buffer_load_dwordx4 v[32:35], v1, s[40:43], s63 offen nt
    s_add_u32 s63, s69, 8192
    buffer_load_dwordx4 v[36:39], v1, s[40:43], s63 offen nt
    s_add_u32 s63, s69, 16384
    buffer_load_dwordx4 v[64:67], v1, s[40:43], s63 offen nt
    s_add_u32 s63, s69, 24576
    buffer_load_dwordx4 v[68:71], v1, s[40:43], s63 offen nt
.Lnokpre:
    s_mov_b32 s44, s8
    s_and_b32 s45, s9, 0xffff
    s_mov_b32 s46, 0x10000000
    s_mov_b32 s47, 0x00020000
    s_cmp_eq_u32 s3, 0
    s_cselect_b64 exec, 1, 0
    buffer_load_dword v255, v2, s[44:47], s69 offen nt
    s_mov_b64 exec, -1
    s_mov_b32 s36, s32
    s_and_b32 s37, s33, 0xffff
    s_mov_b32 s38, 0x40000000
    s_mov_b32 s39, 0x00020000
    s_lshl3_add_u32 s56, s3, s2
    s_cmp_lt_u32 s56, 8
    s_cbranch_scc0 .Let_no
    s_lshl2_add_u32 s56, s2, 0x4a1000
    v_lshlrev_b32 v6, 8, v0
    v_mov_b32 v7, s70
    s_mov_b64 exec, 3
    buffer_store_dword v7, v6, s[36:39], s56 offen sc1
    s_mov_b64 exec, -1
.Let_no:
    v_mov_b32 v6, 159232
    v_mov_b32 v7, 0
    ds_write_b32 v6, v7
    s_waitcnt lgkmcnt(0)
    s_barrier
    s_cmp_lt_u32 s3, 4
    s_cbranch_scc1 1
    s_setprio 1
    s_cmp_lt_u32 s65, 9
    s_cbranch_scc1 .Lm
    s_cmp_lt_u32 s65, 18
    s_cbranch_scc1 .Lbc
    s_sub_u32 s65, s65, 18
    s_cmp_ge_u32 s65, 8
    s_cbranch_scc1 .La_early
    s_cmp_eq_u32 s65, 3
    s_mov_b32 s14, 0xb55aab55
    s_cselect_b32 s14, 0x8421084, s14
    s_mov_b32 s15, 0x5aab55aa
    s_cselect_b32 s15, 0x42108421, s15
    s_add_u32 s30, s70, 0
    s_mov_b32 s31, s70
    v_bfe_u32 v16, v0, 1, 3
    v_mul_u32_u24 v16, 1312, v16
    v_lshrrev_b32 v12, 4, v0
    v_lshl_add_u32 v16, v12, 5, v16
    v_and_b32 v12, 1, v0
    v_lshl_add_u32 v16, v12, 4, v16
    v_add_u32 v16, 147456, v16
    s_mul_i32 s56, s3, 1312
    s_add_u32 s56, s56, 147456
    v_add_u32 v17, s56, v3
    v_add_u32 v18, s56, v4
    v_lshrrev_b32 v12, 4, v0
    v_bfe_u32 v13, v0, 1, 1
    v_lshl_add_u32 v12, v12, 1, v13
    v_bfe_u32 v13, v0, 2, 2
    v_lshl_add_u32 v20, v12, 3, v13
    v_lshlrev_b32 v20, 7, v20
    v_and_b32 v12, 3, v12
    v_lshrrev_b32 v13, 1, v13
    v_lshl_add_u32 v12, v12, 1, v13
    v_xor_b32 v12, s3, v12
    v_lshl_add_u32 v20, v12, 4, v20
    v_and_b32 v12, 1, v0
    v_lshl_add_u32 v20, v12, 3, v20
    v_bfe_u32 v23, v0, 1, 3
    v_mul_u32_u24 v23, 144, v23
    v_bfe_u32 v12, v0, 4, 1
    v_lshl_add_u32 v23, v12, 3, v23
    s_branch .Lsk_q0_0
.Lst_q0_0:
    s_branch .Lrt_q0_0
.Lsk_q0_0:
    v_lshrrev_b32 v12, 5, v0
    v_lshl_add_u32 v23, v12, 2, v23
    v_and_b32 v12, 1, v0
    v_lshl_add_u32 v23, v12, 1, v23
    s_lshl_b32 s56, s3, 4
    s_add_u32 s56, s56, 157952
    v_add_u32 v23, s56, v23
    v_and_b32 v24, 15, v0
    v_lshlrev_b32 v24, 3, v24
    s_mul_i32 s56, s3, 144
    s_add_u32 s56, s56, 157952
    v_add_u32 v24, s56, v24
    v_add_u32 v21, 32768, v20
    s_lshl_b32 s100, s3, 10
    s_mul_i32 s58, s3, 1152
    s_mov_b32 s52, s4
    s_and_b32 s53, s5, 0xffff
    s_mov_b32 s54, 0x2400
    s_mov_b32 s55, 0x00020000
    buffer_load_dwordx2 v[246:247], v3, s[52:55], s58 offen
    buffer_load_dwordx2 v[248:249], v3, s[52:55], s58 offen offset:512
    buffer_load_dword v250, v4, s[52:55], s58 offen
    s_mov_b32 s48, s10
    s_and_b32 s49, s11, 0xffff
    s_mov_b32 s50, 0x480000
    s_mov_b32 s51, 0x00020000
    v_bfe_u32 v12, v0, 4, 1
    s_and_b32 s56, s3, 3
    s_lshl_b32 s56, s56, 1
    v_or_b32 v12, s56, v12
    v_and_b32 v19, 7, v0
    v_xor_b32 v12, v12, v19
    v_lshrrev_b32 v19, 3, v0
    v_mul_u32_u24 v19, 8192, v19
    v_lshl_add_u32 v19, v12, 4, v19
    s_lshl3_add_u32 s101, s64, s65
    s_lshl_b32 s57, s3, 16
    s_lshl_b32 s59, s101, 7
    s_add_u32 s57, s57, s59
    s_mov_b32 s99, s57
    s_add_u32 m0, s100, 0
    s_add_u32 s56, s99, 0
    buffer_load_dwordx4 v19, s[48:51], s56 offen nt lds
    s_add_u32 s63, s69, 32768
    buffer_load_dwordx4 v[96:99], v1, s[40:43], s63 offen nt
    s_waitcnt lgkmcnt(0)
    s_add_u32 s34, s34, 1
    s_getreg_b32 s1, hwreg(HW_REG_XCC_ID)
    s_lshl_b32 s1, s1, 24
    s_add_u32 s1, s1, s34
    s_lshr_b32 s0, s2, 3
    s_lshl_b32 s63, s64, 8
    s_add_u32 s0, s0, s63
    s_lshl2_add_u32 s0, s0, 0x480000
    v_mov_b32 v30, s1
    s_cmp_eq_u32 s3, 0
    s_cselect_b64 exec, 1, 0
    buffer_store_dword v30, v2, s[36:39], s0 offen sc1
    s_mov_b64 exec, -1
    s_and_b32 s58, s101, 1
    s_lshl_b32 s101, s101, 8
    s_lshl_b32 s58, s58, 7
    s_sub_u32 s101, s101, s58
    s_lshl_b32 s58, s3, 14
    s_add_u32 s101, s101, s58
    s_add_u32 s101, s101, 0x70000
    s_and_b32 s58, s64, 0
    s_mul_i32 s58, s58, 18432
    s_mul_i32 s59, s3, 2304
    s_add_u32 s58, s58, s59
    s_add_u32 s58, s58, 0x1000
    s_add_u32 s59, s58, 73728
    s_waitcnt vmcnt(5)
    s_add_u32 m0, s100, 8192
    s_add_u32 s56, s99, 524288
    buffer_load_dwordx4 v19, s[48:51], s56 offen nt lds
    s_waitcnt vmcnt(5)
    s_add_u32 s63, s69, 40960
    buffer_load_dwordx4 v[100:103], v1, s[40:43], s63 offen nt
    s_waitcnt vmcnt(5)
    s_add_u32 m0, s100, 16384
    s_add_u32 s56, s99, 1048576
    buffer_load_dwordx4 v19, s[48:51], s56 offen nt lds
    s_waitcnt vmcnt(5)
    s_add_u32 s63, s69, 49152
    buffer_load_dwordx4 v[128:131], v1, s[40:43], s63 offen nt
    v_lshlrev_b32 v236, 16, v246
    v_and_b32 v237, 0xffff0000, v246
    v_lshlrev_b32 v238, 16, v247
    v_and_b32 v239, 0xffff0000, v247
    v_lshlrev_b32 v240, 16, v248
    v_and_b32 v241, 0xffff0000, v248
    v_lshlrev_b32 v242, 16, v249
    v_and_b32 v243, 0xffff0000, v249
    v_lshlrev_b32 v244, 16, v250
    v_and_b32 v245, 0xffff0000, v250
    s_mov_b32 s56, 0x3f803f80
    v_dot2_f32_bf16 v10, v246, s56, 0
    v_dot2_f32_bf16 v11, v246, v246, 0
    v_dot2_f32_bf16 v10, v247, s56, v10
    v_dot2_f32_bf16 v11, v247, v247, v11
    v_dot2_f32_bf16 v10, v248, s56, v10
    v_dot2_f32_bf16 v11, v248, v248, v11
    v_dot2_f32_bf16 v10, v249, s56, v10
    v_dot2_f32_bf16 v11, v249, v249, v11
    s_mov_b64 exec, 0xffffffff
    v_dot2_f32_bf16 v10, v250, s56, v10
    v_dot2_f32_bf16 v11, v250, v250, v11
    s_mov_b64 exec, -1
    s_nop 1
    v_permlane32_swap_b32 v10, v11
    v_add_f32 v10, v10, v11
    v_mov_b32 v12, v10
    s_nop 1
    v_permlane16_swap_b32 v12, v10
    v_add_f32 v10, v12, v10
    s_nop 1
    v_add_f32_dpp v10, v10, v10 row_ror:8 row_mask:0xf bank_mask:0xf
    s_nop 1
    v_add_f32_dpp v10, v10, v10 row_ror:4 row_mask:0xf bank_mask:0xf
    s_nop 1
    v_add_f32_dpp v10, v10, v10 quad_perm:[2,3,0,1] row_mask:0xf bank_mask:0xf
    s_nop 1
    v_add_f32_dpp v10, v10, v10 quad_perm:[1,0,3,2] row_mask:0xf bank_mask:0xf
    v_mul_f32 v10, 0x3ae38e39, v10
    s_nop 0
    v_readlane_b32 s56, v10, 0
    v_readlane_b32 s57, v10, 32
    s_nop 0
    v_mov_b32 v10, s56
    v_fma_f32 v11, -v10, v10, s57
    v_max_f32 v11, 0, v11
    v_cvt_pk_bf16_f32 v12, -v10, v11
    v_and_b32 v13, 0xffff0000, v12
    v_add_f32 v13, 0x3727c5ac, v13
    v_lshlrev_b32 v10, 16, v12
    v_cvt_pk_bf16_f32 v13, v13, v13
    v_lshlrev_b32 v13, 16, v13
    v_sqrt_f32 v13, v13
    v_mov_b32 v11, v10
    v_cvt_pk_bf16_f32 v13, v13, v13
    v_lshlrev_b32 v13, 16, v13
    v_rcp_f32 v12, v13
    v_rcp_f32 v13, v13
    v_pk_add_f32 v[236:237], v[236:237], v[10:11]
    v_pk_add_f32 v[238:239], v[238:239], v[10:11]
    v_pk_add_f32 v[240:241], v[240:241], v[10:11]
    v_pk_add_f32 v[242:243], v[242:243], v[10:11]
    v_pk_add_f32 v[244:245], v[244:245], v[10:11]
    v_cvt_pk_bf16_f32 v236, v236, v237
    v_and_b32 v237, 0xffff0000, v236
    v_lshlrev_b32 v236, 16, v236
    v_cvt_pk_bf16_f32 v238, v238, v239
    v_and_b32 v239, 0xffff0000, v238
    v_lshlrev_b32 v238, 16, v238
    v_cvt_pk_bf16_f32 v240, v240, v241
    v_and_b32 v241, 0xffff0000, v240
    v_lshlrev_b32 v240, 16, v240
    v_cvt_pk_bf16_f32 v242, v242, v243
    v_and_b32 v243, 0xffff0000, v242
    v_lshlrev_b32 v242, 16, v242
    v_cvt_pk_bf16_f32 v244, v244, v245
    v_and_b32 v245, 0xffff0000, v244
    v_lshlrev_b32 v244, 16, v244
    v_pk_mul_f32 v[236:237], v[236:237], v[12:13]
    v_pk_mul_f32 v[238:239], v[238:239], v[12:13]
    v_pk_mul_f32 v[240:241], v[240:241], v[12:13]
    v_pk_mul_f32 v[242:243], v[242:243], v[12:13]
    v_pk_mul_f32 v[244:245], v[244:245], v[12:13]
    v_cvt_pk_bf16_f32 v236, v236, v237
    v_and_b32 v237, 0xffff0000, v236
    v_lshlrev_b32 v236, 16, v236
    v_cvt_pk_bf16_f32 v238, v238, v239
    v_and_b32 v239, 0xffff0000, v238
    v_lshlrev_b32 v238, 16, v238
    v_cvt_pk_bf16_f32 v240, v240, v241
    v_and_b32 v241, 0xffff0000, v240
    v_lshlrev_b32 v240, 16, v240
    v_cvt_pk_bf16_f32 v242, v242, v243
    v_and_b32 v243, 0xffff0000, v242
    v_lshlrev_b32 v242, 16, v242
    v_cvt_pk_bf16_f32 v244, v244, v245
    v_and_b32 v245, 0xffff0000, v244
    v_lshlrev_b32 v244, 16, v244
    s_branch .Lsk_q0_1
.Lst_q0_1:
    s_branch .Lrt_q0_1
.Lsk_q0_1:
    s_waitcnt vmcnt(5)
    s_add_u32 m0, s100, 24576
    s_add_u32 s56, s99, 1572864
    buffer_load_dwordx4 v19, s[48:51], s56 offen nt lds
    s_waitcnt vmcnt(4)
    s_add_u32 s63, s69, 57344
    buffer_load_dwordx4 v[132:135], v1, s[40:43], s63 offen nt
    s_waitcnt vmcnt(4)
    s_add_u32 m0, s100, 32768
    s_add_u32 s56, s99, 2097152
    buffer_load_dwordx4 v19, s[48:51], s56 offen nt lds
    s_waitcnt vmcnt(4)
    s_add_u32 s63, s69, 131072
    buffer_load_dwordx4 v[40:43], v1, s[40:43], s63 offen nt
    s_waitcnt vmcnt(4)
    s_add_u32 m0, s100, 40960
    s_add_u32 s56, s99, 2621440
    buffer_load_dwordx4 v19, s[48:51], s56 offen nt lds
    s_waitcnt vmcnt(4)
    s_add_u32 s63, s69, 139264
    buffer_load_dwordx4 v[44:47], v1, s[40:43], s63 offen nt
    s_waitcnt vmcnt(4)
    s_add_u32 m0, s100, 49152
    s_add_u32 s56, s99, 3145728
    buffer_load_dwordx4 v19, s[48:51], s56 offen nt lds
    s_waitcnt vmcnt(4)
    s_add_u32 s63, s69, 147456
    buffer_load_dwordx4 v[72:75], v1, s[40:43], s63 offen nt
    s_waitcnt vmcnt(4)
    s_add_u32 m0, s100, 57344
    s_add_u32 s56, s99, 3670016
    buffer_load_dwordx4 v19, s[48:51], s56 offen nt lds
    s_waitcnt vmcnt(4)
    s_add_u32 s63, s69, 155648
    buffer_load_dwordx4 v[76:79], v1, s[40:43], s63 offen nt
    s_waitcnt vmcnt(4)
    s_add_u32 m0, s100, 65536
    s_add_u32 s56, s99, 4194304
    buffer_load_dwordx4 v19, s[48:51], s56 offen nt lds
    s_waitcnt vmcnt(4)
    s_add_u32 s63, s69, 163840
    buffer_load_dwordx4 v[104:107], v1, s[40:43], s63 offen nt
    s_waitcnt vmcnt(4)
    s_add_u32 s63, s69, 172032
    buffer_load_dwordx4 v[108:111], v1, s[40:43], s63 offen nt
    s_waitcnt vmcnt(4)
    s_add_u32 s63, s69, 180224
    buffer_load_dwordx4 v[136:139], v1, s[40:43], s63 offen nt
    s_waitcnt vmcnt(4)
    s_add_u32 s63, s69, 188416
    buffer_load_dwordx4 v[140:143], v1, s[40:43], s63 offen nt
    s_waitcnt vmcnt(4)
    s_add_u32 s63, s69, 262144
    buffer_load_dwordx4 v[48:51], v1, s[40:43], s63 offen nt
    s_waitcnt vmcnt(4)
    s_add_u32 s63, s69, 270336
    buffer_load_dwordx4 v[52:55], v1, s[40:43], s63 offen nt
    s_and_b32 s12, s0, 0xffffff80
    s_sub_u32 s12, s12, 1024
    buffer_load_dword v28, v4, s[36:39], s12 offen sc1
    buffer_load_dwordx4 v[196:199], v2, s[36:39], s58 offen offset:0 sc1
    buffer_load_dwordx4 v[200:203], v2, s[36:39], s58 offen offset:1024 sc1
    buffer_load_dwordx2 v[204:205], v5, s[36:39], s58 offen offset:0 sc1
    buffer_load_dwordx4 v[206:209], v2, s[36:39], s59 offen offset:0 sc1
    buffer_load_dwordx4 v[210:213], v2, s[36:39], s59 offen offset:1024 sc1
    buffer_load_dwordx2 v[214:215], v5, s[36:39], s59 offen offset:0 sc1
    s_add_u32 s63, s69, 278528
    buffer_load_dwordx4 v[80:83], v1, s[40:43], s63 offen nt
    s_add_u32 s63, s69, 286720
    buffer_load_dwordx4 v[84:87], v1, s[40:43], s63 offen nt
    s_add_u32 s63, s69, 294912
    buffer_load_dwordx4 v[112:115], v1, s[40:43], s63 offen nt
    s_barrier
    ds_read_b64_tr_b16 v[160:161], v20 offset:0
    ds_read_b64_tr_b16 v[162:163], v20 offset:512
    ds_read_b64_tr_b16 v[164:165], v20 offset:8192
    ds_read_b64_tr_b16 v[166:167], v20 offset:8704
    ds_read_b64_tr_b16 v[168:169], v20 offset:16384
    ds_read_b64_tr_b16 v[170:171], v20 offset:16896
    ds_read_b64_tr_b16 v[172:173], v20 offset:24576
    ds_read_b64_tr_b16 v[174:175], v20 offset:25088
    ds_read_b64_tr_b16 v[176:177], v21 offset:0
    ds_read_b64_tr_b16 v[178:179], v21 offset:512
    ds_read_b64_tr_b16 v[180:181], v21 offset:8192
    ds_read_b64_tr_b16 v[182:183], v21 offset:8704
    ds_read_b64_tr_b16 v[184:185], v21 offset:16384
    ds_read_b64_tr_b16 v[186:187], v21 offset:16896
    ds_read_b64_tr_b16 v[188:189], v21 offset:24576
    ds_read_b64_tr_b16 v[190:191], v21 offset:25088
    ds_read_b64_tr_b16 v[192:193], v21 offset:32768
    ds_read_b64_tr_b16 v[194:195], v21 offset:33280
    s_add_u32 s63, s69, 303104
    buffer_load_dwordx4 v[116:119], v1, s[40:43], s63 offen nt
    s_waitcnt vmcnt(4)
    s_branch .gpc_2
.gp_1:
    buffer_load_dwordx4 v[196:199], v2, s[36:39], s58 offen offset:0 sc1
    buffer_load_dwordx4 v[200:203], v2, s[36:39], s58 offen offset:1024 sc1
    buffer_load_dwordx2 v[204:205], v5, s[36:39], s58 offen offset:0 sc1
    buffer_load_dwordx4 v[206:209], v2, s[36:39], s59 offen offset:0 sc1
    buffer_load_dwordx4 v[210:213], v2, s[36:39], s59 offen offset:1024 sc1
    buffer_load_dwordx2 v[214:215], v5, s[36:39], s59 offen offset:0 sc1
    s_waitcnt vmcnt(0)
.gpc_2:
    v_min_u32 v10, v197, v199
    v_max_u32 v11, v197, v199
    v_min3_u32 v10, v10, v201, v203
    v_max3_u32 v11, v11, v201, v203
    v_min3_u32 v10, v10, v205, v207
    v_max3_u32 v11, v11, v205, v207
    v_min3_u32 v10, v10, v209, v211
    v_max3_u32 v11, v11, v209, v211
    v_min3_u32 v10, v10, v213, v215
    v_max3_u32 v11, v11, v213, v215
    v_cmp_eq_u32 vcc, s34, v10
    v_cmp_eq_u32 s[56:57], s34, v11
    s_and_b64 vcc, vcc, s[56:57]
    s_cmp_eq_u64 vcc, -1
    s_nop 2
    s_cbranch_scc1 .gpd_3
    s_sub_u32 s35, s35, 1
    s_cbranch_scc1 .Lexit
    s_branch .gp_1
.gpd_3:
    s_add_u32 s63, s69, 311296
    buffer_load_dwordx4 v[144:147], v1, s[40:43], s63 offen nt
    v_and_b32 v207, 0xffff0000, v206
    v_lshlrev_b32 v206, 16, v206
    v_and_b32 v209, 0xffff0000, v208
    v_lshlrev_b32 v208, 16, v208
    v_and_b32 v211, 0xffff0000, v210
    v_lshlrev_b32 v210, 16, v210
    v_and_b32 v213, 0xffff0000, v212
    v_lshlrev_b32 v212, 16, v212
    v_and_b32 v215, 0xffff0000, v214
    v_lshlrev_b32 v214, 16, v214
    v_and_b32 v197, 0xffff0000, v196
    v_lshlrev_b32 v196, 16, v196
    v_and_b32 v199, 0xffff0000, v198
    v_lshlrev_b32 v198, 16, v198
    v_and_b32 v201, 0xffff0000, v200
    v_lshlrev_b32 v200, 16, v200
    v_and_b32 v203, 0xffff0000, v202
    v_lshlrev_b32 v202, 16, v202
    v_and_b32 v205, 0xffff0000, v204
    v_lshlrev_b32 v204, 16, v204
    v_pk_mul_f32 v[236:237], v[236:237], v[206:207]
    v_pk_mul_f32 v[238:239], v[238:239], v[208:209]
    v_pk_mul_f32 v[240:241], v[240:241], v[210:211]
    v_pk_mul_f32 v[242:243], v[242:243], v[212:213]
    v_pk_mul_f32 v[244:245], v[244:245], v[214:215]
    v_cvt_pk_bf16_f32 v236, v236, v237
    s_branch .Lsk_q0_2
.Lst_q0_2:
    s_branch .Lrt_q0_2
.Lsk_q0_2:
    v_and_b32 v237, 0xffff0000, v236
    v_lshlrev_b32 v236, 16, v236
    v_cvt_pk_bf16_f32 v238, v238, v239
    v_and_b32 v239, 0xffff0000, v238
    v_lshlrev_b32 v238, 16, v238
    v_cvt_pk_bf16_f32 v240, v240, v241
    v_and_b32 v241, 0xffff0000, v240
    v_lshlrev_b32 v240, 16, v240
    v_cvt_pk_bf16_f32 v242, v242, v243
    s_branch .Lsk_q0_3
.Lst_q0_3:
    s_branch .Lrt_q0_3
.Lsk_q0_3:
    v_and_b32 v243, 0xffff0000, v242
    v_lshlrev_b32 v242, 16, v242
    v_cvt_pk_bf16_f32 v244, v244, v245
    v_and_b32 v245, 0xffff0000, v244
    v_lshlrev_b32 v244, 16, v244
    v_pk_add_f32 v[236:237], v[236:237], v[196:197]
    v_pk_add_f32 v[238:239], v[238:239], v[198:199]
    v_pk_add_f32 v[240:241], v[240:241], v[200:201]
    v_pk_add_f32 v[242:243], v[242:243], v[202:203]
    v_pk_add_f32 v[244:245], v[244:245], v[204:205]
    v_cvt_pk_bf16_f32 v246, v236, v237
    v_cvt_pk_bf16_f32 v247, v238, v239
    v_cvt_pk_bf16_f32 v248, v240, v241
    v_cvt_pk_bf16_f32 v249, v242, v243
    v_cvt_pk_bf16_f32 v250, v244, v245
    ds_write_b64 v17, v[246:247] offset:0
    ds_write_b64 v17, v[248:249] offset:512
    ds_write_b32 v18, v250 offset:0
    s_add_u32 s63, s69, 319488
    buffer_load_dwordx4 v[148:151], v1, s[40:43], s63 offen nt
    s_waitcnt lgkmcnt(0)
    s_barrier
    s_add_u32 s63, s69, 393216
    buffer_load_dwordx4 v[56:59], v1, s[40:43], s63 offen nt
    ds_read_b128 v[196:199], v16 offset:0
    ds_read_b128 v[200:203], v16 offset:128
    ds_read_b128 v[204:207], v16 offset:256
    ds_read_b128 v[208:211], v16 offset:384
    ds_read_b128 v[212:215], v16 offset:512
    ds_read_b128 v[216:219], v16 offset:640
    ds_read_b128 v[220:223], v16 offset:768
    ds_read_b128 v[224:227], v16 offset:896
    ds_read_b128 v[228:231], v16 offset:1024
    s_waitcnt lgkmcnt(8)
    v_mfma_f32_16x16x32_bf16 v[232:235], v[160:163], v[196:199], 0
    s_waitcnt lgkmcnt(7)
    v_mfma_f32_16x16x32_bf16 v[232:235], v[164:167], v[200:203], v[232:235]
    s_waitcnt lgkmcnt(6)
    v_mfma_f32_16x16x32_bf16 v[232:235], v[168:171], v[204:207], v[232:235]
    s_waitcnt lgkmcnt(5)
    v_mfma_f32_16x16x32_bf16 v[232:235], v[172:175], v[208:211], v[232:235]
    s_waitcnt lgkmcnt(4)
    v_mfma_f32_16x16x32_bf16 v[232:235], v[176:179], v[212:215], v[232:235]
    s_waitcnt lgkmcnt(3)
    v_mfma_f32_16x16x32_bf16 v[232:235], v[180:183], v[216:219], v[232:235]
    s_waitcnt lgkmcnt(2)
    v_mfma_f32_16x16x32_bf16 v[232:235], v[184:187], v[220:223], v[232:235]
    s_waitcnt lgkmcnt(1)
    v_mfma_f32_16x16x32_bf16 v[232:235], v[188:191], v[224:227], v[232:235]
    s_waitcnt lgkmcnt(0)
    v_mfma_f32_16x16x32_bf16 v[232:235], v[192:195], v[228:231], v[232:235]
    s_nop 7
    v_permlane32_swap_b32 v232, v234
    v_permlane32_swap_b32 v233, v235
    v_cndmask_b32 v233, v233, v234, s[96:97]
    v_cndmask_b32 v232, v232, v235, s[96:97]
    s_nop 1
    v_add_f32_dpp v236, v233, v232 quad_perm:[1,0,3,2] row_mask:0xf bank_mask:0xf
    v_and_b32 v12, 1, v0
    v_lshlrev_b32 v12, 8, v12
    v_bfe_u32 v13, v0, 1, 3
    v_lshl_add_u32 v12, v13, 4, v12
    v_cvt_pk_bf16_f32 v236, v236, v236
    ds_write_b16 v23, v236
    v_mov_b32 v243, s34
    s_waitcnt lgkmcnt(0)
    s_barrier
    ds_read2_b32 v[244:245], v24 offset1:1
    v_mov_b32 v241, s34
    s_waitcnt lgkmcnt(0)
    v_mov_b32 v240, v244
    v_mov_b32 v242, v245
    v_cmp_eq_u32 vcc, s1, v28
    s_add_u32 s57, s101, 0x800000
    s_cmp_eq_u64 vcc, -1
    s_mov_b64 exec, 0xffff
    buffer_store_dwordx4 v[240:243], v12, s[36:39], s57 offen
    s_nop 1
    s_cbranch_scc1 .lq_4
    s_mov_b64 exec, 0xffff
    buffer_store_dwordx4 v[240:243], v12, s[36:39], s101 offen sc1
.lq_4:
    s_mov_b64 exec, -1
    s_mov_b64 s[18:19], 0
    v_mov_b32 v6, 0
    s_waitcnt vmcnt(3)
    s_bitcmp1_b64 s[14:15], 25
    s_cbranch_scc0 1
    s_waitcnt vmcnt(2)
    s_add_u32 s63, s69, 401408
    buffer_load_dwordx4 v[60:63], v1, s[40:43], s63 offen nt
    s_branch .Ln_att
.La_early:
    s_branch .Lsk_a0_0
.Lst_a0_0:
    s_branch .Lrt_a0_0
.Lsk_a0_0:
    s_mov_b32 s14, 0x6ddb76dd
    s_mov_b32 s15, 0xdb76ddb7
    s_add_u32 s30, s70, -55
    s_mov_b32 s31, s70
    s_cmp_ge_u32 s65, 11
    s_cselect_b32 s99, 1, 0
    s_mul_i32 s57, s99, 3
    s_sub_u32 s100, s65, s57
    s_sub_u32 s100, s100, 8
    s_lshl1_add_u32 s99, s64, s99
    s_mov_b32 s48, s12
    s_and_b32 s49, s13, 0xffff
    s_mov_b32 s50, 0x480000
    s_mov_b32 s51, 0x00020000
    v_bfe_u32 v12, v0, 4, 1
    s_and_b32 s56, s3, 1
    s_lshl_b32 s56, s56, 2
    v_lshl_or_b32 v12, v12, 1, s56
    v_and_b32 v13, 7, v0
    v_xor_b32 v12, v12, v13
    v_lshrrev_b32 v13, 3, v0
    v_mul_u32_u24 v13, 1152, v13
    v_lshl_add_u32 v6, v12, 4, v13
    s_mul_i32 s101, s99, 294912
    s_mul_i32 s56, s100, 384
    s_add_u32 s101, s101, s56
    s_mul_i32 s56, s3, 9216
    s_add_u32 s101, s101, s56
    s_lshl_b32 s57, s3, 10
    s_waitcnt vmcnt(4)
    s_add_u32 m0, s57, 0
    s_add_u32 s56, s101, 0
    buffer_load_dwordx4 v6, s[48:51], s56 offen nt lds
    s_waitcnt vmcnt(4)
    s_add_u32 m0, s57, 32768
    s_add_u32 s56, s101, 128
    buffer_load_dwordx4 v6, s[48:51], s56 offen nt lds
    s_waitcnt vmcnt(4)
    s_bitcmp1_b64 s[14:15], 4
    s_cbranch_scc0 1
    s_waitcnt vmcnt(3)
    s_add_u32 s63, s69, 32768
    buffer_load_dwordx4 v[96:99], v1, s[40:43], s63 offen nt
    s_waitcnt vmcnt(4)
    s_waitcnt lgkmcnt(0)
    s_add_u32 s34, s34, 1
    s_getreg_b32 s1, hwreg(HW_REG_XCC_ID)
    s_lshl_b32 s1, s1, 24
    s_add_u32 s1, s1, s34
    s_lshr_b32 s0, s2, 3
    s_lshl_b32 s63, s64, 8
    s_add_u32 s0, s0, s63
    s_lshl2_add_u32 s0, s0, 0x480000
    v_mov_b32 v30, s1
    s_cmp_eq_u32 s3, 0
    s_cselect_b64 exec, 1, 0
    buffer_store_dword v30, v2, s[36:39], s0 offen sc1
    s_mov_b64 exec, -1
    s_bitcmp1_b64 s[14:15], 5
    s_cbranch_scc0 1
    s_waitcnt vmcnt(3)
    s_add_u32 s63, s69, 40960
    buffer_load_dwordx4 v[100:103], v1, s[40:43], s63 offen nt
    s_waitcnt vmcnt(4)
    s_add_u32 m0, s57, 65536
    s_add_u32 s56, s101, 256
    buffer_load_dwordx4 v6, s[48:51], s56 offen nt lds
    s_waitcnt vmcnt(4)
    s_bitcmp1_b64 s[14:15], 6
    s_cbranch_scc0 1
    s_waitcnt vmcnt(3)
    s_add_u32 s63, s69, 49152
    buffer_load_dwordx4 v[128:131], v1, s[40:43], s63 offen nt
    s_waitcnt vmcnt(4)
    s_bitcmp1_b64 s[14:15], 7
    s_cbranch_scc0 1
    s_waitcnt vmcnt(2)
    s_add_u32 s63, s69, 57344
    buffer_load_dwordx4 v[132:135], v1, s[40:43], s63 offen nt
    s_waitcnt vmcnt(3)
    s_add_u32 m0, s57, 8192
    s_add_u32 s56, s101, 73728
    buffer_load_dwordx4 v6, s[48:51], s56 offen nt lds
    s_waitcnt vmcnt(3)
    s_bitcmp1_b64 s[14:15], 8
    s_cbranch_scc0 1
    s_waitcnt vmcnt(2)
    s_add_u32 s63, s69, 131072
    buffer_load_dwordx4 v[40:43], v1, s[40:43], s63 offen nt
    s_waitcnt vmcnt(3)
    s_bitcmp1_b64 s[14:15], 9
    s_cbranch_scc0 1
    s_waitcnt vmcnt(2)
    s_add_u32 s63, s69, 139264
    buffer_load_dwordx4 v[44:47], v1, s[40:43], s63 offen nt
    s_waitcnt vmcnt(3)
    s_add_u32 m0, s57, 40960
    s_add_u32 s56, s101, 73856
    buffer_load_dwordx4 v6, s[48:51], s56 offen nt lds
    s_waitcnt vmcnt(3)
    s_bitcmp1_b64 s[14:15], 10
    s_cbranch_scc0 1
    s_waitcnt vmcnt(2)
    s_add_u32 s63, s69, 147456
    buffer_load_dwordx4 v[72:75], v1, s[40:43], s63 offen nt
    s_waitcnt vmcnt(3)
    s_bitcmp1_b64 s[14:15], 11
    s_cbranch_scc0 1
    s_waitcnt vmcnt(2)
    s_add_u32 s63, s69, 155648
    buffer_load_dwordx4 v[76:79], v1, s[40:43], s63 offen nt
    s_waitcnt vmcnt(3)
    s_add_u32 m0, s57, 73728
    s_add_u32 s56, s101, 73984
    buffer_load_dwordx4 v6, s[48:51], s56 offen nt lds
    s_waitcnt vmcnt(3)
    s_bitcmp1_b64 s[14:15], 12
    s_cbranch_scc0 1
    s_waitcnt vmcnt(2)
    s_add_u32 s63, s69, 163840
    buffer_load_dwordx4 v[104:107], v1, s[40:43], s63 offen nt
    s_waitcnt vmcnt(3)
    s_bitcmp1_b64 s[14:15], 13
    s_cbranch_scc0 1
    s_waitcnt vmcnt(2)
    s_add_u32 s63, s69, 172032
    buffer_load_dwordx4 v[108:111], v1, s[40:43], s63 offen nt
    s_waitcnt vmcnt(3)
    s_add_u32 m0, s57, 16384
    s_add_u32 s56, s101, 147456
    buffer_load_dwordx4 v6, s[48:51], s56 offen nt lds
    s_waitcnt vmcnt(3)
    s_bitcmp1_b64 s[14:15], 14
    s_cbranch_scc0 1
    s_waitcnt vmcnt(2)
    s_add_u32 s63, s69, 180224
    buffer_load_dwordx4 v[136:139], v1, s[40:43], s63 offen nt
    s_waitcnt vmcnt(3)
    s_bitcmp1_b64 s[14:15], 15
    s_cbranch_scc0 1
    s_waitcnt vmcnt(2)
    s_add_u32 s63, s69, 188416
    buffer_load_dwordx4 v[140:143], v1, s[40:43], s63 offen nt
    s_waitcnt vmcnt(3)
    s_add_u32 m0, s57, 49152
    s_add_u32 s56, s101, 147584
    buffer_load_dwordx4 v6, s[48:51], s56 offen nt lds
    s_waitcnt vmcnt(3)
    s_bitcmp1_b64 s[14:15], 16
    s_cbranch_scc0 1
    s_waitcnt vmcnt(2)
    s_add_u32 s63, s69, 262144
    buffer_load_dwordx4 v[48:51], v1, s[40:43], s63 offen nt
    s_waitcnt vmcnt(3)
    s_bitcmp1_b64 s[14:15], 17
    s_cbranch_scc0 1
    s_waitcnt vmcnt(2)
    s_add_u32 s63, s69, 270336
    buffer_load_dwordx4 v[52:55], v1, s[40:43], s63 offen nt
    s_waitcnt vmcnt(3)
    s_add_u32 m0, s57, 81920
    s_add_u32 s56, s101, 147712
    buffer_load_dwordx4 v6, s[48:51], s56 offen nt lds
    s_waitcnt vmcnt(3)
    s_bitcmp1_b64 s[14:15], 18
    s_cbranch_scc0 1
    s_waitcnt vmcnt(2)
    s_add_u32 s63, s69, 278528
    buffer_load_dwordx4 v[80:83], v1, s[40:43], s63 offen nt
    s_waitcnt vmcnt(3)
    s_bitcmp1_b64 s[14:15], 19
    s_cbranch_scc0 1
    s_waitcnt vmcnt(2)
    s_add_u32 s63, s69, 286720
    buffer_load_dwordx4 v[84:87], v1, s[40:43], s63 offen nt
    s_waitcnt vmcnt(3)
    s_bitcmp1_b64 s[14:15], 20
    s_cbranch_scc0 1
    s_waitcnt vmcnt(2)
    s_add_u32 s63, s69, 294912
    buffer_load_dwordx4 v[112:115], v1, s[40:43], s63 offen nt
    s_waitcnt vmcnt(3)
    s_bitcmp1_b64 s[14:15], 21
    s_cbranch_scc0 1
    s_waitcnt vmcnt(2)
    s_add_u32 s63, s69, 303104
    buffer_load_dwordx4 v[116:119], v1, s[40:43], s63 offen nt
    s_waitcnt vmcnt(3)
    s_bitcmp1_b64 s[14:15], 22
    s_cbranch_scc0 1
    s_waitcnt vmcnt(2)
    s_add_u32 s63, s69, 311296
    buffer_load_dwordx4 v[144:147], v1, s[40:43], s63 offen nt
    s_branch .Lsk_a0_1
.Lst_a0_1:
    s_branch .Lrt_a0_1
.Lsk_a0_1:
    s_waitcnt vmcnt(3)
    s_bitcmp1_b64 s[14:15], 23
    s_cbranch_scc0 1
    s_waitcnt vmcnt(2)
    s_add_u32 s63, s69, 319488
    buffer_load_dwordx4 v[148:151], v1, s[40:43], s63 offen nt
    s_waitcnt vmcnt(3)
    s_bitcmp1_b64 s[14:15], 24
    s_cbranch_scc0 1
    s_waitcnt vmcnt(2)
    s_add_u32 s63, s69, 393216
    buffer_load_dwordx4 v[56:59], v1, s[40:43], s63 offen nt
    s_waitcnt vmcnt(3)
    s_bitcmp1_b64 s[14:15], 25
    s_cbranch_scc0 1
    s_waitcnt vmcnt(2)
    s_add_u32 s63, s69, 401408
    buffer_load_dwordx4 v[60:63], v1, s[40:43], s63 offen nt
    s_mov_b64 s[18:19], -1
.Ln_att:
    v_and_b32 v8, 1, v0
    v_lshlrev_b32 v8, 8, v8
    v_and_b32 v9, 0x3c, v0
    v_lshl_add_u32 v9, v9, 2, v8
    v_add_u32 v7, v9, v8
    v_and_b32 v9, 0x3c, v0
    v_lshrrev_b32 v8, 4, v8
    v_and_b32 v9, 4, v0
    v_lshl_add_u32 v9, v9, 3, v8
    s_lshl_b32 s58, s66, 14
    s_lshl_b32 s59, s67, 10
    s_add_u32 s58, s58, s59
    s_add_u32 s58, s58, 0x70000
    s_lshl4_add_u32 s59, s66, s67
    s_lshl_b32 s59, s59, 7
    s_add_u32 s59, s59, 0x430000
    s_memrealtime s[8:9]
    s_waitcnt vmcnt(8)
    s_waitcnt lgkmcnt(0)
    s_sub_u32 s8, s8, s30
    s_cmpk_ge_u32 s8, 1207
    s_cbranch_scc1 .ap_5
    s_waitcnt vmcnt(5)
    s_cmpk_ge_u32 s8, 1107
    s_cbranch_scc1 .ap_5
    s_waitcnt vmcnt(3)
    s_bitcmp1_b64 s[14:15], 26
    s_cbranch_scc0 1
    s_waitcnt vmcnt(2)
    s_cmpk_ge_u32 s8, 987
    s_cbranch_scc1 .ap_5
    s_waitcnt vmcnt(1)
.ap_5:
    s_add_u32 s63, s69, 409600
    buffer_load_dwordx4 v[88:91], v1, s[40:43], s63 offen nt
    v_and_b32 v157, 7, v0
    v_lshlrev_b32 v157, 2, v157
    s_mov_b32 s63, 0x4a1000
    buffer_load_dword v156, v157, s[36:39], s63 offen
    s_cmp_eq_u32 s3, 0
    s_cbranch_scc1 .Lst_n1_0
.Lrt_n1_0:
    s_cmp_eq_u32 s3, 1
    s_cbranch_scc1 .Lst_n1_1
    s_cmp_eq_u32 s3, 2
    s_cbranch_scc1 .Lst_n1_2
    s_cmp_eq_u32 s3, 3
    s_cbranch_scc1 .Lst_n1_3
    s_cmp_eq_u32 s3, 4
    s_cbranch_scc1 .Lst_n1_4
    s_cmp_eq_u32 s3, 5
    s_cbranch_scc1 .Lst_n1_5
    s_cmp_eq_u32 s3, 6
    s_cbranch_scc1 .Lst_n1_6
    s_cmp_eq_u32 s3, 7
    s_cbranch_scc1 .Lst_n1_7
    s_cmp_eq_u32 s3, 0
    s_cbranch_scc1 .Lrt_n1_8
.Lrt_n1_1:
.Lrt_n1_2:
.Lrt_n1_3:
.Lrt_n1_4:
.Lrt_n1_5:
.Lrt_n1_6:
.Lrt_n1_7:
.Lrt_n1_8:
    s_memrealtime s[8:9]
    s_waitcnt vmcnt(9)
    s_waitcnt lgkmcnt(0)
    s_sub_u32 s8, s8, s30
    s_cmpk_ge_u32 s8, 1234
    s_cbranch_scc1 .ap_6
    s_waitcnt vmcnt(6)
    s_cmpk_ge_u32 s8, 1134
    s_cbranch_scc1 .ap_6
    s_waitcnt vmcnt(4)
    s_bitcmp1_b64 s[14:15], 27
    s_cbranch_scc0 1
    s_waitcnt vmcnt(3)
    s_cmpk_ge_u32 s8, 1014
    s_cbranch_scc1 .ap_6
    s_waitcnt vmcnt(2)
.ap_6:
    s_add_u32 s63, s69, 417792
    buffer_load_dwordx4 v[92:95], v1, s[40:43], s63 offen nt
    s_memrealtime s[8:9]
    s_waitcnt vmcnt(9)
    s_waitcnt lgkmcnt(0)
    s_sub_u32 s8, s8, s30
    s_cmpk_ge_u32 s8, 1261
    s_cbranch_scc1 .ap_7
    s_waitcnt vmcnt(6)
    s_cmpk_ge_u32 s8, 1161
    s_cbranch_scc1 .ap_7
    s_waitcnt vmcnt(4)
    s_bitcmp1_b64 s[14:15], 28
    s_cbranch_scc0 1
    s_waitcnt vmcnt(3)
    s_cmpk_ge_u32 s8, 1041
    s_cbranch_scc1 .ap_7
    s_waitcnt vmcnt(2)
.ap_7:
    s_add_u32 s63, s69, 425984
    buffer_load_dwordx4 v[120:123], v1, s[40:43], s63 offen nt
    s_memrealtime s[8:9]
    s_waitcnt vmcnt(9)
    s_waitcnt lgkmcnt(0)
    s_sub_u32 s8, s8, s30
    s_cmpk_ge_u32 s8, 1288
    s_cbranch_scc1 .ap_8
    s_waitcnt vmcnt(6)
    s_cmpk_ge_u32 s8, 1188
    s_cbranch_scc1 .ap_8
    s_waitcnt vmcnt(4)
    s_bitcmp1_b64 s[14:15], 29
    s_cbranch_scc0 1
    s_waitcnt vmcnt(3)
    s_cmpk_ge_u32 s8, 1068
    s_cbranch_scc1 .ap_8
    s_waitcnt vmcnt(1)
.ap_8:
    s_add_u32 s63, s69, 434176
    buffer_load_dwordx4 v[124:127], v1, s[40:43], s63 offen nt
    s_memrealtime s[8:9]
    s_waitcnt vmcnt(9)
    s_waitcnt lgkmcnt(0)
    s_sub_u32 s8, s8, s30
    s_cmpk_ge_u32 s8, 1315
    s_cbranch_scc1 .ap_9
    s_waitcnt vmcnt(6)
    s_cmpk_ge_u32 s8, 1215
    s_cbranch_scc1 .ap_9
    s_waitcnt vmcnt(4)
    s_bitcmp1_b64 s[14:15], 30
    s_cbranch_scc0 1
    s_waitcnt vmcnt(2)
    s_cmpk_ge_u32 s8, 1095
    s_cbranch_scc1 .ap_9
    s_waitcnt vmcnt(1)
.ap_9:
    s_add_u32 s63, s69, 442368
    buffer_load_dwordx4 v[152:155], v1, s[40:43], s63 offen nt
    s_waitcnt vmcnt(4)
    s_sub_u32 s63, s70, 300
    v_subrev_u32 v156, s63, v156
    v_mov_b32 v157, 600
    v_cmp_lt_u32 s[8:9], v156, v157
    v_add_u32_dpp v156, v156, v156 quad_perm:[1,0,3,2] row_mask:0xf bank_mask:0xf
    s_nop 1
    v_add_u32_dpp v156, v156, v156 quad_perm:[2,3,0,1] row_mask:0xf bank_mask:0xf
    s_nop 1
    v_add_u32_dpp v156, v156, v156 row_ror:4 row_mask:0xf bank_mask:0xf
    s_nop 0
    v_readfirstlane_b32 s63, v156
    s_cmp_eq_u64 s[8:9], -1
    s_nop 3
    s_cbranch_scc0 .et_10
    s_lshr_b32 s63, s63, 3
    s_sub_u32 s63, s63, 300
    s_add_u32 s30, s30, s63
    s_add_u32 s31, s31, s63
.et_10:
    s_and_b32 s0, s0, 0xffffff80
    s_sub_u32 s0, s0, 1024
    buffer_load_dword v28, v4, s[36:39], s0 offen sc1
    s_memrealtime s[8:9]
    s_waitcnt lgkmcnt(0)
    s_sub_u32 s8, s8, s30
    s_cmpk_ge_u32 s8, 1342
    s_cbranch_scc1 .ap_11
    s_waitcnt vmcnt(5)
    s_cmpk_ge_u32 s8, 1242
    s_cbranch_scc1 .ap_11
    s_waitcnt vmcnt(4)
    s_bitcmp1_b64 s[14:15], 31
    s_cbranch_scc0 1
    s_waitcnt vmcnt(3)
    s_cmpk_ge_u32 s8, 1122
    s_cbranch_scc1 .ap_11
    s_waitcnt vmcnt(2)
.ap_11:
    s_add_u32 s63, s69, 450560
    buffer_load_dwordx4 v[156:159], v1, s[40:43], s63 offen nt
    s_memrealtime s[8:9]
    s_waitcnt lgkmcnt(0)
    s_sub_u32 s8, s8, s30
    s_cmpk_ge_u32 s8, 1369
    s_cbranch_scc1 .ap_12
    s_waitcnt vmcnt(6)
    s_cmpk_ge_u32 s8, 1269
    s_cbranch_scc1 .ap_12
    s_waitcnt vmcnt(4)
    s_bitcmp1_b64 s[14:15], 32
    s_cbranch_scc0 1
    s_waitcnt vmcnt(3)
    s_cmpk_ge_u32 s8, 1149
    s_cbranch_scc1 .ap_12
    s_waitcnt vmcnt(2)
.ap_12:
    v_bfe_u32 v1, v0, 4, 2
    v_and_b32 v10, 0xf0, v2
    v_lshlrev_b32 v1, 2, v1
    v_bfe_u32 v1, s6, v1, 4
    v_lshl_add_u32 v1, v1, 8, v10
    s_add_u32 s63, s69, 0
    buffer_load_dwordx4 v[160:163], v1, s[44:47], s63 offen nt
    s_memrealtime s[8:9]
    s_waitcnt lgkmcnt(0)
    s_sub_u32 s8, s8, s30
    s_cmpk_ge_u32 s8, 1396
    s_cbranch_scc1 .ap_13
    s_waitcnt vmcnt(6)
    s_cmpk_ge_u32 s8, 1296
    s_cbranch_scc1 .ap_13
    s_waitcnt vmcnt(4)
    s_bitcmp1_b64 s[14:15], 33
    s_cbranch_scc0 1
    s_waitcnt vmcnt(3)
    s_cmpk_ge_u32 s8, 1176
    s_cbranch_scc1 .ap_13
    s_waitcnt vmcnt(1)
.ap_13:
    s_add_u32 s63, s69, 8192
    buffer_load_dwordx4 v[164:167], v1, s[44:47], s63 offen nt
    s_memrealtime s[8:9]
    s_waitcnt lgkmcnt(0)
    s_sub_u32 s8, s8, s30
    s_cmpk_ge_u32 s8, 1423
    s_cbranch_scc1 .ap_14
    s_waitcnt vmcnt(6)
    s_cmpk_ge_u32 s8, 1323
    s_cbranch_scc1 .ap_14
    s_branch .Lsk_n1_0
.Lst_n1_0:
    s_branch .Lrt_n1_0
.Lsk_n1_0:
    s_waitcnt vmcnt(4)
    s_bitcmp1_b64 s[14:15], 34
    s_cbranch_scc0 1
    s_waitcnt vmcnt(2)
    s_cmpk_ge_u32 s8, 1203
    s_cbranch_scc1 .ap_14
    s_waitcnt vmcnt(1)
.ap_14:
    s_add_u32 s63, s69, 16384
    buffer_load_dwordx4 v[168:171], v1, s[44:47], s63 offen nt
    s_memrealtime s[8:9]
    s_waitcnt lgkmcnt(0)
    s_sub_u32 s8, s8, s30
    s_cmpk_ge_u32 s8, 1450
    s_cbranch_scc1 .ap_15
    s_waitcnt vmcnt(6)
    s_cmpk_ge_u32 s8, 1350
    s_cbranch_scc1 .ap_15
    s_waitcnt vmcnt(3)
    s_bitcmp1_b64 s[14:15], 35
    s_cbranch_scc0 1
    s_waitcnt vmcnt(2)
    s_cmpk_ge_u32 s8, 1230
    s_cbranch_scc1 .ap_15
    s_waitcnt vmcnt(1)
.ap_15:
    s_add_u32 s63, s69, 24576
    buffer_load_dwordx4 v[172:175], v1, s[44:47], s63 offen nt
    s_waitcnt vmcnt(5)
    v_cmp_eq_u32 vcc, s1, v28
    s_cmp_eq_u64 vcc, -1
    s_cselect_b32 s0, 0x800000, 0
    s_add_u32 s58, s58, s0
    buffer_load_dwordx4 v[16:19], v7, s[36:39], s58 offen offset:0 sc1
    buffer_load_dwordx4 v[20:23], v7, s[36:39], s58 offen offset:256 sc1
    s_memrealtime s[8:9]
    s_waitcnt lgkmcnt(0)
    s_sub_u32 s8, s8, s30
    s_cmpk_ge_u32 s8, 1479
    s_cbranch_scc1 .ap_16
    s_waitcnt vmcnt(5)
    s_cmpk_ge_u32 s8, 1379
    s_cbranch_scc1 .ap_16
    s_waitcnt vmcnt(3)
    s_bitcmp1_b64 s[14:15], 36
    s_cbranch_scc0 1
    s_waitcnt vmcnt(2)
    s_cmpk_ge_u32 s8, 1259
    s_cbranch_scc1 .ap_16
    s_waitcnt vmcnt(1)
.ap_16:
    s_add_u32 s63, s69, 32768
    buffer_load_dwordx4 v[176:179], v1, s[44:47], s63 offen nt
    s_memrealtime s[8:9]
    s_waitcnt lgkmcnt(0)
    s_sub_u32 s8, s8, s30
    s_cmpk_ge_u32 s8, 1509
    s_cbranch_scc1 .ap_17
    s_waitcnt vmcnt(5)
    s_cmpk_ge_u32 s8, 1409
    s_cbranch_scc1 .ap_17
    s_waitcnt vmcnt(3)
    s_bitcmp1_b64 s[14:15], 37
    s_cbranch_scc0 1
    s_waitcnt vmcnt(2)
    s_cmpk_ge_u32 s8, 1289
    s_cbranch_scc1 .ap_17
    s_waitcnt vmcnt(1)
.ap_17:
    s_add_u32 s63, s69, 40960
    buffer_load_dwordx4 v[180:183], v1, s[44:47], s63 offen nt
    s_memrealtime s[8:9]
    s_waitcnt vmcnt(8)
    s_waitcnt lgkmcnt(0)
    s_sub_u32 s8, s8, s30
    s_cmpk_ge_u32 s8, 1539
    s_cbranch_scc1 .ap_18
    s_waitcnt vmcnt(5)
    s_cmpk_ge_u32 s8, 1439
    s_cbranch_scc1 .ap_18
    s_waitcnt vmcnt(3)
    s_bitcmp1_b64 s[14:15], 38
    s_cbranch_scc0 1
    s_waitcnt vmcnt(2)
    s_cmpk_ge_u32 s8, 1319
    s_cbranch_scc1 .ap_18
    s_waitcnt vmcnt(1)
.ap_18:
    s_add_u32 s63, s69, 49152
    buffer_load_dwordx4 v[184:187], v1, s[44:47], s63 offen nt
    s_waitcnt vmcnt(3)
    s_branch .gpc_20
.gp_19:
    s_xor_b32 s58, s58, 0x800000
    buffer_load_dwordx4 v[16:19], v7, s[36:39], s58 offen offset:0 sc1
    buffer_load_dwordx4 v[20:23], v7, s[36:39], s58 offen offset:256 sc1
    s_waitcnt vmcnt(0)
.gpc_20:
    v_min_u32 v10, v17, v19
    v_max_u32 v11, v17, v19
    v_min3_u32 v10, v10, v21, v23
    v_max3_u32 v11, v11, v21, v23
    v_cmp_eq_u32 vcc, s34, v10
    v_cmp_eq_u32 s[56:57], s34, v11
    s_and_b64 vcc, vcc, s[56:57]
    s_cmp_eq_u64 vcc, -1
    s_nop 2
    s_cbranch_scc1 .gpd_21
    s_sub_u32 s35, s35, 1
    s_cbranch_scc1 .Lexit
    s_sleep 1
    s_branch .gp_19
.gpd_21:
    s_mov_b32 vcc_lo, 0xcccccccc
    s_mov_b32 vcc_hi, 0xcccccccc
    v_cndmask_b32_e64 v24, v16, 0, vcc
    v_cndmask_b32_e64 v25, v18, 0, vcc
    v_cndmask_b32_e64 v26, v20, 0, vcc
    v_cndmask_b32_e64 v27, v22, 0, vcc
    v_cndmask_b32_e32 v28, 0, v16, vcc
    v_cndmask_b32_e32 v29, 0, v18, vcc
    v_cndmask_b32_e32 v30, 0, v20, vcc
    v_cndmask_b32_e32 v31, 0, v22, vcc
    v_mfma_f32_16x16x32_bf16 v[16:19], v[32:35], v[24:27], 0
    v_mfma_f32_16x16x32_bf16 v[32:35], v[40:43], v[24:27], 0
    v_mfma_f32_16x16x32_bf16 v[16:19], v[36:39], v[28:31], v[16:19]
    v_mfma_f32_16x16x32_bf16 v[40:43], v[48:51], v[24:27], 0
    v_mfma_f32_16x16x32_bf16 v[32:35], v[44:47], v[28:31], v[32:35]
    v_mfma_f32_16x16x32_bf16 v[48:51], v[56:59], v[24:27], 0
    v_mfma_f32_16x16x32_bf16 v[40:43], v[52:55], v[28:31], v[40:43]
    v_mfma_f32_16x16x32_bf16 v[56:59], v[64:67], v[24:27], 0
    v_mfma_f32_16x16x32_bf16 v[48:51], v[60:63], v[28:31], v[48:51]
    s_nop 1
    v_add_f32_dpp v10, v17, v16 row_ror:12 row_mask:0xf bank_mask:0x1
    s_memrealtime s[8:9]
    s_waitcnt lgkmcnt(0)
    s_sub_u32 s8, s8, s30
    s_cmpk_ge_u32 s8, 1569
    s_nop 0
    s_cbranch_scc1 .ap_22
    s_waitcnt vmcnt(3)
    s_cmpk_ge_u32 s8, 1469
    s_cbranch_scc1 .ap_22
    s_waitcnt vmcnt(3)
    s_bitcmp1_b64 s[14:15], 39
    s_cbranch_scc0 1
    s_waitcnt vmcnt(2)
    s_cmpk_ge_u32 s8, 1349
    s_cbranch_scc1 .ap_22
    s_waitcnt vmcnt(1)
.ap_22:
    s_add_u32 s63, s69, 57344
    buffer_load_dwordx4 v[188:191], v1, s[44:47], s63 offen nt
    v_mfma_f32_16x16x32_bf16 v[64:67], v[72:75], v[24:27], 0
    v_mfma_f32_16x16x32_bf16 v[56:59], v[68:71], v[28:31], v[56:59]
    v_add_f32_dpp v11, v33, v32 row_ror:12 row_mask:0xf bank_mask:0x1
    v_add_f32_dpp v10, v18, v10 row_ror:8 row_mask:0xf bank_mask:0x1
    v_mfma_f32_16x16x32_bf16 v[72:75], v[80:83], v[24:27], 0
    v_mfma_f32_16x16x32_bf16 v[64:67], v[76:79], v[28:31], v[64:67]
    v_add_f32_dpp v12, v41, v40 row_ror:12 row_mask:0xf bank_mask:0x1
    v_add_f32_dpp v11, v34, v11 row_ror:8 row_mask:0xf bank_mask:0x1
    v_add_f32_dpp v10, v19, v10 row_ror:4 row_mask:0xf bank_mask:0x1
    v_mfma_f32_16x16x32_bf16 v[80:83], v[88:91], v[24:27], 0
    v_mfma_f32_16x16x32_bf16 v[72:75], v[84:87], v[28:31], v[72:75]
    v_add_f32_dpp v13, v49, v48 row_ror:12 row_mask:0xf bank_mask:0x1
    v_add_f32_dpp v12, v42, v12 row_ror:8 row_mask:0xf bank_mask:0x1
    v_add_f32_dpp v11, v35, v11 row_ror:4 row_mask:0xf bank_mask:0x1
    v_mfma_f32_16x16x32_bf16 v[88:91], v[96:99], v[24:27], 0
    v_mfma_f32_16x16x32_bf16 v[80:83], v[92:95], v[28:31], v[80:83]
    v_add_f32_dpp v10, v58, v57 row_ror:12 row_mask:0xf bank_mask:0x2
    v_add_f32_dpp v13, v50, v13 row_ror:8 row_mask:0xf bank_mask:0x1
    v_add_f32_dpp v12, v43, v12 row_ror:4 row_mask:0xf bank_mask:0x1
    s_memrealtime s[8:9]
    s_waitcnt lgkmcnt(0)
    s_sub_u32 s8, s8, s30
    s_cmpk_ge_u32 s8, 1599
    s_nop 0
    s_cbranch_scc1 .ap_23
    s_waitcnt vmcnt(4)
    s_cmpk_ge_u32 s8, 1499
    s_cbranch_scc1 .ap_23
    s_waitcnt vmcnt(3)
    s_bitcmp1_b64 s[14:15], 40
    s_cbranch_scc0 1
    s_waitcnt vmcnt(2)
    s_cmpk_ge_u32 s8, 1379
    s_cbranch_scc1 .ap_23
    s_waitcnt vmcnt(1)
.ap_23:
    s_add_u32 s63, s69, 131072
    buffer_load_dwordx4 v[192:195], v1, s[44:47], s63 offen nt
    v_mfma_f32_16x16x32_bf16 v[96:99], v[104:107], v[24:27], 0
    v_mfma_f32_16x16x32_bf16 v[88:91], v[100:103], v[28:31], v[88:91]
    v_add_f32_dpp v11, v66, v65 row_ror:12 row_mask:0xf bank_mask:0x2
    v_add_f32_dpp v10, v59, v10 row_ror:8 row_mask:0xf bank_mask:0x2
    v_add_f32_dpp v13, v51, v13 row_ror:4 row_mask:0xf bank_mask:0x1
    v_mfma_f32_16x16x32_bf16 v[104:107], v[112:115], v[24:27], 0
    v_mfma_f32_16x16x32_bf16 v[96:99], v[108:111], v[28:31], v[96:99]
    v_add_f32_dpp v12, v74, v73 row_ror:12 row_mask:0xf bank_mask:0x2
    v_add_f32_dpp v11, v67, v11 row_ror:8 row_mask:0xf bank_mask:0x2
    v_add_f32_dpp v10, v56, v10 row_ror:4 row_mask:0xf bank_mask:0x2
    v_mfma_f32_16x16x32_bf16 v[112:115], v[120:123], v[24:27], 0
    v_mfma_f32_16x16x32_bf16 v[104:107], v[116:119], v[28:31], v[104:107]
    s_branch .Lsk_n1_1
.Lst_n1_1:
    s_branch .Lrt_n1_1
.Lsk_n1_1:
    v_add_f32_dpp v13, v82, v81 row_ror:12 row_mask:0xf bank_mask:0x2
    v_add_f32_dpp v12, v75, v12 row_ror:8 row_mask:0xf bank_mask:0x2
    v_add_f32_dpp v11, v64, v11 row_ror:4 row_mask:0xf bank_mask:0x2
    v_mfma_f32_16x16x32_bf16 v[120:123], v[128:131], v[24:27], 0
    v_mfma_f32_16x16x32_bf16 v[112:115], v[124:127], v[28:31], v[112:115]
    v_add_f32_dpp v10, v91, v90 row_ror:12 row_mask:0xf bank_mask:0x4
    v_add_f32_dpp v13, v83, v13 row_ror:8 row_mask:0xf bank_mask:0x2
    v_add_f32_dpp v12, v72, v12 row_ror:4 row_mask:0xf bank_mask:0x2
    s_memrealtime s[8:9]
    s_waitcnt lgkmcnt(0)
    s_sub_u32 s8, s8, s30
    s_cmpk_ge_u32 s8, 1629
    s_nop 0
    s_cbranch_scc1 .ap_24
    s_waitcnt vmcnt(5)
    s_cmpk_ge_u32 s8, 1529
    s_cbranch_scc1 .ap_24
    s_waitcnt vmcnt(3)
    s_bitcmp1_b64 s[14:15], 41
    s_cbranch_scc0 1
    s_waitcnt vmcnt(2)
    s_cmpk_ge_u32 s8, 1409
    s_cbranch_scc1 .ap_24
    s_waitcnt vmcnt(1)
.ap_24:
    s_add_u32 s63, s69, 139264
    buffer_load_dwordx4 v[196:199], v1, s[44:47], s63 offen nt
    v_mfma_f32_16x16x32_bf16 v[128:131], v[136:139], v[24:27], 0
    v_mfma_f32_16x16x32_bf16 v[120:123], v[132:135], v[28:31], v[120:123]
    v_add_f32_dpp v11, v99, v98 row_ror:12 row_mask:0xf bank_mask:0x4
    v_add_f32_dpp v10, v88, v10 row_ror:8 row_mask:0xf bank_mask:0x4
    v_add_f32_dpp v13, v80, v13 row_ror:4 row_mask:0xf bank_mask:0x2
    s_branch .Lsk_n1_2
.Lst_n1_2:
    s_branch .Lrt_n1_2
.Lsk_n1_2:
    v_mfma_f32_16x16x32_bf16 v[136:139], v[144:147], v[24:27], 0
    v_mfma_f32_16x16x32_bf16 v[128:131], v[140:143], v[28:31], v[128:131]
    v_add_f32_dpp v12, v107, v106 row_ror:12 row_mask:0xf bank_mask:0x4
    v_add_f32_dpp v11, v96, v11 row_ror:8 row_mask:0xf bank_mask:0x4
    v_add_f32_dpp v10, v89, v10 row_ror:4 row_mask:0xf bank_mask:0x4
    v_mfma_f32_16x16x32_bf16 v[144:147], v[152:155], v[24:27], 0
    v_mfma_f32_16x16x32_bf16 v[136:139], v[148:151], v[28:31], v[136:139]
    v_add_f32_dpp v13, v115, v114 row_ror:12 row_mask:0xf bank_mask:0x4
    v_add_f32_dpp v12, v104, v12 row_ror:8 row_mask:0xf bank_mask:0x4
    v_add_f32_dpp v11, v97, v11 row_ror:4 row_mask:0xf bank_mask:0x4
    v_mfma_f32_16x16x32_bf16 v[144:147], v[156:159], v[28:31], v[144:147]
    v_add_f32_dpp v10, v120, v123 row_ror:12 row_mask:0xf bank_mask:0x8
    v_add_f32_dpp v13, v112, v13 row_ror:8 row_mask:0xf bank_mask:0x4
    v_add_f32_dpp v12, v105, v12 row_ror:4 row_mask:0xf bank_mask:0x4
    s_memrealtime s[8:9]
    s_waitcnt lgkmcnt(0)
    s_sub_u32 s8, s8, s30
    s_cmpk_ge_u32 s8, 1659
    s_nop 0
    s_cbranch_scc1 .ap_25
    s_waitcnt vmcnt(5)
    s_cmpk_ge_u32 s8, 1559
    s_cbranch_scc1 .ap_25
    s_waitcnt vmcnt(3)
    s_bitcmp1_b64 s[14:15], 42
    s_cbranch_scc0 1
    s_waitcnt vmcnt(2)
    s_cmpk_ge_u32 s8, 1439
    s_cbranch_scc1 .ap_25
    s_waitcnt vmcnt(1)
.ap_25:
    s_add_u32 s63, s69, 147456
    buffer_load_dwordx4 v[200:203], v1, s[44:47], s63 offen nt
    v_add_f32_dpp v11, v128, v131 row_ror:12 row_mask:0xf bank_mask:0x8
    v_add_f32_dpp v10, v121, v10 row_ror:8 row_mask:0xf bank_mask:0x8
    v_add_f32_dpp v13, v113, v13 row_ror:4 row_mask:0xf bank_mask:0x4
    v_add_f32_dpp v12, v136, v139 row_ror:12 row_mask:0xf bank_mask:0x8
    v_add_f32_dpp v11, v129, v11 row_ror:8 row_mask:0xf bank_mask:0x8
    v_add_f32_dpp v10, v122, v10 row_ror:4 row_mask:0xf bank_mask:0x8
    v_add_f32_dpp v13, v144, v147 row_ror:12 row_mask:0xf bank_mask:0x8
    v_add_f32_dpp v12, v137, v12 row_ror:8 row_mask:0xf bank_mask:0x8
    v_add_f32_dpp v11, v130, v11 row_ror:4 row_mask:0xf bank_mask:0x8
    v_add_f32_dpp v13, v145, v13 row_ror:8 row_mask:0xf bank_mask:0x8
    v_add_f32_dpp v12, v138, v12 row_ror:4 row_mask:0xf bank_mask:0x8
    s_memrealtime s[8:9]
    s_waitcnt lgkmcnt(0)
    s_sub_u32 s8, s8, s30
    s_cmpk_ge_u32 s8, 1689
    s_cbranch_scc1 .ap_26
    s_waitcnt vmcnt(5)
    s_cmpk_ge_u32 s8, 1589
    s_cbranch_scc1 .ap_26
    s_waitcnt vmcnt(3)
    s_bitcmp1_b64 s[14:15], 43
    s_cbranch_scc0 1
    s_waitcnt vmcnt(2)
    s_cmpk_ge_u32 s8, 1469
    s_cbranch_scc1 .ap_26
    s_waitcnt vmcnt(1)
.ap_26:
    s_add_u32 s63, s69, 155648
    buffer_load_dwordx4 v[204:207], v1, s[44:47], s63 offen nt
    v_add_f32_dpp v13, v146, v13 row_ror:4 row_mask:0xf bank_mask:0x8
    s_mov_b32 s60, 0x3db504f3
    s_mov_b32 s61, 0x3db504f3
    v_cvt_pk_bf16_f32 v10, v10, v11
    v_and_b32 v11, 0xffff0000, v10
    v_lshlrev_b32 v10, 16, v10
    v_cvt_pk_bf16_f32 v12, v12, v13
    v_and_b32 v13, 0xffff0000, v12
    v_lshlrev_b32 v12, 16, v12
    v_pk_mul_f32 v[10:11], v[10:11], s[60:61]
    v_pk_mul_f32 v[12:13], v[12:13], s[60:61]
    v_cvt_pk_bf16_f32 v10, v10, v11
    v_and_b32 v11, 0xffff0000, v10
    v_lshlrev_b32 v10, 16, v10
    v_cvt_pk_bf16_f32 v12, v12, v13
    v_and_b32 v13, 0xffff0000, v12
    v_lshlrev_b32 v12, 16, v12
    v_max_f32 v14, v10, v11
    v_max3_f32 v14, v14, v12, v13
    s_mov_b32 s60, 0x3fb8aa3b
    v_mov_b32 v22, s34
    v_mov_b32 v23, s34
    v_max_f32_dpp v14, v14, v14 quad_perm:[2,3,0,1] row_mask:0xf bank_mask:0xf
    s_nop 1
    v_max_f32_dpp v14, v14, v14 row_ror:4 row_mask:0xf bank_mask:0xf
    s_nop 1
    v_max_f32_dpp v14, v14, v14 row_ror:8 row_mask:0xf bank_mask:0xf
    v_mov_b32 v15, v14
    s_nop 1
    v_permlane16_swap_b32 v15, v14
    v_max_f32 v14, v15, v14
    v_mov_b32 v15, v14
    s_nop 1
    v_permlane32_swap_b32 v15, v14
    v_max_f32 v14, v15, v14
    v_mul_f32 v15, 0xbfb8aa3b, v14
    v_fma_f32 v10, v10, s60, v15
    v_fma_f32 v11, v11, s60, v15
    v_fma_f32 v12, v12, s60, v15
    v_fma_f32 v13, v13, s60, v15
    v_exp_f32 v10, v10
    v_exp_f32 v11, v11
    v_exp_f32 v12, v12
    v_exp_f32 v13, v13
    v_mov_b32 v20, v14
    v_pk_add_f32 v[16:17], v[10:11], v[12:13]
    v_add_f32 v21, v16, v17
    s_lshl_b32 s60, s68, 5
    s_lshl_b32 s61, s3, 4
    s_add_u32 s61, s61, 159104
    v_add_u32 v16, s61, v3
    v_mov_b32 v17, 159232
    v_mov_b32 v18, 1
    s_add_u32 s60, s60, s59
    v_add_f32_dpp v21, v21, v21 quad_perm:[2,3,0,1] row_mask:0xf bank_mask:0xf
    s_nop 1
    v_add_f32_dpp v21, v21, v21 row_ror:4 row_mask:0xf bank_mask:0xf
    s_nop 1
    v_add_f32_dpp v21, v21, v21 row_ror:8 row_mask:0xf bank_mask:0xf
    v_mov_b32 v15, v21
    s_nop 1
    v_permlane16_swap_b32 v15, v21
    v_add_f32 v21, v15, v21
    v_mov_b32 v15, v21
    s_nop 1
    v_permlane32_swap_b32 v15, v21
    v_add_f32 v21, v15, v21
    s_mov_b64 exec, 3
    ds_write_b64 v16, v[20:21]
    s_mov_b64 exec, 1
    ds_add_rtn_u32 v18, v17, v18
    s_mov_b64 exec, -1
    v_and_b32 v16, 0x78, v3
    v_or_b32 v16, 159104, v16
    s_waitcnt lgkmcnt(0)
    v_readfirstlane_b32 s61, v18
    s_cmp_eq_u32 s61, 7
    s_nop 3
    s_cbranch_scc0 .mlc_27
    ds_read_b64 v[18:19], v16
    s_waitcnt lgkmcnt(0)
    v_mov_b32 v20, v18
    s_nop 1
    v_max_f32_dpp v20, v20, v20 quad_perm:[2,3,0,1] row_mask:0xf bank_mask:0xf
    s_nop 1
    v_max_f32_dpp v20, v20, v20 row_ror:4 row_mask:0xf bank_mask:0xf
    s_nop 1
    v_max_f32_dpp v20, v20, v20 row_ror:8 row_mask:0xf bank_mask:0xf
    v_sub_f32 v18, v18, v20
    v_mul_f32 v18, 0x3fb8aa3b, v18
    v_exp_f32 v18, v18
    s_nop 0
    v_mul_f32 v21, v18, v19
    s_nop 1
    v_add_f32_dpp v21, v21, v21 quad_perm:[2,3,0,1] row_mask:0xf bank_mask:0xf
    s_nop 1
    v_add_f32_dpp v21, v21, v21 row_ror:4 row_mask:0xf bank_mask:0xf
    s_nop 1
    v_add_f32_dpp v21, v21, v21 row_ror:8 row_mask:0xf bank_mask:0xf
    s_mov_b64 exec, 3
    s_add_u32 s57, s60, 0x800000
    buffer_store_dwordx4 v[20:23], v2, s[36:39], s57 offen
    s_cmp_lg_u32 s0, 0
    s_nop 0
    s_cbranch_scc1 .nosl_28
    buffer_store_dwordx4 v[20:23], v2, s[36:39], s60 offen sc1
.nosl_28:
    s_mov_b64 exec, -1
.mlc_27:
    s_add_u32 s59, s59, s0
    s_memrealtime s[8:9]
    s_waitcnt lgkmcnt(0)
    s_sub_u32 s8, s8, s30
    s_cmpk_ge_u32 s8, 1719
    s_cbranch_scc1 .ap_29
    s_waitcnt vmcnt(5)
    s_cmpk_ge_u32 s8, 1619
    s_cbranch_scc1 .ap_29
    s_waitcnt vmcnt(3)
    s_bitcmp1_b64 s[14:15], 44
    s_cbranch_scc0 1
    s_waitcnt vmcnt(2)
    s_cmpk_ge_u32 s8, 1499
    s_cbranch_scc1 .ap_29
    s_waitcnt vmcnt(1)
.ap_29:
    s_add_u32 s63, s69, 163840
    buffer_load_dwordx4 v[208:211], v1, s[44:47], s63 offen nt
    s_memrealtime s[8:9]
    s_waitcnt vmcnt(8)
    s_waitcnt lgkmcnt(0)
    s_sub_u32 s8, s8, s30
    s_cmpk_ge_u32 s8, 1749
    s_cbranch_scc1 .ap_30
    s_branch .Lsk_n1_3
.Lst_n1_3:
    s_branch .Lrt_n1_3
.Lsk_n1_3:
    s_waitcnt vmcnt(5)
    s_cmpk_ge_u32 s8, 1649
    s_cbranch_scc1 .ap_30
    s_waitcnt vmcnt(3)
    s_bitcmp1_b64 s[14:15], 45
    s_cbranch_scc0 1
    s_waitcnt vmcnt(2)
    s_cmpk_ge_u32 s8, 1529
    s_cbranch_scc1 .ap_30
    s_waitcnt vmcnt(1)
.ap_30:
    s_add_u32 s63, s69, 172032
    buffer_load_dwordx4 v[212:215], v1, s[44:47], s63 offen nt
    s_memrealtime s[8:9]
    s_waitcnt vmcnt(8)
    s_waitcnt lgkmcnt(0)
    s_sub_u32 s8, s8, s30
    s_cmpk_ge_u32 s8, 1780
    s_cbranch_scc1 .ap_31
    s_waitcnt vmcnt(5)
    s_cmpk_ge_u32 s8, 1680
    s_cbranch_scc1 .ap_31
    s_waitcnt vmcnt(3)
    s_bitcmp1_b64 s[14:15], 46
    s_cbranch_scc0 1
    s_waitcnt vmcnt(2)
    s_cmpk_ge_u32 s8, 1560
    s_cbranch_scc1 .ap_31
    s_waitcnt vmcnt(1)
.ap_31:
    s_add_u32 s63, s69, 180224
    buffer_load_dwordx4 v[216:219], v1, s[44:47], s63 offen nt
    s_memrealtime s[8:9]
    s_waitcnt vmcnt(8)
    s_waitcnt lgkmcnt(0)
    s_sub_u32 s8, s8, s30
    s_cmpk_ge_u32 s8, 1812
    s_cbranch_scc1 .ap_32
    s_waitcnt vmcnt(5)
    s_cmpk_ge_u32 s8, 1712
    s_cbranch_scc1 .ap_32
    s_waitcnt vmcnt(3)
    s_bitcmp1_b64 s[14:15], 47
    s_cbranch_scc0 1
    s_waitcnt vmcnt(2)
    s_cmpk_ge_u32 s8, 1592
    s_cbranch_scc1 .ap_32
    s_waitcnt vmcnt(1)
.ap_32:
    s_add_u32 s63, s69, 188416
    buffer_load_dwordx4 v[220:223], v1, s[44:47], s63 offen nt
    s_memrealtime s[8:9]
    s_waitcnt vmcnt(8)
    s_waitcnt lgkmcnt(0)
    s_sub_u32 s8, s8, s30
    s_cmpk_ge_u32 s8, 1844
    s_cbranch_scc1 .ap_33
    s_waitcnt vmcnt(5)
    s_cmpk_ge_u32 s8, 1744
    s_cbranch_scc1 .ap_33
    s_waitcnt vmcnt(3)
    s_bitcmp1_b64 s[14:15], 48
    s_cbranch_scc0 1
    s_waitcnt vmcnt(2)
    s_cmpk_ge_u32 s8, 1624
    s_cbranch_scc1 .ap_33
    s_waitcnt vmcnt(1)
.ap_33:
    s_add_u32 s63, s69, 262144
    buffer_load_dwordx4 v[224:227], v1, s[44:47], s63 offen nt
    s_memrealtime s[8:9]
    s_waitcnt vmcnt(8)
    s_waitcnt lgkmcnt(0)
    s_sub_u32 s8, s8, s30
    s_cmpk_ge_u32 s8, 1876
    s_cbranch_scc1 .ap_34
    s_waitcnt vmcnt(5)
    s_cmpk_ge_u32 s8, 1776
    s_cbranch_scc1 .ap_34
    s_waitcnt vmcnt(3)
    s_bitcmp1_b64 s[14:15], 49
    s_cbranch_scc0 1
    s_waitcnt vmcnt(2)
    s_cmpk_ge_u32 s8, 1656
    s_cbranch_scc1 .ap_34
    s_waitcnt vmcnt(1)
.ap_34:
    s_add_u32 s63, s69, 270336
    buffer_load_dwordx4 v[228:231], v1, s[44:47], s63 offen nt
    s_memrealtime s[8:9]
    s_waitcnt vmcnt(8)
    s_waitcnt lgkmcnt(0)
    s_sub_u32 s8, s8, s30
    s_cmpk_ge_u32 s8, 1908
    s_cbranch_scc1 .ap_35
    s_waitcnt vmcnt(5)
    s_cmpk_ge_u32 s8, 1808
    s_cbranch_scc1 .ap_35
    s_waitcnt vmcnt(3)
    s_bitcmp1_b64 s[14:15], 50
    s_cbranch_scc0 1
    s_waitcnt vmcnt(2)
    s_cmpk_ge_u32 s8, 1688
    s_cbranch_scc1 .ap_35
    s_waitcnt vmcnt(1)
.ap_35:
    s_add_u32 s63, s69, 278528
    buffer_load_dwordx4 v[232:235], v1, s[44:47], s63 offen nt
    s_memrealtime s[8:9]
    s_waitcnt vmcnt(8)
    s_waitcnt lgkmcnt(0)
    s_sub_u32 s8, s8, s30
    s_cmpk_ge_u32 s8, 1939
    s_cbranch_scc1 .ap_36
    s_waitcnt vmcnt(5)
    s_cmpk_ge_u32 s8, 1839
    s_cbranch_scc1 .ap_36
    s_waitcnt vmcnt(3)
    s_bitcmp1_b64 s[14:15], 51
    s_cbranch_scc0 1
    s_waitcnt vmcnt(2)
    s_cmpk_ge_u32 s8, 1719
    s_cbranch_scc1 .ap_36
    s_waitcnt vmcnt(1)
.ap_36:
    s_add_u32 s63, s69, 286720
    buffer_load_dwordx4 v[236:239], v1, s[44:47], s63 offen nt
    s_memrealtime s[8:9]
    s_waitcnt vmcnt(8)
    s_waitcnt lgkmcnt(0)
    s_sub_u32 s8, s8, s30
    s_cmpk_ge_u32 s8, 1971
    s_cbranch_scc1 .ap_37
    s_waitcnt vmcnt(5)
    s_cmpk_ge_u32 s8, 1871
    s_cbranch_scc1 .ap_37
    s_waitcnt vmcnt(3)
    s_bitcmp1_b64 s[14:15], 52
    s_cbranch_scc0 1
    s_waitcnt vmcnt(2)
    s_cmpk_ge_u32 s8, 1751
    s_cbranch_scc1 .ap_37
    s_waitcnt vmcnt(1)
.ap_37:
    s_add_u32 s63, s69, 294912
    buffer_load_dwordx4 v[240:243], v1, s[44:47], s63 offen nt
    s_memrealtime s[8:9]
    s_waitcnt vmcnt(8)
    s_waitcnt lgkmcnt(0)
    s_sub_u32 s8, s8, s30
    s_cmpk_ge_u32 s8, 2003
    s_cbranch_scc1 .ap_38
    s_waitcnt vmcnt(5)
    s_cmpk_ge_u32 s8, 1903
    s_cbranch_scc1 .ap_38
    s_waitcnt vmcnt(3)
    s_bitcmp1_b64 s[14:15], 53
    s_cbranch_scc0 1
    s_waitcnt vmcnt(2)
    s_cmpk_ge_u32 s8, 1783
    s_cbranch_scc1 .ap_38
    s_waitcnt vmcnt(1)
.ap_38:
    s_add_u32 s63, s69, 303104
    buffer_load_dwordx4 v[244:247], v1, s[44:47], s63 offen nt
    buffer_load_dwordx4 v[24:27], v9, s[36:39], s59 offen offset:0 sc1
    s_memrealtime s[8:9]
    s_waitcnt vmcnt(8)
    s_waitcnt lgkmcnt(0)
    s_sub_u32 s8, s8, s30
    s_cmpk_ge_u32 s8, 2035
    s_cbranch_scc1 .ap_39
    s_waitcnt vmcnt(5)
    s_cmpk_ge_u32 s8, 1935
    s_cbranch_scc1 .ap_39
    s_waitcnt vmcnt(3)
    s_bitcmp1_b64 s[14:15], 54
    s_cbranch_scc0 1
    s_waitcnt vmcnt(2)
    s_cmpk_ge_u32 s8, 1815
    s_cbranch_scc1 .ap_39
    s_waitcnt vmcnt(1)
.ap_39:
    s_add_u32 s63, s69, 311296
    buffer_load_dwordx4 v[248:251], v1, s[44:47], s63 offen nt
    s_memrealtime s[8:9]
    s_waitcnt vmcnt(8)
    s_waitcnt lgkmcnt(0)
    s_sub_u32 s8, s8, s30
    s_cmpk_ge_u32 s8, 2067
    s_cbranch_scc1 .ap_40
    s_waitcnt vmcnt(5)
    s_cmpk_ge_u32 s8, 1967
    s_cbranch_scc1 .ap_40
    s_waitcnt vmcnt(3)
    s_bitcmp1_b64 s[14:15], 55
    s_cbranch_scc0 1
    s_waitcnt vmcnt(2)
    s_cmpk_ge_u32 s8, 1847
    s_cbranch_scc1 .ap_40
    s_waitcnt vmcnt(1)
.ap_40:
    s_add_u32 s63, s69, 319488
    buffer_load_dwordx4 v[252:255], v1, s[44:47], s63 offen nt
    s_memrealtime s[8:9]
    s_waitcnt vmcnt(8)
    s_waitcnt lgkmcnt(0)
    s_sub_u32 s8, s8, s30
    s_cmpk_ge_u32 s8, 2098
    s_cbranch_scc1 .ap_41
    s_waitcnt vmcnt(5)
    s_cmpk_ge_u32 s8, 1998
    s_cbranch_scc1 .ap_41
    s_waitcnt vmcnt(3)
    s_bitcmp1_b64 s[14:15], 56
    s_cbranch_scc0 1
    s_waitcnt vmcnt(2)
    s_cmpk_ge_u32 s8, 1878
    s_cbranch_scc1 .ap_41
    s_waitcnt vmcnt(1)
.ap_41:
    s_add_u32 s63, s69, 393216
    buffer_load_dwordx4 v[36:39], v1, s[44:47], s63 offen nt
    s_memrealtime s[8:9]
    s_waitcnt vmcnt(8)
    s_waitcnt lgkmcnt(0)
    s_sub_u32 s8, s8, s30
    s_cmpk_ge_u32 s8, 2130
    s_cbranch_scc1 .ap_42
    s_waitcnt vmcnt(5)
    s_cmpk_ge_u32 s8, 2030
    s_cbranch_scc1 .ap_42
    s_waitcnt vmcnt(3)
    s_bitcmp1_b64 s[14:15], 57
    s_cbranch_scc0 1
    s_waitcnt vmcnt(2)
    s_cmpk_ge_u32 s8, 1910
    s_cbranch_scc1 .ap_42
    s_waitcnt vmcnt(1)
.ap_42:
    s_add_u32 s63, s69, 401408
    buffer_load_dwordx4 v[44:47], v1, s[44:47], s63 offen nt
    s_memrealtime s[8:9]
    s_branch .Lsk_n1_4
.Lst_n1_4:
    s_branch .Lrt_n1_4
.Lsk_n1_4:
    s_waitcnt vmcnt(8)
    s_waitcnt lgkmcnt(0)
    s_sub_u32 s8, s8, s30
    s_cmpk_ge_u32 s8, 2162
    s_cbranch_scc1 .ap_43
    s_waitcnt vmcnt(5)
    s_cmpk_ge_u32 s8, 2062
    s_cbranch_scc1 .ap_43
    s_waitcnt vmcnt(3)
    s_bitcmp1_b64 s[14:15], 58
    s_cbranch_scc0 1
    s_waitcnt vmcnt(2)
    s_cmpk_ge_u32 s8, 1942
    s_cbranch_scc1 .ap_43
    s_waitcnt vmcnt(1)
.ap_43:
    s_add_u32 s63, s69, 409600
    buffer_load_dwordx4 v[52:55], v1, s[44:47], s63 offen nt
    s_waitcnt vmcnt(5)
    s_branch .gpc_45
.gp_44:
    s_xor_b32 s59, s59, 0x800000
    buffer_load_dwordx4 v[24:27], v9, s[36:39], s59 offen offset:0 sc1
    s_waitcnt vmcnt(0)
.gpc_45:
    v_cmp_eq_u32 vcc, s34, v26
    s_cmp_eq_u64 vcc, -1
    s_nop 3
    s_cbranch_scc1 .gpd_46
    s_sub_u32 s35, s35, 1
    s_cbranch_scc1 .Lexit
    s_sleep 1
    s_branch .gp_44
.gpd_46:
    v_mov_b32 v16, v24
    s_nop 1
    v_max_f32_dpp v16, v16, v16 row_ror:4 row_mask:0xf bank_mask:0xf
    v_sub_f32 v17, v24, v16
    v_sub_f32 v18, v14, v16
    v_mul_f32 v17, 0x3fb8aa3b, v17
    v_mul_f32 v18, 0x3fb8aa3b, v18
    v_exp_f32 v17, v17
    v_exp_f32 v18, v18
    v_mul_f32 v17, v17, v25
    s_nop 1
    v_add_f32_dpp v17, v17, v17 row_ror:4 row_mask:0xf bank_mask:0xf
    v_rcp_f32 v19, v17
    s_nop 0
    v_fma_f32 v15, -v17, v19, 1.0
    v_fma_f32 v19, v15, v19, v19
    v_mul_f32 v18, v18, v19
    v_mul_f32 v10, v10, v18
    v_mul_f32 v11, v11, v18
    v_mul_f32 v12, v12, v18
    v_mul_f32 v13, v13, v18
    v_mov_b32_dpp v112, v10 quad_perm:[2,3,0,1] row_mask:0xf bank_mask:0xf
    v_mov_b32_dpp v113, v11 quad_perm:[2,3,0,1] row_mask:0xf bank_mask:0xf
    v_mov_b32_dpp v114, v12 quad_perm:[2,3,0,1] row_mask:0xf bank_mask:0xf
    v_mov_b32_dpp v115, v13 quad_perm:[2,3,0,1] row_mask:0xf bank_mask:0xf
    v_cvt_pk_bf16_f32 v96, v10, v112
    v_cvt_pk_bf16_f32 v100, v11, v113
    v_cvt_pk_bf16_f32 v104, v12, v114
    v_cvt_pk_bf16_f32 v108, v13, v115
    v_mov_b32_dpp v97, v96 row_ror:12 row_mask:0xf bank_mask:0xf
    v_mov_b32_dpp v101, v100 row_ror:12 row_mask:0xf bank_mask:0xf
    v_mov_b32_dpp v105, v104 row_ror:12 row_mask:0xf bank_mask:0xf
    v_mov_b32_dpp v109, v108 row_ror:12 row_mask:0xf bank_mask:0xf
    v_mov_b32_dpp v98, v96 row_ror:8 row_mask:0xf bank_mask:0xf
    v_mov_b32_dpp v102, v100 row_ror:8 row_mask:0xf bank_mask:0xf
    v_mov_b32_dpp v106, v104 row_ror:8 row_mask:0xf bank_mask:0xf
    v_mov_b32_dpp v110, v108 row_ror:8 row_mask:0xf bank_mask:0xf
    v_mov_b32_dpp v99, v96 row_ror:4 row_mask:0xf bank_mask:0xf
    v_mov_b32_dpp v103, v100 row_ror:4 row_mask:0xf bank_mask:0xf
    v_mov_b32_dpp v107, v104 row_ror:4 row_mask:0xf bank_mask:0xf
    v_mov_b32_dpp v111, v108 row_ror:4 row_mask:0xf bank_mask:0xf
    s_lshl_b32 s60, s3, 10
    s_add_u32 s60, s60, 147456
    v_lshlrev_b32 v10, 5, v0
    v_add_u32 v10, s60, v10
    s_memrealtime s[8:9]
    s_waitcnt lgkmcnt(0)
    s_sub_u32 s8, s8, s30
    s_cmpk_ge_u32 s8, 2194
    s_cbranch_scc1 .ap_47
    s_waitcnt vmcnt(5)
    s_cmpk_ge_u32 s8, 2094
    s_cbranch_scc1 .ap_47
    s_waitcnt vmcnt(3)
    s_bitcmp1_b64 s[14:15], 59
    s_cbranch_scc0 1
    s_waitcnt vmcnt(2)
    s_cmpk_ge_u32 s8, 1974
    s_cbranch_scc1 .ap_47
    s_waitcnt vmcnt(1)
.ap_47:
    s_add_u32 s63, s69, 417792
    buffer_load_dwordx4 v[60:63], v1, s[44:47], s63 offen nt
    v_perm_b32 v112, v164, v160, s94
    v_perm_b32 v113, v172, v168, s94
    v_perm_b32 v114, v180, v176, s94
    v_perm_b32 v115, v188, v184, s94
    s_nop 1
    v_mfma_f32_16x16x32_bf16 v[128:131], v[96:99], v[112:115], 0
    v_perm_b32 v116, v164, v160, s95
    v_perm_b32 v117, v172, v168, s95
    v_perm_b32 v118, v180, v176, s95
    v_perm_b32 v119, v188, v184, s95
    s_nop 1
    v_mfma_f32_16x16x32_bf16 v[132:135], v[96:99], v[116:119], 0
    v_perm_b32 v120, v165, v161, s94
    v_perm_b32 v121, v173, v169, s94
    v_perm_b32 v122, v181, v177, s94
    v_perm_b32 v123, v189, v185, s94
    s_nop 1
    v_mfma_f32_16x16x32_bf16 v[136:139], v[96:99], v[120:123], 0
    v_perm_b32 v124, v165, v161, s95
    v_perm_b32 v125, v173, v169, s95
    v_perm_b32 v126, v181, v177, s95
    v_perm_b32 v127, v189, v185, s95
    s_nop 1
    v_mfma_f32_16x16x32_bf16 v[140:143], v[96:99], v[124:127], 0
    v_perm_b32 v112, v166, v162, s94
    v_perm_b32 v113, v174, v170, s94
    v_perm_b32 v114, v182, v178, s94
    v_perm_b32 v115, v190, v186, s94
    s_nop 1
    v_mfma_f32_16x16x32_bf16 v[144:147], v[96:99], v[112:115], 0
    v_perm_b32 v116, v166, v162, s95
    v_perm_b32 v117, v174, v170, s95
    v_perm_b32 v118, v182, v178, s95
    v_perm_b32 v119, v190, v186, s95
    s_nop 1
    v_mfma_f32_16x16x32_bf16 v[148:151], v[96:99], v[116:119], 0
    v_perm_b32 v120, v167, v163, s94
    v_perm_b32 v121, v175, v171, s94
    v_perm_b32 v122, v183, v179, s94
    v_perm_b32 v123, v191, v187, s94
    s_nop 1
    v_mfma_f32_16x16x32_bf16 v[152:155], v[96:99], v[120:123], 0
    v_perm_b32 v124, v167, v163, s95
    v_perm_b32 v125, v175, v171, s95
    v_perm_b32 v126, v183, v179, s95
    v_perm_b32 v127, v191, v187, s95
    s_nop 1
    v_mfma_f32_16x16x32_bf16 v[156:159], v[96:99], v[124:127], 0
    s_memrealtime s[8:9]
    s_waitcnt lgkmcnt(0)
    s_sub_u32 s8, s8, s30
    s_cmpk_ge_u32 s8, 2226
    s_nop 3
    s_cbranch_scc1 .ap_48
    s_waitcnt vmcnt(5)
    s_cmpk_ge_u32 s8, 2126
    s_cbranch_scc1 .ap_48
    s_waitcnt vmcnt(3)
    s_bitcmp1_b64 s[14:15], 60
    s_cbranch_scc0 1
    s_waitcnt vmcnt(2)
    s_cmpk_ge_u32 s8, 2006
    s_cbranch_scc1 .ap_48
    s_waitcnt vmcnt(1)
.ap_48:
    s_add_u32 s63, s69, 425984
    buffer_load_dwordx4 v[68:71], v1, s[44:47], s63 offen nt
    v_perm_b32 v112, v196, v192, s94
    v_perm_b32 v113, v204, v200, s94
    v_perm_b32 v114, v212, v208, s94
    v_perm_b32 v115, v220, v216, s94
    s_nop 1
    v_mfma_f32_16x16x32_bf16 v[128:131], v[100:103], v[112:115], v[128:131]
    v_perm_b32 v116, v196, v192, s95
    v_perm_b32 v117, v204, v200, s95
    v_perm_b32 v118, v212, v208, s95
    v_perm_b32 v119, v220, v216, s95
    s_nop 1
    v_mfma_f32_16x16x32_bf16 v[132:135], v[100:103], v[116:119], v[132:135]
    v_perm_b32 v120, v197, v193, s94
    v_perm_b32 v121, v205, v201, s94
    v_perm_b32 v122, v213, v209, s94
    v_perm_b32 v123, v221, v217, s94
    s_nop 1
    v_mfma_f32_16x16x32_bf16 v[136:139], v[100:103], v[120:123], v[136:139]
    v_perm_b32 v124, v197, v193, s95
    s_branch .Lsk_n1_5
.Lst_n1_5:
    s_branch .Lrt_n1_5
.Lsk_n1_5:
    v_perm_b32 v125, v205, v201, s95
    v_perm_b32 v126, v213, v209, s95
    v_perm_b32 v127, v221, v217, s95
    s_nop 1
    v_mfma_f32_16x16x32_bf16 v[140:143], v[100:103], v[124:127], v[140:143]
    v_perm_b32 v112, v198, v194, s94
    v_perm_b32 v113, v206, v202, s94
    v_perm_b32 v114, v214, v210, s94
    v_perm_b32 v115, v222, v218, s94
    s_nop 1
    v_mfma_f32_16x16x32_bf16 v[144:147], v[100:103], v[112:115], v[144:147]
    v_perm_b32 v116, v198, v194, s95
    v_perm_b32 v117, v206, v202, s95
    v_perm_b32 v118, v214, v210, s95
    v_perm_b32 v119, v222, v218, s95
    s_nop 1
    v_mfma_f32_16x16x32_bf16 v[148:151], v[100:103], v[116:119], v[148:151]
    v_perm_b32 v120, v199, v195, s94
    v_perm_b32 v121, v207, v203, s94
    v_perm_b32 v122, v215, v211, s94
    v_perm_b32 v123, v223, v219, s94
    s_nop 1
    v_mfma_f32_16x16x32_bf16 v[152:155], v[100:103], v[120:123], v[152:155]
    v_perm_b32 v124, v199, v195, s95
    v_perm_b32 v125, v207, v203, s95
    v_perm_b32 v126, v215, v211, s95
    v_perm_b32 v127, v223, v219, s95
    s_nop 1
    v_mfma_f32_16x16x32_bf16 v[156:159], v[100:103], v[124:127], v[156:159]
    s_memrealtime s[8:9]
    s_waitcnt lgkmcnt(0)
    s_sub_u32 s8, s8, s30
    s_cmpk_ge_u32 s8, 2257
    s_nop 3
    s_cbranch_scc1 .ap_49
    s_waitcnt vmcnt(5)
    s_cmpk_ge_u32 s8, 2157
    s_cbranch_scc1 .ap_49
    s_waitcnt vmcnt(3)
    s_bitcmp1_b64 s[14:15], 61
    s_cbranch_scc0 1
    s_waitcnt vmcnt(2)
    s_cmpk_ge_u32 s8, 2037
    s_cbranch_scc1 .ap_49
    s_waitcnt vmcnt(1)
.ap_49:
    s_add_u32 s63, s69, 434176
    buffer_load_dwordx4 v[76:79], v1, s[44:47], s63 offen nt
    s_waitcnt vmcnt(6)
    v_perm_b32 v112, v228, v224, s94
    v_perm_b32 v113, v236, v232, s94
    v_perm_b32 v114, v244, v240, s94
    v_perm_b32 v115, v252, v248, s94
    s_nop 1
    v_mfma_f32_16x16x32_bf16 v[128:131], v[104:107], v[112:115], v[128:131]
    v_perm_b32 v116, v228, v224, s95
    v_perm_b32 v117, v236, v232, s95
    v_perm_b32 v118, v244, v240, s95
    v_perm_b32 v119, v252, v248, s95
    s_nop 1
    v_mfma_f32_16x16x32_bf16 v[132:135], v[104:107], v[116:119], v[132:135]
    v_perm_b32 v120, v229, v225, s94
    v_perm_b32 v121, v237, v233, s94
    v_perm_b32 v122, v245, v241, s94
    v_perm_b32 v123, v253, v249, s94
    s_nop 1
    v_mfma_f32_16x16x32_bf16 v[136:139], v[104:107], v[120:123], v[136:139]
    v_perm_b32 v124, v229, v225, s95
    v_perm_b32 v125, v237, v233, s95
    v_perm_b32 v126, v245, v241, s95
    v_perm_b32 v127, v253, v249, s95
    s_nop 1
    v_mfma_f32_16x16x32_bf16 v[140:143], v[104:107], v[124:127], v[140:143]
    v_perm_b32 v112, v230, v226, s94
    v_perm_b32 v113, v238, v234, s94
    v_perm_b32 v114, v246, v242, s94
    v_perm_b32 v115, v254, v250, s94
    s_nop 1
    v_mfma_f32_16x16x32_bf16 v[144:147], v[104:107], v[112:115], v[144:147]
    v_perm_b32 v116, v230, v226, s95
    v_perm_b32 v117, v238, v234, s95
    v_perm_b32 v118, v246, v242, s95
    v_perm_b32 v119, v254, v250, s95
    s_nop 1
    v_mfma_f32_16x16x32_bf16 v[148:151], v[104:107], v[116:119], v[148:151]
    v_perm_b32 v120, v231, v227, s94
    v_perm_b32 v121, v239, v235, s94
    v_perm_b32 v122, v247, v243, s94
    v_perm_b32 v123, v255, v251, s94
    s_nop 1
    v_mfma_f32_16x16x32_bf16 v[152:155], v[104:107], v[120:123], v[152:155]
    v_perm_b32 v124, v231, v227, s95
    v_perm_b32 v125, v239, v235, s95
    v_perm_b32 v126, v247, v243, s95
    v_perm_b32 v127, v255, v251, s95
    s_nop 1
    v_mfma_f32_16x16x32_bf16 v[156:159], v[104:107], v[124:127], v[156:159]
    s_memrealtime s[8:9]
    s_waitcnt lgkmcnt(0)
    s_sub_u32 s8, s8, s30
    s_cmpk_ge_u32 s8, 2289
    s_nop 3
    s_cbranch_scc1 .ap_50
    s_waitcnt vmcnt(5)
    s_cmpk_ge_u32 s8, 2189
    s_cbranch_scc1 .ap_50
    s_waitcnt vmcnt(3)
    s_bitcmp1_b64 s[14:15], 62
    s_cbranch_scc0 1
    s_waitcnt vmcnt(2)
    s_cmpk_ge_u32 s8, 2069
    s_cbranch_scc1 .ap_50
    s_waitcnt vmcnt(1)
.ap_50:
    s_add_u32 s63, s69, 442368
    buffer_load_dwordx4 v[84:87], v1, s[44:47], s63 offen nt
    s_memrealtime s[8:9]
    s_waitcnt lgkmcnt(0)
    s_sub_u32 s8, s8, s30
    s_cmpk_ge_u32 s8, 2321
    s_cbranch_scc1 .ap_51
    s_waitcnt vmcnt(5)
    s_cmpk_ge_u32 s8, 2221
    s_cbranch_scc1 .ap_51
    s_waitcnt vmcnt(3)
    s_bitcmp1_b64 s[14:15], 63
    s_cbranch_scc0 1
    s_waitcnt vmcnt(2)
    s_cmpk_ge_u32 s8, 2101
    s_cbranch_scc1 .ap_51
    s_waitcnt vmcnt(1)
.ap_51:
    s_add_u32 s63, s69, 450560
    buffer_load_dwordx4 v[92:95], v1, s[44:47], s63 offen nt
    s_setprio 0
    s_branch .Lsk_n1_6
.Lst_n1_6:
    s_branch .Lrt_n1_6
.Lsk_n1_6:
    s_waitcnt vmcnt(6)
    v_perm_b32 v160, v44, v36, s94
    v_perm_b32 v164, v44, v36, s95
    v_perm_b32 v168, v45, v37, s94
    v_perm_b32 v172, v45, v37, s95
    v_perm_b32 v176, v46, v38, s94
    v_perm_b32 v180, v46, v38, s95
    v_perm_b32 v184, v47, v39, s94
    v_perm_b32 v188, v47, v39, s95
    s_waitcnt vmcnt(4)
    v_perm_b32 v161, v60, v52, s94
    v_perm_b32 v165, v60, v52, s95
    v_perm_b32 v169, v61, v53, s94
    v_perm_b32 v173, v61, v53, s95
    v_perm_b32 v177, v62, v54, s94
    v_perm_b32 v181, v62, v54, s95
    v_perm_b32 v185, v63, v55, s94
    v_perm_b32 v189, v63, v55, s95
    s_waitcnt vmcnt(2)
    v_perm_b32 v162, v76, v68, s94
    v_perm_b32 v166, v76, v68, s95
    v_perm_b32 v170, v77, v69, s94
    v_perm_b32 v174, v77, v69, s95
    v_perm_b32 v178, v78, v70, s94
    v_perm_b32 v182, v78, v70, s95
    v_perm_b32 v186, v79, v71, s94
    v_perm_b32 v190, v79, v71, s95
    s_waitcnt vmcnt(0)
    s_cmp_lt_u32 s65, 8
    s_cbranch_scc1 .wol_52
    s_lshl_b32 s56, s3, 10
    s_add_u32 m0, s56, 24576
    s_add_u32 s56, s101, 221184
    s_mov_b64 exec, s[18:19]
    buffer_load_dwordx4 v6, s[48:51], s56 offen nt lds
    s_mov_b64 exec, -1
    s_lshl_b32 s56, s3, 10
    s_add_u32 m0, s56, 57344
    s_add_u32 s56, s101, 221312
    s_mov_b64 exec, s[18:19]
    buffer_load_dwordx4 v6, s[48:51], s56 offen nt lds
    s_mov_b64 exec, -1
    s_lshl_b32 s56, s3, 10
    s_add_u32 m0, s56, 90112
    s_add_u32 s56, s101, 221440
    s_mov_b64 exec, s[18:19]
    buffer_load_dwordx4 v6, s[48:51], s56 offen nt lds
    s_mov_b64 exec, -1
.wol_52:
    v_perm_b32 v163, v92, v84, s94
    v_perm_b32 v167, v92, v84, s95
    v_perm_b32 v171, v93, v85, s94
    v_mfma_f32_16x16x32_bf16 v[128:131], v[108:111], v[160:163], v[128:131]
    v_perm_b32 v175, v93, v85, s95
    v_mfma_f32_16x16x32_bf16 v[132:135], v[108:111], v[164:167], v[132:135]
    v_perm_b32 v179, v94, v86, s94
    v_mfma_f32_16x16x32_bf16 v[136:139], v[108:111], v[168:171], v[136:139]
    v_perm_b32 v183, v94, v86, s95
    v_mfma_f32_16x16x32_bf16 v[140:143], v[108:111], v[172:175], v[140:143]
    v_perm_b32 v187, v95, v87, s94
    v_mfma_f32_16x16x32_bf16 v[144:147], v[108:111], v[176:179], v[144:147]
    v_perm_b32 v191, v95, v87, s95
    v_mfma_f32_16x16x32_bf16 v[148:151], v[108:111], v[180:183], v[148:151]
    v_mfma_f32_16x16x32_bf16 v[152:155], v[108:111], v[184:187], v[152:155]
    v_mfma_f32_16x16x32_bf16 v[156:159], v[108:111], v[188:191], v[156:159]
    s_mov_b64 exec, 0xffff
    ds_write2_b32 v10, v128, v129 offset0:0 offset1:128
    ds_write2_b32 v10, v132, v133 offset0:1 offset1:129
    ds_write2_b32 v10, v136, v137 offset0:2 offset1:130
    ds_write2_b32 v10, v140, v141 offset0:3 offset1:131
    ds_write2_b32 v10, v144, v145 offset0:4 offset1:132
    ds_write2_b32 v10, v148, v149 offset0:5 offset1:133
    ds_write2_b32 v10, v152, v153 offset0:6 offset1:134
    ds_write2_b32 v10, v156, v157 offset0:7 offset1:135
    s_mov_b64 exec, -1
    s_waitcnt lgkmcnt(0)
    s_barrier
    s_cmp_lg_u32 s3, 7
    s_cbranch_scc1 .opub_53
    v_add_u32 v10, 147456, v2
    ds_read_b128 v[196:199], v10 offset:0
    ds_read_b128 v[200:203], v10 offset:1024
    ds_read_b128 v[204:207], v10 offset:2048
    ds_read_b128 v[208:211], v10 offset:3072
    ds_read_b128 v[212:215], v10 offset:4096
    ds_read_b128 v[216:219], v10 offset:5120
    ds_read_b128 v[220:223], v10 offset:6144
    ds_read_b128 v[224:227], v10 offset:7168
    v_lshrrev_b32 v11, 5, v0
    v_lshlrev_b32 v11, 13, v11
    v_and_b32 v12, 31, v0
    v_lshl_add_u32 v11, v12, 4, v11
    s_lshl4_add_u32 s56, s67, s66
    s_lshl1_add_u32 s56, s56, s68
    s_lshl_b32 s56, s56, 9
    s_add_u32 s56, s56, 0xa0000
    s_mov_b32 s60, 0x07060503
    s_mov_b32 s61, 0x07060502
    s_mov_b32 s62, 0x07060501
    v_mov_b32 v15, s34
    s_waitcnt lgkmcnt(6)
    v_pk_add_f32 v[196:197], v[196:197], v[200:201]
    v_pk_add_f32 v[198:199], v[198:199], v[202:203]
    s_waitcnt lgkmcnt(5)
    v_pk_add_f32 v[196:197], v[196:197], v[204:205]
    v_pk_add_f32 v[198:199], v[198:199], v[206:207]
    s_waitcnt lgkmcnt(4)
    v_pk_add_f32 v[196:197], v[196:197], v[208:209]
    v_pk_add_f32 v[198:199], v[198:199], v[210:211]
    s_waitcnt lgkmcnt(3)
    v_pk_add_f32 v[196:197], v[196:197], v[212:213]
    v_pk_add_f32 v[198:199], v[198:199], v[214:215]
    s_waitcnt lgkmcnt(2)
    v_pk_add_f32 v[196:197], v[196:197], v[216:217]
    v_pk_add_f32 v[198:199], v[198:199], v[218:219]
    s_waitcnt lgkmcnt(1)
    v_pk_add_f32 v[196:197], v[196:197], v[220:221]
    v_pk_add_f32 v[198:199], v[198:199], v[222:223]
    s_waitcnt lgkmcnt(0)
    v_pk_add_f32 v[196:197], v[196:197], v[224:225]
    v_pk_add_f32 v[198:199], v[198:199], v[226:227]
    v_perm_b32 v12, v196, v199, s60
    v_perm_b32 v13, v197, v199, s61
    v_perm_b32 v14, v198, v199, s62
    s_add_u32 s57, s56, 0x800000
    buffer_store_dwordx4 v[12:15], v11, s[36:39], s57 offen
    s_cmp_lg_u32 s0, 0
    s_nop 0
    s_cbranch_scc1 .nosl_54
    buffer_store_dwordx4 v[12:15], v11, s[36:39], s56 offen sc1
.nosl_54:
.opub_53:
    s_cmp_lt_u32 s65, 8
    s_nop 0
    s_cbranch_scc1 .Lexit
    v_mov_b32 v6, 0
    v_bfe_u32 v7, v0, 4, 1
    v_lshl_add_u32 v6, v7, 7, v6
    v_bfe_u32 v7, v0, 2, 2
    v_lshl_add_u32 v6, v7, 5, v6
    v_bfe_u32 v7, v0, 5, 1
    v_lshl_add_u32 v6, v7, 4, v6
    v_bfe_u32 v7, v0, 0, 2
    v_lshl_add_u32 v6, v7, 2, v6
    s_mul_i32 s56, s3, 528
    s_add_u32 s56, s56, 131072
    v_add_u32 v6, s56, v6
    s_lshl4_add_u32 s101, s99, s3
    s_lshl_b32 s101, s101, 10
    s_add_u32 s101, s101, 0xa0000
    v_add_u32 v5, 8192, v2
    s_cmp_ge_u32 s3, 6
    s_nop 0
    s_cbranch_scc1 .La_w67
    v_lshrrev_b32 v16, 4, v0
    v_bfe_u32 v17, v0, 2, 2
    v_lshl_add_u32 v7, v16, 3, v17
    v_lshlrev_b32 v7, 7, v7
    v_and_b32 v16, 1, v16
    v_lshrrev_b32 v17, 1, v17
    v_lshl_add_u32 v16, v16, 1, v17
    s_and_b32 s56, s3, 1
    s_lshl_b32 s56, s56, 1
    v_xor_b32 v16, s56, v16
    v_and_b32 v17, 3, v0
    v_lshl_add_u32 v7, v17, 3, v7
    s_branch .Lsk_n1_7
.Lst_n1_7:
    s_branch .Lrt_n1_7
.Lsk_n1_7:
    s_lshr_b32 s56, s3, 1
    s_lshl_b32 s56, s56, 15
    v_add_u32 v7, s56, v7
    v_xor_b32 v17, 1, v16
    v_lshl_add_u32 v8, v17, 5, v7
    v_lshl_add_u32 v7, v16, 5, v7
    ds_read_b64_tr_b16 v[32:33], v7 offset:0
    ds_read_b64_tr_b16 v[34:35], v7 offset:512
    ds_read_b64_tr_b16 v[64:65], v8 offset:0
    ds_read_b64_tr_b16 v[66:67], v8 offset:512
    ds_read_b64_tr_b16 v[36:37], v7 offset:4096
    ds_read_b64_tr_b16 v[38:39], v7 offset:4608
    ds_read_b64_tr_b16 v[68:69], v8 offset:4096
    ds_read_b64_tr_b16 v[70:71], v8 offset:4608
    ds_read_b64_tr_b16 v[40:41], v7 offset:8192
    ds_read_b64_tr_b16 v[42:43], v7 offset:8704
    ds_read_b64_tr_b16 v[72:73], v8 offset:8192
    ds_read_b64_tr_b16 v[74:75], v8 offset:8704
    ds_read_b64_tr_b16 v[44:45], v7 offset:12288
    ds_read_b64_tr_b16 v[46:47], v7 offset:12800
    ds_read_b64_tr_b16 v[76:77], v8 offset:12288
    ds_read_b64_tr_b16 v[78:79], v8 offset:12800
    ds_read_b64_tr_b16 v[48:49], v7 offset:16384
    ds_read_b64_tr_b16 v[50:51], v7 offset:16896
    ds_read_b64_tr_b16 v[80:81], v8 offset:16384
    ds_read_b64_tr_b16 v[82:83], v8 offset:16896
    ds_read_b64_tr_b16 v[52:53], v7 offset:20480
    ds_read_b64_tr_b16 v[54:55], v7 offset:20992
    ds_read_b64_tr_b16 v[84:85], v8 offset:20480
    ds_read_b64_tr_b16 v[86:87], v8 offset:20992
    s_mov_b32 s56, 131072
    v_bfe_u32 v9, v0, 1, 3
    v_mul_u32_u24 v9, 528, v9
    v_and_b32 v16, 48, v0
    v_lshl_add_u32 v9, v16, 1, v9
    v_and_b32 v16, 1, v0
    v_lshlrev_b32 v16, 4, v16
    v_add3_u32 v9, v9, v16, s56
    v_lshrrev_b32 v10, 4, v0
    v_and_b32 v16, 1, v0
    v_lshl_add_u32 v10, v10, 1, v16
    v_mul_u32_u24 v10, 36864, v10
    v_bfe_u32 v16, v0, 1, 3
    v_lshl_add_u32 v10, v16, 4, v10
    s_mul_i32 s59, s100, 3
    s_lshr_b32 s56, s3, 1
    s_add_u32 s59, s59, s56
    s_lshl4_add_u32 s59, s59, s99
    s_and_b32 s56, s3, 1
    s_lshl1_add_u32 s59, s59, s56
    s_lshl_b32 s59, s59, 7
    s_add_u32 s59, s59, 0xe0000
    s_mul_i32 s6, s64, 3
    s_add_u32 s6, s6, s100
    s_mul_i32 s6, s6, 3
    s_lshr_b32 s56, s3, 1
    s_add_u32 s6, s6, s56
    s_and_b32 s56, s99, 1
    s_lshl1_add_u32 s6, s6, s56
    s_and_b32 s56, s3, 1
    s_lshl1_add_u32 s6, s6, s56
    s_lshl4_add_u32 s6, s6, 0xca2000
    v_mov_b32 v139, s34
    v_mov_b32 v140, 0x4444
    v_mov_b32 v141, 0xeeee
    v_cndmask_b32 v140, v140, v141, s[96:97]
    v_mov_b32 v128, 0
    v_mov_b32 v129, 0
    v_mov_b32 v130, 0
    v_mov_b32 v131, 0
    v_mov_b32 v132, 0
    v_mov_b32 v133, 0
    v_mov_b32 v134, 0
    v_mov_b32 v135, 0
    s_waitcnt vmcnt(0)
    s_barrier
    ds_read_b64_tr_b16 v[56:57], v7 offset:24576
    ds_read_b64_tr_b16 v[58:59], v7 offset:25088
    ds_read_b64_tr_b16 v[88:89], v8 offset:24576
    ds_read_b64_tr_b16 v[90:91], v8 offset:25088
    ds_read_b64_tr_b16 v[60:61], v7 offset:28672
    ds_read_b64_tr_b16 v[62:63], v7 offset:29184
    ds_read_b64_tr_b16 v[92:93], v8 offset:28672
    ds_read_b64_tr_b16 v[94:95], v8 offset:29184
    s_branch .La_poll
.La_w67:
    s_cmp_eq_u32 s3, 7
    s_cbranch_scc0 2
    s_waitcnt vmcnt(1)
    s_branch 1
    s_waitcnt vmcnt(0)
    s_barrier
.La_poll:
    s_mov_b32 s60, 0x04000c0c
    s_mov_b32 s61, 0x0706000c
    s_mov_b32 s69, 0
.gp_55:
    s_add_u32 s69, s69, 1
    s_and_b32 s56, s69, 0x41
    s_cmp_lg_u32 s56, 0x41
    s_cselect_b32 s56, 0, 0x800000
    s_xor_b32 s56, s56, s0
    s_add_u32 s58, s101, s56
    buffer_load_dwordx4 v[16:19], v2, s[36:39], s58 offen offset:0 sc1
    buffer_load_dwordx4 v[20:23], v5, s[36:39], s58 offen offset:0 sc1
    s_waitcnt vmcnt(0)
    v_cmp_eq_u32 vcc, s34, v19
    v_cmp_eq_u32 s[56:57], s34, v23
    s_and_b64 vcc, vcc, s[56:57]
    s_cmp_eq_u64 vcc, -1
    s_nop 2
    s_cbranch_scc1 .gpd_56
    s_sub_u32 s35, s35, 1
    s_cbranch_scc1 .Lexit
    s_branch .gp_55
.gpd_56:
    v_perm_b32 v19, v16, v17, s60
    v_perm_b32 v19, v19, v18, s61
    v_perm_b32 v23, v20, v21, s60
    v_perm_b32 v23, v23, v22, s61
    v_permlane32_swap_b32 v16, v18
    v_permlane32_swap_b32 v17, v19
    v_permlane32_swap_b32 v20, v22
    v_permlane32_swap_b32 v21, v23
    v_pk_add_f32 v[16:17], v[16:17], v[18:19]
    v_pk_add_f32 v[20:21], v[20:21], v[22:23]
    v_cvt_pk_bf16_f32 v16, v16, v17
    v_cvt_pk_bf16_f32 v20, v20, v21
    ds_write2_b32 v6, v16, v20 offset1:64
    s_mov_b32 s60, 0x07060503
    s_mov_b32 s61, 0x07060502
    s_mov_b32 s62, 0x07060501
    s_mov_b32 vcc_lo, 0x55555555
    s_mov_b32 vcc_hi, 0x55555555
    s_waitcnt lgkmcnt(0)
    s_barrier
    s_cmp_ge_u32 s3, 6
    s_cbranch_scc1 .Lexit
    ds_read_b128 v[96:99], v9 offset:0
    ds_read_b128 v[100:103], v9 offset:128
    ds_read_b128 v[104:107], v9 offset:256
    ds_read_b128 v[108:111], v9 offset:384
    s_waitcnt lgkmcnt(3)
    v_smfmac_f32_16x16x64_bf16 v[128:131], v[96:99], v[32:39], v140
    v_smfmac_f32_16x16x64_bf16 v[132:135], v[96:99], v[64:71], v140
    s_waitcnt lgkmcnt(2)
    v_smfmac_f32_16x16x64_bf16 v[128:131], v[100:103], v[40:47], v140
    v_smfmac_f32_16x16x64_bf16 v[132:135], v[100:103], v[72:79], v140
    s_waitcnt lgkmcnt(1)
    v_smfmac_f32_16x16x64_bf16 v[128:131], v[104:107], v[48:55], v140
    v_smfmac_f32_16x16x64_bf16 v[132:135], v[104:107], v[80:87], v140
    s_waitcnt lgkmcnt(0)
    v_smfmac_f32_16x16x64_bf16 v[128:131], v[108:111], v[56:63], v140
    v_smfmac_f32_16x16x64_bf16 v[132:135], v[108:111], v[88:95], v140
    s_nop 6
    v_add_f32 v128, v128, v129
    v_add_f32 v130, v130, v131
    v_add_f32 v132, v132, v133
    v_add_f32 v134, v134, v135
    s_not_b64 vcc, vcc
    v_cndmask_b32_dpp v129, v128, v130, vcc quad_perm:[1,0,3,2] row_mask:0xf bank_mask:0xf
    v_cndmask_b32_dpp v131, v132, v134, vcc quad_perm:[1,0,3,2] row_mask:0xf bank_mask:0xf
    s_not_b64 vcc, vcc
    v_cndmask_b32_dpp v128, v130, v128, vcc quad_perm:[1,0,3,2] row_mask:0xf bank_mask:0xf
    v_cndmask_b32_dpp v130, v134, v132, vcc quad_perm:[1,0,3,2] row_mask:0xf bank_mask:0xf
    v_perm_b32 v136, v128, v131, s60
    v_perm_b32 v137, v129, v131, s61
    v_perm_b32 v138, v130, v131, s62
    buffer_store_dwordx4 v[136:139], v10, s[36:39], s59 offen sc1
    s_mov_b64 exec, 1
    buffer_store_dword v139, v2, s[36:39], s6 offen
    s_mov_b64 exec, -1
    s_branch .Lexit
.Lm:
    s_branch .Lsk_m0_0
.Lst_m0_0:
    s_branch .Lrt_m0_0
.Lsk_m0_0:
    s_cmp_lt_u32 s2, 54
    s_mov_b32 s14, 0xfdff7fdf
    s_cselect_b32 s14, 0x6b5ad6b5, s14
    s_mov_b32 s15, 0xff7fdff7
    s_cselect_b32 s15, 0x5ad6b5ad, s15
    s_add_u32 s30, s70, 0
    s_mov_b32 s31, s70
    v_bfe_u32 v16, v0, 1, 3
    v_mul_u32_u24 v16, 1312, v16
    v_lshrrev_b32 v12, 4, v0
    v_lshl_add_u32 v16, v12, 5, v16
    v_and_b32 v12, 1, v0
    v_lshl_add_u32 v16, v12, 4, v16
    v_add_u32 v16, 147456, v16
    s_mul_i32 s56, s3, 1312
    s_add_u32 s56, s56, 147456
    v_add_u32 v17, s56, v3
    v_add_u32 v18, s56, v4
    v_lshrrev_b32 v12, 4, v0
    v_bfe_u32 v13, v0, 1, 1
    v_lshl_add_u32 v12, v12, 1, v13
    v_bfe_u32 v13, v0, 2, 2
    v_lshl_add_u32 v20, v12, 3, v13
    v_lshlrev_b32 v20, 7, v20
    v_and_b32 v12, 3, v12
    v_lshrrev_b32 v13, 1, v13
    v_lshl_add_u32 v12, v12, 1, v13
    v_xor_b32 v12, s3, v12
    v_lshl_add_u32 v20, v12, 4, v20
    v_and_b32 v12, 1, v0
    v_lshl_add_u32 v20, v12, 3, v20
    v_bfe_u32 v23, v0, 1, 3
    v_mul_u32_u24 v23, 144, v23
    v_bfe_u32 v12, v0, 4, 1
    v_lshl_add_u32 v23, v12, 3, v23
    v_lshrrev_b32 v12, 5, v0
    v_lshl_add_u32 v23, v12, 2, v23
    v_and_b32 v12, 1, v0
    v_lshl_add_u32 v23, v12, 1, v23
    s_lshl_b32 s56, s3, 4
    s_add_u32 s56, s56, 157952
    v_add_u32 v23, s56, v23
    v_and_b32 v24, 15, v0
    v_lshlrev_b32 v24, 3, v24
    s_mul_i32 s56, s3, 144
    s_add_u32 s56, s56, 157952
    v_add_u32 v24, s56, v24
    v_add_u32 v21, 32768, v20
    s_lshl_b32 s100, s3, 10
    s_mov_b32 s99, s2
    s_cmp_ge_u32 s99, 18
    s_cbranch_scc1 .Lm_rel
    s_mul_i32 s58, s3, 1152
    s_mov_b32 s52, s24
    s_and_b32 s53, s25, 0xffff
    s_mov_b32 s54, 0x2400
    s_mov_b32 s55, 0x00020000
    buffer_load_dwordx2 v[246:247], v3, s[52:55], s58 offen
    buffer_load_dwordx2 v[248:249], v3, s[52:55], s58 offen offset:512
    buffer_load_dword v250, v4, s[52:55], s58 offen
    s_mov_b32 s48, s26
    s_and_b32 s49, s27, 0xffff
    s_mov_b32 s50, 0x3cc000
    s_mov_b32 s51, 0x00020000
    v_bfe_u32 v12, v0, 4, 1
    s_and_b32 s56, s3, 3
    s_lshl_b32 s56, s56, 1
    v_or_b32 v12, s56, v12
    v_and_b32 v19, 7, v0
    v_xor_b32 v12, v12, v19
    v_lshrrev_b32 v19, 3, v0
    v_mul_u32_u24 v19, 6912, v19
    v_lshl_add_u32 v19, v12, 4, v19
    s_mul_i32 s57, s3, 55296
    s_lshl_b32 s59, s99, 7
    s_add_u32 s57, s57, s59
    s_add_u32 m0, s100, 0
    s_add_u32 s56, s57, 0
    buffer_load_dwordx4 v19, s[48:51], s56 offen nt lds
    s_add_u32 m0, s100, 8192
    s_add_u32 s56, s57, 442368
    buffer_load_dwordx4 v19, s[48:51], s56 offen nt lds
    s_add_u32 m0, s100, 16384
    s_add_u32 s56, s57, 884736
    buffer_load_dwordx4 v19, s[48:51], s56 offen nt lds
    s_add_u32 m0, s100, 24576
    s_add_u32 s56, s57, 1327104
    buffer_load_dwordx4 v19, s[48:51], s56 offen nt lds
    s_add_u32 m0, s100, 32768
    s_add_u32 s56, s57, 1769472
    buffer_load_dwordx4 v19, s[48:51], s56 offen nt lds
    s_add_u32 m0, s100, 40960
    s_add_u32 s56, s57, 2211840
    buffer_load_dwordx4 v19, s[48:51], s56 offen nt lds
    s_add_u32 m0, s100, 49152
    s_add_u32 s56, s57, 2654208
    buffer_load_dwordx4 v19, s[48:51], s56 offen nt lds
    s_add_u32 m0, s100, 57344
    s_add_u32 s56, s57, 3096576
    buffer_load_dwordx4 v19, s[48:51], s56 offen nt lds
    s_add_u32 m0, s100, 65536
    s_add_u32 s56, s57, 3538944
    buffer_load_dwordx4 v19, s[48:51], s56 offen nt lds
    s_waitcnt lgkmcnt(0)
    s_add_u32 s34, s34, 1
    s_getreg_b32 s1, hwreg(HW_REG_XCC_ID)
    s_lshl_b32 s1, s1, 24
    s_add_u32 s1, s1, s34
    s_lshr_b32 s0, s2, 3
    s_lshl_b32 s63, s64, 8
    s_add_u32 s0, s0, s63
    s_lshl2_add_u32 s0, s0, 0x480000
    v_mov_b32 v30, s1
    s_cmp_eq_u32 s3, 0
    s_cselect_b64 exec, 1, 0
    buffer_store_dword v30, v2, s[36:39], s0 offen sc1
    s_mov_b64 exec, -1
    v_lshrrev_b32 v12, 4, v0
    v_mul_u32_u24 v12, 18432, v12
    v_and_b32 v13, 15, v0
    v_lshl_add_u32 v22, v13, 4, v12
    s_mul_i32 s57, s99, 57
    s_lshr_b32 s57, s57, 9
    s_mul_i32 s58, s57, 9
    s_sub_u32 s58, s99, s58
    s_mul_i32 s59, s57, 73728
    s_lshl_b32 s58, s58, 8
    s_add_u32 s59, s59, s58
    s_mul_i32 s58, s3, 2304
    s_add_u32 s59, s59, s58
    s_add_u32 s59, s59, 0x1000
    s_mov_b32 s58, 0
    s_cmp_eq_u32 s57, 1
    s_cselect_b32 s58, 1.0, s58
    s_cmp_eq_u32 s57, 4
    s_cselect_b32 s58, 1.0, s58
    s_waitcnt vmcnt(10)
    v_lshlrev_b32 v236, 16, v246
    v_and_b32 v237, 0xffff0000, v246
    v_max_f32 v236, 0xc2ae0000, v236
    v_min_f32 v242, 0x43000000, v236
    v_mul_f32 v238, 0xbfb8aa3b, v242
    v_fma_f32 v240, v242, s98, -v238
    v_fmac_f32 v240, 0xb2a57060, v242
    v_exp_f32 v238, v238
    v_mul_f32 v240, 0x3f317218, v240
    v_fmac_f32 v238, v238, v240
    v_add_f32 v238, 1.0, v238
    v_rcp_f32 v240, v238
    s_nop 0
    v_mul_f32 v242, v236, v240
    v_fma_f32 v238, -v242, v238, v236
    v_fma_f32 v236, v238, v240, v242
    v_max_f32 v237, 0xc2ae0000, v237
    v_min_f32 v243, 0x43000000, v237
    v_mul_f32 v239, 0xbfb8aa3b, v243
    v_fma_f32 v241, v243, s98, -v239
    v_fmac_f32 v241, 0xb2a57060, v243
    v_exp_f32 v239, v239
    v_mul_f32 v241, 0x3f317218, v241
    v_fmac_f32 v239, v239, v241
    v_add_f32 v239, 1.0, v239
    v_rcp_f32 v241, v239
    s_nop 0
    v_mul_f32 v243, v237, v241
    v_fma_f32 v239, -v243, v239, v237
    v_fma_f32 v237, v239, v241, v243
    v_cvt_pk_bf16_f32 v246, v236, v237
    v_lshlrev_b32 v236, 16, v247
    v_and_b32 v237, 0xffff0000, v247
    s_branch .Lsk_m0_1
.Lst_m0_1:
    s_branch .Lrt_m0_1
.Lsk_m0_1:
    v_max_f32 v236, 0xc2ae0000, v236
    v_min_f32 v242, 0x43000000, v236
    v_mul_f32 v238, 0xbfb8aa3b, v242
    v_fma_f32 v240, v242, s98, -v238
    v_fmac_f32 v240, 0xb2a57060, v242
    v_exp_f32 v238, v238
    v_mul_f32 v240, 0x3f317218, v240
    v_fmac_f32 v238, v238, v240
    v_add_f32 v238, 1.0, v238
    v_rcp_f32 v240, v238
    s_nop 0
    v_mul_f32 v242, v236, v240
    v_fma_f32 v238, -v242, v238, v236
    v_fma_f32 v236, v238, v240, v242
    v_max_f32 v237, 0xc2ae0000, v237
    v_min_f32 v243, 0x43000000, v237
    v_mul_f32 v239, 0xbfb8aa3b, v243
    v_fma_f32 v241, v243, s98, -v239
    v_fmac_f32 v241, 0xb2a57060, v243
    v_exp_f32 v239, v239
    v_mul_f32 v241, 0x3f317218, v241
    v_fmac_f32 v239, v239, v241
    v_add_f32 v239, 1.0, v239
    v_rcp_f32 v241, v239
    s_nop 0
    v_mul_f32 v243, v237, v241
    v_fma_f32 v239, -v243, v239, v237
    v_fma_f32 v237, v239, v241, v243
    v_cvt_pk_bf16_f32 v247, v236, v237
    v_lshlrev_b32 v236, 16, v248
    v_and_b32 v237, 0xffff0000, v248
    v_max_f32 v236, 0xc2ae0000, v236
    v_min_f32 v242, 0x43000000, v236
    v_mul_f32 v238, 0xbfb8aa3b, v242
    v_fma_f32 v240, v242, s98, -v238
    v_fmac_f32 v240, 0xb2a57060, v242
    v_exp_f32 v238, v238
    v_mul_f32 v240, 0x3f317218, v240
    v_fmac_f32 v238, v238, v240
    v_add_f32 v238, 1.0, v238
    v_rcp_f32 v240, v238
    s_nop 0
    v_mul_f32 v242, v236, v240
    v_fma_f32 v238, -v242, v238, v236
    v_fma_f32 v236, v238, v240, v242
    v_max_f32 v237, 0xc2ae0000, v237
    v_min_f32 v243, 0x43000000, v237
    v_mul_f32 v239, 0xbfb8aa3b, v243
    v_fma_f32 v241, v243, s98, -v239
    v_fmac_f32 v241, 0xb2a57060, v243
    v_exp_f32 v239, v239
    v_mul_f32 v241, 0x3f317218, v241
    v_fmac_f32 v239, v239, v241
    v_add_f32 v239, 1.0, v239
    v_rcp_f32 v241, v239
    s_nop 0
    v_mul_f32 v243, v237, v241
    v_fma_f32 v239, -v243, v239, v237
    v_fma_f32 v237, v239, v241, v243
    v_cvt_pk_bf16_f32 v248, v236, v237
    v_lshlrev_b32 v236, 16, v249
    v_and_b32 v237, 0xffff0000, v249
    v_max_f32 v236, 0xc2ae0000, v236
    v_min_f32 v242, 0x43000000, v236
    v_mul_f32 v238, 0xbfb8aa3b, v242
    v_fma_f32 v240, v242, s98, -v238
    v_fmac_f32 v240, 0xb2a57060, v242
    v_exp_f32 v238, v238
    v_mul_f32 v240, 0x3f317218, v240
    v_fmac_f32 v238, v238, v240
    v_add_f32 v238, 1.0, v238
    v_rcp_f32 v240, v238
    s_nop 0
    v_mul_f32 v242, v236, v240
    v_fma_f32 v238, -v242, v238, v236
    v_fma_f32 v236, v238, v240, v242
    v_max_f32 v237, 0xc2ae0000, v237
    v_min_f32 v243, 0x43000000, v237
    v_mul_f32 v239, 0xbfb8aa3b, v243
    v_fma_f32 v241, v243, s98, -v239
    v_fmac_f32 v241, 0xb2a57060, v243
    v_exp_f32 v239, v239
    v_mul_f32 v241, 0x3f317218, v241
    v_fmac_f32 v239, v239, v241
    v_add_f32 v239, 1.0, v239
    v_rcp_f32 v241, v239
    s_nop 0
    v_mul_f32 v243, v237, v241
    v_fma_f32 v239, -v243, v239, v237
    v_fma_f32 v237, v239, v241, v243
    v_cvt_pk_bf16_f32 v249, v236, v237
    v_lshlrev_b32 v236, 16, v250
    v_and_b32 v237, 0xffff0000, v250
    v_max_f32 v236, 0xc2ae0000, v236
    v_min_f32 v242, 0x43000000, v236
    v_mul_f32 v238, 0xbfb8aa3b, v242
    v_fma_f32 v240, v242, s98, -v238
    v_fmac_f32 v240, 0xb2a57060, v242
    v_exp_f32 v238, v238
    v_mul_f32 v240, 0x3f317218, v240
    v_fmac_f32 v238, v238, v240
    v_add_f32 v238, 1.0, v238
    v_rcp_f32 v240, v238
    s_nop 0
    v_mul_f32 v242, v236, v240
    v_fma_f32 v238, -v242, v238, v236
    v_fma_f32 v236, v238, v240, v242
    v_max_f32 v237, 0xc2ae0000, v237
    v_min_f32 v243, 0x43000000, v237
    v_mul_f32 v239, 0xbfb8aa3b, v243
    v_fma_f32 v241, v243, s98, -v239
    v_fmac_f32 v241, 0xb2a57060, v243
    v_exp_f32 v239, v239
    v_mul_f32 v241, 0x3f317218, v241
    v_fmac_f32 v239, v239, v241
    v_add_f32 v239, 1.0, v239
    v_rcp_f32 v241, v239
    s_nop 0
    v_mul_f32 v243, v237, v241
    v_fma_f32 v239, -v243, v239, v237
    v_fma_f32 v237, v239, v241, v243
    v_cvt_pk_bf16_f32 v250, v236, v237
    ds_write_b64 v17, v[246:247] offset:0
    ds_write_b64 v17, v[248:249] offset:512
    ds_write_b32 v18, v250 offset:0
    s_waitcnt vmcnt(1)
    s_waitcnt lgkmcnt(0)
    s_barrier
    ds_read_b64_tr_b16 v[160:161], v20 offset:0
    ds_read_b64_tr_b16 v[162:163], v20 offset:512
    ds_read_b64_tr_b16 v[164:165], v20 offset:8192
    ds_read_b64_tr_b16 v[166:167], v20 offset:8704
    ds_read_b64_tr_b16 v[168:169], v20 offset:16384
    ds_read_b64_tr_b16 v[170:171], v20 offset:16896
    ds_read_b64_tr_b16 v[172:173], v20 offset:24576
    ds_read_b64_tr_b16 v[174:175], v20 offset:25088
    ds_read_b64_tr_b16 v[176:177], v21 offset:0
    ds_read_b64_tr_b16 v[178:179], v21 offset:512
    s_branch .Lsk_m0_2
.Lst_m0_2:
    s_branch .Lrt_m0_2
.Lsk_m0_2:
    ds_read_b64_tr_b16 v[180:181], v21 offset:8192
    ds_read_b64_tr_b16 v[182:183], v21 offset:8704
    ds_read_b64_tr_b16 v[184:185], v21 offset:16384
    ds_read_b64_tr_b16 v[186:187], v21 offset:16896
    ds_read_b64_tr_b16 v[188:189], v21 offset:24576
    ds_read_b64_tr_b16 v[190:191], v21 offset:25088
    ds_read_b64_tr_b16 v[192:193], v21 offset:32768
    ds_read_b64_tr_b16 v[194:195], v21 offset:33280
    ds_read_b128 v[196:199], v16 offset:0
    ds_read_b128 v[200:203], v16 offset:128
    ds_read_b128 v[204:207], v16 offset:256
    ds_read_b128 v[208:211], v16 offset:384
    ds_read_b128 v[212:215], v16 offset:512
    ds_read_b128 v[216:219], v16 offset:640
    ds_read_b128 v[220:223], v16 offset:768
    ds_read_b128 v[224:227], v16 offset:896
    ds_read_b128 v[228:231], v16 offset:1024
    s_waitcnt lgkmcnt(8)
    v_mfma_f32_16x16x32_bf16 v[232:235], v[160:163], v[196:199], 0
    s_waitcnt lgkmcnt(7)
    v_mfma_f32_16x16x32_bf16 v[232:235], v[164:167], v[200:203], v[232:235]
    s_waitcnt lgkmcnt(6)
    v_mfma_f32_16x16x32_bf16 v[232:235], v[168:171], v[204:207], v[232:235]
    s_waitcnt lgkmcnt(5)
    v_mfma_f32_16x16x32_bf16 v[232:235], v[172:175], v[208:211], v[232:235]
    s_waitcnt lgkmcnt(4)
    v_mfma_f32_16x16x32_bf16 v[232:235], v[176:179], v[212:215], v[232:235]
    s_waitcnt lgkmcnt(3)
    v_mfma_f32_16x16x32_bf16 v[232:235], v[180:183], v[216:219], v[232:235]
    s_waitcnt lgkmcnt(2)
    v_mfma_f32_16x16x32_bf16 v[232:235], v[184:187], v[220:223], v[232:235]
    s_waitcnt lgkmcnt(1)
    v_mfma_f32_16x16x32_bf16 v[232:235], v[188:191], v[224:227], v[232:235]
    s_waitcnt lgkmcnt(0)
    v_mfma_f32_16x16x32_bf16 v[232:235], v[192:195], v[228:231], v[232:235]
    s_nop 7
    v_permlane32_swap_b32 v232, v234
    v_permlane32_swap_b32 v233, v235
    v_cndmask_b32 v233, v233, v234, s[96:97]
    v_cndmask_b32 v232, v232, v235, s[96:97]
    s_nop 1
    v_add_f32_dpp v236, v233, v232 quad_perm:[1,0,3,2] row_mask:0xf bank_mask:0xf
    v_cvt_pk_bf16_f32 v236, v236, v236
    v_lshlrev_b32 v236, 16, v236
    v_add_f32 v236, s58, v236
    v_cvt_pk_bf16_f32 v236, v236, v236
    ds_write_b16 v23, v236
    v_mov_b32 v243, s34
    s_waitcnt lgkmcnt(0)
    s_barrier
    ds_read2_b32 v[244:245], v24 offset1:1
    v_mov_b32 v241, s34
    s_waitcnt lgkmcnt(0)
    v_mov_b32 v240, v244
    v_mov_b32 v242, v245
    s_bfm_b64 exec, 16, 0
    buffer_store_dwordx4 v[240:243], v22, s[36:39], s59 offen sc1
    s_mov_b64 exec, -1
    s_add_u32 s63, s69, 32768
    buffer_load_dwordx4 v[96:99], v1, s[40:43], s63 offen nt
    s_add_u32 s63, s69, 40960
    buffer_load_dwordx4 v[100:103], v1, s[40:43], s63 offen nt
    s_add_u32 s63, s69, 49152
    buffer_load_dwordx4 v[128:131], v1, s[40:43], s63 offen nt
    s_add_u32 s63, s69, 57344
    buffer_load_dwordx4 v[132:135], v1, s[40:43], s63 offen nt
    s_waitcnt vmcnt(3)
    s_add_u32 s63, s69, 131072
    buffer_load_dwordx4 v[40:43], v1, s[40:43], s63 offen nt
    s_waitcnt vmcnt(3)
    s_add_u32 s63, s69, 139264
    buffer_load_dwordx4 v[44:47], v1, s[40:43], s63 offen nt
    s_waitcnt vmcnt(3)
    s_add_u32 s63, s69, 147456
    buffer_load_dwordx4 v[72:75], v1, s[40:43], s63 offen nt
    s_waitcnt vmcnt(3)
    s_add_u32 s63, s69, 155648
    buffer_load_dwordx4 v[76:79], v1, s[40:43], s63 offen nt
    s_waitcnt vmcnt(3)
    s_add_u32 s63, s69, 163840
    buffer_load_dwordx4 v[104:107], v1, s[40:43], s63 offen nt
    s_waitcnt vmcnt(3)
    s_add_u32 s63, s69, 172032
    buffer_load_dwordx4 v[108:111], v1, s[40:43], s63 offen nt
    s_waitcnt vmcnt(3)
    s_add_u32 s63, s69, 180224
    buffer_load_dwordx4 v[136:139], v1, s[40:43], s63 offen nt
    s_waitcnt vmcnt(3)
    s_add_u32 s63, s69, 188416
    buffer_load_dwordx4 v[140:143], v1, s[40:43], s63 offen nt
    s_waitcnt vmcnt(3)
    s_add_u32 s63, s69, 262144
    buffer_load_dwordx4 v[48:51], v1, s[40:43], s63 offen nt
    s_waitcnt vmcnt(3)
    s_add_u32 s63, s69, 270336
    buffer_load_dwordx4 v[52:55], v1, s[40:43], s63 offen nt
    s_branch .Le_done
.Lm_rel:
    s_waitcnt vmcnt(4)
    s_bitcmp1_b64 s[14:15], 4
    s_cbranch_scc0 1
    s_waitcnt vmcnt(3)
    s_add_u32 s63, s69, 32768
    buffer_load_dwordx4 v[96:99], v1, s[40:43], s63 offen nt
    s_waitcnt vmcnt(4)
    s_bitcmp1_b64 s[14:15], 5
    s_cbranch_scc0 1
    s_waitcnt vmcnt(3)
    s_add_u32 s63, s69, 40960
    buffer_load_dwordx4 v[100:103], v1, s[40:43], s63 offen nt
    s_waitcnt vmcnt(4)
    s_bitcmp1_b64 s[14:15], 6
    s_cbranch_scc0 1
    s_waitcnt vmcnt(3)
    s_add_u32 s63, s69, 49152
    buffer_load_dwordx4 v[128:131], v1, s[40:43], s63 offen nt
    s_waitcnt vmcnt(4)
    s_bitcmp1_b64 s[14:15], 7
    s_cbranch_scc0 1
    s_waitcnt vmcnt(2)
    s_add_u32 s63, s69, 57344
    buffer_load_dwordx4 v[132:135], v1, s[40:43], s63 offen nt
    s_waitcnt vmcnt(3)
    s_bitcmp1_b64 s[14:15], 8
    s_cbranch_scc0 1
    s_waitcnt vmcnt(2)
    s_add_u32 s63, s69, 131072
    buffer_load_dwordx4 v[40:43], v1, s[40:43], s63 offen nt
    s_waitcnt vmcnt(3)
    s_bitcmp1_b64 s[14:15], 9
    s_cbranch_scc0 1
    s_waitcnt vmcnt(2)
    s_add_u32 s63, s69, 139264
    buffer_load_dwordx4 v[44:47], v1, s[40:43], s63 offen nt
    s_waitcnt lgkmcnt(0)
    s_add_u32 s34, s34, 1
    s_getreg_b32 s1, hwreg(HW_REG_XCC_ID)
    s_lshl_b32 s1, s1, 24
    s_add_u32 s1, s1, s34
    s_lshr_b32 s0, s2, 3
    s_lshl_b32 s63, s64, 8
    s_add_u32 s0, s0, s63
    s_lshl2_add_u32 s0, s0, 0x480000
    v_mov_b32 v30, s1
    s_cmp_eq_u32 s3, 0
    s_cselect_b64 exec, 1, 0
    buffer_store_dword v30, v2, s[36:39], s0 offen sc1
    s_mov_b64 exec, -1
    s_cmp_lt_u32 s99, 54
    s_cbranch_scc1 .Lmr_part
    s_waitcnt vmcnt(4)
    s_bitcmp1_b64 s[14:15], 10
    s_cbranch_scc0 1
    s_waitcnt vmcnt(3)
    s_add_u32 s63, s69, 147456
    buffer_load_dwordx4 v[72:75], v1, s[40:43], s63 offen nt
    s_waitcnt vmcnt(4)
    s_bitcmp1_b64 s[14:15], 11
    s_cbranch_scc0 1
    s_waitcnt vmcnt(3)
    s_add_u32 s63, s69, 155648
    buffer_load_dwordx4 v[76:79], v1, s[40:43], s63 offen nt
    s_waitcnt vmcnt(4)
    s_bitcmp1_b64 s[14:15], 12
    s_cbranch_scc0 1
    s_waitcnt vmcnt(3)
    s_add_u32 s63, s69, 163840
    buffer_load_dwordx4 v[104:107], v1, s[40:43], s63 offen nt
    s_waitcnt vmcnt(4)
    s_bitcmp1_b64 s[14:15], 13
    s_cbranch_scc0 1
    s_waitcnt vmcnt(2)
    s_add_u32 s63, s69, 172032
    buffer_load_dwordx4 v[108:111], v1, s[40:43], s63 offen nt
    s_waitcnt vmcnt(3)
    s_bitcmp1_b64 s[14:15], 14
    s_cbranch_scc0 1
    s_waitcnt vmcnt(2)
    s_add_u32 s63, s69, 180224
    buffer_load_dwordx4 v[136:139], v1, s[40:43], s63 offen nt
    s_waitcnt vmcnt(3)
    s_bitcmp1_b64 s[14:15], 15
    s_cbranch_scc0 1
    s_waitcnt vmcnt(2)
    s_add_u32 s63, s69, 188416
    buffer_load_dwordx4 v[140:143], v1, s[40:43], s63 offen nt
    s_branch .Lsk_m0_3
.Lst_m0_3:
    s_branch .Lrt_m0_3
.Lsk_m0_3:
    s_waitcnt vmcnt(3)
    s_bitcmp1_b64 s[14:15], 16
    s_cbranch_scc0 1
    s_waitcnt vmcnt(2)
    s_add_u32 s63, s69, 262144
    buffer_load_dwordx4 v[48:51], v1, s[40:43], s63 offen nt
    s_waitcnt vmcnt(3)
    s_bitcmp1_b64 s[14:15], 17
    s_cbranch_scc0 1
    s_waitcnt vmcnt(2)
    s_add_u32 s63, s69, 270336
    buffer_load_dwordx4 v[52:55], v1, s[40:43], s63 offen nt
    s_branch .Le_done
.Lmr_part:
    s_mul_i32 s58, s3, 1152
    s_mov_b32 s52, s24
    s_and_b32 s53, s25, 0xffff
    s_mov_b32 s54, 0x2400
    s_mov_b32 s55, 0x00020000
    buffer_load_dwordx2 v[246:247], v3, s[52:55], s58 offen
    buffer_load_dwordx2 v[248:249], v3, s[52:55], s58 offen offset:512
    buffer_load_dword v250, v4, s[52:55], s58 offen
    s_mov_b32 s48, s26
    s_and_b32 s49, s27, 0xffff
    s_mov_b32 s50, 0x3cc000
    s_mov_b32 s51, 0x00020000
    v_bfe_u32 v12, v0, 4, 1
    s_and_b32 s56, s3, 3
    s_lshl_b32 s56, s56, 1
    v_or_b32 v12, s56, v12
    v_and_b32 v19, 7, v0
    v_xor_b32 v12, v12, v19
    v_lshrrev_b32 v19, 3, v0
    v_mul_u32_u24 v19, 6912, v19
    v_lshl_add_u32 v19, v12, 4, v19
    s_mul_i32 s57, s3, 55296
    s_lshl_b32 s59, s99, 7
    s_add_u32 s57, s57, s59
    s_add_u32 m0, s100, 0
    s_add_u32 s56, s57, 0
    buffer_load_dwordx4 v19, s[48:51], s56 offen nt lds
    s_add_u32 m0, s100, 8192
    s_add_u32 s56, s57, 442368
    buffer_load_dwordx4 v19, s[48:51], s56 offen nt lds
    s_add_u32 m0, s100, 16384
    s_add_u32 s56, s57, 884736
    buffer_load_dwordx4 v19, s[48:51], s56 offen nt lds
    s_add_u32 m0, s100, 24576
    s_add_u32 s56, s57, 1327104
    buffer_load_dwordx4 v19, s[48:51], s56 offen nt lds
    s_add_u32 m0, s100, 32768
    s_add_u32 s56, s57, 1769472
    buffer_load_dwordx4 v19, s[48:51], s56 offen nt lds
    s_add_u32 m0, s100, 40960
    s_add_u32 s56, s57, 2211840
    buffer_load_dwordx4 v19, s[48:51], s56 offen nt lds
    s_add_u32 m0, s100, 49152
    s_add_u32 s56, s57, 2654208
    buffer_load_dwordx4 v19, s[48:51], s56 offen nt lds
    s_add_u32 m0, s100, 57344
    s_add_u32 s56, s57, 3096576
    buffer_load_dwordx4 v19, s[48:51], s56 offen nt lds
    s_add_u32 m0, s100, 65536
    s_add_u32 s56, s57, 3538944
    buffer_load_dwordx4 v19, s[48:51], s56 offen nt lds
    v_lshrrev_b32 v12, 4, v0
    v_mul_u32_u24 v12, 18432, v12
    v_and_b32 v13, 15, v0
    v_lshl_add_u32 v22, v13, 4, v12
    s_mul_i32 s57, s99, 57
    s_lshr_b32 s57, s57, 9
    s_mul_i32 s58, s57, 9
    s_sub_u32 s58, s99, s58
    s_mul_i32 s59, s57, 73728
    s_lshl_b32 s58, s58, 8
    s_add_u32 s59, s59, s58
    s_mul_i32 s58, s3, 2304
    s_add_u32 s59, s59, s58
    s_add_u32 s59, s59, 0x1000
    s_mov_b32 s58, 0
    s_cmp_eq_u32 s57, 1
    s_cselect_b32 s58, 1.0, s58
    s_cmp_eq_u32 s57, 4
    s_cselect_b32 s58, 1.0, s58
    s_waitcnt vmcnt(9)
    v_lshlrev_b32 v236, 16, v246
    v_and_b32 v237, 0xffff0000, v246
    v_max_f32 v236, 0xc2ae0000, v236
    v_min_f32 v242, 0x43000000, v236
    v_mul_f32 v238, 0xbfb8aa3b, v242
    v_fma_f32 v240, v242, s98, -v238
    v_fmac_f32 v240, 0xb2a57060, v242
    v_exp_f32 v238, v238
    v_mul_f32 v240, 0x3f317218, v240
    v_fmac_f32 v238, v238, v240
    v_add_f32 v238, 1.0, v238
    v_rcp_f32 v240, v238
    s_nop 0
    v_mul_f32 v242, v236, v240
    v_fma_f32 v238, -v242, v238, v236
    v_fma_f32 v236, v238, v240, v242
    v_max_f32 v237, 0xc2ae0000, v237
    v_min_f32 v243, 0x43000000, v237
    v_mul_f32 v239, 0xbfb8aa3b, v243
    v_fma_f32 v241, v243, s98, -v239
    v_fmac_f32 v241, 0xb2a57060, v243
    v_exp_f32 v239, v239
    v_mul_f32 v241, 0x3f317218, v241
    v_fmac_f32 v239, v239, v241
    v_add_f32 v239, 1.0, v239
    v_rcp_f32 v241, v239
    s_nop 0
    v_mul_f32 v243, v237, v241
    v_fma_f32 v239, -v243, v239, v237
    v_fma_f32 v237, v239, v241, v243
    v_cvt_pk_bf16_f32 v246, v236, v237
    v_lshlrev_b32 v236, 16, v247
    v_and_b32 v237, 0xffff0000, v247
    v_max_f32 v236, 0xc2ae0000, v236
    v_min_f32 v242, 0x43000000, v236
    v_mul_f32 v238, 0xbfb8aa3b, v242
    v_fma_f32 v240, v242, s98, -v238
    v_fmac_f32 v240, 0xb2a57060, v242
    v_exp_f32 v238, v238
    v_mul_f32 v240, 0x3f317218, v240
    v_fmac_f32 v238, v238, v240
    v_add_f32 v238, 1.0, v238
    v_rcp_f32 v240, v238
    s_nop 0
    v_mul_f32 v242, v236, v240
    v_fma_f32 v238, -v242, v238, v236
    v_fma_f32 v236, v238, v240, v242
    v_max_f32 v237, 0xc2ae0000, v237
    v_min_f32 v243, 0x43000000, v237
    v_mul_f32 v239, 0xbfb8aa3b, v243
    v_fma_f32 v241, v243, s98, -v239
    v_fmac_f32 v241, 0xb2a57060, v243
    v_exp_f32 v239, v239
    v_mul_f32 v241, 0x3f317218, v241
    v_fmac_f32 v239, v239, v241
    v_add_f32 v239, 1.0, v239
    v_rcp_f32 v241, v239
    s_nop 0
    v_mul_f32 v243, v237, v241
    v_fma_f32 v239, -v243, v239, v237
    v_fma_f32 v237, v239, v241, v243
    v_cvt_pk_bf16_f32 v247, v236, v237
    v_lshlrev_b32 v236, 16, v248
    v_and_b32 v237, 0xffff0000, v248
    v_max_f32 v236, 0xc2ae0000, v236
    v_min_f32 v242, 0x43000000, v236
    v_mul_f32 v238, 0xbfb8aa3b, v242
    v_fma_f32 v240, v242, s98, -v238
    v_fmac_f32 v240, 0xb2a57060, v242
    v_exp_f32 v238, v238
    v_mul_f32 v240, 0x3f317218, v240
    v_fmac_f32 v238, v238, v240
    v_add_f32 v238, 1.0, v238
    v_rcp_f32 v240, v238
    s_nop 0
    v_mul_f32 v242, v236, v240
    v_fma_f32 v238, -v242, v238, v236
    v_fma_f32 v236, v238, v240, v242
    v_max_f32 v237, 0xc2ae0000, v237
    v_min_f32 v243, 0x43000000, v237
    v_mul_f32 v239, 0xbfb8aa3b, v243
    v_fma_f32 v241, v243, s98, -v239
    v_fmac_f32 v241, 0xb2a57060, v243
    v_exp_f32 v239, v239
    v_mul_f32 v241, 0x3f317218, v241
    s_branch .Lsk_m0_4
.Lst_m0_4:
    s_branch .Lrt_m0_4
.Lsk_m0_4:
    v_fmac_f32 v239, v239, v241
    v_add_f32 v239, 1.0, v239
    v_rcp_f32 v241, v239
    s_nop 0
    v_mul_f32 v243, v237, v241
    v_fma_f32 v239, -v243, v239, v237
    v_fma_f32 v237, v239, v241, v243
    v_cvt_pk_bf16_f32 v248, v236, v237
    v_lshlrev_b32 v236, 16, v249
    v_and_b32 v237, 0xffff0000, v249
    v_max_f32 v236, 0xc2ae0000, v236
    v_min_f32 v242, 0x43000000, v236
    v_mul_f32 v238, 0xbfb8aa3b, v242
    v_fma_f32 v240, v242, s98, -v238
    v_fmac_f32 v240, 0xb2a57060, v242
    v_exp_f32 v238, v238
    v_mul_f32 v240, 0x3f317218, v240
    v_fmac_f32 v238, v238, v240
    v_add_f32 v238, 1.0, v238
    v_rcp_f32 v240, v238
    s_nop 0
    v_mul_f32 v242, v236, v240
    v_fma_f32 v238, -v242, v238, v236
    v_fma_f32 v236, v238, v240, v242
    v_max_f32 v237, 0xc2ae0000, v237
    v_min_f32 v243, 0x43000000, v237
    v_mul_f32 v239, 0xbfb8aa3b, v243
    v_fma_f32 v241, v243, s98, -v239
    v_fmac_f32 v241, 0xb2a57060, v243
    v_exp_f32 v239, v239
    v_mul_f32 v241, 0x3f317218, v241
    v_fmac_f32 v239, v239, v241
    v_add_f32 v239, 1.0, v239
    v_rcp_f32 v241, v239
    s_nop 0
    v_mul_f32 v243, v237, v241
    v_fma_f32 v239, -v243, v239, v237
    v_fma_f32 v237, v239, v241, v243
    v_cvt_pk_bf16_f32 v249, v236, v237
    v_lshlrev_b32 v236, 16, v250
    v_and_b32 v237, 0xffff0000, v250
    v_max_f32 v236, 0xc2ae0000, v236
    v_min_f32 v242, 0x43000000, v236
    v_mul_f32 v238, 0xbfb8aa3b, v242
    v_fma_f32 v240, v242, s98, -v238
    v_fmac_f32 v240, 0xb2a57060, v242
    v_exp_f32 v238, v238
    v_mul_f32 v240, 0x3f317218, v240
    v_fmac_f32 v238, v238, v240
    v_add_f32 v238, 1.0, v238
    v_rcp_f32 v240, v238
    s_nop 0
    v_mul_f32 v242, v236, v240
    v_fma_f32 v238, -v242, v238, v236
    v_fma_f32 v236, v238, v240, v242
    v_max_f32 v237, 0xc2ae0000, v237
    v_min_f32 v243, 0x43000000, v237
    v_mul_f32 v239, 0xbfb8aa3b, v243
    v_fma_f32 v241, v243, s98, -v239
    v_fmac_f32 v241, 0xb2a57060, v243
    v_exp_f32 v239, v239
    v_mul_f32 v241, 0x3f317218, v241
    v_fmac_f32 v239, v239, v241
    v_add_f32 v239, 1.0, v239
    v_rcp_f32 v241, v239
    s_nop 0
    v_mul_f32 v243, v237, v241
    v_fma_f32 v239, -v243, v239, v237
    v_fma_f32 v237, v239, v241, v243
    v_cvt_pk_bf16_f32 v250, v236, v237
    ds_write_b64 v17, v[246:247] offset:0
    ds_write_b64 v17, v[248:249] offset:512
    ds_write_b32 v18, v250 offset:0
    s_waitcnt vmcnt(3)
    s_add_u32 s63, s69, 147456
    buffer_load_dwordx4 v[72:75], v1, s[40:43], s63 offen nt
    s_waitcnt vmcnt(3)
    s_add_u32 s63, s69, 155648
    buffer_load_dwordx4 v[76:79], v1, s[40:43], s63 offen nt
    s_waitcnt vmcnt(3)
    s_add_u32 s63, s69, 163840
    buffer_load_dwordx4 v[104:107], v1, s[40:43], s63 offen nt
    s_waitcnt vmcnt(3)
    s_add_u32 s63, s69, 172032
    buffer_load_dwordx4 v[108:111], v1, s[40:43], s63 offen nt
    s_waitcnt vmcnt(3)
    s_add_u32 s63, s69, 180224
    buffer_load_dwordx4 v[136:139], v1, s[40:43], s63 offen nt
    s_waitcnt vmcnt(3)
    s_add_u32 s63, s69, 188416
    buffer_load_dwordx4 v[140:143], v1, s[40:43], s63 offen nt
    s_waitcnt vmcnt(3)
    s_add_u32 s63, s69, 262144
    buffer_load_dwordx4 v[48:51], v1, s[40:43], s63 offen nt
    s_waitcnt vmcnt(3)
    s_add_u32 s63, s69, 270336
    buffer_load_dwordx4 v[52:55], v1, s[40:43], s63 offen nt
    s_waitcnt lgkmcnt(0)
    s_barrier
    ds_read_b64_tr_b16 v[160:161], v20 offset:0
    ds_read_b64_tr_b16 v[162:163], v20 offset:512
    ds_read_b64_tr_b16 v[164:165], v20 offset:8192
    ds_read_b64_tr_b16 v[166:167], v20 offset:8704
    ds_read_b64_tr_b16 v[168:169], v20 offset:16384
    ds_read_b64_tr_b16 v[170:171], v20 offset:16896
    ds_read_b64_tr_b16 v[172:173], v20 offset:24576
    ds_read_b64_tr_b16 v[174:175], v20 offset:25088
    ds_read_b64_tr_b16 v[176:177], v21 offset:0
    ds_read_b64_tr_b16 v[178:179], v21 offset:512
    ds_read_b64_tr_b16 v[180:181], v21 offset:8192
    ds_read_b64_tr_b16 v[182:183], v21 offset:8704
    ds_read_b64_tr_b16 v[184:185], v21 offset:16384
    ds_read_b64_tr_b16 v[186:187], v21 offset:16896
    ds_read_b64_tr_b16 v[188:189], v21 offset:24576
    ds_read_b64_tr_b16 v[190:191], v21 offset:25088
    ds_read_b64_tr_b16 v[192:193], v21 offset:32768
    ds_read_b64_tr_b16 v[194:195], v21 offset:33280
    ds_read_b128 v[196:199], v16 offset:0
    ds_read_b128 v[200:203], v16 offset:128
    ds_read_b128 v[204:207], v16 offset:256
    ds_read_b128 v[208:211], v16 offset:384
    ds_read_b128 v[212:215], v16 offset:512
    ds_read_b128 v[216:219], v16 offset:640
    ds_read_b128 v[220:223], v16 offset:768
    ds_read_b128 v[224:227], v16 offset:896
    ds_read_b128 v[228:231], v16 offset:1024
    s_waitcnt lgkmcnt(8)
    v_mfma_f32_16x16x32_bf16 v[232:235], v[160:163], v[196:199], 0
    s_waitcnt lgkmcnt(7)
    v_mfma_f32_16x16x32_bf16 v[232:235], v[164:167], v[200:203], v[232:235]
    s_waitcnt lgkmcnt(6)
    v_mfma_f32_16x16x32_bf16 v[232:235], v[168:171], v[204:207], v[232:235]
    s_waitcnt lgkmcnt(5)
    v_mfma_f32_16x16x32_bf16 v[232:235], v[172:175], v[208:211], v[232:235]
    s_waitcnt lgkmcnt(4)
    v_mfma_f32_16x16x32_bf16 v[232:235], v[176:179], v[212:215], v[232:235]
    s_waitcnt lgkmcnt(3)
    v_mfma_f32_16x16x32_bf16 v[232:235], v[180:183], v[216:219], v[232:235]
    s_waitcnt lgkmcnt(2)
    v_mfma_f32_16x16x32_bf16 v[232:235], v[184:187], v[220:223], v[232:235]
    s_waitcnt lgkmcnt(1)
    v_mfma_f32_16x16x32_bf16 v[232:235], v[188:191], v[224:227], v[232:235]
    s_waitcnt lgkmcnt(0)
    v_mfma_f32_16x16x32_bf16 v[232:235], v[192:195], v[228:231], v[232:235]
    s_nop 7
    v_permlane32_swap_b32 v232, v234
    v_permlane32_swap_b32 v233, v235
    v_cndmask_b32 v233, v233, v234, s[96:97]
    v_cndmask_b32 v232, v232, v235, s[96:97]
    s_nop 1
    v_add_f32_dpp v236, v233, v232 quad_perm:[1,0,3,2] row_mask:0xf bank_mask:0xf
    v_cvt_pk_bf16_f32 v236, v236, v236
    v_lshlrev_b32 v236, 16, v236
    v_add_f32 v236, s58, v236
    v_cvt_pk_bf16_f32 v236, v236, v236
    ds_write_b16 v23, v236
    v_mov_b32 v243, s34
    s_waitcnt lgkmcnt(0)
    s_barrier
    ds_read2_b32 v[244:245], v24 offset1:1
    v_mov_b32 v241, s34
    s_waitcnt lgkmcnt(0)
    v_mov_b32 v240, v244
    v_mov_b32 v242, v245
    s_bfm_b64 exec, 16, 0
    buffer_store_dwordx4 v[240:243], v22, s[36:39], s59 offen sc1
    s_mov_b64 exec, -1
.Le_done:
    v_and_b32 v8, 1, v0
    v_lshlrev_b32 v8, 8, v8
    v_and_b32 v9, 0x3c, v0
    v_lshl_add_u32 v9, v9, 2, v8
    v_add_u32 v7, v9, v8
    v_and_b32 v9, 0x3c, v0
    v_lshrrev_b32 v8, 4, v8
    v_and_b32 v9, 4, v0
    v_lshl_add_u32 v9, v9, 3, v8
    s_lshl_b32 s58, s66, 14
    s_lshl_b32 s59, s67, 10
    s_add_u32 s58, s58, s59
    s_add_u32 s58, s58, 0x70000
    s_lshl4_add_u32 s59, s66, s67
    s_lshl_b32 s59, s59, 7
    s_add_u32 s59, s59, 0x430000
    s_waitcnt vmcnt(3)
    s_bitcmp1_b64 s[14:15], 18
    s_cbranch_scc0 1
    s_waitcnt vmcnt(2)
    s_add_u32 s63, s69, 278528
    buffer_load_dwordx4 v[80:83], v1, s[40:43], s63 offen nt
    v_and_b32 v157, 7, v0
    v_lshlrev_b32 v157, 2, v157
    s_mov_b32 s63, 0x4a1000
    buffer_load_dword v156, v157, s[36:39], s63 offen
    s_cmp_eq_u32 s3, 0
    s_cbranch_scc1 .Lst_m1_0
    s_cmp_eq_u32 s3, 1
    s_cbranch_scc1 .Lst_m1_1
    s_cmp_eq_u32 s3, 2
    s_cbranch_scc1 .Lst_m1_2
    s_cmp_eq_u32 s3, 3
    s_cbranch_scc1 .Lst_m1_3
    s_cmp_eq_u32 s3, 4
    s_cbranch_scc1 .Lst_m1_4
    s_cmp_eq_u32 s3, 5
    s_cbranch_scc1 .Lst_m1_5
    s_cmp_eq_u32 s3, 6
    s_cbranch_scc1 .Lst_m1_6
    s_cmp_eq_u32 s3, 7
    s_cbranch_scc1 .Lst_m1_7
.Lrt_m1_0:
.Lrt_m1_1:
.Lrt_m1_2:
.Lrt_m1_3:
.Lrt_m1_4:
.Lrt_m1_5:
.Lrt_m1_6:
.Lrt_m1_7:
    s_memrealtime s[8:9]
    s_waitcnt lgkmcnt(0)
    s_sub_u32 s8, s8, s30
    s_cmpk_ge_u32 s8, 909
    s_cbranch_scc1 .ap_57
    s_waitcnt vmcnt(5)
    s_cmpk_ge_u32 s8, 809
    s_cbranch_scc1 .ap_57
    s_waitcnt vmcnt(4)
    s_bitcmp1_b64 s[14:15], 19
    s_cbranch_scc0 1
    s_waitcnt vmcnt(3)
    s_cmpk_ge_u32 s8, 689
    s_cbranch_scc1 .ap_57
    s_waitcnt vmcnt(2)
.ap_57:
    s_add_u32 s63, s69, 286720
    buffer_load_dwordx4 v[84:87], v1, s[40:43], s63 offen nt
    s_memrealtime s[8:9]
    s_waitcnt lgkmcnt(0)
    s_sub_u32 s8, s8, s30
    s_cmpk_ge_u32 s8, 954
    s_cbranch_scc1 .ap_58
    s_waitcnt vmcnt(6)
    s_cmpk_ge_u32 s8, 854
    s_cbranch_scc1 .ap_58
    s_waitcnt vmcnt(4)
    s_bitcmp1_b64 s[14:15], 20
    s_cbranch_scc0 1
    s_waitcnt vmcnt(3)
    s_cmpk_ge_u32 s8, 734
    s_cbranch_scc1 .ap_58
    s_waitcnt vmcnt(2)
.ap_58:
    s_add_u32 s63, s69, 294912
    buffer_load_dwordx4 v[112:115], v1, s[40:43], s63 offen nt
    s_memrealtime s[8:9]
    s_waitcnt lgkmcnt(0)
    s_sub_u32 s8, s8, s30
    s_cmpk_ge_u32 s8, 999
    s_cbranch_scc1 .ap_59
    s_waitcnt vmcnt(6)
    s_cmpk_ge_u32 s8, 899
    s_cbranch_scc1 .ap_59
    s_waitcnt vmcnt(4)
    s_bitcmp1_b64 s[14:15], 21
    s_cbranch_scc0 1
    s_waitcnt vmcnt(3)
    s_cmpk_ge_u32 s8, 779
    s_cbranch_scc1 .ap_59
    s_waitcnt vmcnt(1)
.ap_59:
    s_add_u32 s63, s69, 303104
    buffer_load_dwordx4 v[116:119], v1, s[40:43], s63 offen nt
    s_memrealtime s[8:9]
    s_waitcnt lgkmcnt(0)
    s_sub_u32 s8, s8, s30
    s_cmpk_ge_u32 s8, 1044
    s_cbranch_scc1 .ap_60
    s_waitcnt vmcnt(6)
    s_cmpk_ge_u32 s8, 944
    s_cbranch_scc1 .ap_60
    s_waitcnt vmcnt(4)
    s_bitcmp1_b64 s[14:15], 22
    s_cbranch_scc0 1
    s_waitcnt vmcnt(2)
    s_cmpk_ge_u32 s8, 824
    s_cbranch_scc1 .ap_60
    s_waitcnt vmcnt(1)
.ap_60:
    s_add_u32 s63, s69, 311296
    buffer_load_dwordx4 v[144:147], v1, s[40:43], s63 offen nt
    s_waitcnt vmcnt(4)
    s_sub_u32 s63, s70, 300
    v_subrev_u32 v156, s63, v156
    v_mov_b32 v157, 600
    v_cmp_lt_u32 s[8:9], v156, v157
    v_add_u32_dpp v156, v156, v156 quad_perm:[1,0,3,2] row_mask:0xf bank_mask:0xf
    s_nop 1
    v_add_u32_dpp v156, v156, v156 quad_perm:[2,3,0,1] row_mask:0xf bank_mask:0xf
    s_nop 1
    v_add_u32_dpp v156, v156, v156 row_ror:4 row_mask:0xf bank_mask:0xf
    s_nop 0
    v_readfirstlane_b32 s63, v156
    s_cmp_eq_u64 s[8:9], -1
    s_nop 3
    s_cbranch_scc0 .et_61
    s_lshr_b32 s63, s63, 3
    s_sub_u32 s63, s63, 300
    s_add_u32 s30, s30, s63
    s_add_u32 s31, s31, s63
.et_61:
    s_memrealtime s[8:9]
    s_waitcnt lgkmcnt(0)
    s_sub_u32 s8, s8, s30
    s_cmpk_ge_u32 s8, 1089
    s_cbranch_scc1 .ap_62
    s_waitcnt vmcnt(4)
    s_cmpk_ge_u32 s8, 989
    s_cbranch_scc1 .ap_62
    s_waitcnt vmcnt(3)
    s_bitcmp1_b64 s[14:15], 23
    s_cbranch_scc0 1
    s_waitcnt vmcnt(2)
    s_cmpk_ge_u32 s8, 869
    s_cbranch_scc1 .ap_62
    s_waitcnt vmcnt(1)
.ap_62:
    s_add_u32 s63, s69, 319488
    buffer_load_dwordx4 v[148:151], v1, s[40:43], s63 offen nt
    s_memrealtime s[8:9]
    s_waitcnt lgkmcnt(0)
    s_sub_u32 s8, s8, s30
    s_cmpk_ge_u32 s8, 1134
    s_cbranch_scc1 .ap_63
    s_waitcnt vmcnt(5)
    s_cmpk_ge_u32 s8, 1034
    s_cbranch_scc1 .ap_63
    s_waitcnt vmcnt(3)
    s_bitcmp1_b64 s[14:15], 24
    s_cbranch_scc0 1
    s_waitcnt vmcnt(2)
    s_cmpk_ge_u32 s8, 914
    s_cbranch_scc1 .ap_63
    s_waitcnt vmcnt(1)
.ap_63:
    s_add_u32 s63, s69, 393216
    buffer_load_dwordx4 v[56:59], v1, s[40:43], s63 offen nt
    s_memrealtime s[8:9]
    s_waitcnt lgkmcnt(0)
    s_sub_u32 s8, s8, s30
    s_cmpk_ge_u32 s8, 1180
    s_cbranch_scc1 .ap_64
    s_waitcnt vmcnt(5)
    s_cmpk_ge_u32 s8, 1080
    s_cbranch_scc1 .ap_64
    s_waitcnt vmcnt(3)
    s_bitcmp1_b64 s[14:15], 25
    s_cbranch_scc0 1
    s_waitcnt vmcnt(2)
    s_cmpk_ge_u32 s8, 960
    s_cbranch_scc1 .ap_64
    s_branch .Lsk_m1_0
.Lst_m1_0:
    s_branch .Lrt_m1_0
.Lsk_m1_0:
    s_waitcnt vmcnt(1)
.ap_64:
    s_add_u32 s63, s69, 401408
    buffer_load_dwordx4 v[60:63], v1, s[40:43], s63 offen nt
    s_memrealtime s[8:9]
    s_waitcnt lgkmcnt(0)
    s_sub_u32 s8, s8, s30
    s_cmpk_ge_u32 s8, 1207
    s_cbranch_scc1 .ap_65
    s_waitcnt vmcnt(5)
    s_cmpk_ge_u32 s8, 1107
    s_cbranch_scc1 .ap_65
    s_waitcnt vmcnt(3)
    s_bitcmp1_b64 s[14:15], 26
    s_cbranch_scc0 1
    s_waitcnt vmcnt(2)
    s_cmpk_ge_u32 s8, 987
    s_cbranch_scc1 .ap_65
    s_waitcnt vmcnt(1)
.ap_65:
    s_add_u32 s63, s69, 409600
    buffer_load_dwordx4 v[88:91], v1, s[40:43], s63 offen nt
    s_memrealtime s[8:9]
    s_waitcnt lgkmcnt(0)
    s_sub_u32 s8, s8, s30
    s_cmpk_ge_u32 s8, 1234
    s_cbranch_scc1 .ap_66
    s_waitcnt vmcnt(5)
    s_cmpk_ge_u32 s8, 1134
    s_cbranch_scc1 .ap_66
    s_waitcnt vmcnt(3)
    s_bitcmp1_b64 s[14:15], 27
    s_cbranch_scc0 1
    s_waitcnt vmcnt(2)
    s_cmpk_ge_u32 s8, 1014
    s_cbranch_scc1 .ap_66
    s_waitcnt vmcnt(1)
.ap_66:
    s_add_u32 s63, s69, 417792
    buffer_load_dwordx4 v[92:95], v1, s[40:43], s63 offen nt
    s_memrealtime s[8:9]
    s_waitcnt vmcnt(8)
    s_waitcnt lgkmcnt(0)
    s_sub_u32 s8, s8, s30
    s_cmpk_ge_u32 s8, 1261
    s_cbranch_scc1 .ap_67
    s_waitcnt vmcnt(5)
    s_cmpk_ge_u32 s8, 1161
    s_cbranch_scc1 .ap_67
    s_waitcnt vmcnt(3)
    s_bitcmp1_b64 s[14:15], 28
    s_cbranch_scc0 1
    s_waitcnt vmcnt(2)
    s_cmpk_ge_u32 s8, 1041
    s_cbranch_scc1 .ap_67
    s_waitcnt vmcnt(1)
.ap_67:
    s_add_u32 s63, s69, 425984
    buffer_load_dwordx4 v[120:123], v1, s[40:43], s63 offen nt
    s_memrealtime s[8:9]
    s_waitcnt vmcnt(8)
    s_waitcnt lgkmcnt(0)
    s_sub_u32 s8, s8, s30
    s_cmpk_ge_u32 s8, 1288
    s_cbranch_scc1 .ap_68
    s_waitcnt vmcnt(5)
    s_cmpk_ge_u32 s8, 1188
    s_cbranch_scc1 .ap_68
    s_waitcnt vmcnt(3)
    s_bitcmp1_b64 s[14:15], 29
    s_cbranch_scc0 1
    s_waitcnt vmcnt(2)
    s_cmpk_ge_u32 s8, 1068
    s_cbranch_scc1 .ap_68
    s_waitcnt vmcnt(1)
.ap_68:
    s_add_u32 s63, s69, 434176
    buffer_load_dwordx4 v[124:127], v1, s[40:43], s63 offen nt
    s_memrealtime s[8:9]
    s_waitcnt vmcnt(8)
    s_waitcnt lgkmcnt(0)
    s_sub_u32 s8, s8, s30
    s_cmpk_ge_u32 s8, 1315
    s_cbranch_scc1 .ap_69
    s_waitcnt vmcnt(5)
    s_cmpk_ge_u32 s8, 1215
    s_cbranch_scc1 .ap_69
    s_waitcnt vmcnt(3)
    s_bitcmp1_b64 s[14:15], 30
    s_cbranch_scc0 1
    s_waitcnt vmcnt(2)
    s_cmpk_ge_u32 s8, 1095
    s_cbranch_scc1 .ap_69
    s_waitcnt vmcnt(1)
.ap_69:
    s_add_u32 s63, s69, 442368
    buffer_load_dwordx4 v[152:155], v1, s[40:43], s63 offen nt
    s_and_b32 s0, s0, 0xffffff80
    s_sub_u32 s0, s0, 1024
    buffer_load_dword v28, v4, s[36:39], s0 offen sc1
    s_memrealtime s[8:9]
    s_waitcnt vmcnt(9)
    s_waitcnt lgkmcnt(0)
    s_sub_u32 s8, s8, s30
    s_cmpk_ge_u32 s8, 1342
    s_cbranch_scc1 .ap_70
    s_waitcnt vmcnt(6)
    s_cmpk_ge_u32 s8, 1242
    s_cbranch_scc1 .ap_70
    s_waitcnt vmcnt(4)
    s_bitcmp1_b64 s[14:15], 31
    s_cbranch_scc0 1
    s_waitcnt vmcnt(3)
    s_cmpk_ge_u32 s8, 1122
    s_cbranch_scc1 .ap_70
    s_waitcnt vmcnt(2)
.ap_70:
    s_add_u32 s63, s69, 450560
    buffer_load_dwordx4 v[156:159], v1, s[40:43], s63 offen nt
    s_memrealtime s[8:9]
    s_waitcnt vmcnt(9)
    s_waitcnt lgkmcnt(0)
    s_sub_u32 s8, s8, s30
    s_cmpk_ge_u32 s8, 1369
    s_cbranch_scc1 .ap_71
    s_waitcnt vmcnt(6)
    s_cmpk_ge_u32 s8, 1269
    s_cbranch_scc1 .ap_71
    s_waitcnt vmcnt(4)
    s_bitcmp1_b64 s[14:15], 32
    s_cbranch_scc0 1
    s_waitcnt vmcnt(3)
    s_cmpk_ge_u32 s8, 1149
    s_cbranch_scc1 .ap_71
    s_waitcnt vmcnt(2)
.ap_71:
    v_bfe_u32 v1, v0, 4, 2
    v_and_b32 v10, 0xf0, v2
    v_lshlrev_b32 v1, 2, v1
    v_bfe_u32 v1, s6, v1, 4
    v_lshl_add_u32 v1, v1, 8, v10
    s_add_u32 s63, s69, 0
    buffer_load_dwordx4 v[160:163], v1, s[44:47], s63 offen nt
    s_memrealtime s[8:9]
    s_waitcnt vmcnt(9)
    s_waitcnt lgkmcnt(0)
    s_sub_u32 s8, s8, s30
    s_cmpk_ge_u32 s8, 1396
    s_cbranch_scc1 .ap_72
    s_waitcnt vmcnt(6)
    s_cmpk_ge_u32 s8, 1296
    s_cbranch_scc1 .ap_72
    s_waitcnt vmcnt(4)
    s_bitcmp1_b64 s[14:15], 33
    s_cbranch_scc0 1
    s_waitcnt vmcnt(3)
    s_cmpk_ge_u32 s8, 1176
    s_cbranch_scc1 .ap_72
    s_waitcnt vmcnt(1)
.ap_72:
    s_add_u32 s63, s69, 8192
    buffer_load_dwordx4 v[164:167], v1, s[44:47], s63 offen nt
    s_memrealtime s[8:9]
    s_waitcnt vmcnt(9)
    s_waitcnt lgkmcnt(0)
    s_sub_u32 s8, s8, s30
    s_cmpk_ge_u32 s8, 1423
    s_cbranch_scc1 .ap_73
    s_waitcnt vmcnt(6)
    s_cmpk_ge_u32 s8, 1323
    s_cbranch_scc1 .ap_73
    s_waitcnt vmcnt(4)
    s_bitcmp1_b64 s[14:15], 34
    s_cbranch_scc0 1
    s_waitcnt vmcnt(2)
    s_cmpk_ge_u32 s8, 1203
    s_cbranch_scc1 .ap_73
    s_waitcnt vmcnt(1)
.ap_73:
    s_add_u32 s63, s69, 16384
    buffer_load_dwordx4 v[168:171], v1, s[44:47], s63 offen nt
    s_memrealtime s[8:9]
    s_waitcnt vmcnt(9)
    s_waitcnt lgkmcnt(0)
    s_sub_u32 s8, s8, s30
    s_cmpk_ge_u32 s8, 1450
    s_cbranch_scc1 .ap_74
    s_waitcnt vmcnt(6)
    s_cmpk_ge_u32 s8, 1350
    s_cbranch_scc1 .ap_74
    s_waitcnt vmcnt(3)
    s_bitcmp1_b64 s[14:15], 35
    s_cbranch_scc0 1
    s_waitcnt vmcnt(2)
    s_cmpk_ge_u32 s8, 1230
    s_cbranch_scc1 .ap_74
    s_waitcnt vmcnt(1)
.ap_74:
    s_add_u32 s63, s69, 24576
    buffer_load_dwordx4 v[172:175], v1, s[44:47], s63 offen nt
    s_waitcnt vmcnt(5)
    v_cmp_eq_u32 vcc, s1, v28
    s_cmp_eq_u64 vcc, -1
    s_cselect_b32 s0, 0x800000, 0
    s_add_u32 s58, s58, s0
    buffer_load_dwordx4 v[16:19], v7, s[36:39], s58 offen offset:0 sc1
    buffer_load_dwordx4 v[20:23], v7, s[36:39], s58 offen offset:256 sc1
    s_memrealtime s[8:9]
    s_waitcnt lgkmcnt(0)
    s_sub_u32 s8, s8, s30
    s_cmpk_ge_u32 s8, 1479
    s_cbranch_scc1 .ap_75
    s_waitcnt vmcnt(5)
    s_cmpk_ge_u32 s8, 1379
    s_cbranch_scc1 .ap_75
    s_waitcnt vmcnt(3)
    s_bitcmp1_b64 s[14:15], 36
    s_cbranch_scc0 1
    s_waitcnt vmcnt(2)
    s_cmpk_ge_u32 s8, 1259
    s_cbranch_scc1 .ap_75
    s_waitcnt vmcnt(1)
.ap_75:
    s_add_u32 s63, s69, 32768
    buffer_load_dwordx4 v[176:179], v1, s[44:47], s63 offen nt
    s_memrealtime s[8:9]
    s_waitcnt lgkmcnt(0)
    s_sub_u32 s8, s8, s30
    s_cmpk_ge_u32 s8, 1509
    s_cbranch_scc1 .ap_76
    s_waitcnt vmcnt(5)
    s_cmpk_ge_u32 s8, 1409
    s_cbranch_scc1 .ap_76
    s_waitcnt vmcnt(3)
    s_bitcmp1_b64 s[14:15], 37
    s_cbranch_scc0 1
    s_waitcnt vmcnt(2)
    s_cmpk_ge_u32 s8, 1289
    s_cbranch_scc1 .ap_76
    s_branch .Lsk_m1_1
.Lst_m1_1:
    s_branch .Lrt_m1_1
.Lsk_m1_1:
    s_waitcnt vmcnt(1)
.ap_76:
    s_add_u32 s63, s69, 40960
    buffer_load_dwordx4 v[180:183], v1, s[44:47], s63 offen nt
    s_memrealtime s[8:9]
    s_waitcnt vmcnt(8)
    s_waitcnt lgkmcnt(0)
    s_sub_u32 s8, s8, s30
    s_cmpk_ge_u32 s8, 1539
    s_cbranch_scc1 .ap_77
    s_waitcnt vmcnt(5)
    s_cmpk_ge_u32 s8, 1439
    s_cbranch_scc1 .ap_77
    s_waitcnt vmcnt(3)
    s_bitcmp1_b64 s[14:15], 38
    s_cbranch_scc0 1
    s_waitcnt vmcnt(2)
    s_cmpk_ge_u32 s8, 1319
    s_cbranch_scc1 .ap_77
    s_waitcnt vmcnt(1)
.ap_77:
    s_add_u32 s63, s69, 49152
    buffer_load_dwordx4 v[184:187], v1, s[44:47], s63 offen nt
    s_waitcnt vmcnt(3)
    s_branch .gpc_79
.gp_78:
    s_xor_b32 s58, s58, 0x800000
    buffer_load_dwordx4 v[16:19], v7, s[36:39], s58 offen offset:0 sc1
    buffer_load_dwordx4 v[20:23], v7, s[36:39], s58 offen offset:256 sc1
    s_waitcnt vmcnt(0)
.gpc_79:
    v_min_u32 v10, v17, v19
    v_max_u32 v11, v17, v19
    v_min3_u32 v10, v10, v21, v23
    v_max3_u32 v11, v11, v21, v23
    v_cmp_eq_u32 vcc, s34, v10
    v_cmp_eq_u32 s[56:57], s34, v11
    s_and_b64 vcc, vcc, s[56:57]
    s_cmp_eq_u64 vcc, -1
    s_nop 2
    s_cbranch_scc1 .gpd_80
    s_sub_u32 s35, s35, 1
    s_cbranch_scc1 .Lexit
    s_sleep 1
    s_branch .gp_78
.gpd_80:
    s_mov_b32 vcc_lo, 0xcccccccc
    s_mov_b32 vcc_hi, 0xcccccccc
    v_cndmask_b32_e64 v24, v16, 0, vcc
    v_cndmask_b32_e64 v25, v18, 0, vcc
    v_cndmask_b32_e64 v26, v20, 0, vcc
    v_cndmask_b32_e64 v27, v22, 0, vcc
    v_cndmask_b32_e32 v28, 0, v16, vcc
    v_cndmask_b32_e32 v29, 0, v18, vcc
    v_cndmask_b32_e32 v30, 0, v20, vcc
    v_cndmask_b32_e32 v31, 0, v22, vcc
    v_mfma_f32_16x16x32_bf16 v[16:19], v[32:35], v[24:27], 0
    v_mfma_f32_16x16x32_bf16 v[32:35], v[40:43], v[24:27], 0
    v_mfma_f32_16x16x32_bf16 v[16:19], v[36:39], v[28:31], v[16:19]
    v_mfma_f32_16x16x32_bf16 v[40:43], v[48:51], v[24:27], 0
    v_mfma_f32_16x16x32_bf16 v[32:35], v[44:47], v[28:31], v[32:35]
    v_mfma_f32_16x16x32_bf16 v[48:51], v[56:59], v[24:27], 0
    v_mfma_f32_16x16x32_bf16 v[40:43], v[52:55], v[28:31], v[40:43]
    v_mfma_f32_16x16x32_bf16 v[56:59], v[64:67], v[24:27], 0
    v_mfma_f32_16x16x32_bf16 v[48:51], v[60:63], v[28:31], v[48:51]
    s_nop 1
    v_add_f32_dpp v10, v17, v16 row_ror:12 row_mask:0xf bank_mask:0x1
    s_memrealtime s[8:9]
    s_waitcnt lgkmcnt(0)
    s_sub_u32 s8, s8, s30
    s_cmpk_ge_u32 s8, 1569
    s_nop 0
    s_cbranch_scc1 .ap_81
    s_waitcnt vmcnt(3)
    s_cmpk_ge_u32 s8, 1469
    s_cbranch_scc1 .ap_81
    s_waitcnt vmcnt(3)
    s_bitcmp1_b64 s[14:15], 39
    s_cbranch_scc0 1
    s_waitcnt vmcnt(2)
    s_cmpk_ge_u32 s8, 1349
    s_cbranch_scc1 .ap_81
    s_waitcnt vmcnt(1)
.ap_81:
    s_add_u32 s63, s69, 57344
    buffer_load_dwordx4 v[188:191], v1, s[44:47], s63 offen nt
    v_mfma_f32_16x16x32_bf16 v[64:67], v[72:75], v[24:27], 0
    v_mfma_f32_16x16x32_bf16 v[56:59], v[68:71], v[28:31], v[56:59]
    v_add_f32_dpp v11, v33, v32 row_ror:12 row_mask:0xf bank_mask:0x1
    v_add_f32_dpp v10, v18, v10 row_ror:8 row_mask:0xf bank_mask:0x1
    v_mfma_f32_16x16x32_bf16 v[72:75], v[80:83], v[24:27], 0
    v_mfma_f32_16x16x32_bf16 v[64:67], v[76:79], v[28:31], v[64:67]
    v_add_f32_dpp v12, v41, v40 row_ror:12 row_mask:0xf bank_mask:0x1
    v_add_f32_dpp v11, v34, v11 row_ror:8 row_mask:0xf bank_mask:0x1
    v_add_f32_dpp v10, v19, v10 row_ror:4 row_mask:0xf bank_mask:0x1
    v_mfma_f32_16x16x32_bf16 v[80:83], v[88:91], v[24:27], 0
    v_mfma_f32_16x16x32_bf16 v[72:75], v[84:87], v[28:31], v[72:75]
    v_add_f32_dpp v13, v49, v48 row_ror:12 row_mask:0xf bank_mask:0x1
    v_add_f32_dpp v12, v42, v12 row_ror:8 row_mask:0xf bank_mask:0x1
    v_add_f32_dpp v11, v35, v11 row_ror:4 row_mask:0xf bank_mask:0x1
    v_mfma_f32_16x16x32_bf16 v[88:91], v[96:99], v[24:27], 0
    v_mfma_f32_16x16x32_bf16 v[80:83], v[92:95], v[28:31], v[80:83]
    v_add_f32_dpp v10, v58, v57 row_ror:12 row_mask:0xf bank_mask:0x2
    v_add_f32_dpp v13, v50, v13 row_ror:8 row_mask:0xf bank_mask:0x1
    v_add_f32_dpp v12, v43, v12 row_ror:4 row_mask:0xf bank_mask:0x1
    s_memrealtime s[8:9]
    s_waitcnt lgkmcnt(0)
    s_sub_u32 s8, s8, s30
    s_cmpk_ge_u32 s8, 1599
    s_nop 0
    s_cbranch_scc1 .ap_82
    s_waitcnt vmcnt(4)
    s_cmpk_ge_u32 s8, 1499
    s_cbranch_scc1 .ap_82
    s_waitcnt vmcnt(3)
    s_bitcmp1_b64 s[14:15], 40
    s_cbranch_scc0 1
    s_waitcnt vmcnt(2)
    s_cmpk_ge_u32 s8, 1379
    s_cbranch_scc1 .ap_82
    s_waitcnt vmcnt(1)
.ap_82:
    s_add_u32 s63, s69, 131072
    buffer_load_dwordx4 v[192:195], v1, s[44:47], s63 offen nt
    v_mfma_f32_16x16x32_bf16 v[96:99], v[104:107], v[24:27], 0
    v_mfma_f32_16x16x32_bf16 v[88:91], v[100:103], v[28:31], v[88:91]
    v_add_f32_dpp v11, v66, v65 row_ror:12 row_mask:0xf bank_mask:0x2
    v_add_f32_dpp v10, v59, v10 row_ror:8 row_mask:0xf bank_mask:0x2
    v_add_f32_dpp v13, v51, v13 row_ror:4 row_mask:0xf bank_mask:0x1
    v_mfma_f32_16x16x32_bf16 v[104:107], v[112:115], v[24:27], 0
    v_mfma_f32_16x16x32_bf16 v[96:99], v[108:111], v[28:31], v[96:99]
    v_add_f32_dpp v12, v74, v73 row_ror:12 row_mask:0xf bank_mask:0x2
    v_add_f32_dpp v11, v67, v11 row_ror:8 row_mask:0xf bank_mask:0x2
    v_add_f32_dpp v10, v56, v10 row_ror:4 row_mask:0xf bank_mask:0x2
    v_mfma_f32_16x16x32_bf16 v[112:115], v[120:123], v[24:27], 0
    v_mfma_f32_16x16x32_bf16 v[104:107], v[116:119], v[28:31], v[104:107]
    v_add_f32_dpp v13, v82, v81 row_ror:12 row_mask:0xf bank_mask:0x2
    v_add_f32_dpp v12, v75, v12 row_ror:8 row_mask:0xf bank_mask:0x2
    v_add_f32_dpp v11, v64, v11 row_ror:4 row_mask:0xf bank_mask:0x2
    v_mfma_f32_16x16x32_bf16 v[120:123], v[128:131], v[24:27], 0
    v_mfma_f32_16x16x32_bf16 v[112:115], v[124:127], v[28:31], v[112:115]
    v_add_f32_dpp v10, v91, v90 row_ror:12 row_mask:0xf bank_mask:0x4
    v_add_f32_dpp v13, v83, v13 row_ror:8 row_mask:0xf bank_mask:0x2
    v_add_f32_dpp v12, v72, v12 row_ror:4 row_mask:0xf bank_mask:0x2
    s_memrealtime s[8:9]
    s_waitcnt lgkmcnt(0)
    s_sub_u32 s8, s8, s30
    s_cmpk_ge_u32 s8, 1629
    s_nop 0
    s_cbranch_scc1 .ap_83
    s_waitcnt vmcnt(5)
    s_cmpk_ge_u32 s8, 1529
    s_cbranch_scc1 .ap_83
    s_waitcnt vmcnt(3)
    s_bitcmp1_b64 s[14:15], 41
    s_cbranch_scc0 1
    s_waitcnt vmcnt(2)
    s_cmpk_ge_u32 s8, 1409
    s_cbranch_scc1 .ap_83
    s_waitcnt vmcnt(1)
.ap_83:
    s_add_u32 s63, s69, 139264
    buffer_load_dwordx4 v[196:199], v1, s[44:47], s63 offen nt
    v_mfma_f32_16x16x32_bf16 v[128:131], v[136:139], v[24:27], 0
    v_mfma_f32_16x16x32_bf16 v[120:123], v[132:135], v[28:31], v[120:123]
    v_add_f32_dpp v11, v99, v98 row_ror:12 row_mask:0xf bank_mask:0x4
    v_add_f32_dpp v10, v88, v10 row_ror:8 row_mask:0xf bank_mask:0x4
    v_add_f32_dpp v13, v80, v13 row_ror:4 row_mask:0xf bank_mask:0x2
    v_mfma_f32_16x16x32_bf16 v[136:139], v[144:147], v[24:27], 0
    v_mfma_f32_16x16x32_bf16 v[128:131], v[140:143], v[28:31], v[128:131]
    v_add_f32_dpp v12, v107, v106 row_ror:12 row_mask:0xf bank_mask:0x4
    v_add_f32_dpp v11, v96, v11 row_ror:8 row_mask:0xf bank_mask:0x4
    v_add_f32_dpp v10, v89, v10 row_ror:4 row_mask:0xf bank_mask:0x4
    v_mfma_f32_16x16x32_bf16 v[144:147], v[152:155], v[24:27], 0
    v_mfma_f32_16x16x32_bf16 v[136:139], v[148:151], v[28:31], v[136:139]
    v_add_f32_dpp v13, v115, v114 row_ror:12 row_mask:0xf bank_mask:0x4
    v_add_f32_dpp v12, v104, v12 row_ror:8 row_mask:0xf bank_mask:0x4
    v_add_f32_dpp v11, v97, v11 row_ror:4 row_mask:0xf bank_mask:0x4
    v_mfma_f32_16x16x32_bf16 v[144:147], v[156:159], v[28:31], v[144:147]
    v_add_f32_dpp v10, v120, v123 row_ror:12 row_mask:0xf bank_mask:0x8
    v_add_f32_dpp v13, v112, v13 row_ror:8 row_mask:0xf bank_mask:0x4
    v_add_f32_dpp v12, v105, v12 row_ror:4 row_mask:0xf bank_mask:0x4
    s_branch .Lsk_m1_2
.Lst_m1_2:
    s_branch .Lrt_m1_2
.Lsk_m1_2:
    s_memrealtime s[8:9]
    s_waitcnt lgkmcnt(0)
    s_sub_u32 s8, s8, s30
    s_cmpk_ge_u32 s8, 1659
    s_nop 0
    s_cbranch_scc1 .ap_84
    s_waitcnt vmcnt(5)
    s_cmpk_ge_u32 s8, 1559
    s_cbranch_scc1 .ap_84
    s_waitcnt vmcnt(3)
    s_bitcmp1_b64 s[14:15], 42
    s_cbranch_scc0 1
    s_waitcnt vmcnt(2)
    s_cmpk_ge_u32 s8, 1439
    s_cbranch_scc1 .ap_84
    s_waitcnt vmcnt(1)
.ap_84:
    s_add_u32 s63, s69, 147456
    buffer_load_dwordx4 v[200:203], v1, s[44:47], s63 offen nt
    v_add_f32_dpp v11, v128, v131 row_ror:12 row_mask:0xf bank_mask:0x8
    v_add_f32_dpp v10, v121, v10 row_ror:8 row_mask:0xf bank_mask:0x8
    v_add_f32_dpp v13, v113, v13 row_ror:4 row_mask:0xf bank_mask:0x4
    v_add_f32_dpp v12, v136, v139 row_ror:12 row_mask:0xf bank_mask:0x8
    v_add_f32_dpp v11, v129, v11 row_ror:8 row_mask:0xf bank_mask:0x8
    v_add_f32_dpp v10, v122, v10 row_ror:4 row_mask:0xf bank_mask:0x8
    v_add_f32_dpp v13, v144, v147 row_ror:12 row_mask:0xf bank_mask:0x8
    v_add_f32_dpp v12, v137, v12 row_ror:8 row_mask:0xf bank_mask:0x8
    v_add_f32_dpp v11, v130, v11 row_ror:4 row_mask:0xf bank_mask:0x8
    v_add_f32_dpp v13, v145, v13 row_ror:8 row_mask:0xf bank_mask:0x8
    v_add_f32_dpp v12, v138, v12 row_ror:4 row_mask:0xf bank_mask:0x8
    s_memrealtime s[8:9]
    s_waitcnt lgkmcnt(0)
    s_sub_u32 s8, s8, s30
    s_cmpk_ge_u32 s8, 1689
    s_cbranch_scc1 .ap_85
    s_waitcnt vmcnt(5)
    s_cmpk_ge_u32 s8, 1589
    s_cbranch_scc1 .ap_85
    s_waitcnt vmcnt(3)
    s_bitcmp1_b64 s[14:15], 43
    s_cbranch_scc0 1
    s_waitcnt vmcnt(2)
    s_cmpk_ge_u32 s8, 1469
    s_cbranch_scc1 .ap_85
    s_waitcnt vmcnt(1)
.ap_85:
    s_add_u32 s63, s69, 155648
    buffer_load_dwordx4 v[204:207], v1, s[44:47], s63 offen nt
    v_add_f32_dpp v13, v146, v13 row_ror:4 row_mask:0xf bank_mask:0x8
    s_mov_b32 s60, 0x3db504f3
    s_mov_b32 s61, 0x3db504f3
    v_cvt_pk_bf16_f32 v10, v10, v11
    v_and_b32 v11, 0xffff0000, v10
    v_lshlrev_b32 v10, 16, v10
    v_cvt_pk_bf16_f32 v12, v12, v13
    v_and_b32 v13, 0xffff0000, v12
    v_lshlrev_b32 v12, 16, v12
    v_pk_mul_f32 v[10:11], v[10:11], s[60:61]
    v_pk_mul_f32 v[12:13], v[12:13], s[60:61]
    v_cvt_pk_bf16_f32 v10, v10, v11
    v_and_b32 v11, 0xffff0000, v10
    v_lshlrev_b32 v10, 16, v10
    v_cvt_pk_bf16_f32 v12, v12, v13
    v_and_b32 v13, 0xffff0000, v12
    v_lshlrev_b32 v12, 16, v12
    v_max_f32 v14, v10, v11
    v_max3_f32 v14, v14, v12, v13
    s_mov_b32 s60, 0x3fb8aa3b
    v_mov_b32 v22, s34
    v_mov_b32 v23, s34
    v_max_f32_dpp v14, v14, v14 quad_perm:[2,3,0,1] row_mask:0xf bank_mask:0xf
    s_nop 1
    v_max_f32_dpp v14, v14, v14 row_ror:4 row_mask:0xf bank_mask:0xf
    s_nop 1
    v_max_f32_dpp v14, v14, v14 row_ror:8 row_mask:0xf bank_mask:0xf
    v_mov_b32 v15, v14
    s_nop 1
    v_permlane16_swap_b32 v15, v14
    v_max_f32 v14, v15, v14
    v_mov_b32 v15, v14
    s_nop 1
    v_permlane32_swap_b32 v15, v14
    v_max_f32 v14, v15, v14
    v_mul_f32 v15, 0xbfb8aa3b, v14
    v_fma_f32 v10, v10, s60, v15
    v_fma_f32 v11, v11, s60, v15
    v_fma_f32 v12, v12, s60, v15
    v_fma_f32 v13, v13, s60, v15
    v_exp_f32 v10, v10
    v_exp_f32 v11, v11
    v_exp_f32 v12, v12
    v_exp_f32 v13, v13
    v_mov_b32 v20, v14
    v_pk_add_f32 v[16:17], v[10:11], v[12:13]
    v_add_f32 v21, v16, v17
    s_lshl_b32 s60, s68, 5
    s_lshl_b32 s61, s3, 4
    s_add_u32 s61, s61, 159104
    v_add_u32 v16, s61, v3
    v_mov_b32 v17, 159232
    v_mov_b32 v18, 1
    s_add_u32 s60, s60, s59
    v_add_f32_dpp v21, v21, v21 quad_perm:[2,3,0,1] row_mask:0xf bank_mask:0xf
    s_nop 1
    v_add_f32_dpp v21, v21, v21 row_ror:4 row_mask:0xf bank_mask:0xf
    s_nop 1
    v_add_f32_dpp v21, v21, v21 row_ror:8 row_mask:0xf bank_mask:0xf
    v_mov_b32 v15, v21
    s_nop 1
    v_permlane16_swap_b32 v15, v21
    v_add_f32 v21, v15, v21
    v_mov_b32 v15, v21
    s_nop 1
    v_permlane32_swap_b32 v15, v21
    v_add_f32 v21, v15, v21
    s_mov_b64 exec, 3
    ds_write_b64 v16, v[20:21]
    s_mov_b64 exec, 1
    ds_add_rtn_u32 v18, v17, v18
    s_mov_b64 exec, -1
    v_and_b32 v16, 0x78, v3
    v_or_b32 v16, 159104, v16
    s_waitcnt lgkmcnt(0)
    v_readfirstlane_b32 s61, v18
    s_cmp_eq_u32 s61, 7
    s_nop 3
    s_cbranch_scc0 .mlc_86
    ds_read_b64 v[18:19], v16
    s_waitcnt lgkmcnt(0)
    v_mov_b32 v20, v18
    s_nop 1
    v_max_f32_dpp v20, v20, v20 quad_perm:[2,3,0,1] row_mask:0xf bank_mask:0xf
    s_nop 1
    v_max_f32_dpp v20, v20, v20 row_ror:4 row_mask:0xf bank_mask:0xf
    s_nop 1
    v_max_f32_dpp v20, v20, v20 row_ror:8 row_mask:0xf bank_mask:0xf
    v_sub_f32 v18, v18, v20
    v_mul_f32 v18, 0x3fb8aa3b, v18
    v_exp_f32 v18, v18
    s_nop 0
    v_mul_f32 v21, v18, v19
    s_nop 1
    v_add_f32_dpp v21, v21, v21 quad_perm:[2,3,0,1] row_mask:0xf bank_mask:0xf
    s_nop 1
    v_add_f32_dpp v21, v21, v21 row_ror:4 row_mask:0xf bank_mask:0xf
    s_nop 1
    v_add_f32_dpp v21, v21, v21 row_ror:8 row_mask:0xf bank_mask:0xf
    s_mov_b64 exec, 3
    s_add_u32 s57, s60, 0x800000
    buffer_store_dwordx4 v[20:23], v2, s[36:39], s57 offen
    s_cmp_lg_u32 s0, 0
    s_nop 0
    s_cbranch_scc1 .nosl_87
    buffer_store_dwordx4 v[20:23], v2, s[36:39], s60 offen sc1
.nosl_87:
    s_mov_b64 exec, -1
.mlc_86:
    s_add_u32 s59, s59, s0
    s_memrealtime s[8:9]
    s_waitcnt lgkmcnt(0)
    s_sub_u32 s8, s8, s30
    s_cmpk_ge_u32 s8, 1719
    s_cbranch_scc1 .ap_88
    s_waitcnt vmcnt(5)
    s_cmpk_ge_u32 s8, 1619
    s_cbranch_scc1 .ap_88
    s_waitcnt vmcnt(3)
    s_bitcmp1_b64 s[14:15], 44
    s_cbranch_scc0 1
    s_waitcnt vmcnt(2)
    s_cmpk_ge_u32 s8, 1499
    s_cbranch_scc1 .ap_88
    s_waitcnt vmcnt(1)
.ap_88:
    s_add_u32 s63, s69, 163840
    buffer_load_dwordx4 v[208:211], v1, s[44:47], s63 offen nt
    s_cmp_eq_u32 s3, 0
    s_cbranch_scc1 .Lst_m2_0
    s_cmp_eq_u32 s3, 1
    s_cbranch_scc1 .Lst_m2_1
    s_cmp_eq_u32 s3, 2
    s_cbranch_scc1 .Lst_m2_2
    s_cmp_eq_u32 s3, 3
    s_cbranch_scc1 .Lrt_m2_3
.Lrt_m2_0:
.Lrt_m2_1:
.Lrt_m2_2:
.Lrt_m2_3:
    v_mov_b32 v16, 0
    v_bfe_u32 v17, v0, 3, 1
    v_lshl_add_u32 v16, v17, 5, v16
    v_bfe_u32 v17, v0, 5, 1
    v_lshl_add_u32 v16, v17, 4, v16
    v_bfe_u32 v17, v0, 0, 3
    v_lshl_add_u32 v16, v17, 1, v16
    v_bfe_u32 v17, v0, 4, 1
    v_lshl_add_u32 v16, v17, 0, v16
    v_lshlrev_b32 v7, 1, v16
    v_and_b32 v8, 62, v16
    v_lshlrev_b32 v8, 2, v8
    s_mul_i32 s100, s3, 1152
    s_lshl_b32 s56, s65, 7
    s_add_u32 s100, s100, s56
    s_branch .Lsk_m1_3
.Lst_m1_3:
    s_branch .Lrt_m1_3
.Lsk_m1_3:
    s_mov_b32 s52, s4
    s_and_b32 s53, s5, 0xffff
    s_mov_b32 s54, 0x2400
    s_mov_b32 s55, 0x00020000
    buffer_load_ushort v40, v7, s[52:55], s100 offen
    s_lshr_b32 s56, s64, 1
    s_and_b32 s57, s3, 3
    s_cmp_lg_u32 s56, s57
    s_cselect_b64 exec, 0, -1
    s_mov_b32 s48, s16
    s_and_b32 s49, s17, 0xffff
    s_mov_b32 s50, 0x480
    s_mov_b32 s51, 0x00020000
    buffer_load_dwordx2 v[48:49], v3, s[48:51], 0 offen
    buffer_load_dwordx2 v[50:51], v3, s[48:51], 0 offen offset:512
    buffer_load_dword v34, v4, s[48:51], 0 offen
    s_mov_b32 s48, s28
    s_and_b32 s49, s29, 0xffff
    s_mov_b32 s50, 0x2400
    s_mov_b32 s51, 0x00020000
    buffer_load_ushort v39, v7, s[48:51], s100 offen nt
    s_mov_b64 exec, -1
    s_memrealtime s[8:9]
    s_waitcnt vmcnt(13)
    s_waitcnt lgkmcnt(0)
    s_sub_u32 s8, s8, s30
    s_cmpk_ge_u32 s8, 1749
    s_cbranch_scc1 .ap_89
    s_waitcnt vmcnt(10)
    s_cmpk_ge_u32 s8, 1649
    s_cbranch_scc1 .ap_89
    s_waitcnt vmcnt(8)
    s_bitcmp1_b64 s[14:15], 45
    s_cbranch_scc0 1
    s_waitcnt vmcnt(7)
    s_cmpk_ge_u32 s8, 1529
    s_cbranch_scc1 .ap_89
    s_waitcnt vmcnt(6)
.ap_89:
    s_add_u32 s63, s69, 172032
    buffer_load_dwordx4 v[212:215], v1, s[44:47], s63 offen nt
    s_memrealtime s[8:9]
    s_waitcnt vmcnt(13)
    s_waitcnt lgkmcnt(0)
    s_sub_u32 s8, s8, s30
    s_cmpk_ge_u32 s8, 1780
    s_cbranch_scc1 .ap_90
    s_waitcnt vmcnt(10)
    s_cmpk_ge_u32 s8, 1680
    s_cbranch_scc1 .ap_90
    s_waitcnt vmcnt(8)
    s_bitcmp1_b64 s[14:15], 46
    s_cbranch_scc0 1
    s_waitcnt vmcnt(7)
    s_cmpk_ge_u32 s8, 1560
    s_cbranch_scc1 .ap_90
    s_waitcnt vmcnt(6)
.ap_90:
    s_add_u32 s63, s69, 180224
    buffer_load_dwordx4 v[216:219], v1, s[44:47], s63 offen nt
    s_memrealtime s[8:9]
    s_waitcnt vmcnt(13)
    s_waitcnt lgkmcnt(0)
    s_sub_u32 s8, s8, s30
    s_cmpk_ge_u32 s8, 1812
    s_cbranch_scc1 .ap_91
    s_waitcnt vmcnt(10)
    s_cmpk_ge_u32 s8, 1712
    s_cbranch_scc1 .ap_91
    s_waitcnt vmcnt(8)
    s_bitcmp1_b64 s[14:15], 47
    s_cbranch_scc0 1
    s_waitcnt vmcnt(7)
    s_cmpk_ge_u32 s8, 1592
    s_cbranch_scc1 .ap_91
    s_waitcnt vmcnt(1)
.ap_91:
    s_add_u32 s63, s69, 188416
    buffer_load_dwordx4 v[220:223], v1, s[44:47], s63 offen nt
    s_memrealtime s[8:9]
    s_waitcnt vmcnt(13)
    s_waitcnt lgkmcnt(0)
    s_sub_u32 s8, s8, s30
    s_cmpk_ge_u32 s8, 1844
    s_cbranch_scc1 .ap_92
    s_waitcnt vmcnt(10)
    s_cmpk_ge_u32 s8, 1744
    s_cbranch_scc1 .ap_92
    s_waitcnt vmcnt(8)
    s_bitcmp1_b64 s[14:15], 48
    s_cbranch_scc0 1
    s_waitcnt vmcnt(2)
    s_cmpk_ge_u32 s8, 1624
    s_cbranch_scc1 .ap_92
    s_waitcnt vmcnt(1)
.ap_92:
    s_add_u32 s63, s69, 262144
    buffer_load_dwordx4 v[224:227], v1, s[44:47], s63 offen nt
    s_memrealtime s[8:9]
    s_waitcnt vmcnt(13)
    s_waitcnt lgkmcnt(0)
    s_sub_u32 s8, s8, s30
    s_cmpk_ge_u32 s8, 1876
    s_cbranch_scc1 .ap_93
    s_waitcnt vmcnt(10)
    s_cmpk_ge_u32 s8, 1776
    s_cbranch_scc1 .ap_93
    s_waitcnt vmcnt(3)
    s_bitcmp1_b64 s[14:15], 49
    s_cbranch_scc0 1
    s_waitcnt vmcnt(2)
    s_cmpk_ge_u32 s8, 1656
    s_cbranch_scc1 .ap_93
    s_waitcnt vmcnt(1)
.ap_93:
    s_add_u32 s63, s69, 270336
    buffer_load_dwordx4 v[228:231], v1, s[44:47], s63 offen nt
    s_memrealtime s[8:9]
    s_waitcnt vmcnt(13)
    s_waitcnt lgkmcnt(0)
    s_sub_u32 s8, s8, s30
    s_cmpk_ge_u32 s8, 1908
    s_cbranch_scc1 .ap_94
    s_waitcnt vmcnt(10)
    s_cmpk_ge_u32 s8, 1808
    s_cbranch_scc1 .ap_94
    s_waitcnt vmcnt(3)
    s_bitcmp1_b64 s[14:15], 50
    s_cbranch_scc0 1
    s_waitcnt vmcnt(2)
    s_cmpk_ge_u32 s8, 1688
    s_cbranch_scc1 .ap_94
    s_waitcnt vmcnt(1)
.ap_94:
    s_add_u32 s63, s69, 278528
    buffer_load_dwordx4 v[232:235], v1, s[44:47], s63 offen nt
    s_memrealtime s[8:9]
    s_waitcnt vmcnt(13)
    s_waitcnt lgkmcnt(0)
    s_sub_u32 s8, s8, s30
    s_cmpk_ge_u32 s8, 1939
    s_cbranch_scc1 .ap_95
    s_waitcnt vmcnt(5)
    s_cmpk_ge_u32 s8, 1839
    s_cbranch_scc1 .ap_95
    s_waitcnt vmcnt(3)
    s_bitcmp1_b64 s[14:15], 51
    s_cbranch_scc0 1
    s_waitcnt vmcnt(2)
    s_cmpk_ge_u32 s8, 1719
    s_cbranch_scc1 .ap_95
    s_waitcnt vmcnt(1)
.ap_95:
    s_add_u32 s63, s69, 286720
    buffer_load_dwordx4 v[236:239], v1, s[44:47], s63 offen nt
    s_memrealtime s[8:9]
    s_waitcnt vmcnt(13)
    s_waitcnt lgkmcnt(0)
    s_sub_u32 s8, s8, s30
    s_cmpk_ge_u32 s8, 1971
    s_cbranch_scc1 .ap_96
    s_waitcnt vmcnt(5)
    s_cmpk_ge_u32 s8, 1871
    s_cbranch_scc1 .ap_96
    s_waitcnt vmcnt(3)
    s_bitcmp1_b64 s[14:15], 52
    s_cbranch_scc0 1
    s_waitcnt vmcnt(2)
    s_cmpk_ge_u32 s8, 1751
    s_cbranch_scc1 .ap_96
    s_waitcnt vmcnt(1)
.ap_96:
    s_add_u32 s63, s69, 294912
    buffer_load_dwordx4 v[240:243], v1, s[44:47], s63 offen nt
    s_memrealtime s[8:9]
    s_branch .Lsk_m1_4
.Lst_m1_4:
    s_branch .Lrt_m1_4
.Lsk_m1_4:
    s_waitcnt vmcnt(13)
    s_waitcnt lgkmcnt(0)
    s_sub_u32 s8, s8, s30
    s_cmpk_ge_u32 s8, 2003
    s_cbranch_scc1 .ap_97
    s_waitcnt vmcnt(5)
    s_cmpk_ge_u32 s8, 1903
    s_cbranch_scc1 .ap_97
    s_waitcnt vmcnt(3)
    s_bitcmp1_b64 s[14:15], 53
    s_cbranch_scc0 1
    s_waitcnt vmcnt(2)
    s_cmpk_ge_u32 s8, 1783
    s_cbranch_scc1 .ap_97
    s_waitcnt vmcnt(1)
.ap_97:
    s_add_u32 s63, s69, 303104
    buffer_load_dwordx4 v[244:247], v1, s[44:47], s63 offen nt
    buffer_load_dwordx4 v[24:27], v9, s[36:39], s59 offen offset:0 sc1
    s_memrealtime s[8:9]
    s_waitcnt vmcnt(8)
    s_waitcnt lgkmcnt(0)
    s_sub_u32 s8, s8, s30
    s_cmpk_ge_u32 s8, 2035
    s_cbranch_scc1 .ap_98
    s_waitcnt vmcnt(5)
    s_cmpk_ge_u32 s8, 1935
    s_cbranch_scc1 .ap_98
    s_waitcnt vmcnt(3)
    s_bitcmp1_b64 s[14:15], 54
    s_cbranch_scc0 1
    s_waitcnt vmcnt(2)
    s_cmpk_ge_u32 s8, 1815
    s_cbranch_scc1 .ap_98
    s_waitcnt vmcnt(1)
.ap_98:
    s_add_u32 s63, s69, 311296
    buffer_load_dwordx4 v[248:251], v1, s[44:47], s63 offen nt
    s_memrealtime s[8:9]
    s_waitcnt vmcnt(8)
    s_waitcnt lgkmcnt(0)
    s_sub_u32 s8, s8, s30
    s_cmpk_ge_u32 s8, 2067
    s_cbranch_scc1 .ap_99
    s_waitcnt vmcnt(5)
    s_cmpk_ge_u32 s8, 1967
    s_cbranch_scc1 .ap_99
    s_waitcnt vmcnt(3)
    s_bitcmp1_b64 s[14:15], 55
    s_cbranch_scc0 1
    s_waitcnt vmcnt(2)
    s_cmpk_ge_u32 s8, 1847
    s_cbranch_scc1 .ap_99
    s_waitcnt vmcnt(1)
.ap_99:
    s_add_u32 s63, s69, 319488
    buffer_load_dwordx4 v[252:255], v1, s[44:47], s63 offen nt
    s_memrealtime s[8:9]
    s_waitcnt vmcnt(8)
    s_waitcnt lgkmcnt(0)
    s_sub_u32 s8, s8, s30
    s_cmpk_ge_u32 s8, 2098
    s_cbranch_scc1 .ap_100
    s_waitcnt vmcnt(5)
    s_cmpk_ge_u32 s8, 1998
    s_cbranch_scc1 .ap_100
    s_waitcnt vmcnt(3)
    s_bitcmp1_b64 s[14:15], 56
    s_cbranch_scc0 1
    s_waitcnt vmcnt(2)
    s_cmpk_ge_u32 s8, 1878
    s_cbranch_scc1 .ap_100
    s_waitcnt vmcnt(1)
.ap_100:
    s_add_u32 s63, s69, 393216
    buffer_load_dwordx4 v[36:39], v1, s[44:47], s63 offen nt
    s_memrealtime s[8:9]
    s_waitcnt vmcnt(8)
    s_waitcnt lgkmcnt(0)
    s_sub_u32 s8, s8, s30
    s_cmpk_ge_u32 s8, 2130
    s_cbranch_scc1 .ap_101
    s_waitcnt vmcnt(5)
    s_cmpk_ge_u32 s8, 2030
    s_cbranch_scc1 .ap_101
    s_waitcnt vmcnt(3)
    s_bitcmp1_b64 s[14:15], 57
    s_cbranch_scc0 1
    s_waitcnt vmcnt(2)
    s_cmpk_ge_u32 s8, 1910
    s_cbranch_scc1 .ap_101
    s_waitcnt vmcnt(1)
.ap_101:
    s_add_u32 s63, s69, 401408
    buffer_load_dwordx4 v[44:47], v1, s[44:47], s63 offen nt
    s_memrealtime s[8:9]
    s_waitcnt vmcnt(8)
    s_waitcnt lgkmcnt(0)
    s_sub_u32 s8, s8, s30
    s_cmpk_ge_u32 s8, 2162
    s_cbranch_scc1 .ap_102
    s_waitcnt vmcnt(5)
    s_cmpk_ge_u32 s8, 2062
    s_cbranch_scc1 .ap_102
    s_waitcnt vmcnt(3)
    s_bitcmp1_b64 s[14:15], 58
    s_cbranch_scc0 1
    s_waitcnt vmcnt(2)
    s_cmpk_ge_u32 s8, 1942
    s_cbranch_scc1 .ap_102
    s_waitcnt vmcnt(1)
.ap_102:
    s_add_u32 s63, s69, 409600
    buffer_load_dwordx4 v[52:55], v1, s[44:47], s63 offen nt
    s_waitcnt vmcnt(5)
    s_branch .gpc_104
.gp_103:
    s_xor_b32 s59, s59, 0x800000
    buffer_load_dwordx4 v[24:27], v9, s[36:39], s59 offen offset:0 sc1
    s_waitcnt vmcnt(0)
.gpc_104:
    v_cmp_eq_u32 vcc, s34, v26
    s_cmp_eq_u64 vcc, -1
    s_nop 3
    s_cbranch_scc1 .gpd_105
    s_sub_u32 s35, s35, 1
    s_cbranch_scc1 .Lexit
    s_sleep 1
    s_branch .gp_103
.gpd_105:
    v_mov_b32 v16, v24
    s_nop 1
    v_max_f32_dpp v16, v16, v16 row_ror:4 row_mask:0xf bank_mask:0xf
    v_sub_f32 v17, v24, v16
    v_sub_f32 v18, v14, v16
    v_mul_f32 v17, 0x3fb8aa3b, v17
    v_mul_f32 v18, 0x3fb8aa3b, v18
    v_exp_f32 v17, v17
    v_exp_f32 v18, v18
    v_mul_f32 v17, v17, v25
    s_nop 1
    v_add_f32_dpp v17, v17, v17 row_ror:4 row_mask:0xf bank_mask:0xf
    v_rcp_f32 v19, v17
    s_nop 0
    v_fma_f32 v15, -v17, v19, 1.0
    v_fma_f32 v19, v15, v19, v19
    v_mul_f32 v18, v18, v19
    v_mul_f32 v10, v10, v18
    v_mul_f32 v11, v11, v18
    v_mul_f32 v12, v12, v18
    v_mul_f32 v13, v13, v18
    v_mov_b32_dpp v112, v10 quad_perm:[2,3,0,1] row_mask:0xf bank_mask:0xf
    v_mov_b32_dpp v113, v11 quad_perm:[2,3,0,1] row_mask:0xf bank_mask:0xf
    v_mov_b32_dpp v114, v12 quad_perm:[2,3,0,1] row_mask:0xf bank_mask:0xf
    v_mov_b32_dpp v115, v13 quad_perm:[2,3,0,1] row_mask:0xf bank_mask:0xf
    v_cvt_pk_bf16_f32 v96, v10, v112
    v_cvt_pk_bf16_f32 v100, v11, v113
    v_cvt_pk_bf16_f32 v104, v12, v114
    v_cvt_pk_bf16_f32 v108, v13, v115
    v_mov_b32_dpp v97, v96 row_ror:12 row_mask:0xf bank_mask:0xf
    v_mov_b32_dpp v101, v100 row_ror:12 row_mask:0xf bank_mask:0xf
    v_mov_b32_dpp v105, v104 row_ror:12 row_mask:0xf bank_mask:0xf
    v_mov_b32_dpp v109, v108 row_ror:12 row_mask:0xf bank_mask:0xf
    v_mov_b32_dpp v98, v96 row_ror:8 row_mask:0xf bank_mask:0xf
    v_mov_b32_dpp v102, v100 row_ror:8 row_mask:0xf bank_mask:0xf
    v_mov_b32_dpp v106, v104 row_ror:8 row_mask:0xf bank_mask:0xf
    v_mov_b32_dpp v110, v108 row_ror:8 row_mask:0xf bank_mask:0xf
    v_mov_b32_dpp v99, v96 row_ror:4 row_mask:0xf bank_mask:0xf
    v_mov_b32_dpp v103, v100 row_ror:4 row_mask:0xf bank_mask:0xf
    v_mov_b32_dpp v107, v104 row_ror:4 row_mask:0xf bank_mask:0xf
    v_mov_b32_dpp v111, v108 row_ror:4 row_mask:0xf bank_mask:0xf
    s_lshl_b32 s60, s3, 10
    s_add_u32 s60, s60, 147456
    v_lshlrev_b32 v10, 5, v0
    v_add_u32 v10, s60, v10
    s_memrealtime s[8:9]
    s_waitcnt lgkmcnt(0)
    s_sub_u32 s8, s8, s30
    s_cmpk_ge_u32 s8, 2194
    s_cbranch_scc1 .ap_106
    s_waitcnt vmcnt(5)
    s_cmpk_ge_u32 s8, 2094
    s_cbranch_scc1 .ap_106
    s_waitcnt vmcnt(3)
    s_bitcmp1_b64 s[14:15], 59
    s_cbranch_scc0 1
    s_waitcnt vmcnt(2)
    s_cmpk_ge_u32 s8, 1974
    s_cbranch_scc1 .ap_106
    s_waitcnt vmcnt(1)
.ap_106:
    s_add_u32 s63, s69, 417792
    buffer_load_dwordx4 v[60:63], v1, s[44:47], s63 offen nt
    v_perm_b32 v112, v164, v160, s94
    v_perm_b32 v113, v172, v168, s94
    v_perm_b32 v114, v180, v176, s94
    v_perm_b32 v115, v188, v184, s94
    s_nop 1
    v_mfma_f32_16x16x32_bf16 v[128:131], v[96:99], v[112:115], 0
    v_perm_b32 v116, v164, v160, s95
    v_perm_b32 v117, v172, v168, s95
    v_perm_b32 v118, v180, v176, s95
    v_perm_b32 v119, v188, v184, s95
    s_nop 1
    v_mfma_f32_16x16x32_bf16 v[132:135], v[96:99], v[116:119], 0
    v_perm_b32 v120, v165, v161, s94
    v_perm_b32 v121, v173, v169, s94
    v_perm_b32 v122, v181, v177, s94
    v_perm_b32 v123, v189, v185, s94
    s_nop 1
    v_mfma_f32_16x16x32_bf16 v[136:139], v[96:99], v[120:123], 0
    v_perm_b32 v124, v165, v161, s95
    v_perm_b32 v125, v173, v169, s95
    s_branch .Lsk_m1_5
.Lst_m1_5:
    s_branch .Lrt_m1_5
.Lsk_m1_5:
    v_perm_b32 v126, v181, v177, s95
    v_perm_b32 v127, v189, v185, s95
    s_nop 1
    v_mfma_f32_16x16x32_bf16 v[140:143], v[96:99], v[124:127], 0
    v_perm_b32 v112, v166, v162, s94
    v_perm_b32 v113, v174, v170, s94
    v_perm_b32 v114, v182, v178, s94
    v_perm_b32 v115, v190, v186, s94
    s_nop 1
    v_mfma_f32_16x16x32_bf16 v[144:147], v[96:99], v[112:115], 0
    v_perm_b32 v116, v166, v162, s95
    v_perm_b32 v117, v174, v170, s95
    v_perm_b32 v118, v182, v178, s95
    v_perm_b32 v119, v190, v186, s95
    s_nop 1
    v_mfma_f32_16x16x32_bf16 v[148:151], v[96:99], v[116:119], 0
    v_perm_b32 v120, v167, v163, s94
    v_perm_b32 v121, v175, v171, s94
    v_perm_b32 v122, v183, v179, s94
    v_perm_b32 v123, v191, v187, s94
    s_nop 1
    v_mfma_f32_16x16x32_bf16 v[152:155], v[96:99], v[120:123], 0
    v_perm_b32 v124, v167, v163, s95
    v_perm_b32 v125, v175, v171, s95
    v_perm_b32 v126, v183, v179, s95
    v_perm_b32 v127, v191, v187, s95
    s_nop 1
    v_mfma_f32_16x16x32_bf16 v[156:159], v[96:99], v[124:127], 0
    s_memrealtime s[8:9]
    s_waitcnt lgkmcnt(0)
    s_sub_u32 s8, s8, s30
    s_cmpk_ge_u32 s8, 2226
    s_nop 3
    s_cbranch_scc1 .ap_107
    s_waitcnt vmcnt(5)
    s_cmpk_ge_u32 s8, 2126
    s_cbranch_scc1 .ap_107
    s_waitcnt vmcnt(3)
    s_bitcmp1_b64 s[14:15], 60
    s_cbranch_scc0 1
    s_waitcnt vmcnt(2)
    s_cmpk_ge_u32 s8, 2006
    s_cbranch_scc1 .ap_107
    s_waitcnt vmcnt(1)
.ap_107:
    s_add_u32 s63, s69, 425984
    buffer_load_dwordx4 v[68:71], v1, s[44:47], s63 offen nt
    v_perm_b32 v112, v196, v192, s94
    v_perm_b32 v113, v204, v200, s94
    v_perm_b32 v114, v212, v208, s94
    v_perm_b32 v115, v220, v216, s94
    s_nop 1
    v_mfma_f32_16x16x32_bf16 v[128:131], v[100:103], v[112:115], v[128:131]
    v_perm_b32 v116, v196, v192, s95
    v_perm_b32 v117, v204, v200, s95
    v_perm_b32 v118, v212, v208, s95
    v_perm_b32 v119, v220, v216, s95
    s_nop 1
    v_mfma_f32_16x16x32_bf16 v[132:135], v[100:103], v[116:119], v[132:135]
    v_perm_b32 v120, v197, v193, s94
    v_perm_b32 v121, v205, v201, s94
    v_perm_b32 v122, v213, v209, s94
    v_perm_b32 v123, v221, v217, s94
    s_nop 1
    v_mfma_f32_16x16x32_bf16 v[136:139], v[100:103], v[120:123], v[136:139]
    v_perm_b32 v124, v197, v193, s95
    v_perm_b32 v125, v205, v201, s95
    v_perm_b32 v126, v213, v209, s95
    v_perm_b32 v127, v221, v217, s95
    s_nop 1
    v_mfma_f32_16x16x32_bf16 v[140:143], v[100:103], v[124:127], v[140:143]
    v_perm_b32 v112, v198, v194, s94
    v_perm_b32 v113, v206, v202, s94
    v_perm_b32 v114, v214, v210, s94
    v_perm_b32 v115, v222, v218, s94
    s_nop 1
    v_mfma_f32_16x16x32_bf16 v[144:147], v[100:103], v[112:115], v[144:147]
    v_perm_b32 v116, v198, v194, s95
    v_perm_b32 v117, v206, v202, s95
    v_perm_b32 v118, v214, v210, s95
    v_perm_b32 v119, v222, v218, s95
    s_nop 1
    v_mfma_f32_16x16x32_bf16 v[148:151], v[100:103], v[116:119], v[148:151]
    v_perm_b32 v120, v199, v195, s94
    v_perm_b32 v121, v207, v203, s94
    v_perm_b32 v122, v215, v211, s94
    v_perm_b32 v123, v223, v219, s94
    s_nop 1
    v_mfma_f32_16x16x32_bf16 v[152:155], v[100:103], v[120:123], v[152:155]
    v_perm_b32 v124, v199, v195, s95
    v_perm_b32 v125, v207, v203, s95
    v_perm_b32 v126, v215, v211, s95
    v_perm_b32 v127, v223, v219, s95
    s_nop 1
    v_mfma_f32_16x16x32_bf16 v[156:159], v[100:103], v[124:127], v[156:159]
    s_memrealtime s[8:9]
    s_waitcnt lgkmcnt(0)
    s_sub_u32 s8, s8, s30
    s_cmpk_ge_u32 s8, 2257
    s_nop 3
    s_cbranch_scc1 .ap_108
    s_waitcnt vmcnt(5)
    s_cmpk_ge_u32 s8, 2157
    s_cbranch_scc1 .ap_108
    s_waitcnt vmcnt(3)
    s_bitcmp1_b64 s[14:15], 61
    s_cbranch_scc0 1
    s_waitcnt vmcnt(2)
    s_cmpk_ge_u32 s8, 2037
    s_cbranch_scc1 .ap_108
    s_waitcnt vmcnt(1)
.ap_108:
    s_add_u32 s63, s69, 434176
    buffer_load_dwordx4 v[76:79], v1, s[44:47], s63 offen nt
    s_waitcnt vmcnt(6)
    v_perm_b32 v112, v228, v224, s94
    v_perm_b32 v113, v236, v232, s94
    v_perm_b32 v114, v244, v240, s94
    v_perm_b32 v115, v252, v248, s94
    s_nop 1
    v_mfma_f32_16x16x32_bf16 v[128:131], v[104:107], v[112:115], v[128:131]
    v_perm_b32 v116, v228, v224, s95
    v_perm_b32 v117, v236, v232, s95
    v_perm_b32 v118, v244, v240, s95
    v_perm_b32 v119, v252, v248, s95
    s_nop 1
    v_mfma_f32_16x16x32_bf16 v[132:135], v[104:107], v[116:119], v[132:135]
    v_perm_b32 v120, v229, v225, s94
    v_perm_b32 v121, v237, v233, s94
    v_perm_b32 v122, v245, v241, s94
    v_perm_b32 v123, v253, v249, s94
    s_nop 1
    v_mfma_f32_16x16x32_bf16 v[136:139], v[104:107], v[120:123], v[136:139]
    v_perm_b32 v124, v229, v225, s95
    v_perm_b32 v125, v237, v233, s95
    v_perm_b32 v126, v245, v241, s95
    v_perm_b32 v127, v253, v249, s95
    s_nop 1
    v_mfma_f32_16x16x32_bf16 v[140:143], v[104:107], v[124:127], v[140:143]
    v_perm_b32 v112, v230, v226, s94
    v_perm_b32 v113, v238, v234, s94
    v_perm_b32 v114, v246, v242, s94
    v_perm_b32 v115, v254, v250, s94
    s_nop 1
    v_mfma_f32_16x16x32_bf16 v[144:147], v[104:107], v[112:115], v[144:147]
    v_perm_b32 v116, v230, v226, s95
    v_perm_b32 v117, v238, v234, s95
    v_perm_b32 v118, v246, v242, s95
    v_perm_b32 v119, v254, v250, s95
    s_nop 1
    v_mfma_f32_16x16x32_bf16 v[148:151], v[104:107], v[116:119], v[148:151]
    v_perm_b32 v120, v231, v227, s94
    v_perm_b32 v121, v239, v235, s94
    v_perm_b32 v122, v247, v243, s94
    v_perm_b32 v123, v255, v251, s94
    s_nop 1
    v_mfma_f32_16x16x32_bf16 v[152:155], v[104:107], v[120:123], v[152:155]
    v_perm_b32 v124, v231, v227, s95
    v_perm_b32 v125, v239, v235, s95
    v_perm_b32 v126, v247, v243, s95
    v_perm_b32 v127, v255, v251, s95
    s_nop 1
    v_mfma_f32_16x16x32_bf16 v[156:159], v[104:107], v[124:127], v[156:159]
    s_branch .Lsk_m1_6
.Lst_m1_6:
    s_branch .Lrt_m1_6
.Lsk_m1_6:
    s_memrealtime s[8:9]
    s_waitcnt lgkmcnt(0)
    s_sub_u32 s8, s8, s30
    s_cmpk_ge_u32 s8, 2289
    s_nop 3
    s_cbranch_scc1 .ap_109
    s_waitcnt vmcnt(5)
    s_cmpk_ge_u32 s8, 2189
    s_cbranch_scc1 .ap_109
    s_waitcnt vmcnt(3)
    s_bitcmp1_b64 s[14:15], 62
    s_cbranch_scc0 1
    s_waitcnt vmcnt(2)
    s_cmpk_ge_u32 s8, 2069
    s_cbranch_scc1 .ap_109
    s_waitcnt vmcnt(1)
.ap_109:
    s_add_u32 s63, s69, 442368
    buffer_load_dwordx4 v[84:87], v1, s[44:47], s63 offen nt
    s_memrealtime s[8:9]
    s_waitcnt lgkmcnt(0)
    s_sub_u32 s8, s8, s30
    s_cmpk_ge_u32 s8, 2321
    s_cbranch_scc1 .ap_110
    s_waitcnt vmcnt(5)
    s_cmpk_ge_u32 s8, 2221
    s_cbranch_scc1 .ap_110
    s_waitcnt vmcnt(3)
    s_bitcmp1_b64 s[14:15], 63
    s_cbranch_scc0 1
    s_waitcnt vmcnt(2)
    s_cmpk_ge_u32 s8, 2101
    s_cbranch_scc1 .ap_110
    s_waitcnt vmcnt(1)
.ap_110:
    s_add_u32 s63, s69, 450560
    buffer_load_dwordx4 v[92:95], v1, s[44:47], s63 offen nt
    s_setprio 0
    s_waitcnt vmcnt(6)
    v_perm_b32 v160, v44, v36, s94
    v_perm_b32 v164, v44, v36, s95
    v_perm_b32 v168, v45, v37, s94
    v_perm_b32 v172, v45, v37, s95
    v_perm_b32 v176, v46, v38, s94
    v_perm_b32 v180, v46, v38, s95
    v_perm_b32 v184, v47, v39, s94
    v_perm_b32 v188, v47, v39, s95
    s_waitcnt vmcnt(4)
    v_perm_b32 v161, v60, v52, s94
    v_perm_b32 v165, v60, v52, s95
    v_perm_b32 v169, v61, v53, s94
    v_perm_b32 v173, v61, v53, s95
    v_perm_b32 v177, v62, v54, s94
    v_perm_b32 v181, v62, v54, s95
    v_perm_b32 v185, v63, v55, s94
    v_perm_b32 v189, v63, v55, s95
    s_waitcnt vmcnt(2)
    v_perm_b32 v162, v76, v68, s94
    v_perm_b32 v166, v76, v68, s95
    v_perm_b32 v170, v77, v69, s94
    v_perm_b32 v174, v77, v69, s95
    v_perm_b32 v178, v78, v70, s94
    v_perm_b32 v182, v78, v70, s95
    v_perm_b32 v186, v79, v71, s94
    v_perm_b32 v190, v79, v71, s95
    s_waitcnt vmcnt(0)
    v_perm_b32 v163, v92, v84, s94
    v_perm_b32 v167, v92, v84, s95
    v_perm_b32 v171, v93, v85, s94
    v_mfma_f32_16x16x32_bf16 v[128:131], v[108:111], v[160:163], v[128:131]
    v_perm_b32 v175, v93, v85, s95
    v_mfma_f32_16x16x32_bf16 v[132:135], v[108:111], v[164:167], v[132:135]
    v_perm_b32 v179, v94, v86, s94
    v_mfma_f32_16x16x32_bf16 v[136:139], v[108:111], v[168:171], v[136:139]
    v_perm_b32 v183, v94, v86, s95
    v_mfma_f32_16x16x32_bf16 v[140:143], v[108:111], v[172:175], v[140:143]
    v_perm_b32 v187, v95, v87, s94
    v_mfma_f32_16x16x32_bf16 v[144:147], v[108:111], v[176:179], v[144:147]
    v_perm_b32 v191, v95, v87, s95
    v_mfma_f32_16x16x32_bf16 v[148:151], v[108:111], v[180:183], v[148:151]
    v_mfma_f32_16x16x32_bf16 v[152:155], v[108:111], v[184:187], v[152:155]
    v_mfma_f32_16x16x32_bf16 v[156:159], v[108:111], v[188:191], v[156:159]
    s_mov_b64 exec, 0xffff
    ds_write2_b32 v10, v128, v129 offset0:0 offset1:128
    ds_write2_b32 v10, v132, v133 offset0:1 offset1:129
    ds_write2_b32 v10, v136, v137 offset0:2 offset1:130
    ds_write2_b32 v10, v140, v141 offset0:3 offset1:131
    ds_write2_b32 v10, v144, v145 offset0:4 offset1:132
    ds_write2_b32 v10, v148, v149 offset0:5 offset1:133
    ds_write2_b32 v10, v152, v153 offset0:6 offset1:134
    ds_write2_b32 v10, v156, v157 offset0:7 offset1:135
    s_mov_b64 exec, -1
    s_waitcnt lgkmcnt(0)
    s_barrier
    s_cmp_lg_u32 s3, 7
    s_cbranch_scc1 .opub_111
    v_add_u32 v10, 147456, v2
    ds_read_b128 v[196:199], v10 offset:0
    ds_read_b128 v[200:203], v10 offset:1024
    ds_read_b128 v[204:207], v10 offset:2048
    ds_read_b128 v[208:211], v10 offset:3072
    ds_read_b128 v[212:215], v10 offset:4096
    ds_read_b128 v[216:219], v10 offset:5120
    ds_read_b128 v[220:223], v10 offset:6144
    ds_read_b128 v[224:227], v10 offset:7168
    v_lshrrev_b32 v11, 5, v0
    v_lshlrev_b32 v11, 13, v11
    v_and_b32 v12, 31, v0
    v_lshl_add_u32 v11, v12, 4, v11
    s_lshl4_add_u32 s56, s67, s66
    s_lshl1_add_u32 s56, s56, s68
    s_lshl_b32 s56, s56, 9
    s_add_u32 s56, s56, 0xa0000
    s_mov_b32 s60, 0x07060503
    s_mov_b32 s61, 0x07060502
    s_mov_b32 s62, 0x07060501
    v_mov_b32 v15, s34
    s_waitcnt lgkmcnt(6)
    v_pk_add_f32 v[196:197], v[196:197], v[200:201]
    v_pk_add_f32 v[198:199], v[198:199], v[202:203]
    s_waitcnt lgkmcnt(5)
    v_pk_add_f32 v[196:197], v[196:197], v[204:205]
    v_pk_add_f32 v[198:199], v[198:199], v[206:207]
    s_waitcnt lgkmcnt(4)
    v_pk_add_f32 v[196:197], v[196:197], v[208:209]
    v_pk_add_f32 v[198:199], v[198:199], v[210:211]
    s_waitcnt lgkmcnt(3)
    v_pk_add_f32 v[196:197], v[196:197], v[212:213]
    v_pk_add_f32 v[198:199], v[198:199], v[214:215]
    s_waitcnt lgkmcnt(2)
    v_pk_add_f32 v[196:197], v[196:197], v[216:217]
    v_pk_add_f32 v[198:199], v[198:199], v[218:219]
    s_waitcnt lgkmcnt(1)
    v_pk_add_f32 v[196:197], v[196:197], v[220:221]
    v_pk_add_f32 v[198:199], v[198:199], v[222:223]
    s_waitcnt lgkmcnt(0)
    v_pk_add_f32 v[196:197], v[196:197], v[224:225]
    v_pk_add_f32 v[198:199], v[198:199], v[226:227]
    v_perm_b32 v12, v196, v199, s60
    v_perm_b32 v13, v197, v199, s61
    v_perm_b32 v14, v198, v199, s62
    s_add_u32 s57, s56, 0x800000
    buffer_store_dwordx4 v[12:15], v11, s[36:39], s57 offen
    s_cmp_lg_u32 s0, 0
    s_nop 0
    s_cbranch_scc1 .nosl_112
    buffer_store_dwordx4 v[12:15], v11, s[36:39], s56 offen sc1
.nosl_112:
.opub_111:
    s_and_b32 s58, s64, 0
    s_mul_i32 s58, s58, 18432
    s_mul_i32 s59, s3, 2304
    s_add_u32 s58, s58, s59
    s_add_u32 s62, s58, 0x37000
    s_add_u32 s63, s58, 0x49000
    s_mul_i32 s101, s64, 18432
    s_add_u32 s101, s101, s59
    s_add_u32 s101, s101, 0x170000
    s_lshl_b32 s56, s65, 8
    s_add_u32 s58, s58, s56
    s_add_u32 s58, s58, 0x25000
    s_add_u32 s99, s101, s56
    s_lshr_b32 s56, s64, 1
    s_and_b32 s57, s3, 3
    s_cmp_lg_u32 s56, s57
    s_cbranch_scc1 .Lr_ga
    s_add_u32 s59, s58, 73728
    s_add_u32 s60, s58, 147456
    s_add_u32 s61, s58, 221184
.gp_113:
    buffer_load_dwordx4 v[56:59], v2, s[36:39], s62 offen offset:0 sc1
    buffer_load_dwordx4 v[60:63], v2, s[36:39], s62 offen offset:1024 sc1
    buffer_load_dwordx2 v[64:65], v5, s[36:39], s62 offen offset:0 sc1
    buffer_load_dwordx4 v[66:69], v2, s[36:39], s63 offen offset:0 sc1
    buffer_load_dwordx4 v[70:73], v2, s[36:39], s63 offen offset:1024 sc1
    buffer_load_dwordx2 v[74:75], v5, s[36:39], s63 offen offset:0 sc1
    buffer_load_dwordx2 v[76:77], v8, s[36:39], s59 offen offset:0 sc1
    buffer_load_dwordx2 v[78:79], v8, s[36:39], s60 offen offset:0 sc1
    buffer_load_dwordx2 v[80:81], v8, s[36:39], s61 offen offset:0 sc1
    buffer_load_dwordx2 v[42:43], v8, s[36:39], s58 offen offset:0 sc1
    s_branch .Lsk_m1_7
.Lst_m1_7:
    s_branch .Lrt_m1_7
.Lsk_m1_7:
    s_waitcnt vmcnt(0)
.gpc_114:
    v_min_u32 v24, v57, v59
    v_max_u32 v25, v57, v59
    v_min3_u32 v24, v24, v61, v63
    v_max3_u32 v25, v25, v61, v63
    v_min3_u32 v24, v24, v65, v67
    v_max3_u32 v25, v25, v65, v67
    v_min3_u32 v24, v24, v69, v71
    v_max3_u32 v25, v25, v69, v71
    v_min3_u32 v24, v24, v73, v75
    v_max3_u32 v25, v25, v73, v75
    v_min3_u32 v24, v24, v77, v79
    v_max3_u32 v25, v25, v77, v79
    v_min3_u32 v24, v24, v81, v43
    v_max3_u32 v25, v25, v81, v43
    v_cmp_eq_u32 vcc, s34, v24
    v_cmp_eq_u32 s[56:57], s34, v25
    s_and_b64 vcc, vcc, s[56:57]
    s_cmp_eq_u64 vcc, -1
    s_nop 2
    s_cbranch_scc1 .gpd_115
    s_sub_u32 s35, s35, 1
    s_cbranch_scc1 .Lexit
    s_sleep 2
    s_branch .gp_113
.gpd_115:
    v_and_b32 v57, 0xffff0000, v56
    v_lshlrev_b32 v56, 16, v56
    v_and_b32 v67, 0xffff0000, v66
    v_lshlrev_b32 v66, 16, v66
    v_and_b32 v59, 0xffff0000, v58
    v_lshlrev_b32 v58, 16, v58
    v_and_b32 v69, 0xffff0000, v68
    v_lshlrev_b32 v68, 16, v68
    v_and_b32 v61, 0xffff0000, v60
    v_lshlrev_b32 v60, 16, v60
    v_and_b32 v71, 0xffff0000, v70
    v_lshlrev_b32 v70, 16, v70
    v_and_b32 v63, 0xffff0000, v62
    v_lshlrev_b32 v62, 16, v62
    v_and_b32 v73, 0xffff0000, v72
    v_lshlrev_b32 v72, 16, v72
    v_and_b32 v65, 0xffff0000, v64
    v_lshlrev_b32 v64, 16, v64
    v_and_b32 v75, 0xffff0000, v74
    v_lshlrev_b32 v74, 16, v74
    v_lshlrev_b32 v77, 16, v76
    v_and_b32 v76, 0xffff0000, v76
    s_mov_b32 vcc_lo, 0xffff0000
    s_mov_b32 vcc_hi, 0xffff0000
    v_cndmask_b32 v77, v77, v76, vcc
    v_lshlrev_b32 v79, 16, v78
    v_and_b32 v78, 0xffff0000, v78
    s_mov_b32 vcc_lo, 0xffff0000
    s_mov_b32 vcc_hi, 0xffff0000
    v_cndmask_b32 v79, v79, v78, vcc
    v_lshlrev_b32 v81, 16, v80
    v_and_b32 v80, 0xffff0000, v80
    s_mov_b32 vcc_lo, 0xffff0000
    s_mov_b32 vcc_hi, 0xffff0000
    v_cndmask_b32 v81, v81, v80, vcc
    s_nop 1
    s_branch .Lr_ga2
.Lr_ga:
.gp_116:
    buffer_load_dwordx2 v[42:43], v8, s[36:39], s58 offen offset:0 sc1
    s_waitcnt vmcnt(0)
.gpc_117:
    v_cmp_eq_u32 vcc, s34, v43
    s_cmp_eq_u64 vcc, -1
    s_nop 3
    s_cbranch_scc1 .gpd_118
    s_sub_u32 s35, s35, 1
    s_cbranch_scc1 .Lexit
    s_sleep 2
    s_branch .gp_116
.gpd_118:
.Lr_ga2:
    v_lshlrev_b32 v40, 16, v40
    v_lshlrev_b32 v41, 16, v42
    v_and_b32 v42, 0xffff0000, v42
    s_mov_b32 vcc_lo, 0xffff0000
    s_mov_b32 vcc_hi, 0xffff0000
    v_cndmask_b32 v41, v41, v42, vcc
    s_mul_i32 s59, s3, 9
    s_add_u32 s59, s59, s65
    s_lshl_b32 s59, s59, 12
    s_add_u32 s59, s59, 0xe0000
    s_mov_b32 s60, 0x04000c0c
    s_mov_b32 s61, 0x0706000c
    v_mov_b32 v45, s34
    v_mov_b32 v47, s34
    s_cmp_eq_u32 s0, 0
    s_nop 0
    s_cbranch_scc1 .tg_119
    s_mul_i32 s6, s64, 9
    s_add_u32 s6, s6, s65
    s_lshl_b32 s6, s6, 6
    s_add_u32 s6, s6, 0xca2000
    v_and_b32 v10, 0x30, v2
.gp_120:
    buffer_load_dword v11, v10, s[36:39], s6 offen offset:0 sc1
    s_waitcnt vmcnt(0)
.gpc_121:
    v_cmp_eq_u32 vcc, s34, v11
    s_cmp_eq_u64 vcc, -1
    s_nop 3
    s_cbranch_scc1 .gpd_122
    s_sub_u32 s35, s35, 1
    s_cbranch_scc1 .Lexit
    s_sleep 1
    s_branch .gp_120
.gpd_122:
.tg_119:
.ip_123:
    s_branch .Lsk_m2_0
    .fill 47, 4, 0xbf800000
.Lst_m2_0:
    s_branch .Lrt_m2_0
.Lsk_m2_0:
    buffer_load_dwordx4 v[16:19], v2, s[36:39], s59 offen offset:0 sc1
    buffer_load_dwordx4 v[20:23], v2, s[36:39], s59 offen offset:1024 sc1
    buffer_load_dwordx4 v[24:27], v2, s[36:39], s59 offen offset:2048 sc1
    buffer_load_dwordx4 v[28:31], v2, s[36:39], s59 offen offset:3072 sc1
    s_waitcnt vmcnt(3)
    v_mov_b32 v32, v19
    v_mov_b32 v33, v19
    v_perm_b32 v19, v16, v17, s60
    v_perm_b32 v19, v19, v18, s61
    s_waitcnt vmcnt(2)
    v_min_u32 v32, v32, v23
    v_max_u32 v33, v33, v23
    v_perm_b32 v23, v20, v21, s60
    v_perm_b32 v23, v23, v22, s61
    v_pk_add_f32 v[16:17], v[16:17], v[20:21]
    v_pk_add_f32 v[18:19], v[18:19], v[22:23]
    s_waitcnt vmcnt(1)
    v_min_u32 v32, v32, v27
    v_max_u32 v33, v33, v27
    v_perm_b32 v27, v24, v25, s60
    v_perm_b32 v27, v27, v26, s61
    v_pk_add_f32 v[16:17], v[16:17], v[24:25]
    v_pk_add_f32 v[18:19], v[18:19], v[26:27]
    s_waitcnt vmcnt(0)
    v_min_u32 v32, v32, v31
    v_max_u32 v33, v33, v31
    v_cmp_eq_u32 vcc, s34, v32
    v_cmp_eq_u32 s[56:57], s34, v33
    v_perm_b32 v31, v28, v29, s60
    v_perm_b32 v31, v31, v30, s61
    v_pk_add_f32 v[16:17], v[16:17], v[28:29]
    v_pk_add_f32 v[18:19], v[18:19], v[30:31]
    s_and_b64 vcc, vcc, s[56:57]
    s_cmp_eq_u64 vcc, -1
    s_cbranch_scc1 .ipd_124
    s_sub_u32 s35, s35, 1
    s_cbranch_scc0 .ip_123
    s_branch .Lexit
.ipd_124:
    v_permlane32_swap_b32 v16, v18
    v_permlane32_swap_b32 v17, v19
    v_pk_add_f32 v[16:17], v[16:17], v[18:19]
    s_nop 1
    v_permlane16_swap_b32 v16, v17
    v_add_f32 v16, v16, v17
    v_cvt_pk_bf16_f32 v16, v16, v16
    v_lshlrev_b32 v16, 16, v16
    v_mul_f32 v16, v16, v41
    v_cvt_pk_bf16_f32 v16, v16, v16
    v_lshlrev_b32 v16, 16, v16
    v_add_f32 v17, v16, v40
    v_add_f32 v16, v16, v40
    v_mov_b32 v40, v16
    s_nop 0
    v_permlane16_swap_b32 v16, v17
    v_cvt_pk_bf16_f32 v44, v16, v17
    s_mov_b32 exec_lo, 0xffff
    s_mov_b32 exec_hi, 0xffff
    s_add_u32 s57, s99, 0x800000
    buffer_store_dwordx2 v[44:45], v8, s[36:39], s57 offen
    s_cmp_lg_u32 s0, 0
    s_cbranch_scc1 .nosl_125
    buffer_store_dwordx2 v[44:45], v8, s[36:39], s99 offen sc1
.nosl_125:
    s_mov_b64 exec, -1
    s_lshr_b32 s56, s64, 1
    s_and_b32 s57, s3, 3
    s_cmp_lg_u32 s56, s57
    s_cbranch_scc1 .Lexit
    v_cvt_pk_bf16_f32 v40, v40, v40
    v_lshlrev_b32 v40, 16, v40
    s_mov_b32 s69, 0
.gp_126:
    s_add_u32 s69, s69, 1
    s_and_b32 s56, s69, 0x41
    s_cmp_lg_u32 s56, 0x41
    s_cselect_b32 s56, 0, 0x800000
    s_xor_b32 s56, s56, s0
    s_add_u32 s58, s101, s56
    buffer_load_dwordx4 v[84:87], v2, s[36:39], s58 offen offset:0 sc1
    buffer_load_dwordx4 v[88:91], v2, s[36:39], s58 offen offset:1024 sc1
    buffer_load_dwordx2 v[92:93], v5, s[36:39], s58 offen offset:0 sc1
    s_waitcnt vmcnt(0)
    v_min3_u32 v24, v85, v87, v89
    v_max3_u32 v25, v85, v87, v89
    v_min3_u32 v24, v24, v91, v93
    v_max3_u32 v25, v25, v91, v93
    v_cmp_eq_u32 vcc, s34, v24
    v_cmp_eq_u32 s[56:57], s34, v25
    s_and_b64 vcc, vcc, s[56:57]
    s_cmp_eq_u64 vcc, -1
    s_nop 2
    s_cbranch_scc1 .gpd_127
    s_sub_u32 s35, s35, 1
    s_cbranch_scc1 .Lexit
    s_sleep 1
    s_branch .gp_126
.gpd_127:
    s_mov_b32 s56, 0x3f803f80
    v_dot2_f32_bf16 v104, v84, s56, 0
    v_dot2_f32_bf16 v105, v84, v84, 0
    v_dot2_f32_bf16 v104, v86, s56, v104
    v_dot2_f32_bf16 v105, v86, v86, v105
    v_dot2_f32_bf16 v104, v88, s56, v104
    v_dot2_f32_bf16 v105, v88, v88, v105
    v_dot2_f32_bf16 v104, v90, s56, v104
    v_dot2_f32_bf16 v105, v90, v90, v105
    s_mov_b64 exec, 0xffffffff
    v_dot2_f32_bf16 v104, v92, s56, v104
    v_dot2_f32_bf16 v105, v92, v92, v105
    s_mov_b64 exec, -1
    s_nop 1
    v_permlane32_swap_b32 v104, v105
    v_add_f32 v104, v104, v105
    v_mov_b32 v106, v104
    s_nop 1
    v_permlane16_swap_b32 v106, v104
    v_add_f32 v104, v106, v104
    v_and_b32 v95, 0xffff0000, v84
    v_lshlrev_b32 v94, 16, v84
    v_add_f32_dpp v104, v104, v104 row_ror:8 row_mask:0xf bank_mask:0xf
    v_and_b32 v97, 0xffff0000, v86
    v_lshlrev_b32 v96, 16, v86
    v_add_f32_dpp v104, v104, v104 row_ror:4 row_mask:0xf bank_mask:0xf
    v_and_b32 v99, 0xffff0000, v88
    v_lshlrev_b32 v98, 16, v88
    v_add_f32_dpp v104, v104, v104 quad_perm:[2,3,0,1] row_mask:0xf bank_mask:0xf
    v_and_b32 v101, 0xffff0000, v90
    v_lshlrev_b32 v100, 16, v90
    v_add_f32_dpp v104, v104, v104 quad_perm:[1,0,3,2] row_mask:0xf bank_mask:0xf
    v_mul_f32 v104, 0x3ae38e39, v104
    v_and_b32 v103, 0xffff0000, v92
    v_lshlrev_b32 v102, 16, v92
    v_readlane_b32 s56, v104, 0
    v_readlane_b32 s57, v104, 32
    s_nop 0
    v_mov_b32 v104, s56
    v_fma_f32 v105, -v104, v104, s57
    v_max_f32 v105, 0, v105
    v_cvt_pk_bf16_f32 v106, -v104, v105
    v_and_b32 v107, 0xffff0000, v106
    v_add_f32 v107, 0x3727c5ac, v107
    v_lshlrev_b32 v104, 16, v106
    v_cvt_pk_bf16_f32 v107, v107, v107
    v_lshlrev_b32 v107, 16, v107
    v_sqrt_f32 v107, v107
    v_mov_b32 v105, v104
    v_cvt_pk_bf16_f32 v107, v107, v107
    v_lshlrev_b32 v107, 16, v107
    v_rcp_f32 v106, v107
    v_rcp_f32 v107, v107
    v_pk_add_f32 v[94:95], v[94:95], v[104:105]
    v_pk_add_f32 v[96:97], v[96:97], v[104:105]
    v_pk_add_f32 v[98:99], v[98:99], v[104:105]
    v_pk_add_f32 v[100:101], v[100:101], v[104:105]
    v_pk_add_f32 v[102:103], v[102:103], v[104:105]
    v_cvt_pk_bf16_f32 v94, v94, v95
    v_and_b32 v95, 0xffff0000, v94
    v_lshlrev_b32 v94, 16, v94
    v_cvt_pk_bf16_f32 v96, v96, v97
    v_and_b32 v97, 0xffff0000, v96
    v_lshlrev_b32 v96, 16, v96
    v_cvt_pk_bf16_f32 v98, v98, v99
    v_and_b32 v99, 0xffff0000, v98
    v_lshlrev_b32 v98, 16, v98
    v_cvt_pk_bf16_f32 v100, v100, v101
    v_and_b32 v101, 0xffff0000, v100
    v_lshlrev_b32 v100, 16, v100
    v_cvt_pk_bf16_f32 v102, v102, v103
    v_and_b32 v103, 0xffff0000, v102
    v_lshlrev_b32 v102, 16, v102
    v_pk_mul_f32 v[94:95], v[94:95], v[106:107]
    v_pk_mul_f32 v[96:97], v[96:97], v[106:107]
    v_pk_mul_f32 v[98:99], v[98:99], v[106:107]
    v_pk_mul_f32 v[100:101], v[100:101], v[106:107]
    v_pk_mul_f32 v[102:103], v[102:103], v[106:107]
    v_cvt_pk_bf16_f32 v94, v94, v95
    v_and_b32 v95, 0xffff0000, v94
    v_lshlrev_b32 v94, 16, v94
    v_cvt_pk_bf16_f32 v96, v96, v97
    v_and_b32 v97, 0xffff0000, v96
    s_branch .Lsk_m2_1
.Lst_m2_1:
    s_branch .Lrt_m2_1
.Lsk_m2_1:
    v_lshlrev_b32 v96, 16, v96
    v_cvt_pk_bf16_f32 v98, v98, v99
    v_and_b32 v99, 0xffff0000, v98
    v_lshlrev_b32 v98, 16, v98
    v_cvt_pk_bf16_f32 v100, v100, v101
    v_and_b32 v101, 0xffff0000, v100
    v_lshlrev_b32 v100, 16, v100
    v_cvt_pk_bf16_f32 v102, v102, v103
    v_and_b32 v103, 0xffff0000, v102
    v_lshlrev_b32 v102, 16, v102
    v_pk_mul_f32 v[94:95], v[94:95], v[66:67]
    v_pk_mul_f32 v[96:97], v[96:97], v[68:69]
    v_pk_mul_f32 v[98:99], v[98:99], v[70:71]
    v_pk_mul_f32 v[100:101], v[100:101], v[72:73]
    v_pk_mul_f32 v[102:103], v[102:103], v[74:75]
    v_cvt_pk_bf16_f32 v94, v94, v95
    v_and_b32 v95, 0xffff0000, v94
    v_lshlrev_b32 v94, 16, v94
    v_cvt_pk_bf16_f32 v96, v96, v97
    v_and_b32 v97, 0xffff0000, v96
    v_lshlrev_b32 v96, 16, v96
    v_cvt_pk_bf16_f32 v98, v98, v99
    v_and_b32 v99, 0xffff0000, v98
    v_lshlrev_b32 v98, 16, v98
    v_cvt_pk_bf16_f32 v100, v100, v101
    v_and_b32 v101, 0xffff0000, v100
    v_lshlrev_b32 v100, 16, v100
    v_cvt_pk_bf16_f32 v102, v102, v103
    v_and_b32 v103, 0xffff0000, v102
    v_lshlrev_b32 v102, 16, v102
    v_pk_add_f32 v[94:95], v[94:95], v[56:57]
    v_pk_add_f32 v[96:97], v[96:97], v[58:59]
    v_pk_add_f32 v[98:99], v[98:99], v[60:61]
    v_pk_add_f32 v[100:101], v[100:101], v[62:63]
    v_pk_add_f32 v[102:103], v[102:103], v[64:65]
    v_cvt_pk_bf16_f32 v110, v94, v95
    v_cvt_pk_bf16_f32 v111, v96, v97
    v_cvt_pk_bf16_f32 v112, v98, v99
    v_cvt_pk_bf16_f32 v113, v100, v101
    v_cvt_pk_bf16_f32 v114, v102, v103
    v_dot2_f32_bf16 v14, v110, v48, 0
    v_dot2_f32_bf16 v14, v111, v49, v14
    v_dot2_f32_bf16 v14, v112, v50, v14
    v_dot2_f32_bf16 v14, v113, v51, v14
    s_mov_b64 exec, 0xffffffff
    v_dot2_f32_bf16 v14, v114, v34, v14
    s_mov_b64 exec, -1
    s_nop 1
    v_mov_b32 v15, v14
    s_nop 1
    v_permlane32_swap_b32 v15, v14
    v_add_f32 v14, v15, v14
    v_mov_b32 v15, v14
    s_nop 1
    v_permlane16_swap_b32 v15, v14
    v_add_f32 v14, v15, v14
    s_nop 1
    v_add_f32_dpp v14, v14, v14 row_ror:8 row_mask:0xf bank_mask:0xf
    s_nop 1
    v_add_f32_dpp v14, v14, v14 row_ror:4 row_mask:0xf bank_mask:0xf
    s_nop 1
    v_add_f32_dpp v14, v14, v14 quad_perm:[2,3,0,1] row_mask:0xf bank_mask:0xf
    s_nop 1
    v_add_f32_dpp v14, v14, v14 quad_perm:[1,0,3,2] row_mask:0xf bank_mask:0xf
    v_cvt_pk_bf16_f32 v14, v14, v14
    v_lshlrev_b32 v14, 16, v14
    v_max_f32 v14, 0xc2ae0000, v14
    v_min_f32 v14, 0x43000000, v14
    v_mul_f32 v15, 0xbfb8aa3b, v14
    v_fma_f32 v16, v14, s98, -v15
    v_fmac_f32 v16, 0xb2a57060, v14
    v_exp_f32 v15, v15
    v_mul_f32 v16, 0x3f317218, v16
    v_fmac_f32 v15, v15, v16
    v_add_f32 v15, 1.0, v15
    v_rcp_f32 v16, v15
    s_nop 0
    v_fma_f32 v15, -v15, v16, 1.0
    v_fma_f32 v14, v15, v16, v16
    v_cvt_pk_bf16_f32 v14, v14, v14
    v_lshlrev_b32 v14, 16, v14
    v_add_f32 v41, v40, v104
    v_cvt_pk_bf16_f32 v41, v41, v41
    v_lshlrev_b32 v41, 16, v41
    v_mul_f32 v41, v41, v106
    v_cvt_pk_bf16_f32 v41, v41, v41
    v_lshlrev_b32 v41, 16, v41
    v_mul_f32 v41, v41, v79
    v_cvt_pk_bf16_f32 v41, v41, v41
    v_lshlrev_b32 v41, 16, v41
    v_add_f32 v41, v41, v77
    v_cvt_pk_bf16_f32 v41, v41, v41
    v_lshlrev_b32 v41, 16, v41
    s_and_b32 s62, s64, 1
    s_lshl1_add_u32 s58, s65, s62
    s_lshl3_add_u32 s58, s58, s3
    s_mul_i32 s58, s58, 9216
    s_add_u32 s58, s58, 0x1a0000
    s_add_u32 s59, s58, 4096
    s_add_u32 s63, s58, 8192
    s_cmp_eq_u32 s62, 0
    s_mov_b32 s56, 0x00ff00ff
    s_cselect_b32 s62, s56, 0xff00ff00
    s_mov_b32 s60, 0x04000c0c
    s_mov_b32 s61, 0x0706000c
    s_mov_b32 s48, s28
    s_and_b32 s49, s29, 0xffff
    s_mov_b32 s50, 0x2400
    s_mov_b32 s51, 0x00020000
    s_cmp_eq_u32 s0, 0
    s_cbranch_scc1 .tc_128
    s_lshl_b32 s6, s64, 8
    s_add_u32 s6, s6, 0xca4000
    v_min_u32 v10, 8, v0
    v_lshlrev_b32 v10, 4, v10
.gp_129:
    buffer_load_dword v11, v10, s[36:39], s6 offen offset:0 sc1
    s_waitcnt vmcnt(0)
.gpc_130:
    v_cmp_eq_u32 vcc, s34, v11
    s_cmp_eq_u64 vcc, -1
    s_nop 3
    s_cbranch_scc1 .gpd_131
    s_sub_u32 s35, s35, 1
    s_cbranch_scc1 .Lexit
    s_sleep 1
    s_branch .gp_129
.gpd_131:
.tc_128:
.ip_132:
    s_branch .Lsk_m2_2
    .fill 76, 4, 0xbf800000
.Lst_m2_2:
    s_branch .Lrt_m2_2
.Lsk_m2_2:
    buffer_load_dwordx4 v[120:123], v2, s[36:39], s58 offen offset:0 sc1
    buffer_load_dwordx4 v[124:127], v2, s[36:39], s58 offen offset:1024 sc1
    buffer_load_dwordx4 v[128:131], v2, s[36:39], s58 offen offset:2048 sc1
    buffer_load_dwordx4 v[132:135], v2, s[36:39], s58 offen offset:3072 sc1
    buffer_load_dwordx4 v[136:139], v2, s[36:39], s59 offen offset:0 sc1
    buffer_load_dwordx4 v[140:143], v2, s[36:39], s59 offen offset:1024 sc1
    buffer_load_dwordx4 v[144:147], v2, s[36:39], s59 offen offset:2048 sc1
    buffer_load_dwordx4 v[148:151], v2, s[36:39], s59 offen offset:3072 sc1
    buffer_load_dwordx4 v[152:155], v2, s[36:39], s63 offen offset:0 sc1
    s_waitcnt vmcnt(8)
    v_mov_b32 v24, v123
    v_mov_b32 v25, v123
    v_perm_b32 v123, v120, v121, s60
    v_perm_b32 v123, v123, v122, s61
    s_waitcnt vmcnt(7)
    v_min_u32 v24, v24, v127
    v_max_u32 v25, v25, v127
    v_perm_b32 v127, v124, v125, s60
    v_perm_b32 v127, v127, v126, s61
    v_pk_add_f32 v[120:121], v[120:121], v[124:125]
    v_pk_add_f32 v[122:123], v[122:123], v[126:127]
    s_waitcnt vmcnt(6)
    v_min_u32 v24, v24, v131
    v_max_u32 v25, v25, v131
    v_perm_b32 v131, v128, v129, s60
    v_perm_b32 v131, v131, v130, s61
    v_pk_add_f32 v[120:121], v[120:121], v[128:129]
    v_pk_add_f32 v[122:123], v[122:123], v[130:131]
    s_waitcnt vmcnt(5)
    v_min_u32 v24, v24, v135
    v_max_u32 v25, v25, v135
    v_perm_b32 v135, v132, v133, s60
    v_perm_b32 v135, v135, v134, s61
    v_pk_add_f32 v[120:121], v[120:121], v[132:133]
    v_pk_add_f32 v[122:123], v[122:123], v[134:135]
    s_waitcnt vmcnt(4)
    v_min_u32 v24, v24, v139
    v_max_u32 v25, v25, v139
    v_perm_b32 v139, v136, v137, s60
    v_perm_b32 v139, v139, v138, s61
    v_pk_add_f32 v[120:121], v[120:121], v[136:137]
    v_pk_add_f32 v[122:123], v[122:123], v[138:139]
    s_waitcnt vmcnt(3)
    v_min_u32 v24, v24, v143
    v_max_u32 v25, v25, v143
    v_perm_b32 v143, v140, v141, s60
    v_perm_b32 v143, v143, v142, s61
    v_pk_add_f32 v[120:121], v[120:121], v[140:141]
    v_pk_add_f32 v[122:123], v[122:123], v[142:143]
    s_waitcnt vmcnt(2)
    v_min_u32 v24, v24, v147
    v_max_u32 v25, v25, v147
    v_perm_b32 v147, v144, v145, s60
    v_perm_b32 v147, v147, v146, s61
    v_pk_add_f32 v[120:121], v[120:121], v[144:145]
    v_pk_add_f32 v[122:123], v[122:123], v[146:147]
    s_waitcnt vmcnt(1)
    v_min_u32 v24, v24, v151
    v_max_u32 v25, v25, v151
    v_perm_b32 v151, v148, v149, s60
    v_perm_b32 v151, v151, v150, s61
    v_pk_add_f32 v[120:121], v[120:121], v[148:149]
    v_pk_add_f32 v[122:123], v[122:123], v[150:151]
    s_waitcnt vmcnt(0)
    v_min_u32 v24, v24, v155
    v_max_u32 v25, v25, v155
    v_cmp_eq_u32 vcc, s34, v24
    v_cmp_eq_u32 s[56:57], s34, v25
    v_perm_b32 v155, v152, v153, s60
    v_perm_b32 v155, v155, v154, s61
    v_pk_add_f32 v[120:121], v[120:121], v[152:153]
    v_pk_add_f32 v[122:123], v[122:123], v[154:155]
    s_and_b64 vcc, vcc, s[56:57]
    s_cmp_eq_u64 vcc, -1
    s_cbranch_scc1 .ipd_133
    s_sub_u32 s35, s35, 1
    s_cbranch_scc0 .ip_132
    s_branch .Lexit
.ipd_133:
    v_permlane32_swap_b32 v120, v122
    v_permlane32_swap_b32 v121, v123
    v_pk_add_f32 v[120:121], v[120:121], v[122:123]
    s_nop 1
    v_permlane16_swap_b32 v120, v121
    v_add_f32 v120, v120, v121
    s_nop 1
    v_add_f32_dpp v120, v120, v120 row_ror:8 row_mask:0xf bank_mask:0xf
    v_cvt_pk_bf16_f32 v120, v120, v120
    v_lshlrev_b32 v120, 16, v120
    v_mul_f32 v120, v120, v14
    v_cvt_pk_bf16_f32 v120, v120, v120
    v_lshlrev_b32 v120, 16, v120
    v_add_f32 v120, v120, v41
    v_cvt_pk_bf16_f32 v120, v120, v120
    v_lshlrev_b32 v120, 16, v120
    v_mul_f32 v120, v120, v81
    v_cvt_pk_bf16_f32 v120, v120, v120
    v_lshlrev_b32 v120, 16, v120
    v_add_f32 v120, v120, v40
    v_cvt_pk_bf16_f32 v120, v120, v120
    s_mov_b32 exec_lo, s62
    s_mov_b32 exec_hi, s62
    buffer_store_short v120, v7, s[48:51], s100 offen
    s_mov_b64 exec, -1
    s_or_b32 s56, s2, s3
    s_cmp_lg_u32 s56, 0
    s_cbranch_scc1 .Lexit
    v_mov_b32 v13, s34
    v_mov_b32 v12, 0
    s_mov_b64 exec, 1
    buffer_store_dword v13, v12, s[36:39], 0 offen
    s_mov_b64 exec, -1
    s_branch .Lexit
.Lbc:
    s_branch .Lsk_b0_0
.Lst_b0_0:
    s_branch .Lrt_b0_0
.Lsk_b0_0:
    s_sub_u32 s56, s65, 9
    s_mov_b32 s57, 0x63054210
    s_cmp_eq_u32 s65, 14
    s_cselect_b32 s56, s64, s56
    s_cselect_b32 s57, 0x37654210, s57
    s_cselect_b32 s99, 8, s64
    s_lshl_b32 s56, s56, 2
    s_lshr_b32 s56, s57, s56
    s_and_b32 s56, s56, 7
    s_cmp_eq_u32 s65, 17
    s_cselect_b32 s56, 7, s56
    s_lshl3_add_u32 s99, s99, s56
    s_and_b32 s56, s99, 7
    s_cmp_eq_u32 s56, 3
    s_mov_b32 s14, 0xb5b5b5b5
    s_cselect_b32 s14, 0x0, s14
    s_mov_b32 s15, 0xd6d6b6b6
    s_cselect_b32 s15, 0x0, s15
    s_cselect_b32 s30, -50, 0
    s_add_u32 s30, s30, 0
    s_add_u32 s30, s30, s70
    s_mov_b32 s31, s70
    s_mov_b32 s48, s18
    s_and_b32 s49, s19, 0xffff
    s_mov_b32 s50, 0x510000
    s_mov_b32 s51, 0x00020000
    s_mov_b32 s52, s20
    s_and_b32 s53, s21, 0xffff
    s_mov_b32 s54, 0x510000
    s_mov_b32 s55, 0x00020000
    v_bfe_u32 v12, v0, 4, 1
    s_and_b32 s56, s3, 3
    s_lshl_b32 s56, s56, 1
    v_or_b32 v12, s56, v12
    v_and_b32 v6, 7, v0
    v_xor_b32 v12, v12, v6
    v_lshrrev_b32 v6, 3, v0
    v_mul_u32_u24 v6, 9216, v6
    v_lshl_add_u32 v6, v12, 4, v6
    s_mul_i32 s100, s3, 73728
    s_lshl_b32 s56, s99, 7
    s_add_u32 s100, s100, s56
    s_lshl_b32 s101, s3, 10
    s_waitcnt lgkmcnt(0)
    s_add_u32 s34, s34, 1
    s_getreg_b32 s1, hwreg(HW_REG_XCC_ID)
    s_lshl_b32 s1, s1, 24
    s_add_u32 s1, s1, s34
    s_lshr_b32 s0, s2, 3
    s_lshl_b32 s63, s64, 8
    s_add_u32 s0, s0, s63
    s_lshl2_add_u32 s0, s0, 0x480000
    v_mov_b32 v30, s1
    s_cmp_eq_u32 s3, 0
    s_cselect_b64 exec, 1, 0
    buffer_store_dword v30, v2, s[36:39], s0 offen sc1
    s_mov_b64 exec, -1
    v_and_b32 v8, 1, v0
    v_lshlrev_b32 v8, 8, v8
    v_and_b32 v9, 0x3c, v0
    v_lshl_add_u32 v9, v9, 2, v8
    v_add_u32 v7, v9, v8
    v_and_b32 v9, 0x3c, v0
    v_lshrrev_b32 v8, 4, v8
    v_and_b32 v9, 4, v0
    v_lshl_add_u32 v9, v9, 3, v8
    s_lshl_b32 s58, s66, 14
    s_lshl_b32 s59, s67, 10
    s_add_u32 s58, s58, s59
    s_add_u32 s58, s58, 0x70000
    s_lshl4_add_u32 s59, s66, s67
    s_lshl_b32 s59, s59, 7
    s_add_u32 s59, s59, 0x430000
    s_bitcmp1_b64 s[14:15], 4
    s_cbranch_scc0 1
    s_waitcnt vmcnt(4)
    s_add_u32 s63, s69, 32768
    buffer_load_dwordx4 v[96:99], v1, s[40:43], s63 offen nt
    s_waitcnt vmcnt(6)
    s_add_u32 m0, s101, 0
    s_add_u32 s56, s100, 0
    buffer_load_dwordx4 v6, s[48:51], s56 offen nt lds
    s_waitcnt vmcnt(6)
    s_bitcmp1_b64 s[14:15], 5
    s_cbranch_scc0 1
    s_waitcnt vmcnt(4)
    s_add_u32 s63, s69, 40960
    buffer_load_dwordx4 v[100:103], v1, s[40:43], s63 offen nt
    s_waitcnt vmcnt(6)
    s_bitcmp1_b64 s[14:15], 6
    s_cbranch_scc0 1
    s_waitcnt vmcnt(2)
    s_add_u32 s63, s69, 49152
    buffer_load_dwordx4 v[128:131], v1, s[40:43], s63 offen nt
    s_cmp_eq_u32 s3, 0
    s_cbranch_scc1 .Lst_b1_0
    s_cmp_eq_u32 s3, 1
    s_cbranch_scc1 .Lst_b1_1
    s_cmp_eq_u32 s3, 2
    s_cbranch_scc1 .Lst_b1_2
    s_cmp_eq_u32 s3, 3
    s_cbranch_scc1 .Lst_b1_3
    s_cmp_eq_u32 s3, 4
    s_cbranch_scc1 .Lst_b1_4
    s_cmp_eq_u32 s3, 5
    s_cbranch_scc1 .Lst_b1_5
    s_cmp_eq_u32 s3, 6
    s_cbranch_scc1 .Lst_b1_6
    s_cmp_eq_u32 s3, 7
    s_cbranch_scc1 .Lst_b1_7
.Lrt_b1_0:
.Lrt_b1_1:
.Lrt_b1_2:
.Lrt_b1_3:
.Lrt_b1_4:
.Lrt_b1_5:
.Lrt_b1_6:
.Lrt_b1_7:
    s_waitcnt vmcnt(6)
    s_add_u32 m0, s101, 8192
    s_add_u32 s56, s100, 589824
    buffer_load_dwordx4 v6, s[48:51], s56 offen nt lds
    s_waitcnt vmcnt(4)
    s_bitcmp1_b64 s[14:15], 7
    s_cbranch_scc0 1
    s_waitcnt vmcnt(2)
    s_add_u32 s63, s69, 57344
    buffer_load_dwordx4 v[132:135], v1, s[40:43], s63 offen nt
    s_waitcnt vmcnt(4)
    s_bitcmp1_b64 s[14:15], 8
    s_cbranch_scc0 1
    s_waitcnt vmcnt(2)
    s_add_u32 s63, s69, 131072
    buffer_load_dwordx4 v[40:43], v1, s[40:43], s63 offen nt
    s_memrealtime s[8:9]
    s_waitcnt lgkmcnt(0)
    s_sub_u32 s8, s8, s30
    s_cmpk_ge_u32 s8, 436
    s_cbranch_scc1 .ap_134
    s_waitcnt vmcnt(5)
    s_cmpk_ge_u32 s8, 336
    s_cbranch_scc1 .ap_134
    s_waitcnt vmcnt(4)
    s_bitcmp1_b64 s[14:15], 9
    s_cbranch_scc0 1
    s_waitcnt vmcnt(2)
    s_cmpk_ge_u32 s8, 216
    s_cbranch_scc1 .ap_134
    s_waitcnt vmcnt(1)
.ap_134:
    s_add_u32 s63, s69, 139264
    buffer_load_dwordx4 v[44:47], v1, s[40:43], s63 offen nt
    s_memrealtime s[8:9]
    s_waitcnt lgkmcnt(0)
    s_sub_u32 s8, s8, s30
    s_cmpk_ge_u32 s8, 469
    s_cbranch_scc1 .ap_135
    s_waitcnt vmcnt(5)
    s_cmpk_ge_u32 s8, 369
    s_cbranch_scc1 .ap_135
    s_waitcnt vmcnt(4)
    s_bitcmp1_b64 s[14:15], 10
    s_cbranch_scc0 1
    s_waitcnt vmcnt(2)
    s_cmpk_ge_u32 s8, 249
    s_cbranch_scc1 .ap_135
    s_waitcnt vmcnt(1)
.ap_135:
    s_add_u32 s63, s69, 147456
    buffer_load_dwordx4 v[72:75], v1, s[40:43], s63 offen nt
    s_memrealtime s[8:9]
    s_waitcnt lgkmcnt(0)
    s_sub_u32 s8, s8, s30
    s_cmpk_ge_u32 s8, 503
    s_cbranch_scc1 .ap_136
    s_waitcnt vmcnt(5)
    s_cmpk_ge_u32 s8, 403
    s_cbranch_scc1 .ap_136
    s_waitcnt vmcnt(4)
    s_cmpk_ge_u32 s8, 283
    s_cbranch_scc1 .ap_136
    s_waitcnt vmcnt(1)
.ap_136:
    s_add_u32 m0, s101, 16384
    s_add_u32 s56, s100, 1179648
    buffer_load_dwordx4 v6, s[48:51], s56 offen nt lds
    s_memrealtime s[8:9]
    s_waitcnt lgkmcnt(0)
    s_sub_u32 s8, s8, s30
    s_cmpk_ge_u32 s8, 503
    s_cbranch_scc1 .ap_137
    s_waitcnt vmcnt(5)
    s_cmpk_ge_u32 s8, 403
    s_cbranch_scc1 .ap_137
    s_waitcnt vmcnt(4)
    s_bitcmp1_b64 s[14:15], 11
    s_cbranch_scc0 1
    s_waitcnt vmcnt(2)
    s_cmpk_ge_u32 s8, 283
    s_cbranch_scc1 .ap_137
    s_waitcnt vmcnt(1)
.ap_137:
    s_add_u32 s63, s69, 155648
    buffer_load_dwordx4 v[76:79], v1, s[40:43], s63 offen nt
    s_memrealtime s[8:9]
    s_waitcnt vmcnt(8)
    s_waitcnt lgkmcnt(0)
    s_sub_u32 s8, s8, s30
    s_cmpk_ge_u32 s8, 537
    s_cbranch_scc1 .ap_138
    s_waitcnt vmcnt(5)
    s_cmpk_ge_u32 s8, 437
    s_cbranch_scc1 .ap_138
    s_waitcnt vmcnt(4)
    s_bitcmp1_b64 s[14:15], 12
    s_cbranch_scc0 1
    s_waitcnt vmcnt(2)
    s_cmpk_ge_u32 s8, 317
    s_cbranch_scc1 .ap_138
    s_waitcnt vmcnt(1)
.ap_138:
    s_add_u32 s63, s69, 163840
    buffer_load_dwordx4 v[104:107], v1, s[40:43], s63 offen nt
    v_and_b32 v157, 7, v0
    v_lshlrev_b32 v157, 2, v157
    s_mov_b32 s63, 0x4a1100
    buffer_load_dword v156, v157, s[36:39], s63 offen
    s_branch .Lsk_b0_1
.Lst_b0_1:
    s_branch .Lrt_b0_1
.Lsk_b0_1:
    s_memrealtime s[8:9]
    s_waitcnt vmcnt(9)
    s_waitcnt lgkmcnt(0)
    s_sub_u32 s8, s8, s30
    s_cmpk_ge_u32 s8, 571
    s_cbranch_scc1 .ap_139
    s_waitcnt vmcnt(6)
    s_cmpk_ge_u32 s8, 471
    s_cbranch_scc1 .ap_139
    s_waitcnt vmcnt(5)
    s_bitcmp1_b64 s[14:15], 13
    s_cbranch_scc0 1
    s_waitcnt vmcnt(3)
    s_cmpk_ge_u32 s8, 351
    s_cbranch_scc1 .ap_139
    s_waitcnt vmcnt(2)
.ap_139:
    s_add_u32 s63, s69, 172032
    buffer_load_dwordx4 v[108:111], v1, s[40:43], s63 offen nt
    s_memrealtime s[8:9]
    s_waitcnt vmcnt(9)
    s_waitcnt lgkmcnt(0)
    s_sub_u32 s8, s8, s30
    s_cmpk_ge_u32 s8, 605
    s_cbranch_scc1 .ap_140
    s_waitcnt vmcnt(6)
    s_cmpk_ge_u32 s8, 505
    s_cbranch_scc1 .ap_140
    s_waitcnt vmcnt(5)
    s_bitcmp1_b64 s[14:15], 14
    s_cbranch_scc0 1
    s_waitcnt vmcnt(3)
    s_cmpk_ge_u32 s8, 385
    s_cbranch_scc1 .ap_140
    s_waitcnt vmcnt(2)
.ap_140:
    s_add_u32 s63, s69, 180224
    buffer_load_dwordx4 v[136:139], v1, s[40:43], s63 offen nt
    s_branch .Lsk_b0_2
.Lst_b0_2:
    s_branch .Lrt_b0_2
.Lsk_b0_2:
    s_memrealtime s[8:9]
    s_waitcnt vmcnt(9)
    s_waitcnt lgkmcnt(0)
    s_sub_u32 s8, s8, s30
    s_cmpk_ge_u32 s8, 639
    s_cbranch_scc1 .ap_141
    s_waitcnt vmcnt(6)
    s_cmpk_ge_u32 s8, 539
    s_cbranch_scc1 .ap_141
    s_waitcnt vmcnt(5)
    s_cmpk_ge_u32 s8, 419
    s_cbranch_scc1 .ap_141
    s_waitcnt vmcnt(1)
.ap_141:
    s_add_u32 m0, s101, 24576
    s_add_u32 s56, s100, 1769472
    buffer_load_dwordx4 v6, s[48:51], s56 offen nt lds
    s_memrealtime s[8:9]
    s_waitcnt vmcnt(9)
    s_waitcnt lgkmcnt(0)
    s_sub_u32 s8, s8, s30
    s_cmpk_ge_u32 s8, 639
    s_cbranch_scc1 .ap_142
    s_waitcnt vmcnt(6)
    s_cmpk_ge_u32 s8, 539
    s_cbranch_scc1 .ap_142
    s_waitcnt vmcnt(5)
    s_bitcmp1_b64 s[14:15], 15
    s_cbranch_scc0 1
    s_waitcnt vmcnt(2)
    s_cmpk_ge_u32 s8, 419
    s_cbranch_scc1 .ap_142
    s_waitcnt vmcnt(1)
.ap_142:
    s_add_u32 s63, s69, 188416
    buffer_load_dwordx4 v[140:143], v1, s[40:43], s63 offen nt
    s_memrealtime s[8:9]
    s_waitcnt vmcnt(9)
    s_waitcnt lgkmcnt(0)
    s_sub_u32 s8, s8, s30
    s_cmpk_ge_u32 s8, 673
    s_cbranch_scc1 .ap_143
    s_waitcnt vmcnt(6)
    s_cmpk_ge_u32 s8, 573
    s_cbranch_scc1 .ap_143
    s_waitcnt vmcnt(5)
    s_bitcmp1_b64 s[14:15], 16
    s_cbranch_scc0 1
    s_waitcnt vmcnt(2)
    s_cmpk_ge_u32 s8, 453
    s_cbranch_scc1 .ap_143
    s_waitcnt vmcnt(1)
.ap_143:
    s_add_u32 s63, s69, 262144
    buffer_load_dwordx4 v[48:51], v1, s[40:43], s63 offen nt
    s_waitcnt vmcnt(5)
    s_sub_u32 s63, s70, 300
    v_subrev_u32 v156, s63, v156
    v_mov_b32 v157, 600
    v_cmp_lt_u32 s[8:9], v156, v157
    v_add_u32_dpp v156, v156, v156 quad_perm:[1,0,3,2] row_mask:0xf bank_mask:0xf
    s_nop 1
    v_add_u32_dpp v156, v156, v156 quad_perm:[2,3,0,1] row_mask:0xf bank_mask:0xf
    s_nop 1
    v_add_u32_dpp v156, v156, v156 row_ror:4 row_mask:0xf bank_mask:0xf
    s_nop 0
    v_readfirstlane_b32 s63, v156
    s_cmp_eq_u64 s[8:9], -1
    s_nop 3
    s_cbranch_scc0 .et_144
    s_lshr_b32 s63, s63, 3
    s_sub_u32 s63, s63, 300
    s_add_u32 s30, s30, s63
    s_add_u32 s31, s31, s63
.et_144:
    s_memrealtime s[8:9]
    s_waitcnt lgkmcnt(0)
    s_sub_u32 s8, s8, s30
    s_cmpk_ge_u32 s8, 707
    s_cbranch_scc1 .ap_145
    s_waitcnt vmcnt(5)
    s_cmpk_ge_u32 s8, 607
    s_cbranch_scc1 .ap_145
    s_waitcnt vmcnt(4)
    s_bitcmp1_b64 s[14:15], 17
    s_cbranch_scc0 1
    s_waitcnt vmcnt(2)
    s_cmpk_ge_u32 s8, 487
    s_cbranch_scc1 .ap_145
    s_waitcnt vmcnt(1)
.ap_145:
    s_add_u32 s63, s69, 270336
    buffer_load_dwordx4 v[52:55], v1, s[40:43], s63 offen nt
    s_memrealtime s[8:9]
    s_waitcnt lgkmcnt(0)
    s_sub_u32 s8, s8, s30
    s_cmpk_ge_u32 s8, 742
    s_cbranch_scc1 .ap_146
    s_waitcnt vmcnt(5)
    s_cmpk_ge_u32 s8, 642
    s_cbranch_scc1 .ap_146
    s_waitcnt vmcnt(4)
    s_bitcmp1_b64 s[14:15], 18
    s_cbranch_scc0 1
    s_waitcnt vmcnt(2)
    s_cmpk_ge_u32 s8, 522
    s_cbranch_scc1 .ap_146
    s_waitcnt vmcnt(1)
.ap_146:
    s_add_u32 s63, s69, 278528
    buffer_load_dwordx4 v[80:83], v1, s[40:43], s63 offen nt
    s_memrealtime s[8:9]
    s_waitcnt lgkmcnt(0)
    s_sub_u32 s8, s8, s30
    s_cmpk_ge_u32 s8, 777
    s_cbranch_scc1 .ap_147
    s_waitcnt vmcnt(5)
    s_cmpk_ge_u32 s8, 677
    s_cbranch_scc1 .ap_147
    s_waitcnt vmcnt(4)
    s_cmpk_ge_u32 s8, 557
    s_cbranch_scc1 .ap_147
    s_waitcnt vmcnt(1)
.ap_147:
    s_add_u32 m0, s101, 32768
    s_add_u32 s56, s100, 2359296
    buffer_load_dwordx4 v6, s[48:51], s56 offen nt lds
    s_memrealtime s[8:9]
    s_waitcnt lgkmcnt(0)
    s_sub_u32 s8, s8, s30
    s_cmpk_ge_u32 s8, 777
    s_cbranch_scc1 .ap_148
    s_waitcnt vmcnt(5)
    s_cmpk_ge_u32 s8, 677
    s_cbranch_scc1 .ap_148
    s_waitcnt vmcnt(4)
    s_bitcmp1_b64 s[14:15], 19
    s_cbranch_scc0 1
    s_waitcnt vmcnt(2)
    s_cmpk_ge_u32 s8, 557
    s_cbranch_scc1 .ap_148
    s_waitcnt vmcnt(1)
.ap_148:
    s_add_u32 s63, s69, 286720
    buffer_load_dwordx4 v[84:87], v1, s[40:43], s63 offen nt
    s_memrealtime s[8:9]
    s_waitcnt vmcnt(8)
    s_waitcnt lgkmcnt(0)
    s_sub_u32 s8, s8, s30
    s_cmpk_ge_u32 s8, 812
    s_cbranch_scc1 .ap_149
    s_waitcnt vmcnt(5)
    s_cmpk_ge_u32 s8, 712
    s_cbranch_scc1 .ap_149
    s_waitcnt vmcnt(4)
    s_bitcmp1_b64 s[14:15], 20
    s_cbranch_scc0 1
    s_waitcnt vmcnt(2)
    s_cmpk_ge_u32 s8, 592
    s_cbranch_scc1 .ap_149
    s_waitcnt vmcnt(1)
.ap_149:
    s_add_u32 s63, s69, 294912
    buffer_load_dwordx4 v[112:115], v1, s[40:43], s63 offen nt
    s_memrealtime s[8:9]
    s_waitcnt vmcnt(8)
    s_waitcnt lgkmcnt(0)
    s_sub_u32 s8, s8, s30
    s_cmpk_ge_u32 s8, 847
    s_cbranch_scc1 .ap_150
    s_waitcnt vmcnt(5)
    s_cmpk_ge_u32 s8, 747
    s_cbranch_scc1 .ap_150
    s_waitcnt vmcnt(4)
    s_bitcmp1_b64 s[14:15], 21
    s_cbranch_scc0 1
    s_waitcnt vmcnt(2)
    s_cmpk_ge_u32 s8, 627
    s_cbranch_scc1 .ap_150
    s_waitcnt vmcnt(1)
.ap_150:
    s_add_u32 s63, s69, 303104
    buffer_load_dwordx4 v[116:119], v1, s[40:43], s63 offen nt
    s_memrealtime s[8:9]
    s_waitcnt vmcnt(8)
    s_waitcnt lgkmcnt(0)
    s_sub_u32 s8, s8, s30
    s_cmpk_ge_u32 s8, 882
    s_cbranch_scc1 .ap_151
    s_waitcnt vmcnt(5)
    s_cmpk_ge_u32 s8, 782
    s_cbranch_scc1 .ap_151
    s_waitcnt vmcnt(4)
    s_bitcmp1_b64 s[14:15], 22
    s_cbranch_scc0 1
    s_waitcnt vmcnt(2)
    s_cmpk_ge_u32 s8, 662
    s_cbranch_scc1 .ap_151
    s_waitcnt vmcnt(1)
.ap_151:
    s_add_u32 s63, s69, 311296
    buffer_load_dwordx4 v[144:147], v1, s[40:43], s63 offen nt
    s_memrealtime s[8:9]
    s_waitcnt vmcnt(8)
    s_waitcnt lgkmcnt(0)
    s_sub_u32 s8, s8, s30
    s_cmpk_ge_u32 s8, 917
    s_cbranch_scc1 .ap_152
    s_waitcnt vmcnt(5)
    s_cmpk_ge_u32 s8, 817
    s_cbranch_scc1 .ap_152
    s_waitcnt vmcnt(4)
    s_cmpk_ge_u32 s8, 697
    s_cbranch_scc1 .ap_152
    s_waitcnt vmcnt(1)
.ap_152:
    s_add_u32 m0, s101, 40960
    s_add_u32 s56, s100, 2949120
    buffer_load_dwordx4 v6, s[48:51], s56 offen nt lds
    s_memrealtime s[8:9]
    s_waitcnt vmcnt(8)
    s_waitcnt lgkmcnt(0)
    s_sub_u32 s8, s8, s30
    s_cmpk_ge_u32 s8, 917
    s_cbranch_scc1 .ap_153
    s_waitcnt vmcnt(5)
    s_cmpk_ge_u32 s8, 817
    s_cbranch_scc1 .ap_153
    s_waitcnt vmcnt(4)
    s_bitcmp1_b64 s[14:15], 23
    s_cbranch_scc0 1
    s_waitcnt vmcnt(2)
    s_cmpk_ge_u32 s8, 697
    s_cbranch_scc1 .ap_153
    s_waitcnt vmcnt(1)
.ap_153:
    s_add_u32 s63, s69, 319488
    buffer_load_dwordx4 v[148:151], v1, s[40:43], s63 offen nt
    s_branch .Lsk_b0_3
.Lst_b0_3:
    s_branch .Lrt_b0_3
.Lsk_b0_3:
    s_memrealtime s[8:9]
    s_waitcnt vmcnt(8)
    s_waitcnt lgkmcnt(0)
    s_sub_u32 s8, s8, s30
    s_cmpk_ge_u32 s8, 952
    s_cbranch_scc1 .ap_154
    s_waitcnt vmcnt(5)
    s_cmpk_ge_u32 s8, 852
    s_cbranch_scc1 .ap_154
    s_waitcnt vmcnt(4)
    s_bitcmp1_b64 s[14:15], 24
    s_cbranch_scc0 1
    s_waitcnt vmcnt(2)
    s_cmpk_ge_u32 s8, 732
    s_cbranch_scc1 .ap_154
    s_waitcnt vmcnt(1)
.ap_154:
    s_add_u32 s63, s69, 393216
    buffer_load_dwordx4 v[56:59], v1, s[40:43], s63 offen nt
    s_memrealtime s[8:9]
    s_waitcnt vmcnt(8)
    s_waitcnt lgkmcnt(0)
    s_sub_u32 s8, s8, s30
    s_cmpk_ge_u32 s8, 987
    s_cbranch_scc1 .ap_155
    s_waitcnt vmcnt(5)
    s_cmpk_ge_u32 s8, 887
    s_cbranch_scc1 .ap_155
    s_waitcnt vmcnt(4)
    s_bitcmp1_b64 s[14:15], 25
    s_cbranch_scc0 1
    s_waitcnt vmcnt(2)
    s_cmpk_ge_u32 s8, 767
    s_cbranch_scc1 .ap_155
    s_waitcnt vmcnt(1)
.ap_155:
    s_add_u32 s63, s69, 401408
    buffer_load_dwordx4 v[60:63], v1, s[40:43], s63 offen nt
    s_memrealtime s[8:9]
    s_waitcnt vmcnt(8)
    s_waitcnt lgkmcnt(0)
    s_sub_u32 s8, s8, s30
    s_cmpk_ge_u32 s8, 1025
    s_cbranch_scc1 .ap_156
    s_waitcnt vmcnt(5)
    s_cmpk_ge_u32 s8, 925
    s_cbranch_scc1 .ap_156
    s_waitcnt vmcnt(4)
    s_bitcmp1_b64 s[14:15], 26
    s_cbranch_scc0 1
    s_waitcnt vmcnt(2)
    s_cmpk_ge_u32 s8, 805
    s_cbranch_scc1 .ap_156
    s_waitcnt vmcnt(1)
.ap_156:
    s_add_u32 s63, s69, 409600
    buffer_load_dwordx4 v[88:91], v1, s[40:43], s63 offen nt
    s_memrealtime s[8:9]
    s_waitcnt vmcnt(8)
    s_waitcnt lgkmcnt(0)
    s_sub_u32 s8, s8, s30
    s_cmpk_ge_u32 s8, 1064
    s_cbranch_scc1 .ap_157
    s_waitcnt vmcnt(5)
    s_cmpk_ge_u32 s8, 964
    s_cbranch_scc1 .ap_157
    s_waitcnt vmcnt(4)
    s_cmpk_ge_u32 s8, 844
    s_cbranch_scc1 .ap_157
    s_waitcnt vmcnt(1)
.ap_157:
    s_add_u32 m0, s101, 49152
    s_add_u32 s56, s100, 3538944
    buffer_load_dwordx4 v6, s[48:51], s56 offen nt lds
    s_memrealtime s[8:9]
    s_waitcnt vmcnt(8)
    s_waitcnt lgkmcnt(0)
    s_sub_u32 s8, s8, s30
    s_cmpk_ge_u32 s8, 1064
    s_cbranch_scc1 .ap_158
    s_waitcnt vmcnt(5)
    s_cmpk_ge_u32 s8, 964
    s_cbranch_scc1 .ap_158
    s_waitcnt vmcnt(4)
    s_bitcmp1_b64 s[14:15], 27
    s_cbranch_scc0 1
    s_waitcnt vmcnt(2)
    s_cmpk_ge_u32 s8, 844
    s_cbranch_scc1 .ap_158
    s_waitcnt vmcnt(1)
.ap_158:
    s_add_u32 s63, s69, 417792
    buffer_load_dwordx4 v[92:95], v1, s[40:43], s63 offen nt
    s_memrealtime s[8:9]
    s_waitcnt vmcnt(8)
    s_waitcnt lgkmcnt(0)
    s_sub_u32 s8, s8, s30
    s_cmpk_ge_u32 s8, 1102
    s_cbranch_scc1 .ap_159
    s_waitcnt vmcnt(5)
    s_cmpk_ge_u32 s8, 1002
    s_cbranch_scc1 .ap_159
    s_waitcnt vmcnt(4)
    s_bitcmp1_b64 s[14:15], 28
    s_cbranch_scc0 1
    s_waitcnt vmcnt(2)
    s_cmpk_ge_u32 s8, 882
    s_cbranch_scc1 .ap_159
    s_waitcnt vmcnt(1)
.ap_159:
    s_add_u32 s63, s69, 425984
    buffer_load_dwordx4 v[120:123], v1, s[40:43], s63 offen nt
    s_memrealtime s[8:9]
    s_waitcnt vmcnt(8)
    s_waitcnt lgkmcnt(0)
    s_sub_u32 s8, s8, s30
    s_cmpk_ge_u32 s8, 1141
    s_cbranch_scc1 .ap_160
    s_waitcnt vmcnt(5)
    s_cmpk_ge_u32 s8, 1041
    s_cbranch_scc1 .ap_160
    s_waitcnt vmcnt(4)
    s_bitcmp1_b64 s[14:15], 29
    s_cbranch_scc0 1
    s_waitcnt vmcnt(2)
    s_cmpk_ge_u32 s8, 921
    s_cbranch_scc1 .ap_160
    s_waitcnt vmcnt(1)
.ap_160:
    s_add_u32 s63, s69, 434176
    buffer_load_dwordx4 v[124:127], v1, s[40:43], s63 offen nt
    s_memrealtime s[8:9]
    s_waitcnt vmcnt(8)
    s_waitcnt lgkmcnt(0)
    s_sub_u32 s8, s8, s30
    s_cmpk_ge_u32 s8, 1179
    s_cbranch_scc1 .ap_161
    s_waitcnt vmcnt(5)
    s_cmpk_ge_u32 s8, 1079
    s_cbranch_scc1 .ap_161
    s_waitcnt vmcnt(4)
    s_bitcmp1_b64 s[14:15], 30
    s_cbranch_scc0 1
    s_waitcnt vmcnt(2)
    s_cmpk_ge_u32 s8, 959
    s_cbranch_scc1 .ap_161
    s_waitcnt vmcnt(1)
.ap_161:
    s_add_u32 s63, s69, 442368
    buffer_load_dwordx4 v[152:155], v1, s[40:43], s63 offen nt
    s_memrealtime s[8:9]
    s_waitcnt vmcnt(8)
    s_waitcnt lgkmcnt(0)
    s_sub_u32 s8, s8, s30
    s_cmpk_ge_u32 s8, 1218
    s_cbranch_scc1 .ap_162
    s_waitcnt vmcnt(5)
    s_cmpk_ge_u32 s8, 1118
    s_cbranch_scc1 .ap_162
    s_waitcnt vmcnt(4)
    s_cmpk_ge_u32 s8, 998
    s_cbranch_scc1 .ap_162
    s_waitcnt vmcnt(1)
.ap_162:
    s_add_u32 m0, s101, 57344
    s_add_u32 s56, s100, 4128768
    buffer_load_dwordx4 v6, s[48:51], s56 offen nt lds
    s_and_b32 s0, s0, 0xffffff80
    s_sub_u32 s0, s0, 1024
    buffer_load_dword v28, v4, s[36:39], s0 offen sc1
    s_memrealtime s[8:9]
    s_waitcnt vmcnt(9)
    s_waitcnt lgkmcnt(0)
    s_sub_u32 s8, s8, s30
    s_cmpk_ge_u32 s8, 1218
    s_cbranch_scc1 .ap_163
    s_waitcnt vmcnt(6)
    s_cmpk_ge_u32 s8, 1118
    s_cbranch_scc1 .ap_163
    s_waitcnt vmcnt(5)
    s_bitcmp1_b64 s[14:15], 31
    s_cbranch_scc0 1
    s_waitcnt vmcnt(3)
    s_cmpk_ge_u32 s8, 998
    s_cbranch_scc1 .ap_163
    s_waitcnt vmcnt(2)
.ap_163:
    s_add_u32 s63, s69, 450560
    buffer_load_dwordx4 v[156:159], v1, s[40:43], s63 offen nt
    s_memrealtime s[8:9]
    s_waitcnt vmcnt(9)
    s_waitcnt lgkmcnt(0)
    s_sub_u32 s8, s8, s30
    s_cmpk_ge_u32 s8, 1257
    s_cbranch_scc1 .ap_164
    s_waitcnt vmcnt(6)
    s_cmpk_ge_u32 s8, 1157
    s_cbranch_scc1 .ap_164
    s_waitcnt vmcnt(5)
    s_bitcmp1_b64 s[14:15], 32
    s_cbranch_scc0 1
    s_waitcnt vmcnt(3)
    s_cmpk_ge_u32 s8, 1037
    s_cbranch_scc1 .ap_164
    s_waitcnt vmcnt(2)
.ap_164:
    v_bfe_u32 v1, v0, 4, 2
    v_and_b32 v10, 0xf0, v2
    v_lshlrev_b32 v1, 2, v1
    v_bfe_u32 v1, s6, v1, 4
    v_lshl_add_u32 v1, v1, 8, v10
    s_add_u32 s63, s69, 0
    buffer_load_dwordx4 v[160:163], v1, s[44:47], s63 offen nt
    s_memrealtime s[8:9]
    s_waitcnt vmcnt(9)
    s_waitcnt lgkmcnt(0)
    s_sub_u32 s8, s8, s30
    s_cmpk_ge_u32 s8, 1293
    s_cbranch_scc1 .ap_165
    s_waitcnt vmcnt(6)
    s_cmpk_ge_u32 s8, 1193
    s_cbranch_scc1 .ap_165
    s_waitcnt vmcnt(5)
    s_bitcmp1_b64 s[14:15], 33
    s_cbranch_scc0 1
    s_waitcnt vmcnt(3)
    s_cmpk_ge_u32 s8, 1073
    s_cbranch_scc1 .ap_165
    s_waitcnt vmcnt(1)
.ap_165:
    s_add_u32 s63, s69, 8192
    buffer_load_dwordx4 v[164:167], v1, s[44:47], s63 offen nt
    s_memrealtime s[8:9]
    s_waitcnt vmcnt(9)
    s_waitcnt lgkmcnt(0)
    s_sub_u32 s8, s8, s30
    s_cmpk_ge_u32 s8, 1329
    s_cbranch_scc1 .ap_166
    s_branch .Lsk_b1_0
.Lst_b1_0:
    s_branch .Lrt_b1_0
.Lsk_b1_0:
    s_waitcnt vmcnt(6)
    s_cmpk_ge_u32 s8, 1229
    s_cbranch_scc1 .ap_166
    s_waitcnt vmcnt(5)
    s_bitcmp1_b64 s[14:15], 34
    s_cbranch_scc0 1
    s_waitcnt vmcnt(2)
    s_cmpk_ge_u32 s8, 1109
    s_cbranch_scc1 .ap_166
    s_waitcnt vmcnt(1)
.ap_166:
    s_add_u32 s63, s69, 16384
    buffer_load_dwordx4 v[168:171], v1, s[44:47], s63 offen nt
    s_memrealtime s[8:9]
    s_waitcnt vmcnt(9)
    s_waitcnt lgkmcnt(0)
    s_sub_u32 s8, s8, s30
    s_cmpk_ge_u32 s8, 1366
    s_cbranch_scc1 .ap_167
    s_waitcnt vmcnt(6)
    s_cmpk_ge_u32 s8, 1266
    s_cbranch_scc1 .ap_167
    s_waitcnt vmcnt(5)
    s_cmpk_ge_u32 s8, 1146
    s_cbranch_scc1 .ap_167
    s_waitcnt vmcnt(1)
.ap_167:
    s_add_u32 m0, s101, 65536
    s_add_u32 s56, s100, 4718592
    buffer_load_dwordx4 v6, s[48:51], s56 offen nt lds
    s_memrealtime s[8:9]
    s_waitcnt vmcnt(9)
    s_waitcnt lgkmcnt(0)
    s_sub_u32 s8, s8, s30
    s_cmpk_ge_u32 s8, 1366
    s_cbranch_scc1 .ap_168
    s_waitcnt vmcnt(6)
    s_cmpk_ge_u32 s8, 1266
    s_cbranch_scc1 .ap_168
    s_waitcnt vmcnt(4)
    s_bitcmp1_b64 s[14:15], 35
    s_cbranch_scc0 1
    s_waitcnt vmcnt(2)
    s_cmpk_ge_u32 s8, 1146
    s_cbranch_scc1 .ap_168
    s_waitcnt vmcnt(1)
.ap_168:
    s_add_u32 s63, s69, 24576
    buffer_load_dwordx4 v[172:175], v1, s[44:47], s63 offen nt
    s_memrealtime s[8:9]
    s_waitcnt vmcnt(9)
    s_waitcnt lgkmcnt(0)
    s_sub_u32 s8, s8, s30
    s_cmpk_ge_u32 s8, 1402
    s_cbranch_scc1 .ap_169
    s_waitcnt vmcnt(5)
    s_cmpk_ge_u32 s8, 1302
    s_cbranch_scc1 .ap_169
    s_waitcnt vmcnt(4)
    s_bitcmp1_b64 s[14:15], 36
    s_cbranch_scc0 1
    s_waitcnt vmcnt(2)
    s_cmpk_ge_u32 s8, 1182
    s_cbranch_scc1 .ap_169
    s_waitcnt vmcnt(1)
.ap_169:
    s_add_u32 s63, s69, 32768
    buffer_load_dwordx4 v[176:179], v1, s[44:47], s63 offen nt
    s_waitcnt vmcnt(7)
    v_cmp_eq_u32 vcc, s1, v28
    s_cmp_eq_u64 vcc, -1
    s_cselect_b32 s0, 0x800000, 0
    s_add_u32 s58, s58, s0
    buffer_load_dwordx4 v[16:19], v7, s[36:39], s58 offen offset:0 sc1
    buffer_load_dwordx4 v[20:23], v7, s[36:39], s58 offen offset:256 sc1
    s_memrealtime s[8:9]
    s_waitcnt vmcnt(8)
    s_waitcnt lgkmcnt(0)
    s_sub_u32 s8, s8, s30
    s_cmpk_ge_u32 s8, 1439
    s_cbranch_scc1 .ap_170
    s_waitcnt vmcnt(5)
    s_cmpk_ge_u32 s8, 1339
    s_cbranch_scc1 .ap_170
    s_waitcnt vmcnt(4)
    s_bitcmp1_b64 s[14:15], 37
    s_cbranch_scc0 1
    s_waitcnt vmcnt(2)
    s_cmpk_ge_u32 s8, 1219
    s_cbranch_scc1 .ap_170
    s_waitcnt vmcnt(1)
.ap_170:
    s_add_u32 s63, s69, 40960
    buffer_load_dwordx4 v[180:183], v1, s[44:47], s63 offen nt
    s_memrealtime s[8:9]
    s_waitcnt vmcnt(8)
    s_waitcnt lgkmcnt(0)
    s_sub_u32 s8, s8, s30
    s_cmpk_ge_u32 s8, 1475
    s_cbranch_scc1 .ap_171
    s_waitcnt vmcnt(5)
    s_cmpk_ge_u32 s8, 1375
    s_cbranch_scc1 .ap_171
    s_waitcnt vmcnt(4)
    s_bitcmp1_b64 s[14:15], 38
    s_cbranch_scc0 1
    s_waitcnt vmcnt(2)
    s_cmpk_ge_u32 s8, 1255
    s_cbranch_scc1 .ap_171
    s_waitcnt vmcnt(1)
.ap_171:
    s_add_u32 s63, s69, 49152
    buffer_load_dwordx4 v[184:187], v1, s[44:47], s63 offen nt
    s_memrealtime s[8:9]
    s_waitcnt vmcnt(8)
    s_waitcnt lgkmcnt(0)
    s_sub_u32 s8, s8, s30
    s_cmpk_ge_u32 s8, 1512
    s_cbranch_scc1 .ap_172
    s_waitcnt vmcnt(5)
    s_cmpk_ge_u32 s8, 1412
    s_cbranch_scc1 .ap_172
    s_waitcnt vmcnt(4)
    s_cmpk_ge_u32 s8, 1292
    s_cbranch_scc1 .ap_172
    s_waitcnt vmcnt(1)
.ap_172:
    s_add_u32 m0, s101, 73728
    s_add_u32 s56, s100, 0
    buffer_load_dwordx4 v6, s[52:55], s56 offen nt lds
    s_memrealtime s[8:9]
    s_waitcnt vmcnt(8)
    s_waitcnt lgkmcnt(0)
    s_sub_u32 s8, s8, s30
    s_cmpk_ge_u32 s8, 1512
    s_cbranch_scc1 .ap_173
    s_waitcnt vmcnt(5)
    s_cmpk_ge_u32 s8, 1412
    s_cbranch_scc1 .ap_173
    s_waitcnt vmcnt(4)
    s_bitcmp1_b64 s[14:15], 39
    s_cbranch_scc0 1
    s_waitcnt vmcnt(2)
    s_cmpk_ge_u32 s8, 1292
    s_cbranch_scc1 .ap_173
    s_waitcnt vmcnt(1)
.ap_173:
    s_add_u32 s63, s69, 57344
    buffer_load_dwordx4 v[188:191], v1, s[44:47], s63 offen nt
    s_memrealtime s[8:9]
    s_waitcnt vmcnt(8)
    s_waitcnt lgkmcnt(0)
    s_sub_u32 s8, s8, s30
    s_cmpk_ge_u32 s8, 1548
    s_cbranch_scc1 .ap_174
    s_waitcnt vmcnt(5)
    s_cmpk_ge_u32 s8, 1448
    s_cbranch_scc1 .ap_174
    s_waitcnt vmcnt(4)
    s_bitcmp1_b64 s[14:15], 40
    s_cbranch_scc0 1
    s_waitcnt vmcnt(2)
    s_cmpk_ge_u32 s8, 1328
    s_cbranch_scc1 .ap_174
    s_waitcnt vmcnt(1)
.ap_174:
    s_add_u32 s63, s69, 131072
    buffer_load_dwordx4 v[192:195], v1, s[44:47], s63 offen nt
    s_waitcnt vmcnt(5)
    s_branch .gpc_176
.gp_175:
    s_xor_b32 s58, s58, 0x800000
    buffer_load_dwordx4 v[16:19], v7, s[36:39], s58 offen offset:0 sc1
    buffer_load_dwordx4 v[20:23], v7, s[36:39], s58 offen offset:256 sc1
    s_waitcnt vmcnt(0)
.gpc_176:
    v_min_u32 v10, v17, v19
    v_max_u32 v11, v17, v19
    v_min3_u32 v10, v10, v21, v23
    v_max3_u32 v11, v11, v21, v23
    v_cmp_eq_u32 vcc, s34, v10
    v_cmp_eq_u32 s[56:57], s34, v11
    s_and_b64 vcc, vcc, s[56:57]
    s_cmp_eq_u64 vcc, -1
    s_nop 2
    s_cbranch_scc1 .gpd_177
    s_sub_u32 s35, s35, 1
    s_cbranch_scc1 .Lexit
    s_sleep 1
    s_branch .gp_175
.gpd_177:
    s_mov_b32 vcc_lo, 0xcccccccc
    s_mov_b32 vcc_hi, 0xcccccccc
    v_cndmask_b32_e64 v24, v16, 0, vcc
    v_cndmask_b32_e64 v25, v18, 0, vcc
    v_cndmask_b32_e64 v26, v20, 0, vcc
    v_cndmask_b32_e64 v27, v22, 0, vcc
    v_cndmask_b32_e32 v28, 0, v16, vcc
    v_cndmask_b32_e32 v29, 0, v18, vcc
    v_cndmask_b32_e32 v30, 0, v20, vcc
    v_cndmask_b32_e32 v31, 0, v22, vcc
    v_mfma_f32_16x16x32_bf16 v[16:19], v[32:35], v[24:27], 0
    v_mfma_f32_16x16x32_bf16 v[32:35], v[40:43], v[24:27], 0
    v_mfma_f32_16x16x32_bf16 v[16:19], v[36:39], v[28:31], v[16:19]
    v_mfma_f32_16x16x32_bf16 v[40:43], v[48:51], v[24:27], 0
    v_mfma_f32_16x16x32_bf16 v[32:35], v[44:47], v[28:31], v[32:35]
    v_mfma_f32_16x16x32_bf16 v[48:51], v[56:59], v[24:27], 0
    v_mfma_f32_16x16x32_bf16 v[40:43], v[52:55], v[28:31], v[40:43]
    v_mfma_f32_16x16x32_bf16 v[56:59], v[64:67], v[24:27], 0
    v_mfma_f32_16x16x32_bf16 v[48:51], v[60:63], v[28:31], v[48:51]
    s_nop 1
    v_add_f32_dpp v10, v17, v16 row_ror:12 row_mask:0xf bank_mask:0x1
    s_memrealtime s[8:9]
    s_waitcnt lgkmcnt(0)
    s_sub_u32 s8, s8, s30
    s_cmpk_ge_u32 s8, 1585
    s_nop 0
    s_cbranch_scc1 .ap_178
    s_waitcnt vmcnt(5)
    s_cmpk_ge_u32 s8, 1485
    s_cbranch_scc1 .ap_178
    s_waitcnt vmcnt(4)
    s_bitcmp1_b64 s[14:15], 41
    s_cbranch_scc0 1
    s_waitcnt vmcnt(2)
    s_cmpk_ge_u32 s8, 1365
    s_cbranch_scc1 .ap_178
    s_branch .Lsk_b1_1
.Lst_b1_1:
    s_branch .Lrt_b1_1
.Lsk_b1_1:
    s_waitcnt vmcnt(1)
.ap_178:
    s_add_u32 s63, s69, 139264
    buffer_load_dwordx4 v[196:199], v1, s[44:47], s63 offen nt
    v_mfma_f32_16x16x32_bf16 v[64:67], v[72:75], v[24:27], 0
    v_mfma_f32_16x16x32_bf16 v[56:59], v[68:71], v[28:31], v[56:59]
    v_add_f32_dpp v11, v33, v32 row_ror:12 row_mask:0xf bank_mask:0x1
    v_add_f32_dpp v10, v18, v10 row_ror:8 row_mask:0xf bank_mask:0x1
    v_mfma_f32_16x16x32_bf16 v[72:75], v[80:83], v[24:27], 0
    v_mfma_f32_16x16x32_bf16 v[64:67], v[76:79], v[28:31], v[64:67]
    v_add_f32_dpp v12, v41, v40 row_ror:12 row_mask:0xf bank_mask:0x1
    v_add_f32_dpp v11, v34, v11 row_ror:8 row_mask:0xf bank_mask:0x1
    v_add_f32_dpp v10, v19, v10 row_ror:4 row_mask:0xf bank_mask:0x1
    v_mfma_f32_16x16x32_bf16 v[80:83], v[88:91], v[24:27], 0
    v_mfma_f32_16x16x32_bf16 v[72:75], v[84:87], v[28:31], v[72:75]
    v_add_f32_dpp v13, v49, v48 row_ror:12 row_mask:0xf bank_mask:0x1
    v_add_f32_dpp v12, v42, v12 row_ror:8 row_mask:0xf bank_mask:0x1
    v_add_f32_dpp v11, v35, v11 row_ror:4 row_mask:0xf bank_mask:0x1
    v_mfma_f32_16x16x32_bf16 v[88:91], v[96:99], v[24:27], 0
    v_mfma_f32_16x16x32_bf16 v[80:83], v[92:95], v[28:31], v[80:83]
    v_add_f32_dpp v10, v58, v57 row_ror:12 row_mask:0xf bank_mask:0x2
    v_add_f32_dpp v13, v50, v13 row_ror:8 row_mask:0xf bank_mask:0x1
    v_add_f32_dpp v12, v43, v12 row_ror:4 row_mask:0xf bank_mask:0x1
    s_memrealtime s[8:9]
    s_waitcnt lgkmcnt(0)
    s_sub_u32 s8, s8, s30
    s_cmpk_ge_u32 s8, 1591
    s_nop 0
    s_cbranch_scc1 .ap_179
    s_waitcnt vmcnt(5)
    s_cmpk_ge_u32 s8, 1491
    s_cbranch_scc1 .ap_179
    s_waitcnt vmcnt(4)
    s_bitcmp1_b64 s[14:15], 42
    s_cbranch_scc0 1
    s_waitcnt vmcnt(2)
    s_cmpk_ge_u32 s8, 1371
    s_cbranch_scc1 .ap_179
    s_waitcnt vmcnt(1)
.ap_179:
    s_add_u32 s63, s69, 147456
    buffer_load_dwordx4 v[200:203], v1, s[44:47], s63 offen nt
    s_memrealtime s[8:9]
    s_waitcnt lgkmcnt(0)
    s_sub_u32 s8, s8, s30
    s_cmpk_ge_u32 s8, 1597
    s_cbranch_scc1 .ap_180
    s_waitcnt vmcnt(5)
    s_cmpk_ge_u32 s8, 1497
    s_cbranch_scc1 .ap_180
    s_waitcnt vmcnt(4)
    s_cmpk_ge_u32 s8, 1377
    s_cbranch_scc1 .ap_180
    s_waitcnt vmcnt(1)
.ap_180:
    s_add_u32 m0, s101, 81920
    s_add_u32 s56, s100, 589824
    buffer_load_dwordx4 v6, s[52:55], s56 offen nt lds
    v_mfma_f32_16x16x32_bf16 v[96:99], v[104:107], v[24:27], 0
    v_mfma_f32_16x16x32_bf16 v[88:91], v[100:103], v[28:31], v[88:91]
    v_add_f32_dpp v11, v66, v65 row_ror:12 row_mask:0xf bank_mask:0x2
    v_add_f32_dpp v10, v59, v10 row_ror:8 row_mask:0xf bank_mask:0x2
    v_add_f32_dpp v13, v51, v13 row_ror:4 row_mask:0xf bank_mask:0x1
    v_mfma_f32_16x16x32_bf16 v[104:107], v[112:115], v[24:27], 0
    v_mfma_f32_16x16x32_bf16 v[96:99], v[108:111], v[28:31], v[96:99]
    v_add_f32_dpp v12, v74, v73 row_ror:12 row_mask:0xf bank_mask:0x2
    v_add_f32_dpp v11, v67, v11 row_ror:8 row_mask:0xf bank_mask:0x2
    v_add_f32_dpp v10, v56, v10 row_ror:4 row_mask:0xf bank_mask:0x2
    v_mfma_f32_16x16x32_bf16 v[112:115], v[120:123], v[24:27], 0
    v_mfma_f32_16x16x32_bf16 v[104:107], v[116:119], v[28:31], v[104:107]
    v_add_f32_dpp v13, v82, v81 row_ror:12 row_mask:0xf bank_mask:0x2
    v_add_f32_dpp v12, v75, v12 row_ror:8 row_mask:0xf bank_mask:0x2
    v_add_f32_dpp v11, v64, v11 row_ror:4 row_mask:0xf bank_mask:0x2
    v_mfma_f32_16x16x32_bf16 v[120:123], v[128:131], v[24:27], 0
    v_mfma_f32_16x16x32_bf16 v[112:115], v[124:127], v[28:31], v[112:115]
    v_add_f32_dpp v10, v91, v90 row_ror:12 row_mask:0xf bank_mask:0x4
    v_add_f32_dpp v13, v83, v13 row_ror:8 row_mask:0xf bank_mask:0x2
    v_add_f32_dpp v12, v72, v12 row_ror:4 row_mask:0xf bank_mask:0x2
    s_memrealtime s[8:9]
    s_waitcnt lgkmcnt(0)
    s_sub_u32 s8, s8, s30
    s_cmpk_ge_u32 s8, 1597
    s_nop 0
    s_cbranch_scc1 .ap_181
    s_waitcnt vmcnt(5)
    s_cmpk_ge_u32 s8, 1497
    s_cbranch_scc1 .ap_181
    s_waitcnt vmcnt(4)
    s_bitcmp1_b64 s[14:15], 43
    s_cbranch_scc0 1
    s_waitcnt vmcnt(2)
    s_cmpk_ge_u32 s8, 1377
    s_cbranch_scc1 .ap_181
    s_waitcnt vmcnt(1)
.ap_181:
    s_add_u32 s63, s69, 155648
    buffer_load_dwordx4 v[204:207], v1, s[44:47], s63 offen nt
    v_mfma_f32_16x16x32_bf16 v[128:131], v[136:139], v[24:27], 0
    v_mfma_f32_16x16x32_bf16 v[120:123], v[132:135], v[28:31], v[120:123]
    v_add_f32_dpp v11, v99, v98 row_ror:12 row_mask:0xf bank_mask:0x4
    v_add_f32_dpp v10, v88, v10 row_ror:8 row_mask:0xf bank_mask:0x4
    v_add_f32_dpp v13, v80, v13 row_ror:4 row_mask:0xf bank_mask:0x2
    v_mfma_f32_16x16x32_bf16 v[136:139], v[144:147], v[24:27], 0
    v_mfma_f32_16x16x32_bf16 v[128:131], v[140:143], v[28:31], v[128:131]
    v_add_f32_dpp v12, v107, v106 row_ror:12 row_mask:0xf bank_mask:0x4
    v_add_f32_dpp v11, v96, v11 row_ror:8 row_mask:0xf bank_mask:0x4
    v_add_f32_dpp v10, v89, v10 row_ror:4 row_mask:0xf bank_mask:0x4
    v_mfma_f32_16x16x32_bf16 v[144:147], v[152:155], v[24:27], 0
    v_mfma_f32_16x16x32_bf16 v[136:139], v[148:151], v[28:31], v[136:139]
    v_add_f32_dpp v13, v115, v114 row_ror:12 row_mask:0xf bank_mask:0x4
    v_add_f32_dpp v12, v104, v12 row_ror:8 row_mask:0xf bank_mask:0x4
    v_add_f32_dpp v11, v97, v11 row_ror:4 row_mask:0xf bank_mask:0x4
    v_mfma_f32_16x16x32_bf16 v[144:147], v[156:159], v[28:31], v[144:147]
    v_add_f32_dpp v10, v120, v123 row_ror:12 row_mask:0xf bank_mask:0x8
    v_add_f32_dpp v13, v112, v13 row_ror:8 row_mask:0xf bank_mask:0x4
    v_add_f32_dpp v12, v105, v12 row_ror:4 row_mask:0xf bank_mask:0x4
    s_memrealtime s[8:9]
    s_waitcnt vmcnt(8)
    s_waitcnt lgkmcnt(0)
    s_sub_u32 s8, s8, s30
    s_cmpk_ge_u32 s8, 1603
    s_cbranch_scc1 .ap_182
    s_waitcnt vmcnt(5)
    s_cmpk_ge_u32 s8, 1503
    s_cbranch_scc1 .ap_182
    s_waitcnt vmcnt(4)
    s_bitcmp1_b64 s[14:15], 44
    s_cbranch_scc0 1
    s_waitcnt vmcnt(2)
    s_cmpk_ge_u32 s8, 1383
    s_cbranch_scc1 .ap_182
    s_waitcnt vmcnt(1)
.ap_182:
    s_add_u32 s63, s69, 163840
    buffer_load_dwordx4 v[208:211], v1, s[44:47], s63 offen nt
    s_cmp_eq_u32 s3, 0
    s_cbranch_scc1 .Lst_b2_0
    s_cmp_eq_u32 s3, 1
    s_branch .Lsk_b1_2
.Lst_b1_2:
    s_branch .Lrt_b1_2
.Lsk_b1_2:
    s_cbranch_scc1 .Lst_b2_1
    s_cmp_eq_u32 s3, 2
    s_cbranch_scc1 .Lst_b2_2
    s_cmp_eq_u32 s3, 3
    s_cbranch_scc1 .Lst_b2_3
.Lrt_b2_0:
.Lrt_b2_1:
.Lrt_b2_2:
.Lrt_b2_3:
    v_add_f32_dpp v11, v128, v131 row_ror:12 row_mask:0xf bank_mask:0x8
    v_add_f32_dpp v10, v121, v10 row_ror:8 row_mask:0xf bank_mask:0x8
    v_add_f32_dpp v13, v113, v13 row_ror:4 row_mask:0xf bank_mask:0x4
    v_add_f32_dpp v12, v136, v139 row_ror:12 row_mask:0xf bank_mask:0x8
    v_add_f32_dpp v11, v129, v11 row_ror:8 row_mask:0xf bank_mask:0x8
    v_add_f32_dpp v10, v122, v10 row_ror:4 row_mask:0xf bank_mask:0x8
    v_add_f32_dpp v13, v144, v147 row_ror:12 row_mask:0xf bank_mask:0x8
    v_add_f32_dpp v12, v137, v12 row_ror:8 row_mask:0xf bank_mask:0x8
    v_add_f32_dpp v11, v130, v11 row_ror:4 row_mask:0xf bank_mask:0x8
    v_add_f32_dpp v13, v145, v13 row_ror:8 row_mask:0xf bank_mask:0x8
    v_add_f32_dpp v12, v138, v12 row_ror:4 row_mask:0xf bank_mask:0x8
    s_memrealtime s[8:9]
    s_waitcnt vmcnt(8)
    s_waitcnt lgkmcnt(0)
    s_sub_u32 s8, s8, s30
    s_cmpk_ge_u32 s8, 1609
    s_cbranch_scc1 .ap_183
    s_waitcnt vmcnt(5)
    s_cmpk_ge_u32 s8, 1509
    s_cbranch_scc1 .ap_183
    s_waitcnt vmcnt(4)
    s_bitcmp1_b64 s[14:15], 45
    s_cbranch_scc0 1
    s_waitcnt vmcnt(2)
    s_cmpk_ge_u32 s8, 1389
    s_cbranch_scc1 .ap_183
    s_waitcnt vmcnt(1)
.ap_183:
    s_add_u32 s63, s69, 172032
    buffer_load_dwordx4 v[212:215], v1, s[44:47], s63 offen nt
    v_add_f32_dpp v13, v146, v13 row_ror:4 row_mask:0xf bank_mask:0x8
    s_mov_b32 s60, 0x3db504f3
    s_mov_b32 s61, 0x3db504f3
    v_cvt_pk_bf16_f32 v10, v10, v11
    v_and_b32 v11, 0xffff0000, v10
    v_lshlrev_b32 v10, 16, v10
    v_cvt_pk_bf16_f32 v12, v12, v13
    v_and_b32 v13, 0xffff0000, v12
    v_lshlrev_b32 v12, 16, v12
    v_pk_mul_f32 v[10:11], v[10:11], s[60:61]
    v_pk_mul_f32 v[12:13], v[12:13], s[60:61]
    v_cvt_pk_bf16_f32 v10, v10, v11
    v_and_b32 v11, 0xffff0000, v10
    v_lshlrev_b32 v10, 16, v10
    v_cvt_pk_bf16_f32 v12, v12, v13
    v_and_b32 v13, 0xffff0000, v12
    v_lshlrev_b32 v12, 16, v12
    v_max_f32 v14, v10, v11
    v_max3_f32 v14, v14, v12, v13
    s_mov_b32 s60, 0x3fb8aa3b
    v_mov_b32 v22, s34
    v_mov_b32 v23, s34
    v_max_f32_dpp v14, v14, v14 quad_perm:[2,3,0,1] row_mask:0xf bank_mask:0xf
    s_nop 1
    v_max_f32_dpp v14, v14, v14 row_ror:4 row_mask:0xf bank_mask:0xf
    s_nop 1
    v_max_f32_dpp v14, v14, v14 row_ror:8 row_mask:0xf bank_mask:0xf
    v_mov_b32 v15, v14
    s_nop 1
    v_permlane16_swap_b32 v15, v14
    v_max_f32 v14, v15, v14
    v_mov_b32 v15, v14
    s_nop 1
    v_permlane32_swap_b32 v15, v14
    v_max_f32 v14, v15, v14
    v_mul_f32 v15, 0xbfb8aa3b, v14
    v_fma_f32 v10, v10, s60, v15
    v_fma_f32 v11, v11, s60, v15
    v_fma_f32 v12, v12, s60, v15
    v_fma_f32 v13, v13, s60, v15
    v_exp_f32 v10, v10
    v_exp_f32 v11, v11
    v_exp_f32 v12, v12
    v_exp_f32 v13, v13
    v_mov_b32 v20, v14
    v_pk_add_f32 v[16:17], v[10:11], v[12:13]
    v_add_f32 v21, v16, v17
    s_lshl_b32 s60, s68, 5
    s_lshl_b32 s61, s3, 4
    s_add_u32 s61, s61, 159104
    v_add_u32 v16, s61, v3
    v_mov_b32 v17, 159232
    v_mov_b32 v18, 1
    s_add_u32 s60, s60, s59
    v_add_f32_dpp v21, v21, v21 quad_perm:[2,3,0,1] row_mask:0xf bank_mask:0xf
    s_nop 1
    v_add_f32_dpp v21, v21, v21 row_ror:4 row_mask:0xf bank_mask:0xf
    s_nop 1
    v_add_f32_dpp v21, v21, v21 row_ror:8 row_mask:0xf bank_mask:0xf
    v_mov_b32 v15, v21
    s_nop 1
    v_permlane16_swap_b32 v15, v21
    v_add_f32 v21, v15, v21
    v_mov_b32 v15, v21
    s_nop 1
    v_permlane32_swap_b32 v15, v21
    v_add_f32 v21, v15, v21
    s_mov_b64 exec, 3
    ds_write_b64 v16, v[20:21]
    s_mov_b64 exec, 1
    ds_add_rtn_u32 v18, v17, v18
    s_mov_b64 exec, -1
    v_and_b32 v16, 0x78, v3
    v_or_b32 v16, 159104, v16
    s_waitcnt lgkmcnt(0)
    v_readfirstlane_b32 s61, v18
    s_cmp_eq_u32 s61, 7
    s_nop 3
    s_cbranch_scc0 .mlc_184
    ds_read_b64 v[18:19], v16
    s_waitcnt lgkmcnt(0)
    v_mov_b32 v20, v18
    s_nop 1
    v_max_f32_dpp v20, v20, v20 quad_perm:[2,3,0,1] row_mask:0xf bank_mask:0xf
    s_nop 1
    v_max_f32_dpp v20, v20, v20 row_ror:4 row_mask:0xf bank_mask:0xf
    s_nop 1
    v_max_f32_dpp v20, v20, v20 row_ror:8 row_mask:0xf bank_mask:0xf
    v_sub_f32 v18, v18, v20
    v_mul_f32 v18, 0x3fb8aa3b, v18
    v_exp_f32 v18, v18
    s_nop 0
    v_mul_f32 v21, v18, v19
    s_nop 1
    v_add_f32_dpp v21, v21, v21 quad_perm:[2,3,0,1] row_mask:0xf bank_mask:0xf
    s_nop 1
    v_add_f32_dpp v21, v21, v21 row_ror:4 row_mask:0xf bank_mask:0xf
    s_nop 1
    v_add_f32_dpp v21, v21, v21 row_ror:8 row_mask:0xf bank_mask:0xf
    s_mov_b64 exec, 3
    s_add_u32 s57, s60, 0x800000
    buffer_store_dwordx4 v[20:23], v2, s[36:39], s57 offen
    s_cmp_lg_u32 s0, 0
    s_nop 0
    s_cbranch_scc1 .nosl_185
    buffer_store_dwordx4 v[20:23], v2, s[36:39], s60 offen sc1
.nosl_185:
    s_mov_b64 exec, -1
.mlc_184:
    s_add_u32 s59, s59, s0
    s_memrealtime s[8:9]
    s_waitcnt vmcnt(8)
    s_waitcnt lgkmcnt(0)
    s_sub_u32 s8, s8, s30
    s_cmpk_ge_u32 s8, 1640
    s_cbranch_scc1 .ap_186
    s_waitcnt vmcnt(5)
    s_cmpk_ge_u32 s8, 1540
    s_cbranch_scc1 .ap_186
    s_waitcnt vmcnt(4)
    s_bitcmp1_b64 s[14:15], 46
    s_cbranch_scc0 1
    s_waitcnt vmcnt(2)
    s_cmpk_ge_u32 s8, 1420
    s_cbranch_scc1 .ap_186
    s_waitcnt vmcnt(1)
.ap_186:
    s_add_u32 s63, s69, 180224
    buffer_load_dwordx4 v[216:219], v1, s[44:47], s63 offen nt
    s_memrealtime s[8:9]
    s_waitcnt vmcnt(8)
    s_waitcnt lgkmcnt(0)
    s_sub_u32 s8, s8, s30
    s_cmpk_ge_u32 s8, 1672
    s_cbranch_scc1 .ap_187
    s_waitcnt vmcnt(5)
    s_cmpk_ge_u32 s8, 1572
    s_cbranch_scc1 .ap_187
    s_waitcnt vmcnt(4)
    s_bitcmp1_b64 s[14:15], 47
    s_cbranch_scc0 1
    s_waitcnt vmcnt(2)
    s_cmpk_ge_u32 s8, 1452
    s_cbranch_scc1 .ap_187
    s_waitcnt vmcnt(1)
.ap_187:
    s_add_u32 s63, s69, 188416
    buffer_load_dwordx4 v[220:223], v1, s[44:47], s63 offen nt
    s_and_b32 s56, s64, 0
    s_mul_i32 s56, s56, 18432
    s_mul_i32 s57, s3, 2304
    s_add_u32 s56, s56, s57
    s_add_u32 s56, s56, 0x37000
    buffer_load_dwordx4 v[32:35], v2, s[36:39], s56 offen offset:0 sc1
    buffer_load_dwordx4 v[40:43], v2, s[36:39], s56 offen offset:1024 sc1
    buffer_load_dwordx2 v[48:49], v5, s[36:39], s56 offen offset:0 sc1
    s_memrealtime s[8:9]
    s_waitcnt vmcnt(11)
    s_waitcnt lgkmcnt(0)
    s_sub_u32 s8, s8, s30
    s_cmpk_ge_u32 s8, 1704
    s_cbranch_scc1 .ap_188
    s_waitcnt vmcnt(8)
    s_cmpk_ge_u32 s8, 1604
    s_cbranch_scc1 .ap_188
    s_waitcnt vmcnt(7)
    s_bitcmp1_b64 s[14:15], 48
    s_cbranch_scc0 1
    s_waitcnt vmcnt(5)
    s_cmpk_ge_u32 s8, 1484
    s_cbranch_scc1 .ap_188
    s_branch .Lsk_b1_3
.Lst_b1_3:
    s_branch .Lrt_b1_3
.Lsk_b1_3:
    s_waitcnt vmcnt(4)
.ap_188:
    s_add_u32 s63, s69, 262144
    buffer_load_dwordx4 v[224:227], v1, s[44:47], s63 offen nt
    s_memrealtime s[8:9]
    s_waitcnt vmcnt(11)
    s_waitcnt lgkmcnt(0)
    s_sub_u32 s8, s8, s30
    s_cmpk_ge_u32 s8, 1736
    s_cbranch_scc1 .ap_189
    s_waitcnt vmcnt(8)
    s_cmpk_ge_u32 s8, 1636
    s_cbranch_scc1 .ap_189
    s_waitcnt vmcnt(7)
    s_bitcmp1_b64 s[14:15], 49
    s_cbranch_scc0 1
    s_waitcnt vmcnt(5)
    s_cmpk_ge_u32 s8, 1516
    s_cbranch_scc1 .ap_189
    s_waitcnt vmcnt(4)
.ap_189:
    s_add_u32 s63, s69, 270336
    buffer_load_dwordx4 v[228:231], v1, s[44:47], s63 offen nt
    s_and_b32 s56, s64, 0
    s_mul_i32 s56, s56, 18432
    s_mul_i32 s57, s3, 2304
    s_add_u32 s56, s56, s57
    s_add_u32 s56, s56, 0x49000
    buffer_load_dwordx4 v[56:59], v2, s[36:39], s56 offen offset:0 sc1
    buffer_load_dwordx4 v[64:67], v2, s[36:39], s56 offen offset:1024 sc1
    buffer_load_dwordx2 v[72:73], v5, s[36:39], s56 offen offset:0 sc1
    s_memrealtime s[8:9]
    s_waitcnt vmcnt(14)
    s_waitcnt lgkmcnt(0)
    s_sub_u32 s8, s8, s30
    s_cmpk_ge_u32 s8, 1768
    s_cbranch_scc1 .ap_190
    s_waitcnt vmcnt(11)
    s_cmpk_ge_u32 s8, 1668
    s_cbranch_scc1 .ap_190
    s_waitcnt vmcnt(10)
    s_bitcmp1_b64 s[14:15], 50
    s_cbranch_scc0 1
    s_waitcnt vmcnt(8)
    s_cmpk_ge_u32 s8, 1548
    s_cbranch_scc1 .ap_190
    s_waitcnt vmcnt(4)
.ap_190:
    s_add_u32 s63, s69, 278528
    buffer_load_dwordx4 v[232:235], v1, s[44:47], s63 offen nt
    s_memrealtime s[8:9]
    s_waitcnt vmcnt(14)
    s_waitcnt lgkmcnt(0)
    s_sub_u32 s8, s8, s30
    s_cmpk_ge_u32 s8, 1799
    s_cbranch_scc1 .ap_191
    s_waitcnt vmcnt(11)
    s_cmpk_ge_u32 s8, 1699
    s_cbranch_scc1 .ap_191
    s_waitcnt vmcnt(10)
    s_bitcmp1_b64 s[14:15], 51
    s_cbranch_scc0 1
    s_waitcnt vmcnt(5)
    s_cmpk_ge_u32 s8, 1579
    s_cbranch_scc1 .ap_191
    s_waitcnt vmcnt(4)
.ap_191:
    s_add_u32 s63, s69, 286720
    buffer_load_dwordx4 v[236:239], v1, s[44:47], s63 offen nt
    s_memrealtime s[8:9]
    s_waitcnt vmcnt(14)
    s_waitcnt lgkmcnt(0)
    s_sub_u32 s8, s8, s30
    s_cmpk_ge_u32 s8, 1831
    s_cbranch_scc1 .ap_192
    s_waitcnt vmcnt(11)
    s_cmpk_ge_u32 s8, 1731
    s_cbranch_scc1 .ap_192
    s_waitcnt vmcnt(10)
    s_bitcmp1_b64 s[14:15], 52
    s_cbranch_scc0 1
    s_waitcnt vmcnt(5)
    s_cmpk_ge_u32 s8, 1611
    s_cbranch_scc1 .ap_192
    s_waitcnt vmcnt(1)
.ap_192:
    s_add_u32 s63, s69, 294912
    buffer_load_dwordx4 v[240:243], v1, s[44:47], s63 offen nt
    s_memrealtime s[8:9]
    s_waitcnt vmcnt(14)
    s_waitcnt lgkmcnt(0)
    s_sub_u32 s8, s8, s30
    s_cmpk_ge_u32 s8, 1863
    s_cbranch_scc1 .ap_193
    s_waitcnt vmcnt(11)
    s_cmpk_ge_u32 s8, 1763
    s_cbranch_scc1 .ap_193
    s_waitcnt vmcnt(7)
    s_bitcmp1_b64 s[14:15], 53
    s_cbranch_scc0 1
    s_waitcnt vmcnt(2)
    s_cmpk_ge_u32 s8, 1643
    s_cbranch_scc1 .ap_193
    s_waitcnt vmcnt(1)
.ap_193:
    s_add_u32 s63, s69, 303104
    buffer_load_dwordx4 v[244:247], v1, s[44:47], s63 offen nt
    buffer_load_dwordx4 v[24:27], v9, s[36:39], s59 offen offset:0 sc1
    s_memrealtime s[8:9]
    s_waitcnt vmcnt(14)
    s_waitcnt lgkmcnt(0)
    s_sub_u32 s8, s8, s30
    s_cmpk_ge_u32 s8, 1895
    s_cbranch_scc1 .ap_194
    s_waitcnt vmcnt(8)
    s_cmpk_ge_u32 s8, 1795
    s_cbranch_scc1 .ap_194
    s_waitcnt vmcnt(4)
    s_bitcmp1_b64 s[14:15], 54
    s_cbranch_scc0 1
    s_waitcnt vmcnt(2)
    s_cmpk_ge_u32 s8, 1675
    s_cbranch_scc1 .ap_194
    s_waitcnt vmcnt(1)
.ap_194:
    s_add_u32 s63, s69, 311296
    buffer_load_dwordx4 v[248:251], v1, s[44:47], s63 offen nt
    s_memrealtime s[8:9]
    s_waitcnt vmcnt(14)
    s_waitcnt lgkmcnt(0)
    s_sub_u32 s8, s8, s30
    s_cmpk_ge_u32 s8, 1927
    s_cbranch_scc1 .ap_195
    s_waitcnt vmcnt(5)
    s_cmpk_ge_u32 s8, 1827
    s_cbranch_scc1 .ap_195
    s_waitcnt vmcnt(4)
    s_bitcmp1_b64 s[14:15], 55
    s_cbranch_scc0 1
    s_waitcnt vmcnt(2)
    s_cmpk_ge_u32 s8, 1707
    s_cbranch_scc1 .ap_195
    s_waitcnt vmcnt(1)
.ap_195:
    s_add_u32 s63, s69, 319488
    buffer_load_dwordx4 v[252:255], v1, s[44:47], s63 offen nt
    s_memrealtime s[8:9]
    s_waitcnt vmcnt(11)
    s_waitcnt lgkmcnt(0)
    s_sub_u32 s8, s8, s30
    s_cmpk_ge_u32 s8, 1958
    s_cbranch_scc1 .ap_196
    s_waitcnt vmcnt(5)
    s_cmpk_ge_u32 s8, 1858
    s_cbranch_scc1 .ap_196
    s_waitcnt vmcnt(4)
    s_bitcmp1_b64 s[14:15], 56
    s_cbranch_scc0 1
    s_waitcnt vmcnt(2)
    s_cmpk_ge_u32 s8, 1738
    s_cbranch_scc1 .ap_196
    s_waitcnt vmcnt(1)
.ap_196:
    s_add_u32 s63, s69, 393216
    buffer_load_dwordx4 v[36:39], v1, s[44:47], s63 offen nt
    s_memrealtime s[8:9]
    s_waitcnt vmcnt(11)
    s_waitcnt lgkmcnt(0)
    s_sub_u32 s8, s8, s30
    s_cmpk_ge_u32 s8, 1990
    s_cbranch_scc1 .ap_197
    s_waitcnt vmcnt(5)
    s_cmpk_ge_u32 s8, 1890
    s_cbranch_scc1 .ap_197
    s_waitcnt vmcnt(4)
    s_bitcmp1_b64 s[14:15], 57
    s_cbranch_scc0 1
    s_waitcnt vmcnt(2)
    s_cmpk_ge_u32 s8, 1770
    s_cbranch_scc1 .ap_197
    s_waitcnt vmcnt(1)
.ap_197:
    s_add_u32 s63, s69, 401408
    buffer_load_dwordx4 v[44:47], v1, s[44:47], s63 offen nt
    s_memrealtime s[8:9]
    s_waitcnt vmcnt(8)
    s_waitcnt lgkmcnt(0)
    s_sub_u32 s8, s8, s30
    s_cmpk_ge_u32 s8, 2022
    s_cbranch_scc1 .ap_198
    s_waitcnt vmcnt(5)
    s_cmpk_ge_u32 s8, 1922
    s_cbranch_scc1 .ap_198
    s_waitcnt vmcnt(4)
    s_bitcmp1_b64 s[14:15], 58
    s_cbranch_scc0 1
    s_waitcnt vmcnt(2)
    s_cmpk_ge_u32 s8, 1802
    s_cbranch_scc1 .ap_198
    s_waitcnt vmcnt(1)
.ap_198:
    s_add_u32 s63, s69, 409600
    buffer_load_dwordx4 v[52:55], v1, s[44:47], s63 offen nt
    s_waitcnt vmcnt(5)
    s_branch .gpc_200
.gp_199:
    s_xor_b32 s59, s59, 0x800000
    buffer_load_dwordx4 v[24:27], v9, s[36:39], s59 offen offset:0 sc1
    s_waitcnt vmcnt(0)
.gpc_200:
    v_cmp_eq_u32 vcc, s34, v26
    s_cmp_eq_u64 vcc, -1
    s_nop 3
    s_cbranch_scc1 .gpd_201
    s_sub_u32 s35, s35, 1
    s_cbranch_scc1 .Lexit
    s_sleep 1
    s_branch .gp_199
.gpd_201:
    v_mov_b32 v16, v24
    s_nop 1
    v_max_f32_dpp v16, v16, v16 row_ror:4 row_mask:0xf bank_mask:0xf
    v_sub_f32 v17, v24, v16
    v_sub_f32 v18, v14, v16
    v_mul_f32 v17, 0x3fb8aa3b, v17
    v_mul_f32 v18, 0x3fb8aa3b, v18
    v_exp_f32 v17, v17
    v_exp_f32 v18, v18
    v_mul_f32 v17, v17, v25
    s_nop 1
    v_add_f32_dpp v17, v17, v17 row_ror:4 row_mask:0xf bank_mask:0xf
    v_rcp_f32 v19, v17
    s_nop 0
    v_fma_f32 v15, -v17, v19, 1.0
    v_fma_f32 v19, v15, v19, v19
    s_branch .Lsk_b1_4
.Lst_b1_4:
    s_branch .Lrt_b1_4
.Lsk_b1_4:
    v_mul_f32 v18, v18, v19
    v_mul_f32 v10, v10, v18
    v_mul_f32 v11, v11, v18
    v_mul_f32 v12, v12, v18
    v_mul_f32 v13, v13, v18
    v_mov_b32_dpp v112, v10 quad_perm:[2,3,0,1] row_mask:0xf bank_mask:0xf
    v_mov_b32_dpp v113, v11 quad_perm:[2,3,0,1] row_mask:0xf bank_mask:0xf
    v_mov_b32_dpp v114, v12 quad_perm:[2,3,0,1] row_mask:0xf bank_mask:0xf
    v_mov_b32_dpp v115, v13 quad_perm:[2,3,0,1] row_mask:0xf bank_mask:0xf
    v_cvt_pk_bf16_f32 v96, v10, v112
    v_cvt_pk_bf16_f32 v100, v11, v113
    v_cvt_pk_bf16_f32 v104, v12, v114
    v_cvt_pk_bf16_f32 v108, v13, v115
    v_mov_b32_dpp v97, v96 row_ror:12 row_mask:0xf bank_mask:0xf
    v_mov_b32_dpp v101, v100 row_ror:12 row_mask:0xf bank_mask:0xf
    v_mov_b32_dpp v105, v104 row_ror:12 row_mask:0xf bank_mask:0xf
    v_mov_b32_dpp v109, v108 row_ror:12 row_mask:0xf bank_mask:0xf
    v_mov_b32_dpp v98, v96 row_ror:8 row_mask:0xf bank_mask:0xf
    v_mov_b32_dpp v102, v100 row_ror:8 row_mask:0xf bank_mask:0xf
    v_mov_b32_dpp v106, v104 row_ror:8 row_mask:0xf bank_mask:0xf
    v_mov_b32_dpp v110, v108 row_ror:8 row_mask:0xf bank_mask:0xf
    v_mov_b32_dpp v99, v96 row_ror:4 row_mask:0xf bank_mask:0xf
    v_mov_b32_dpp v103, v100 row_ror:4 row_mask:0xf bank_mask:0xf
    v_mov_b32_dpp v107, v104 row_ror:4 row_mask:0xf bank_mask:0xf
    v_mov_b32_dpp v111, v108 row_ror:4 row_mask:0xf bank_mask:0xf
    s_lshl_b32 s60, s3, 10
    s_add_u32 s60, s60, 147456
    v_lshlrev_b32 v10, 5, v0
    v_add_u32 v10, s60, v10
    s_memrealtime s[8:9]
    s_waitcnt lgkmcnt(0)
    s_sub_u32 s8, s8, s30
    s_cmpk_ge_u32 s8, 2054
    s_cbranch_scc1 .ap_202
    s_waitcnt vmcnt(5)
    s_cmpk_ge_u32 s8, 1954
    s_cbranch_scc1 .ap_202
    s_waitcnt vmcnt(4)
    s_bitcmp1_b64 s[14:15], 59
    s_cbranch_scc0 1
    s_waitcnt vmcnt(2)
    s_cmpk_ge_u32 s8, 1834
    s_cbranch_scc1 .ap_202
    s_waitcnt vmcnt(1)
.ap_202:
    s_add_u32 s63, s69, 417792
    buffer_load_dwordx4 v[60:63], v1, s[44:47], s63 offen nt
    v_perm_b32 v112, v164, v160, s94
    v_perm_b32 v113, v172, v168, s94
    v_perm_b32 v114, v180, v176, s94
    v_perm_b32 v115, v188, v184, s94
    s_nop 1
    v_mfma_f32_16x16x32_bf16 v[128:131], v[96:99], v[112:115], 0
    v_perm_b32 v116, v164, v160, s95
    v_perm_b32 v117, v172, v168, s95
    v_perm_b32 v118, v180, v176, s95
    v_perm_b32 v119, v188, v184, s95
    s_nop 1
    v_mfma_f32_16x16x32_bf16 v[132:135], v[96:99], v[116:119], 0
    v_perm_b32 v120, v165, v161, s94
    v_perm_b32 v121, v173, v169, s94
    v_perm_b32 v122, v181, v177, s94
    v_perm_b32 v123, v189, v185, s94
    s_nop 1
    v_mfma_f32_16x16x32_bf16 v[136:139], v[96:99], v[120:123], 0
    v_perm_b32 v124, v165, v161, s95
    v_perm_b32 v125, v173, v169, s95
    v_perm_b32 v126, v181, v177, s95
    v_perm_b32 v127, v189, v185, s95
    s_nop 1
    v_mfma_f32_16x16x32_bf16 v[140:143], v[96:99], v[124:127], 0
    v_perm_b32 v112, v166, v162, s94
    v_perm_b32 v113, v174, v170, s94
    v_perm_b32 v114, v182, v178, s94
    v_perm_b32 v115, v190, v186, s94
    s_nop 1
    v_mfma_f32_16x16x32_bf16 v[144:147], v[96:99], v[112:115], 0
    v_perm_b32 v116, v166, v162, s95
    v_perm_b32 v117, v174, v170, s95
    v_perm_b32 v118, v182, v178, s95
    v_perm_b32 v119, v190, v186, s95
    s_nop 1
    v_mfma_f32_16x16x32_bf16 v[148:151], v[96:99], v[116:119], 0
    v_perm_b32 v120, v167, v163, s94
    v_perm_b32 v121, v175, v171, s94
    v_perm_b32 v122, v183, v179, s94
    v_perm_b32 v123, v191, v187, s94
    s_nop 1
    v_mfma_f32_16x16x32_bf16 v[152:155], v[96:99], v[120:123], 0
    v_perm_b32 v124, v167, v163, s95
    v_perm_b32 v125, v175, v171, s95
    v_perm_b32 v126, v183, v179, s95
    v_perm_b32 v127, v191, v187, s95
    s_nop 1
    v_mfma_f32_16x16x32_bf16 v[156:159], v[96:99], v[124:127], 0
    s_memrealtime s[8:9]
    s_waitcnt lgkmcnt(0)
    s_sub_u32 s8, s8, s30
    s_cmpk_ge_u32 s8, 2086
    s_nop 3
    s_cbranch_scc1 .ap_203
    s_waitcnt vmcnt(5)
    s_cmpk_ge_u32 s8, 1986
    s_cbranch_scc1 .ap_203
    s_waitcnt vmcnt(4)
    s_bitcmp1_b64 s[14:15], 60
    s_cbranch_scc0 1
    s_waitcnt vmcnt(2)
    s_cmpk_ge_u32 s8, 1866
    s_cbranch_scc1 .ap_203
    s_waitcnt vmcnt(1)
.ap_203:
    s_add_u32 s63, s69, 425984
    buffer_load_dwordx4 v[68:71], v1, s[44:47], s63 offen nt
    v_perm_b32 v112, v196, v192, s94
    v_perm_b32 v113, v204, v200, s94
    v_perm_b32 v114, v212, v208, s94
    v_perm_b32 v115, v220, v216, s94
    s_nop 1
    v_mfma_f32_16x16x32_bf16 v[128:131], v[100:103], v[112:115], v[128:131]
    v_perm_b32 v116, v196, v192, s95
    v_perm_b32 v117, v204, v200, s95
    v_perm_b32 v118, v212, v208, s95
    v_perm_b32 v119, v220, v216, s95
    s_nop 1
    v_mfma_f32_16x16x32_bf16 v[132:135], v[100:103], v[116:119], v[132:135]
    v_perm_b32 v120, v197, v193, s94
    v_perm_b32 v121, v205, v201, s94
    v_perm_b32 v122, v213, v209, s94
    v_perm_b32 v123, v221, v217, s94
    s_nop 1
    v_mfma_f32_16x16x32_bf16 v[136:139], v[100:103], v[120:123], v[136:139]
    v_perm_b32 v124, v197, v193, s95
    v_perm_b32 v125, v205, v201, s95
    v_perm_b32 v126, v213, v209, s95
    v_perm_b32 v127, v221, v217, s95
    s_nop 1
    v_mfma_f32_16x16x32_bf16 v[140:143], v[100:103], v[124:127], v[140:143]
    v_perm_b32 v112, v198, v194, s94
    v_perm_b32 v113, v206, v202, s94
    v_perm_b32 v114, v214, v210, s94
    v_perm_b32 v115, v222, v218, s94
    s_nop 1
    v_mfma_f32_16x16x32_bf16 v[144:147], v[100:103], v[112:115], v[144:147]
    v_perm_b32 v116, v198, v194, s95
    v_perm_b32 v117, v206, v202, s95
    v_perm_b32 v118, v214, v210, s95
    v_perm_b32 v119, v222, v218, s95
    s_nop 1
    v_mfma_f32_16x16x32_bf16 v[148:151], v[100:103], v[116:119], v[148:151]
    v_perm_b32 v120, v199, v195, s94
    v_perm_b32 v121, v207, v203, s94
    v_perm_b32 v122, v215, v211, s94
    v_perm_b32 v123, v223, v219, s94
    s_nop 1
    v_mfma_f32_16x16x32_bf16 v[152:155], v[100:103], v[120:123], v[152:155]
    v_perm_b32 v124, v199, v195, s95
    v_perm_b32 v125, v207, v203, s95
    v_perm_b32 v126, v215, v211, s95
    v_perm_b32 v127, v223, v219, s95
    s_nop 1
    v_mfma_f32_16x16x32_bf16 v[156:159], v[100:103], v[124:127], v[156:159]
    s_memrealtime s[8:9]
    s_waitcnt lgkmcnt(0)
    s_sub_u32 s8, s8, s30
    s_cmpk_ge_u32 s8, 2117
    s_nop 3
    s_cbranch_scc1 .ap_204
    s_branch .Lsk_b1_5
.Lst_b1_5:
    s_branch .Lrt_b1_5
.Lsk_b1_5:
    s_waitcnt vmcnt(5)
    s_cmpk_ge_u32 s8, 2017
    s_cbranch_scc1 .ap_204
    s_waitcnt vmcnt(4)
    s_bitcmp1_b64 s[14:15], 61
    s_cbranch_scc0 1
    s_waitcnt vmcnt(2)
    s_cmpk_ge_u32 s8, 1897
    s_cbranch_scc1 .ap_204
    s_waitcnt vmcnt(1)
.ap_204:
    s_add_u32 s63, s69, 434176
    buffer_load_dwordx4 v[76:79], v1, s[44:47], s63 offen nt
    s_waitcnt vmcnt(6)
    v_perm_b32 v112, v228, v224, s94
    v_perm_b32 v113, v236, v232, s94
    v_perm_b32 v114, v244, v240, s94
    v_perm_b32 v115, v252, v248, s94
    s_nop 1
    v_mfma_f32_16x16x32_bf16 v[128:131], v[104:107], v[112:115], v[128:131]
    v_perm_b32 v116, v228, v224, s95
    v_perm_b32 v117, v236, v232, s95
    v_perm_b32 v118, v244, v240, s95
    v_perm_b32 v119, v252, v248, s95
    s_nop 1
    v_mfma_f32_16x16x32_bf16 v[132:135], v[104:107], v[116:119], v[132:135]
    v_perm_b32 v120, v229, v225, s94
    v_perm_b32 v121, v237, v233, s94
    v_perm_b32 v122, v245, v241, s94
    v_perm_b32 v123, v253, v249, s94
    s_nop 1
    v_mfma_f32_16x16x32_bf16 v[136:139], v[104:107], v[120:123], v[136:139]
    v_perm_b32 v124, v229, v225, s95
    v_perm_b32 v125, v237, v233, s95
    v_perm_b32 v126, v245, v241, s95
    v_perm_b32 v127, v253, v249, s95
    s_nop 1
    v_mfma_f32_16x16x32_bf16 v[140:143], v[104:107], v[124:127], v[140:143]
    v_perm_b32 v112, v230, v226, s94
    v_perm_b32 v113, v238, v234, s94
    v_perm_b32 v114, v246, v242, s94
    v_perm_b32 v115, v254, v250, s94
    s_nop 1
    v_mfma_f32_16x16x32_bf16 v[144:147], v[104:107], v[112:115], v[144:147]
    v_perm_b32 v116, v230, v226, s95
    v_perm_b32 v117, v238, v234, s95
    v_perm_b32 v118, v246, v242, s95
    v_perm_b32 v119, v254, v250, s95
    s_nop 1
    v_mfma_f32_16x16x32_bf16 v[148:151], v[104:107], v[116:119], v[148:151]
    v_perm_b32 v120, v231, v227, s94
    v_perm_b32 v121, v239, v235, s94
    v_perm_b32 v122, v247, v243, s94
    v_perm_b32 v123, v255, v251, s94
    s_nop 1
    v_mfma_f32_16x16x32_bf16 v[152:155], v[104:107], v[120:123], v[152:155]
    v_perm_b32 v124, v231, v227, s95
    v_perm_b32 v125, v239, v235, s95
    v_perm_b32 v126, v247, v243, s95
    v_perm_b32 v127, v255, v251, s95
    s_nop 1
    v_mfma_f32_16x16x32_bf16 v[156:159], v[104:107], v[124:127], v[156:159]
    s_memrealtime s[8:9]
    s_waitcnt lgkmcnt(0)
    s_sub_u32 s8, s8, s30
    s_cmpk_ge_u32 s8, 2149
    s_nop 3
    s_cbranch_scc1 .ap_205
    s_waitcnt vmcnt(5)
    s_cmpk_ge_u32 s8, 2049
    s_cbranch_scc1 .ap_205
    s_waitcnt vmcnt(4)
    s_bitcmp1_b64 s[14:15], 62
    s_cbranch_scc0 1
    s_waitcnt vmcnt(2)
    s_cmpk_ge_u32 s8, 1929
    s_cbranch_scc1 .ap_205
    s_waitcnt vmcnt(1)
.ap_205:
    s_add_u32 s63, s69, 442368
    buffer_load_dwordx4 v[84:87], v1, s[44:47], s63 offen nt
    s_memrealtime s[8:9]
    s_waitcnt lgkmcnt(0)
    s_sub_u32 s8, s8, s30
    s_cmpk_ge_u32 s8, 2181
    s_cbranch_scc1 .ap_206
    s_waitcnt vmcnt(5)
    s_cmpk_ge_u32 s8, 2081
    s_cbranch_scc1 .ap_206
    s_waitcnt vmcnt(4)
    s_bitcmp1_b64 s[14:15], 63
    s_cbranch_scc0 1
    s_waitcnt vmcnt(2)
    s_cmpk_ge_u32 s8, 1961
    s_cbranch_scc1 .ap_206
    s_waitcnt vmcnt(1)
.ap_206:
    s_add_u32 s63, s69, 450560
    buffer_load_dwordx4 v[92:95], v1, s[44:47], s63 offen nt
    s_setprio 0
    s_waitcnt vmcnt(6)
    v_perm_b32 v160, v44, v36, s94
    v_perm_b32 v164, v44, v36, s95
    v_perm_b32 v168, v45, v37, s94
    v_perm_b32 v172, v45, v37, s95
    v_perm_b32 v176, v46, v38, s94
    v_perm_b32 v180, v46, v38, s95
    v_perm_b32 v184, v47, v39, s94
    v_perm_b32 v188, v47, v39, s95
    s_waitcnt vmcnt(4)
    v_perm_b32 v161, v60, v52, s94
    v_perm_b32 v165, v60, v52, s95
    v_perm_b32 v169, v61, v53, s94
    v_perm_b32 v173, v61, v53, s95
    v_perm_b32 v177, v62, v54, s94
    v_perm_b32 v181, v62, v54, s95
    v_perm_b32 v185, v63, v55, s94
    v_perm_b32 v189, v63, v55, s95
    s_waitcnt vmcnt(2)
    v_perm_b32 v162, v76, v68, s94
    v_perm_b32 v166, v76, v68, s95
    v_perm_b32 v170, v77, v69, s94
    v_perm_b32 v174, v77, v69, s95
    v_perm_b32 v178, v78, v70, s94
    v_perm_b32 v182, v78, v70, s95
    v_perm_b32 v186, v79, v71, s94
    v_perm_b32 v190, v79, v71, s95
    s_branch .Lsk_b1_6
    .fill 6, 4, 0xbf800000
.Lst_b1_6:
    s_branch .Lrt_b1_6
.Lsk_b1_6:
    s_waitcnt vmcnt(0)
    s_add_u32 m0, s101, 90112
    s_add_u32 s56, s100, 1179648
    buffer_load_dwordx4 v6, s[52:55], s56 offen nt lds
    s_add_u32 m0, s101, 98304
    s_add_u32 s56, s100, 1769472
    buffer_load_dwordx4 v6, s[52:55], s56 offen nt lds
    s_add_u32 m0, s101, 106496
    s_add_u32 s56, s100, 2359296
    buffer_load_dwordx4 v6, s[52:55], s56 offen nt lds
    s_add_u32 m0, s101, 114688
    s_add_u32 s56, s100, 2949120
    buffer_load_dwordx4 v6, s[52:55], s56 offen nt lds
    s_add_u32 m0, s101, 122880
    s_add_u32 s56, s100, 3538944
    buffer_load_dwordx4 v6, s[52:55], s56 offen nt lds
    v_perm_b32 v163, v92, v84, s94
    v_perm_b32 v167, v92, v84, s95
    v_perm_b32 v171, v93, v85, s94
    v_mfma_f32_16x16x32_bf16 v[128:131], v[108:111], v[160:163], v[128:131]
    v_perm_b32 v175, v93, v85, s95
    v_mfma_f32_16x16x32_bf16 v[132:135], v[108:111], v[164:167], v[132:135]
    v_perm_b32 v179, v94, v86, s94
    v_mfma_f32_16x16x32_bf16 v[136:139], v[108:111], v[168:171], v[136:139]
    v_perm_b32 v183, v94, v86, s95
    v_mfma_f32_16x16x32_bf16 v[140:143], v[108:111], v[172:175], v[140:143]
    v_perm_b32 v187, v95, v87, s94
    v_mfma_f32_16x16x32_bf16 v[144:147], v[108:111], v[176:179], v[144:147]
    v_perm_b32 v191, v95, v87, s95
    v_mfma_f32_16x16x32_bf16 v[148:151], v[108:111], v[180:183], v[148:151]
    v_mfma_f32_16x16x32_bf16 v[152:155], v[108:111], v[184:187], v[152:155]
    v_mfma_f32_16x16x32_bf16 v[156:159], v[108:111], v[188:191], v[156:159]
    s_mov_b64 exec, 0xffff
    ds_write2_b32 v10, v128, v129 offset0:0 offset1:128
    ds_write2_b32 v10, v132, v133 offset0:1 offset1:129
    ds_write2_b32 v10, v136, v137 offset0:2 offset1:130
    ds_write2_b32 v10, v140, v141 offset0:3 offset1:131
    ds_write2_b32 v10, v144, v145 offset0:4 offset1:132
    ds_write2_b32 v10, v148, v149 offset0:5 offset1:133
    ds_write2_b32 v10, v152, v153 offset0:6 offset1:134
    ds_write2_b32 v10, v156, v157 offset0:7 offset1:135
    s_mov_b64 exec, -1
    s_waitcnt lgkmcnt(0)
    s_barrier
    s_cmp_lg_u32 s3, 7
    s_cbranch_scc1 .opub_207
    v_add_u32 v10, 147456, v2
    ds_read_b128 v[196:199], v10 offset:0
    ds_read_b128 v[200:203], v10 offset:1024
    ds_read_b128 v[204:207], v10 offset:2048
    ds_read_b128 v[208:211], v10 offset:3072
    ds_read_b128 v[212:215], v10 offset:4096
    ds_read_b128 v[216:219], v10 offset:5120
    ds_read_b128 v[220:223], v10 offset:6144
    ds_read_b128 v[224:227], v10 offset:7168
    v_lshrrev_b32 v11, 5, v0
    v_lshlrev_b32 v11, 13, v11
    v_and_b32 v12, 31, v0
    v_lshl_add_u32 v11, v12, 4, v11
    s_lshl4_add_u32 s56, s67, s66
    s_lshl1_add_u32 s56, s56, s68
    s_lshl_b32 s56, s56, 9
    s_add_u32 s56, s56, 0xa0000
    s_mov_b32 s60, 0x07060503
    s_mov_b32 s61, 0x07060502
    s_mov_b32 s62, 0x07060501
    v_mov_b32 v15, s34
    s_waitcnt lgkmcnt(6)
    v_pk_add_f32 v[196:197], v[196:197], v[200:201]
    v_pk_add_f32 v[198:199], v[198:199], v[202:203]
    s_waitcnt lgkmcnt(5)
    v_pk_add_f32 v[196:197], v[196:197], v[204:205]
    v_pk_add_f32 v[198:199], v[198:199], v[206:207]
    s_waitcnt lgkmcnt(4)
    v_pk_add_f32 v[196:197], v[196:197], v[208:209]
    v_pk_add_f32 v[198:199], v[198:199], v[210:211]
    s_waitcnt lgkmcnt(3)
    v_pk_add_f32 v[196:197], v[196:197], v[212:213]
    v_pk_add_f32 v[198:199], v[198:199], v[214:215]
    s_waitcnt lgkmcnt(2)
    v_pk_add_f32 v[196:197], v[196:197], v[216:217]
    v_pk_add_f32 v[198:199], v[198:199], v[218:219]
    s_waitcnt lgkmcnt(1)
    v_pk_add_f32 v[196:197], v[196:197], v[220:221]
    v_pk_add_f32 v[198:199], v[198:199], v[222:223]
    s_waitcnt lgkmcnt(0)
    v_pk_add_f32 v[196:197], v[196:197], v[224:225]
    v_pk_add_f32 v[198:199], v[198:199], v[226:227]
    v_perm_b32 v12, v196, v199, s60
    v_perm_b32 v13, v197, v199, s61
    v_perm_b32 v14, v198, v199, s62
    s_add_u32 s57, s56, 0x800000
    buffer_store_dwordx4 v[12:15], v11, s[36:39], s57 offen
    s_cmp_lg_u32 s0, 0
    s_nop 0
    s_cbranch_scc1 .nosl_208
    buffer_store_dwordx4 v[12:15], v11, s[36:39], s56 offen sc1
.nosl_208:
.opub_207:
    s_mov_b32 s61, s101
    v_lshrrev_b32 v25, 4, v0
    v_bfe_u32 v26, v0, 1, 1
    v_lshl_add_u32 v25, v25, 1, v26
    v_bfe_u32 v26, v0, 2, 2
    v_lshl_add_u32 v19, v25, 3, v26
    v_lshlrev_b32 v19, 7, v19
    v_and_b32 v25, 3, v25
    v_lshrrev_b32 v26, 1, v26
    v_lshl_add_u32 v25, v25, 1, v26
    v_xor_b32 v25, s3, v25
    v_lshl_add_u32 v19, v25, 4, v19
    v_and_b32 v25, 1, v0
    v_lshl_add_u32 v19, v25, 3, v19
    v_add_u32 v20, 32768, v19
    ds_read_b64_tr_b16 v[160:161], v19 offset:0
    ds_read_b64_tr_b16 v[162:163], v19 offset:512
    ds_read_b64_tr_b16 v[168:169], v19 offset:8192
    ds_read_b64_tr_b16 v[170:171], v19 offset:8704
    ds_read_b64_tr_b16 v[176:177], v19 offset:16384
    ds_read_b64_tr_b16 v[178:179], v19 offset:16896
    ds_read_b64_tr_b16 v[184:185], v19 offset:24576
    ds_read_b64_tr_b16 v[186:187], v19 offset:25088
    ds_read_b64_tr_b16 v[192:193], v20 offset:0
    ds_read_b64_tr_b16 v[194:195], v20 offset:512
    ds_read_b64_tr_b16 v[200:201], v20 offset:8192
    ds_read_b64_tr_b16 v[202:203], v20 offset:8704
    ds_read_b64_tr_b16 v[208:209], v20 offset:16384
    ds_read_b64_tr_b16 v[210:211], v20 offset:16896
    ds_read_b64_tr_b16 v[216:217], v20 offset:24576
    ds_read_b64_tr_b16 v[218:219], v20 offset:25088
    ds_read_b64_tr_b16 v[224:225], v20 offset:32768
    ds_read_b64_tr_b16 v[226:227], v20 offset:33280
    v_add_u32 v19, 73728, v19
    v_add_u32 v20, 73728, v20
    s_mov_b32 s48, s22
    s_and_b32 s49, s23, 0xffff
    s_mov_b32 s50, 0x510000
    s_mov_b32 s51, 0x00020000
    s_mul_i32 s69, s99, 73728
    s_mul_i32 s56, s3, 9216
    s_add_u32 s69, s69, s56
    v_bfe_u32 v25, v0, 4, 1
    s_and_b32 s56, s3, 1
    s_lshl_b32 s56, s56, 2
    v_lshl_or_b32 v25, v25, 1, s56
    v_and_b32 v26, 7, v0
    v_xor_b32 v25, v25, v26
    v_lshrrev_b32 v26, 3, v0
    v_mul_u32_u24 v26, 1152, v26
    v_lshl_add_u32 v24, v25, 4, v26
    s_and_b32 s58, s64, 0
    s_mul_i32 s58, s58, 18432
    s_mul_i32 s59, s3, 2304
    s_add_u32 s58, s58, s59
    s_add_u32 s62, s58, 0x37000
    s_add_u32 s63, s58, 0x49000
    s_mul_i32 s101, s64, 18432
    s_add_u32 s101, s101, s59
    s_add_u32 s101, s101, 0x170000
    s_branch .Lsk_b1_7
.Lst_b1_7:
    s_branch .Lrt_b1_7
.Lsk_b1_7:
    s_waitcnt lgkmcnt(0)
    s_barrier
    s_add_u32 m0, s61, 131072
    s_add_u32 s56, s100, 4128768
    buffer_load_dwordx4 v6, s[52:55], s56 offen nt lds
    s_add_u32 m0, s61, 139264
    s_add_u32 s56, s100, 4718592
    buffer_load_dwordx4 v6, s[52:55], s56 offen nt lds
    s_add_u32 m0, s61, 0
    s_nop 0
    buffer_load_dwordx4 v24, s[48:51], s69 offen offset:0 nt lds
    s_add_u32 m0, s61, 8064
    s_nop 0
    buffer_load_dwordx4 v24, s[48:51], s69 offen offset:128 nt lds
    s_add_u32 m0, s61, 16128
    s_nop 0
    buffer_load_dwordx4 v24, s[48:51], s69 offen offset:256 nt lds
    s_add_u32 m0, s61, 24192
    s_nop 0
    buffer_load_dwordx4 v24, s[48:51], s69 offen offset:384 nt lds
    s_add_u32 m0, s61, 32256
    s_nop 0
    buffer_load_dwordx4 v24, s[48:51], s69 offen offset:512 nt lds
    s_add_u32 m0, s61, 40320
    s_nop 0
    buffer_load_dwordx4 v24, s[48:51], s69 offen offset:640 nt lds
    s_add_u32 m0, s61, 48384
    s_nop 0
    buffer_load_dwordx4 v24, s[48:51], s69 offen offset:768 nt lds
    s_add_u32 m0, s61, 56448
    s_nop 0
    buffer_load_dwordx4 v24, s[48:51], s69 offen offset:896 nt lds
    s_add_u32 m0, s61, 64512
    s_nop 0
    buffer_load_dwordx4 v24, s[48:51], s69 offen offset:1024 nt lds
    v_bfe_u32 v16, v0, 1, 3
    v_mul_u32_u24 v16, 1312, v16
    v_lshrrev_b32 v25, 4, v0
    v_lshl_add_u32 v16, v25, 5, v16
    v_and_b32 v25, 1, v0
    v_lshl_add_u32 v16, v25, 4, v16
    v_add_u32 v16, 147456, v16
    s_mul_i32 s56, s3, 1312
    s_add_u32 s56, s56, 147456
    v_add_u32 v17, s56, v3
    v_add_u32 v18, s56, v4
    v_bfe_u32 v21, v0, 1, 3
    v_mul_u32_u24 v21, 144, v21
    v_bfe_u32 v25, v0, 4, 1
    v_lshl_add_u32 v21, v25, 3, v21
    v_lshrrev_b32 v25, 5, v0
    v_lshl_add_u32 v21, v25, 2, v21
    v_and_b32 v25, 1, v0
    v_lshl_add_u32 v21, v25, 1, v21
    s_lshl_b32 s56, s3, 4
    s_add_u32 s56, s56, 157952
    v_add_u32 v21, s56, v21
    v_and_b32 v22, 15, v0
    v_lshlrev_b32 v22, 3, v22
    s_mul_i32 s56, s3, 144
    s_add_u32 s56, s56, 157952
    v_add_u32 v22, s56, v22
    s_mul_i32 s56, s3, 1312
    s_add_u32 s56, s56, 147456
    v_mov_b32 v17, s56
    v_bfe_u32 v25, v0, 4, 2
    v_lshl_add_u32 v17, v25, 7, v17
    v_bfe_u32 v25, v0, 1, 1
    v_lshl_add_u32 v17, v25, 6, v17
    v_bfe_u32 v25, v0, 3, 1
    v_lshl_add_u32 v17, v25, 5, v17
    v_bfe_u32 v25, v0, 2, 1
    v_lshl_add_u32 v17, v25, 3, v17
    v_bfe_u32 v25, v0, 0, 1
    v_lshl_add_u32 v17, v25, 2, v17
    s_add_u32 s56, s56, 1024
    v_mov_b32 v18, s56
    v_bfe_u32 v25, v0, 2, 1
    v_lshl_add_u32 v18, v25, 6, v18
    v_bfe_u32 v25, v0, 4, 1
    v_lshl_add_u32 v18, v25, 5, v18
    v_bfe_u32 v25, v0, 0, 1
    v_lshl_add_u32 v18, v25, 4, v18
    v_bfe_u32 v25, v0, 3, 1
    v_lshl_add_u32 v18, v25, 3, v18
    v_bfe_u32 v25, v0, 1, 1
    v_lshl_add_u32 v18, v25, 2, v18
    v_lshrrev_b32 v25, 3, v0
    v_mul_u32_u24 v21, 144, v25
    v_and_b32 v25, 7, v0
    v_lshl_add_u32 v21, v25, 1, v21
    s_lshl_b32 s56, s3, 4
    v_lshrrev_b32 v25, 3, v0
    v_mul_u32_u24 v26, 144, v25
    v_mov_b32 v21, v26
    v_bfe_u32 v25, v0, 1, 1
    v_lshl_add_u32 v21, v25, 4, v21
    v_bfe_u32 v25, v0, 2, 1
    v_lshl_add_u32 v21, v25, 2, v21
    v_bfe_u32 v25, v0, 0, 1
    v_lshl_add_u32 v21, v25, 1, v21
    s_and_b32 s57, s3, 1
    s_lshl_b32 s57, s57, 3
    s_sub_u32 s56, s56, s57
    s_add_u32 s56, s56, 157952
    v_add_u32 v21, s56, v21
    v_mov_b32 v156, 0x4444
    v_mov_b32 v25, 0xeeee
    v_cndmask_b32 v156, v156, v25, s[96:97]
    v_mov_b32 v152, 0
    v_mov_b32 v153, 0
    v_mov_b32 v154, 0
    v_mov_b32 v155, 0
    v_mov_b32 v232, 0
    v_mov_b32 v233, 0
    v_mov_b32 v234, 0
    v_mov_b32 v235, 0
    v_mov_b32 v236, 0
    v_mov_b32 v237, 0
    v_mov_b32 v238, 0
    v_mov_b32 v239, 0
    v_mov_b32 v240, 0
    v_mov_b32 v241, 0
    v_mov_b32 v242, 0
    v_mov_b32 v243, 0
    v_mov_b32 v244, 0
    v_mov_b32 v245, 0
    v_mov_b32 v246, 0
    v_mov_b32 v247, 0
    v_mov_b32 v248, 0
    v_mov_b32 v249, 0
    v_mov_b32 v250, 0
    v_mov_b32 v251, 0
    v_mov_b32 v252, 0
    v_mov_b32 v253, 0
    v_mov_b32 v254, 0
    v_mov_b32 v255, 0
    s_mov_b32 s56, 157952
    v_bfe_u32 v22, v0, 1, 3
    v_mul_u32_u24 v22, 144, v22
    v_and_b32 v25, 48, v0
    v_lshl_add_u32 v22, v25, 1, v22
    v_and_b32 v25, 1, v0
    v_lshlrev_b32 v25, 4, v25
    v_add3_u32 v22, v22, v25, s56
    v_lshrrev_b32 v23, 4, v0
    v_and_b32 v25, 1, v0
    v_lshl_add_u32 v23, v23, 1, v25
    v_mul_u32_u24 v23, 9216, v23
    v_bfe_u32 v25, v0, 1, 3
    v_lshl_add_u32 v23, v25, 4, v23
    v_lshrrev_b32 v25, 4, v0
    v_bfe_u32 v26, v0, 2, 2
    v_lshl_add_u32 v28, v25, 3, v26
    v_lshlrev_b32 v28, 7, v28
    v_and_b32 v25, 1, v25
    v_lshrrev_b32 v26, 1, v26
    v_lshl_add_u32 v25, v25, 1, v26
    s_and_b32 s56, s3, 1
    s_lshl_b32 s56, s56, 1
    v_xor_b32 v25, s56, v25
    v_and_b32 v26, 3, v0
    v_lshl_add_u32 v28, v26, 3, v28
    s_lshr_b32 s56, s3, 1
    s_lshl_b32 s56, s56, 13
    v_add_u32 v28, s56, v28
    v_xor_b32 v26, 1, v25
    v_lshl_add_u32 v29, v26, 5, v28
    v_lshl_add_u32 v28, v25, 5, v28
    v_add_u32 v30, 0x10000, v28
    v_add_u32 v31, 0x10000, v29
    s_mul_i32 s59, s3, 73728
    s_lshl_b32 s56, s99, 7
    s_branch .Lsk_b2_0
.Lst_b2_0:
    s_branch .Lrt_b2_0
.Lsk_b2_0:
    s_add_u32 s59, s59, s56
    s_add_u32 s59, s59, 0x1a0000
    s_add_u32 s99, s59, 589824
    s_add_u32 s100, s59, 1179648
    s_lshl4_add_u32 s6, s64, s65
    s_lshl4_add_u32 s6, s6, 0xca3f70
    s_branch .gpc_210
.gp_209:
    buffer_load_dwordx4 v[32:35], v2, s[36:39], s62 offen offset:0 sc1
    buffer_load_dwordx4 v[40:43], v2, s[36:39], s62 offen offset:1024 sc1
    buffer_load_dwordx2 v[48:49], v5, s[36:39], s62 offen offset:0 sc1
    buffer_load_dwordx4 v[56:59], v2, s[36:39], s63 offen offset:0 sc1
    buffer_load_dwordx4 v[64:67], v2, s[36:39], s63 offen offset:1024 sc1
    buffer_load_dwordx2 v[72:73], v5, s[36:39], s63 offen offset:0 sc1
    s_waitcnt vmcnt(0)
.gpc_210:
    v_min_u32 v25, v33, v35
    v_max_u32 v26, v33, v35
    v_min3_u32 v25, v25, v41, v43
    v_max3_u32 v26, v26, v41, v43
    v_min3_u32 v25, v25, v49, v57
    v_max3_u32 v26, v26, v49, v57
    v_min3_u32 v25, v25, v59, v65
    v_max3_u32 v26, v26, v59, v65
    v_min3_u32 v25, v25, v67, v73
    v_max3_u32 v26, v26, v67, v73
    v_cmp_eq_u32 vcc, s34, v25
    v_cmp_eq_u32 s[56:57], s34, v26
    s_and_b64 vcc, vcc, s[56:57]
    s_cmp_eq_u64 vcc, -1
    s_nop 2
    s_cbranch_scc1 .gpd_211
    s_sub_u32 s35, s35, 1
    s_cbranch_scc1 .Lexit
    s_sleep 2
    s_branch .gp_209
.gpd_211:
    v_lshlrev_b32 v78, 16, v32
    v_and_b32 v79, 0xffff0000, v32
    v_lshlrev_b32 v88, 16, v56
    v_and_b32 v89, 0xffff0000, v56
    v_lshlrev_b32 v80, 16, v34
    v_and_b32 v81, 0xffff0000, v34
    v_lshlrev_b32 v90, 16, v58
    v_and_b32 v91, 0xffff0000, v58
    v_lshlrev_b32 v82, 16, v40
    v_and_b32 v83, 0xffff0000, v40
    v_lshlrev_b32 v92, 16, v64
    v_and_b32 v93, 0xffff0000, v64
    v_lshlrev_b32 v84, 16, v42
    v_and_b32 v85, 0xffff0000, v42
    v_lshlrev_b32 v94, 16, v66
    v_and_b32 v95, 0xffff0000, v66
    v_lshlrev_b32 v86, 16, v48
    v_and_b32 v87, 0xffff0000, v48
    v_lshlrev_b32 v96, 16, v72
    v_and_b32 v97, 0xffff0000, v72
    s_waitcnt vmcnt(9)
    s_barrier
    ds_read_b64_tr_b16 v[164:165], v19 offset:0
    ds_read_b64_tr_b16 v[166:167], v19 offset:512
    ds_read_b64_tr_b16 v[172:173], v19 offset:8192
    ds_read_b64_tr_b16 v[174:175], v19 offset:8704
    ds_read_b64_tr_b16 v[180:181], v19 offset:16384
    ds_read_b64_tr_b16 v[182:183], v19 offset:16896
    ds_read_b64_tr_b16 v[188:189], v19 offset:24576
    ds_read_b64_tr_b16 v[190:191], v19 offset:25088
    ds_read_b64_tr_b16 v[196:197], v20 offset:0
    ds_read_b64_tr_b16 v[198:199], v20 offset:512
    ds_read_b64_tr_b16 v[204:205], v20 offset:8192
    ds_read_b64_tr_b16 v[206:207], v20 offset:8704
    ds_read_b64_tr_b16 v[212:213], v20 offset:16384
    ds_read_b64_tr_b16 v[214:215], v20 offset:16896
    ds_read_b64_tr_b16 v[220:221], v20 offset:24576
    ds_read_b64_tr_b16 v[222:223], v20 offset:25088
    ds_read_b64_tr_b16 v[228:229], v20 offset:32768
    ds_read_b64_tr_b16 v[230:231], v20 offset:33280
    s_waitcnt lgkmcnt(0)
    v_mov_b32 v8, v160
    v_mov_b32 v9, v161
    v_mov_b32 v10, v162
    v_mov_b32 v11, v163
    v_mov_b32_dpp v160, v164 row_ror:8 row_mask:0xf bank_mask:0xc
    v_mov_b32_dpp v161, v165 row_ror:8 row_mask:0xf bank_mask:0xc
    v_mov_b32_dpp v162, v166 row_ror:8 row_mask:0xf bank_mask:0xc
    v_mov_b32_dpp v163, v167 row_ror:8 row_mask:0xf bank_mask:0xc
    v_mov_b32_dpp v164, v8 row_ror:8 row_mask:0xf bank_mask:0x3
    v_mov_b32_dpp v165, v9 row_ror:8 row_mask:0xf bank_mask:0x3
    v_mov_b32_dpp v166, v10 row_ror:8 row_mask:0xf bank_mask:0x3
    v_mov_b32_dpp v167, v11 row_ror:8 row_mask:0xf bank_mask:0x3
    v_mov_b32 v8, v168
    v_mov_b32 v9, v169
    v_mov_b32 v10, v170
    v_mov_b32 v11, v171
    v_mov_b32_dpp v168, v172 row_ror:8 row_mask:0xf bank_mask:0xc
    v_mov_b32_dpp v169, v173 row_ror:8 row_mask:0xf bank_mask:0xc
    v_mov_b32_dpp v170, v174 row_ror:8 row_mask:0xf bank_mask:0xc
    v_mov_b32_dpp v171, v175 row_ror:8 row_mask:0xf bank_mask:0xc
    v_mov_b32_dpp v172, v8 row_ror:8 row_mask:0xf bank_mask:0x3
    v_mov_b32_dpp v173, v9 row_ror:8 row_mask:0xf bank_mask:0x3
    v_mov_b32_dpp v174, v10 row_ror:8 row_mask:0xf bank_mask:0x3
    v_mov_b32_dpp v175, v11 row_ror:8 row_mask:0xf bank_mask:0x3
    v_mov_b32 v8, v176
    v_mov_b32 v9, v177
    v_mov_b32 v10, v178
    v_mov_b32 v11, v179
    v_mov_b32_dpp v176, v180 row_ror:8 row_mask:0xf bank_mask:0xc
    v_mov_b32_dpp v177, v181 row_ror:8 row_mask:0xf bank_mask:0xc
    v_mov_b32_dpp v178, v182 row_ror:8 row_mask:0xf bank_mask:0xc
    v_mov_b32_dpp v179, v183 row_ror:8 row_mask:0xf bank_mask:0xc
    v_mov_b32_dpp v180, v8 row_ror:8 row_mask:0xf bank_mask:0x3
    v_mov_b32_dpp v181, v9 row_ror:8 row_mask:0xf bank_mask:0x3
    v_mov_b32_dpp v182, v10 row_ror:8 row_mask:0xf bank_mask:0x3
    v_mov_b32_dpp v183, v11 row_ror:8 row_mask:0xf bank_mask:0x3
    v_mov_b32 v8, v184
    v_mov_b32 v9, v185
    v_mov_b32 v10, v186
    v_mov_b32 v11, v187
    v_mov_b32_dpp v184, v188 row_ror:8 row_mask:0xf bank_mask:0xc
    v_mov_b32_dpp v185, v189 row_ror:8 row_mask:0xf bank_mask:0xc
    v_mov_b32_dpp v186, v190 row_ror:8 row_mask:0xf bank_mask:0xc
    v_mov_b32_dpp v187, v191 row_ror:8 row_mask:0xf bank_mask:0xc
    v_mov_b32_dpp v188, v8 row_ror:8 row_mask:0xf bank_mask:0x3
    v_mov_b32_dpp v189, v9 row_ror:8 row_mask:0xf bank_mask:0x3
    v_mov_b32_dpp v190, v10 row_ror:8 row_mask:0xf bank_mask:0x3
    v_mov_b32_dpp v191, v11 row_ror:8 row_mask:0xf bank_mask:0x3
    v_mov_b32 v8, v192
    v_mov_b32 v9, v193
    v_mov_b32 v10, v194
    v_mov_b32 v11, v195
    v_mov_b32_dpp v192, v196 row_ror:8 row_mask:0xf bank_mask:0xc
    v_mov_b32_dpp v193, v197 row_ror:8 row_mask:0xf bank_mask:0xc
    v_mov_b32_dpp v194, v198 row_ror:8 row_mask:0xf bank_mask:0xc
    v_mov_b32_dpp v195, v199 row_ror:8 row_mask:0xf bank_mask:0xc
    v_mov_b32_dpp v196, v8 row_ror:8 row_mask:0xf bank_mask:0x3
    v_mov_b32_dpp v197, v9 row_ror:8 row_mask:0xf bank_mask:0x3
    v_mov_b32_dpp v198, v10 row_ror:8 row_mask:0xf bank_mask:0x3
    v_mov_b32_dpp v199, v11 row_ror:8 row_mask:0xf bank_mask:0x3
    v_mov_b32 v8, v200
    v_mov_b32 v9, v201
    v_mov_b32 v10, v202
    v_mov_b32 v11, v203
    v_mov_b32_dpp v200, v204 row_ror:8 row_mask:0xf bank_mask:0xc
    v_mov_b32_dpp v201, v205 row_ror:8 row_mask:0xf bank_mask:0xc
    v_mov_b32_dpp v202, v206 row_ror:8 row_mask:0xf bank_mask:0xc
    v_mov_b32_dpp v203, v207 row_ror:8 row_mask:0xf bank_mask:0xc
    v_mov_b32_dpp v204, v8 row_ror:8 row_mask:0xf bank_mask:0x3
    v_mov_b32_dpp v205, v9 row_ror:8 row_mask:0xf bank_mask:0x3
    v_mov_b32_dpp v206, v10 row_ror:8 row_mask:0xf bank_mask:0x3
    v_mov_b32_dpp v207, v11 row_ror:8 row_mask:0xf bank_mask:0x3
    v_mov_b32 v8, v208
    v_mov_b32 v9, v209
    v_mov_b32 v10, v210
    v_mov_b32 v11, v211
    v_mov_b32_dpp v208, v212 row_ror:8 row_mask:0xf bank_mask:0xc
    v_mov_b32_dpp v209, v213 row_ror:8 row_mask:0xf bank_mask:0xc
    v_mov_b32_dpp v210, v214 row_ror:8 row_mask:0xf bank_mask:0xc
    v_mov_b32_dpp v211, v215 row_ror:8 row_mask:0xf bank_mask:0xc
    v_mov_b32_dpp v212, v8 row_ror:8 row_mask:0xf bank_mask:0x3
    v_mov_b32_dpp v213, v9 row_ror:8 row_mask:0xf bank_mask:0x3
    v_mov_b32_dpp v214, v10 row_ror:8 row_mask:0xf bank_mask:0x3
    v_mov_b32_dpp v215, v11 row_ror:8 row_mask:0xf bank_mask:0x3
    v_mov_b32 v8, v216
    v_mov_b32 v9, v217
    v_mov_b32 v10, v218
    v_mov_b32 v11, v219
    v_mov_b32_dpp v216, v220 row_ror:8 row_mask:0xf bank_mask:0xc
    v_mov_b32_dpp v217, v221 row_ror:8 row_mask:0xf bank_mask:0xc
    s_branch .Lsk_b2_1
.Lst_b2_1:
    s_branch .Lrt_b2_1
.Lsk_b2_1:
    v_mov_b32_dpp v218, v222 row_ror:8 row_mask:0xf bank_mask:0xc
    v_mov_b32_dpp v219, v223 row_ror:8 row_mask:0xf bank_mask:0xc
    v_mov_b32_dpp v220, v8 row_ror:8 row_mask:0xf bank_mask:0x3
    v_mov_b32_dpp v221, v9 row_ror:8 row_mask:0xf bank_mask:0x3
    v_mov_b32_dpp v222, v10 row_ror:8 row_mask:0xf bank_mask:0x3
    v_mov_b32_dpp v223, v11 row_ror:8 row_mask:0xf bank_mask:0x3
    v_mov_b32 v8, v224
    v_mov_b32 v9, v225
    v_mov_b32 v10, v226
    v_mov_b32 v11, v227
    v_mov_b32_dpp v224, v228 row_ror:8 row_mask:0xf bank_mask:0xc
    v_mov_b32_dpp v225, v229 row_ror:8 row_mask:0xf bank_mask:0xc
    v_mov_b32_dpp v226, v230 row_ror:8 row_mask:0xf bank_mask:0xc
    v_mov_b32_dpp v227, v231 row_ror:8 row_mask:0xf bank_mask:0xc
    v_mov_b32_dpp v228, v8 row_ror:8 row_mask:0xf bank_mask:0x3
    v_mov_b32_dpp v229, v9 row_ror:8 row_mask:0xf bank_mask:0x3
    v_mov_b32_dpp v230, v10 row_ror:8 row_mask:0xf bank_mask:0x3
    v_mov_b32_dpp v231, v11 row_ror:8 row_mask:0xf bank_mask:0x3
    s_waitcnt vmcnt(0)
    s_barrier
    ds_read_b64_tr_b16 v[104:105], v28 offset:0
    ds_read_b64_tr_b16 v[106:107], v28 offset:512
    ds_read_b64_tr_b16 v[112:113], v29 offset:0
    ds_read_b64_tr_b16 v[114:115], v29 offset:512
    ds_read_b64_tr_b16 v[108:109], v28 offset:4096
    ds_read_b64_tr_b16 v[110:111], v28 offset:4608
    ds_read_b64_tr_b16 v[116:117], v29 offset:4096
    ds_read_b64_tr_b16 v[118:119], v29 offset:4608
    ds_read_b64_tr_b16 v[120:121], v28 offset:32768
    ds_read_b64_tr_b16 v[122:123], v28 offset:33280
    ds_read_b64_tr_b16 v[128:129], v29 offset:32768
    ds_read_b64_tr_b16 v[130:131], v29 offset:33280
    ds_read_b64_tr_b16 v[124:125], v28 offset:36864
    ds_read_b64_tr_b16 v[126:127], v28 offset:37376
    ds_read_b64_tr_b16 v[132:133], v29 offset:36864
    ds_read_b64_tr_b16 v[134:135], v29 offset:37376
    s_cmp_ge_u32 s3, 2
    s_cbranch_scc1 .Lbc_nodn3
    ds_read_b64_tr_b16 v[136:137], v30 offset:0
    ds_read_b64_tr_b16 v[138:139], v30 offset:512
    ds_read_b64_tr_b16 v[144:145], v31 offset:0
    ds_read_b64_tr_b16 v[146:147], v31 offset:512
    ds_read_b64_tr_b16 v[140:141], v30 offset:4096
    ds_read_b64_tr_b16 v[142:143], v30 offset:4608
    ds_read_b64_tr_b16 v[148:149], v31 offset:4096
    ds_read_b64_tr_b16 v[150:151], v31 offset:4608
.Lbc_nodn3:
    s_branch .Lsk_b2_2
    .fill 122, 4, 0xbf800000
.Lst_b2_2:
    s_branch .Lrt_b2_2
.Lsk_b2_2:
    s_mov_b32 s69, 0
.gp_212:
    s_add_u32 s69, s69, 1
    s_and_b32 s56, s69, 0x41
    s_cmp_lg_u32 s56, 0x41
    s_cselect_b32 s56, 0, 0x800000
    s_xor_b32 s56, s56, s0
    s_add_u32 s58, s101, s56
    buffer_load_dwordx4 v[68:71], v2, s[36:39], s58 offen offset:0 sc1
    buffer_load_dwordx4 v[72:75], v2, s[36:39], s58 offen offset:1024 sc1
    buffer_load_dwordx2 v[76:77], v5, s[36:39], s58 offen offset:0 sc1
    s_waitcnt vmcnt(0)
    v_min3_u32 v25, v69, v71, v73
    v_max3_u32 v26, v69, v71, v73
    v_min3_u32 v25, v25, v75, v77
    v_max3_u32 v26, v26, v75, v77
    v_cmp_eq_u32 vcc, s34, v25
    v_cmp_eq_u32 s[56:57], s34, v26
    s_and_b64 vcc, vcc, s[56:57]
    s_cmp_eq_u64 vcc, -1
    s_nop 2
    s_cbranch_scc1 .gpd_213
    s_sub_u32 s35, s35, 1
    s_cbranch_scc1 .Lexit
    s_branch .gp_212
.gpd_213:
    s_mov_b32 s56, 0x3f803f80
    v_dot2_f32_bf16 v98, v68, s56, 0
    v_dot2_f32_bf16 v99, v68, v68, 0
    v_dot2_f32_bf16 v98, v70, s56, v98
    v_dot2_f32_bf16 v99, v70, v70, v99
    v_dot2_f32_bf16 v98, v72, s56, v98
    v_dot2_f32_bf16 v99, v72, v72, v99
    v_dot2_f32_bf16 v98, v74, s56, v98
    v_dot2_f32_bf16 v99, v74, v74, v99
    s_mov_b64 exec, 0xffffffff
    v_dot2_f32_bf16 v98, v76, s56, v98
    v_dot2_f32_bf16 v99, v76, v76, v99
    s_mov_b64 exec, -1
    s_nop 1
    v_permlane32_swap_b32 v98, v99
    v_add_f32 v98, v98, v99
    v_mov_b32 v100, v98
    s_nop 1
    v_permlane16_swap_b32 v100, v98
    v_add_f32 v98, v100, v98
    v_and_b32 v69, 0xffff0000, v68
    v_lshlrev_b32 v68, 16, v68
    v_add_f32_dpp v98, v98, v98 row_ror:8 row_mask:0xf bank_mask:0xf
    v_and_b32 v71, 0xffff0000, v70
    v_lshlrev_b32 v70, 16, v70
    v_add_f32_dpp v98, v98, v98 row_ror:4 row_mask:0xf bank_mask:0xf
    v_and_b32 v73, 0xffff0000, v72
    v_lshlrev_b32 v72, 16, v72
    v_add_f32_dpp v98, v98, v98 quad_perm:[2,3,0,1] row_mask:0xf bank_mask:0xf
    v_and_b32 v75, 0xffff0000, v74
    v_lshlrev_b32 v74, 16, v74
    v_add_f32_dpp v98, v98, v98 quad_perm:[1,0,3,2] row_mask:0xf bank_mask:0xf
    v_mul_f32 v98, 0x3ae38e39, v98
    v_and_b32 v77, 0xffff0000, v76
    v_lshlrev_b32 v76, 16, v76
    v_readlane_b32 s56, v98, 0
    v_readlane_b32 s57, v98, 32
    s_nop 0
    v_mov_b32 v98, s56
    v_fma_f32 v99, -v98, v98, s57
    v_max_f32 v99, 0, v99
    v_cvt_pk_bf16_f32 v100, -v98, v99
    v_and_b32 v101, 0xffff0000, v100
    v_add_f32 v101, 0x3727c5ac, v101
    v_lshlrev_b32 v98, 16, v100
    v_cvt_pk_bf16_f32 v101, v101, v101
    v_lshlrev_b32 v101, 16, v101
    v_sqrt_f32 v101, v101
    v_mov_b32 v99, v98
    v_cvt_pk_bf16_f32 v101, v101, v101
    v_lshlrev_b32 v101, 16, v101
    v_rcp_f32 v100, v101
    v_rcp_f32 v101, v101
    v_pk_add_f32 v[68:69], v[68:69], v[98:99]
    v_pk_add_f32 v[70:71], v[70:71], v[98:99]
    v_pk_add_f32 v[72:73], v[72:73], v[98:99]
    v_pk_add_f32 v[74:75], v[74:75], v[98:99]
    v_pk_add_f32 v[76:77], v[76:77], v[98:99]
    v_cvt_pk_bf16_f32 v68, v68, v69
    v_and_b32 v69, 0xffff0000, v68
    v_lshlrev_b32 v68, 16, v68
    v_cvt_pk_bf16_f32 v70, v70, v71
    v_and_b32 v71, 0xffff0000, v70
    v_lshlrev_b32 v70, 16, v70
    v_cvt_pk_bf16_f32 v72, v72, v73
    v_and_b32 v73, 0xffff0000, v72
    v_lshlrev_b32 v72, 16, v72
    v_cvt_pk_bf16_f32 v74, v74, v75
    v_and_b32 v75, 0xffff0000, v74
    v_lshlrev_b32 v74, 16, v74
    v_cvt_pk_bf16_f32 v76, v76, v77
    v_and_b32 v77, 0xffff0000, v76
    v_lshlrev_b32 v76, 16, v76
    v_pk_mul_f32 v[68:69], v[68:69], v[100:101]
    v_pk_mul_f32 v[70:71], v[70:71], v[100:101]
    v_pk_mul_f32 v[72:73], v[72:73], v[100:101]
    v_pk_mul_f32 v[74:75], v[74:75], v[100:101]
    v_pk_mul_f32 v[76:77], v[76:77], v[100:101]
    v_cvt_pk_bf16_f32 v68, v68, v69
    v_and_b32 v69, 0xffff0000, v68
    v_lshlrev_b32 v68, 16, v68
    v_cvt_pk_bf16_f32 v70, v70, v71
    v_and_b32 v71, 0xffff0000, v70
    v_lshlrev_b32 v70, 16, v70
    v_cvt_pk_bf16_f32 v72, v72, v73
    v_and_b32 v73, 0xffff0000, v72
    v_lshlrev_b32 v72, 16, v72
    v_cvt_pk_bf16_f32 v74, v74, v75
    v_and_b32 v75, 0xffff0000, v74
    v_lshlrev_b32 v74, 16, v74
    v_cvt_pk_bf16_f32 v76, v76, v77
    v_and_b32 v77, 0xffff0000, v76
    v_lshlrev_b32 v76, 16, v76
    v_pk_mul_f32 v[68:69], v[68:69], v[88:89]
    v_pk_mul_f32 v[70:71], v[70:71], v[90:91]
    v_pk_mul_f32 v[72:73], v[72:73], v[92:93]
    v_pk_mul_f32 v[74:75], v[74:75], v[94:95]
    v_pk_mul_f32 v[76:77], v[76:77], v[96:97]
    v_cvt_pk_bf16_f32 v68, v68, v69
    v_and_b32 v69, 0xffff0000, v68
    v_lshlrev_b32 v68, 16, v68
    v_cvt_pk_bf16_f32 v70, v70, v71
    v_and_b32 v71, 0xffff0000, v70
    v_lshlrev_b32 v70, 16, v70
    v_cvt_pk_bf16_f32 v72, v72, v73
    v_and_b32 v73, 0xffff0000, v72
    v_lshlrev_b32 v72, 16, v72
    v_cvt_pk_bf16_f32 v74, v74, v75
    v_and_b32 v75, 0xffff0000, v74
    v_lshlrev_b32 v74, 16, v74
    v_cvt_pk_bf16_f32 v76, v76, v77
    v_and_b32 v77, 0xffff0000, v76
    v_lshlrev_b32 v76, 16, v76
    v_pk_add_f32 v[68:69], v[68:69], v[78:79]
    v_pk_add_f32 v[70:71], v[70:71], v[80:81]
    v_pk_add_f32 v[72:73], v[72:73], v[82:83]
    v_pk_add_f32 v[74:75], v[74:75], v[84:85]
    v_pk_add_f32 v[76:77], v[76:77], v[86:87]
    v_cvt_pk_bf16_f32 v8, v68, v69
    v_cvt_pk_bf16_f32 v9, v70, v71
    v_cvt_pk_bf16_f32 v10, v72, v73
    v_cvt_pk_bf16_f32 v11, v74, v75
    v_cvt_pk_bf16_f32 v12, v76, v77
    ds_write2_b32 v17, v8, v9 offset0:0 offset1:4
    ds_write2_b32 v17, v10, v11 offset0:128 offset1:132
    ds_write_b32 v18, v12
    s_branch .Lsk_b2_3
    .fill 21, 4, 0xbf800000
.Lst_b2_3:
    s_branch .Lrt_b2_3
.Lsk_b2_3:
    s_waitcnt lgkmcnt(0)
    s_barrier
    ds_read_b128 v[32:35], v16 offset:0
    ds_read_b128 v[36:39], v16 offset:128
    ds_read_b128 v[40:43], v16 offset:256
    ds_read_b128 v[44:47], v16 offset:384
    ds_read_b128 v[48:51], v16 offset:512
    ds_read_b128 v[52:55], v16 offset:640
    ds_read_b128 v[56:59], v16 offset:768
    ds_read_b128 v[60:63], v16 offset:896
    ds_read_b128 v[64:67], v16 offset:1024
    s_waitcnt lgkmcnt(8)
    v_smfmac_f32_16x16x64_bf16 v[152:155], v[32:35], v[160:167], v156
    s_waitcnt lgkmcnt(7)
    v_smfmac_f32_16x16x64_bf16 v[152:155], v[36:39], v[168:175], v156
    s_waitcnt lgkmcnt(6)
    v_smfmac_f32_16x16x64_bf16 v[152:155], v[40:43], v[176:183], v156
    s_waitcnt lgkmcnt(5)
    v_smfmac_f32_16x16x64_bf16 v[152:155], v[44:47], v[184:191], v156
    s_waitcnt lgkmcnt(4)
    v_smfmac_f32_16x16x64_bf16 v[152:155], v[48:51], v[192:199], v156
    s_waitcnt lgkmcnt(3)
    v_smfmac_f32_16x16x64_bf16 v[152:155], v[52:55], v[200:207], v156
    s_waitcnt lgkmcnt(2)
    v_smfmac_f32_16x16x64_bf16 v[152:155], v[56:59], v[208:215], v156
    s_waitcnt lgkmcnt(1)
    v_smfmac_f32_16x16x64_bf16 v[152:155], v[60:63], v[216:223], v156
    s_waitcnt lgkmcnt(0)
    v_smfmac_f32_16x16x64_bf16 v[152:155], v[64:67], v[224:231], v156
    s_nop 7
    v_add_f32 v12, v152, v153
    v_add_f32 v13, v154, v155
    v_cvt_pk_bf16_f32 v13, v12, v13
    v_lshlrev_b32 v12, 16, v13
    v_and_b32 v14, 0xffff0000, v13
    v_mov_b32 v13, v14
    s_nop 0
    v_mov_b32_dpp v14, v12 row_ror:8 row_mask:0xf bank_mask:0x3
    v_mov_b32_dpp v12, v13 row_ror:8 row_mask:0xf bank_mask:0xc
    v_max_f32 v12, 0xc2ae0000, v12
    v_min_f32 v27, 0x43000000, v12
    v_mul_f32 v25, 0xbfb8aa3b, v27
    v_fma_f32 v26, v27, s98, -v25
    v_fmac_f32 v26, 0xb2a57060, v27
    v_exp_f32 v25, v25
    v_mul_f32 v26, 0x3f317218, v26
    v_fmac_f32 v25, v25, v26
    v_add_f32 v25, 1.0, v25
    v_rcp_f32 v26, v25
    s_nop 0
    v_mul_f32 v27, v12, v26
    v_fma_f32 v25, -v27, v25, v12
    v_fma_f32 v12, v25, v26, v27
    v_cvt_pk_bf16_f32 v12, v12, v12
    v_lshlrev_b32 v12, 16, v12
    v_mul_f32 v12, v12, v14
    v_cvt_pk_bf16_f32 v12, v12, v12
    ds_write_b16 v21, v12
    s_mov_b32 s60, 0x07060503
    s_mov_b32 s61, 0x07060502
    s_mov_b32 s62, 0x07060501
    s_mov_b32 vcc_lo, 0x55555555
    s_mov_b32 vcc_hi, 0x55555555
    v_mov_b32 v59, s34
    v_mov_b32 v63, s34
    v_mov_b32 v67, s34
    s_cmp_ge_u32 s3, 2
    s_waitcnt lgkmcnt(0)
    s_barrier
    ds_read_b128 v[8:11], v22
    s_waitcnt lgkmcnt(0)
    v_smfmac_f32_16x16x64_bf16 v[232:235], v[8:11], v[104:111], v156
    v_smfmac_f32_16x16x64_bf16 v[236:239], v[8:11], v[112:119], v156
    v_smfmac_f32_16x16x64_bf16 v[240:243], v[8:11], v[120:127], v156
    v_smfmac_f32_16x16x64_bf16 v[244:247], v[8:11], v[128:135], v156
    s_cbranch_scc0 .Lbc_three
    s_nop 4
    v_add_f32 v232, v232, v233
    v_add_f32 v234, v234, v235
    v_add_f32 v236, v236, v237
    v_add_f32 v238, v238, v239
    s_not_b64 vcc, vcc
    v_cndmask_b32_dpp v233, v232, v234, vcc quad_perm:[1,0,3,2] row_mask:0xf bank_mask:0xf
    v_cndmask_b32_dpp v235, v236, v238, vcc quad_perm:[1,0,3,2] row_mask:0xf bank_mask:0xf
    s_not_b64 vcc, vcc
    v_cndmask_b32_dpp v232, v234, v232, vcc quad_perm:[1,0,3,2] row_mask:0xf bank_mask:0xf
    v_cndmask_b32_dpp v234, v238, v236, vcc quad_perm:[1,0,3,2] row_mask:0xf bank_mask:0xf
    v_perm_b32 v56, v232, v235, s60
    v_perm_b32 v57, v233, v235, s61
    v_perm_b32 v58, v234, v235, s62
    buffer_store_dwordx4 v[56:59], v23, s[36:39], s59 offen sc1
    v_add_f32 v240, v240, v241
    v_add_f32 v242, v242, v243
    v_add_f32 v244, v244, v245
    v_add_f32 v246, v246, v247
    s_not_b64 vcc, vcc
    v_cndmask_b32_dpp v241, v240, v242, vcc quad_perm:[1,0,3,2] row_mask:0xf bank_mask:0xf
    v_cndmask_b32_dpp v243, v244, v246, vcc quad_perm:[1,0,3,2] row_mask:0xf bank_mask:0xf
    s_not_b64 vcc, vcc
    v_cndmask_b32_dpp v240, v242, v240, vcc quad_perm:[1,0,3,2] row_mask:0xf bank_mask:0xf
    v_cndmask_b32_dpp v242, v246, v244, vcc quad_perm:[1,0,3,2] row_mask:0xf bank_mask:0xf
    v_perm_b32 v60, v240, v243, s60
    v_perm_b32 v61, v241, v243, s61
    v_perm_b32 v62, v242, v243, s62
    buffer_store_dwordx4 v[60:63], v23, s[36:39], s99 offen sc1
    s_nop 1
    s_branch .Lexit
.Lbc_three:
    v_smfmac_f32_16x16x64_bf16 v[248:251], v[8:11], v[136:143], v156
    v_smfmac_f32_16x16x64_bf16 v[252:255], v[8:11], v[144:151], v156
    s_nop 3
    v_add_f32 v232, v232, v233
    v_add_f32 v234, v234, v235
    v_add_f32 v236, v236, v237
    v_add_f32 v238, v238, v239
    s_not_b64 vcc, vcc
    v_cndmask_b32_dpp v233, v232, v234, vcc quad_perm:[1,0,3,2] row_mask:0xf bank_mask:0xf
    v_cndmask_b32_dpp v235, v236, v238, vcc quad_perm:[1,0,3,2] row_mask:0xf bank_mask:0xf
    s_not_b64 vcc, vcc
    v_cndmask_b32_dpp v232, v234, v232, vcc quad_perm:[1,0,3,2] row_mask:0xf bank_mask:0xf
    v_cndmask_b32_dpp v234, v238, v236, vcc quad_perm:[1,0,3,2] row_mask:0xf bank_mask:0xf
    v_perm_b32 v56, v232, v235, s60
    v_perm_b32 v57, v233, v235, s61
    v_perm_b32 v58, v234, v235, s62
    buffer_store_dwordx4 v[56:59], v23, s[36:39], s59 offen sc1
    v_add_f32 v240, v240, v241
    v_add_f32 v242, v242, v243
    v_add_f32 v244, v244, v245
    v_add_f32 v246, v246, v247
    s_not_b64 vcc, vcc
    v_cndmask_b32_dpp v241, v240, v242, vcc quad_perm:[1,0,3,2] row_mask:0xf bank_mask:0xf
    v_cndmask_b32_dpp v243, v244, v246, vcc quad_perm:[1,0,3,2] row_mask:0xf bank_mask:0xf
    s_not_b64 vcc, vcc
    v_cndmask_b32_dpp v240, v242, v240, vcc quad_perm:[1,0,3,2] row_mask:0xf bank_mask:0xf
    v_cndmask_b32_dpp v242, v246, v244, vcc quad_perm:[1,0,3,2] row_mask:0xf bank_mask:0xf
    v_perm_b32 v60, v240, v243, s60
    v_perm_b32 v61, v241, v243, s61
    v_perm_b32 v62, v242, v243, s62
    buffer_store_dwordx4 v[60:63], v23, s[36:39], s99 offen sc1
    v_add_f32 v248, v248, v249
    v_add_f32 v250, v250, v251
    v_add_f32 v252, v252, v253
    v_add_f32 v254, v254, v255
    s_not_b64 vcc, vcc
    v_cndmask_b32_dpp v249, v248, v250, vcc quad_perm:[1,0,3,2] row_mask:0xf bank_mask:0xf
    v_cndmask_b32_dpp v251, v252, v254, vcc quad_perm:[1,0,3,2] row_mask:0xf bank_mask:0xf
    s_not_b64 vcc, vcc
    v_cndmask_b32_dpp v248, v250, v248, vcc quad_perm:[1,0,3,2] row_mask:0xf bank_mask:0xf
    v_cndmask_b32_dpp v250, v254, v252, vcc quad_perm:[1,0,3,2] row_mask:0xf bank_mask:0xf
    v_perm_b32 v64, v248, v251, s60
    v_perm_b32 v65, v249, v251, s61
    v_perm_b32 v66, v250, v251, s62
    buffer_store_dwordx4 v[64:67], v23, s[36:39], s100 offen sc1
    s_cmp_eq_u32 s3, 0
    s_cselect_b64 exec, 1, 0
    buffer_store_dword v59, v2, s[36:39], s6 offen
    s_mov_b64 exec, -1
.Lexit:
.Lend:
s_endpgm
.section .rodata,"a"
.p2align 6
.amdhsa_kernel adaLN_cond__sliding_block_cached__moe_arch_mod__decode_kernel
  .amdhsa_next_free_vgpr 256
  .amdhsa_next_free_sgpr 102
  .amdhsa_accum_offset 256
  .amdhsa_group_segment_fixed_size 0
  .amdhsa_kernarg_size 120
  .amdhsa_user_sgpr_count 2
  .amdhsa_user_sgpr_kernarg_segment_ptr 1
  .amdhsa_system_sgpr_workgroup_id_x 1
.end_amdhsa_kernel
```

```asm
; @launch grid=(256,1,1) block=(512,1,1) lds=159360
.amdgcn_target "amdgcn-amd-amdhsa--gfx950"
.text
.p2align 12
.globl adaLN_cond__sliding_block_cached__moe_arch_mod__decode_kernel
.p2align 8
.type adaLN_cond__sliding_block_cached__moe_arch_mod__decode_kernel,@function
adaLN_cond__sliding_block_cached__moe_arch_mod__decode_kernel:
    s_cmp_ge_u32 s2, 256
    s_cbranch_scc1 .Lend
    s_load_dwordx16 s[4:19], s[0:1], 0
    s_load_dwordx8 s[20:27], s[0:1], 64
    s_load_dwordx4 s[28:31], s[0:1], 96
    s_load_dwordx2 s[32:33], s[0:1], 112
    s_memrealtime s[70:71]
    v_lshrrev_b32 v1, 6, v0
    v_and_b32 v0, 63, v0
    v_readfirstlane_b32 s3, v1
    s_cmp_lt_u32 s3, 4
    s_nop 3
    s_cbranch_scc1 .Ltw_done
    s_cmp_lt_u32 s2, 72
    s_cbranch_scc1 .Ltw_m
    s_cmp_lt_u32 s2, 144
    s_cbranch_scc1 .Ltw_b
    s_cmp_lt_u32 s2, 208
    s_cbranch_scc1 .Ltw_q
    s_cmp_eq_u32 s3, 4
    s_cbranch_scc1 .Lst_a0_0
    s_cmp_eq_u32 s3, 5
    s_cbranch_scc1 .Lst_a0_1
.Lrt_a0_0:
.Lrt_a0_1:
    s_branch .Ltw_done
.Ltw_m:
    s_cmp_eq_u32 s3, 4
    s_cbranch_scc1 .Lst_m0_0
    s_cmp_eq_u32 s3, 5
    s_cbranch_scc1 .Lst_m0_1
.Lrt_m0_1:
    s_cmp_eq_u32 s3, 6
    s_cbranch_scc1 .Lst_m0_2
.Lrt_m0_2:
    s_cmp_eq_u32 s3, 7
    s_cbranch_scc1 .Lst_m0_3
    s_cmp_eq_u32 s3, 5
    s_cbranch_scc1 .Lst_m0_4
    s_cmp_eq_u32 s3, 6
    s_cbranch_scc1 .Lrt_m0_5
.Lrt_m0_0:
.Lrt_m0_3:
.Lrt_m0_4:
.Lrt_m0_5:
    s_branch .Ltw_done
.Ltw_b:
    s_cmp_eq_u32 s3, 4
    s_cbranch_scc1 .Lst_b0_0
    s_cmp_eq_u32 s3, 5
    s_cbranch_scc1 .Lst_b0_1
    s_cmp_eq_u32 s3, 6
    s_cbranch_scc1 .Lst_b0_2
    s_cmp_eq_u32 s3, 7
    s_cbranch_scc1 .Lst_b0_3
.Lrt_b0_0:
.Lrt_b0_1:
.Lrt_b0_2:
.Lrt_b0_3:
    s_branch .Ltw_done
.Ltw_q:
    s_cmp_eq_u32 s3, 4
    s_cbranch_scc1 .Lst_q0_0
    s_cmp_eq_u32 s3, 5
    s_cbranch_scc1 .Lst_q0_1
    s_cmp_eq_u32 s3, 6
    s_cbranch_scc1 .Lst_q0_2
    s_cmp_eq_u32 s3, 7
    s_cbranch_scc1 .Lst_q0_3
.Lrt_q0_0:
.Lrt_q0_1:
.Lrt_q0_2:
.Lrt_q0_3:
.Ltw_done:
    s_mov_b32 s35, 0x3ffff
    s_mov_b32 s98, 0xbfb8aa3b
    s_mov_b32 s94, 0x05040100
    s_mov_b32 s95, 0x07060302
    s_mov_b32 s96, 0xaaaaaaaa
    s_mov_b32 s97, 0xaaaaaaaa
    s_and_b32 s64, s2, 7
    s_lshr_b32 s65, s2, 3
    s_mov_b32 s58, 0x2554433
    s_mov_b32 s59, 0x2877661
    s_cmp_ge_u32 s65, 16
    s_cselect_b32 s58, 0xbb1aa998, s58
    s_cselect_b32 s59, 0xffeeddcc, s59
    s_lshl_b32 s57, s65, 2
    s_lshr_b64 s[58:59], s[58:59], s57
    s_lshl1_add_u32 s59, s64, 1
    s_mul_i32 s58, s58, s59
    s_add_u32 s58, s58, s64
    s_add_u32 s58, s58, s59
    s_and_b32 s66, s58, 7
    s_bfe_u32 s67, s58, 0x10003
    s_lshl1_add_u32 s67, s64, s67
    s_lshr_b32 s68, 0xaab5d42a, s65
    s_and_b32 s68, s68, 1
    s_movk_i32 s60, 0x7651
    s_cselect_b32 s60, 0x4320, s60
    s_lshl4_add_u32 s69, s66, s67
    s_lshl_b32 s69, s69, 21
    s_cmp_eq_u32 s64, 7
    s_cselect_b32 s58, 0x4040, 0
    s_or_b32 s58, s58, 0x208180
    s_bitcmp1_b32 s58, s65
    s_cselect_b32 s60, s60, 0x3210
    s_and_b32 s57, s3, 1
    s_and_b32 s59, s3, 6
    s_cmpk_eq_u32 s60, 0x3210
    s_cselect_b32 s57, s68, s57
    s_cselect_b32 s59, s3, s59
    s_lshl_b32 s57, s57, 16
    s_lshl_b32 s59, s59, 10
    s_add_u32 s69, s69, s57
    s_add_u32 s69, s69, s59
    s_add_u32 s69, s69, 0x180000
    v_bfe_u32 v1, v0, 2, 2
    v_lshlrev_b32 v1, 2, v1
    v_bfe_u32 v1, s60, v1, 4
    v_lshrrev_b32 v2, 4, v0
    v_lshl_add_u32 v1, v1, 2, v2
    v_and_b32 v2, 3, v0
    v_lshl_add_u32 v1, v1, 2, v2
    v_lshlrev_b32 v1, 4, v1
    v_lshlrev_b32 v2, 4, v0
    v_lshlrev_b32 v3, 3, v0
    v_and_b32 v4, 31, v0
    v_lshlrev_b32 v4, 2, v4
    v_add_u32 v4, 1024, v4
    v_lshlrev_b32 v5, 1, v4
    s_waitcnt lgkmcnt(0)
    s_load_dword s34, s[32:33], 0
    s_mov_b32 s40, s6
    s_and_b32 s41, s7, 0xffff
    s_mov_b32 s42, 0x10000000
    s_mov_b32 s43, 0x00020000
    s_mov_b32 s6, s60
    s_add_u32 s63, s69, 0
    buffer_load_dwordx4 v[32:35], v1, s[40:43], s63 offen nt
    s_add_u32 s63, s69, 8192
    buffer_load_dwordx4 v[36:39], v1, s[40:43], s63 offen nt
    s_add_u32 s63, s69, 16384
    buffer_load_dwordx4 v[64:67], v1, s[40:43], s63 offen nt
    s_add_u32 s63, s69, 24576
    buffer_load_dwordx4 v[68:71], v1, s[40:43], s63 offen nt
.Lnokpre:
    s_mov_b32 s44, s8
    s_and_b32 s45, s9, 0xffff
    s_mov_b32 s46, 0x10000000
    s_mov_b32 s47, 0x00020000
    s_cmp_eq_u32 s3, 0
    s_cselect_b64 exec, 1, 0
    buffer_load_dword v255, v2, s[44:47], s69 offen nt
    s_mov_b64 exec, -1
    s_mov_b32 s36, s32
    s_and_b32 s37, s33, 0xffff
    s_mov_b32 s38, 0x40000000
    s_mov_b32 s39, 0x00020000
    s_lshl3_add_u32 s56, s3, s2
    s_cmp_lt_u32 s56, 8
    s_cbranch_scc0 .Let_no
    s_lshl2_add_u32 s56, s2, 0x4a1000
    v_lshlrev_b32 v6, 8, v0
    v_mov_b32 v7, s70
    s_mov_b64 exec, 3
    buffer_store_dword v7, v6, s[36:39], s56 offen sc1
    s_mov_b64 exec, -1
.Let_no:
    v_mov_b32 v6, 159232
    v_mov_b32 v7, 0
    ds_write_b32 v6, v7
    s_waitcnt lgkmcnt(0)
    s_barrier
    s_cmp_lt_u32 s3, 4
    s_cbranch_scc1 1
    s_setprio 1
    s_cmp_lt_u32 s65, 9
    s_cbranch_scc1 .Lm
    s_cmp_lt_u32 s65, 18
    s_cbranch_scc1 .Lbc
    s_sub_u32 s65, s65, 18
    s_cmp_ge_u32 s65, 8
    s_cbranch_scc1 .La_early
    s_cmp_eq_u32 s65, 3
    s_mov_b32 s14, 0xb55aab55
    s_cselect_b32 s14, 0x8421084, s14
    s_mov_b32 s15, 0x5aab55aa
    s_cselect_b32 s15, 0x42108421, s15
    s_add_u32 s30, s70, 0
    s_mov_b32 s31, s70
    v_bfe_u32 v16, v0, 1, 3
    v_mul_u32_u24 v16, 1312, v16
    v_lshrrev_b32 v12, 4, v0
    v_lshl_add_u32 v16, v12, 5, v16
    v_and_b32 v12, 1, v0
    v_lshl_add_u32 v16, v12, 4, v16
    v_add_u32 v16, 147456, v16
    s_mul_i32 s56, s3, 1312
    s_add_u32 s56, s56, 147456
    v_add_u32 v17, s56, v3
    v_add_u32 v18, s56, v4
    v_lshrrev_b32 v12, 4, v0
    v_bfe_u32 v13, v0, 1, 1
    v_lshl_add_u32 v12, v12, 1, v13
    v_bfe_u32 v13, v0, 2, 2
    v_lshl_add_u32 v20, v12, 3, v13
    v_lshlrev_b32 v20, 7, v20
    v_and_b32 v12, 3, v12
    v_lshrrev_b32 v13, 1, v13
    v_lshl_add_u32 v12, v12, 1, v13
    v_xor_b32 v12, s3, v12
    v_lshl_add_u32 v20, v12, 4, v20
    v_and_b32 v12, 1, v0
    v_lshl_add_u32 v20, v12, 3, v20
    v_bfe_u32 v23, v0, 1, 3
    v_mul_u32_u24 v23, 144, v23
    v_bfe_u32 v12, v0, 4, 1
    v_lshl_add_u32 v23, v12, 3, v23
    s_branch .Lsk_q0_0
.Lst_q0_0:
    s_branch .Lrt_q0_0
.Lsk_q0_0:
    v_lshrrev_b32 v12, 5, v0
    v_lshl_add_u32 v23, v12, 2, v23
    v_and_b32 v12, 1, v0
    v_lshl_add_u32 v23, v12, 1, v23
    s_lshl_b32 s56, s3, 4
    s_add_u32 s56, s56, 157952
    v_add_u32 v23, s56, v23
    v_and_b32 v24, 15, v0
    v_lshlrev_b32 v24, 3, v24
    s_mul_i32 s56, s3, 144
    s_add_u32 s56, s56, 157952
    v_add_u32 v24, s56, v24
    v_add_u32 v21, 32768, v20
    s_lshl_b32 s100, s3, 10
    s_mul_i32 s58, s3, 1152
    s_mov_b32 s52, s4
    s_and_b32 s53, s5, 0xffff
    s_mov_b32 s54, 0x2400
    s_mov_b32 s55, 0x00020000
    buffer_load_dwordx2 v[246:247], v3, s[52:55], s58 offen
    buffer_load_dwordx2 v[248:249], v3, s[52:55], s58 offen offset:512
    buffer_load_dword v250, v4, s[52:55], s58 offen
    s_mov_b32 s48, s10
    s_and_b32 s49, s11, 0xffff
    s_mov_b32 s50, 0x480000
    s_mov_b32 s51, 0x00020000
    v_bfe_u32 v12, v0, 4, 1
    s_and_b32 s56, s3, 3
    s_lshl_b32 s56, s56, 1
    v_or_b32 v12, s56, v12
    v_and_b32 v19, 7, v0
    v_xor_b32 v12, v12, v19
    v_lshrrev_b32 v19, 3, v0
    v_mul_u32_u24 v19, 8192, v19
    v_lshl_add_u32 v19, v12, 4, v19
    s_lshl3_add_u32 s101, s64, s65
    s_lshl_b32 s57, s3, 16
    s_lshl_b32 s59, s101, 7
    s_add_u32 s57, s57, s59
    s_mov_b32 s99, s57
    s_add_u32 m0, s100, 0
    s_add_u32 s56, s99, 0
    buffer_load_dwordx4 v19, s[48:51], s56 offen nt lds
    s_add_u32 s63, s69, 32768
    buffer_load_dwordx4 v[96:99], v1, s[40:43], s63 offen nt
    s_waitcnt lgkmcnt(0)
    s_add_u32 s34, s34, 1
    s_getreg_b32 s1, hwreg(HW_REG_XCC_ID)
    s_lshl_b32 s1, s1, 24
    s_add_u32 s1, s1, s34
    s_lshr_b32 s0, s2, 3
    s_lshl_b32 s63, s64, 8
    s_add_u32 s0, s0, s63
    s_lshl2_add_u32 s0, s0, 0x480000
    v_mov_b32 v30, s1
    s_cmp_eq_u32 s3, 0
    s_cselect_b64 exec, 1, 0
    buffer_store_dword v30, v2, s[36:39], s0 offen sc1
    s_mov_b64 exec, -1
    s_and_b32 s58, s101, 1
    s_lshl_b32 s101, s101, 8
    s_lshl_b32 s58, s58, 7
    s_sub_u32 s101, s101, s58
    s_lshl_b32 s58, s3, 14
    s_add_u32 s101, s101, s58
    s_add_u32 s101, s101, 0x70000
    s_and_b32 s58, s64, 0
    s_mul_i32 s58, s58, 18432
    s_mul_i32 s59, s3, 2304
    s_add_u32 s58, s58, s59
    s_add_u32 s58, s58, 0x1000
    s_add_u32 s59, s58, 73728
    s_waitcnt vmcnt(5)
    s_add_u32 m0, s100, 8192
    s_add_u32 s56, s99, 524288
    buffer_load_dwordx4 v19, s[48:51], s56 offen nt lds
    s_waitcnt vmcnt(5)
    s_add_u32 s63, s69, 40960
    buffer_load_dwordx4 v[100:103], v1, s[40:43], s63 offen nt
    s_waitcnt vmcnt(5)
    s_add_u32 m0, s100, 16384
    s_add_u32 s56, s99, 1048576
    buffer_load_dwordx4 v19, s[48:51], s56 offen nt lds
    s_waitcnt vmcnt(5)
    s_add_u32 s63, s69, 49152
    buffer_load_dwordx4 v[128:131], v1, s[40:43], s63 offen nt
    v_lshlrev_b32 v236, 16, v246
    v_and_b32 v237, 0xffff0000, v246
    v_lshlrev_b32 v238, 16, v247
    v_and_b32 v239, 0xffff0000, v247
    v_lshlrev_b32 v240, 16, v248
    v_and_b32 v241, 0xffff0000, v248
    v_lshlrev_b32 v242, 16, v249
    v_and_b32 v243, 0xffff0000, v249
    v_lshlrev_b32 v244, 16, v250
    v_and_b32 v245, 0xffff0000, v250
    s_mov_b32 s56, 0x3f803f80
    v_dot2_f32_bf16 v10, v246, s56, 0
    v_dot2_f32_bf16 v11, v246, v246, 0
    v_dot2_f32_bf16 v10, v247, s56, v10
    v_dot2_f32_bf16 v11, v247, v247, v11
    v_dot2_f32_bf16 v10, v248, s56, v10
    v_dot2_f32_bf16 v11, v248, v248, v11
    v_dot2_f32_bf16 v10, v249, s56, v10
    v_dot2_f32_bf16 v11, v249, v249, v11
    s_mov_b64 exec, 0xffffffff
    v_dot2_f32_bf16 v10, v250, s56, v10
    v_dot2_f32_bf16 v11, v250, v250, v11
    s_mov_b64 exec, -1
    s_nop 1
    v_permlane32_swap_b32 v10, v11
    v_add_f32 v10, v10, v11
    v_mov_b32 v12, v10
    s_nop 1
    v_permlane16_swap_b32 v12, v10
    v_add_f32 v10, v12, v10
    s_nop 1
    v_add_f32_dpp v10, v10, v10 row_ror:8 row_mask:0xf bank_mask:0xf
    s_nop 1
    v_add_f32_dpp v10, v10, v10 row_ror:4 row_mask:0xf bank_mask:0xf
    s_nop 1
    v_add_f32_dpp v10, v10, v10 quad_perm:[2,3,0,1] row_mask:0xf bank_mask:0xf
    s_nop 1
    v_add_f32_dpp v10, v10, v10 quad_perm:[1,0,3,2] row_mask:0xf bank_mask:0xf
    v_mul_f32 v10, 0x3ae38e39, v10
    s_nop 0
    v_readlane_b32 s56, v10, 0
    v_readlane_b32 s57, v10, 32
    s_nop 0
    v_mov_b32 v10, s56
    v_fma_f32 v11, -v10, v10, s57
    v_max_f32 v11, 0, v11
    v_cvt_pk_bf16_f32 v12, -v10, v11
    v_and_b32 v13, 0xffff0000, v12
    v_add_f32 v13, 0x3727c5ac, v13
    v_lshlrev_b32 v10, 16, v12
    v_cvt_pk_bf16_f32 v13, v13, v13
    v_lshlrev_b32 v13, 16, v13
    v_sqrt_f32 v13, v13
    v_mov_b32 v11, v10
    v_cvt_pk_bf16_f32 v13, v13, v13
    v_lshlrev_b32 v13, 16, v13
    v_rcp_f32 v12, v13
    v_rcp_f32 v13, v13
    v_pk_add_f32 v[236:237], v[236:237], v[10:11]
    v_pk_add_f32 v[238:239], v[238:239], v[10:11]
    v_pk_add_f32 v[240:241], v[240:241], v[10:11]
    v_pk_add_f32 v[242:243], v[242:243], v[10:11]
    v_pk_add_f32 v[244:245], v[244:245], v[10:11]
    v_cvt_pk_bf16_f32 v236, v236, v237
    v_and_b32 v237, 0xffff0000, v236
    v_lshlrev_b32 v236, 16, v236
    v_cvt_pk_bf16_f32 v238, v238, v239
    v_and_b32 v239, 0xffff0000, v238
    v_lshlrev_b32 v238, 16, v238
    v_cvt_pk_bf16_f32 v240, v240, v241
    v_and_b32 v241, 0xffff0000, v240
    v_lshlrev_b32 v240, 16, v240
    v_cvt_pk_bf16_f32 v242, v242, v243
    v_and_b32 v243, 0xffff0000, v242
    v_lshlrev_b32 v242, 16, v242
    v_cvt_pk_bf16_f32 v244, v244, v245
    v_and_b32 v245, 0xffff0000, v244
    v_lshlrev_b32 v244, 16, v244
    v_pk_mul_f32 v[236:237], v[236:237], v[12:13]
    v_pk_mul_f32 v[238:239], v[238:239], v[12:13]
    v_pk_mul_f32 v[240:241], v[240:241], v[12:13]
    v_pk_mul_f32 v[242:243], v[242:243], v[12:13]
    v_pk_mul_f32 v[244:245], v[244:245], v[12:13]
    v_cvt_pk_bf16_f32 v236, v236, v237
    v_and_b32 v237, 0xffff0000, v236
    v_lshlrev_b32 v236, 16, v236
    v_cvt_pk_bf16_f32 v238, v238, v239
    v_and_b32 v239, 0xffff0000, v238
    v_lshlrev_b32 v238, 16, v238
    v_cvt_pk_bf16_f32 v240, v240, v241
    v_and_b32 v241, 0xffff0000, v240
    v_lshlrev_b32 v240, 16, v240
    v_cvt_pk_bf16_f32 v242, v242, v243
    v_and_b32 v243, 0xffff0000, v242
    v_lshlrev_b32 v242, 16, v242
    v_cvt_pk_bf16_f32 v244, v244, v245
    v_and_b32 v245, 0xffff0000, v244
    v_lshlrev_b32 v244, 16, v244
    s_branch .Lsk_q0_1
.Lst_q0_1:
    s_branch .Lrt_q0_1
.Lsk_q0_1:
    s_waitcnt vmcnt(5)
    s_add_u32 m0, s100, 24576
    s_add_u32 s56, s99, 1572864
    buffer_load_dwordx4 v19, s[48:51], s56 offen nt lds
    s_waitcnt vmcnt(4)
    s_add_u32 s63, s69, 57344
    buffer_load_dwordx4 v[132:135], v1, s[40:43], s63 offen nt
    s_waitcnt vmcnt(4)
    s_add_u32 m0, s100, 32768
    s_add_u32 s56, s99, 2097152
    buffer_load_dwordx4 v19, s[48:51], s56 offen nt lds
    s_waitcnt vmcnt(4)
    s_add_u32 s63, s69, 131072
    buffer_load_dwordx4 v[40:43], v1, s[40:43], s63 offen nt
    s_waitcnt vmcnt(4)
    s_add_u32 m0, s100, 40960
    s_add_u32 s56, s99, 2621440
    buffer_load_dwordx4 v19, s[48:51], s56 offen nt lds
    s_waitcnt vmcnt(4)
    s_add_u32 s63, s69, 139264
    buffer_load_dwordx4 v[44:47], v1, s[40:43], s63 offen nt
    s_waitcnt vmcnt(4)
    s_add_u32 m0, s100, 49152
    s_add_u32 s56, s99, 3145728
    buffer_load_dwordx4 v19, s[48:51], s56 offen nt lds
    s_waitcnt vmcnt(4)
    s_add_u32 s63, s69, 147456
    buffer_load_dwordx4 v[72:75], v1, s[40:43], s63 offen nt
    s_waitcnt vmcnt(4)
    s_add_u32 m0, s100, 57344
    s_add_u32 s56, s99, 3670016
    buffer_load_dwordx4 v19, s[48:51], s56 offen nt lds
    s_waitcnt vmcnt(4)
    s_add_u32 s63, s69, 155648
    buffer_load_dwordx4 v[76:79], v1, s[40:43], s63 offen nt
    s_waitcnt vmcnt(4)
    s_add_u32 m0, s100, 65536
    s_add_u32 s56, s99, 4194304
    buffer_load_dwordx4 v19, s[48:51], s56 offen nt lds
    s_waitcnt vmcnt(4)
    s_add_u32 s63, s69, 163840
    buffer_load_dwordx4 v[104:107], v1, s[40:43], s63 offen nt
    s_waitcnt vmcnt(4)
    s_add_u32 s63, s69, 172032
    buffer_load_dwordx4 v[108:111], v1, s[40:43], s63 offen nt
    s_waitcnt vmcnt(4)
    s_add_u32 s63, s69, 180224
    buffer_load_dwordx4 v[136:139], v1, s[40:43], s63 offen nt
    s_waitcnt vmcnt(4)
    s_add_u32 s63, s69, 188416
    buffer_load_dwordx4 v[140:143], v1, s[40:43], s63 offen nt
    s_waitcnt vmcnt(4)
    s_add_u32 s63, s69, 262144
    buffer_load_dwordx4 v[48:51], v1, s[40:43], s63 offen nt
    s_waitcnt vmcnt(4)
    s_add_u32 s63, s69, 270336
    buffer_load_dwordx4 v[52:55], v1, s[40:43], s63 offen nt
    s_and_b32 s12, s0, 0xffffff80
    s_sub_u32 s12, s12, 1024
    buffer_load_dword v28, v4, s[36:39], s12 offen sc1
    buffer_load_dwordx4 v[196:199], v2, s[36:39], s58 offen offset:0 sc1
    buffer_load_dwordx4 v[200:203], v2, s[36:39], s58 offen offset:1024 sc1
    buffer_load_dwordx2 v[204:205], v5, s[36:39], s58 offen offset:0 sc1
    buffer_load_dwordx4 v[206:209], v2, s[36:39], s59 offen offset:0 sc1
    buffer_load_dwordx4 v[210:213], v2, s[36:39], s59 offen offset:1024 sc1
    buffer_load_dwordx2 v[214:215], v5, s[36:39], s59 offen offset:0 sc1
    s_add_u32 s63, s69, 278528
    buffer_load_dwordx4 v[80:83], v1, s[40:43], s63 offen nt
    s_add_u32 s63, s69, 286720
    buffer_load_dwordx4 v[84:87], v1, s[40:43], s63 offen nt
    s_add_u32 s63, s69, 294912
    buffer_load_dwordx4 v[112:115], v1, s[40:43], s63 offen nt
    s_barrier
    ds_read_b64_tr_b16 v[160:161], v20 offset:0
    ds_read_b64_tr_b16 v[162:163], v20 offset:512
    ds_read_b64_tr_b16 v[164:165], v20 offset:8192
    ds_read_b64_tr_b16 v[166:167], v20 offset:8704
    ds_read_b64_tr_b16 v[168:169], v20 offset:16384
    ds_read_b64_tr_b16 v[170:171], v20 offset:16896
    ds_read_b64_tr_b16 v[172:173], v20 offset:24576
    ds_read_b64_tr_b16 v[174:175], v20 offset:25088
    ds_read_b64_tr_b16 v[176:177], v21 offset:0
    ds_read_b64_tr_b16 v[178:179], v21 offset:512
    ds_read_b64_tr_b16 v[180:181], v21 offset:8192
    ds_read_b64_tr_b16 v[182:183], v21 offset:8704
    ds_read_b64_tr_b16 v[184:185], v21 offset:16384
    ds_read_b64_tr_b16 v[186:187], v21 offset:16896
    ds_read_b64_tr_b16 v[188:189], v21 offset:24576
    ds_read_b64_tr_b16 v[190:191], v21 offset:25088
    ds_read_b64_tr_b16 v[192:193], v21 offset:32768
    ds_read_b64_tr_b16 v[194:195], v21 offset:33280
    s_add_u32 s63, s69, 303104
    buffer_load_dwordx4 v[116:119], v1, s[40:43], s63 offen nt
    s_waitcnt vmcnt(4)
    s_branch .gpc_2
.gp_1:
    buffer_load_dwordx4 v[196:199], v2, s[36:39], s58 offen offset:0 sc1
    buffer_load_dwordx4 v[200:203], v2, s[36:39], s58 offen offset:1024 sc1
    buffer_load_dwordx2 v[204:205], v5, s[36:39], s58 offen offset:0 sc1
    buffer_load_dwordx4 v[206:209], v2, s[36:39], s59 offen offset:0 sc1
    buffer_load_dwordx4 v[210:213], v2, s[36:39], s59 offen offset:1024 sc1
    buffer_load_dwordx2 v[214:215], v5, s[36:39], s59 offen offset:0 sc1
    s_waitcnt vmcnt(0)
.gpc_2:
    v_min_u32 v10, v197, v199
    v_max_u32 v11, v197, v199
    v_min3_u32 v10, v10, v201, v203
    v_max3_u32 v11, v11, v201, v203
    v_min3_u32 v10, v10, v205, v207
    v_max3_u32 v11, v11, v205, v207
    v_min3_u32 v10, v10, v209, v211
    v_max3_u32 v11, v11, v209, v211
    v_min3_u32 v10, v10, v213, v215
    v_max3_u32 v11, v11, v213, v215
    v_cmp_eq_u32 vcc, s34, v10
    v_cmp_eq_u32 s[56:57], s34, v11
    s_and_b64 vcc, vcc, s[56:57]
    s_cmp_eq_u64 vcc, -1
    s_nop 2
    s_cbranch_scc1 .gpd_3
    s_sub_u32 s35, s35, 1
    s_cbranch_scc1 .Lexit
    s_branch .gp_1
.gpd_3:
    s_add_u32 s63, s69, 311296
    buffer_load_dwordx4 v[144:147], v1, s[40:43], s63 offen nt
    v_and_b32 v207, 0xffff0000, v206
    v_lshlrev_b32 v206, 16, v206
    v_and_b32 v209, 0xffff0000, v208
    v_lshlrev_b32 v208, 16, v208
    v_and_b32 v211, 0xffff0000, v210
    v_lshlrev_b32 v210, 16, v210
    v_and_b32 v213, 0xffff0000, v212
    v_lshlrev_b32 v212, 16, v212
    v_and_b32 v215, 0xffff0000, v214
    v_lshlrev_b32 v214, 16, v214
    v_and_b32 v197, 0xffff0000, v196
    v_lshlrev_b32 v196, 16, v196
    v_and_b32 v199, 0xffff0000, v198
    v_lshlrev_b32 v198, 16, v198
    v_and_b32 v201, 0xffff0000, v200
    v_lshlrev_b32 v200, 16, v200
    v_and_b32 v203, 0xffff0000, v202
    v_lshlrev_b32 v202, 16, v202
    v_and_b32 v205, 0xffff0000, v204
    v_lshlrev_b32 v204, 16, v204
    v_pk_mul_f32 v[236:237], v[236:237], v[206:207]
    v_pk_mul_f32 v[238:239], v[238:239], v[208:209]
    v_pk_mul_f32 v[240:241], v[240:241], v[210:211]
    v_pk_mul_f32 v[242:243], v[242:243], v[212:213]
    v_pk_mul_f32 v[244:245], v[244:245], v[214:215]
    v_cvt_pk_bf16_f32 v236, v236, v237
    s_branch .Lsk_q0_2
.Lst_q0_2:
    s_branch .Lrt_q0_2
.Lsk_q0_2:
    v_and_b32 v237, 0xffff0000, v236
    v_lshlrev_b32 v236, 16, v236
    v_cvt_pk_bf16_f32 v238, v238, v239
    v_and_b32 v239, 0xffff0000, v238
    v_lshlrev_b32 v238, 16, v238
    v_cvt_pk_bf16_f32 v240, v240, v241
    v_and_b32 v241, 0xffff0000, v240
    v_lshlrev_b32 v240, 16, v240
    v_cvt_pk_bf16_f32 v242, v242, v243
    s_branch .Lsk_q0_3
.Lst_q0_3:
    s_branch .Lrt_q0_3
.Lsk_q0_3:
    v_and_b32 v243, 0xffff0000, v242
    v_lshlrev_b32 v242, 16, v242
    v_cvt_pk_bf16_f32 v244, v244, v245
    v_and_b32 v245, 0xffff0000, v244
    v_lshlrev_b32 v244, 16, v244
    v_pk_add_f32 v[236:237], v[236:237], v[196:197]
    v_pk_add_f32 v[238:239], v[238:239], v[198:199]
    v_pk_add_f32 v[240:241], v[240:241], v[200:201]
    v_pk_add_f32 v[242:243], v[242:243], v[202:203]
    v_pk_add_f32 v[244:245], v[244:245], v[204:205]
    v_cvt_pk_bf16_f32 v246, v236, v237
    v_cvt_pk_bf16_f32 v247, v238, v239
    v_cvt_pk_bf16_f32 v248, v240, v241
    v_cvt_pk_bf16_f32 v249, v242, v243
    v_cvt_pk_bf16_f32 v250, v244, v245
    ds_write_b64 v17, v[246:247] offset:0
    ds_write_b64 v17, v[248:249] offset:512
    ds_write_b32 v18, v250 offset:0
    s_add_u32 s63, s69, 319488
    buffer_load_dwordx4 v[148:151], v1, s[40:43], s63 offen nt
    s_waitcnt lgkmcnt(0)
    s_barrier
    s_add_u32 s63, s69, 393216
    buffer_load_dwordx4 v[56:59], v1, s[40:43], s63 offen nt
    ds_read_b128 v[196:199], v16 offset:0
    ds_read_b128 v[200:203], v16 offset:128
    ds_read_b128 v[204:207], v16 offset:256
    ds_read_b128 v[208:211], v16 offset:384
    ds_read_b128 v[212:215], v16 offset:512
    ds_read_b128 v[216:219], v16 offset:640
    ds_read_b128 v[220:223], v16 offset:768
    ds_read_b128 v[224:227], v16 offset:896
    ds_read_b128 v[228:231], v16 offset:1024
    s_waitcnt lgkmcnt(8)
    v_mfma_f32_16x16x32_bf16 v[232:235], v[160:163], v[196:199], 0
    s_waitcnt lgkmcnt(7)
    v_mfma_f32_16x16x32_bf16 v[232:235], v[164:167], v[200:203], v[232:235]
    s_waitcnt lgkmcnt(6)
    v_mfma_f32_16x16x32_bf16 v[232:235], v[168:171], v[204:207], v[232:235]
    s_waitcnt lgkmcnt(5)
    v_mfma_f32_16x16x32_bf16 v[232:235], v[172:175], v[208:211], v[232:235]
    s_waitcnt lgkmcnt(4)
    v_mfma_f32_16x16x32_bf16 v[232:235], v[176:179], v[212:215], v[232:235]
    s_waitcnt lgkmcnt(3)
    v_mfma_f32_16x16x32_bf16 v[232:235], v[180:183], v[216:219], v[232:235]
    s_waitcnt lgkmcnt(2)
    v_mfma_f32_16x16x32_bf16 v[232:235], v[184:187], v[220:223], v[232:235]
    s_waitcnt lgkmcnt(1)
    v_mfma_f32_16x16x32_bf16 v[232:235], v[188:191], v[224:227], v[232:235]
    s_waitcnt lgkmcnt(0)
    v_mfma_f32_16x16x32_bf16 v[232:235], v[192:195], v[228:231], v[232:235]
    s_nop 7
    v_permlane32_swap_b32 v232, v234
    v_permlane32_swap_b32 v233, v235
    v_cndmask_b32 v233, v233, v234, s[96:97]
    v_cndmask_b32 v232, v232, v235, s[96:97]
    s_nop 1
    v_add_f32_dpp v236, v233, v232 quad_perm:[1,0,3,2] row_mask:0xf bank_mask:0xf
    v_and_b32 v12, 1, v0
    v_lshlrev_b32 v12, 8, v12
    v_bfe_u32 v13, v0, 1, 3
    v_lshl_add_u32 v12, v13, 4, v12
    v_cvt_pk_bf16_f32 v236, v236, v236
    ds_write_b16 v23, v236
    v_mov_b32 v243, s34
    s_waitcnt lgkmcnt(0)
    s_barrier
    ds_read2_b32 v[244:245], v24 offset1:1
    v_mov_b32 v241, s34
    s_waitcnt lgkmcnt(0)
    v_mov_b32 v240, v244
    v_mov_b32 v242, v245
    v_cmp_eq_u32 vcc, s1, v28
    s_add_u32 s57, s101, 0x800000
    s_cmp_eq_u64 vcc, -1
    s_mov_b64 exec, 0xffff
    buffer_store_dwordx4 v[240:243], v12, s[36:39], s57 offen
    s_nop 1
    s_cbranch_scc1 .lq_4
    s_mov_b64 exec, 0xffff
    buffer_store_dwordx4 v[240:243], v12, s[36:39], s101 offen sc1
.lq_4:
    s_mov_b64 exec, -1
    s_mov_b64 s[18:19], 0
    v_mov_b32 v6, 0
    s_waitcnt vmcnt(3)
    s_bitcmp1_b64 s[14:15], 25
    s_cbranch_scc0 1
    s_waitcnt vmcnt(2)
    s_add_u32 s63, s69, 401408
    buffer_load_dwordx4 v[60:63], v1, s[40:43], s63 offen nt
    s_branch .Ln_att
.La_early:
    s_branch .Lsk_a0_0
.Lst_a0_0:
    s_branch .Lrt_a0_0
.Lsk_a0_0:
    s_mov_b32 s14, 0x6ddb76dd
    s_mov_b32 s15, 0xdb76ddb7
    s_add_u32 s30, s70, -55
    s_mov_b32 s31, s70
    s_cmp_ge_u32 s65, 11
    s_cselect_b32 s99, 1, 0
    s_mul_i32 s57, s99, 3
    s_sub_u32 s100, s65, s57
    s_sub_u32 s100, s100, 8
    s_lshl1_add_u32 s99, s64, s99
    s_mov_b32 s48, s12
    s_and_b32 s49, s13, 0xffff
    s_mov_b32 s50, 0x480000
    s_mov_b32 s51, 0x00020000
    v_bfe_u32 v12, v0, 4, 1
    s_and_b32 s56, s3, 1
    s_lshl_b32 s56, s56, 2
    v_lshl_or_b32 v12, v12, 1, s56
    v_and_b32 v13, 7, v0
    v_xor_b32 v12, v12, v13
    v_lshrrev_b32 v13, 3, v0
    v_mul_u32_u24 v13, 1152, v13
    v_lshl_add_u32 v6, v12, 4, v13
    s_mul_i32 s101, s99, 294912
    s_mul_i32 s56, s100, 384
    s_add_u32 s101, s101, s56
    s_mul_i32 s56, s3, 9216
    s_add_u32 s101, s101, s56
    s_lshl_b32 s57, s3, 10
    s_waitcnt vmcnt(4)
    s_add_u32 m0, s57, 0
    s_add_u32 s56, s101, 0
    buffer_load_dwordx4 v6, s[48:51], s56 offen nt lds
    s_waitcnt vmcnt(4)
    s_add_u32 m0, s57, 32768
    s_add_u32 s56, s101, 128
    buffer_load_dwordx4 v6, s[48:51], s56 offen nt lds
    s_waitcnt vmcnt(4)
    s_bitcmp1_b64 s[14:15], 4
    s_cbranch_scc0 1
    s_waitcnt vmcnt(3)
    s_add_u32 s63, s69, 32768
    buffer_load_dwordx4 v[96:99], v1, s[40:43], s63 offen nt
    s_waitcnt vmcnt(4)
    s_waitcnt lgkmcnt(0)
    s_add_u32 s34, s34, 1
    s_getreg_b32 s1, hwreg(HW_REG_XCC_ID)
    s_lshl_b32 s1, s1, 24
    s_add_u32 s1, s1, s34
    s_lshr_b32 s0, s2, 3
    s_lshl_b32 s63, s64, 8
    s_add_u32 s0, s0, s63
    s_lshl2_add_u32 s0, s0, 0x480000
    v_mov_b32 v30, s1
    s_cmp_eq_u32 s3, 0
    s_cselect_b64 exec, 1, 0
    buffer_store_dword v30, v2, s[36:39], s0 offen sc1
    s_mov_b64 exec, -1
    s_bitcmp1_b64 s[14:15], 5
    s_cbranch_scc0 1
    s_waitcnt vmcnt(3)
    s_add_u32 s63, s69, 40960
    buffer_load_dwordx4 v[100:103], v1, s[40:43], s63 offen nt
    s_waitcnt vmcnt(4)
    s_add_u32 m0, s57, 65536
    s_add_u32 s56, s101, 256
    buffer_load_dwordx4 v6, s[48:51], s56 offen nt lds
    s_waitcnt vmcnt(4)
    s_bitcmp1_b64 s[14:15], 6
    s_cbranch_scc0 1
    s_waitcnt vmcnt(3)
    s_add_u32 s63, s69, 49152
    buffer_load_dwordx4 v[128:131], v1, s[40:43], s63 offen nt
    s_waitcnt vmcnt(4)
    s_bitcmp1_b64 s[14:15], 7
    s_cbranch_scc0 1
    s_waitcnt vmcnt(2)
    s_add_u32 s63, s69, 57344
    buffer_load_dwordx4 v[132:135], v1, s[40:43], s63 offen nt
    s_waitcnt vmcnt(3)
    s_add_u32 m0, s57, 8192
    s_add_u32 s56, s101, 73728
    buffer_load_dwordx4 v6, s[48:51], s56 offen nt lds
    s_waitcnt vmcnt(3)
    s_bitcmp1_b64 s[14:15], 8
    s_cbranch_scc0 1
    s_waitcnt vmcnt(2)
    s_add_u32 s63, s69, 131072
    buffer_load_dwordx4 v[40:43], v1, s[40:43], s63 offen nt
    s_waitcnt vmcnt(3)
    s_bitcmp1_b64 s[14:15], 9
    s_cbranch_scc0 1
    s_waitcnt vmcnt(2)
    s_add_u32 s63, s69, 139264
    buffer_load_dwordx4 v[44:47], v1, s[40:43], s63 offen nt
    s_waitcnt vmcnt(3)
    s_add_u32 m0, s57, 40960
    s_add_u32 s56, s101, 73856
    buffer_load_dwordx4 v6, s[48:51], s56 offen nt lds
    s_waitcnt vmcnt(3)
    s_bitcmp1_b64 s[14:15], 10
    s_cbranch_scc0 1
    s_waitcnt vmcnt(2)
    s_add_u32 s63, s69, 147456
    buffer_load_dwordx4 v[72:75], v1, s[40:43], s63 offen nt
    s_waitcnt vmcnt(3)
    s_bitcmp1_b64 s[14:15], 11
    s_cbranch_scc0 1
    s_waitcnt vmcnt(2)
    s_add_u32 s63, s69, 155648
    buffer_load_dwordx4 v[76:79], v1, s[40:43], s63 offen nt
    s_waitcnt vmcnt(3)
    s_add_u32 m0, s57, 73728
    s_add_u32 s56, s101, 73984
    buffer_load_dwordx4 v6, s[48:51], s56 offen nt lds
    s_waitcnt vmcnt(3)
    s_bitcmp1_b64 s[14:15], 12
    s_cbranch_scc0 1
    s_waitcnt vmcnt(2)
    s_add_u32 s63, s69, 163840
    buffer_load_dwordx4 v[104:107], v1, s[40:43], s63 offen nt
    s_waitcnt vmcnt(3)
    s_bitcmp1_b64 s[14:15], 13
    s_cbranch_scc0 1
    s_waitcnt vmcnt(2)
    s_add_u32 s63, s69, 172032
    buffer_load_dwordx4 v[108:111], v1, s[40:43], s63 offen nt
    s_waitcnt vmcnt(3)
    s_add_u32 m0, s57, 16384
    s_add_u32 s56, s101, 147456
    buffer_load_dwordx4 v6, s[48:51], s56 offen nt lds
    s_waitcnt vmcnt(3)
    s_bitcmp1_b64 s[14:15], 14
    s_cbranch_scc0 1
    s_waitcnt vmcnt(2)
    s_add_u32 s63, s69, 180224
    buffer_load_dwordx4 v[136:139], v1, s[40:43], s63 offen nt
    s_waitcnt vmcnt(3)
    s_bitcmp1_b64 s[14:15], 15
    s_cbranch_scc0 1
    s_waitcnt vmcnt(2)
    s_add_u32 s63, s69, 188416
    buffer_load_dwordx4 v[140:143], v1, s[40:43], s63 offen nt
    s_waitcnt vmcnt(3)
    s_add_u32 m0, s57, 49152
    s_add_u32 s56, s101, 147584
    buffer_load_dwordx4 v6, s[48:51], s56 offen nt lds
    s_waitcnt vmcnt(3)
    s_bitcmp1_b64 s[14:15], 16
    s_cbranch_scc0 1
    s_waitcnt vmcnt(2)
    s_add_u32 s63, s69, 262144
    buffer_load_dwordx4 v[48:51], v1, s[40:43], s63 offen nt
    s_waitcnt vmcnt(3)
    s_bitcmp1_b64 s[14:15], 17
    s_cbranch_scc0 1
    s_waitcnt vmcnt(2)
    s_add_u32 s63, s69, 270336
    buffer_load_dwordx4 v[52:55], v1, s[40:43], s63 offen nt
    s_waitcnt vmcnt(3)
    s_add_u32 m0, s57, 81920
    s_add_u32 s56, s101, 147712
    buffer_load_dwordx4 v6, s[48:51], s56 offen nt lds
    s_waitcnt vmcnt(3)
    s_bitcmp1_b64 s[14:15], 18
    s_cbranch_scc0 1
    s_waitcnt vmcnt(2)
    s_add_u32 s63, s69, 278528
    buffer_load_dwordx4 v[80:83], v1, s[40:43], s63 offen nt
    s_waitcnt vmcnt(3)
    s_bitcmp1_b64 s[14:15], 19
    s_cbranch_scc0 1
    s_waitcnt vmcnt(2)
    s_add_u32 s63, s69, 286720
    buffer_load_dwordx4 v[84:87], v1, s[40:43], s63 offen nt
    s_waitcnt vmcnt(3)
    s_bitcmp1_b64 s[14:15], 20
    s_cbranch_scc0 1
    s_waitcnt vmcnt(2)
    s_add_u32 s63, s69, 294912
    buffer_load_dwordx4 v[112:115], v1, s[40:43], s63 offen nt
    s_waitcnt vmcnt(3)
    s_bitcmp1_b64 s[14:15], 21
    s_cbranch_scc0 1
    s_waitcnt vmcnt(2)
    s_add_u32 s63, s69, 303104
    buffer_load_dwordx4 v[116:119], v1, s[40:43], s63 offen nt
    s_waitcnt vmcnt(3)
    s_bitcmp1_b64 s[14:15], 22
    s_cbranch_scc0 1
    s_waitcnt vmcnt(2)
    s_add_u32 s63, s69, 311296
    buffer_load_dwordx4 v[144:147], v1, s[40:43], s63 offen nt
    s_branch .Lsk_a0_1
.Lst_a0_1:
    s_branch .Lrt_a0_1
.Lsk_a0_1:
    s_waitcnt vmcnt(3)
    s_bitcmp1_b64 s[14:15], 23
    s_cbranch_scc0 1
    s_waitcnt vmcnt(2)
    s_add_u32 s63, s69, 319488
    buffer_load_dwordx4 v[148:151], v1, s[40:43], s63 offen nt
    s_waitcnt vmcnt(3)
    s_bitcmp1_b64 s[14:15], 24
    s_cbranch_scc0 1
    s_waitcnt vmcnt(2)
    s_add_u32 s63, s69, 393216
    buffer_load_dwordx4 v[56:59], v1, s[40:43], s63 offen nt
    s_waitcnt vmcnt(3)
    s_bitcmp1_b64 s[14:15], 25
    s_cbranch_scc0 1
    s_waitcnt vmcnt(2)
    s_add_u32 s63, s69, 401408
    buffer_load_dwordx4 v[60:63], v1, s[40:43], s63 offen nt
    s_mov_b64 s[18:19], -1
.Ln_att:
    v_and_b32 v8, 1, v0
    v_lshlrev_b32 v8, 8, v8
    v_and_b32 v9, 0x3c, v0
    v_lshl_add_u32 v9, v9, 2, v8
    v_add_u32 v7, v9, v8
    v_and_b32 v9, 0x3c, v0
    v_lshrrev_b32 v8, 4, v8
    v_and_b32 v9, 4, v0
    v_lshl_add_u32 v9, v9, 3, v8
    s_lshl_b32 s58, s66, 14
    s_lshl_b32 s59, s67, 10
    s_add_u32 s58, s58, s59
    s_add_u32 s58, s58, 0x70000
    s_lshl4_add_u32 s59, s66, s67
    s_lshl_b32 s59, s59, 7
    s_add_u32 s59, s59, 0x430000
    s_memrealtime s[8:9]
    s_waitcnt vmcnt(8)
    s_waitcnt lgkmcnt(0)
    s_sub_u32 s8, s8, s30
    s_cmpk_ge_u32 s8, 1207
    s_cbranch_scc1 .ap_5
    s_waitcnt vmcnt(5)
    s_cmpk_ge_u32 s8, 1107
    s_cbranch_scc1 .ap_5
    s_waitcnt vmcnt(3)
    s_bitcmp1_b64 s[14:15], 26
    s_cbranch_scc0 1
    s_waitcnt vmcnt(2)
    s_cmpk_ge_u32 s8, 987
    s_cbranch_scc1 .ap_5
    s_waitcnt vmcnt(1)
.ap_5:
    s_add_u32 s63, s69, 409600
    buffer_load_dwordx4 v[88:91], v1, s[40:43], s63 offen nt
    v_and_b32 v157, 7, v0
    v_lshlrev_b32 v157, 2, v157
    s_mov_b32 s63, 0x4a1000
    buffer_load_dword v156, v157, s[36:39], s63 offen
    s_cmp_eq_u32 s3, 0
    s_cbranch_scc1 .Lst_n1_0
.Lrt_n1_0:
    s_cmp_eq_u32 s3, 1
    s_cbranch_scc1 .Lst_n1_1
    s_cmp_eq_u32 s3, 2
    s_cbranch_scc1 .Lst_n1_2
    s_cmp_eq_u32 s3, 3
    s_cbranch_scc1 .Lst_n1_3
    s_cmp_eq_u32 s3, 4
    s_cbranch_scc1 .Lst_n1_4
    s_cmp_eq_u32 s3, 5
    s_cbranch_scc1 .Lst_n1_5
    s_cmp_eq_u32 s3, 6
    s_cbranch_scc1 .Lst_n1_6
    s_cmp_eq_u32 s3, 7
    s_cbranch_scc1 .Lst_n1_7
    s_cmp_eq_u32 s3, 0
    s_cbranch_scc1 .Lrt_n1_8
.Lrt_n1_1:
.Lrt_n1_2:
.Lrt_n1_3:
.Lrt_n1_4:
.Lrt_n1_5:
.Lrt_n1_6:
.Lrt_n1_7:
.Lrt_n1_8:
    s_memrealtime s[8:9]
    s_waitcnt vmcnt(9)
    s_waitcnt lgkmcnt(0)
    s_sub_u32 s8, s8, s30
    s_cmpk_ge_u32 s8, 1234
    s_cbranch_scc1 .ap_6
    s_waitcnt vmcnt(6)
    s_cmpk_ge_u32 s8, 1134
    s_cbranch_scc1 .ap_6
    s_waitcnt vmcnt(4)
    s_bitcmp1_b64 s[14:15], 27
    s_cbranch_scc0 1
    s_waitcnt vmcnt(3)
    s_cmpk_ge_u32 s8, 1014
    s_cbranch_scc1 .ap_6
    s_waitcnt vmcnt(2)
.ap_6:
    s_add_u32 s63, s69, 417792
    buffer_load_dwordx4 v[92:95], v1, s[40:43], s63 offen nt
    s_memrealtime s[8:9]
    s_waitcnt vmcnt(9)
    s_waitcnt lgkmcnt(0)
    s_sub_u32 s8, s8, s30
    s_cmpk_ge_u32 s8, 1261
    s_cbranch_scc1 .ap_7
    s_waitcnt vmcnt(6)
    s_cmpk_ge_u32 s8, 1161
    s_cbranch_scc1 .ap_7
    s_waitcnt vmcnt(4)
    s_bitcmp1_b64 s[14:15], 28
    s_cbranch_scc0 1
    s_waitcnt vmcnt(3)
    s_cmpk_ge_u32 s8, 1041
    s_cbranch_scc1 .ap_7
    s_waitcnt vmcnt(2)
.ap_7:
    s_add_u32 s63, s69, 425984
    buffer_load_dwordx4 v[120:123], v1, s[40:43], s63 offen nt
    s_memrealtime s[8:9]
    s_waitcnt vmcnt(9)
    s_waitcnt lgkmcnt(0)
    s_sub_u32 s8, s8, s30
    s_cmpk_ge_u32 s8, 1288
    s_cbranch_scc1 .ap_8
    s_waitcnt vmcnt(6)
    s_cmpk_ge_u32 s8, 1188
    s_cbranch_scc1 .ap_8
    s_waitcnt vmcnt(4)
    s_bitcmp1_b64 s[14:15], 29
    s_cbranch_scc0 1
    s_waitcnt vmcnt(3)
    s_cmpk_ge_u32 s8, 1068
    s_cbranch_scc1 .ap_8
    s_waitcnt vmcnt(1)
.ap_8:
    s_add_u32 s63, s69, 434176
    buffer_load_dwordx4 v[124:127], v1, s[40:43], s63 offen nt
    s_memrealtime s[8:9]
    s_waitcnt vmcnt(9)
    s_waitcnt lgkmcnt(0)
    s_sub_u32 s8, s8, s30
    s_cmpk_ge_u32 s8, 1315
    s_cbranch_scc1 .ap_9
    s_waitcnt vmcnt(6)
    s_cmpk_ge_u32 s8, 1215
    s_cbranch_scc1 .ap_9
    s_waitcnt vmcnt(4)
    s_bitcmp1_b64 s[14:15], 30
    s_cbranch_scc0 1
    s_waitcnt vmcnt(2)
    s_cmpk_ge_u32 s8, 1095
    s_cbranch_scc1 .ap_9
    s_waitcnt vmcnt(1)
.ap_9:
    s_add_u32 s63, s69, 442368
    buffer_load_dwordx4 v[152:155], v1, s[40:43], s63 offen nt
    s_waitcnt vmcnt(4)
    s_sub_u32 s63, s70, 300
    v_subrev_u32 v156, s63, v156
    v_mov_b32 v157, 600
    v_cmp_lt_u32 s[8:9], v156, v157
    v_add_u32_dpp v156, v156, v156 quad_perm:[1,0,3,2] row_mask:0xf bank_mask:0xf
    s_nop 1
    v_add_u32_dpp v156, v156, v156 quad_perm:[2,3,0,1] row_mask:0xf bank_mask:0xf
    s_nop 1
    v_add_u32_dpp v156, v156, v156 row_ror:4 row_mask:0xf bank_mask:0xf
    s_nop 0
    v_readfirstlane_b32 s63, v156
    s_cmp_eq_u64 s[8:9], -1
    s_nop 3
    s_cbranch_scc0 .et_10
    s_lshr_b32 s63, s63, 3
    s_sub_u32 s63, s63, 300
    s_add_u32 s30, s30, s63
    s_add_u32 s31, s31, s63
.et_10:
    s_and_b32 s0, s0, 0xffffff80
    s_sub_u32 s0, s0, 1024
    buffer_load_dword v28, v4, s[36:39], s0 offen sc1
    s_memrealtime s[8:9]
    s_waitcnt lgkmcnt(0)
    s_sub_u32 s8, s8, s30
    s_cmpk_ge_u32 s8, 1342
    s_cbranch_scc1 .ap_11
    s_waitcnt vmcnt(5)
    s_cmpk_ge_u32 s8, 1242
    s_cbranch_scc1 .ap_11
    s_waitcnt vmcnt(4)
    s_bitcmp1_b64 s[14:15], 31
    s_cbranch_scc0 1
    s_waitcnt vmcnt(3)
    s_cmpk_ge_u32 s8, 1122
    s_cbranch_scc1 .ap_11
    s_waitcnt vmcnt(2)
.ap_11:
    s_add_u32 s63, s69, 450560
    buffer_load_dwordx4 v[156:159], v1, s[40:43], s63 offen nt
    s_memrealtime s[8:9]
    s_waitcnt lgkmcnt(0)
    s_sub_u32 s8, s8, s30
    s_cmpk_ge_u32 s8, 1369
    s_cbranch_scc1 .ap_12
    s_waitcnt vmcnt(6)
    s_cmpk_ge_u32 s8, 1269
    s_cbranch_scc1 .ap_12
    s_waitcnt vmcnt(4)
    s_bitcmp1_b64 s[14:15], 32
    s_cbranch_scc0 1
    s_waitcnt vmcnt(3)
    s_cmpk_ge_u32 s8, 1149
    s_cbranch_scc1 .ap_12
    s_waitcnt vmcnt(2)
.ap_12:
    v_bfe_u32 v1, v0, 4, 2
    v_and_b32 v10, 0xf0, v2
    v_lshlrev_b32 v1, 2, v1
    v_bfe_u32 v1, s6, v1, 4
    v_lshl_add_u32 v1, v1, 8, v10
    s_add_u32 s63, s69, 0
    buffer_load_dwordx4 v[160:163], v1, s[44:47], s63 offen nt
    s_memrealtime s[8:9]
    s_waitcnt lgkmcnt(0)
    s_sub_u32 s8, s8, s30
    s_cmpk_ge_u32 s8, 1396
    s_cbranch_scc1 .ap_13
    s_waitcnt vmcnt(6)
    s_cmpk_ge_u32 s8, 1296
    s_cbranch_scc1 .ap_13
    s_waitcnt vmcnt(4)
    s_bitcmp1_b64 s[14:15], 33
    s_cbranch_scc0 1
    s_waitcnt vmcnt(3)
    s_cmpk_ge_u32 s8, 1176
    s_cbranch_scc1 .ap_13
    s_waitcnt vmcnt(1)
.ap_13:
    s_add_u32 s63, s69, 8192
    buffer_load_dwordx4 v[164:167], v1, s[44:47], s63 offen nt
    s_memrealtime s[8:9]
    s_waitcnt lgkmcnt(0)
    s_sub_u32 s8, s8, s30
    s_cmpk_ge_u32 s8, 1423
    s_cbranch_scc1 .ap_14
    s_waitcnt vmcnt(6)
    s_cmpk_ge_u32 s8, 1323
    s_cbranch_scc1 .ap_14
    s_branch .Lsk_n1_0
.Lst_n1_0:
    s_branch .Lrt_n1_0
.Lsk_n1_0:
    s_waitcnt vmcnt(4)
    s_bitcmp1_b64 s[14:15], 34
    s_cbranch_scc0 1
    s_waitcnt vmcnt(2)
    s_cmpk_ge_u32 s8, 1203
    s_cbranch_scc1 .ap_14
    s_waitcnt vmcnt(1)
.ap_14:
    s_add_u32 s63, s69, 16384
    buffer_load_dwordx4 v[168:171], v1, s[44:47], s63 offen nt
    s_memrealtime s[8:9]
    s_waitcnt lgkmcnt(0)
    s_sub_u32 s8, s8, s30
    s_cmpk_ge_u32 s8, 1450
    s_cbranch_scc1 .ap_15
    s_waitcnt vmcnt(6)
    s_cmpk_ge_u32 s8, 1350
    s_cbranch_scc1 .ap_15
    s_waitcnt vmcnt(3)
    s_bitcmp1_b64 s[14:15], 35
    s_cbranch_scc0 1
    s_waitcnt vmcnt(2)
    s_cmpk_ge_u32 s8, 1230
    s_cbranch_scc1 .ap_15
    s_waitcnt vmcnt(1)
.ap_15:
    s_add_u32 s63, s69, 24576
    buffer_load_dwordx4 v[172:175], v1, s[44:47], s63 offen nt
    s_waitcnt vmcnt(5)
    v_cmp_eq_u32 vcc, s1, v28
    s_cmp_eq_u64 vcc, -1
    s_cselect_b32 s0, 0x800000, 0
    s_add_u32 s58, s58, s0
    buffer_load_dwordx4 v[16:19], v7, s[36:39], s58 offen offset:0 sc1
    buffer_load_dwordx4 v[20:23], v7, s[36:39], s58 offen offset:256 sc1
    s_memrealtime s[8:9]
    s_waitcnt lgkmcnt(0)
    s_sub_u32 s8, s8, s30
    s_cmpk_ge_u32 s8, 1479
    s_cbranch_scc1 .ap_16
    s_waitcnt vmcnt(5)
    s_cmpk_ge_u32 s8, 1379
    s_cbranch_scc1 .ap_16
    s_waitcnt vmcnt(3)
    s_bitcmp1_b64 s[14:15], 36
    s_cbranch_scc0 1
    s_waitcnt vmcnt(2)
    s_cmpk_ge_u32 s8, 1259
    s_cbranch_scc1 .ap_16
    s_waitcnt vmcnt(1)
.ap_16:
    s_add_u32 s63, s69, 32768
    buffer_load_dwordx4 v[176:179], v1, s[44:47], s63 offen nt
    s_memrealtime s[8:9]
    s_waitcnt lgkmcnt(0)
    s_sub_u32 s8, s8, s30
    s_cmpk_ge_u32 s8, 1509
    s_cbranch_scc1 .ap_17
    s_waitcnt vmcnt(5)
    s_cmpk_ge_u32 s8, 1409
    s_cbranch_scc1 .ap_17
    s_waitcnt vmcnt(3)
    s_bitcmp1_b64 s[14:15], 37
    s_cbranch_scc0 1
    s_waitcnt vmcnt(2)
    s_cmpk_ge_u32 s8, 1289
    s_cbranch_scc1 .ap_17
    s_waitcnt vmcnt(1)
.ap_17:
    s_add_u32 s63, s69, 40960
    buffer_load_dwordx4 v[180:183], v1, s[44:47], s63 offen nt
    s_memrealtime s[8:9]
    s_waitcnt vmcnt(8)
    s_waitcnt lgkmcnt(0)
    s_sub_u32 s8, s8, s30
    s_cmpk_ge_u32 s8, 1539
    s_cbranch_scc1 .ap_18
    s_waitcnt vmcnt(5)
    s_cmpk_ge_u32 s8, 1439
    s_cbranch_scc1 .ap_18
    s_waitcnt vmcnt(3)
    s_bitcmp1_b64 s[14:15], 38
    s_cbranch_scc0 1
    s_waitcnt vmcnt(2)
    s_cmpk_ge_u32 s8, 1319
    s_cbranch_scc1 .ap_18
    s_waitcnt vmcnt(1)
.ap_18:
    s_add_u32 s63, s69, 49152
    buffer_load_dwordx4 v[184:187], v1, s[44:47], s63 offen nt
    s_waitcnt vmcnt(3)
    s_branch .gpc_20
.gp_19:
    s_xor_b32 s58, s58, 0x800000
    buffer_load_dwordx4 v[16:19], v7, s[36:39], s58 offen offset:0 sc1
    buffer_load_dwordx4 v[20:23], v7, s[36:39], s58 offen offset:256 sc1
    s_waitcnt vmcnt(0)
.gpc_20:
    v_min_u32 v10, v17, v19
    v_max_u32 v11, v17, v19
    v_min3_u32 v10, v10, v21, v23
    v_max3_u32 v11, v11, v21, v23
    v_cmp_eq_u32 vcc, s34, v10
    v_cmp_eq_u32 s[56:57], s34, v11
    s_and_b64 vcc, vcc, s[56:57]
    s_cmp_eq_u64 vcc, -1
    s_nop 2
    s_cbranch_scc1 .gpd_21
    s_sub_u32 s35, s35, 1
    s_cbranch_scc1 .Lexit
    s_sleep 1
    s_branch .gp_19
.gpd_21:
    s_mov_b32 vcc_lo, 0xcccccccc
    s_mov_b32 vcc_hi, 0xcccccccc
    v_cndmask_b32_e64 v24, v16, 0, vcc
    v_cndmask_b32_e64 v25, v18, 0, vcc
    v_cndmask_b32_e64 v26, v20, 0, vcc
    v_cndmask_b32_e64 v27, v22, 0, vcc
    v_cndmask_b32_e32 v28, 0, v16, vcc
    v_cndmask_b32_e32 v29, 0, v18, vcc
    v_cndmask_b32_e32 v30, 0, v20, vcc
    v_cndmask_b32_e32 v31, 0, v22, vcc
    v_mfma_f32_16x16x32_bf16 v[16:19], v[32:35], v[24:27], 0
    v_mfma_f32_16x16x32_bf16 v[32:35], v[40:43], v[24:27], 0
    v_mfma_f32_16x16x32_bf16 v[16:19], v[36:39], v[28:31], v[16:19]
    v_mfma_f32_16x16x32_bf16 v[40:43], v[48:51], v[24:27], 0
    v_mfma_f32_16x16x32_bf16 v[32:35], v[44:47], v[28:31], v[32:35]
    v_mfma_f32_16x16x32_bf16 v[48:51], v[56:59], v[24:27], 0
    v_mfma_f32_16x16x32_bf16 v[40:43], v[52:55], v[28:31], v[40:43]
    v_mfma_f32_16x16x32_bf16 v[56:59], v[64:67], v[24:27], 0
    v_mfma_f32_16x16x32_bf16 v[48:51], v[60:63], v[28:31], v[48:51]
    s_nop 1
    v_add_f32_dpp v10, v17, v16 row_ror:12 row_mask:0xf bank_mask:0x1
    s_memrealtime s[8:9]
    s_waitcnt lgkmcnt(0)
    s_sub_u32 s8, s8, s30
    s_cmpk_ge_u32 s8, 1569
    s_nop 0
    s_cbranch_scc1 .ap_22
    s_waitcnt vmcnt(3)
    s_cmpk_ge_u32 s8, 1469
    s_cbranch_scc1 .ap_22
    s_waitcnt vmcnt(3)
    s_bitcmp1_b64 s[14:15], 39
    s_cbranch_scc0 1
    s_waitcnt vmcnt(2)
    s_cmpk_ge_u32 s8, 1349
    s_cbranch_scc1 .ap_22
    s_waitcnt vmcnt(1)
.ap_22:
    s_add_u32 s63, s69, 57344
    buffer_load_dwordx4 v[188:191], v1, s[44:47], s63 offen nt
    v_mfma_f32_16x16x32_bf16 v[64:67], v[72:75], v[24:27], 0
    v_mfma_f32_16x16x32_bf16 v[56:59], v[68:71], v[28:31], v[56:59]
    v_add_f32_dpp v11, v33, v32 row_ror:12 row_mask:0xf bank_mask:0x1
    v_add_f32_dpp v10, v18, v10 row_ror:8 row_mask:0xf bank_mask:0x1
    v_mfma_f32_16x16x32_bf16 v[72:75], v[80:83], v[24:27], 0
    v_mfma_f32_16x16x32_bf16 v[64:67], v[76:79], v[28:31], v[64:67]
    v_add_f32_dpp v12, v41, v40 row_ror:12 row_mask:0xf bank_mask:0x1
    v_add_f32_dpp v11, v34, v11 row_ror:8 row_mask:0xf bank_mask:0x1
    v_add_f32_dpp v10, v19, v10 row_ror:4 row_mask:0xf bank_mask:0x1
    v_mfma_f32_16x16x32_bf16 v[80:83], v[88:91], v[24:27], 0
    v_mfma_f32_16x16x32_bf16 v[72:75], v[84:87], v[28:31], v[72:75]
    v_add_f32_dpp v13, v49, v48 row_ror:12 row_mask:0xf bank_mask:0x1
    v_add_f32_dpp v12, v42, v12 row_ror:8 row_mask:0xf bank_mask:0x1
    v_add_f32_dpp v11, v35, v11 row_ror:4 row_mask:0xf bank_mask:0x1
    v_mfma_f32_16x16x32_bf16 v[88:91], v[96:99], v[24:27], 0
    v_mfma_f32_16x16x32_bf16 v[80:83], v[92:95], v[28:31], v[80:83]
    v_add_f32_dpp v10, v58, v57 row_ror:12 row_mask:0xf bank_mask:0x2
    v_add_f32_dpp v13, v50, v13 row_ror:8 row_mask:0xf bank_mask:0x1
    v_add_f32_dpp v12, v43, v12 row_ror:4 row_mask:0xf bank_mask:0x1
    s_memrealtime s[8:9]
    s_waitcnt lgkmcnt(0)
    s_sub_u32 s8, s8, s30
    s_cmpk_ge_u32 s8, 1599
    s_nop 0
    s_cbranch_scc1 .ap_23
    s_waitcnt vmcnt(4)
    s_cmpk_ge_u32 s8, 1499
    s_cbranch_scc1 .ap_23
    s_waitcnt vmcnt(3)
    s_bitcmp1_b64 s[14:15], 40
    s_cbranch_scc0 1
    s_waitcnt vmcnt(2)
    s_cmpk_ge_u32 s8, 1379
    s_cbranch_scc1 .ap_23
    s_waitcnt vmcnt(1)
.ap_23:
    s_add_u32 s63, s69, 131072
    buffer_load_dwordx4 v[192:195], v1, s[44:47], s63 offen nt
    v_mfma_f32_16x16x32_bf16 v[96:99], v[104:107], v[24:27], 0
    v_mfma_f32_16x16x32_bf16 v[88:91], v[100:103], v[28:31], v[88:91]
    v_add_f32_dpp v11, v66, v65 row_ror:12 row_mask:0xf bank_mask:0x2
    v_add_f32_dpp v10, v59, v10 row_ror:8 row_mask:0xf bank_mask:0x2
    v_add_f32_dpp v13, v51, v13 row_ror:4 row_mask:0xf bank_mask:0x1
    v_mfma_f32_16x16x32_bf16 v[104:107], v[112:115], v[24:27], 0
    v_mfma_f32_16x16x32_bf16 v[96:99], v[108:111], v[28:31], v[96:99]
    v_add_f32_dpp v12, v74, v73 row_ror:12 row_mask:0xf bank_mask:0x2
    v_add_f32_dpp v11, v67, v11 row_ror:8 row_mask:0xf bank_mask:0x2
    v_add_f32_dpp v10, v56, v10 row_ror:4 row_mask:0xf bank_mask:0x2
    v_mfma_f32_16x16x32_bf16 v[112:115], v[120:123], v[24:27], 0
    v_mfma_f32_16x16x32_bf16 v[104:107], v[116:119], v[28:31], v[104:107]
    s_branch .Lsk_n1_1
.Lst_n1_1:
    s_branch .Lrt_n1_1
.Lsk_n1_1:
    v_add_f32_dpp v13, v82, v81 row_ror:12 row_mask:0xf bank_mask:0x2
    v_add_f32_dpp v12, v75, v12 row_ror:8 row_mask:0xf bank_mask:0x2
    v_add_f32_dpp v11, v64, v11 row_ror:4 row_mask:0xf bank_mask:0x2
    v_mfma_f32_16x16x32_bf16 v[120:123], v[128:131], v[24:27], 0
    v_mfma_f32_16x16x32_bf16 v[112:115], v[124:127], v[28:31], v[112:115]
    v_add_f32_dpp v10, v91, v90 row_ror:12 row_mask:0xf bank_mask:0x4
    v_add_f32_dpp v13, v83, v13 row_ror:8 row_mask:0xf bank_mask:0x2
    v_add_f32_dpp v12, v72, v12 row_ror:4 row_mask:0xf bank_mask:0x2
    s_memrealtime s[8:9]
    s_waitcnt lgkmcnt(0)
    s_sub_u32 s8, s8, s30
    s_cmpk_ge_u32 s8, 1629
    s_nop 0
    s_cbranch_scc1 .ap_24
    s_waitcnt vmcnt(5)
    s_cmpk_ge_u32 s8, 1529
    s_cbranch_scc1 .ap_24
    s_waitcnt vmcnt(3)
    s_bitcmp1_b64 s[14:15], 41
    s_cbranch_scc0 1
    s_waitcnt vmcnt(2)
    s_cmpk_ge_u32 s8, 1409
    s_cbranch_scc1 .ap_24
    s_waitcnt vmcnt(1)
.ap_24:
    s_add_u32 s63, s69, 139264
    buffer_load_dwordx4 v[196:199], v1, s[44:47], s63 offen nt
    v_mfma_f32_16x16x32_bf16 v[128:131], v[136:139], v[24:27], 0
    v_mfma_f32_16x16x32_bf16 v[120:123], v[132:135], v[28:31], v[120:123]
    v_add_f32_dpp v11, v99, v98 row_ror:12 row_mask:0xf bank_mask:0x4
    v_add_f32_dpp v10, v88, v10 row_ror:8 row_mask:0xf bank_mask:0x4
    v_add_f32_dpp v13, v80, v13 row_ror:4 row_mask:0xf bank_mask:0x2
    s_branch .Lsk_n1_2
.Lst_n1_2:
    s_branch .Lrt_n1_2
.Lsk_n1_2:
    v_mfma_f32_16x16x32_bf16 v[136:139], v[144:147], v[24:27], 0
    v_mfma_f32_16x16x32_bf16 v[128:131], v[140:143], v[28:31], v[128:131]
    v_add_f32_dpp v12, v107, v106 row_ror:12 row_mask:0xf bank_mask:0x4
    v_add_f32_dpp v11, v96, v11 row_ror:8 row_mask:0xf bank_mask:0x4
    v_add_f32_dpp v10, v89, v10 row_ror:4 row_mask:0xf bank_mask:0x4
    v_mfma_f32_16x16x32_bf16 v[144:147], v[152:155], v[24:27], 0
    v_mfma_f32_16x16x32_bf16 v[136:139], v[148:151], v[28:31], v[136:139]
    v_add_f32_dpp v13, v115, v114 row_ror:12 row_mask:0xf bank_mask:0x4
    v_add_f32_dpp v12, v104, v12 row_ror:8 row_mask:0xf bank_mask:0x4
    v_add_f32_dpp v11, v97, v11 row_ror:4 row_mask:0xf bank_mask:0x4
    v_mfma_f32_16x16x32_bf16 v[144:147], v[156:159], v[28:31], v[144:147]
    v_add_f32_dpp v10, v120, v123 row_ror:12 row_mask:0xf bank_mask:0x8
    v_add_f32_dpp v13, v112, v13 row_ror:8 row_mask:0xf bank_mask:0x4
    v_add_f32_dpp v12, v105, v12 row_ror:4 row_mask:0xf bank_mask:0x4
    s_memrealtime s[8:9]
    s_waitcnt lgkmcnt(0)
    s_sub_u32 s8, s8, s30
    s_cmpk_ge_u32 s8, 1659
    s_nop 0
    s_cbranch_scc1 .ap_25
    s_waitcnt vmcnt(5)
    s_cmpk_ge_u32 s8, 1559
    s_cbranch_scc1 .ap_25
    s_waitcnt vmcnt(3)
    s_bitcmp1_b64 s[14:15], 42
    s_cbranch_scc0 1
    s_waitcnt vmcnt(2)
    s_cmpk_ge_u32 s8, 1439
    s_cbranch_scc1 .ap_25
    s_waitcnt vmcnt(1)
.ap_25:
    s_add_u32 s63, s69, 147456
    buffer_load_dwordx4 v[200:203], v1, s[44:47], s63 offen nt
    v_add_f32_dpp v11, v128, v131 row_ror:12 row_mask:0xf bank_mask:0x8
    v_add_f32_dpp v10, v121, v10 row_ror:8 row_mask:0xf bank_mask:0x8
    v_add_f32_dpp v13, v113, v13 row_ror:4 row_mask:0xf bank_mask:0x4
    v_add_f32_dpp v12, v136, v139 row_ror:12 row_mask:0xf bank_mask:0x8
    v_add_f32_dpp v11, v129, v11 row_ror:8 row_mask:0xf bank_mask:0x8
    v_add_f32_dpp v10, v122, v10 row_ror:4 row_mask:0xf bank_mask:0x8
    v_add_f32_dpp v13, v144, v147 row_ror:12 row_mask:0xf bank_mask:0x8
    v_add_f32_dpp v12, v137, v12 row_ror:8 row_mask:0xf bank_mask:0x8
    v_add_f32_dpp v11, v130, v11 row_ror:4 row_mask:0xf bank_mask:0x8
    v_add_f32_dpp v13, v145, v13 row_ror:8 row_mask:0xf bank_mask:0x8
    v_add_f32_dpp v12, v138, v12 row_ror:4 row_mask:0xf bank_mask:0x8
    s_memrealtime s[8:9]
    s_waitcnt lgkmcnt(0)
    s_sub_u32 s8, s8, s30
    s_cmpk_ge_u32 s8, 1689
    s_cbranch_scc1 .ap_26
    s_waitcnt vmcnt(5)
    s_cmpk_ge_u32 s8, 1589
    s_cbranch_scc1 .ap_26
    s_waitcnt vmcnt(3)
    s_bitcmp1_b64 s[14:15], 43
    s_cbranch_scc0 1
    s_waitcnt vmcnt(2)
    s_cmpk_ge_u32 s8, 1469
    s_cbranch_scc1 .ap_26
    s_waitcnt vmcnt(1)
.ap_26:
    s_add_u32 s63, s69, 155648
    buffer_load_dwordx4 v[204:207], v1, s[44:47], s63 offen nt
    v_add_f32_dpp v13, v146, v13 row_ror:4 row_mask:0xf bank_mask:0x8
    s_mov_b32 s60, 0x3db504f3
    s_mov_b32 s61, 0x3db504f3
    v_cvt_pk_bf16_f32 v10, v10, v11
    v_and_b32 v11, 0xffff0000, v10
    v_lshlrev_b32 v10, 16, v10
    v_cvt_pk_bf16_f32 v12, v12, v13
    v_and_b32 v13, 0xffff0000, v12
    v_lshlrev_b32 v12, 16, v12
    v_pk_mul_f32 v[10:11], v[10:11], s[60:61]
    v_pk_mul_f32 v[12:13], v[12:13], s[60:61]
    v_cvt_pk_bf16_f32 v10, v10, v11
    v_and_b32 v11, 0xffff0000, v10
    v_lshlrev_b32 v10, 16, v10
    v_cvt_pk_bf16_f32 v12, v12, v13
    v_and_b32 v13, 0xffff0000, v12
    v_lshlrev_b32 v12, 16, v12
    v_max_f32 v14, v10, v11
    v_max3_f32 v14, v14, v12, v13
    s_mov_b32 s60, 0x3fb8aa3b
    v_mov_b32 v22, s34
    v_mov_b32 v23, s34
    v_max_f32_dpp v14, v14, v14 quad_perm:[2,3,0,1] row_mask:0xf bank_mask:0xf
    s_nop 1
    v_max_f32_dpp v14, v14, v14 row_ror:4 row_mask:0xf bank_mask:0xf
    s_nop 1
    v_max_f32_dpp v14, v14, v14 row_ror:8 row_mask:0xf bank_mask:0xf
    v_mov_b32 v15, v14
    s_nop 1
    v_permlane16_swap_b32 v15, v14
    v_max_f32 v14, v15, v14
    v_mov_b32 v15, v14
    s_nop 1
    v_permlane32_swap_b32 v15, v14
    v_max_f32 v14, v15, v14
    v_mul_f32 v15, 0xbfb8aa3b, v14
    v_fma_f32 v10, v10, s60, v15
    v_fma_f32 v11, v11, s60, v15
    v_fma_f32 v12, v12, s60, v15
    v_fma_f32 v13, v13, s60, v15
    v_exp_f32 v10, v10
    v_exp_f32 v11, v11
    v_exp_f32 v12, v12
    v_exp_f32 v13, v13
    v_mov_b32 v20, v14
    v_pk_add_f32 v[16:17], v[10:11], v[12:13]
    v_add_f32 v21, v16, v17
    s_lshl_b32 s60, s68, 5
    s_lshl_b32 s61, s3, 4
    s_add_u32 s61, s61, 159104
    v_add_u32 v16, s61, v3
    v_mov_b32 v17, 159232
    v_mov_b32 v18, 1
    s_add_u32 s60, s60, s59
    v_add_f32_dpp v21, v21, v21 quad_perm:[2,3,0,1] row_mask:0xf bank_mask:0xf
    s_nop 1
    v_add_f32_dpp v21, v21, v21 row_ror:4 row_mask:0xf bank_mask:0xf
    s_nop 1
    v_add_f32_dpp v21, v21, v21 row_ror:8 row_mask:0xf bank_mask:0xf
    v_mov_b32 v15, v21
    s_nop 1
    v_permlane16_swap_b32 v15, v21
    v_add_f32 v21, v15, v21
    v_mov_b32 v15, v21
    s_nop 1
    v_permlane32_swap_b32 v15, v21
    v_add_f32 v21, v15, v21
    s_mov_b64 exec, 3
    ds_write_b64 v16, v[20:21]
    s_mov_b64 exec, 1
    ds_add_rtn_u32 v18, v17, v18
    s_mov_b64 exec, -1
    v_and_b32 v16, 0x78, v3
    v_or_b32 v16, 159104, v16
    s_waitcnt lgkmcnt(0)
    v_readfirstlane_b32 s61, v18
    s_cmp_eq_u32 s61, 7
    s_nop 3
    s_cbranch_scc0 .mlc_27
    ds_read_b64 v[18:19], v16
    s_waitcnt lgkmcnt(0)
    v_mov_b32 v20, v18
    s_nop 1
    v_max_f32_dpp v20, v20, v20 quad_perm:[2,3,0,1] row_mask:0xf bank_mask:0xf
    s_nop 1
    v_max_f32_dpp v20, v20, v20 row_ror:4 row_mask:0xf bank_mask:0xf
    s_nop 1
    v_max_f32_dpp v20, v20, v20 row_ror:8 row_mask:0xf bank_mask:0xf
    v_sub_f32 v18, v18, v20
    v_mul_f32 v18, 0x3fb8aa3b, v18
    v_exp_f32 v18, v18
    s_nop 0
    v_mul_f32 v21, v18, v19
    s_nop 1
    v_add_f32_dpp v21, v21, v21 quad_perm:[2,3,0,1] row_mask:0xf bank_mask:0xf
    s_nop 1
    v_add_f32_dpp v21, v21, v21 row_ror:4 row_mask:0xf bank_mask:0xf
    s_nop 1
    v_add_f32_dpp v21, v21, v21 row_ror:8 row_mask:0xf bank_mask:0xf
    s_mov_b64 exec, 3
    s_add_u32 s57, s60, 0x800000
    buffer_store_dwordx4 v[20:23], v2, s[36:39], s57 offen
    s_cmp_lg_u32 s0, 0
    s_nop 0
    s_cbranch_scc1 .nosl_28
    buffer_store_dwordx4 v[20:23], v2, s[36:39], s60 offen sc1
.nosl_28:
    s_mov_b64 exec, -1
.mlc_27:
    s_add_u32 s59, s59, s0
    s_memrealtime s[8:9]
    s_waitcnt lgkmcnt(0)
    s_sub_u32 s8, s8, s30
    s_cmpk_ge_u32 s8, 1719
    s_cbranch_scc1 .ap_29
    s_waitcnt vmcnt(5)
    s_cmpk_ge_u32 s8, 1619
    s_cbranch_scc1 .ap_29
    s_waitcnt vmcnt(3)
    s_bitcmp1_b64 s[14:15], 44
    s_cbranch_scc0 1
    s_waitcnt vmcnt(2)
    s_cmpk_ge_u32 s8, 1499
    s_cbranch_scc1 .ap_29
    s_waitcnt vmcnt(1)
.ap_29:
    s_add_u32 s63, s69, 163840
    buffer_load_dwordx4 v[208:211], v1, s[44:47], s63 offen nt
    s_memrealtime s[8:9]
    s_waitcnt vmcnt(8)
    s_waitcnt lgkmcnt(0)
    s_sub_u32 s8, s8, s30
    s_cmpk_ge_u32 s8, 1749
    s_cbranch_scc1 .ap_30
    s_branch .Lsk_n1_3
.Lst_n1_3:
    s_branch .Lrt_n1_3
.Lsk_n1_3:
    s_waitcnt vmcnt(5)
    s_cmpk_ge_u32 s8, 1649
    s_cbranch_scc1 .ap_30
    s_waitcnt vmcnt(3)
    s_bitcmp1_b64 s[14:15], 45
    s_cbranch_scc0 1
    s_waitcnt vmcnt(2)
    s_cmpk_ge_u32 s8, 1529
    s_cbranch_scc1 .ap_30
    s_waitcnt vmcnt(1)
.ap_30:
    s_add_u32 s63, s69, 172032
    buffer_load_dwordx4 v[212:215], v1, s[44:47], s63 offen nt
    s_memrealtime s[8:9]
    s_waitcnt vmcnt(8)
    s_waitcnt lgkmcnt(0)
    s_sub_u32 s8, s8, s30
    s_cmpk_ge_u32 s8, 1780
    s_cbranch_scc1 .ap_31
    s_waitcnt vmcnt(5)
    s_cmpk_ge_u32 s8, 1680
    s_cbranch_scc1 .ap_31
    s_waitcnt vmcnt(3)
    s_bitcmp1_b64 s[14:15], 46
    s_cbranch_scc0 1
    s_waitcnt vmcnt(2)
    s_cmpk_ge_u32 s8, 1560
    s_cbranch_scc1 .ap_31
    s_waitcnt vmcnt(1)
.ap_31:
    s_add_u32 s63, s69, 180224
    buffer_load_dwordx4 v[216:219], v1, s[44:47], s63 offen nt
    s_memrealtime s[8:9]
    s_waitcnt vmcnt(8)
    s_waitcnt lgkmcnt(0)
    s_sub_u32 s8, s8, s30
    s_cmpk_ge_u32 s8, 1812
    s_cbranch_scc1 .ap_32
    s_waitcnt vmcnt(5)
    s_cmpk_ge_u32 s8, 1712
    s_cbranch_scc1 .ap_32
    s_waitcnt vmcnt(3)
    s_bitcmp1_b64 s[14:15], 47
    s_cbranch_scc0 1
    s_waitcnt vmcnt(2)
    s_cmpk_ge_u32 s8, 1592
    s_cbranch_scc1 .ap_32
    s_waitcnt vmcnt(1)
.ap_32:
    s_add_u32 s63, s69, 188416
    buffer_load_dwordx4 v[220:223], v1, s[44:47], s63 offen nt
    s_memrealtime s[8:9]
    s_waitcnt vmcnt(8)
    s_waitcnt lgkmcnt(0)
    s_sub_u32 s8, s8, s30
    s_cmpk_ge_u32 s8, 1844
    s_cbranch_scc1 .ap_33
    s_waitcnt vmcnt(5)
    s_cmpk_ge_u32 s8, 1744
    s_cbranch_scc1 .ap_33
    s_waitcnt vmcnt(3)
    s_bitcmp1_b64 s[14:15], 48
    s_cbranch_scc0 1
    s_waitcnt vmcnt(2)
    s_cmpk_ge_u32 s8, 1624
    s_cbranch_scc1 .ap_33
    s_waitcnt vmcnt(1)
.ap_33:
    s_add_u32 s63, s69, 262144
    buffer_load_dwordx4 v[224:227], v1, s[44:47], s63 offen nt
    s_memrealtime s[8:9]
    s_waitcnt vmcnt(8)
    s_waitcnt lgkmcnt(0)
    s_sub_u32 s8, s8, s30
    s_cmpk_ge_u32 s8, 1876
    s_cbranch_scc1 .ap_34
    s_waitcnt vmcnt(5)
    s_cmpk_ge_u32 s8, 1776
    s_cbranch_scc1 .ap_34
    s_waitcnt vmcnt(3)
    s_bitcmp1_b64 s[14:15], 49
    s_cbranch_scc0 1
    s_waitcnt vmcnt(2)
    s_cmpk_ge_u32 s8, 1656
    s_cbranch_scc1 .ap_34
    s_waitcnt vmcnt(1)
.ap_34:
    s_add_u32 s63, s69, 270336
    buffer_load_dwordx4 v[228:231], v1, s[44:47], s63 offen nt
    s_memrealtime s[8:9]
    s_waitcnt vmcnt(8)
    s_waitcnt lgkmcnt(0)
    s_sub_u32 s8, s8, s30
    s_cmpk_ge_u32 s8, 1908
    s_cbranch_scc1 .ap_35
    s_waitcnt vmcnt(5)
    s_cmpk_ge_u32 s8, 1808
    s_cbranch_scc1 .ap_35
    s_waitcnt vmcnt(3)
    s_bitcmp1_b64 s[14:15], 50
    s_cbranch_scc0 1
    s_waitcnt vmcnt(2)
    s_cmpk_ge_u32 s8, 1688
    s_cbranch_scc1 .ap_35
    s_waitcnt vmcnt(1)
.ap_35:
    s_add_u32 s63, s69, 278528
    buffer_load_dwordx4 v[232:235], v1, s[44:47], s63 offen nt
    s_memrealtime s[8:9]
    s_waitcnt vmcnt(8)
    s_waitcnt lgkmcnt(0)
    s_sub_u32 s8, s8, s30
    s_cmpk_ge_u32 s8, 1939
    s_cbranch_scc1 .ap_36
    s_waitcnt vmcnt(5)
    s_cmpk_ge_u32 s8, 1839
    s_cbranch_scc1 .ap_36
    s_waitcnt vmcnt(3)
    s_bitcmp1_b64 s[14:15], 51
    s_cbranch_scc0 1
    s_waitcnt vmcnt(2)
    s_cmpk_ge_u32 s8, 1719
    s_cbranch_scc1 .ap_36
    s_waitcnt vmcnt(1)
.ap_36:
    s_add_u32 s63, s69, 286720
    buffer_load_dwordx4 v[236:239], v1, s[44:47], s63 offen nt
    s_memrealtime s[8:9]
    s_waitcnt vmcnt(8)
    s_waitcnt lgkmcnt(0)
    s_sub_u32 s8, s8, s30
    s_cmpk_ge_u32 s8, 1971
    s_cbranch_scc1 .ap_37
    s_waitcnt vmcnt(5)
    s_cmpk_ge_u32 s8, 1871
    s_cbranch_scc1 .ap_37
    s_waitcnt vmcnt(3)
    s_bitcmp1_b64 s[14:15], 52
    s_cbranch_scc0 1
    s_waitcnt vmcnt(2)
    s_cmpk_ge_u32 s8, 1751
    s_cbranch_scc1 .ap_37
    s_waitcnt vmcnt(1)
.ap_37:
    s_add_u32 s63, s69, 294912
    buffer_load_dwordx4 v[240:243], v1, s[44:47], s63 offen nt
    s_memrealtime s[8:9]
    s_waitcnt vmcnt(8)
    s_waitcnt lgkmcnt(0)
    s_sub_u32 s8, s8, s30
    s_cmpk_ge_u32 s8, 2003
    s_cbranch_scc1 .ap_38
    s_waitcnt vmcnt(5)
    s_cmpk_ge_u32 s8, 1903
    s_cbranch_scc1 .ap_38
    s_waitcnt vmcnt(3)
    s_bitcmp1_b64 s[14:15], 53
    s_cbranch_scc0 1
    s_waitcnt vmcnt(2)
    s_cmpk_ge_u32 s8, 1783
    s_cbranch_scc1 .ap_38
    s_waitcnt vmcnt(1)
.ap_38:
    s_add_u32 s63, s69, 303104
    buffer_load_dwordx4 v[244:247], v1, s[44:47], s63 offen nt
    buffer_load_dwordx4 v[24:27], v9, s[36:39], s59 offen offset:0 sc1
    s_memrealtime s[8:9]
    s_waitcnt vmcnt(8)
    s_waitcnt lgkmcnt(0)
    s_sub_u32 s8, s8, s30
    s_cmpk_ge_u32 s8, 2035
    s_cbranch_scc1 .ap_39
    s_waitcnt vmcnt(5)
    s_cmpk_ge_u32 s8, 1935
    s_cbranch_scc1 .ap_39
    s_waitcnt vmcnt(3)
    s_bitcmp1_b64 s[14:15], 54
    s_cbranch_scc0 1
    s_waitcnt vmcnt(2)
    s_cmpk_ge_u32 s8, 1815
    s_cbranch_scc1 .ap_39
    s_waitcnt vmcnt(1)
.ap_39:
    s_add_u32 s63, s69, 311296
    buffer_load_dwordx4 v[248:251], v1, s[44:47], s63 offen nt
    s_memrealtime s[8:9]
    s_waitcnt vmcnt(8)
    s_waitcnt lgkmcnt(0)
    s_sub_u32 s8, s8, s30
    s_cmpk_ge_u32 s8, 2067
    s_cbranch_scc1 .ap_40
    s_waitcnt vmcnt(5)
    s_cmpk_ge_u32 s8, 1967
    s_cbranch_scc1 .ap_40
    s_waitcnt vmcnt(3)
    s_bitcmp1_b64 s[14:15], 55
    s_cbranch_scc0 1
    s_waitcnt vmcnt(2)
    s_cmpk_ge_u32 s8, 1847
    s_cbranch_scc1 .ap_40
    s_waitcnt vmcnt(1)
.ap_40:
    s_add_u32 s63, s69, 319488
    buffer_load_dwordx4 v[252:255], v1, s[44:47], s63 offen nt
    s_memrealtime s[8:9]
    s_waitcnt vmcnt(8)
    s_waitcnt lgkmcnt(0)
    s_sub_u32 s8, s8, s30
    s_cmpk_ge_u32 s8, 2098
    s_cbranch_scc1 .ap_41
    s_waitcnt vmcnt(5)
    s_cmpk_ge_u32 s8, 1998
    s_cbranch_scc1 .ap_41
    s_waitcnt vmcnt(3)
    s_bitcmp1_b64 s[14:15], 56
    s_cbranch_scc0 1
    s_waitcnt vmcnt(2)
    s_cmpk_ge_u32 s8, 1878
    s_cbranch_scc1 .ap_41
    s_waitcnt vmcnt(1)
.ap_41:
    s_add_u32 s63, s69, 393216
    buffer_load_dwordx4 v[36:39], v1, s[44:47], s63 offen nt
    s_memrealtime s[8:9]
    s_waitcnt vmcnt(8)
    s_waitcnt lgkmcnt(0)
    s_sub_u32 s8, s8, s30
    s_cmpk_ge_u32 s8, 2130
    s_cbranch_scc1 .ap_42
    s_waitcnt vmcnt(5)
    s_cmpk_ge_u32 s8, 2030
    s_cbranch_scc1 .ap_42
    s_waitcnt vmcnt(3)
    s_bitcmp1_b64 s[14:15], 57
    s_cbranch_scc0 1
    s_waitcnt vmcnt(2)
    s_cmpk_ge_u32 s8, 1910
    s_cbranch_scc1 .ap_42
    s_waitcnt vmcnt(1)
.ap_42:
    s_add_u32 s63, s69, 401408
    buffer_load_dwordx4 v[44:47], v1, s[44:47], s63 offen nt
    s_memrealtime s[8:9]
    s_branch .Lsk_n1_4
.Lst_n1_4:
    s_branch .Lrt_n1_4
.Lsk_n1_4:
    s_waitcnt vmcnt(8)
    s_waitcnt lgkmcnt(0)
    s_sub_u32 s8, s8, s30
    s_cmpk_ge_u32 s8, 2162
    s_cbranch_scc1 .ap_43
    s_waitcnt vmcnt(5)
    s_cmpk_ge_u32 s8, 2062
    s_cbranch_scc1 .ap_43
    s_waitcnt vmcnt(3)
    s_bitcmp1_b64 s[14:15], 58
    s_cbranch_scc0 1
    s_waitcnt vmcnt(2)
    s_cmpk_ge_u32 s8, 1942
    s_cbranch_scc1 .ap_43
    s_waitcnt vmcnt(1)
.ap_43:
    s_add_u32 s63, s69, 409600
    buffer_load_dwordx4 v[52:55], v1, s[44:47], s63 offen nt
    s_waitcnt vmcnt(5)
    s_branch .gpc_45
.gp_44:
    s_xor_b32 s59, s59, 0x800000
    buffer_load_dwordx4 v[24:27], v9, s[36:39], s59 offen offset:0 sc1
    s_waitcnt vmcnt(0)
.gpc_45:
    v_cmp_eq_u32 vcc, s34, v26
    s_cmp_eq_u64 vcc, -1
    s_nop 3
    s_cbranch_scc1 .gpd_46
    s_sub_u32 s35, s35, 1
    s_cbranch_scc1 .Lexit
    s_sleep 1
    s_branch .gp_44
.gpd_46:
    v_mov_b32 v16, v24
    s_nop 1
    v_max_f32_dpp v16, v16, v16 row_ror:4 row_mask:0xf bank_mask:0xf
    v_sub_f32 v17, v24, v16
    v_sub_f32 v18, v14, v16
    v_mul_f32 v17, 0x3fb8aa3b, v17
    v_mul_f32 v18, 0x3fb8aa3b, v18
    v_exp_f32 v17, v17
    v_exp_f32 v18, v18
    v_mul_f32 v17, v17, v25
    s_nop 1
    v_add_f32_dpp v17, v17, v17 row_ror:4 row_mask:0xf bank_mask:0xf
    v_rcp_f32 v19, v17
    s_nop 0
    v_fma_f32 v15, -v17, v19, 1.0
    v_fma_f32 v19, v15, v19, v19
    v_mul_f32 v18, v18, v19
    v_mul_f32 v10, v10, v18
    v_mul_f32 v11, v11, v18
    v_mul_f32 v12, v12, v18
    v_mul_f32 v13, v13, v18
    v_mov_b32_dpp v112, v10 quad_perm:[2,3,0,1] row_mask:0xf bank_mask:0xf
    v_mov_b32_dpp v113, v11 quad_perm:[2,3,0,1] row_mask:0xf bank_mask:0xf
    v_mov_b32_dpp v114, v12 quad_perm:[2,3,0,1] row_mask:0xf bank_mask:0xf
    v_mov_b32_dpp v115, v13 quad_perm:[2,3,0,1] row_mask:0xf bank_mask:0xf
    v_cvt_pk_bf16_f32 v96, v10, v112
    v_cvt_pk_bf16_f32 v100, v11, v113
    v_cvt_pk_bf16_f32 v104, v12, v114
    v_cvt_pk_bf16_f32 v108, v13, v115
    v_mov_b32_dpp v97, v96 row_ror:12 row_mask:0xf bank_mask:0xf
    v_mov_b32_dpp v101, v100 row_ror:12 row_mask:0xf bank_mask:0xf
    v_mov_b32_dpp v105, v104 row_ror:12 row_mask:0xf bank_mask:0xf
    v_mov_b32_dpp v109, v108 row_ror:12 row_mask:0xf bank_mask:0xf
    v_mov_b32_dpp v98, v96 row_ror:8 row_mask:0xf bank_mask:0xf
    v_mov_b32_dpp v102, v100 row_ror:8 row_mask:0xf bank_mask:0xf
    v_mov_b32_dpp v106, v104 row_ror:8 row_mask:0xf bank_mask:0xf
    v_mov_b32_dpp v110, v108 row_ror:8 row_mask:0xf bank_mask:0xf
    v_mov_b32_dpp v99, v96 row_ror:4 row_mask:0xf bank_mask:0xf
    v_mov_b32_dpp v103, v100 row_ror:4 row_mask:0xf bank_mask:0xf
    v_mov_b32_dpp v107, v104 row_ror:4 row_mask:0xf bank_mask:0xf
    v_mov_b32_dpp v111, v108 row_ror:4 row_mask:0xf bank_mask:0xf
    s_lshl_b32 s60, s3, 10
    s_add_u32 s60, s60, 147456
    v_lshlrev_b32 v10, 5, v0
    v_add_u32 v10, s60, v10
    s_memrealtime s[8:9]
    s_waitcnt lgkmcnt(0)
    s_sub_u32 s8, s8, s30
    s_cmpk_ge_u32 s8, 2194
    s_cbranch_scc1 .ap_47
    s_waitcnt vmcnt(5)
    s_cmpk_ge_u32 s8, 2094
    s_cbranch_scc1 .ap_47
    s_waitcnt vmcnt(3)
    s_bitcmp1_b64 s[14:15], 59
    s_cbranch_scc0 1
    s_waitcnt vmcnt(2)
    s_cmpk_ge_u32 s8, 1974
    s_cbranch_scc1 .ap_47
    s_waitcnt vmcnt(1)
.ap_47:
    s_add_u32 s63, s69, 417792
    buffer_load_dwordx4 v[60:63], v1, s[44:47], s63 offen nt
    v_perm_b32 v112, v164, v160, s94
    v_perm_b32 v113, v172, v168, s94
    v_perm_b32 v114, v180, v176, s94
    v_perm_b32 v115, v188, v184, s94
    s_nop 1
    v_mfma_f32_16x16x32_bf16 v[128:131], v[96:99], v[112:115], 0
    v_perm_b32 v116, v164, v160, s95
    v_perm_b32 v117, v172, v168, s95
    v_perm_b32 v118, v180, v176, s95
    v_perm_b32 v119, v188, v184, s95
    s_nop 1
    v_mfma_f32_16x16x32_bf16 v[132:135], v[96:99], v[116:119], 0
    v_perm_b32 v120, v165, v161, s94
    v_perm_b32 v121, v173, v169, s94
    v_perm_b32 v122, v181, v177, s94
    v_perm_b32 v123, v189, v185, s94
    s_nop 1
    v_mfma_f32_16x16x32_bf16 v[136:139], v[96:99], v[120:123], 0
    v_perm_b32 v124, v165, v161, s95
    v_perm_b32 v125, v173, v169, s95
    v_perm_b32 v126, v181, v177, s95
    v_perm_b32 v127, v189, v185, s95
    s_nop 1
    v_mfma_f32_16x16x32_bf16 v[140:143], v[96:99], v[124:127], 0
    v_perm_b32 v112, v166, v162, s94
    v_perm_b32 v113, v174, v170, s94
    v_perm_b32 v114, v182, v178, s94
    v_perm_b32 v115, v190, v186, s94
    s_nop 1
    v_mfma_f32_16x16x32_bf16 v[144:147], v[96:99], v[112:115], 0
    v_perm_b32 v116, v166, v162, s95
    v_perm_b32 v117, v174, v170, s95
    v_perm_b32 v118, v182, v178, s95
    v_perm_b32 v119, v190, v186, s95
    s_nop 1
    v_mfma_f32_16x16x32_bf16 v[148:151], v[96:99], v[116:119], 0
    v_perm_b32 v120, v167, v163, s94
    v_perm_b32 v121, v175, v171, s94
    v_perm_b32 v122, v183, v179, s94
    v_perm_b32 v123, v191, v187, s94
    s_nop 1
    v_mfma_f32_16x16x32_bf16 v[152:155], v[96:99], v[120:123], 0
    v_perm_b32 v124, v167, v163, s95
    v_perm_b32 v125, v175, v171, s95
    v_perm_b32 v126, v183, v179, s95
    v_perm_b32 v127, v191, v187, s95
    s_nop 1
    v_mfma_f32_16x16x32_bf16 v[156:159], v[96:99], v[124:127], 0
    s_memrealtime s[8:9]
    s_waitcnt lgkmcnt(0)
    s_sub_u32 s8, s8, s30
    s_cmpk_ge_u32 s8, 2226
    s_nop 3
    s_cbranch_scc1 .ap_48
    s_waitcnt vmcnt(5)
    s_cmpk_ge_u32 s8, 2126
    s_cbranch_scc1 .ap_48
    s_waitcnt vmcnt(3)
    s_bitcmp1_b64 s[14:15], 60
    s_cbranch_scc0 1
    s_waitcnt vmcnt(2)
    s_cmpk_ge_u32 s8, 2006
    s_cbranch_scc1 .ap_48
    s_waitcnt vmcnt(1)
.ap_48:
    s_add_u32 s63, s69, 425984
    buffer_load_dwordx4 v[68:71], v1, s[44:47], s63 offen nt
    v_perm_b32 v112, v196, v192, s94
    v_perm_b32 v113, v204, v200, s94
    v_perm_b32 v114, v212, v208, s94
    v_perm_b32 v115, v220, v216, s94
    s_nop 1
    v_mfma_f32_16x16x32_bf16 v[128:131], v[100:103], v[112:115], v[128:131]
    v_perm_b32 v116, v196, v192, s95
    v_perm_b32 v117, v204, v200, s95
    v_perm_b32 v118, v212, v208, s95
    v_perm_b32 v119, v220, v216, s95
    s_nop 1
    v_mfma_f32_16x16x32_bf16 v[132:135], v[100:103], v[116:119], v[132:135]
    v_perm_b32 v120, v197, v193, s94
    v_perm_b32 v121, v205, v201, s94
    v_perm_b32 v122, v213, v209, s94
    v_perm_b32 v123, v221, v217, s94
    s_nop 1
    v_mfma_f32_16x16x32_bf16 v[136:139], v[100:103], v[120:123], v[136:139]
    v_perm_b32 v124, v197, v193, s95
    s_branch .Lsk_n1_5
.Lst_n1_5:
    s_branch .Lrt_n1_5
.Lsk_n1_5:
    v_perm_b32 v125, v205, v201, s95
    v_perm_b32 v126, v213, v209, s95
    v_perm_b32 v127, v221, v217, s95
    s_nop 1
    v_mfma_f32_16x16x32_bf16 v[140:143], v[100:103], v[124:127], v[140:143]
    v_perm_b32 v112, v198, v194, s94
    v_perm_b32 v113, v206, v202, s94
    v_perm_b32 v114, v214, v210, s94
    v_perm_b32 v115, v222, v218, s94
    s_nop 1
    v_mfma_f32_16x16x32_bf16 v[144:147], v[100:103], v[112:115], v[144:147]
    v_perm_b32 v116, v198, v194, s95
    v_perm_b32 v117, v206, v202, s95
    v_perm_b32 v118, v214, v210, s95
    v_perm_b32 v119, v222, v218, s95
    s_nop 1
    v_mfma_f32_16x16x32_bf16 v[148:151], v[100:103], v[116:119], v[148:151]
    v_perm_b32 v120, v199, v195, s94
    v_perm_b32 v121, v207, v203, s94
    v_perm_b32 v122, v215, v211, s94
    v_perm_b32 v123, v223, v219, s94
    s_nop 1
    v_mfma_f32_16x16x32_bf16 v[152:155], v[100:103], v[120:123], v[152:155]
    v_perm_b32 v124, v199, v195, s95
    v_perm_b32 v125, v207, v203, s95
    v_perm_b32 v126, v215, v211, s95
    v_perm_b32 v127, v223, v219, s95
    s_nop 1
    v_mfma_f32_16x16x32_bf16 v[156:159], v[100:103], v[124:127], v[156:159]
    s_memrealtime s[8:9]
    s_waitcnt lgkmcnt(0)
    s_sub_u32 s8, s8, s30
    s_cmpk_ge_u32 s8, 2257
    s_nop 3
    s_cbranch_scc1 .ap_49
    s_waitcnt vmcnt(5)
    s_cmpk_ge_u32 s8, 2157
    s_cbranch_scc1 .ap_49
    s_waitcnt vmcnt(3)
    s_bitcmp1_b64 s[14:15], 61
    s_cbranch_scc0 1
    s_waitcnt vmcnt(2)
    s_cmpk_ge_u32 s8, 2037
    s_cbranch_scc1 .ap_49
    s_waitcnt vmcnt(1)
.ap_49:
    s_add_u32 s63, s69, 434176
    buffer_load_dwordx4 v[76:79], v1, s[44:47], s63 offen nt
    s_waitcnt vmcnt(6)
    v_perm_b32 v112, v228, v224, s94
    v_perm_b32 v113, v236, v232, s94
    v_perm_b32 v114, v244, v240, s94
    v_perm_b32 v115, v252, v248, s94
    s_nop 1
    v_mfma_f32_16x16x32_bf16 v[128:131], v[104:107], v[112:115], v[128:131]
    v_perm_b32 v116, v228, v224, s95
    v_perm_b32 v117, v236, v232, s95
    v_perm_b32 v118, v244, v240, s95
    v_perm_b32 v119, v252, v248, s95
    s_nop 1
    v_mfma_f32_16x16x32_bf16 v[132:135], v[104:107], v[116:119], v[132:135]
    v_perm_b32 v120, v229, v225, s94
    v_perm_b32 v121, v237, v233, s94
    v_perm_b32 v122, v245, v241, s94
    v_perm_b32 v123, v253, v249, s94
    s_nop 1
    v_mfma_f32_16x16x32_bf16 v[136:139], v[104:107], v[120:123], v[136:139]
    v_perm_b32 v124, v229, v225, s95
    v_perm_b32 v125, v237, v233, s95
    v_perm_b32 v126, v245, v241, s95
    v_perm_b32 v127, v253, v249, s95
    s_nop 1
    v_mfma_f32_16x16x32_bf16 v[140:143], v[104:107], v[124:127], v[140:143]
    v_perm_b32 v112, v230, v226, s94
    v_perm_b32 v113, v238, v234, s94
    v_perm_b32 v114, v246, v242, s94
    v_perm_b32 v115, v254, v250, s94
    s_nop 1
    v_mfma_f32_16x16x32_bf16 v[144:147], v[104:107], v[112:115], v[144:147]
    v_perm_b32 v116, v230, v226, s95
    v_perm_b32 v117, v238, v234, s95
    v_perm_b32 v118, v246, v242, s95
    v_perm_b32 v119, v254, v250, s95
    s_nop 1
    v_mfma_f32_16x16x32_bf16 v[148:151], v[104:107], v[116:119], v[148:151]
    v_perm_b32 v120, v231, v227, s94
    v_perm_b32 v121, v239, v235, s94
    v_perm_b32 v122, v247, v243, s94
    v_perm_b32 v123, v255, v251, s94
    s_nop 1
    v_mfma_f32_16x16x32_bf16 v[152:155], v[104:107], v[120:123], v[152:155]
    v_perm_b32 v124, v231, v227, s95
    v_perm_b32 v125, v239, v235, s95
    v_perm_b32 v126, v247, v243, s95
    v_perm_b32 v127, v255, v251, s95
    s_nop 1
    v_mfma_f32_16x16x32_bf16 v[156:159], v[104:107], v[124:127], v[156:159]
    s_memrealtime s[8:9]
    s_waitcnt lgkmcnt(0)
    s_sub_u32 s8, s8, s30
    s_cmpk_ge_u32 s8, 2289
    s_nop 3
    s_cbranch_scc1 .ap_50
    s_waitcnt vmcnt(5)
    s_cmpk_ge_u32 s8, 2189
    s_cbranch_scc1 .ap_50
    s_waitcnt vmcnt(3)
    s_bitcmp1_b64 s[14:15], 62
    s_cbranch_scc0 1
    s_waitcnt vmcnt(2)
    s_cmpk_ge_u32 s8, 2069
    s_cbranch_scc1 .ap_50
    s_waitcnt vmcnt(1)
.ap_50:
    s_add_u32 s63, s69, 442368
    buffer_load_dwordx4 v[84:87], v1, s[44:47], s63 offen nt
    s_memrealtime s[8:9]
    s_waitcnt lgkmcnt(0)
    s_sub_u32 s8, s8, s30
    s_cmpk_ge_u32 s8, 2321
    s_cbranch_scc1 .ap_51
    s_waitcnt vmcnt(5)
    s_cmpk_ge_u32 s8, 2221
    s_cbranch_scc1 .ap_51
    s_waitcnt vmcnt(3)
    s_bitcmp1_b64 s[14:15], 63
    s_cbranch_scc0 1
    s_waitcnt vmcnt(2)
    s_cmpk_ge_u32 s8, 2101
    s_cbranch_scc1 .ap_51
    s_waitcnt vmcnt(1)
.ap_51:
    s_add_u32 s63, s69, 450560
    buffer_load_dwordx4 v[92:95], v1, s[44:47], s63 offen nt
    s_setprio 0
    s_branch .Lsk_n1_6
.Lst_n1_6:
    s_branch .Lrt_n1_6
.Lsk_n1_6:
    s_waitcnt vmcnt(6)
    v_perm_b32 v160, v44, v36, s94
    v_perm_b32 v164, v44, v36, s95
    v_perm_b32 v168, v45, v37, s94
    v_perm_b32 v172, v45, v37, s95
    v_perm_b32 v176, v46, v38, s94
    v_perm_b32 v180, v46, v38, s95
    v_perm_b32 v184, v47, v39, s94
    v_perm_b32 v188, v47, v39, s95
    s_waitcnt vmcnt(4)
    v_perm_b32 v161, v60, v52, s94
    v_perm_b32 v165, v60, v52, s95
    v_perm_b32 v169, v61, v53, s94
    v_perm_b32 v173, v61, v53, s95
    v_perm_b32 v177, v62, v54, s94
    v_perm_b32 v181, v62, v54, s95
    v_perm_b32 v185, v63, v55, s94
    v_perm_b32 v189, v63, v55, s95
    s_waitcnt vmcnt(2)
    v_perm_b32 v162, v76, v68, s94
    v_perm_b32 v166, v76, v68, s95
    v_perm_b32 v170, v77, v69, s94
    v_perm_b32 v174, v77, v69, s95
    v_perm_b32 v178, v78, v70, s94
    v_perm_b32 v182, v78, v70, s95
    v_perm_b32 v186, v79, v71, s94
    v_perm_b32 v190, v79, v71, s95
    s_waitcnt vmcnt(0)
    s_cmp_lt_u32 s65, 8
    s_cbranch_scc1 .wol_52
    s_lshl_b32 s56, s3, 10
    s_add_u32 m0, s56, 24576
    s_add_u32 s56, s101, 221184
    s_mov_b64 exec, s[18:19]
    buffer_load_dwordx4 v6, s[48:51], s56 offen nt lds
    s_mov_b64 exec, -1
    s_lshl_b32 s56, s3, 10
    s_add_u32 m0, s56, 57344
    s_add_u32 s56, s101, 221312
    s_mov_b64 exec, s[18:19]
    buffer_load_dwordx4 v6, s[48:51], s56 offen nt lds
    s_mov_b64 exec, -1
    s_lshl_b32 s56, s3, 10
    s_add_u32 m0, s56, 90112
    s_add_u32 s56, s101, 221440
    s_mov_b64 exec, s[18:19]
    buffer_load_dwordx4 v6, s[48:51], s56 offen nt lds
    s_mov_b64 exec, -1
.wol_52:
    v_perm_b32 v163, v92, v84, s94
    v_perm_b32 v167, v92, v84, s95
    v_perm_b32 v171, v93, v85, s94
    v_mfma_f32_16x16x32_bf16 v[128:131], v[108:111], v[160:163], v[128:131]
    v_perm_b32 v175, v93, v85, s95
    v_mfma_f32_16x16x32_bf16 v[132:135], v[108:111], v[164:167], v[132:135]
    v_perm_b32 v179, v94, v86, s94
    v_mfma_f32_16x16x32_bf16 v[136:139], v[108:111], v[168:171], v[136:139]
    v_perm_b32 v183, v94, v86, s95
    v_mfma_f32_16x16x32_bf16 v[140:143], v[108:111], v[172:175], v[140:143]
    v_perm_b32 v187, v95, v87, s94
    v_mfma_f32_16x16x32_bf16 v[144:147], v[108:111], v[176:179], v[144:147]
    v_perm_b32 v191, v95, v87, s95
    v_mfma_f32_16x16x32_bf16 v[148:151], v[108:111], v[180:183], v[148:151]
    v_mfma_f32_16x16x32_bf16 v[152:155], v[108:111], v[184:187], v[152:155]
    v_mfma_f32_16x16x32_bf16 v[156:159], v[108:111], v[188:191], v[156:159]
    s_mov_b64 exec, 0xffff
    ds_write2_b32 v10, v128, v129 offset0:0 offset1:128
    ds_write2_b32 v10, v132, v133 offset0:1 offset1:129
    ds_write2_b32 v10, v136, v137 offset0:2 offset1:130
    ds_write2_b32 v10, v140, v141 offset0:3 offset1:131
    ds_write2_b32 v10, v144, v145 offset0:4 offset1:132
    ds_write2_b32 v10, v148, v149 offset0:5 offset1:133
    ds_write2_b32 v10, v152, v153 offset0:6 offset1:134
    ds_write2_b32 v10, v156, v157 offset0:7 offset1:135
    s_mov_b64 exec, -1
    s_waitcnt lgkmcnt(0)
    s_barrier
    s_cmp_lg_u32 s3, 7
    s_cbranch_scc1 .opub_53
    v_add_u32 v10, 147456, v2
    ds_read_b128 v[196:199], v10 offset:0
    ds_read_b128 v[200:203], v10 offset:1024
    ds_read_b128 v[204:207], v10 offset:2048
    ds_read_b128 v[208:211], v10 offset:3072
    ds_read_b128 v[212:215], v10 offset:4096
    ds_read_b128 v[216:219], v10 offset:5120
    ds_read_b128 v[220:223], v10 offset:6144
    ds_read_b128 v[224:227], v10 offset:7168
    v_lshrrev_b32 v11, 5, v0
    v_lshlrev_b32 v11, 13, v11
    v_and_b32 v12, 31, v0
    v_lshl_add_u32 v11, v12, 4, v11
    s_lshl4_add_u32 s56, s67, s66
    s_lshl1_add_u32 s56, s56, s68
    s_lshl_b32 s56, s56, 9
    s_add_u32 s56, s56, 0xa0000
    s_mov_b32 s60, 0x07060503
    s_mov_b32 s61, 0x07060502
    s_mov_b32 s62, 0x07060501
    v_mov_b32 v15, s34
    s_waitcnt lgkmcnt(6)
    v_pk_add_f32 v[196:197], v[196:197], v[200:201]
    v_pk_add_f32 v[198:199], v[198:199], v[202:203]
    s_waitcnt lgkmcnt(5)
    v_pk_add_f32 v[196:197], v[196:197], v[204:205]
    v_pk_add_f32 v[198:199], v[198:199], v[206:207]
    s_waitcnt lgkmcnt(4)
    v_pk_add_f32 v[196:197], v[196:197], v[208:209]
    v_pk_add_f32 v[198:199], v[198:199], v[210:211]
    s_waitcnt lgkmcnt(3)
    v_pk_add_f32 v[196:197], v[196:197], v[212:213]
    v_pk_add_f32 v[198:199], v[198:199], v[214:215]
    s_waitcnt lgkmcnt(2)
    v_pk_add_f32 v[196:197], v[196:197], v[216:217]
    v_pk_add_f32 v[198:199], v[198:199], v[218:219]
    s_waitcnt lgkmcnt(1)
    v_pk_add_f32 v[196:197], v[196:197], v[220:221]
    v_pk_add_f32 v[198:199], v[198:199], v[222:223]
    s_waitcnt lgkmcnt(0)
    v_pk_add_f32 v[196:197], v[196:197], v[224:225]
    v_pk_add_f32 v[198:199], v[198:199], v[226:227]
    v_perm_b32 v12, v196, v199, s60
    v_perm_b32 v13, v197, v199, s61
    v_perm_b32 v14, v198, v199, s62
    s_add_u32 s57, s56, 0x800000
    buffer_store_dwordx4 v[12:15], v11, s[36:39], s57 offen
    s_cmp_lg_u32 s0, 0
    s_nop 0
    s_cbranch_scc1 .nosl_54
    buffer_store_dwordx4 v[12:15], v11, s[36:39], s56 offen sc1
.nosl_54:
.opub_53:
    s_cmp_lt_u32 s65, 8
    s_nop 0
    s_cbranch_scc1 .Lexit
    v_mov_b32 v6, 0
    v_bfe_u32 v7, v0, 4, 1
    v_lshl_add_u32 v6, v7, 7, v6
    v_bfe_u32 v7, v0, 2, 2
    v_lshl_add_u32 v6, v7, 5, v6
    v_bfe_u32 v7, v0, 5, 1
    v_lshl_add_u32 v6, v7, 4, v6
    v_bfe_u32 v7, v0, 0, 2
    v_lshl_add_u32 v6, v7, 2, v6
    s_mul_i32 s56, s3, 528
    s_add_u32 s56, s56, 131072
    v_add_u32 v6, s56, v6
    s_lshl4_add_u32 s101, s99, s3
    s_lshl_b32 s101, s101, 10
    s_add_u32 s101, s101, 0xa0000
    v_add_u32 v5, 8192, v2
    s_cmp_ge_u32 s3, 6
    s_nop 0
    s_cbranch_scc1 .La_w67
    v_lshrrev_b32 v16, 4, v0
    v_bfe_u32 v17, v0, 2, 2
    v_lshl_add_u32 v7, v16, 3, v17
    v_lshlrev_b32 v7, 7, v7
    v_and_b32 v16, 1, v16
    v_lshrrev_b32 v17, 1, v17
    v_lshl_add_u32 v16, v16, 1, v17
    s_and_b32 s56, s3, 1
    s_lshl_b32 s56, s56, 1
    v_xor_b32 v16, s56, v16
    v_and_b32 v17, 3, v0
    v_lshl_add_u32 v7, v17, 3, v7
    s_branch .Lsk_n1_7
.Lst_n1_7:
    s_branch .Lrt_n1_7
.Lsk_n1_7:
    s_lshr_b32 s56, s3, 1
    s_lshl_b32 s56, s56, 15
    v_add_u32 v7, s56, v7
    v_xor_b32 v17, 1, v16
    v_lshl_add_u32 v8, v17, 5, v7
    v_lshl_add_u32 v7, v16, 5, v7
    ds_read_b64_tr_b16 v[32:33], v7 offset:0
    ds_read_b64_tr_b16 v[34:35], v7 offset:512
    ds_read_b64_tr_b16 v[64:65], v8 offset:0
    ds_read_b64_tr_b16 v[66:67], v8 offset:512
    ds_read_b64_tr_b16 v[36:37], v7 offset:4096
    ds_read_b64_tr_b16 v[38:39], v7 offset:4608
    ds_read_b64_tr_b16 v[68:69], v8 offset:4096
    ds_read_b64_tr_b16 v[70:71], v8 offset:4608
    ds_read_b64_tr_b16 v[40:41], v7 offset:8192
    ds_read_b64_tr_b16 v[42:43], v7 offset:8704
    ds_read_b64_tr_b16 v[72:73], v8 offset:8192
    ds_read_b64_tr_b16 v[74:75], v8 offset:8704
    ds_read_b64_tr_b16 v[44:45], v7 offset:12288
    ds_read_b64_tr_b16 v[46:47], v7 offset:12800
    ds_read_b64_tr_b16 v[76:77], v8 offset:12288
    ds_read_b64_tr_b16 v[78:79], v8 offset:12800
    ds_read_b64_tr_b16 v[48:49], v7 offset:16384
    ds_read_b64_tr_b16 v[50:51], v7 offset:16896
    ds_read_b64_tr_b16 v[80:81], v8 offset:16384
    ds_read_b64_tr_b16 v[82:83], v8 offset:16896
    ds_read_b64_tr_b16 v[52:53], v7 offset:20480
    ds_read_b64_tr_b16 v[54:55], v7 offset:20992
    ds_read_b64_tr_b16 v[84:85], v8 offset:20480
    ds_read_b64_tr_b16 v[86:87], v8 offset:20992
    s_mov_b32 s56, 131072
    v_bfe_u32 v9, v0, 1, 3
    v_mul_u32_u24 v9, 528, v9
    v_and_b32 v16, 48, v0
    v_lshl_add_u32 v9, v16, 1, v9
    v_and_b32 v16, 1, v0
    v_lshlrev_b32 v16, 4, v16
    v_add3_u32 v9, v9, v16, s56
    v_lshrrev_b32 v10, 4, v0
    v_and_b32 v16, 1, v0
    v_lshl_add_u32 v10, v10, 1, v16
    v_mul_u32_u24 v10, 36864, v10
    v_bfe_u32 v16, v0, 1, 3
    v_lshl_add_u32 v10, v16, 4, v10
    s_mul_i32 s59, s100, 3
    s_lshr_b32 s56, s3, 1
    s_add_u32 s59, s59, s56
    s_lshl4_add_u32 s59, s59, s99
    s_and_b32 s56, s3, 1
    s_lshl1_add_u32 s59, s59, s56
    s_lshl_b32 s59, s59, 7
    s_add_u32 s59, s59, 0xe0000
    s_mul_i32 s6, s64, 3
    s_add_u32 s6, s6, s100
    s_mul_i32 s6, s6, 3
    s_lshr_b32 s56, s3, 1
    s_add_u32 s6, s6, s56
    s_and_b32 s56, s99, 1
    s_lshl1_add_u32 s6, s6, s56
    s_and_b32 s56, s3, 1
    s_lshl1_add_u32 s6, s6, s56
    s_lshl4_add_u32 s6, s6, 0xca2000
    v_mov_b32 v139, s34
    v_mov_b32 v140, 0x4444
    v_mov_b32 v141, 0xeeee
    v_cndmask_b32 v140, v140, v141, s[96:97]
    v_mov_b32 v128, 0
    v_mov_b32 v129, 0
    v_mov_b32 v130, 0
    v_mov_b32 v131, 0
    v_mov_b32 v132, 0
    v_mov_b32 v133, 0
    v_mov_b32 v134, 0
    v_mov_b32 v135, 0
    s_waitcnt vmcnt(0)
    s_barrier
    ds_read_b64_tr_b16 v[56:57], v7 offset:24576
    ds_read_b64_tr_b16 v[58:59], v7 offset:25088
    ds_read_b64_tr_b16 v[88:89], v8 offset:24576
    ds_read_b64_tr_b16 v[90:91], v8 offset:25088
    ds_read_b64_tr_b16 v[60:61], v7 offset:28672
    ds_read_b64_tr_b16 v[62:63], v7 offset:29184
    ds_read_b64_tr_b16 v[92:93], v8 offset:28672
    ds_read_b64_tr_b16 v[94:95], v8 offset:29184
    s_branch .La_poll
.La_w67:
    s_cmp_eq_u32 s3, 7
    s_cbranch_scc0 2
    s_waitcnt vmcnt(1)
    s_branch 1
    s_waitcnt vmcnt(0)
    s_barrier
.La_poll:
    s_mov_b32 s60, 0x04000c0c
    s_mov_b32 s61, 0x0706000c
    s_mov_b32 s69, 0
.gp_55:
    s_add_u32 s69, s69, 1
    s_and_b32 s56, s69, 0x41
    s_cmp_lg_u32 s56, 0x41
    s_cselect_b32 s56, 0, 0x800000
    s_xor_b32 s56, s56, s0
    s_add_u32 s58, s101, s56
    buffer_load_dwordx4 v[16:19], v2, s[36:39], s58 offen offset:0 sc1
    buffer_load_dwordx4 v[20:23], v5, s[36:39], s58 offen offset:0 sc1
    s_waitcnt vmcnt(0)
    v_cmp_eq_u32 vcc, s34, v19
    v_cmp_eq_u32 s[56:57], s34, v23
    s_and_b64 vcc, vcc, s[56:57]
    s_cmp_eq_u64 vcc, -1
    s_nop 2
    s_cbranch_scc1 .gpd_56
    s_sub_u32 s35, s35, 1
    s_cbranch_scc1 .Lexit
    s_branch .gp_55
.gpd_56:
    v_perm_b32 v19, v16, v17, s60
    v_perm_b32 v19, v19, v18, s61
    v_perm_b32 v23, v20, v21, s60
    v_perm_b32 v23, v23, v22, s61
    v_permlane32_swap_b32 v16, v18
    v_permlane32_swap_b32 v17, v19
    v_permlane32_swap_b32 v20, v22
    v_permlane32_swap_b32 v21, v23
    v_pk_add_f32 v[16:17], v[16:17], v[18:19]
    v_pk_add_f32 v[20:21], v[20:21], v[22:23]
    v_cvt_pk_bf16_f32 v16, v16, v17
    v_cvt_pk_bf16_f32 v20, v20, v21
    ds_write2_b32 v6, v16, v20 offset1:64
    s_mov_b32 s60, 0x07060503
    s_mov_b32 s61, 0x07060502
    s_mov_b32 s62, 0x07060501
    s_mov_b32 vcc_lo, 0x55555555
    s_mov_b32 vcc_hi, 0x55555555
    s_waitcnt lgkmcnt(0)
    s_barrier
    s_cmp_ge_u32 s3, 6
    s_cbranch_scc1 .Lexit
    ds_read_b128 v[96:99], v9 offset:0
    ds_read_b128 v[100:103], v9 offset:128
    ds_read_b128 v[104:107], v9 offset:256
    ds_read_b128 v[108:111], v9 offset:384
    s_waitcnt lgkmcnt(3)
    v_smfmac_f32_16x16x64_bf16 v[128:131], v[96:99], v[32:39], v140
    v_smfmac_f32_16x16x64_bf16 v[132:135], v[96:99], v[64:71], v140
    s_waitcnt lgkmcnt(2)
    v_smfmac_f32_16x16x64_bf16 v[128:131], v[100:103], v[40:47], v140
    v_smfmac_f32_16x16x64_bf16 v[132:135], v[100:103], v[72:79], v140
    s_waitcnt lgkmcnt(1)
    v_smfmac_f32_16x16x64_bf16 v[128:131], v[104:107], v[48:55], v140
    v_smfmac_f32_16x16x64_bf16 v[132:135], v[104:107], v[80:87], v140
    s_waitcnt lgkmcnt(0)
    v_smfmac_f32_16x16x64_bf16 v[128:131], v[108:111], v[56:63], v140
    v_smfmac_f32_16x16x64_bf16 v[132:135], v[108:111], v[88:95], v140
    s_nop 6
    v_add_f32 v128, v128, v129
    v_add_f32 v130, v130, v131
    v_add_f32 v132, v132, v133
    v_add_f32 v134, v134, v135
    s_not_b64 vcc, vcc
    v_cndmask_b32_dpp v129, v128, v130, vcc quad_perm:[1,0,3,2] row_mask:0xf bank_mask:0xf
    v_cndmask_b32_dpp v131, v132, v134, vcc quad_perm:[1,0,3,2] row_mask:0xf bank_mask:0xf
    s_not_b64 vcc, vcc
    v_cndmask_b32_dpp v128, v130, v128, vcc quad_perm:[1,0,3,2] row_mask:0xf bank_mask:0xf
    v_cndmask_b32_dpp v130, v134, v132, vcc quad_perm:[1,0,3,2] row_mask:0xf bank_mask:0xf
    v_perm_b32 v136, v128, v131, s60
    v_perm_b32 v137, v129, v131, s61
    v_perm_b32 v138, v130, v131, s62
    buffer_store_dwordx4 v[136:139], v10, s[36:39], s59 offen sc1
    s_mov_b64 exec, 1
    buffer_store_dword v139, v2, s[36:39], s6 offen
    s_mov_b64 exec, -1
    s_branch .Lexit
.Lm:
    s_branch .Lsk_m0_0
.Lst_m0_0:
    s_branch .Lrt_m0_0
.Lsk_m0_0:
    s_cmp_lt_u32 s2, 54
    s_mov_b32 s14, 0xfdff7fdf
    s_cselect_b32 s14, 0x6b5ad6b5, s14
    s_mov_b32 s15, 0xff7fdff7
    s_cselect_b32 s15, 0x5ad6b5ad, s15
    s_add_u32 s30, s70, 0
    s_mov_b32 s31, s70
    v_bfe_u32 v16, v0, 1, 3
    v_mul_u32_u24 v16, 1312, v16
    v_lshrrev_b32 v12, 4, v0
    v_lshl_add_u32 v16, v12, 5, v16
    v_and_b32 v12, 1, v0
    v_lshl_add_u32 v16, v12, 4, v16
    v_add_u32 v16, 147456, v16
    s_mul_i32 s56, s3, 1312
    s_add_u32 s56, s56, 147456
    v_add_u32 v17, s56, v3
    v_add_u32 v18, s56, v4
    v_lshrrev_b32 v12, 4, v0
    v_bfe_u32 v13, v0, 1, 1
    v_lshl_add_u32 v12, v12, 1, v13
    v_bfe_u32 v13, v0, 2, 2
    v_lshl_add_u32 v20, v12, 3, v13
    v_lshlrev_b32 v20, 7, v20
    v_and_b32 v12, 3, v12
    v_lshrrev_b32 v13, 1, v13
    v_lshl_add_u32 v12, v12, 1, v13
    v_xor_b32 v12, s3, v12
    v_lshl_add_u32 v20, v12, 4, v20
    v_and_b32 v12, 1, v0
    v_lshl_add_u32 v20, v12, 3, v20
    v_bfe_u32 v23, v0, 1, 3
    v_mul_u32_u24 v23, 144, v23
    v_bfe_u32 v12, v0, 4, 1
    v_lshl_add_u32 v23, v12, 3, v23
    v_lshrrev_b32 v12, 5, v0
    v_lshl_add_u32 v23, v12, 2, v23
    v_and_b32 v12, 1, v0
    v_lshl_add_u32 v23, v12, 1, v23
    s_lshl_b32 s56, s3, 4
    s_add_u32 s56, s56, 157952
    v_add_u32 v23, s56, v23
    v_and_b32 v24, 15, v0
    v_lshlrev_b32 v24, 3, v24
    s_mul_i32 s56, s3, 144
    s_add_u32 s56, s56, 157952
    v_add_u32 v24, s56, v24
    v_add_u32 v21, 32768, v20
    s_lshl_b32 s100, s3, 10
    s_mov_b32 s99, s2
    s_cmp_ge_u32 s99, 18
    s_cbranch_scc1 .Lm_rel
    s_mul_i32 s58, s3, 1152
    s_mov_b32 s52, s24
    s_and_b32 s53, s25, 0xffff
    s_mov_b32 s54, 0x2400
    s_mov_b32 s55, 0x00020000
    buffer_load_dwordx2 v[246:247], v3, s[52:55], s58 offen
    buffer_load_dwordx2 v[248:249], v3, s[52:55], s58 offen offset:512
    buffer_load_dword v250, v4, s[52:55], s58 offen
    s_mov_b32 s48, s26
    s_and_b32 s49, s27, 0xffff
    s_mov_b32 s50, 0x3cc000
    s_mov_b32 s51, 0x00020000
    v_bfe_u32 v12, v0, 4, 1
    s_and_b32 s56, s3, 3
    s_lshl_b32 s56, s56, 1
    v_or_b32 v12, s56, v12
    v_and_b32 v19, 7, v0
    v_xor_b32 v12, v12, v19
    v_lshrrev_b32 v19, 3, v0
    v_mul_u32_u24 v19, 6912, v19
    v_lshl_add_u32 v19, v12, 4, v19
    s_mul_i32 s57, s3, 55296
    s_lshl_b32 s59, s99, 7
    s_add_u32 s57, s57, s59
    s_add_u32 m0, s100, 0
    s_add_u32 s56, s57, 0
    buffer_load_dwordx4 v19, s[48:51], s56 offen nt lds
    s_add_u32 m0, s100, 8192
    s_add_u32 s56, s57, 442368
    buffer_load_dwordx4 v19, s[48:51], s56 offen nt lds
    s_add_u32 m0, s100, 16384
    s_add_u32 s56, s57, 884736
    buffer_load_dwordx4 v19, s[48:51], s56 offen nt lds
    s_add_u32 m0, s100, 24576
    s_add_u32 s56, s57, 1327104
    buffer_load_dwordx4 v19, s[48:51], s56 offen nt lds
    s_add_u32 m0, s100, 32768
    s_add_u32 s56, s57, 1769472
    buffer_load_dwordx4 v19, s[48:51], s56 offen nt lds
    s_add_u32 m0, s100, 40960
    s_add_u32 s56, s57, 2211840
    buffer_load_dwordx4 v19, s[48:51], s56 offen nt lds
    s_add_u32 m0, s100, 49152
    s_add_u32 s56, s57, 2654208
    buffer_load_dwordx4 v19, s[48:51], s56 offen nt lds
    s_add_u32 m0, s100, 57344
    s_add_u32 s56, s57, 3096576
    buffer_load_dwordx4 v19, s[48:51], s56 offen nt lds
    s_add_u32 m0, s100, 65536
    s_add_u32 s56, s57, 3538944
    buffer_load_dwordx4 v19, s[48:51], s56 offen nt lds
    s_waitcnt lgkmcnt(0)
    s_add_u32 s34, s34, 1
    s_getreg_b32 s1, hwreg(HW_REG_XCC_ID)
    s_lshl_b32 s1, s1, 24
    s_add_u32 s1, s1, s34
    s_lshr_b32 s0, s2, 3
    s_lshl_b32 s63, s64, 8
    s_add_u32 s0, s0, s63
    s_lshl2_add_u32 s0, s0, 0x480000
    v_mov_b32 v30, s1
    s_cmp_eq_u32 s3, 0
    s_cselect_b64 exec, 1, 0
    buffer_store_dword v30, v2, s[36:39], s0 offen sc1
    s_mov_b64 exec, -1
    v_lshrrev_b32 v12, 4, v0
    v_mul_u32_u24 v12, 18432, v12
    v_and_b32 v13, 15, v0
    v_lshl_add_u32 v22, v13, 4, v12
    s_mul_i32 s57, s99, 57
    s_lshr_b32 s57, s57, 9
    s_mul_i32 s58, s57, 9
    s_sub_u32 s58, s99, s58
    s_mul_i32 s59, s57, 73728
    s_lshl_b32 s58, s58, 8
    s_add_u32 s59, s59, s58
    s_mul_i32 s58, s3, 2304
    s_add_u32 s59, s59, s58
    s_add_u32 s59, s59, 0x1000
    s_mov_b32 s58, 0
    s_cmp_eq_u32 s57, 1
    s_cselect_b32 s58, 1.0, s58
    s_cmp_eq_u32 s57, 4
    s_cselect_b32 s58, 1.0, s58
    s_waitcnt vmcnt(10)
    v_lshlrev_b32 v236, 16, v246
    v_and_b32 v237, 0xffff0000, v246
    v_max_f32 v236, 0xc2ae0000, v236
    v_min_f32 v242, 0x43000000, v236
    v_mul_f32 v238, 0xbfb8aa3b, v242
    v_fma_f32 v240, v242, s98, -v238
    v_fmac_f32 v240, 0xb2a57060, v242
    v_exp_f32 v238, v238
    v_mul_f32 v240, 0x3f317218, v240
    v_fmac_f32 v238, v238, v240
    v_add_f32 v238, 1.0, v238
    v_rcp_f32 v240, v238
    s_nop 0
    v_mul_f32 v242, v236, v240
    v_fma_f32 v238, -v242, v238, v236
    v_fma_f32 v236, v238, v240, v242
    v_max_f32 v237, 0xc2ae0000, v237
    v_min_f32 v243, 0x43000000, v237
    v_mul_f32 v239, 0xbfb8aa3b, v243
    v_fma_f32 v241, v243, s98, -v239
    v_fmac_f32 v241, 0xb2a57060, v243
    v_exp_f32 v239, v239
    v_mul_f32 v241, 0x3f317218, v241
    v_fmac_f32 v239, v239, v241
    v_add_f32 v239, 1.0, v239
    v_rcp_f32 v241, v239
    s_nop 0
    v_mul_f32 v243, v237, v241
    v_fma_f32 v239, -v243, v239, v237
    v_fma_f32 v237, v239, v241, v243
    v_cvt_pk_bf16_f32 v246, v236, v237
    v_lshlrev_b32 v236, 16, v247
    v_and_b32 v237, 0xffff0000, v247
    s_branch .Lsk_m0_1
.Lst_m0_1:
    s_branch .Lrt_m0_1
.Lsk_m0_1:
    v_max_f32 v236, 0xc2ae0000, v236
    v_min_f32 v242, 0x43000000, v236
    v_mul_f32 v238, 0xbfb8aa3b, v242
    v_fma_f32 v240, v242, s98, -v238
    v_fmac_f32 v240, 0xb2a57060, v242
    v_exp_f32 v238, v238
    v_mul_f32 v240, 0x3f317218, v240
    v_fmac_f32 v238, v238, v240
    v_add_f32 v238, 1.0, v238
    v_rcp_f32 v240, v238
    s_nop 0
    v_mul_f32 v242, v236, v240
    v_fma_f32 v238, -v242, v238, v236
    v_fma_f32 v236, v238, v240, v242
    v_max_f32 v237, 0xc2ae0000, v237
    v_min_f32 v243, 0x43000000, v237
    v_mul_f32 v239, 0xbfb8aa3b, v243
    v_fma_f32 v241, v243, s98, -v239
    v_fmac_f32 v241, 0xb2a57060, v243
    v_exp_f32 v239, v239
    v_mul_f32 v241, 0x3f317218, v241
    v_fmac_f32 v239, v239, v241
    v_add_f32 v239, 1.0, v239
    v_rcp_f32 v241, v239
    s_nop 0
    v_mul_f32 v243, v237, v241
    v_fma_f32 v239, -v243, v239, v237
    v_fma_f32 v237, v239, v241, v243
    v_cvt_pk_bf16_f32 v247, v236, v237
    v_lshlrev_b32 v236, 16, v248
    v_and_b32 v237, 0xffff0000, v248
    v_max_f32 v236, 0xc2ae0000, v236
    v_min_f32 v242, 0x43000000, v236
    v_mul_f32 v238, 0xbfb8aa3b, v242
    v_fma_f32 v240, v242, s98, -v238
    v_fmac_f32 v240, 0xb2a57060, v242
    v_exp_f32 v238, v238
    v_mul_f32 v240, 0x3f317218, v240
    v_fmac_f32 v238, v238, v240
    v_add_f32 v238, 1.0, v238
    v_rcp_f32 v240, v238
    s_nop 0
    v_mul_f32 v242, v236, v240
    v_fma_f32 v238, -v242, v238, v236
    v_fma_f32 v236, v238, v240, v242
    v_max_f32 v237, 0xc2ae0000, v237
    v_min_f32 v243, 0x43000000, v237
    v_mul_f32 v239, 0xbfb8aa3b, v243
    v_fma_f32 v241, v243, s98, -v239
    v_fmac_f32 v241, 0xb2a57060, v243
    v_exp_f32 v239, v239
    v_mul_f32 v241, 0x3f317218, v241
    v_fmac_f32 v239, v239, v241
    v_add_f32 v239, 1.0, v239
    v_rcp_f32 v241, v239
    s_nop 0
    v_mul_f32 v243, v237, v241
    v_fma_f32 v239, -v243, v239, v237
    v_fma_f32 v237, v239, v241, v243
    v_cvt_pk_bf16_f32 v248, v236, v237
    v_lshlrev_b32 v236, 16, v249
    v_and_b32 v237, 0xffff0000, v249
    v_max_f32 v236, 0xc2ae0000, v236
    v_min_f32 v242, 0x43000000, v236
    v_mul_f32 v238, 0xbfb8aa3b, v242
    v_fma_f32 v240, v242, s98, -v238
    v_fmac_f32 v240, 0xb2a57060, v242
    v_exp_f32 v238, v238
    v_mul_f32 v240, 0x3f317218, v240
    v_fmac_f32 v238, v238, v240
    v_add_f32 v238, 1.0, v238
    v_rcp_f32 v240, v238
    s_nop 0
    v_mul_f32 v242, v236, v240
    v_fma_f32 v238, -v242, v238, v236
    v_fma_f32 v236, v238, v240, v242
    v_max_f32 v237, 0xc2ae0000, v237
    v_min_f32 v243, 0x43000000, v237
    v_mul_f32 v239, 0xbfb8aa3b, v243
    v_fma_f32 v241, v243, s98, -v239
    v_fmac_f32 v241, 0xb2a57060, v243
    v_exp_f32 v239, v239
    v_mul_f32 v241, 0x3f317218, v241
    v_fmac_f32 v239, v239, v241
    v_add_f32 v239, 1.0, v239
    v_rcp_f32 v241, v239
    s_nop 0
    v_mul_f32 v243, v237, v241
    v_fma_f32 v239, -v243, v239, v237
    v_fma_f32 v237, v239, v241, v243
    v_cvt_pk_bf16_f32 v249, v236, v237
    v_lshlrev_b32 v236, 16, v250
    v_and_b32 v237, 0xffff0000, v250
    v_max_f32 v236, 0xc2ae0000, v236
    v_min_f32 v242, 0x43000000, v236
    v_mul_f32 v238, 0xbfb8aa3b, v242
    v_fma_f32 v240, v242, s98, -v238
    v_fmac_f32 v240, 0xb2a57060, v242
    v_exp_f32 v238, v238
    v_mul_f32 v240, 0x3f317218, v240
    v_fmac_f32 v238, v238, v240
    v_add_f32 v238, 1.0, v238
    v_rcp_f32 v240, v238
    s_nop 0
    v_mul_f32 v242, v236, v240
    v_fma_f32 v238, -v242, v238, v236
    v_fma_f32 v236, v238, v240, v242
    v_max_f32 v237, 0xc2ae0000, v237
    v_min_f32 v243, 0x43000000, v237
    v_mul_f32 v239, 0xbfb8aa3b, v243
    v_fma_f32 v241, v243, s98, -v239
    v_fmac_f32 v241, 0xb2a57060, v243
    v_exp_f32 v239, v239
    v_mul_f32 v241, 0x3f317218, v241
    v_fmac_f32 v239, v239, v241
    v_add_f32 v239, 1.0, v239
    v_rcp_f32 v241, v239
    s_nop 0
    v_mul_f32 v243, v237, v241
    v_fma_f32 v239, -v243, v239, v237
    v_fma_f32 v237, v239, v241, v243
    v_cvt_pk_bf16_f32 v250, v236, v237
    ds_write_b64 v17, v[246:247] offset:0
    ds_write_b64 v17, v[248:249] offset:512
    ds_write_b32 v18, v250 offset:0
    s_waitcnt vmcnt(1)
    s_waitcnt lgkmcnt(0)
    s_barrier
    ds_read_b64_tr_b16 v[160:161], v20 offset:0
    ds_read_b64_tr_b16 v[162:163], v20 offset:512
    ds_read_b64_tr_b16 v[164:165], v20 offset:8192
    ds_read_b64_tr_b16 v[166:167], v20 offset:8704
    ds_read_b64_tr_b16 v[168:169], v20 offset:16384
    ds_read_b64_tr_b16 v[170:171], v20 offset:16896
    ds_read_b64_tr_b16 v[172:173], v20 offset:24576
    ds_read_b64_tr_b16 v[174:175], v20 offset:25088
    ds_read_b64_tr_b16 v[176:177], v21 offset:0
    ds_read_b64_tr_b16 v[178:179], v21 offset:512
    s_branch .Lsk_m0_2
.Lst_m0_2:
    s_branch .Lrt_m0_2
.Lsk_m0_2:
    ds_read_b64_tr_b16 v[180:181], v21 offset:8192
    ds_read_b64_tr_b16 v[182:183], v21 offset:8704
    ds_read_b64_tr_b16 v[184:185], v21 offset:16384
    ds_read_b64_tr_b16 v[186:187], v21 offset:16896
    ds_read_b64_tr_b16 v[188:189], v21 offset:24576
    ds_read_b64_tr_b16 v[190:191], v21 offset:25088
    ds_read_b64_tr_b16 v[192:193], v21 offset:32768
    ds_read_b64_tr_b16 v[194:195], v21 offset:33280
    ds_read_b128 v[196:199], v16 offset:0
    ds_read_b128 v[200:203], v16 offset:128
    ds_read_b128 v[204:207], v16 offset:256
    ds_read_b128 v[208:211], v16 offset:384
    ds_read_b128 v[212:215], v16 offset:512
    ds_read_b128 v[216:219], v16 offset:640
    ds_read_b128 v[220:223], v16 offset:768
    ds_read_b128 v[224:227], v16 offset:896
    ds_read_b128 v[228:231], v16 offset:1024
    s_waitcnt lgkmcnt(8)
    v_mfma_f32_16x16x32_bf16 v[232:235], v[160:163], v[196:199], 0
    s_waitcnt lgkmcnt(7)
    v_mfma_f32_16x16x32_bf16 v[232:235], v[164:167], v[200:203], v[232:235]
    s_waitcnt lgkmcnt(6)
    v_mfma_f32_16x16x32_bf16 v[232:235], v[168:171], v[204:207], v[232:235]
    s_waitcnt lgkmcnt(5)
    v_mfma_f32_16x16x32_bf16 v[232:235], v[172:175], v[208:211], v[232:235]
    s_waitcnt lgkmcnt(4)
    v_mfma_f32_16x16x32_bf16 v[232:235], v[176:179], v[212:215], v[232:235]
    s_waitcnt lgkmcnt(3)
    v_mfma_f32_16x16x32_bf16 v[232:235], v[180:183], v[216:219], v[232:235]
    s_waitcnt lgkmcnt(2)
    v_mfma_f32_16x16x32_bf16 v[232:235], v[184:187], v[220:223], v[232:235]
    s_waitcnt lgkmcnt(1)
    v_mfma_f32_16x16x32_bf16 v[232:235], v[188:191], v[224:227], v[232:235]
    s_waitcnt lgkmcnt(0)
    v_mfma_f32_16x16x32_bf16 v[232:235], v[192:195], v[228:231], v[232:235]
    s_nop 7
    v_permlane32_swap_b32 v232, v234
    v_permlane32_swap_b32 v233, v235
    v_cndmask_b32 v233, v233, v234, s[96:97]
    v_cndmask_b32 v232, v232, v235, s[96:97]
    s_nop 1
    v_add_f32_dpp v236, v233, v232 quad_perm:[1,0,3,2] row_mask:0xf bank_mask:0xf
    v_cvt_pk_bf16_f32 v236, v236, v236
    v_lshlrev_b32 v236, 16, v236
    v_add_f32 v236, s58, v236
    v_cvt_pk_bf16_f32 v236, v236, v236
    ds_write_b16 v23, v236
    v_mov_b32 v243, s34
    s_waitcnt lgkmcnt(0)
    s_barrier
    ds_read2_b32 v[244:245], v24 offset1:1
    v_mov_b32 v241, s34
    s_waitcnt lgkmcnt(0)
    v_mov_b32 v240, v244
    v_mov_b32 v242, v245
    s_bfm_b64 exec, 16, 0
    buffer_store_dwordx4 v[240:243], v22, s[36:39], s59 offen sc1
    s_mov_b64 exec, -1
    s_add_u32 s63, s69, 32768
    buffer_load_dwordx4 v[96:99], v1, s[40:43], s63 offen nt
    s_add_u32 s63, s69, 40960
    buffer_load_dwordx4 v[100:103], v1, s[40:43], s63 offen nt
    s_add_u32 s63, s69, 49152
    buffer_load_dwordx4 v[128:131], v1, s[40:43], s63 offen nt
    s_add_u32 s63, s69, 57344
    buffer_load_dwordx4 v[132:135], v1, s[40:43], s63 offen nt
    s_waitcnt vmcnt(3)
    s_add_u32 s63, s69, 131072
    buffer_load_dwordx4 v[40:43], v1, s[40:43], s63 offen nt
    s_waitcnt vmcnt(3)
    s_add_u32 s63, s69, 139264
    buffer_load_dwordx4 v[44:47], v1, s[40:43], s63 offen nt
    s_waitcnt vmcnt(3)
    s_add_u32 s63, s69, 147456
    buffer_load_dwordx4 v[72:75], v1, s[40:43], s63 offen nt
    s_waitcnt vmcnt(3)
    s_add_u32 s63, s69, 155648
    buffer_load_dwordx4 v[76:79], v1, s[40:43], s63 offen nt
    s_waitcnt vmcnt(3)
    s_add_u32 s63, s69, 163840
    buffer_load_dwordx4 v[104:107], v1, s[40:43], s63 offen nt
    s_waitcnt vmcnt(3)
    s_add_u32 s63, s69, 172032
    buffer_load_dwordx4 v[108:111], v1, s[40:43], s63 offen nt
    s_waitcnt vmcnt(3)
    s_add_u32 s63, s69, 180224
    buffer_load_dwordx4 v[136:139], v1, s[40:43], s63 offen nt
    s_waitcnt vmcnt(3)
    s_add_u32 s63, s69, 188416
    buffer_load_dwordx4 v[140:143], v1, s[40:43], s63 offen nt
    s_waitcnt vmcnt(3)
    s_add_u32 s63, s69, 262144
    buffer_load_dwordx4 v[48:51], v1, s[40:43], s63 offen nt
    s_waitcnt vmcnt(3)
    s_add_u32 s63, s69, 270336
    buffer_load_dwordx4 v[52:55], v1, s[40:43], s63 offen nt
    s_branch .Le_done
.Lm_rel:
    s_waitcnt vmcnt(4)
    s_bitcmp1_b64 s[14:15], 4
    s_cbranch_scc0 1
    s_waitcnt vmcnt(3)
    s_add_u32 s63, s69, 32768
    buffer_load_dwordx4 v[96:99], v1, s[40:43], s63 offen nt
    s_waitcnt vmcnt(4)
    s_bitcmp1_b64 s[14:15], 5
    s_cbranch_scc0 1
    s_waitcnt vmcnt(3)
    s_add_u32 s63, s69, 40960
    buffer_load_dwordx4 v[100:103], v1, s[40:43], s63 offen nt
    s_waitcnt vmcnt(4)
    s_bitcmp1_b64 s[14:15], 6
    s_cbranch_scc0 1
    s_waitcnt vmcnt(3)
    s_add_u32 s63, s69, 49152
    buffer_load_dwordx4 v[128:131], v1, s[40:43], s63 offen nt
    s_waitcnt vmcnt(4)
    s_bitcmp1_b64 s[14:15], 7
    s_cbranch_scc0 1
    s_waitcnt vmcnt(2)
    s_add_u32 s63, s69, 57344
    buffer_load_dwordx4 v[132:135], v1, s[40:43], s63 offen nt
    s_waitcnt vmcnt(3)
    s_bitcmp1_b64 s[14:15], 8
    s_cbranch_scc0 1
    s_waitcnt vmcnt(2)
    s_add_u32 s63, s69, 131072
    buffer_load_dwordx4 v[40:43], v1, s[40:43], s63 offen nt
    s_waitcnt vmcnt(3)
    s_bitcmp1_b64 s[14:15], 9
    s_cbranch_scc0 1
    s_waitcnt vmcnt(2)
    s_add_u32 s63, s69, 139264
    buffer_load_dwordx4 v[44:47], v1, s[40:43], s63 offen nt
    s_waitcnt lgkmcnt(0)
    s_add_u32 s34, s34, 1
    s_getreg_b32 s1, hwreg(HW_REG_XCC_ID)
    s_lshl_b32 s1, s1, 24
    s_add_u32 s1, s1, s34
    s_lshr_b32 s0, s2, 3
    s_lshl_b32 s63, s64, 8
    s_add_u32 s0, s0, s63
    s_lshl2_add_u32 s0, s0, 0x480000
    v_mov_b32 v30, s1
    s_cmp_eq_u32 s3, 0
    s_cselect_b64 exec, 1, 0
    buffer_store_dword v30, v2, s[36:39], s0 offen sc1
    s_mov_b64 exec, -1
    s_cmp_lt_u32 s99, 54
    s_cbranch_scc1 .Lmr_part
    s_waitcnt vmcnt(4)
    s_bitcmp1_b64 s[14:15], 10
    s_cbranch_scc0 1
    s_waitcnt vmcnt(3)
    s_add_u32 s63, s69, 147456
    buffer_load_dwordx4 v[72:75], v1, s[40:43], s63 offen nt
    s_waitcnt vmcnt(4)
    s_bitcmp1_b64 s[14:15], 11
    s_cbranch_scc0 1
    s_waitcnt vmcnt(3)
    s_add_u32 s63, s69, 155648
    buffer_load_dwordx4 v[76:79], v1, s[40:43], s63 offen nt
    s_waitcnt vmcnt(4)
    s_bitcmp1_b64 s[14:15], 12
    s_cbranch_scc0 1
    s_waitcnt vmcnt(3)
    s_add_u32 s63, s69, 163840
    buffer_load_dwordx4 v[104:107], v1, s[40:43], s63 offen nt
    s_waitcnt vmcnt(4)
    s_bitcmp1_b64 s[14:15], 13
    s_cbranch_scc0 1
    s_waitcnt vmcnt(2)
    s_add_u32 s63, s69, 172032
    buffer_load_dwordx4 v[108:111], v1, s[40:43], s63 offen nt
    s_waitcnt vmcnt(3)
    s_bitcmp1_b64 s[14:15], 14
    s_cbranch_scc0 1
    s_waitcnt vmcnt(2)
    s_add_u32 s63, s69, 180224
    buffer_load_dwordx4 v[136:139], v1, s[40:43], s63 offen nt
    s_waitcnt vmcnt(3)
    s_bitcmp1_b64 s[14:15], 15
    s_cbranch_scc0 1
    s_waitcnt vmcnt(2)
    s_add_u32 s63, s69, 188416
    buffer_load_dwordx4 v[140:143], v1, s[40:43], s63 offen nt
    s_branch .Lsk_m0_3
.Lst_m0_3:
    s_branch .Lrt_m0_3
.Lsk_m0_3:
    s_waitcnt vmcnt(3)
    s_bitcmp1_b64 s[14:15], 16
    s_cbranch_scc0 1
    s_waitcnt vmcnt(2)
    s_add_u32 s63, s69, 262144
    buffer_load_dwordx4 v[48:51], v1, s[40:43], s63 offen nt
    s_waitcnt vmcnt(3)
    s_bitcmp1_b64 s[14:15], 17
    s_cbranch_scc0 1
    s_waitcnt vmcnt(2)
    s_add_u32 s63, s69, 270336
    buffer_load_dwordx4 v[52:55], v1, s[40:43], s63 offen nt
    s_branch .Le_done
.Lmr_part:
    s_mul_i32 s58, s3, 1152
    s_mov_b32 s52, s24
    s_and_b32 s53, s25, 0xffff
    s_mov_b32 s54, 0x2400
    s_mov_b32 s55, 0x00020000
    buffer_load_dwordx2 v[246:247], v3, s[52:55], s58 offen
    buffer_load_dwordx2 v[248:249], v3, s[52:55], s58 offen offset:512
    buffer_load_dword v250, v4, s[52:55], s58 offen
    s_mov_b32 s48, s26
    s_and_b32 s49, s27, 0xffff
    s_mov_b32 s50, 0x3cc000
    s_mov_b32 s51, 0x00020000
    v_bfe_u32 v12, v0, 4, 1
    s_and_b32 s56, s3, 3
    s_lshl_b32 s56, s56, 1
    v_or_b32 v12, s56, v12
    v_and_b32 v19, 7, v0
    v_xor_b32 v12, v12, v19
    v_lshrrev_b32 v19, 3, v0
    v_mul_u32_u24 v19, 6912, v19
    v_lshl_add_u32 v19, v12, 4, v19
    s_mul_i32 s57, s3, 55296
    s_lshl_b32 s59, s99, 7
    s_add_u32 s57, s57, s59
    s_add_u32 m0, s100, 0
    s_add_u32 s56, s57, 0
    buffer_load_dwordx4 v19, s[48:51], s56 offen nt lds
    s_add_u32 m0, s100, 8192
    s_add_u32 s56, s57, 442368
    buffer_load_dwordx4 v19, s[48:51], s56 offen nt lds
    s_add_u32 m0, s100, 16384
    s_add_u32 s56, s57, 884736
    buffer_load_dwordx4 v19, s[48:51], s56 offen nt lds
    s_add_u32 m0, s100, 24576
    s_add_u32 s56, s57, 1327104
    buffer_load_dwordx4 v19, s[48:51], s56 offen nt lds
    s_add_u32 m0, s100, 32768
    s_add_u32 s56, s57, 1769472
    buffer_load_dwordx4 v19, s[48:51], s56 offen nt lds
    s_add_u32 m0, s100, 40960
    s_add_u32 s56, s57, 2211840
    buffer_load_dwordx4 v19, s[48:51], s56 offen nt lds
    s_add_u32 m0, s100, 49152
    s_add_u32 s56, s57, 2654208
    buffer_load_dwordx4 v19, s[48:51], s56 offen nt lds
    s_add_u32 m0, s100, 57344
    s_add_u32 s56, s57, 3096576
    buffer_load_dwordx4 v19, s[48:51], s56 offen nt lds
    s_add_u32 m0, s100, 65536
    s_add_u32 s56, s57, 3538944
    buffer_load_dwordx4 v19, s[48:51], s56 offen nt lds
    v_lshrrev_b32 v12, 4, v0
    v_mul_u32_u24 v12, 18432, v12
    v_and_b32 v13, 15, v0
    v_lshl_add_u32 v22, v13, 4, v12
    s_mul_i32 s57, s99, 57
    s_lshr_b32 s57, s57, 9
    s_mul_i32 s58, s57, 9
    s_sub_u32 s58, s99, s58
    s_mul_i32 s59, s57, 73728
    s_lshl_b32 s58, s58, 8
    s_add_u32 s59, s59, s58
    s_mul_i32 s58, s3, 2304
    s_add_u32 s59, s59, s58
    s_add_u32 s59, s59, 0x1000
    s_mov_b32 s58, 0
    s_cmp_eq_u32 s57, 1
    s_cselect_b32 s58, 1.0, s58
    s_cmp_eq_u32 s57, 4
    s_cselect_b32 s58, 1.0, s58
    s_waitcnt vmcnt(9)
    v_lshlrev_b32 v236, 16, v246
    v_and_b32 v237, 0xffff0000, v246
    v_max_f32 v236, 0xc2ae0000, v236
    v_min_f32 v242, 0x43000000, v236
    v_mul_f32 v238, 0xbfb8aa3b, v242
    v_fma_f32 v240, v242, s98, -v238
    v_fmac_f32 v240, 0xb2a57060, v242
    v_exp_f32 v238, v238
    v_mul_f32 v240, 0x3f317218, v240
    v_fmac_f32 v238, v238, v240
    v_add_f32 v238, 1.0, v238
    v_rcp_f32 v240, v238
    s_nop 0
    v_mul_f32 v242, v236, v240
    v_fma_f32 v238, -v242, v238, v236
    v_fma_f32 v236, v238, v240, v242
    v_max_f32 v237, 0xc2ae0000, v237
    v_min_f32 v243, 0x43000000, v237
    v_mul_f32 v239, 0xbfb8aa3b, v243
    v_fma_f32 v241, v243, s98, -v239
    v_fmac_f32 v241, 0xb2a57060, v243
    v_exp_f32 v239, v239
    v_mul_f32 v241, 0x3f317218, v241
    v_fmac_f32 v239, v239, v241
    v_add_f32 v239, 1.0, v239
    v_rcp_f32 v241, v239
    s_nop 0
    v_mul_f32 v243, v237, v241
    v_fma_f32 v239, -v243, v239, v237
    v_fma_f32 v237, v239, v241, v243
    v_cvt_pk_bf16_f32 v246, v236, v237
    v_lshlrev_b32 v236, 16, v247
    v_and_b32 v237, 0xffff0000, v247
    v_max_f32 v236, 0xc2ae0000, v236
    v_min_f32 v242, 0x43000000, v236
    v_mul_f32 v238, 0xbfb8aa3b, v242
    v_fma_f32 v240, v242, s98, -v238
    v_fmac_f32 v240, 0xb2a57060, v242
    v_exp_f32 v238, v238
    v_mul_f32 v240, 0x3f317218, v240
    v_fmac_f32 v238, v238, v240
    v_add_f32 v238, 1.0, v238
    v_rcp_f32 v240, v238
    s_nop 0
    v_mul_f32 v242, v236, v240
    v_fma_f32 v238, -v242, v238, v236
    v_fma_f32 v236, v238, v240, v242
    v_max_f32 v237, 0xc2ae0000, v237
    v_min_f32 v243, 0x43000000, v237
    v_mul_f32 v239, 0xbfb8aa3b, v243
    v_fma_f32 v241, v243, s98, -v239
    v_fmac_f32 v241, 0xb2a57060, v243
    v_exp_f32 v239, v239
    v_mul_f32 v241, 0x3f317218, v241
    v_fmac_f32 v239, v239, v241
    v_add_f32 v239, 1.0, v239
    v_rcp_f32 v241, v239
    s_nop 0
    v_mul_f32 v243, v237, v241
    v_fma_f32 v239, -v243, v239, v237
    v_fma_f32 v237, v239, v241, v243
    v_cvt_pk_bf16_f32 v247, v236, v237
    v_lshlrev_b32 v236, 16, v248
    v_and_b32 v237, 0xffff0000, v248
    v_max_f32 v236, 0xc2ae0000, v236
    v_min_f32 v242, 0x43000000, v236
    v_mul_f32 v238, 0xbfb8aa3b, v242
    v_fma_f32 v240, v242, s98, -v238
    v_fmac_f32 v240, 0xb2a57060, v242
    v_exp_f32 v238, v238
    v_mul_f32 v240, 0x3f317218, v240
    v_fmac_f32 v238, v238, v240
    v_add_f32 v238, 1.0, v238
    v_rcp_f32 v240, v238
    s_nop 0
    v_mul_f32 v242, v236, v240
    v_fma_f32 v238, -v242, v238, v236
    v_fma_f32 v236, v238, v240, v242
    v_max_f32 v237, 0xc2ae0000, v237
    v_min_f32 v243, 0x43000000, v237
    v_mul_f32 v239, 0xbfb8aa3b, v243
    v_fma_f32 v241, v243, s98, -v239
    v_fmac_f32 v241, 0xb2a57060, v243
    v_exp_f32 v239, v239
    v_mul_f32 v241, 0x3f317218, v241
    s_branch .Lsk_m0_4
.Lst_m0_4:
    s_branch .Lrt_m0_4
.Lsk_m0_4:
    v_fmac_f32 v239, v239, v241
    v_add_f32 v239, 1.0, v239
    v_rcp_f32 v241, v239
    s_nop 0
    v_mul_f32 v243, v237, v241
    v_fma_f32 v239, -v243, v239, v237
    v_fma_f32 v237, v239, v241, v243
    v_cvt_pk_bf16_f32 v248, v236, v237
    v_lshlrev_b32 v236, 16, v249
    v_and_b32 v237, 0xffff0000, v249
    v_max_f32 v236, 0xc2ae0000, v236
    v_min_f32 v242, 0x43000000, v236
    v_mul_f32 v238, 0xbfb8aa3b, v242
    v_fma_f32 v240, v242, s98, -v238
    v_fmac_f32 v240, 0xb2a57060, v242
    v_exp_f32 v238, v238
    v_mul_f32 v240, 0x3f317218, v240
    v_fmac_f32 v238, v238, v240
    v_add_f32 v238, 1.0, v238
    v_rcp_f32 v240, v238
    s_nop 0
    v_mul_f32 v242, v236, v240
    v_fma_f32 v238, -v242, v238, v236
    v_fma_f32 v236, v238, v240, v242
    v_max_f32 v237, 0xc2ae0000, v237
    v_min_f32 v243, 0x43000000, v237
    v_mul_f32 v239, 0xbfb8aa3b, v243
    v_fma_f32 v241, v243, s98, -v239
    v_fmac_f32 v241, 0xb2a57060, v243
    v_exp_f32 v239, v239
    v_mul_f32 v241, 0x3f317218, v241
    v_fmac_f32 v239, v239, v241
    v_add_f32 v239, 1.0, v239
    v_rcp_f32 v241, v239
    s_nop 0
    v_mul_f32 v243, v237, v241
    v_fma_f32 v239, -v243, v239, v237
    v_fma_f32 v237, v239, v241, v243
    v_cvt_pk_bf16_f32 v249, v236, v237
    v_lshlrev_b32 v236, 16, v250
    v_and_b32 v237, 0xffff0000, v250
    v_max_f32 v236, 0xc2ae0000, v236
    v_min_f32 v242, 0x43000000, v236
    v_mul_f32 v238, 0xbfb8aa3b, v242
    v_fma_f32 v240, v242, s98, -v238
    v_fmac_f32 v240, 0xb2a57060, v242
    v_exp_f32 v238, v238
    v_mul_f32 v240, 0x3f317218, v240
    v_fmac_f32 v238, v238, v240
    v_add_f32 v238, 1.0, v238
    v_rcp_f32 v240, v238
    s_nop 0
    v_mul_f32 v242, v236, v240
    v_fma_f32 v238, -v242, v238, v236
    v_fma_f32 v236, v238, v240, v242
    v_max_f32 v237, 0xc2ae0000, v237
    v_min_f32 v243, 0x43000000, v237
    v_mul_f32 v239, 0xbfb8aa3b, v243
    v_fma_f32 v241, v243, s98, -v239
    v_fmac_f32 v241, 0xb2a57060, v243
    v_exp_f32 v239, v239
    v_mul_f32 v241, 0x3f317218, v241
    v_fmac_f32 v239, v239, v241
    v_add_f32 v239, 1.0, v239
    v_rcp_f32 v241, v239
    s_nop 0
    v_mul_f32 v243, v237, v241
    v_fma_f32 v239, -v243, v239, v237
    v_fma_f32 v237, v239, v241, v243
    v_cvt_pk_bf16_f32 v250, v236, v237
    ds_write_b64 v17, v[246:247] offset:0
    ds_write_b64 v17, v[248:249] offset:512
    ds_write_b32 v18, v250 offset:0
    s_waitcnt vmcnt(3)
    s_add_u32 s63, s69, 147456
    buffer_load_dwordx4 v[72:75], v1, s[40:43], s63 offen nt
    s_waitcnt vmcnt(3)
    s_add_u32 s63, s69, 155648
    buffer_load_dwordx4 v[76:79], v1, s[40:43], s63 offen nt
    s_waitcnt vmcnt(3)
    s_add_u32 s63, s69, 163840
    buffer_load_dwordx4 v[104:107], v1, s[40:43], s63 offen nt
    s_waitcnt vmcnt(3)
    s_add_u32 s63, s69, 172032
    buffer_load_dwordx4 v[108:111], v1, s[40:43], s63 offen nt
    s_waitcnt vmcnt(3)
    s_add_u32 s63, s69, 180224
    buffer_load_dwordx4 v[136:139], v1, s[40:43], s63 offen nt
    s_waitcnt vmcnt(3)
    s_add_u32 s63, s69, 188416
    buffer_load_dwordx4 v[140:143], v1, s[40:43], s63 offen nt
    s_waitcnt vmcnt(3)
    s_add_u32 s63, s69, 262144
    buffer_load_dwordx4 v[48:51], v1, s[40:43], s63 offen nt
    s_waitcnt vmcnt(3)
    s_add_u32 s63, s69, 270336
    buffer_load_dwordx4 v[52:55], v1, s[40:43], s63 offen nt
    s_waitcnt lgkmcnt(0)
    s_barrier
    ds_read_b64_tr_b16 v[160:161], v20 offset:0
    ds_read_b64_tr_b16 v[162:163], v20 offset:512
    ds_read_b64_tr_b16 v[164:165], v20 offset:8192
    ds_read_b64_tr_b16 v[166:167], v20 offset:8704
    ds_read_b64_tr_b16 v[168:169], v20 offset:16384
    ds_read_b64_tr_b16 v[170:171], v20 offset:16896
    ds_read_b64_tr_b16 v[172:173], v20 offset:24576
    ds_read_b64_tr_b16 v[174:175], v20 offset:25088
    ds_read_b64_tr_b16 v[176:177], v21 offset:0
    ds_read_b64_tr_b16 v[178:179], v21 offset:512
    ds_read_b64_tr_b16 v[180:181], v21 offset:8192
    ds_read_b64_tr_b16 v[182:183], v21 offset:8704
    ds_read_b64_tr_b16 v[184:185], v21 offset:16384
    ds_read_b64_tr_b16 v[186:187], v21 offset:16896
    ds_read_b64_tr_b16 v[188:189], v21 offset:24576
    ds_read_b64_tr_b16 v[190:191], v21 offset:25088
    ds_read_b64_tr_b16 v[192:193], v21 offset:32768
    ds_read_b64_tr_b16 v[194:195], v21 offset:33280
    ds_read_b128 v[196:199], v16 offset:0
    ds_read_b128 v[200:203], v16 offset:128
    ds_read_b128 v[204:207], v16 offset:256
    ds_read_b128 v[208:211], v16 offset:384
    ds_read_b128 v[212:215], v16 offset:512
    ds_read_b128 v[216:219], v16 offset:640
    ds_read_b128 v[220:223], v16 offset:768
    ds_read_b128 v[224:227], v16 offset:896
    ds_read_b128 v[228:231], v16 offset:1024
    s_waitcnt lgkmcnt(8)
    v_mfma_f32_16x16x32_bf16 v[232:235], v[160:163], v[196:199], 0
    s_waitcnt lgkmcnt(7)
    v_mfma_f32_16x16x32_bf16 v[232:235], v[164:167], v[200:203], v[232:235]
    s_waitcnt lgkmcnt(6)
    v_mfma_f32_16x16x32_bf16 v[232:235], v[168:171], v[204:207], v[232:235]
    s_waitcnt lgkmcnt(5)
    v_mfma_f32_16x16x32_bf16 v[232:235], v[172:175], v[208:211], v[232:235]
    s_waitcnt lgkmcnt(4)
    v_mfma_f32_16x16x32_bf16 v[232:235], v[176:179], v[212:215], v[232:235]
    s_waitcnt lgkmcnt(3)
    v_mfma_f32_16x16x32_bf16 v[232:235], v[180:183], v[216:219], v[232:235]
    s_waitcnt lgkmcnt(2)
    v_mfma_f32_16x16x32_bf16 v[232:235], v[184:187], v[220:223], v[232:235]
    s_waitcnt lgkmcnt(1)
    v_mfma_f32_16x16x32_bf16 v[232:235], v[188:191], v[224:227], v[232:235]
    s_waitcnt lgkmcnt(0)
    v_mfma_f32_16x16x32_bf16 v[232:235], v[192:195], v[228:231], v[232:235]
    s_nop 7
    v_permlane32_swap_b32 v232, v234
    v_permlane32_swap_b32 v233, v235
    v_cndmask_b32 v233, v233, v234, s[96:97]
    v_cndmask_b32 v232, v232, v235, s[96:97]
    s_nop 1
    v_add_f32_dpp v236, v233, v232 quad_perm:[1,0,3,2] row_mask:0xf bank_mask:0xf
    v_cvt_pk_bf16_f32 v236, v236, v236
    v_lshlrev_b32 v236, 16, v236
    v_add_f32 v236, s58, v236
    v_cvt_pk_bf16_f32 v236, v236, v236
    ds_write_b16 v23, v236
    v_mov_b32 v243, s34
    s_waitcnt lgkmcnt(0)
    s_barrier
    ds_read2_b32 v[244:245], v24 offset1:1
    v_mov_b32 v241, s34
    s_waitcnt lgkmcnt(0)
    v_mov_b32 v240, v244
    v_mov_b32 v242, v245
    s_bfm_b64 exec, 16, 0
    buffer_store_dwordx4 v[240:243], v22, s[36:39], s59 offen sc1
    s_mov_b64 exec, -1
.Le_done:
    v_and_b32 v8, 1, v0
    v_lshlrev_b32 v8, 8, v8
    v_and_b32 v9, 0x3c, v0
    v_lshl_add_u32 v9, v9, 2, v8
    v_add_u32 v7, v9, v8
    v_and_b32 v9, 0x3c, v0
    v_lshrrev_b32 v8, 4, v8
    v_and_b32 v9, 4, v0
    v_lshl_add_u32 v9, v9, 3, v8
    s_lshl_b32 s58, s66, 14
    s_lshl_b32 s59, s67, 10
    s_add_u32 s58, s58, s59
    s_add_u32 s58, s58, 0x70000
    s_lshl4_add_u32 s59, s66, s67
    s_lshl_b32 s59, s59, 7
    s_add_u32 s59, s59, 0x430000
    s_waitcnt vmcnt(3)
    s_bitcmp1_b64 s[14:15], 18
    s_cbranch_scc0 1
    s_waitcnt vmcnt(2)
    s_add_u32 s63, s69, 278528
    buffer_load_dwordx4 v[80:83], v1, s[40:43], s63 offen nt
    v_and_b32 v157, 7, v0
    v_lshlrev_b32 v157, 2, v157
    s_mov_b32 s63, 0x4a1000
    buffer_load_dword v156, v157, s[36:39], s63 offen
    s_cmp_eq_u32 s3, 0
    s_cbranch_scc1 .Lst_m1_0
    s_cmp_eq_u32 s3, 1
    s_cbranch_scc1 .Lst_m1_1
    s_cmp_eq_u32 s3, 2
    s_cbranch_scc1 .Lst_m1_2
    s_cmp_eq_u32 s3, 3
    s_cbranch_scc1 .Lst_m1_3
    s_cmp_eq_u32 s3, 4
    s_cbranch_scc1 .Lst_m1_4
    s_cmp_eq_u32 s3, 5
    s_cbranch_scc1 .Lst_m1_5
    s_cmp_eq_u32 s3, 6
    s_cbranch_scc1 .Lst_m1_6
    s_cmp_eq_u32 s3, 7
    s_cbranch_scc1 .Lst_m1_7
.Lrt_m1_0:
.Lrt_m1_1:
.Lrt_m1_2:
.Lrt_m1_3:
.Lrt_m1_4:
.Lrt_m1_5:
.Lrt_m1_6:
.Lrt_m1_7:
    s_memrealtime s[8:9]
    s_waitcnt lgkmcnt(0)
    s_sub_u32 s8, s8, s30
    s_cmpk_ge_u32 s8, 909
    s_cbranch_scc1 .ap_57
    s_waitcnt vmcnt(5)
    s_cmpk_ge_u32 s8, 809
    s_cbranch_scc1 .ap_57
    s_waitcnt vmcnt(4)
    s_bitcmp1_b64 s[14:15], 19
    s_cbranch_scc0 1
    s_waitcnt vmcnt(3)
    s_cmpk_ge_u32 s8, 689
    s_cbranch_scc1 .ap_57
    s_waitcnt vmcnt(2)
.ap_57:
    s_add_u32 s63, s69, 286720
    buffer_load_dwordx4 v[84:87], v1, s[40:43], s63 offen nt
    s_memrealtime s[8:9]
    s_waitcnt lgkmcnt(0)
    s_sub_u32 s8, s8, s30
    s_cmpk_ge_u32 s8, 954
    s_cbranch_scc1 .ap_58
    s_waitcnt vmcnt(6)
    s_cmpk_ge_u32 s8, 854
    s_cbranch_scc1 .ap_58
    s_waitcnt vmcnt(4)
    s_bitcmp1_b64 s[14:15], 20
    s_cbranch_scc0 1
    s_waitcnt vmcnt(3)
    s_cmpk_ge_u32 s8, 734
    s_cbranch_scc1 .ap_58
    s_waitcnt vmcnt(2)
.ap_58:
    s_add_u32 s63, s69, 294912
    buffer_load_dwordx4 v[112:115], v1, s[40:43], s63 offen nt
    s_memrealtime s[8:9]
    s_waitcnt lgkmcnt(0)
    s_sub_u32 s8, s8, s30
    s_cmpk_ge_u32 s8, 999
    s_cbranch_scc1 .ap_59
    s_waitcnt vmcnt(6)
    s_cmpk_ge_u32 s8, 899
    s_cbranch_scc1 .ap_59
    s_waitcnt vmcnt(4)
    s_bitcmp1_b64 s[14:15], 21
    s_cbranch_scc0 1
    s_waitcnt vmcnt(3)
    s_cmpk_ge_u32 s8, 779
    s_cbranch_scc1 .ap_59
    s_waitcnt vmcnt(1)
.ap_59:
    s_add_u32 s63, s69, 303104
    buffer_load_dwordx4 v[116:119], v1, s[40:43], s63 offen nt
    s_memrealtime s[8:9]
    s_waitcnt lgkmcnt(0)
    s_sub_u32 s8, s8, s30
    s_cmpk_ge_u32 s8, 1044
    s_cbranch_scc1 .ap_60
    s_waitcnt vmcnt(6)
    s_cmpk_ge_u32 s8, 944
    s_cbranch_scc1 .ap_60
    s_waitcnt vmcnt(4)
    s_bitcmp1_b64 s[14:15], 22
    s_cbranch_scc0 1
    s_waitcnt vmcnt(2)
    s_cmpk_ge_u32 s8, 824
    s_cbranch_scc1 .ap_60
    s_waitcnt vmcnt(1)
.ap_60:
    s_add_u32 s63, s69, 311296
    buffer_load_dwordx4 v[144:147], v1, s[40:43], s63 offen nt
    s_waitcnt vmcnt(4)
    s_sub_u32 s63, s70, 300
    v_subrev_u32 v156, s63, v156
    v_mov_b32 v157, 600
    v_cmp_lt_u32 s[8:9], v156, v157
    v_add_u32_dpp v156, v156, v156 quad_perm:[1,0,3,2] row_mask:0xf bank_mask:0xf
    s_nop 1
    v_add_u32_dpp v156, v156, v156 quad_perm:[2,3,0,1] row_mask:0xf bank_mask:0xf
    s_nop 1
    v_add_u32_dpp v156, v156, v156 row_ror:4 row_mask:0xf bank_mask:0xf
    s_nop 0
    v_readfirstlane_b32 s63, v156
    s_cmp_eq_u64 s[8:9], -1
    s_nop 3
    s_cbranch_scc0 .et_61
    s_lshr_b32 s63, s63, 3
    s_sub_u32 s63, s63, 300
    s_add_u32 s30, s30, s63
    s_add_u32 s31, s31, s63
.et_61:
    s_memrealtime s[8:9]
    s_waitcnt lgkmcnt(0)
    s_sub_u32 s8, s8, s30
    s_cmpk_ge_u32 s8, 1089
    s_cbranch_scc1 .ap_62
    s_waitcnt vmcnt(4)
    s_cmpk_ge_u32 s8, 989
    s_cbranch_scc1 .ap_62
    s_waitcnt vmcnt(3)
    s_bitcmp1_b64 s[14:15], 23
    s_cbranch_scc0 1
    s_waitcnt vmcnt(2)
    s_cmpk_ge_u32 s8, 869
    s_cbranch_scc1 .ap_62
    s_waitcnt vmcnt(1)
.ap_62:
    s_add_u32 s63, s69, 319488
    buffer_load_dwordx4 v[148:151], v1, s[40:43], s63 offen nt
    s_memrealtime s[8:9]
    s_waitcnt lgkmcnt(0)
    s_sub_u32 s8, s8, s30
    s_cmpk_ge_u32 s8, 1134
    s_cbranch_scc1 .ap_63
    s_waitcnt vmcnt(5)
    s_cmpk_ge_u32 s8, 1034
    s_cbranch_scc1 .ap_63
    s_waitcnt vmcnt(3)
    s_bitcmp1_b64 s[14:15], 24
    s_cbranch_scc0 1
    s_waitcnt vmcnt(2)
    s_cmpk_ge_u32 s8, 914
    s_cbranch_scc1 .ap_63
    s_waitcnt vmcnt(1)
.ap_63:
    s_add_u32 s63, s69, 393216
    buffer_load_dwordx4 v[56:59], v1, s[40:43], s63 offen nt
    s_memrealtime s[8:9]
    s_waitcnt lgkmcnt(0)
    s_sub_u32 s8, s8, s30
    s_cmpk_ge_u32 s8, 1180
    s_cbranch_scc1 .ap_64
    s_waitcnt vmcnt(5)
    s_cmpk_ge_u32 s8, 1080
    s_cbranch_scc1 .ap_64
    s_waitcnt vmcnt(3)
    s_bitcmp1_b64 s[14:15], 25
    s_cbranch_scc0 1
    s_waitcnt vmcnt(2)
    s_cmpk_ge_u32 s8, 960
    s_cbranch_scc1 .ap_64
    s_branch .Lsk_m1_0
.Lst_m1_0:
    s_branch .Lrt_m1_0
.Lsk_m1_0:
    s_waitcnt vmcnt(1)
.ap_64:
    s_add_u32 s63, s69, 401408
    buffer_load_dwordx4 v[60:63], v1, s[40:43], s63 offen nt
    s_memrealtime s[8:9]
    s_waitcnt lgkmcnt(0)
    s_sub_u32 s8, s8, s30
    s_cmpk_ge_u32 s8, 1207
    s_cbranch_scc1 .ap_65
    s_waitcnt vmcnt(5)
    s_cmpk_ge_u32 s8, 1107
    s_cbranch_scc1 .ap_65
    s_waitcnt vmcnt(3)
    s_bitcmp1_b64 s[14:15], 26
    s_cbranch_scc0 1
    s_waitcnt vmcnt(2)
    s_cmpk_ge_u32 s8, 987
    s_cbranch_scc1 .ap_65
    s_waitcnt vmcnt(1)
.ap_65:
    s_add_u32 s63, s69, 409600
    buffer_load_dwordx4 v[88:91], v1, s[40:43], s63 offen nt
    s_memrealtime s[8:9]
    s_waitcnt lgkmcnt(0)
    s_sub_u32 s8, s8, s30
    s_cmpk_ge_u32 s8, 1234
    s_cbranch_scc1 .ap_66
    s_waitcnt vmcnt(5)
    s_cmpk_ge_u32 s8, 1134
    s_cbranch_scc1 .ap_66
    s_waitcnt vmcnt(3)
    s_bitcmp1_b64 s[14:15], 27
    s_cbranch_scc0 1
    s_waitcnt vmcnt(2)
    s_cmpk_ge_u32 s8, 1014
    s_cbranch_scc1 .ap_66
    s_waitcnt vmcnt(1)
.ap_66:
    s_add_u32 s63, s69, 417792
    buffer_load_dwordx4 v[92:95], v1, s[40:43], s63 offen nt
    s_memrealtime s[8:9]
    s_waitcnt vmcnt(8)
    s_waitcnt lgkmcnt(0)
    s_sub_u32 s8, s8, s30
    s_cmpk_ge_u32 s8, 1261
    s_cbranch_scc1 .ap_67
    s_waitcnt vmcnt(5)
    s_cmpk_ge_u32 s8, 1161
    s_cbranch_scc1 .ap_67
    s_waitcnt vmcnt(3)
    s_bitcmp1_b64 s[14:15], 28
    s_cbranch_scc0 1
    s_waitcnt vmcnt(2)
    s_cmpk_ge_u32 s8, 1041
    s_cbranch_scc1 .ap_67
    s_waitcnt vmcnt(1)
.ap_67:
    s_add_u32 s63, s69, 425984
    buffer_load_dwordx4 v[120:123], v1, s[40:43], s63 offen nt
    s_memrealtime s[8:9]
    s_waitcnt vmcnt(8)
    s_waitcnt lgkmcnt(0)
    s_sub_u32 s8, s8, s30
    s_cmpk_ge_u32 s8, 1288
    s_cbranch_scc1 .ap_68
    s_waitcnt vmcnt(5)
    s_cmpk_ge_u32 s8, 1188
    s_cbranch_scc1 .ap_68
    s_waitcnt vmcnt(3)
    s_bitcmp1_b64 s[14:15], 29
    s_cbranch_scc0 1
    s_waitcnt vmcnt(2)
    s_cmpk_ge_u32 s8, 1068
    s_cbranch_scc1 .ap_68
    s_waitcnt vmcnt(1)
.ap_68:
    s_add_u32 s63, s69, 434176
    buffer_load_dwordx4 v[124:127], v1, s[40:43], s63 offen nt
    s_memrealtime s[8:9]
    s_waitcnt vmcnt(8)
    s_waitcnt lgkmcnt(0)
    s_sub_u32 s8, s8, s30
    s_cmpk_ge_u32 s8, 1315
    s_cbranch_scc1 .ap_69
    s_waitcnt vmcnt(5)
    s_cmpk_ge_u32 s8, 1215
    s_cbranch_scc1 .ap_69
    s_waitcnt vmcnt(3)
    s_bitcmp1_b64 s[14:15], 30
    s_cbranch_scc0 1
    s_waitcnt vmcnt(2)
    s_cmpk_ge_u32 s8, 1095
    s_cbranch_scc1 .ap_69
    s_waitcnt vmcnt(1)
.ap_69:
    s_add_u32 s63, s69, 442368
    buffer_load_dwordx4 v[152:155], v1, s[40:43], s63 offen nt
    s_and_b32 s0, s0, 0xffffff80
    s_sub_u32 s0, s0, 1024
    buffer_load_dword v28, v4, s[36:39], s0 offen sc1
    s_memrealtime s[8:9]
    s_waitcnt vmcnt(9)
    s_waitcnt lgkmcnt(0)
    s_sub_u32 s8, s8, s30
    s_cmpk_ge_u32 s8, 1342
    s_cbranch_scc1 .ap_70
    s_waitcnt vmcnt(6)
    s_cmpk_ge_u32 s8, 1242
    s_cbranch_scc1 .ap_70
    s_waitcnt vmcnt(4)
    s_bitcmp1_b64 s[14:15], 31
    s_cbranch_scc0 1
    s_waitcnt vmcnt(3)
    s_cmpk_ge_u32 s8, 1122
    s_cbranch_scc1 .ap_70
    s_waitcnt vmcnt(2)
.ap_70:
    s_add_u32 s63, s69, 450560
    buffer_load_dwordx4 v[156:159], v1, s[40:43], s63 offen nt
    s_memrealtime s[8:9]
    s_waitcnt vmcnt(9)
    s_waitcnt lgkmcnt(0)
    s_sub_u32 s8, s8, s30
    s_cmpk_ge_u32 s8, 1369
    s_cbranch_scc1 .ap_71
    s_waitcnt vmcnt(6)
    s_cmpk_ge_u32 s8, 1269
    s_cbranch_scc1 .ap_71
    s_waitcnt vmcnt(4)
    s_bitcmp1_b64 s[14:15], 32
    s_cbranch_scc0 1
    s_waitcnt vmcnt(3)
    s_cmpk_ge_u32 s8, 1149
    s_cbranch_scc1 .ap_71
    s_waitcnt vmcnt(2)
.ap_71:
    v_bfe_u32 v1, v0, 4, 2
    v_and_b32 v10, 0xf0, v2
    v_lshlrev_b32 v1, 2, v1
    v_bfe_u32 v1, s6, v1, 4
    v_lshl_add_u32 v1, v1, 8, v10
    s_add_u32 s63, s69, 0
    buffer_load_dwordx4 v[160:163], v1, s[44:47], s63 offen nt
    s_memrealtime s[8:9]
    s_waitcnt vmcnt(9)
    s_waitcnt lgkmcnt(0)
    s_sub_u32 s8, s8, s30
    s_cmpk_ge_u32 s8, 1396
    s_cbranch_scc1 .ap_72
    s_waitcnt vmcnt(6)
    s_cmpk_ge_u32 s8, 1296
    s_cbranch_scc1 .ap_72
    s_waitcnt vmcnt(4)
    s_bitcmp1_b64 s[14:15], 33
    s_cbranch_scc0 1
    s_waitcnt vmcnt(3)
    s_cmpk_ge_u32 s8, 1176
    s_cbranch_scc1 .ap_72
    s_waitcnt vmcnt(1)
.ap_72:
    s_add_u32 s63, s69, 8192
    buffer_load_dwordx4 v[164:167], v1, s[44:47], s63 offen nt
    s_memrealtime s[8:9]
    s_waitcnt vmcnt(9)
    s_waitcnt lgkmcnt(0)
    s_sub_u32 s8, s8, s30
    s_cmpk_ge_u32 s8, 1423
    s_cbranch_scc1 .ap_73
    s_waitcnt vmcnt(6)
    s_cmpk_ge_u32 s8, 1323
    s_cbranch_scc1 .ap_73
    s_waitcnt vmcnt(4)
    s_bitcmp1_b64 s[14:15], 34
    s_cbranch_scc0 1
    s_waitcnt vmcnt(2)
    s_cmpk_ge_u32 s8, 1203
    s_cbranch_scc1 .ap_73
    s_waitcnt vmcnt(1)
.ap_73:
    s_add_u32 s63, s69, 16384
    buffer_load_dwordx4 v[168:171], v1, s[44:47], s63 offen nt
    s_memrealtime s[8:9]
    s_waitcnt vmcnt(9)
    s_waitcnt lgkmcnt(0)
    s_sub_u32 s8, s8, s30
    s_cmpk_ge_u32 s8, 1450
    s_cbranch_scc1 .ap_74
    s_waitcnt vmcnt(6)
    s_cmpk_ge_u32 s8, 1350
    s_cbranch_scc1 .ap_74
    s_waitcnt vmcnt(3)
    s_bitcmp1_b64 s[14:15], 35
    s_cbranch_scc0 1
    s_waitcnt vmcnt(2)
    s_cmpk_ge_u32 s8, 1230
    s_cbranch_scc1 .ap_74
    s_waitcnt vmcnt(1)
.ap_74:
    s_add_u32 s63, s69, 24576
    buffer_load_dwordx4 v[172:175], v1, s[44:47], s63 offen nt
    s_waitcnt vmcnt(5)
    v_cmp_eq_u32 vcc, s1, v28
    s_cmp_eq_u64 vcc, -1
    s_cselect_b32 s0, 0x800000, 0
    s_add_u32 s58, s58, s0
    buffer_load_dwordx4 v[16:19], v7, s[36:39], s58 offen offset:0 sc1
    buffer_load_dwordx4 v[20:23], v7, s[36:39], s58 offen offset:256 sc1
    s_memrealtime s[8:9]
    s_waitcnt lgkmcnt(0)
    s_sub_u32 s8, s8, s30
    s_cmpk_ge_u32 s8, 1479
    s_cbranch_scc1 .ap_75
    s_waitcnt vmcnt(5)
    s_cmpk_ge_u32 s8, 1379
    s_cbranch_scc1 .ap_75
    s_waitcnt vmcnt(3)
    s_bitcmp1_b64 s[14:15], 36
    s_cbranch_scc0 1
    s_waitcnt vmcnt(2)
    s_cmpk_ge_u32 s8, 1259
    s_cbranch_scc1 .ap_75
    s_waitcnt vmcnt(1)
.ap_75:
    s_add_u32 s63, s69, 32768
    buffer_load_dwordx4 v[176:179], v1, s[44:47], s63 offen nt
    s_memrealtime s[8:9]
    s_waitcnt lgkmcnt(0)
    s_sub_u32 s8, s8, s30
    s_cmpk_ge_u32 s8, 1509
    s_cbranch_scc1 .ap_76
    s_waitcnt vmcnt(5)
    s_cmpk_ge_u32 s8, 1409
    s_cbranch_scc1 .ap_76
    s_waitcnt vmcnt(3)
    s_bitcmp1_b64 s[14:15], 37
    s_cbranch_scc0 1
    s_waitcnt vmcnt(2)
    s_cmpk_ge_u32 s8, 1289
    s_cbranch_scc1 .ap_76
    s_branch .Lsk_m1_1
.Lst_m1_1:
    s_branch .Lrt_m1_1
.Lsk_m1_1:
    s_waitcnt vmcnt(1)
.ap_76:
    s_add_u32 s63, s69, 40960
    buffer_load_dwordx4 v[180:183], v1, s[44:47], s63 offen nt
    s_memrealtime s[8:9]
    s_waitcnt vmcnt(8)
    s_waitcnt lgkmcnt(0)
    s_sub_u32 s8, s8, s30
    s_cmpk_ge_u32 s8, 1539
    s_cbranch_scc1 .ap_77
    s_waitcnt vmcnt(5)
    s_cmpk_ge_u32 s8, 1439
    s_cbranch_scc1 .ap_77
    s_waitcnt vmcnt(3)
    s_bitcmp1_b64 s[14:15], 38
    s_cbranch_scc0 1
    s_waitcnt vmcnt(2)
    s_cmpk_ge_u32 s8, 1319
    s_cbranch_scc1 .ap_77
    s_waitcnt vmcnt(1)
.ap_77:
    s_add_u32 s63, s69, 49152
    buffer_load_dwordx4 v[184:187], v1, s[44:47], s63 offen nt
    s_waitcnt vmcnt(3)
    s_branch .gpc_79
.gp_78:
    s_xor_b32 s58, s58, 0x800000
    buffer_load_dwordx4 v[16:19], v7, s[36:39], s58 offen offset:0 sc1
    buffer_load_dwordx4 v[20:23], v7, s[36:39], s58 offen offset:256 sc1
    s_waitcnt vmcnt(0)
.gpc_79:
    v_min_u32 v10, v17, v19
    v_max_u32 v11, v17, v19
    v_min3_u32 v10, v10, v21, v23
    v_max3_u32 v11, v11, v21, v23
    v_cmp_eq_u32 vcc, s34, v10
    v_cmp_eq_u32 s[56:57], s34, v11
    s_and_b64 vcc, vcc, s[56:57]
    s_cmp_eq_u64 vcc, -1
    s_nop 2
    s_cbranch_scc1 .gpd_80
    s_sub_u32 s35, s35, 1
    s_cbranch_scc1 .Lexit
    s_sleep 1
    s_branch .gp_78
.gpd_80:
    s_mov_b32 vcc_lo, 0xcccccccc
    s_mov_b32 vcc_hi, 0xcccccccc
    v_cndmask_b32_e64 v24, v16, 0, vcc
    v_cndmask_b32_e64 v25, v18, 0, vcc
    v_cndmask_b32_e64 v26, v20, 0, vcc
    v_cndmask_b32_e64 v27, v22, 0, vcc
    v_cndmask_b32_e32 v28, 0, v16, vcc
    v_cndmask_b32_e32 v29, 0, v18, vcc
    v_cndmask_b32_e32 v30, 0, v20, vcc
    v_cndmask_b32_e32 v31, 0, v22, vcc
    v_mfma_f32_16x16x32_bf16 v[16:19], v[32:35], v[24:27], 0
    v_mfma_f32_16x16x32_bf16 v[32:35], v[40:43], v[24:27], 0
    v_mfma_f32_16x16x32_bf16 v[16:19], v[36:39], v[28:31], v[16:19]
    v_mfma_f32_16x16x32_bf16 v[40:43], v[48:51], v[24:27], 0
    v_mfma_f32_16x16x32_bf16 v[32:35], v[44:47], v[28:31], v[32:35]
    v_mfma_f32_16x16x32_bf16 v[48:51], v[56:59], v[24:27], 0
    v_mfma_f32_16x16x32_bf16 v[40:43], v[52:55], v[28:31], v[40:43]
    v_mfma_f32_16x16x32_bf16 v[56:59], v[64:67], v[24:27], 0
    v_mfma_f32_16x16x32_bf16 v[48:51], v[60:63], v[28:31], v[48:51]
    s_nop 1
    v_add_f32_dpp v10, v17, v16 row_ror:12 row_mask:0xf bank_mask:0x1
    s_memrealtime s[8:9]
    s_waitcnt lgkmcnt(0)
    s_sub_u32 s8, s8, s30
    s_cmpk_ge_u32 s8, 1569
    s_nop 0
    s_cbranch_scc1 .ap_81
    s_waitcnt vmcnt(3)
    s_cmpk_ge_u32 s8, 1469
    s_cbranch_scc1 .ap_81
    s_waitcnt vmcnt(3)
    s_bitcmp1_b64 s[14:15], 39
    s_cbranch_scc0 1
    s_waitcnt vmcnt(2)
    s_cmpk_ge_u32 s8, 1349
    s_cbranch_scc1 .ap_81
    s_waitcnt vmcnt(1)
.ap_81:
    s_add_u32 s63, s69, 57344
    buffer_load_dwordx4 v[188:191], v1, s[44:47], s63 offen nt
    v_mfma_f32_16x16x32_bf16 v[64:67], v[72:75], v[24:27], 0
    v_mfma_f32_16x16x32_bf16 v[56:59], v[68:71], v[28:31], v[56:59]
    v_add_f32_dpp v11, v33, v32 row_ror:12 row_mask:0xf bank_mask:0x1
    v_add_f32_dpp v10, v18, v10 row_ror:8 row_mask:0xf bank_mask:0x1
    v_mfma_f32_16x16x32_bf16 v[72:75], v[80:83], v[24:27], 0
    v_mfma_f32_16x16x32_bf16 v[64:67], v[76:79], v[28:31], v[64:67]
    v_add_f32_dpp v12, v41, v40 row_ror:12 row_mask:0xf bank_mask:0x1
    v_add_f32_dpp v11, v34, v11 row_ror:8 row_mask:0xf bank_mask:0x1
    v_add_f32_dpp v10, v19, v10 row_ror:4 row_mask:0xf bank_mask:0x1
    v_mfma_f32_16x16x32_bf16 v[80:83], v[88:91], v[24:27], 0
    v_mfma_f32_16x16x32_bf16 v[72:75], v[84:87], v[28:31], v[72:75]
    v_add_f32_dpp v13, v49, v48 row_ror:12 row_mask:0xf bank_mask:0x1
    v_add_f32_dpp v12, v42, v12 row_ror:8 row_mask:0xf bank_mask:0x1
    v_add_f32_dpp v11, v35, v11 row_ror:4 row_mask:0xf bank_mask:0x1
    v_mfma_f32_16x16x32_bf16 v[88:91], v[96:99], v[24:27], 0
    v_mfma_f32_16x16x32_bf16 v[80:83], v[92:95], v[28:31], v[80:83]
    v_add_f32_dpp v10, v58, v57 row_ror:12 row_mask:0xf bank_mask:0x2
    v_add_f32_dpp v13, v50, v13 row_ror:8 row_mask:0xf bank_mask:0x1
    v_add_f32_dpp v12, v43, v12 row_ror:4 row_mask:0xf bank_mask:0x1
    s_memrealtime s[8:9]
    s_waitcnt lgkmcnt(0)
    s_sub_u32 s8, s8, s30
    s_cmpk_ge_u32 s8, 1599
    s_nop 0
    s_cbranch_scc1 .ap_82
    s_waitcnt vmcnt(4)
    s_cmpk_ge_u32 s8, 1499
    s_cbranch_scc1 .ap_82
    s_waitcnt vmcnt(3)
    s_bitcmp1_b64 s[14:15], 40
    s_cbranch_scc0 1
    s_waitcnt vmcnt(2)
    s_cmpk_ge_u32 s8, 1379
    s_cbranch_scc1 .ap_82
    s_waitcnt vmcnt(1)
.ap_82:
    s_add_u32 s63, s69, 131072
    buffer_load_dwordx4 v[192:195], v1, s[44:47], s63 offen nt
    v_mfma_f32_16x16x32_bf16 v[96:99], v[104:107], v[24:27], 0
    v_mfma_f32_16x16x32_bf16 v[88:91], v[100:103], v[28:31], v[88:91]
    v_add_f32_dpp v11, v66, v65 row_ror:12 row_mask:0xf bank_mask:0x2
    v_add_f32_dpp v10, v59, v10 row_ror:8 row_mask:0xf bank_mask:0x2
    v_add_f32_dpp v13, v51, v13 row_ror:4 row_mask:0xf bank_mask:0x1
    v_mfma_f32_16x16x32_bf16 v[104:107], v[112:115], v[24:27], 0
    v_mfma_f32_16x16x32_bf16 v[96:99], v[108:111], v[28:31], v[96:99]
    v_add_f32_dpp v12, v74, v73 row_ror:12 row_mask:0xf bank_mask:0x2
    v_add_f32_dpp v11, v67, v11 row_ror:8 row_mask:0xf bank_mask:0x2
    v_add_f32_dpp v10, v56, v10 row_ror:4 row_mask:0xf bank_mask:0x2
    v_mfma_f32_16x16x32_bf16 v[112:115], v[120:123], v[24:27], 0
    v_mfma_f32_16x16x32_bf16 v[104:107], v[116:119], v[28:31], v[104:107]
    v_add_f32_dpp v13, v82, v81 row_ror:12 row_mask:0xf bank_mask:0x2
    v_add_f32_dpp v12, v75, v12 row_ror:8 row_mask:0xf bank_mask:0x2
    v_add_f32_dpp v11, v64, v11 row_ror:4 row_mask:0xf bank_mask:0x2
    v_mfma_f32_16x16x32_bf16 v[120:123], v[128:131], v[24:27], 0
    v_mfma_f32_16x16x32_bf16 v[112:115], v[124:127], v[28:31], v[112:115]
    v_add_f32_dpp v10, v91, v90 row_ror:12 row_mask:0xf bank_mask:0x4
    v_add_f32_dpp v13, v83, v13 row_ror:8 row_mask:0xf bank_mask:0x2
    v_add_f32_dpp v12, v72, v12 row_ror:4 row_mask:0xf bank_mask:0x2
    s_memrealtime s[8:9]
    s_waitcnt lgkmcnt(0)
    s_sub_u32 s8, s8, s30
    s_cmpk_ge_u32 s8, 1629
    s_nop 0
    s_cbranch_scc1 .ap_83
    s_waitcnt vmcnt(5)
    s_cmpk_ge_u32 s8, 1529
    s_cbranch_scc1 .ap_83
    s_waitcnt vmcnt(3)
    s_bitcmp1_b64 s[14:15], 41
    s_cbranch_scc0 1
    s_waitcnt vmcnt(2)
    s_cmpk_ge_u32 s8, 1409
    s_cbranch_scc1 .ap_83
    s_waitcnt vmcnt(1)
.ap_83:
    s_add_u32 s63, s69, 139264
    buffer_load_dwordx4 v[196:199], v1, s[44:47], s63 offen nt
    v_mfma_f32_16x16x32_bf16 v[128:131], v[136:139], v[24:27], 0
    v_mfma_f32_16x16x32_bf16 v[120:123], v[132:135], v[28:31], v[120:123]
    v_add_f32_dpp v11, v99, v98 row_ror:12 row_mask:0xf bank_mask:0x4
    v_add_f32_dpp v10, v88, v10 row_ror:8 row_mask:0xf bank_mask:0x4
    v_add_f32_dpp v13, v80, v13 row_ror:4 row_mask:0xf bank_mask:0x2
    v_mfma_f32_16x16x32_bf16 v[136:139], v[144:147], v[24:27], 0
    v_mfma_f32_16x16x32_bf16 v[128:131], v[140:143], v[28:31], v[128:131]
    v_add_f32_dpp v12, v107, v106 row_ror:12 row_mask:0xf bank_mask:0x4
    v_add_f32_dpp v11, v96, v11 row_ror:8 row_mask:0xf bank_mask:0x4
    v_add_f32_dpp v10, v89, v10 row_ror:4 row_mask:0xf bank_mask:0x4
    v_mfma_f32_16x16x32_bf16 v[144:147], v[152:155], v[24:27], 0
    v_mfma_f32_16x16x32_bf16 v[136:139], v[148:151], v[28:31], v[136:139]
    v_add_f32_dpp v13, v115, v114 row_ror:12 row_mask:0xf bank_mask:0x4
    v_add_f32_dpp v12, v104, v12 row_ror:8 row_mask:0xf bank_mask:0x4
    v_add_f32_dpp v11, v97, v11 row_ror:4 row_mask:0xf bank_mask:0x4
    v_mfma_f32_16x16x32_bf16 v[144:147], v[156:159], v[28:31], v[144:147]
    v_add_f32_dpp v10, v120, v123 row_ror:12 row_mask:0xf bank_mask:0x8
    v_add_f32_dpp v13, v112, v13 row_ror:8 row_mask:0xf bank_mask:0x4
    v_add_f32_dpp v12, v105, v12 row_ror:4 row_mask:0xf bank_mask:0x4
    s_branch .Lsk_m1_2
.Lst_m1_2:
    s_branch .Lrt_m1_2
.Lsk_m1_2:
    s_memrealtime s[8:9]
    s_waitcnt lgkmcnt(0)
    s_sub_u32 s8, s8, s30
    s_cmpk_ge_u32 s8, 1659
    s_nop 0
    s_cbranch_scc1 .ap_84
    s_waitcnt vmcnt(5)
    s_cmpk_ge_u32 s8, 1559
    s_cbranch_scc1 .ap_84
    s_waitcnt vmcnt(3)
    s_bitcmp1_b64 s[14:15], 42
    s_cbranch_scc0 1
    s_waitcnt vmcnt(2)
    s_cmpk_ge_u32 s8, 1439
    s_cbranch_scc1 .ap_84
    s_waitcnt vmcnt(1)
.ap_84:
    s_add_u32 s63, s69, 147456
    buffer_load_dwordx4 v[200:203], v1, s[44:47], s63 offen nt
    v_add_f32_dpp v11, v128, v131 row_ror:12 row_mask:0xf bank_mask:0x8
    v_add_f32_dpp v10, v121, v10 row_ror:8 row_mask:0xf bank_mask:0x8
    v_add_f32_dpp v13, v113, v13 row_ror:4 row_mask:0xf bank_mask:0x4
    v_add_f32_dpp v12, v136, v139 row_ror:12 row_mask:0xf bank_mask:0x8
    v_add_f32_dpp v11, v129, v11 row_ror:8 row_mask:0xf bank_mask:0x8
    v_add_f32_dpp v10, v122, v10 row_ror:4 row_mask:0xf bank_mask:0x8
    v_add_f32_dpp v13, v144, v147 row_ror:12 row_mask:0xf bank_mask:0x8
    v_add_f32_dpp v12, v137, v12 row_ror:8 row_mask:0xf bank_mask:0x8
    v_add_f32_dpp v11, v130, v11 row_ror:4 row_mask:0xf bank_mask:0x8
    v_add_f32_dpp v13, v145, v13 row_ror:8 row_mask:0xf bank_mask:0x8
    v_add_f32_dpp v12, v138, v12 row_ror:4 row_mask:0xf bank_mask:0x8
    s_memrealtime s[8:9]
    s_waitcnt lgkmcnt(0)
    s_sub_u32 s8, s8, s30
    s_cmpk_ge_u32 s8, 1689
    s_cbranch_scc1 .ap_85
    s_waitcnt vmcnt(5)
    s_cmpk_ge_u32 s8, 1589
    s_cbranch_scc1 .ap_85
    s_waitcnt vmcnt(3)
    s_bitcmp1_b64 s[14:15], 43
    s_cbranch_scc0 1
    s_waitcnt vmcnt(2)
    s_cmpk_ge_u32 s8, 1469
    s_cbranch_scc1 .ap_85
    s_waitcnt vmcnt(1)
.ap_85:
    s_add_u32 s63, s69, 155648
    buffer_load_dwordx4 v[204:207], v1, s[44:47], s63 offen nt
    v_add_f32_dpp v13, v146, v13 row_ror:4 row_mask:0xf bank_mask:0x8
    s_mov_b32 s60, 0x3db504f3
    s_mov_b32 s61, 0x3db504f3
    v_cvt_pk_bf16_f32 v10, v10, v11
    v_and_b32 v11, 0xffff0000, v10
    v_lshlrev_b32 v10, 16, v10
    v_cvt_pk_bf16_f32 v12, v12, v13
    v_and_b32 v13, 0xffff0000, v12
    v_lshlrev_b32 v12, 16, v12
    v_pk_mul_f32 v[10:11], v[10:11], s[60:61]
    v_pk_mul_f32 v[12:13], v[12:13], s[60:61]
    v_cvt_pk_bf16_f32 v10, v10, v11
    v_and_b32 v11, 0xffff0000, v10
    v_lshlrev_b32 v10, 16, v10
    v_cvt_pk_bf16_f32 v12, v12, v13
    v_and_b32 v13, 0xffff0000, v12
    v_lshlrev_b32 v12, 16, v12
    v_max_f32 v14, v10, v11
    v_max3_f32 v14, v14, v12, v13
    s_mov_b32 s60, 0x3fb8aa3b
    v_mov_b32 v22, s34
    v_mov_b32 v23, s34
    v_max_f32_dpp v14, v14, v14 quad_perm:[2,3,0,1] row_mask:0xf bank_mask:0xf
    s_nop 1
    v_max_f32_dpp v14, v14, v14 row_ror:4 row_mask:0xf bank_mask:0xf
    s_nop 1
    v_max_f32_dpp v14, v14, v14 row_ror:8 row_mask:0xf bank_mask:0xf
    v_mov_b32 v15, v14
    s_nop 1
    v_permlane16_swap_b32 v15, v14
    v_max_f32 v14, v15, v14
    v_mov_b32 v15, v14
    s_nop 1
    v_permlane32_swap_b32 v15, v14
    v_max_f32 v14, v15, v14
    v_mul_f32 v15, 0xbfb8aa3b, v14
    v_fma_f32 v10, v10, s60, v15
    v_fma_f32 v11, v11, s60, v15
    v_fma_f32 v12, v12, s60, v15
    v_fma_f32 v13, v13, s60, v15
    v_exp_f32 v10, v10
    v_exp_f32 v11, v11
    v_exp_f32 v12, v12
    v_exp_f32 v13, v13
    v_mov_b32 v20, v14
    v_pk_add_f32 v[16:17], v[10:11], v[12:13]
    v_add_f32 v21, v16, v17
    s_lshl_b32 s60, s68, 5
    s_lshl_b32 s61, s3, 4
    s_add_u32 s61, s61, 159104
    v_add_u32 v16, s61, v3
    v_mov_b32 v17, 159232
    v_mov_b32 v18, 1
    s_add_u32 s60, s60, s59
    v_add_f32_dpp v21, v21, v21 quad_perm:[2,3,0,1] row_mask:0xf bank_mask:0xf
    s_nop 1
    v_add_f32_dpp v21, v21, v21 row_ror:4 row_mask:0xf bank_mask:0xf
    s_nop 1
    v_add_f32_dpp v21, v21, v21 row_ror:8 row_mask:0xf bank_mask:0xf
    v_mov_b32 v15, v21
    s_nop 1
    v_permlane16_swap_b32 v15, v21
    v_add_f32 v21, v15, v21
    v_mov_b32 v15, v21
    s_nop 1
    v_permlane32_swap_b32 v15, v21
    v_add_f32 v21, v15, v21
    s_mov_b64 exec, 3
    ds_write_b64 v16, v[20:21]
    s_mov_b64 exec, 1
    ds_add_rtn_u32 v18, v17, v18
    s_mov_b64 exec, -1
    v_and_b32 v16, 0x78, v3
    v_or_b32 v16, 159104, v16
    s_waitcnt lgkmcnt(0)
    v_readfirstlane_b32 s61, v18
    s_cmp_eq_u32 s61, 7
    s_nop 3
    s_cbranch_scc0 .mlc_86
    ds_read_b64 v[18:19], v16
    s_waitcnt lgkmcnt(0)
    v_mov_b32 v20, v18
    s_nop 1
    v_max_f32_dpp v20, v20, v20 quad_perm:[2,3,0,1] row_mask:0xf bank_mask:0xf
    s_nop 1
    v_max_f32_dpp v20, v20, v20 row_ror:4 row_mask:0xf bank_mask:0xf
    s_nop 1
    v_max_f32_dpp v20, v20, v20 row_ror:8 row_mask:0xf bank_mask:0xf
    v_sub_f32 v18, v18, v20
    v_mul_f32 v18, 0x3fb8aa3b, v18
    v_exp_f32 v18, v18
    s_nop 0
    v_mul_f32 v21, v18, v19
    s_nop 1
    v_add_f32_dpp v21, v21, v21 quad_perm:[2,3,0,1] row_mask:0xf bank_mask:0xf
    s_nop 1
    v_add_f32_dpp v21, v21, v21 row_ror:4 row_mask:0xf bank_mask:0xf
    s_nop 1
    v_add_f32_dpp v21, v21, v21 row_ror:8 row_mask:0xf bank_mask:0xf
    s_mov_b64 exec, 3
    s_add_u32 s57, s60, 0x800000
    buffer_store_dwordx4 v[20:23], v2, s[36:39], s57 offen
    s_cmp_lg_u32 s0, 0
    s_nop 0
    s_cbranch_scc1 .nosl_87
    buffer_store_dwordx4 v[20:23], v2, s[36:39], s60 offen sc1
.nosl_87:
    s_mov_b64 exec, -1
.mlc_86:
    s_add_u32 s59, s59, s0
    s_memrealtime s[8:9]
    s_waitcnt lgkmcnt(0)
    s_sub_u32 s8, s8, s30
    s_cmpk_ge_u32 s8, 1719
    s_cbranch_scc1 .ap_88
    s_waitcnt vmcnt(5)
    s_cmpk_ge_u32 s8, 1619
    s_cbranch_scc1 .ap_88
    s_waitcnt vmcnt(3)
    s_bitcmp1_b64 s[14:15], 44
    s_cbranch_scc0 1
    s_waitcnt vmcnt(2)
    s_cmpk_ge_u32 s8, 1499
    s_cbranch_scc1 .ap_88
    s_waitcnt vmcnt(1)
.ap_88:
    s_add_u32 s63, s69, 163840
    buffer_load_dwordx4 v[208:211], v1, s[44:47], s63 offen nt
    s_cmp_eq_u32 s3, 0
    s_cbranch_scc1 .Lst_m2_0
    s_cmp_eq_u32 s3, 1
    s_cbranch_scc1 .Lst_m2_1
    s_cmp_eq_u32 s3, 2
    s_cbranch_scc1 .Lst_m2_2
    s_cmp_eq_u32 s3, 3
    s_cbranch_scc1 .Lrt_m2_3
.Lrt_m2_0:
.Lrt_m2_1:
.Lrt_m2_2:
.Lrt_m2_3:
    v_mov_b32 v16, 0
    v_bfe_u32 v17, v0, 3, 1
    v_lshl_add_u32 v16, v17, 5, v16
    v_bfe_u32 v17, v0, 5, 1
    v_lshl_add_u32 v16, v17, 4, v16
    v_bfe_u32 v17, v0, 0, 3
    v_lshl_add_u32 v16, v17, 1, v16
    v_bfe_u32 v17, v0, 4, 1
    v_lshl_add_u32 v16, v17, 0, v16
    v_lshlrev_b32 v7, 1, v16
    v_and_b32 v8, 62, v16
    v_lshlrev_b32 v8, 2, v8
    s_mul_i32 s100, s3, 1152
    s_lshl_b32 s56, s65, 7
    s_add_u32 s100, s100, s56
    s_branch .Lsk_m1_3
.Lst_m1_3:
    s_branch .Lrt_m1_3
.Lsk_m1_3:
    s_mov_b32 s52, s4
    s_and_b32 s53, s5, 0xffff
    s_mov_b32 s54, 0x2400
    s_mov_b32 s55, 0x00020000
    buffer_load_ushort v40, v7, s[52:55], s100 offen
    s_lshr_b32 s56, s64, 1
    s_and_b32 s57, s3, 3
    s_cmp_lg_u32 s56, s57
    s_cselect_b64 exec, 0, -1
    s_mov_b32 s48, s16
    s_and_b32 s49, s17, 0xffff
    s_mov_b32 s50, 0x480
    s_mov_b32 s51, 0x00020000
    buffer_load_dwordx2 v[48:49], v3, s[48:51], 0 offen
    buffer_load_dwordx2 v[50:51], v3, s[48:51], 0 offen offset:512
    buffer_load_dword v34, v4, s[48:51], 0 offen
    s_mov_b32 s48, s28
    s_and_b32 s49, s29, 0xffff
    s_mov_b32 s50, 0x2400
    s_mov_b32 s51, 0x00020000
    buffer_load_ushort v39, v7, s[48:51], s100 offen nt
    s_mov_b64 exec, -1
    s_memrealtime s[8:9]
    s_waitcnt vmcnt(13)
    s_waitcnt lgkmcnt(0)
    s_sub_u32 s8, s8, s30
    s_cmpk_ge_u32 s8, 1749
    s_cbranch_scc1 .ap_89
    s_waitcnt vmcnt(10)
    s_cmpk_ge_u32 s8, 1649
    s_cbranch_scc1 .ap_89
    s_waitcnt vmcnt(8)
    s_bitcmp1_b64 s[14:15], 45
    s_cbranch_scc0 1
    s_waitcnt vmcnt(7)
    s_cmpk_ge_u32 s8, 1529
    s_cbranch_scc1 .ap_89
    s_waitcnt vmcnt(6)
.ap_89:
    s_add_u32 s63, s69, 172032
    buffer_load_dwordx4 v[212:215], v1, s[44:47], s63 offen nt
    s_memrealtime s[8:9]
    s_waitcnt vmcnt(13)
    s_waitcnt lgkmcnt(0)
    s_sub_u32 s8, s8, s30
    s_cmpk_ge_u32 s8, 1780
    s_cbranch_scc1 .ap_90
    s_waitcnt vmcnt(10)
    s_cmpk_ge_u32 s8, 1680
    s_cbranch_scc1 .ap_90
    s_waitcnt vmcnt(8)
    s_bitcmp1_b64 s[14:15], 46
    s_cbranch_scc0 1
    s_waitcnt vmcnt(7)
    s_cmpk_ge_u32 s8, 1560
    s_cbranch_scc1 .ap_90
    s_waitcnt vmcnt(6)
.ap_90:
    s_add_u32 s63, s69, 180224
    buffer_load_dwordx4 v[216:219], v1, s[44:47], s63 offen nt
    s_memrealtime s[8:9]
    s_waitcnt vmcnt(13)
    s_waitcnt lgkmcnt(0)
    s_sub_u32 s8, s8, s30
    s_cmpk_ge_u32 s8, 1812
    s_cbranch_scc1 .ap_91
    s_waitcnt vmcnt(10)
    s_cmpk_ge_u32 s8, 1712
    s_cbranch_scc1 .ap_91
    s_waitcnt vmcnt(8)
    s_bitcmp1_b64 s[14:15], 47
    s_cbranch_scc0 1
    s_waitcnt vmcnt(7)
    s_cmpk_ge_u32 s8, 1592
    s_cbranch_scc1 .ap_91
    s_waitcnt vmcnt(1)
.ap_91:
    s_add_u32 s63, s69, 188416
    buffer_load_dwordx4 v[220:223], v1, s[44:47], s63 offen nt
    s_memrealtime s[8:9]
    s_waitcnt vmcnt(13)
    s_waitcnt lgkmcnt(0)
    s_sub_u32 s8, s8, s30
    s_cmpk_ge_u32 s8, 1844
    s_cbranch_scc1 .ap_92
    s_waitcnt vmcnt(10)
    s_cmpk_ge_u32 s8, 1744
    s_cbranch_scc1 .ap_92
    s_waitcnt vmcnt(8)
    s_bitcmp1_b64 s[14:15], 48
    s_cbranch_scc0 1
    s_waitcnt vmcnt(2)
    s_cmpk_ge_u32 s8, 1624
    s_cbranch_scc1 .ap_92
    s_waitcnt vmcnt(1)
.ap_92:
    s_add_u32 s63, s69, 262144
    buffer_load_dwordx4 v[224:227], v1, s[44:47], s63 offen nt
    s_memrealtime s[8:9]
    s_waitcnt vmcnt(13)
    s_waitcnt lgkmcnt(0)
    s_sub_u32 s8, s8, s30
    s_cmpk_ge_u32 s8, 1876
    s_cbranch_scc1 .ap_93
    s_waitcnt vmcnt(10)
    s_cmpk_ge_u32 s8, 1776
    s_cbranch_scc1 .ap_93
    s_waitcnt vmcnt(3)
    s_bitcmp1_b64 s[14:15], 49
    s_cbranch_scc0 1
    s_waitcnt vmcnt(2)
    s_cmpk_ge_u32 s8, 1656
    s_cbranch_scc1 .ap_93
    s_waitcnt vmcnt(1)
.ap_93:
    s_add_u32 s63, s69, 270336
    buffer_load_dwordx4 v[228:231], v1, s[44:47], s63 offen nt
    s_memrealtime s[8:9]
    s_waitcnt vmcnt(13)
    s_waitcnt lgkmcnt(0)
    s_sub_u32 s8, s8, s30
    s_cmpk_ge_u32 s8, 1908
    s_cbranch_scc1 .ap_94
    s_waitcnt vmcnt(10)
    s_cmpk_ge_u32 s8, 1808
    s_cbranch_scc1 .ap_94
    s_waitcnt vmcnt(3)
    s_bitcmp1_b64 s[14:15], 50
    s_cbranch_scc0 1
    s_waitcnt vmcnt(2)
    s_cmpk_ge_u32 s8, 1688
    s_cbranch_scc1 .ap_94
    s_waitcnt vmcnt(1)
.ap_94:
    s_add_u32 s63, s69, 278528
    buffer_load_dwordx4 v[232:235], v1, s[44:47], s63 offen nt
    s_memrealtime s[8:9]
    s_waitcnt vmcnt(13)
    s_waitcnt lgkmcnt(0)
    s_sub_u32 s8, s8, s30
    s_cmpk_ge_u32 s8, 1939
    s_cbranch_scc1 .ap_95
    s_waitcnt vmcnt(5)
    s_cmpk_ge_u32 s8, 1839
    s_cbranch_scc1 .ap_95
    s_waitcnt vmcnt(3)
    s_bitcmp1_b64 s[14:15], 51
    s_cbranch_scc0 1
    s_waitcnt vmcnt(2)
    s_cmpk_ge_u32 s8, 1719
    s_cbranch_scc1 .ap_95
    s_waitcnt vmcnt(1)
.ap_95:
    s_add_u32 s63, s69, 286720
    buffer_load_dwordx4 v[236:239], v1, s[44:47], s63 offen nt
    s_memrealtime s[8:9]
    s_waitcnt vmcnt(13)
    s_waitcnt lgkmcnt(0)
    s_sub_u32 s8, s8, s30
    s_cmpk_ge_u32 s8, 1971
    s_cbranch_scc1 .ap_96
    s_waitcnt vmcnt(5)
    s_cmpk_ge_u32 s8, 1871
    s_cbranch_scc1 .ap_96
    s_waitcnt vmcnt(3)
    s_bitcmp1_b64 s[14:15], 52
    s_cbranch_scc0 1
    s_waitcnt vmcnt(2)
    s_cmpk_ge_u32 s8, 1751
    s_cbranch_scc1 .ap_96
    s_waitcnt vmcnt(1)
.ap_96:
    s_add_u32 s63, s69, 294912
    buffer_load_dwordx4 v[240:243], v1, s[44:47], s63 offen nt
    s_memrealtime s[8:9]
    s_branch .Lsk_m1_4
.Lst_m1_4:
    s_branch .Lrt_m1_4
.Lsk_m1_4:
    s_waitcnt vmcnt(13)
    s_waitcnt lgkmcnt(0)
    s_sub_u32 s8, s8, s30
    s_cmpk_ge_u32 s8, 2003
    s_cbranch_scc1 .ap_97
    s_waitcnt vmcnt(5)
    s_cmpk_ge_u32 s8, 1903
    s_cbranch_scc1 .ap_97
    s_waitcnt vmcnt(3)
    s_bitcmp1_b64 s[14:15], 53
    s_cbranch_scc0 1
    s_waitcnt vmcnt(2)
    s_cmpk_ge_u32 s8, 1783
    s_cbranch_scc1 .ap_97
    s_waitcnt vmcnt(1)
.ap_97:
    s_add_u32 s63, s69, 303104
    buffer_load_dwordx4 v[244:247], v1, s[44:47], s63 offen nt
    buffer_load_dwordx4 v[24:27], v9, s[36:39], s59 offen offset:0 sc1
    s_memrealtime s[8:9]
    s_waitcnt vmcnt(8)
    s_waitcnt lgkmcnt(0)
    s_sub_u32 s8, s8, s30
    s_cmpk_ge_u32 s8, 2035
    s_cbranch_scc1 .ap_98
    s_waitcnt vmcnt(5)
    s_cmpk_ge_u32 s8, 1935
    s_cbranch_scc1 .ap_98
    s_waitcnt vmcnt(3)
    s_bitcmp1_b64 s[14:15], 54
    s_cbranch_scc0 1
    s_waitcnt vmcnt(2)
    s_cmpk_ge_u32 s8, 1815
    s_cbranch_scc1 .ap_98
    s_waitcnt vmcnt(1)
.ap_98:
    s_add_u32 s63, s69, 311296
    buffer_load_dwordx4 v[248:251], v1, s[44:47], s63 offen nt
    s_memrealtime s[8:9]
    s_waitcnt vmcnt(8)
    s_waitcnt lgkmcnt(0)
    s_sub_u32 s8, s8, s30
    s_cmpk_ge_u32 s8, 2067
    s_cbranch_scc1 .ap_99
    s_waitcnt vmcnt(5)
    s_cmpk_ge_u32 s8, 1967
    s_cbranch_scc1 .ap_99
    s_waitcnt vmcnt(3)
    s_bitcmp1_b64 s[14:15], 55
    s_cbranch_scc0 1
    s_waitcnt vmcnt(2)
    s_cmpk_ge_u32 s8, 1847
    s_cbranch_scc1 .ap_99
    s_waitcnt vmcnt(1)
.ap_99:
    s_add_u32 s63, s69, 319488
    buffer_load_dwordx4 v[252:255], v1, s[44:47], s63 offen nt
    s_memrealtime s[8:9]
    s_waitcnt vmcnt(8)
    s_waitcnt lgkmcnt(0)
    s_sub_u32 s8, s8, s30
    s_cmpk_ge_u32 s8, 2098
    s_cbranch_scc1 .ap_100
    s_waitcnt vmcnt(5)
    s_cmpk_ge_u32 s8, 1998
    s_cbranch_scc1 .ap_100
    s_waitcnt vmcnt(3)
    s_bitcmp1_b64 s[14:15], 56
    s_cbranch_scc0 1
    s_waitcnt vmcnt(2)
    s_cmpk_ge_u32 s8, 1878
    s_cbranch_scc1 .ap_100
    s_waitcnt vmcnt(1)
.ap_100:
    s_add_u32 s63, s69, 393216
    buffer_load_dwordx4 v[36:39], v1, s[44:47], s63 offen nt
    s_memrealtime s[8:9]
    s_waitcnt vmcnt(8)
    s_waitcnt lgkmcnt(0)
    s_sub_u32 s8, s8, s30
    s_cmpk_ge_u32 s8, 2130
    s_cbranch_scc1 .ap_101
    s_waitcnt vmcnt(5)
    s_cmpk_ge_u32 s8, 2030
    s_cbranch_scc1 .ap_101
    s_waitcnt vmcnt(3)
    s_bitcmp1_b64 s[14:15], 57
    s_cbranch_scc0 1
    s_waitcnt vmcnt(2)
    s_cmpk_ge_u32 s8, 1910
    s_cbranch_scc1 .ap_101
    s_waitcnt vmcnt(1)
.ap_101:
    s_add_u32 s63, s69, 401408
    buffer_load_dwordx4 v[44:47], v1, s[44:47], s63 offen nt
    s_memrealtime s[8:9]
    s_waitcnt vmcnt(8)
    s_waitcnt lgkmcnt(0)
    s_sub_u32 s8, s8, s30
    s_cmpk_ge_u32 s8, 2162
    s_cbranch_scc1 .ap_102
    s_waitcnt vmcnt(5)
    s_cmpk_ge_u32 s8, 2062
    s_cbranch_scc1 .ap_102
    s_waitcnt vmcnt(3)
    s_bitcmp1_b64 s[14:15], 58
    s_cbranch_scc0 1
    s_waitcnt vmcnt(2)
    s_cmpk_ge_u32 s8, 1942
    s_cbranch_scc1 .ap_102
    s_waitcnt vmcnt(1)
.ap_102:
    s_add_u32 s63, s69, 409600
    buffer_load_dwordx4 v[52:55], v1, s[44:47], s63 offen nt
    s_waitcnt vmcnt(5)
    s_branch .gpc_104
.gp_103:
    s_xor_b32 s59, s59, 0x800000
    buffer_load_dwordx4 v[24:27], v9, s[36:39], s59 offen offset:0 sc1
    s_waitcnt vmcnt(0)
.gpc_104:
    v_cmp_eq_u32 vcc, s34, v26
    s_cmp_eq_u64 vcc, -1
    s_nop 3
    s_cbranch_scc1 .gpd_105
    s_sub_u32 s35, s35, 1
    s_cbranch_scc1 .Lexit
    s_sleep 1
    s_branch .gp_103
.gpd_105:
    v_mov_b32 v16, v24
    s_nop 1
    v_max_f32_dpp v16, v16, v16 row_ror:4 row_mask:0xf bank_mask:0xf
    v_sub_f32 v17, v24, v16
    v_sub_f32 v18, v14, v16
    v_mul_f32 v17, 0x3fb8aa3b, v17
    v_mul_f32 v18, 0x3fb8aa3b, v18
    v_exp_f32 v17, v17
    v_exp_f32 v18, v18
    v_mul_f32 v17, v17, v25
    s_nop 1
    v_add_f32_dpp v17, v17, v17 row_ror:4 row_mask:0xf bank_mask:0xf
    v_rcp_f32 v19, v17
    s_nop 0
    v_fma_f32 v15, -v17, v19, 1.0
    v_fma_f32 v19, v15, v19, v19
    v_mul_f32 v18, v18, v19
    v_mul_f32 v10, v10, v18
    v_mul_f32 v11, v11, v18
    v_mul_f32 v12, v12, v18
    v_mul_f32 v13, v13, v18
    v_mov_b32_dpp v112, v10 quad_perm:[2,3,0,1] row_mask:0xf bank_mask:0xf
    v_mov_b32_dpp v113, v11 quad_perm:[2,3,0,1] row_mask:0xf bank_mask:0xf
    v_mov_b32_dpp v114, v12 quad_perm:[2,3,0,1] row_mask:0xf bank_mask:0xf
    v_mov_b32_dpp v115, v13 quad_perm:[2,3,0,1] row_mask:0xf bank_mask:0xf
    v_cvt_pk_bf16_f32 v96, v10, v112
    v_cvt_pk_bf16_f32 v100, v11, v113
    v_cvt_pk_bf16_f32 v104, v12, v114
    v_cvt_pk_bf16_f32 v108, v13, v115
    v_mov_b32_dpp v97, v96 row_ror:12 row_mask:0xf bank_mask:0xf
    v_mov_b32_dpp v101, v100 row_ror:12 row_mask:0xf bank_mask:0xf
    v_mov_b32_dpp v105, v104 row_ror:12 row_mask:0xf bank_mask:0xf
    v_mov_b32_dpp v109, v108 row_ror:12 row_mask:0xf bank_mask:0xf
    v_mov_b32_dpp v98, v96 row_ror:8 row_mask:0xf bank_mask:0xf
    v_mov_b32_dpp v102, v100 row_ror:8 row_mask:0xf bank_mask:0xf
    v_mov_b32_dpp v106, v104 row_ror:8 row_mask:0xf bank_mask:0xf
    v_mov_b32_dpp v110, v108 row_ror:8 row_mask:0xf bank_mask:0xf
    v_mov_b32_dpp v99, v96 row_ror:4 row_mask:0xf bank_mask:0xf
    v_mov_b32_dpp v103, v100 row_ror:4 row_mask:0xf bank_mask:0xf
    v_mov_b32_dpp v107, v104 row_ror:4 row_mask:0xf bank_mask:0xf
    v_mov_b32_dpp v111, v108 row_ror:4 row_mask:0xf bank_mask:0xf
    s_lshl_b32 s60, s3, 10
    s_add_u32 s60, s60, 147456
    v_lshlrev_b32 v10, 5, v0
    v_add_u32 v10, s60, v10
    s_memrealtime s[8:9]
    s_waitcnt lgkmcnt(0)
    s_sub_u32 s8, s8, s30
    s_cmpk_ge_u32 s8, 2194
    s_cbranch_scc1 .ap_106
    s_waitcnt vmcnt(5)
    s_cmpk_ge_u32 s8, 2094
    s_cbranch_scc1 .ap_106
    s_waitcnt vmcnt(3)
    s_bitcmp1_b64 s[14:15], 59
    s_cbranch_scc0 1
    s_waitcnt vmcnt(2)
    s_cmpk_ge_u32 s8, 1974
    s_cbranch_scc1 .ap_106
    s_waitcnt vmcnt(1)
.ap_106:
    s_add_u32 s63, s69, 417792
    buffer_load_dwordx4 v[60:63], v1, s[44:47], s63 offen nt
    v_perm_b32 v112, v164, v160, s94
    v_perm_b32 v113, v172, v168, s94
    v_perm_b32 v114, v180, v176, s94
    v_perm_b32 v115, v188, v184, s94
    s_nop 1
    v_mfma_f32_16x16x32_bf16 v[128:131], v[96:99], v[112:115], 0
    v_perm_b32 v116, v164, v160, s95
    v_perm_b32 v117, v172, v168, s95
    v_perm_b32 v118, v180, v176, s95
    v_perm_b32 v119, v188, v184, s95
    s_nop 1
    v_mfma_f32_16x16x32_bf16 v[132:135], v[96:99], v[116:119], 0
    v_perm_b32 v120, v165, v161, s94
    v_perm_b32 v121, v173, v169, s94
    v_perm_b32 v122, v181, v177, s94
    v_perm_b32 v123, v189, v185, s94
    s_nop 1
    v_mfma_f32_16x16x32_bf16 v[136:139], v[96:99], v[120:123], 0
    v_perm_b32 v124, v165, v161, s95
    v_perm_b32 v125, v173, v169, s95
    s_branch .Lsk_m1_5
.Lst_m1_5:
    s_branch .Lrt_m1_5
.Lsk_m1_5:
    v_perm_b32 v126, v181, v177, s95
    v_perm_b32 v127, v189, v185, s95
    s_nop 1
    v_mfma_f32_16x16x32_bf16 v[140:143], v[96:99], v[124:127], 0
    v_perm_b32 v112, v166, v162, s94
    v_perm_b32 v113, v174, v170, s94
    v_perm_b32 v114, v182, v178, s94
    v_perm_b32 v115, v190, v186, s94
    s_nop 1
    v_mfma_f32_16x16x32_bf16 v[144:147], v[96:99], v[112:115], 0
    v_perm_b32 v116, v166, v162, s95
    v_perm_b32 v117, v174, v170, s95
    v_perm_b32 v118, v182, v178, s95
    v_perm_b32 v119, v190, v186, s95
    s_nop 1
    v_mfma_f32_16x16x32_bf16 v[148:151], v[96:99], v[116:119], 0
    v_perm_b32 v120, v167, v163, s94
    v_perm_b32 v121, v175, v171, s94
    v_perm_b32 v122, v183, v179, s94
    v_perm_b32 v123, v191, v187, s94
    s_nop 1
    v_mfma_f32_16x16x32_bf16 v[152:155], v[96:99], v[120:123], 0
    v_perm_b32 v124, v167, v163, s95
    v_perm_b32 v125, v175, v171, s95
    v_perm_b32 v126, v183, v179, s95
    v_perm_b32 v127, v191, v187, s95
    s_nop 1
    v_mfma_f32_16x16x32_bf16 v[156:159], v[96:99], v[124:127], 0
    s_memrealtime s[8:9]
    s_waitcnt lgkmcnt(0)
    s_sub_u32 s8, s8, s30
    s_cmpk_ge_u32 s8, 2226
    s_nop 3
    s_cbranch_scc1 .ap_107
    s_waitcnt vmcnt(5)
    s_cmpk_ge_u32 s8, 2126
    s_cbranch_scc1 .ap_107
    s_waitcnt vmcnt(3)
    s_bitcmp1_b64 s[14:15], 60
    s_cbranch_scc0 1
    s_waitcnt vmcnt(2)
    s_cmpk_ge_u32 s8, 2006
    s_cbranch_scc1 .ap_107
    s_waitcnt vmcnt(1)
.ap_107:
    s_add_u32 s63, s69, 425984
    buffer_load_dwordx4 v[68:71], v1, s[44:47], s63 offen nt
    v_perm_b32 v112, v196, v192, s94
    v_perm_b32 v113, v204, v200, s94
    v_perm_b32 v114, v212, v208, s94
    v_perm_b32 v115, v220, v216, s94
    s_nop 1
    v_mfma_f32_16x16x32_bf16 v[128:131], v[100:103], v[112:115], v[128:131]
    v_perm_b32 v116, v196, v192, s95
    v_perm_b32 v117, v204, v200, s95
    v_perm_b32 v118, v212, v208, s95
    v_perm_b32 v119, v220, v216, s95
    s_nop 1
    v_mfma_f32_16x16x32_bf16 v[132:135], v[100:103], v[116:119], v[132:135]
    v_perm_b32 v120, v197, v193, s94
    v_perm_b32 v121, v205, v201, s94
    v_perm_b32 v122, v213, v209, s94
    v_perm_b32 v123, v221, v217, s94
    s_nop 1
    v_mfma_f32_16x16x32_bf16 v[136:139], v[100:103], v[120:123], v[136:139]
    v_perm_b32 v124, v197, v193, s95
    v_perm_b32 v125, v205, v201, s95
    v_perm_b32 v126, v213, v209, s95
    v_perm_b32 v127, v221, v217, s95
    s_nop 1
    v_mfma_f32_16x16x32_bf16 v[140:143], v[100:103], v[124:127], v[140:143]
    v_perm_b32 v112, v198, v194, s94
    v_perm_b32 v113, v206, v202, s94
    v_perm_b32 v114, v214, v210, s94
    v_perm_b32 v115, v222, v218, s94
    s_nop 1
    v_mfma_f32_16x16x32_bf16 v[144:147], v[100:103], v[112:115], v[144:147]
    v_perm_b32 v116, v198, v194, s95
    v_perm_b32 v117, v206, v202, s95
    v_perm_b32 v118, v214, v210, s95
    v_perm_b32 v119, v222, v218, s95
    s_nop 1
    v_mfma_f32_16x16x32_bf16 v[148:151], v[100:103], v[116:119], v[148:151]
    v_perm_b32 v120, v199, v195, s94
    v_perm_b32 v121, v207, v203, s94
    v_perm_b32 v122, v215, v211, s94
    v_perm_b32 v123, v223, v219, s94
    s_nop 1
    v_mfma_f32_16x16x32_bf16 v[152:155], v[100:103], v[120:123], v[152:155]
    v_perm_b32 v124, v199, v195, s95
    v_perm_b32 v125, v207, v203, s95
    v_perm_b32 v126, v215, v211, s95
    v_perm_b32 v127, v223, v219, s95
    s_nop 1
    v_mfma_f32_16x16x32_bf16 v[156:159], v[100:103], v[124:127], v[156:159]
    s_memrealtime s[8:9]
    s_waitcnt lgkmcnt(0)
    s_sub_u32 s8, s8, s30
    s_cmpk_ge_u32 s8, 2257
    s_nop 3
    s_cbranch_scc1 .ap_108
    s_waitcnt vmcnt(5)
    s_cmpk_ge_u32 s8, 2157
    s_cbranch_scc1 .ap_108
    s_waitcnt vmcnt(3)
    s_bitcmp1_b64 s[14:15], 61
    s_cbranch_scc0 1
    s_waitcnt vmcnt(2)
    s_cmpk_ge_u32 s8, 2037
    s_cbranch_scc1 .ap_108
    s_waitcnt vmcnt(1)
.ap_108:
    s_add_u32 s63, s69, 434176
    buffer_load_dwordx4 v[76:79], v1, s[44:47], s63 offen nt
    s_waitcnt vmcnt(6)
    v_perm_b32 v112, v228, v224, s94
    v_perm_b32 v113, v236, v232, s94
    v_perm_b32 v114, v244, v240, s94
    v_perm_b32 v115, v252, v248, s94
    s_nop 1
    v_mfma_f32_16x16x32_bf16 v[128:131], v[104:107], v[112:115], v[128:131]
    v_perm_b32 v116, v228, v224, s95
    v_perm_b32 v117, v236, v232, s95
    v_perm_b32 v118, v244, v240, s95
    v_perm_b32 v119, v252, v248, s95
    s_nop 1
    v_mfma_f32_16x16x32_bf16 v[132:135], v[104:107], v[116:119], v[132:135]
    v_perm_b32 v120, v229, v225, s94
    v_perm_b32 v121, v237, v233, s94
    v_perm_b32 v122, v245, v241, s94
    v_perm_b32 v123, v253, v249, s94
    s_nop 1
    v_mfma_f32_16x16x32_bf16 v[136:139], v[104:107], v[120:123], v[136:139]
    v_perm_b32 v124, v229, v225, s95
    v_perm_b32 v125, v237, v233, s95
    v_perm_b32 v126, v245, v241, s95
    v_perm_b32 v127, v253, v249, s95
    s_nop 1
    v_mfma_f32_16x16x32_bf16 v[140:143], v[104:107], v[124:127], v[140:143]
    v_perm_b32 v112, v230, v226, s94
    v_perm_b32 v113, v238, v234, s94
    v_perm_b32 v114, v246, v242, s94
    v_perm_b32 v115, v254, v250, s94
    s_nop 1
    v_mfma_f32_16x16x32_bf16 v[144:147], v[104:107], v[112:115], v[144:147]
    v_perm_b32 v116, v230, v226, s95
    v_perm_b32 v117, v238, v234, s95
    v_perm_b32 v118, v246, v242, s95
    v_perm_b32 v119, v254, v250, s95
    s_nop 1
    v_mfma_f32_16x16x32_bf16 v[148:151], v[104:107], v[116:119], v[148:151]
    v_perm_b32 v120, v231, v227, s94
    v_perm_b32 v121, v239, v235, s94
    v_perm_b32 v122, v247, v243, s94
    v_perm_b32 v123, v255, v251, s94
    s_nop 1
    v_mfma_f32_16x16x32_bf16 v[152:155], v[104:107], v[120:123], v[152:155]
    v_perm_b32 v124, v231, v227, s95
    v_perm_b32 v125, v239, v235, s95
    v_perm_b32 v126, v247, v243, s95
    v_perm_b32 v127, v255, v251, s95
    s_nop 1
    v_mfma_f32_16x16x32_bf16 v[156:159], v[104:107], v[124:127], v[156:159]
    s_branch .Lsk_m1_6
.Lst_m1_6:
    s_branch .Lrt_m1_6
.Lsk_m1_6:
    s_memrealtime s[8:9]
    s_waitcnt lgkmcnt(0)
    s_sub_u32 s8, s8, s30
    s_cmpk_ge_u32 s8, 2289
    s_nop 3
    s_cbranch_scc1 .ap_109
    s_waitcnt vmcnt(5)
    s_cmpk_ge_u32 s8, 2189
    s_cbranch_scc1 .ap_109
    s_waitcnt vmcnt(3)
    s_bitcmp1_b64 s[14:15], 62
    s_cbranch_scc0 1
    s_waitcnt vmcnt(2)
    s_cmpk_ge_u32 s8, 2069
    s_cbranch_scc1 .ap_109
    s_waitcnt vmcnt(1)
.ap_109:
    s_add_u32 s63, s69, 442368
    buffer_load_dwordx4 v[84:87], v1, s[44:47], s63 offen nt
    s_memrealtime s[8:9]
    s_waitcnt lgkmcnt(0)
    s_sub_u32 s8, s8, s30
    s_cmpk_ge_u32 s8, 2321
    s_cbranch_scc1 .ap_110
    s_waitcnt vmcnt(5)
    s_cmpk_ge_u32 s8, 2221
    s_cbranch_scc1 .ap_110
    s_waitcnt vmcnt(3)
    s_bitcmp1_b64 s[14:15], 63
    s_cbranch_scc0 1
    s_waitcnt vmcnt(2)
    s_cmpk_ge_u32 s8, 2101
    s_cbranch_scc1 .ap_110
    s_waitcnt vmcnt(1)
.ap_110:
    s_add_u32 s63, s69, 450560
    buffer_load_dwordx4 v[92:95], v1, s[44:47], s63 offen nt
    s_setprio 0
    s_waitcnt vmcnt(6)
    v_perm_b32 v160, v44, v36, s94
    v_perm_b32 v164, v44, v36, s95
    v_perm_b32 v168, v45, v37, s94
    v_perm_b32 v172, v45, v37, s95
    v_perm_b32 v176, v46, v38, s94
    v_perm_b32 v180, v46, v38, s95
    v_perm_b32 v184, v47, v39, s94
    v_perm_b32 v188, v47, v39, s95
    s_waitcnt vmcnt(4)
    v_perm_b32 v161, v60, v52, s94
    v_perm_b32 v165, v60, v52, s95
    v_perm_b32 v169, v61, v53, s94
    v_perm_b32 v173, v61, v53, s95
    v_perm_b32 v177, v62, v54, s94
    v_perm_b32 v181, v62, v54, s95
    v_perm_b32 v185, v63, v55, s94
    v_perm_b32 v189, v63, v55, s95
    s_waitcnt vmcnt(2)
    v_perm_b32 v162, v76, v68, s94
    v_perm_b32 v166, v76, v68, s95
    v_perm_b32 v170, v77, v69, s94
    v_perm_b32 v174, v77, v69, s95
    v_perm_b32 v178, v78, v70, s94
    v_perm_b32 v182, v78, v70, s95
    v_perm_b32 v186, v79, v71, s94
    v_perm_b32 v190, v79, v71, s95
    s_waitcnt vmcnt(0)
    v_perm_b32 v163, v92, v84, s94
    v_perm_b32 v167, v92, v84, s95
    v_perm_b32 v171, v93, v85, s94
    v_mfma_f32_16x16x32_bf16 v[128:131], v[108:111], v[160:163], v[128:131]
    v_perm_b32 v175, v93, v85, s95
    v_mfma_f32_16x16x32_bf16 v[132:135], v[108:111], v[164:167], v[132:135]
    v_perm_b32 v179, v94, v86, s94
    v_mfma_f32_16x16x32_bf16 v[136:139], v[108:111], v[168:171], v[136:139]
    v_perm_b32 v183, v94, v86, s95
    v_mfma_f32_16x16x32_bf16 v[140:143], v[108:111], v[172:175], v[140:143]
    v_perm_b32 v187, v95, v87, s94
    v_mfma_f32_16x16x32_bf16 v[144:147], v[108:111], v[176:179], v[144:147]
    v_perm_b32 v191, v95, v87, s95
    v_mfma_f32_16x16x32_bf16 v[148:151], v[108:111], v[180:183], v[148:151]
    v_mfma_f32_16x16x32_bf16 v[152:155], v[108:111], v[184:187], v[152:155]
    v_mfma_f32_16x16x32_bf16 v[156:159], v[108:111], v[188:191], v[156:159]
    s_mov_b64 exec, 0xffff
    ds_write2_b32 v10, v128, v129 offset0:0 offset1:128
    ds_write2_b32 v10, v132, v133 offset0:1 offset1:129
    ds_write2_b32 v10, v136, v137 offset0:2 offset1:130
    ds_write2_b32 v10, v140, v141 offset0:3 offset1:131
    ds_write2_b32 v10, v144, v145 offset0:4 offset1:132
    ds_write2_b32 v10, v148, v149 offset0:5 offset1:133
    ds_write2_b32 v10, v152, v153 offset0:6 offset1:134
    ds_write2_b32 v10, v156, v157 offset0:7 offset1:135
    s_mov_b64 exec, -1
    s_waitcnt lgkmcnt(0)
    s_barrier
    s_cmp_lg_u32 s3, 7
    s_cbranch_scc1 .opub_111
    v_add_u32 v10, 147456, v2
    ds_read_b128 v[196:199], v10 offset:0
    ds_read_b128 v[200:203], v10 offset:1024
    ds_read_b128 v[204:207], v10 offset:2048
    ds_read_b128 v[208:211], v10 offset:3072
    ds_read_b128 v[212:215], v10 offset:4096
    ds_read_b128 v[216:219], v10 offset:5120
    ds_read_b128 v[220:223], v10 offset:6144
    ds_read_b128 v[224:227], v10 offset:7168
    v_lshrrev_b32 v11, 5, v0
    v_lshlrev_b32 v11, 13, v11
    v_and_b32 v12, 31, v0
    v_lshl_add_u32 v11, v12, 4, v11
    s_lshl4_add_u32 s56, s67, s66
    s_lshl1_add_u32 s56, s56, s68
    s_lshl_b32 s56, s56, 9
    s_add_u32 s56, s56, 0xa0000
    s_mov_b32 s60, 0x07060503
    s_mov_b32 s61, 0x07060502
    s_mov_b32 s62, 0x07060501
    v_mov_b32 v15, s34
    s_waitcnt lgkmcnt(6)
    v_pk_add_f32 v[196:197], v[196:197], v[200:201]
    v_pk_add_f32 v[198:199], v[198:199], v[202:203]
    s_waitcnt lgkmcnt(5)
    v_pk_add_f32 v[196:197], v[196:197], v[204:205]
    v_pk_add_f32 v[198:199], v[198:199], v[206:207]
    s_waitcnt lgkmcnt(4)
    v_pk_add_f32 v[196:197], v[196:197], v[208:209]
    v_pk_add_f32 v[198:199], v[198:199], v[210:211]
    s_waitcnt lgkmcnt(3)
    v_pk_add_f32 v[196:197], v[196:197], v[212:213]
    v_pk_add_f32 v[198:199], v[198:199], v[214:215]
    s_waitcnt lgkmcnt(2)
    v_pk_add_f32 v[196:197], v[196:197], v[216:217]
    v_pk_add_f32 v[198:199], v[198:199], v[218:219]
    s_waitcnt lgkmcnt(1)
    v_pk_add_f32 v[196:197], v[196:197], v[220:221]
    v_pk_add_f32 v[198:199], v[198:199], v[222:223]
    s_waitcnt lgkmcnt(0)
    v_pk_add_f32 v[196:197], v[196:197], v[224:225]
    v_pk_add_f32 v[198:199], v[198:199], v[226:227]
    v_perm_b32 v12, v196, v199, s60
    v_perm_b32 v13, v197, v199, s61
    v_perm_b32 v14, v198, v199, s62
    s_add_u32 s57, s56, 0x800000
    buffer_store_dwordx4 v[12:15], v11, s[36:39], s57 offen
    s_cmp_lg_u32 s0, 0
    s_nop 0
    s_cbranch_scc1 .nosl_112
    buffer_store_dwordx4 v[12:15], v11, s[36:39], s56 offen sc1
.nosl_112:
.opub_111:
    s_and_b32 s58, s64, 0
    s_mul_i32 s58, s58, 18432
    s_mul_i32 s59, s3, 2304
    s_add_u32 s58, s58, s59
    s_add_u32 s62, s58, 0x37000
    s_add_u32 s63, s58, 0x49000
    s_mul_i32 s101, s64, 18432
    s_add_u32 s101, s101, s59
    s_add_u32 s101, s101, 0x170000
    s_lshl_b32 s56, s65, 8
    s_add_u32 s58, s58, s56
    s_add_u32 s58, s58, 0x25000
    s_add_u32 s99, s101, s56
    s_lshr_b32 s56, s64, 1
    s_and_b32 s57, s3, 3
    s_cmp_lg_u32 s56, s57
    s_cbranch_scc1 .Lr_ga
    s_add_u32 s59, s58, 73728
    s_add_u32 s60, s58, 147456
    s_add_u32 s61, s58, 221184
.gp_113:
    buffer_load_dwordx4 v[56:59], v2, s[36:39], s62 offen offset:0 sc1
    buffer_load_dwordx4 v[60:63], v2, s[36:39], s62 offen offset:1024 sc1
    buffer_load_dwordx2 v[64:65], v5, s[36:39], s62 offen offset:0 sc1
    buffer_load_dwordx4 v[66:69], v2, s[36:39], s63 offen offset:0 sc1
    buffer_load_dwordx4 v[70:73], v2, s[36:39], s63 offen offset:1024 sc1
    buffer_load_dwordx2 v[74:75], v5, s[36:39], s63 offen offset:0 sc1
    buffer_load_dwordx2 v[76:77], v8, s[36:39], s59 offen offset:0 sc1
    buffer_load_dwordx2 v[78:79], v8, s[36:39], s60 offen offset:0 sc1
    buffer_load_dwordx2 v[80:81], v8, s[36:39], s61 offen offset:0 sc1
    buffer_load_dwordx2 v[42:43], v8, s[36:39], s58 offen offset:0 sc1
    s_branch .Lsk_m1_7
.Lst_m1_7:
    s_branch .Lrt_m1_7
.Lsk_m1_7:
    s_waitcnt vmcnt(0)
.gpc_114:
    v_min_u32 v24, v57, v59
    v_max_u32 v25, v57, v59
    v_min3_u32 v24, v24, v61, v63
    v_max3_u32 v25, v25, v61, v63
    v_min3_u32 v24, v24, v65, v67
    v_max3_u32 v25, v25, v65, v67
    v_min3_u32 v24, v24, v69, v71
    v_max3_u32 v25, v25, v69, v71
    v_min3_u32 v24, v24, v73, v75
    v_max3_u32 v25, v25, v73, v75
    v_min3_u32 v24, v24, v77, v79
    v_max3_u32 v25, v25, v77, v79
    v_min3_u32 v24, v24, v81, v43
    v_max3_u32 v25, v25, v81, v43
    v_cmp_eq_u32 vcc, s34, v24
    v_cmp_eq_u32 s[56:57], s34, v25
    s_and_b64 vcc, vcc, s[56:57]
    s_cmp_eq_u64 vcc, -1
    s_nop 2
    s_cbranch_scc1 .gpd_115
    s_sub_u32 s35, s35, 1
    s_cbranch_scc1 .Lexit
    s_sleep 2
    s_branch .gp_113
.gpd_115:
    v_and_b32 v57, 0xffff0000, v56
    v_lshlrev_b32 v56, 16, v56
    v_and_b32 v67, 0xffff0000, v66
    v_lshlrev_b32 v66, 16, v66
    v_and_b32 v59, 0xffff0000, v58
    v_lshlrev_b32 v58, 16, v58
    v_and_b32 v69, 0xffff0000, v68
    v_lshlrev_b32 v68, 16, v68
    v_and_b32 v61, 0xffff0000, v60
    v_lshlrev_b32 v60, 16, v60
    v_and_b32 v71, 0xffff0000, v70
    v_lshlrev_b32 v70, 16, v70
    v_and_b32 v63, 0xffff0000, v62
    v_lshlrev_b32 v62, 16, v62
    v_and_b32 v73, 0xffff0000, v72
    v_lshlrev_b32 v72, 16, v72
    v_and_b32 v65, 0xffff0000, v64
    v_lshlrev_b32 v64, 16, v64
    v_and_b32 v75, 0xffff0000, v74
    v_lshlrev_b32 v74, 16, v74
    v_lshlrev_b32 v77, 16, v76
    v_and_b32 v76, 0xffff0000, v76
    s_mov_b32 vcc_lo, 0xffff0000
    s_mov_b32 vcc_hi, 0xffff0000
    v_cndmask_b32 v77, v77, v76, vcc
    v_lshlrev_b32 v79, 16, v78
    v_and_b32 v78, 0xffff0000, v78
    s_mov_b32 vcc_lo, 0xffff0000
    s_mov_b32 vcc_hi, 0xffff0000
    v_cndmask_b32 v79, v79, v78, vcc
    v_lshlrev_b32 v81, 16, v80
    v_and_b32 v80, 0xffff0000, v80
    s_mov_b32 vcc_lo, 0xffff0000
    s_mov_b32 vcc_hi, 0xffff0000
    v_cndmask_b32 v81, v81, v80, vcc
    s_nop 1
    s_branch .Lr_ga2
.Lr_ga:
.gp_116:
    buffer_load_dwordx2 v[42:43], v8, s[36:39], s58 offen offset:0 sc1
    s_waitcnt vmcnt(0)
.gpc_117:
    v_cmp_eq_u32 vcc, s34, v43
    s_cmp_eq_u64 vcc, -1
    s_nop 3
    s_cbranch_scc1 .gpd_118
    s_sub_u32 s35, s35, 1
    s_cbranch_scc1 .Lexit
    s_sleep 2
    s_branch .gp_116
.gpd_118:
.Lr_ga2:
    v_lshlrev_b32 v40, 16, v40
    v_lshlrev_b32 v41, 16, v42
    v_and_b32 v42, 0xffff0000, v42
    s_mov_b32 vcc_lo, 0xffff0000
    s_mov_b32 vcc_hi, 0xffff0000
    v_cndmask_b32 v41, v41, v42, vcc
    s_mul_i32 s59, s3, 9
    s_add_u32 s59, s59, s65
    s_lshl_b32 s59, s59, 12
    s_add_u32 s59, s59, 0xe0000
    s_mov_b32 s60, 0x04000c0c
    s_mov_b32 s61, 0x0706000c
    v_mov_b32 v45, s34
    v_mov_b32 v47, s34
    s_cmp_eq_u32 s0, 0
    s_nop 0
    s_cbranch_scc1 .tg_119
    s_mul_i32 s6, s64, 9
    s_add_u32 s6, s6, s65
    s_lshl_b32 s6, s6, 6
    s_add_u32 s6, s6, 0xca2000
    v_and_b32 v10, 0x30, v2
.gp_120:
    buffer_load_dword v11, v10, s[36:39], s6 offen offset:0 sc1
    s_waitcnt vmcnt(0)
.gpc_121:
    v_cmp_eq_u32 vcc, s34, v11
    s_cmp_eq_u64 vcc, -1
    s_nop 3
    s_cbranch_scc1 .gpd_122
    s_sub_u32 s35, s35, 1
    s_cbranch_scc1 .Lexit
    s_sleep 1
    s_branch .gp_120
.gpd_122:
.tg_119:
.ip_123:
    s_branch .Lsk_m2_0
    .fill 47, 4, 0xbf800000
.Lst_m2_0:
    s_branch .Lrt_m2_0
.Lsk_m2_0:
    buffer_load_dwordx4 v[16:19], v2, s[36:39], s59 offen offset:0 sc1
    buffer_load_dwordx4 v[20:23], v2, s[36:39], s59 offen offset:1024 sc1
    buffer_load_dwordx4 v[24:27], v2, s[36:39], s59 offen offset:2048 sc1
    buffer_load_dwordx4 v[28:31], v2, s[36:39], s59 offen offset:3072 sc1
    s_waitcnt vmcnt(3)
    v_mov_b32 v32, v19
    v_mov_b32 v33, v19
    v_perm_b32 v19, v16, v17, s60
    v_perm_b32 v19, v19, v18, s61
    s_waitcnt vmcnt(2)
    v_min_u32 v32, v32, v23
    v_max_u32 v33, v33, v23
    v_perm_b32 v23, v20, v21, s60
    v_perm_b32 v23, v23, v22, s61
    v_pk_add_f32 v[16:17], v[16:17], v[20:21]
    v_pk_add_f32 v[18:19], v[18:19], v[22:23]
    s_waitcnt vmcnt(1)
    v_min_u32 v32, v32, v27
    v_max_u32 v33, v33, v27
    v_perm_b32 v27, v24, v25, s60
    v_perm_b32 v27, v27, v26, s61
    v_pk_add_f32 v[16:17], v[16:17], v[24:25]
    v_pk_add_f32 v[18:19], v[18:19], v[26:27]
    s_waitcnt vmcnt(0)
    v_min_u32 v32, v32, v31
    v_max_u32 v33, v33, v31
    v_cmp_eq_u32 vcc, s34, v32
    v_cmp_eq_u32 s[56:57], s34, v33
    v_perm_b32 v31, v28, v29, s60
    v_perm_b32 v31, v31, v30, s61
    v_pk_add_f32 v[16:17], v[16:17], v[28:29]
    v_pk_add_f32 v[18:19], v[18:19], v[30:31]
    s_and_b64 vcc, vcc, s[56:57]
    s_cmp_eq_u64 vcc, -1
    s_cbranch_scc1 .ipd_124
    s_sub_u32 s35, s35, 1
    s_cbranch_scc0 .ip_123
    s_branch .Lexit
.ipd_124:
    v_permlane32_swap_b32 v16, v18
    v_permlane32_swap_b32 v17, v19
    v_pk_add_f32 v[16:17], v[16:17], v[18:19]
    s_nop 1
    v_permlane16_swap_b32 v16, v17
    v_add_f32 v16, v16, v17
    v_cvt_pk_bf16_f32 v16, v16, v16
    v_lshlrev_b32 v16, 16, v16
    v_mul_f32 v16, v16, v41
    v_cvt_pk_bf16_f32 v16, v16, v16
    v_lshlrev_b32 v16, 16, v16
    v_add_f32 v17, v16, v40
    v_add_f32 v16, v16, v40
    v_mov_b32 v40, v16
    s_nop 0
    v_permlane16_swap_b32 v16, v17
    v_cvt_pk_bf16_f32 v44, v16, v17
    s_mov_b32 exec_lo, 0xffff
    s_mov_b32 exec_hi, 0xffff
    s_add_u32 s57, s99, 0x800000
    buffer_store_dwordx2 v[44:45], v8, s[36:39], s57 offen
    s_cmp_lg_u32 s0, 0
    s_cbranch_scc1 .nosl_125
    buffer_store_dwordx2 v[44:45], v8, s[36:39], s99 offen sc1
.nosl_125:
    s_mov_b64 exec, -1
    s_lshr_b32 s56, s64, 1
    s_and_b32 s57, s3, 3
    s_cmp_lg_u32 s56, s57
    s_cbranch_scc1 .Lexit
    v_cvt_pk_bf16_f32 v40, v40, v40
    v_lshlrev_b32 v40, 16, v40
    s_mov_b32 s69, 0
.gp_126:
    s_add_u32 s69, s69, 1
    s_and_b32 s56, s69, 0x41
    s_cmp_lg_u32 s56, 0x41
    s_cselect_b32 s56, 0, 0x800000
    s_xor_b32 s56, s56, s0
    s_add_u32 s58, s101, s56
    buffer_load_dwordx4 v[84:87], v2, s[36:39], s58 offen offset:0 sc1
    buffer_load_dwordx4 v[88:91], v2, s[36:39], s58 offen offset:1024 sc1
    buffer_load_dwordx2 v[92:93], v5, s[36:39], s58 offen offset:0 sc1
    s_waitcnt vmcnt(0)
    v_min3_u32 v24, v85, v87, v89
    v_max3_u32 v25, v85, v87, v89
    v_min3_u32 v24, v24, v91, v93
    v_max3_u32 v25, v25, v91, v93
    v_cmp_eq_u32 vcc, s34, v24
    v_cmp_eq_u32 s[56:57], s34, v25
    s_and_b64 vcc, vcc, s[56:57]
    s_cmp_eq_u64 vcc, -1
    s_nop 2
    s_cbranch_scc1 .gpd_127
    s_sub_u32 s35, s35, 1
    s_cbranch_scc1 .Lexit
    s_sleep 1
    s_branch .gp_126
.gpd_127:
    s_mov_b32 s56, 0x3f803f80
    v_dot2_f32_bf16 v104, v84, s56, 0
    v_dot2_f32_bf16 v105, v84, v84, 0
    v_dot2_f32_bf16 v104, v86, s56, v104
    v_dot2_f32_bf16 v105, v86, v86, v105
    v_dot2_f32_bf16 v104, v88, s56, v104
    v_dot2_f32_bf16 v105, v88, v88, v105
    v_dot2_f32_bf16 v104, v90, s56, v104
    v_dot2_f32_bf16 v105, v90, v90, v105
    s_mov_b64 exec, 0xffffffff
    v_dot2_f32_bf16 v104, v92, s56, v104
    v_dot2_f32_bf16 v105, v92, v92, v105
    s_mov_b64 exec, -1
    s_nop 1
    v_permlane32_swap_b32 v104, v105
    v_add_f32 v104, v104, v105
    v_mov_b32 v106, v104
    s_nop 1
    v_permlane16_swap_b32 v106, v104
    v_add_f32 v104, v106, v104
    v_and_b32 v95, 0xffff0000, v84
    v_lshlrev_b32 v94, 16, v84
    v_add_f32_dpp v104, v104, v104 row_ror:8 row_mask:0xf bank_mask:0xf
    v_and_b32 v97, 0xffff0000, v86
    v_lshlrev_b32 v96, 16, v86
    v_add_f32_dpp v104, v104, v104 row_ror:4 row_mask:0xf bank_mask:0xf
    v_and_b32 v99, 0xffff0000, v88
    v_lshlrev_b32 v98, 16, v88
    v_add_f32_dpp v104, v104, v104 quad_perm:[2,3,0,1] row_mask:0xf bank_mask:0xf
    v_and_b32 v101, 0xffff0000, v90
    v_lshlrev_b32 v100, 16, v90
    v_add_f32_dpp v104, v104, v104 quad_perm:[1,0,3,2] row_mask:0xf bank_mask:0xf
    v_mul_f32 v104, 0x3ae38e39, v104
    v_and_b32 v103, 0xffff0000, v92
    v_lshlrev_b32 v102, 16, v92
    v_readlane_b32 s56, v104, 0
    v_readlane_b32 s57, v104, 32
    s_nop 0
    v_mov_b32 v104, s56
    v_fma_f32 v105, -v104, v104, s57
    v_max_f32 v105, 0, v105
    v_cvt_pk_bf16_f32 v106, -v104, v105
    v_and_b32 v107, 0xffff0000, v106
    v_add_f32 v107, 0x3727c5ac, v107
    v_lshlrev_b32 v104, 16, v106
    v_cvt_pk_bf16_f32 v107, v107, v107
    v_lshlrev_b32 v107, 16, v107
    v_sqrt_f32 v107, v107
    v_mov_b32 v105, v104
    v_cvt_pk_bf16_f32 v107, v107, v107
    v_lshlrev_b32 v107, 16, v107
    v_rcp_f32 v106, v107
    v_rcp_f32 v107, v107
    v_pk_add_f32 v[94:95], v[94:95], v[104:105]
    v_pk_add_f32 v[96:97], v[96:97], v[104:105]
    v_pk_add_f32 v[98:99], v[98:99], v[104:105]
    v_pk_add_f32 v[100:101], v[100:101], v[104:105]
    v_pk_add_f32 v[102:103], v[102:103], v[104:105]
    v_cvt_pk_bf16_f32 v94, v94, v95
    v_and_b32 v95, 0xffff0000, v94
    v_lshlrev_b32 v94, 16, v94
    v_cvt_pk_bf16_f32 v96, v96, v97
    v_and_b32 v97, 0xffff0000, v96
    v_lshlrev_b32 v96, 16, v96
    v_cvt_pk_bf16_f32 v98, v98, v99
    v_and_b32 v99, 0xffff0000, v98
    v_lshlrev_b32 v98, 16, v98
    v_cvt_pk_bf16_f32 v100, v100, v101
    v_and_b32 v101, 0xffff0000, v100
    v_lshlrev_b32 v100, 16, v100
    v_cvt_pk_bf16_f32 v102, v102, v103
    v_and_b32 v103, 0xffff0000, v102
    v_lshlrev_b32 v102, 16, v102
    v_pk_mul_f32 v[94:95], v[94:95], v[106:107]
    v_pk_mul_f32 v[96:97], v[96:97], v[106:107]
    v_pk_mul_f32 v[98:99], v[98:99], v[106:107]
    v_pk_mul_f32 v[100:101], v[100:101], v[106:107]
    v_pk_mul_f32 v[102:103], v[102:103], v[106:107]
    v_cvt_pk_bf16_f32 v94, v94, v95
    v_and_b32 v95, 0xffff0000, v94
    v_lshlrev_b32 v94, 16, v94
    v_cvt_pk_bf16_f32 v96, v96, v97
    v_and_b32 v97, 0xffff0000, v96
    s_branch .Lsk_m2_1
.Lst_m2_1:
    s_branch .Lrt_m2_1
.Lsk_m2_1:
    v_lshlrev_b32 v96, 16, v96
    v_cvt_pk_bf16_f32 v98, v98, v99
    v_and_b32 v99, 0xffff0000, v98
    v_lshlrev_b32 v98, 16, v98
    v_cvt_pk_bf16_f32 v100, v100, v101
    v_and_b32 v101, 0xffff0000, v100
    v_lshlrev_b32 v100, 16, v100
    v_cvt_pk_bf16_f32 v102, v102, v103
    v_and_b32 v103, 0xffff0000, v102
    v_lshlrev_b32 v102, 16, v102
    v_pk_mul_f32 v[94:95], v[94:95], v[66:67]
    v_pk_mul_f32 v[96:97], v[96:97], v[68:69]
    v_pk_mul_f32 v[98:99], v[98:99], v[70:71]
    v_pk_mul_f32 v[100:101], v[100:101], v[72:73]
    v_pk_mul_f32 v[102:103], v[102:103], v[74:75]
    v_cvt_pk_bf16_f32 v94, v94, v95
    v_and_b32 v95, 0xffff0000, v94
    v_lshlrev_b32 v94, 16, v94
    v_cvt_pk_bf16_f32 v96, v96, v97
    v_and_b32 v97, 0xffff0000, v96
    v_lshlrev_b32 v96, 16, v96
    v_cvt_pk_bf16_f32 v98, v98, v99
    v_and_b32 v99, 0xffff0000, v98
    v_lshlrev_b32 v98, 16, v98
    v_cvt_pk_bf16_f32 v100, v100, v101
    v_and_b32 v101, 0xffff0000, v100
    v_lshlrev_b32 v100, 16, v100
    v_cvt_pk_bf16_f32 v102, v102, v103
    v_and_b32 v103, 0xffff0000, v102
    v_lshlrev_b32 v102, 16, v102
    v_pk_add_f32 v[94:95], v[94:95], v[56:57]
    v_pk_add_f32 v[96:97], v[96:97], v[58:59]
    v_pk_add_f32 v[98:99], v[98:99], v[60:61]
    v_pk_add_f32 v[100:101], v[100:101], v[62:63]
    v_pk_add_f32 v[102:103], v[102:103], v[64:65]
    v_cvt_pk_bf16_f32 v110, v94, v95
    v_cvt_pk_bf16_f32 v111, v96, v97
    v_cvt_pk_bf16_f32 v112, v98, v99
    v_cvt_pk_bf16_f32 v113, v100, v101
    v_cvt_pk_bf16_f32 v114, v102, v103
    v_dot2_f32_bf16 v14, v110, v48, 0
    v_dot2_f32_bf16 v14, v111, v49, v14
    v_dot2_f32_bf16 v14, v112, v50, v14
    v_dot2_f32_bf16 v14, v113, v51, v14
    s_mov_b64 exec, 0xffffffff
    v_dot2_f32_bf16 v14, v114, v34, v14
    s_mov_b64 exec, -1
    s_nop 1
    v_mov_b32 v15, v14
    s_nop 1
    v_permlane32_swap_b32 v15, v14
    v_add_f32 v14, v15, v14
    v_mov_b32 v15, v14
    s_nop 1
    v_permlane16_swap_b32 v15, v14
    v_add_f32 v14, v15, v14
    s_nop 1
    v_add_f32_dpp v14, v14, v14 row_ror:8 row_mask:0xf bank_mask:0xf
    s_nop 1
    v_add_f32_dpp v14, v14, v14 row_ror:4 row_mask:0xf bank_mask:0xf
    s_nop 1
    v_add_f32_dpp v14, v14, v14 quad_perm:[2,3,0,1] row_mask:0xf bank_mask:0xf
    s_nop 1
    v_add_f32_dpp v14, v14, v14 quad_perm:[1,0,3,2] row_mask:0xf bank_mask:0xf
    v_cvt_pk_bf16_f32 v14, v14, v14
    v_lshlrev_b32 v14, 16, v14
    v_max_f32 v14, 0xc2ae0000, v14
    v_min_f32 v14, 0x43000000, v14
    v_mul_f32 v15, 0xbfb8aa3b, v14
    v_fma_f32 v16, v14, s98, -v15
    v_fmac_f32 v16, 0xb2a57060, v14
    v_exp_f32 v15, v15
    v_mul_f32 v16, 0x3f317218, v16
    v_fmac_f32 v15, v15, v16
    v_add_f32 v15, 1.0, v15
    v_rcp_f32 v16, v15
    s_nop 0
    v_fma_f32 v15, -v15, v16, 1.0
    v_fma_f32 v14, v15, v16, v16
    v_cvt_pk_bf16_f32 v14, v14, v14
    v_lshlrev_b32 v14, 16, v14
    v_add_f32 v41, v40, v104
    v_cvt_pk_bf16_f32 v41, v41, v41
    v_lshlrev_b32 v41, 16, v41
    v_mul_f32 v41, v41, v106
    v_cvt_pk_bf16_f32 v41, v41, v41
    v_lshlrev_b32 v41, 16, v41
    v_mul_f32 v41, v41, v79
    v_cvt_pk_bf16_f32 v41, v41, v41
    v_lshlrev_b32 v41, 16, v41
    v_add_f32 v41, v41, v77
    v_cvt_pk_bf16_f32 v41, v41, v41
    v_lshlrev_b32 v41, 16, v41
    s_and_b32 s62, s64, 1
    s_lshl1_add_u32 s58, s65, s62
    s_lshl3_add_u32 s58, s58, s3
    s_mul_i32 s58, s58, 9216
    s_add_u32 s58, s58, 0x1a0000
    s_add_u32 s59, s58, 4096
    s_add_u32 s63, s58, 8192
    s_cmp_eq_u32 s62, 0
    s_mov_b32 s56, 0x00ff00ff
    s_cselect_b32 s62, s56, 0xff00ff00
    s_mov_b32 s60, 0x04000c0c
    s_mov_b32 s61, 0x0706000c
    s_mov_b32 s48, s28
    s_and_b32 s49, s29, 0xffff
    s_mov_b32 s50, 0x2400
    s_mov_b32 s51, 0x00020000
    s_cmp_eq_u32 s0, 0
    s_cbranch_scc1 .tc_128
    s_lshl_b32 s6, s64, 8
    s_add_u32 s6, s6, 0xca4000
    v_min_u32 v10, 8, v0
    v_lshlrev_b32 v10, 4, v10
.gp_129:
    buffer_load_dword v11, v10, s[36:39], s6 offen offset:0 sc1
    s_waitcnt vmcnt(0)
.gpc_130:
    v_cmp_eq_u32 vcc, s34, v11
    s_cmp_eq_u64 vcc, -1
    s_nop 3
    s_cbranch_scc1 .gpd_131
    s_sub_u32 s35, s35, 1
    s_cbranch_scc1 .Lexit
    s_sleep 1
    s_branch .gp_129
.gpd_131:
.tc_128:
.ip_132:
    s_branch .Lsk_m2_2
    .fill 76, 4, 0xbf800000
.Lst_m2_2:
    s_branch .Lrt_m2_2
.Lsk_m2_2:
    buffer_load_dwordx4 v[120:123], v2, s[36:39], s58 offen offset:0 sc1
    buffer_load_dwordx4 v[124:127], v2, s[36:39], s58 offen offset:1024 sc1
    buffer_load_dwordx4 v[128:131], v2, s[36:39], s58 offen offset:2048 sc1
    buffer_load_dwordx4 v[132:135], v2, s[36:39], s58 offen offset:3072 sc1
    buffer_load_dwordx4 v[136:139], v2, s[36:39], s59 offen offset:0 sc1
    buffer_load_dwordx4 v[140:143], v2, s[36:39], s59 offen offset:1024 sc1
    buffer_load_dwordx4 v[144:147], v2, s[36:39], s59 offen offset:2048 sc1
    buffer_load_dwordx4 v[148:151], v2, s[36:39], s59 offen offset:3072 sc1
    buffer_load_dwordx4 v[152:155], v2, s[36:39], s63 offen offset:0 sc1
    s_waitcnt vmcnt(8)
    v_mov_b32 v24, v123
    v_mov_b32 v25, v123
    v_perm_b32 v123, v120, v121, s60
    v_perm_b32 v123, v123, v122, s61
    s_waitcnt vmcnt(7)
    v_min_u32 v24, v24, v127
    v_max_u32 v25, v25, v127
    v_perm_b32 v127, v124, v125, s60
    v_perm_b32 v127, v127, v126, s61
    v_pk_add_f32 v[120:121], v[120:121], v[124:125]
    v_pk_add_f32 v[122:123], v[122:123], v[126:127]
    s_waitcnt vmcnt(6)
    v_min_u32 v24, v24, v131
    v_max_u32 v25, v25, v131
    v_perm_b32 v131, v128, v129, s60
    v_perm_b32 v131, v131, v130, s61
    v_pk_add_f32 v[120:121], v[120:121], v[128:129]
    v_pk_add_f32 v[122:123], v[122:123], v[130:131]
    s_waitcnt vmcnt(5)
    v_min_u32 v24, v24, v135
    v_max_u32 v25, v25, v135
    v_perm_b32 v135, v132, v133, s60
    v_perm_b32 v135, v135, v134, s61
    v_pk_add_f32 v[120:121], v[120:121], v[132:133]
    v_pk_add_f32 v[122:123], v[122:123], v[134:135]
    s_waitcnt vmcnt(4)
    v_min_u32 v24, v24, v139
    v_max_u32 v25, v25, v139
    v_perm_b32 v139, v136, v137, s60
    v_perm_b32 v139, v139, v138, s61
    v_pk_add_f32 v[120:121], v[120:121], v[136:137]
    v_pk_add_f32 v[122:123], v[122:123], v[138:139]
    s_waitcnt vmcnt(3)
    v_min_u32 v24, v24, v143
    v_max_u32 v25, v25, v143
    v_perm_b32 v143, v140, v141, s60
    v_perm_b32 v143, v143, v142, s61
    v_pk_add_f32 v[120:121], v[120:121], v[140:141]
    v_pk_add_f32 v[122:123], v[122:123], v[142:143]
    s_waitcnt vmcnt(2)
    v_min_u32 v24, v24, v147
    v_max_u32 v25, v25, v147
    v_perm_b32 v147, v144, v145, s60
    v_perm_b32 v147, v147, v146, s61
    v_pk_add_f32 v[120:121], v[120:121], v[144:145]
    v_pk_add_f32 v[122:123], v[122:123], v[146:147]
    s_waitcnt vmcnt(1)
    v_min_u32 v24, v24, v151
    v_max_u32 v25, v25, v151
    v_perm_b32 v151, v148, v149, s60
    v_perm_b32 v151, v151, v150, s61
    v_pk_add_f32 v[120:121], v[120:121], v[148:149]
    v_pk_add_f32 v[122:123], v[122:123], v[150:151]
    s_waitcnt vmcnt(0)
    v_min_u32 v24, v24, v155
    v_max_u32 v25, v25, v155
    v_cmp_eq_u32 vcc, s34, v24
    v_cmp_eq_u32 s[56:57], s34, v25
    v_perm_b32 v155, v152, v153, s60
    v_perm_b32 v155, v155, v154, s61
    v_pk_add_f32 v[120:121], v[120:121], v[152:153]
    v_pk_add_f32 v[122:123], v[122:123], v[154:155]
    s_and_b64 vcc, vcc, s[56:57]
    s_cmp_eq_u64 vcc, -1
    s_cbranch_scc1 .ipd_133
    s_sub_u32 s35, s35, 1
    s_cbranch_scc0 .ip_132
    s_branch .Lexit
.ipd_133:
    v_permlane32_swap_b32 v120, v122
    v_permlane32_swap_b32 v121, v123
    v_pk_add_f32 v[120:121], v[120:121], v[122:123]
    s_nop 1
    v_permlane16_swap_b32 v120, v121
    v_add_f32 v120, v120, v121
    s_nop 1
    v_add_f32_dpp v120, v120, v120 row_ror:8 row_mask:0xf bank_mask:0xf
    v_cvt_pk_bf16_f32 v120, v120, v120
    v_lshlrev_b32 v120, 16, v120
    v_mul_f32 v120, v120, v14
    v_cvt_pk_bf16_f32 v120, v120, v120
    v_lshlrev_b32 v120, 16, v120
    v_add_f32 v120, v120, v41
    v_cvt_pk_bf16_f32 v120, v120, v120
    v_lshlrev_b32 v120, 16, v120
    v_mul_f32 v120, v120, v81
    v_cvt_pk_bf16_f32 v120, v120, v120
    v_lshlrev_b32 v120, 16, v120
    v_add_f32 v120, v120, v40
    v_cvt_pk_bf16_f32 v120, v120, v120
    s_mov_b32 exec_lo, s62
    s_mov_b32 exec_hi, s62
    buffer_store_short v120, v7, s[48:51], s100 offen
    s_mov_b64 exec, -1
    s_or_b32 s56, s2, s3
    s_cmp_lg_u32 s56, 0
    s_cbranch_scc1 .Lexit
    v_mov_b32 v13, s34
    v_mov_b32 v12, 0
    s_mov_b64 exec, 1
    buffer_store_dword v13, v12, s[36:39], 0 offen
    s_mov_b64 exec, -1
    s_branch .Lexit
.Lbc:
    s_branch .Lsk_b0_0
.Lst_b0_0:
    s_branch .Lrt_b0_0
.Lsk_b0_0:
    s_sub_u32 s56, s65, 9
    s_mov_b32 s57, 0x63054210
    s_cmp_eq_u32 s65, 14
    s_cselect_b32 s56, s64, s56
    s_cselect_b32 s57, 0x37654210, s57
    s_cselect_b32 s99, 8, s64
    s_lshl_b32 s56, s56, 2
    s_lshr_b32 s56, s57, s56
    s_and_b32 s56, s56, 7
    s_cmp_eq_u32 s65, 17
    s_cselect_b32 s56, 7, s56
    s_lshl3_add_u32 s99, s99, s56
    s_and_b32 s56, s99, 7
    s_cmp_eq_u32 s56, 3
    s_mov_b32 s14, 0xb5b5b5b5
    s_cselect_b32 s14, 0x0, s14
    s_mov_b32 s15, 0xd6d6b6b6
    s_cselect_b32 s15, 0x0, s15
    s_cselect_b32 s30, -50, 0
    s_add_u32 s30, s30, 0
    s_add_u32 s30, s30, s70
    s_mov_b32 s31, s70
    s_mov_b32 s48, s18
    s_and_b32 s49, s19, 0xffff
    s_mov_b32 s50, 0x510000
    s_mov_b32 s51, 0x00020000
    s_mov_b32 s52, s20
    s_and_b32 s53, s21, 0xffff
    s_mov_b32 s54, 0x510000
    s_mov_b32 s55, 0x00020000
    v_bfe_u32 v12, v0, 4, 1
    s_and_b32 s56, s3, 3
    s_lshl_b32 s56, s56, 1
    v_or_b32 v12, s56, v12
    v_and_b32 v6, 7, v0
    v_xor_b32 v12, v12, v6
    v_lshrrev_b32 v6, 3, v0
    v_mul_u32_u24 v6, 9216, v6
    v_lshl_add_u32 v6, v12, 4, v6
    s_mul_i32 s100, s3, 73728
    s_lshl_b32 s56, s99, 7
    s_add_u32 s100, s100, s56
    s_lshl_b32 s101, s3, 10
    s_waitcnt lgkmcnt(0)
    s_add_u32 s34, s34, 1
    s_getreg_b32 s1, hwreg(HW_REG_XCC_ID)
    s_lshl_b32 s1, s1, 24
    s_add_u32 s1, s1, s34
    s_lshr_b32 s0, s2, 3
    s_lshl_b32 s63, s64, 8
    s_add_u32 s0, s0, s63
    s_lshl2_add_u32 s0, s0, 0x480000
    v_mov_b32 v30, s1
    s_cmp_eq_u32 s3, 0
    s_cselect_b64 exec, 1, 0
    buffer_store_dword v30, v2, s[36:39], s0 offen sc1
    s_mov_b64 exec, -1
    v_and_b32 v8, 1, v0
    v_lshlrev_b32 v8, 8, v8
    v_and_b32 v9, 0x3c, v0
    v_lshl_add_u32 v9, v9, 2, v8
    v_add_u32 v7, v9, v8
    v_and_b32 v9, 0x3c, v0
    v_lshrrev_b32 v8, 4, v8
    v_and_b32 v9, 4, v0
    v_lshl_add_u32 v9, v9, 3, v8
    s_lshl_b32 s58, s66, 14
    s_lshl_b32 s59, s67, 10
    s_add_u32 s58, s58, s59
    s_add_u32 s58, s58, 0x70000
    s_lshl4_add_u32 s59, s66, s67
    s_lshl_b32 s59, s59, 7
    s_add_u32 s59, s59, 0x430000
    s_bitcmp1_b64 s[14:15], 4
    s_cbranch_scc0 1
    s_waitcnt vmcnt(4)
    s_add_u32 s63, s69, 32768
    buffer_load_dwordx4 v[96:99], v1, s[40:43], s63 offen nt
    s_waitcnt vmcnt(6)
    s_add_u32 m0, s101, 0
    s_add_u32 s56, s100, 0
    buffer_load_dwordx4 v6, s[48:51], s56 offen nt lds
    s_waitcnt vmcnt(6)
    s_bitcmp1_b64 s[14:15], 5
    s_cbranch_scc0 1
    s_waitcnt vmcnt(4)
    s_add_u32 s63, s69, 40960
    buffer_load_dwordx4 v[100:103], v1, s[40:43], s63 offen nt
    s_waitcnt vmcnt(6)
    s_bitcmp1_b64 s[14:15], 6
    s_cbranch_scc0 1
    s_waitcnt vmcnt(2)
    s_add_u32 s63, s69, 49152
    buffer_load_dwordx4 v[128:131], v1, s[40:43], s63 offen nt
    s_cmp_eq_u32 s3, 0
    s_cbranch_scc1 .Lst_b1_0
    s_cmp_eq_u32 s3, 1
    s_cbranch_scc1 .Lst_b1_1
    s_cmp_eq_u32 s3, 2
    s_cbranch_scc1 .Lst_b1_2
    s_cmp_eq_u32 s3, 3
    s_cbranch_scc1 .Lst_b1_3
    s_cmp_eq_u32 s3, 4
    s_cbranch_scc1 .Lst_b1_4
    s_cmp_eq_u32 s3, 5
    s_cbranch_scc1 .Lst_b1_5
    s_cmp_eq_u32 s3, 6
    s_cbranch_scc1 .Lst_b1_6
    s_cmp_eq_u32 s3, 7
    s_cbranch_scc1 .Lst_b1_7
.Lrt_b1_0:
.Lrt_b1_1:
.Lrt_b1_2:
.Lrt_b1_3:
.Lrt_b1_4:
.Lrt_b1_5:
.Lrt_b1_6:
.Lrt_b1_7:
    s_waitcnt vmcnt(6)
    s_add_u32 m0, s101, 8192
    s_add_u32 s56, s100, 589824
    buffer_load_dwordx4 v6, s[48:51], s56 offen nt lds
    s_waitcnt vmcnt(4)
    s_bitcmp1_b64 s[14:15], 7
    s_cbranch_scc0 1
    s_waitcnt vmcnt(2)
    s_add_u32 s63, s69, 57344
    buffer_load_dwordx4 v[132:135], v1, s[40:43], s63 offen nt
    s_waitcnt vmcnt(4)
    s_bitcmp1_b64 s[14:15], 8
    s_cbranch_scc0 1
    s_waitcnt vmcnt(2)
    s_add_u32 s63, s69, 131072
    buffer_load_dwordx4 v[40:43], v1, s[40:43], s63 offen nt
    s_memrealtime s[8:9]
    s_waitcnt lgkmcnt(0)
    s_sub_u32 s8, s8, s30
    s_cmpk_ge_u32 s8, 436
    s_cbranch_scc1 .ap_134
    s_waitcnt vmcnt(5)
    s_cmpk_ge_u32 s8, 336
    s_cbranch_scc1 .ap_134
    s_waitcnt vmcnt(4)
    s_bitcmp1_b64 s[14:15], 9
    s_cbranch_scc0 1
    s_waitcnt vmcnt(2)
    s_cmpk_ge_u32 s8, 216
    s_cbranch_scc1 .ap_134
    s_waitcnt vmcnt(1)
.ap_134:
    s_add_u32 s63, s69, 139264
    buffer_load_dwordx4 v[44:47], v1, s[40:43], s63 offen nt
    s_memrealtime s[8:9]
    s_waitcnt lgkmcnt(0)
    s_sub_u32 s8, s8, s30
    s_cmpk_ge_u32 s8, 469
    s_cbranch_scc1 .ap_135
    s_waitcnt vmcnt(5)
    s_cmpk_ge_u32 s8, 369
    s_cbranch_scc1 .ap_135
    s_waitcnt vmcnt(4)
    s_bitcmp1_b64 s[14:15], 10
    s_cbranch_scc0 1
    s_waitcnt vmcnt(2)
    s_cmpk_ge_u32 s8, 249
    s_cbranch_scc1 .ap_135
    s_waitcnt vmcnt(1)
.ap_135:
    s_add_u32 s63, s69, 147456
    buffer_load_dwordx4 v[72:75], v1, s[40:43], s63 offen nt
    s_memrealtime s[8:9]
    s_waitcnt lgkmcnt(0)
    s_sub_u32 s8, s8, s30
    s_cmpk_ge_u32 s8, 503
    s_cbranch_scc1 .ap_136
    s_waitcnt vmcnt(5)
    s_cmpk_ge_u32 s8, 403
    s_cbranch_scc1 .ap_136
    s_waitcnt vmcnt(4)
    s_cmpk_ge_u32 s8, 283
    s_cbranch_scc1 .ap_136
    s_waitcnt vmcnt(1)
.ap_136:
    s_add_u32 m0, s101, 16384
    s_add_u32 s56, s100, 1179648
    buffer_load_dwordx4 v6, s[48:51], s56 offen nt lds
    s_memrealtime s[8:9]
    s_waitcnt lgkmcnt(0)
    s_sub_u32 s8, s8, s30
    s_cmpk_ge_u32 s8, 503
    s_cbranch_scc1 .ap_137
    s_waitcnt vmcnt(5)
    s_cmpk_ge_u32 s8, 403
    s_cbranch_scc1 .ap_137
    s_waitcnt vmcnt(4)
    s_bitcmp1_b64 s[14:15], 11
    s_cbranch_scc0 1
    s_waitcnt vmcnt(2)
    s_cmpk_ge_u32 s8, 283
    s_cbranch_scc1 .ap_137
    s_waitcnt vmcnt(1)
.ap_137:
    s_add_u32 s63, s69, 155648
    buffer_load_dwordx4 v[76:79], v1, s[40:43], s63 offen nt
    s_memrealtime s[8:9]
    s_waitcnt vmcnt(8)
    s_waitcnt lgkmcnt(0)
    s_sub_u32 s8, s8, s30
    s_cmpk_ge_u32 s8, 537
    s_cbranch_scc1 .ap_138
    s_waitcnt vmcnt(5)
    s_cmpk_ge_u32 s8, 437
    s_cbranch_scc1 .ap_138
    s_waitcnt vmcnt(4)
    s_bitcmp1_b64 s[14:15], 12
    s_cbranch_scc0 1
    s_waitcnt vmcnt(2)
    s_cmpk_ge_u32 s8, 317
    s_cbranch_scc1 .ap_138
    s_waitcnt vmcnt(1)
.ap_138:
    s_add_u32 s63, s69, 163840
    buffer_load_dwordx4 v[104:107], v1, s[40:43], s63 offen nt
    v_and_b32 v157, 7, v0
    v_lshlrev_b32 v157, 2, v157
    s_mov_b32 s63, 0x4a1100
    buffer_load_dword v156, v157, s[36:39], s63 offen
    s_branch .Lsk_b0_1
.Lst_b0_1:
    s_branch .Lrt_b0_1
.Lsk_b0_1:
    s_memrealtime s[8:9]
    s_waitcnt vmcnt(9)
    s_waitcnt lgkmcnt(0)
    s_sub_u32 s8, s8, s30
    s_cmpk_ge_u32 s8, 571
    s_cbranch_scc1 .ap_139
    s_waitcnt vmcnt(6)
    s_cmpk_ge_u32 s8, 471
    s_cbranch_scc1 .ap_139
    s_waitcnt vmcnt(5)
    s_bitcmp1_b64 s[14:15], 13
    s_cbranch_scc0 1
    s_waitcnt vmcnt(3)
    s_cmpk_ge_u32 s8, 351
    s_cbranch_scc1 .ap_139
    s_waitcnt vmcnt(2)
.ap_139:
    s_add_u32 s63, s69, 172032
    buffer_load_dwordx4 v[108:111], v1, s[40:43], s63 offen nt
    s_memrealtime s[8:9]
    s_waitcnt vmcnt(9)
    s_waitcnt lgkmcnt(0)
    s_sub_u32 s8, s8, s30
    s_cmpk_ge_u32 s8, 605
    s_cbranch_scc1 .ap_140
    s_waitcnt vmcnt(6)
    s_cmpk_ge_u32 s8, 505
    s_cbranch_scc1 .ap_140
    s_waitcnt vmcnt(5)
    s_bitcmp1_b64 s[14:15], 14
    s_cbranch_scc0 1
    s_waitcnt vmcnt(3)
    s_cmpk_ge_u32 s8, 385
    s_cbranch_scc1 .ap_140
    s_waitcnt vmcnt(2)
.ap_140:
    s_add_u32 s63, s69, 180224
    buffer_load_dwordx4 v[136:139], v1, s[40:43], s63 offen nt
    s_branch .Lsk_b0_2
.Lst_b0_2:
    s_branch .Lrt_b0_2
.Lsk_b0_2:
    s_memrealtime s[8:9]
    s_waitcnt vmcnt(9)
    s_waitcnt lgkmcnt(0)
    s_sub_u32 s8, s8, s30
    s_cmpk_ge_u32 s8, 639
    s_cbranch_scc1 .ap_141
    s_waitcnt vmcnt(6)
    s_cmpk_ge_u32 s8, 539
    s_cbranch_scc1 .ap_141
    s_waitcnt vmcnt(5)
    s_cmpk_ge_u32 s8, 419
    s_cbranch_scc1 .ap_141
    s_waitcnt vmcnt(1)
.ap_141:
    s_add_u32 m0, s101, 24576
    s_add_u32 s56, s100, 1769472
    buffer_load_dwordx4 v6, s[48:51], s56 offen nt lds
    s_memrealtime s[8:9]
    s_waitcnt vmcnt(9)
    s_waitcnt lgkmcnt(0)
    s_sub_u32 s8, s8, s30
    s_cmpk_ge_u32 s8, 639
    s_cbranch_scc1 .ap_142
    s_waitcnt vmcnt(6)
    s_cmpk_ge_u32 s8, 539
    s_cbranch_scc1 .ap_142
    s_waitcnt vmcnt(5)
    s_bitcmp1_b64 s[14:15], 15
    s_cbranch_scc0 1
    s_waitcnt vmcnt(2)
    s_cmpk_ge_u32 s8, 419
    s_cbranch_scc1 .ap_142
    s_waitcnt vmcnt(1)
.ap_142:
    s_add_u32 s63, s69, 188416
    buffer_load_dwordx4 v[140:143], v1, s[40:43], s63 offen nt
    s_memrealtime s[8:9]
    s_waitcnt vmcnt(9)
    s_waitcnt lgkmcnt(0)
    s_sub_u32 s8, s8, s30
    s_cmpk_ge_u32 s8, 673
    s_cbranch_scc1 .ap_143
    s_waitcnt vmcnt(6)
    s_cmpk_ge_u32 s8, 573
    s_cbranch_scc1 .ap_143
    s_waitcnt vmcnt(5)
    s_bitcmp1_b64 s[14:15], 16
    s_cbranch_scc0 1
    s_waitcnt vmcnt(2)
    s_cmpk_ge_u32 s8, 453
    s_cbranch_scc1 .ap_143
    s_waitcnt vmcnt(1)
.ap_143:
    s_add_u32 s63, s69, 262144
    buffer_load_dwordx4 v[48:51], v1, s[40:43], s63 offen nt
    s_waitcnt vmcnt(5)
    s_sub_u32 s63, s70, 300
    v_subrev_u32 v156, s63, v156
    v_mov_b32 v157, 600
    v_cmp_lt_u32 s[8:9], v156, v157
    v_add_u32_dpp v156, v156, v156 quad_perm:[1,0,3,2] row_mask:0xf bank_mask:0xf
    s_nop 1
    v_add_u32_dpp v156, v156, v156 quad_perm:[2,3,0,1] row_mask:0xf bank_mask:0xf
    s_nop 1
    v_add_u32_dpp v156, v156, v156 row_ror:4 row_mask:0xf bank_mask:0xf
    s_nop 0
    v_readfirstlane_b32 s63, v156
    s_cmp_eq_u64 s[8:9], -1
    s_nop 3
    s_cbranch_scc0 .et_144
    s_lshr_b32 s63, s63, 3
    s_sub_u32 s63, s63, 300
    s_add_u32 s30, s30, s63
    s_add_u32 s31, s31, s63
.et_144:
    s_memrealtime s[8:9]
    s_waitcnt lgkmcnt(0)
    s_sub_u32 s8, s8, s30
    s_cmpk_ge_u32 s8, 707
    s_cbranch_scc1 .ap_145
    s_waitcnt vmcnt(5)
    s_cmpk_ge_u32 s8, 607
    s_cbranch_scc1 .ap_145
    s_waitcnt vmcnt(4)
    s_bitcmp1_b64 s[14:15], 17
    s_cbranch_scc0 1
    s_waitcnt vmcnt(2)
    s_cmpk_ge_u32 s8, 487
    s_cbranch_scc1 .ap_145
    s_waitcnt vmcnt(1)
.ap_145:
    s_add_u32 s63, s69, 270336
    buffer_load_dwordx4 v[52:55], v1, s[40:43], s63 offen nt
    s_memrealtime s[8:9]
    s_waitcnt lgkmcnt(0)
    s_sub_u32 s8, s8, s30
    s_cmpk_ge_u32 s8, 742
    s_cbranch_scc1 .ap_146
    s_waitcnt vmcnt(5)
    s_cmpk_ge_u32 s8, 642
    s_cbranch_scc1 .ap_146
    s_waitcnt vmcnt(4)
    s_bitcmp1_b64 s[14:15], 18
    s_cbranch_scc0 1
    s_waitcnt vmcnt(2)
    s_cmpk_ge_u32 s8, 522
    s_cbranch_scc1 .ap_146
    s_waitcnt vmcnt(1)
.ap_146:
    s_add_u32 s63, s69, 278528
    buffer_load_dwordx4 v[80:83], v1, s[40:43], s63 offen nt
    s_memrealtime s[8:9]
    s_waitcnt lgkmcnt(0)
    s_sub_u32 s8, s8, s30
    s_cmpk_ge_u32 s8, 777
    s_cbranch_scc1 .ap_147
    s_waitcnt vmcnt(5)
    s_cmpk_ge_u32 s8, 677
    s_cbranch_scc1 .ap_147
    s_waitcnt vmcnt(4)
    s_cmpk_ge_u32 s8, 557
    s_cbranch_scc1 .ap_147
    s_waitcnt vmcnt(1)
.ap_147:
    s_add_u32 m0, s101, 32768
    s_add_u32 s56, s100, 2359296
    buffer_load_dwordx4 v6, s[48:51], s56 offen nt lds
    s_memrealtime s[8:9]
    s_waitcnt lgkmcnt(0)
    s_sub_u32 s8, s8, s30
    s_cmpk_ge_u32 s8, 777
    s_cbranch_scc1 .ap_148
    s_waitcnt vmcnt(5)
    s_cmpk_ge_u32 s8, 677
    s_cbranch_scc1 .ap_148
    s_waitcnt vmcnt(4)
    s_bitcmp1_b64 s[14:15], 19
    s_cbranch_scc0 1
    s_waitcnt vmcnt(2)
    s_cmpk_ge_u32 s8, 557
    s_cbranch_scc1 .ap_148
    s_waitcnt vmcnt(1)
.ap_148:
    s_add_u32 s63, s69, 286720
    buffer_load_dwordx4 v[84:87], v1, s[40:43], s63 offen nt
    s_memrealtime s[8:9]
    s_waitcnt vmcnt(8)
    s_waitcnt lgkmcnt(0)
    s_sub_u32 s8, s8, s30
    s_cmpk_ge_u32 s8, 812
    s_cbranch_scc1 .ap_149
    s_waitcnt vmcnt(5)
    s_cmpk_ge_u32 s8, 712
    s_cbranch_scc1 .ap_149
    s_waitcnt vmcnt(4)
    s_bitcmp1_b64 s[14:15], 20
    s_cbranch_scc0 1
    s_waitcnt vmcnt(2)
    s_cmpk_ge_u32 s8, 592
    s_cbranch_scc1 .ap_149
    s_waitcnt vmcnt(1)
.ap_149:
    s_add_u32 s63, s69, 294912
    buffer_load_dwordx4 v[112:115], v1, s[40:43], s63 offen nt
    s_memrealtime s[8:9]
    s_waitcnt vmcnt(8)
    s_waitcnt lgkmcnt(0)
    s_sub_u32 s8, s8, s30
    s_cmpk_ge_u32 s8, 847
    s_cbranch_scc1 .ap_150
    s_waitcnt vmcnt(5)
    s_cmpk_ge_u32 s8, 747
    s_cbranch_scc1 .ap_150
    s_waitcnt vmcnt(4)
    s_bitcmp1_b64 s[14:15], 21
    s_cbranch_scc0 1
    s_waitcnt vmcnt(2)
    s_cmpk_ge_u32 s8, 627
    s_cbranch_scc1 .ap_150
    s_waitcnt vmcnt(1)
.ap_150:
    s_add_u32 s63, s69, 303104
    buffer_load_dwordx4 v[116:119], v1, s[40:43], s63 offen nt
    s_memrealtime s[8:9]
    s_waitcnt vmcnt(8)
    s_waitcnt lgkmcnt(0)
    s_sub_u32 s8, s8, s30
    s_cmpk_ge_u32 s8, 882
    s_cbranch_scc1 .ap_151
    s_waitcnt vmcnt(5)
    s_cmpk_ge_u32 s8, 782
    s_cbranch_scc1 .ap_151
    s_waitcnt vmcnt(4)
    s_bitcmp1_b64 s[14:15], 22
    s_cbranch_scc0 1
    s_waitcnt vmcnt(2)
    s_cmpk_ge_u32 s8, 662
    s_cbranch_scc1 .ap_151
    s_waitcnt vmcnt(1)
.ap_151:
    s_add_u32 s63, s69, 311296
    buffer_load_dwordx4 v[144:147], v1, s[40:43], s63 offen nt
    s_memrealtime s[8:9]
    s_waitcnt vmcnt(8)
    s_waitcnt lgkmcnt(0)
    s_sub_u32 s8, s8, s30
    s_cmpk_ge_u32 s8, 917
    s_cbranch_scc1 .ap_152
    s_waitcnt vmcnt(5)
    s_cmpk_ge_u32 s8, 817
    s_cbranch_scc1 .ap_152
    s_waitcnt vmcnt(4)
    s_cmpk_ge_u32 s8, 697
    s_cbranch_scc1 .ap_152
    s_waitcnt vmcnt(1)
.ap_152:
    s_add_u32 m0, s101, 40960
    s_add_u32 s56, s100, 2949120
    buffer_load_dwordx4 v6, s[48:51], s56 offen nt lds
    s_memrealtime s[8:9]
    s_waitcnt vmcnt(8)
    s_waitcnt lgkmcnt(0)
    s_sub_u32 s8, s8, s30
    s_cmpk_ge_u32 s8, 917
    s_cbranch_scc1 .ap_153
    s_waitcnt vmcnt(5)
    s_cmpk_ge_u32 s8, 817
    s_cbranch_scc1 .ap_153
    s_waitcnt vmcnt(4)
    s_bitcmp1_b64 s[14:15], 23
    s_cbranch_scc0 1
    s_waitcnt vmcnt(2)
    s_cmpk_ge_u32 s8, 697
    s_cbranch_scc1 .ap_153
    s_waitcnt vmcnt(1)
.ap_153:
    s_add_u32 s63, s69, 319488
    buffer_load_dwordx4 v[148:151], v1, s[40:43], s63 offen nt
    s_branch .Lsk_b0_3
.Lst_b0_3:
    s_branch .Lrt_b0_3
.Lsk_b0_3:
    s_memrealtime s[8:9]
    s_waitcnt vmcnt(8)
    s_waitcnt lgkmcnt(0)
    s_sub_u32 s8, s8, s30
    s_cmpk_ge_u32 s8, 952
    s_cbranch_scc1 .ap_154
    s_waitcnt vmcnt(5)
    s_cmpk_ge_u32 s8, 852
    s_cbranch_scc1 .ap_154
    s_waitcnt vmcnt(4)
    s_bitcmp1_b64 s[14:15], 24
    s_cbranch_scc0 1
    s_waitcnt vmcnt(2)
    s_cmpk_ge_u32 s8, 732
    s_cbranch_scc1 .ap_154
    s_waitcnt vmcnt(1)
.ap_154:
    s_add_u32 s63, s69, 393216
    buffer_load_dwordx4 v[56:59], v1, s[40:43], s63 offen nt
    s_memrealtime s[8:9]
    s_waitcnt vmcnt(8)
    s_waitcnt lgkmcnt(0)
    s_sub_u32 s8, s8, s30
    s_cmpk_ge_u32 s8, 987
    s_cbranch_scc1 .ap_155
    s_waitcnt vmcnt(5)
    s_cmpk_ge_u32 s8, 887
    s_cbranch_scc1 .ap_155
    s_waitcnt vmcnt(4)
    s_bitcmp1_b64 s[14:15], 25
    s_cbranch_scc0 1
    s_waitcnt vmcnt(2)
    s_cmpk_ge_u32 s8, 767
    s_cbranch_scc1 .ap_155
    s_waitcnt vmcnt(1)
.ap_155:
    s_add_u32 s63, s69, 401408
    buffer_load_dwordx4 v[60:63], v1, s[40:43], s63 offen nt
    s_memrealtime s[8:9]
    s_waitcnt vmcnt(8)
    s_waitcnt lgkmcnt(0)
    s_sub_u32 s8, s8, s30
    s_cmpk_ge_u32 s8, 1025
    s_cbranch_scc1 .ap_156
    s_waitcnt vmcnt(5)
    s_cmpk_ge_u32 s8, 925
    s_cbranch_scc1 .ap_156
    s_waitcnt vmcnt(4)
    s_bitcmp1_b64 s[14:15], 26
    s_cbranch_scc0 1
    s_waitcnt vmcnt(2)
    s_cmpk_ge_u32 s8, 805
    s_cbranch_scc1 .ap_156
    s_waitcnt vmcnt(1)
.ap_156:
    s_add_u32 s63, s69, 409600
    buffer_load_dwordx4 v[88:91], v1, s[40:43], s63 offen nt
    s_memrealtime s[8:9]
    s_waitcnt vmcnt(8)
    s_waitcnt lgkmcnt(0)
    s_sub_u32 s8, s8, s30
    s_cmpk_ge_u32 s8, 1064
    s_cbranch_scc1 .ap_157
    s_waitcnt vmcnt(5)
    s_cmpk_ge_u32 s8, 964
    s_cbranch_scc1 .ap_157
    s_waitcnt vmcnt(4)
    s_cmpk_ge_u32 s8, 844
    s_cbranch_scc1 .ap_157
    s_waitcnt vmcnt(1)
.ap_157:
    s_add_u32 m0, s101, 49152
    s_add_u32 s56, s100, 3538944
    buffer_load_dwordx4 v6, s[48:51], s56 offen nt lds
    s_memrealtime s[8:9]
    s_waitcnt vmcnt(8)
    s_waitcnt lgkmcnt(0)
    s_sub_u32 s8, s8, s30
    s_cmpk_ge_u32 s8, 1064
    s_cbranch_scc1 .ap_158
    s_waitcnt vmcnt(5)
    s_cmpk_ge_u32 s8, 964
    s_cbranch_scc1 .ap_158
    s_waitcnt vmcnt(4)
    s_bitcmp1_b64 s[14:15], 27
    s_cbranch_scc0 1
    s_waitcnt vmcnt(2)
    s_cmpk_ge_u32 s8, 844
    s_cbranch_scc1 .ap_158
    s_waitcnt vmcnt(1)
.ap_158:
    s_add_u32 s63, s69, 417792
    buffer_load_dwordx4 v[92:95], v1, s[40:43], s63 offen nt
    s_memrealtime s[8:9]
    s_waitcnt vmcnt(8)
    s_waitcnt lgkmcnt(0)
    s_sub_u32 s8, s8, s30
    s_cmpk_ge_u32 s8, 1102
    s_cbranch_scc1 .ap_159
    s_waitcnt vmcnt(5)
    s_cmpk_ge_u32 s8, 1002
    s_cbranch_scc1 .ap_159
    s_waitcnt vmcnt(4)
    s_bitcmp1_b64 s[14:15], 28
    s_cbranch_scc0 1
    s_waitcnt vmcnt(2)
    s_cmpk_ge_u32 s8, 882
    s_cbranch_scc1 .ap_159
    s_waitcnt vmcnt(1)
.ap_159:
    s_add_u32 s63, s69, 425984
    buffer_load_dwordx4 v[120:123], v1, s[40:43], s63 offen nt
    s_memrealtime s[8:9]
    s_waitcnt vmcnt(8)
    s_waitcnt lgkmcnt(0)
    s_sub_u32 s8, s8, s30
    s_cmpk_ge_u32 s8, 1141
    s_cbranch_scc1 .ap_160
    s_waitcnt vmcnt(5)
    s_cmpk_ge_u32 s8, 1041
    s_cbranch_scc1 .ap_160
    s_waitcnt vmcnt(4)
    s_bitcmp1_b64 s[14:15], 29
    s_cbranch_scc0 1
    s_waitcnt vmcnt(2)
    s_cmpk_ge_u32 s8, 921
    s_cbranch_scc1 .ap_160
    s_waitcnt vmcnt(1)
.ap_160:
    s_add_u32 s63, s69, 434176
    buffer_load_dwordx4 v[124:127], v1, s[40:43], s63 offen nt
    s_memrealtime s[8:9]
    s_waitcnt vmcnt(8)
    s_waitcnt lgkmcnt(0)
    s_sub_u32 s8, s8, s30
    s_cmpk_ge_u32 s8, 1179
    s_cbranch_scc1 .ap_161
    s_waitcnt vmcnt(5)
    s_cmpk_ge_u32 s8, 1079
    s_cbranch_scc1 .ap_161
    s_waitcnt vmcnt(4)
    s_bitcmp1_b64 s[14:15], 30
    s_cbranch_scc0 1
    s_waitcnt vmcnt(2)
    s_cmpk_ge_u32 s8, 959
    s_cbranch_scc1 .ap_161
    s_waitcnt vmcnt(1)
.ap_161:
    s_add_u32 s63, s69, 442368
    buffer_load_dwordx4 v[152:155], v1, s[40:43], s63 offen nt
    s_memrealtime s[8:9]
    s_waitcnt vmcnt(8)
    s_waitcnt lgkmcnt(0)
    s_sub_u32 s8, s8, s30
    s_cmpk_ge_u32 s8, 1218
    s_cbranch_scc1 .ap_162
    s_waitcnt vmcnt(5)
    s_cmpk_ge_u32 s8, 1118
    s_cbranch_scc1 .ap_162
    s_waitcnt vmcnt(4)
    s_cmpk_ge_u32 s8, 998
    s_cbranch_scc1 .ap_162
    s_waitcnt vmcnt(1)
.ap_162:
    s_add_u32 m0, s101, 57344
    s_add_u32 s56, s100, 4128768
    buffer_load_dwordx4 v6, s[48:51], s56 offen nt lds
    s_and_b32 s0, s0, 0xffffff80
    s_sub_u32 s0, s0, 1024
    buffer_load_dword v28, v4, s[36:39], s0 offen sc1
    s_memrealtime s[8:9]
    s_waitcnt vmcnt(9)
    s_waitcnt lgkmcnt(0)
    s_sub_u32 s8, s8, s30
    s_cmpk_ge_u32 s8, 1218
    s_cbranch_scc1 .ap_163
    s_waitcnt vmcnt(6)
    s_cmpk_ge_u32 s8, 1118
    s_cbranch_scc1 .ap_163
    s_waitcnt vmcnt(5)
    s_bitcmp1_b64 s[14:15], 31
    s_cbranch_scc0 1
    s_waitcnt vmcnt(3)
    s_cmpk_ge_u32 s8, 998
    s_cbranch_scc1 .ap_163
    s_waitcnt vmcnt(2)
.ap_163:
    s_add_u32 s63, s69, 450560
    buffer_load_dwordx4 v[156:159], v1, s[40:43], s63 offen nt
    s_memrealtime s[8:9]
    s_waitcnt vmcnt(9)
    s_waitcnt lgkmcnt(0)
    s_sub_u32 s8, s8, s30
    s_cmpk_ge_u32 s8, 1257
    s_cbranch_scc1 .ap_164
    s_waitcnt vmcnt(6)
    s_cmpk_ge_u32 s8, 1157
    s_cbranch_scc1 .ap_164
    s_waitcnt vmcnt(5)
    s_bitcmp1_b64 s[14:15], 32
    s_cbranch_scc0 1
    s_waitcnt vmcnt(3)
    s_cmpk_ge_u32 s8, 1037
    s_cbranch_scc1 .ap_164
    s_waitcnt vmcnt(2)
.ap_164:
    v_bfe_u32 v1, v0, 4, 2
    v_and_b32 v10, 0xf0, v2
    v_lshlrev_b32 v1, 2, v1
    v_bfe_u32 v1, s6, v1, 4
    v_lshl_add_u32 v1, v1, 8, v10
    s_add_u32 s63, s69, 0
    buffer_load_dwordx4 v[160:163], v1, s[44:47], s63 offen nt
    s_memrealtime s[8:9]
    s_waitcnt vmcnt(9)
    s_waitcnt lgkmcnt(0)
    s_sub_u32 s8, s8, s30
    s_cmpk_ge_u32 s8, 1293
    s_cbranch_scc1 .ap_165
    s_waitcnt vmcnt(6)
    s_cmpk_ge_u32 s8, 1193
    s_cbranch_scc1 .ap_165
    s_waitcnt vmcnt(5)
    s_bitcmp1_b64 s[14:15], 33
    s_cbranch_scc0 1
    s_waitcnt vmcnt(3)
    s_cmpk_ge_u32 s8, 1073
    s_cbranch_scc1 .ap_165
    s_waitcnt vmcnt(1)
.ap_165:
    s_add_u32 s63, s69, 8192
    buffer_load_dwordx4 v[164:167], v1, s[44:47], s63 offen nt
    s_memrealtime s[8:9]
    s_waitcnt vmcnt(9)
    s_waitcnt lgkmcnt(0)
    s_sub_u32 s8, s8, s30
    s_cmpk_ge_u32 s8, 1329
    s_cbranch_scc1 .ap_166
    s_branch .Lsk_b1_0
.Lst_b1_0:
    s_branch .Lrt_b1_0
.Lsk_b1_0:
    s_waitcnt vmcnt(6)
    s_cmpk_ge_u32 s8, 1229
    s_cbranch_scc1 .ap_166
    s_waitcnt vmcnt(5)
    s_bitcmp1_b64 s[14:15], 34
    s_cbranch_scc0 1
    s_waitcnt vmcnt(2)
    s_cmpk_ge_u32 s8, 1109
    s_cbranch_scc1 .ap_166
    s_waitcnt vmcnt(1)
.ap_166:
    s_add_u32 s63, s69, 16384
    buffer_load_dwordx4 v[168:171], v1, s[44:47], s63 offen nt
    s_memrealtime s[8:9]
    s_waitcnt vmcnt(9)
    s_waitcnt lgkmcnt(0)
    s_sub_u32 s8, s8, s30
    s_cmpk_ge_u32 s8, 1366
    s_cbranch_scc1 .ap_167
    s_waitcnt vmcnt(6)
    s_cmpk_ge_u32 s8, 1266
    s_cbranch_scc1 .ap_167
    s_waitcnt vmcnt(5)
    s_cmpk_ge_u32 s8, 1146
    s_cbranch_scc1 .ap_167
    s_waitcnt vmcnt(1)
.ap_167:
    s_add_u32 m0, s101, 65536
    s_add_u32 s56, s100, 4718592
    buffer_load_dwordx4 v6, s[48:51], s56 offen nt lds
    s_memrealtime s[8:9]
    s_waitcnt vmcnt(9)
    s_waitcnt lgkmcnt(0)
    s_sub_u32 s8, s8, s30
    s_cmpk_ge_u32 s8, 1366
    s_cbranch_scc1 .ap_168
    s_waitcnt vmcnt(6)
    s_cmpk_ge_u32 s8, 1266
    s_cbranch_scc1 .ap_168
    s_waitcnt vmcnt(4)
    s_bitcmp1_b64 s[14:15], 35
    s_cbranch_scc0 1
    s_waitcnt vmcnt(2)
    s_cmpk_ge_u32 s8, 1146
    s_cbranch_scc1 .ap_168
    s_waitcnt vmcnt(1)
.ap_168:
    s_add_u32 s63, s69, 24576
    buffer_load_dwordx4 v[172:175], v1, s[44:47], s63 offen nt
    s_memrealtime s[8:9]
    s_waitcnt vmcnt(9)
    s_waitcnt lgkmcnt(0)
    s_sub_u32 s8, s8, s30
    s_cmpk_ge_u32 s8, 1402
    s_cbranch_scc1 .ap_169
    s_waitcnt vmcnt(5)
    s_cmpk_ge_u32 s8, 1302
    s_cbranch_scc1 .ap_169
    s_waitcnt vmcnt(4)
    s_bitcmp1_b64 s[14:15], 36
    s_cbranch_scc0 1
    s_waitcnt vmcnt(2)
    s_cmpk_ge_u32 s8, 1182
    s_cbranch_scc1 .ap_169
    s_waitcnt vmcnt(1)
.ap_169:
    s_add_u32 s63, s69, 32768
    buffer_load_dwordx4 v[176:179], v1, s[44:47], s63 offen nt
    s_waitcnt vmcnt(7)
    v_cmp_eq_u32 vcc, s1, v28
    s_cmp_eq_u64 vcc, -1
    s_cselect_b32 s0, 0x800000, 0
    s_add_u32 s58, s58, s0
    buffer_load_dwordx4 v[16:19], v7, s[36:39], s58 offen offset:0 sc1
    buffer_load_dwordx4 v[20:23], v7, s[36:39], s58 offen offset:256 sc1
    s_memrealtime s[8:9]
    s_waitcnt vmcnt(8)
    s_waitcnt lgkmcnt(0)
    s_sub_u32 s8, s8, s30
    s_cmpk_ge_u32 s8, 1439
    s_cbranch_scc1 .ap_170
    s_waitcnt vmcnt(5)
    s_cmpk_ge_u32 s8, 1339
    s_cbranch_scc1 .ap_170
    s_waitcnt vmcnt(4)
    s_bitcmp1_b64 s[14:15], 37
    s_cbranch_scc0 1
    s_waitcnt vmcnt(2)
    s_cmpk_ge_u32 s8, 1219
    s_cbranch_scc1 .ap_170
    s_waitcnt vmcnt(1)
.ap_170:
    s_add_u32 s63, s69, 40960
    buffer_load_dwordx4 v[180:183], v1, s[44:47], s63 offen nt
    s_memrealtime s[8:9]
    s_waitcnt vmcnt(8)
    s_waitcnt lgkmcnt(0)
    s_sub_u32 s8, s8, s30
    s_cmpk_ge_u32 s8, 1475
    s_cbranch_scc1 .ap_171
    s_waitcnt vmcnt(5)
    s_cmpk_ge_u32 s8, 1375
    s_cbranch_scc1 .ap_171
    s_waitcnt vmcnt(4)
    s_bitcmp1_b64 s[14:15], 38
    s_cbranch_scc0 1
    s_waitcnt vmcnt(2)
    s_cmpk_ge_u32 s8, 1255
    s_cbranch_scc1 .ap_171
    s_waitcnt vmcnt(1)
.ap_171:
    s_add_u32 s63, s69, 49152
    buffer_load_dwordx4 v[184:187], v1, s[44:47], s63 offen nt
    s_memrealtime s[8:9]
    s_waitcnt vmcnt(8)
    s_waitcnt lgkmcnt(0)
    s_sub_u32 s8, s8, s30
    s_cmpk_ge_u32 s8, 1512
    s_cbranch_scc1 .ap_172
    s_waitcnt vmcnt(5)
    s_cmpk_ge_u32 s8, 1412
    s_cbranch_scc1 .ap_172
    s_waitcnt vmcnt(4)
    s_cmpk_ge_u32 s8, 1292
    s_cbranch_scc1 .ap_172
    s_waitcnt vmcnt(1)
.ap_172:
    s_add_u32 m0, s101, 73728
    s_add_u32 s56, s100, 0
    buffer_load_dwordx4 v6, s[52:55], s56 offen nt lds
    s_memrealtime s[8:9]
    s_waitcnt vmcnt(8)
    s_waitcnt lgkmcnt(0)
    s_sub_u32 s8, s8, s30
    s_cmpk_ge_u32 s8, 1512
    s_cbranch_scc1 .ap_173
    s_waitcnt vmcnt(5)
    s_cmpk_ge_u32 s8, 1412
    s_cbranch_scc1 .ap_173
    s_waitcnt vmcnt(4)
    s_bitcmp1_b64 s[14:15], 39
    s_cbranch_scc0 1
    s_waitcnt vmcnt(2)
    s_cmpk_ge_u32 s8, 1292
    s_cbranch_scc1 .ap_173
    s_waitcnt vmcnt(1)
.ap_173:
    s_add_u32 s63, s69, 57344
    buffer_load_dwordx4 v[188:191], v1, s[44:47], s63 offen nt
    s_memrealtime s[8:9]
    s_waitcnt vmcnt(8)
    s_waitcnt lgkmcnt(0)
    s_sub_u32 s8, s8, s30
    s_cmpk_ge_u32 s8, 1548
    s_cbranch_scc1 .ap_174
    s_waitcnt vmcnt(5)
    s_cmpk_ge_u32 s8, 1448
    s_cbranch_scc1 .ap_174
    s_waitcnt vmcnt(4)
    s_bitcmp1_b64 s[14:15], 40
    s_cbranch_scc0 1
    s_waitcnt vmcnt(2)
    s_cmpk_ge_u32 s8, 1328
    s_cbranch_scc1 .ap_174
    s_waitcnt vmcnt(1)
.ap_174:
    s_add_u32 s63, s69, 131072
    buffer_load_dwordx4 v[192:195], v1, s[44:47], s63 offen nt
    s_waitcnt vmcnt(5)
    s_branch .gpc_176
.gp_175:
    s_xor_b32 s58, s58, 0x800000
    buffer_load_dwordx4 v[16:19], v7, s[36:39], s58 offen offset:0 sc1
    buffer_load_dwordx4 v[20:23], v7, s[36:39], s58 offen offset:256 sc1
    s_waitcnt vmcnt(0)
.gpc_176:
    v_min_u32 v10, v17, v19
    v_max_u32 v11, v17, v19
    v_min3_u32 v10, v10, v21, v23
    v_max3_u32 v11, v11, v21, v23
    v_cmp_eq_u32 vcc, s34, v10
    v_cmp_eq_u32 s[56:57], s34, v11
    s_and_b64 vcc, vcc, s[56:57]
    s_cmp_eq_u64 vcc, -1
    s_nop 2
    s_cbranch_scc1 .gpd_177
    s_sub_u32 s35, s35, 1
    s_cbranch_scc1 .Lexit
    s_sleep 1
    s_branch .gp_175
.gpd_177:
    s_mov_b32 vcc_lo, 0xcccccccc
    s_mov_b32 vcc_hi, 0xcccccccc
    v_cndmask_b32_e64 v24, v16, 0, vcc
    v_cndmask_b32_e64 v25, v18, 0, vcc
    v_cndmask_b32_e64 v26, v20, 0, vcc
    v_cndmask_b32_e64 v27, v22, 0, vcc
    v_cndmask_b32_e32 v28, 0, v16, vcc
    v_cndmask_b32_e32 v29, 0, v18, vcc
    v_cndmask_b32_e32 v30, 0, v20, vcc
    v_cndmask_b32_e32 v31, 0, v22, vcc
    v_mfma_f32_16x16x32_bf16 v[16:19], v[32:35], v[24:27], 0
    v_mfma_f32_16x16x32_bf16 v[32:35], v[40:43], v[24:27], 0
    v_mfma_f32_16x16x32_bf16 v[16:19], v[36:39], v[28:31], v[16:19]
    v_mfma_f32_16x16x32_bf16 v[40:43], v[48:51], v[24:27], 0
    v_mfma_f32_16x16x32_bf16 v[32:35], v[44:47], v[28:31], v[32:35]
    v_mfma_f32_16x16x32_bf16 v[48:51], v[56:59], v[24:27], 0
    v_mfma_f32_16x16x32_bf16 v[40:43], v[52:55], v[28:31], v[40:43]
    v_mfma_f32_16x16x32_bf16 v[56:59], v[64:67], v[24:27], 0
    v_mfma_f32_16x16x32_bf16 v[48:51], v[60:63], v[28:31], v[48:51]
    s_nop 1
    v_add_f32_dpp v10, v17, v16 row_ror:12 row_mask:0xf bank_mask:0x1
    s_memrealtime s[8:9]
    s_waitcnt lgkmcnt(0)
    s_sub_u32 s8, s8, s30
    s_cmpk_ge_u32 s8, 1585
    s_nop 0
    s_cbranch_scc1 .ap_178
    s_waitcnt vmcnt(5)
    s_cmpk_ge_u32 s8, 1485
    s_cbranch_scc1 .ap_178
    s_waitcnt vmcnt(4)
    s_bitcmp1_b64 s[14:15], 41
    s_cbranch_scc0 1
    s_waitcnt vmcnt(2)
    s_cmpk_ge_u32 s8, 1365
    s_cbranch_scc1 .ap_178
    s_branch .Lsk_b1_1
.Lst_b1_1:
    s_branch .Lrt_b1_1
.Lsk_b1_1:
    s_waitcnt vmcnt(1)
.ap_178:
    s_add_u32 s63, s69, 139264
    buffer_load_dwordx4 v[196:199], v1, s[44:47], s63 offen nt
    v_mfma_f32_16x16x32_bf16 v[64:67], v[72:75], v[24:27], 0
    v_mfma_f32_16x16x32_bf16 v[56:59], v[68:71], v[28:31], v[56:59]
    v_add_f32_dpp v11, v33, v32 row_ror:12 row_mask:0xf bank_mask:0x1
    v_add_f32_dpp v10, v18, v10 row_ror:8 row_mask:0xf bank_mask:0x1
    v_mfma_f32_16x16x32_bf16 v[72:75], v[80:83], v[24:27], 0
    v_mfma_f32_16x16x32_bf16 v[64:67], v[76:79], v[28:31], v[64:67]
    v_add_f32_dpp v12, v41, v40 row_ror:12 row_mask:0xf bank_mask:0x1
    v_add_f32_dpp v11, v34, v11 row_ror:8 row_mask:0xf bank_mask:0x1
    v_add_f32_dpp v10, v19, v10 row_ror:4 row_mask:0xf bank_mask:0x1
    v_mfma_f32_16x16x32_bf16 v[80:83], v[88:91], v[24:27], 0
    v_mfma_f32_16x16x32_bf16 v[72:75], v[84:87], v[28:31], v[72:75]
    v_add_f32_dpp v13, v49, v48 row_ror:12 row_mask:0xf bank_mask:0x1
    v_add_f32_dpp v12, v42, v12 row_ror:8 row_mask:0xf bank_mask:0x1
    v_add_f32_dpp v11, v35, v11 row_ror:4 row_mask:0xf bank_mask:0x1
    v_mfma_f32_16x16x32_bf16 v[88:91], v[96:99], v[24:27], 0
    v_mfma_f32_16x16x32_bf16 v[80:83], v[92:95], v[28:31], v[80:83]
    v_add_f32_dpp v10, v58, v57 row_ror:12 row_mask:0xf bank_mask:0x2
    v_add_f32_dpp v13, v50, v13 row_ror:8 row_mask:0xf bank_mask:0x1
    v_add_f32_dpp v12, v43, v12 row_ror:4 row_mask:0xf bank_mask:0x1
    s_memrealtime s[8:9]
    s_waitcnt lgkmcnt(0)
    s_sub_u32 s8, s8, s30
    s_cmpk_ge_u32 s8, 1589
    s_nop 0
    s_cbranch_scc1 .ap_179
    s_waitcnt vmcnt(5)
    s_cmpk_ge_u32 s8, 1489
    s_cbranch_scc1 .ap_179
    s_waitcnt vmcnt(4)
    s_bitcmp1_b64 s[14:15], 42
    s_cbranch_scc0 1
    s_waitcnt vmcnt(2)
    s_cmpk_ge_u32 s8, 1369
    s_cbranch_scc1 .ap_179
    s_waitcnt vmcnt(1)
.ap_179:
    s_add_u32 s63, s69, 147456
    buffer_load_dwordx4 v[200:203], v1, s[44:47], s63 offen nt
    s_memrealtime s[8:9]
    s_waitcnt lgkmcnt(0)
    s_sub_u32 s8, s8, s30
    s_cmpk_ge_u32 s8, 1594
    s_cbranch_scc1 .ap_180
    s_waitcnt vmcnt(5)
    s_cmpk_ge_u32 s8, 1494
    s_cbranch_scc1 .ap_180
    s_waitcnt vmcnt(4)
    s_cmpk_ge_u32 s8, 1374
    s_cbranch_scc1 .ap_180
    s_waitcnt vmcnt(1)
.ap_180:
    s_add_u32 m0, s101, 81920
    s_add_u32 s56, s100, 589824
    buffer_load_dwordx4 v6, s[52:55], s56 offen nt lds
    v_mfma_f32_16x16x32_bf16 v[96:99], v[104:107], v[24:27], 0
    v_mfma_f32_16x16x32_bf16 v[88:91], v[100:103], v[28:31], v[88:91]
    v_add_f32_dpp v11, v66, v65 row_ror:12 row_mask:0xf bank_mask:0x2
    v_add_f32_dpp v10, v59, v10 row_ror:8 row_mask:0xf bank_mask:0x2
    v_add_f32_dpp v13, v51, v13 row_ror:4 row_mask:0xf bank_mask:0x1
    v_mfma_f32_16x16x32_bf16 v[104:107], v[112:115], v[24:27], 0
    v_mfma_f32_16x16x32_bf16 v[96:99], v[108:111], v[28:31], v[96:99]
    v_add_f32_dpp v12, v74, v73 row_ror:12 row_mask:0xf bank_mask:0x2
    v_add_f32_dpp v11, v67, v11 row_ror:8 row_mask:0xf bank_mask:0x2
    v_add_f32_dpp v10, v56, v10 row_ror:4 row_mask:0xf bank_mask:0x2
    v_mfma_f32_16x16x32_bf16 v[112:115], v[120:123], v[24:27], 0
    v_mfma_f32_16x16x32_bf16 v[104:107], v[116:119], v[28:31], v[104:107]
    v_add_f32_dpp v13, v82, v81 row_ror:12 row_mask:0xf bank_mask:0x2
    v_add_f32_dpp v12, v75, v12 row_ror:8 row_mask:0xf bank_mask:0x2
    v_add_f32_dpp v11, v64, v11 row_ror:4 row_mask:0xf bank_mask:0x2
    v_mfma_f32_16x16x32_bf16 v[120:123], v[128:131], v[24:27], 0
    v_mfma_f32_16x16x32_bf16 v[112:115], v[124:127], v[28:31], v[112:115]
    v_add_f32_dpp v10, v91, v90 row_ror:12 row_mask:0xf bank_mask:0x4
    v_add_f32_dpp v13, v83, v13 row_ror:8 row_mask:0xf bank_mask:0x2
    v_add_f32_dpp v12, v72, v12 row_ror:4 row_mask:0xf bank_mask:0x2
    s_memrealtime s[8:9]
    s_waitcnt lgkmcnt(0)
    s_sub_u32 s8, s8, s30
    s_cmpk_ge_u32 s8, 1594
    s_nop 0
    s_cbranch_scc1 .ap_181
    s_waitcnt vmcnt(5)
    s_cmpk_ge_u32 s8, 1494
    s_cbranch_scc1 .ap_181
    s_waitcnt vmcnt(4)
    s_bitcmp1_b64 s[14:15], 43
    s_cbranch_scc0 1
    s_waitcnt vmcnt(2)
    s_cmpk_ge_u32 s8, 1374
    s_cbranch_scc1 .ap_181
    s_waitcnt vmcnt(1)
.ap_181:
    s_add_u32 s63, s69, 155648
    buffer_load_dwordx4 v[204:207], v1, s[44:47], s63 offen nt
    v_mfma_f32_16x16x32_bf16 v[128:131], v[136:139], v[24:27], 0
    v_mfma_f32_16x16x32_bf16 v[120:123], v[132:135], v[28:31], v[120:123]
    v_add_f32_dpp v11, v99, v98 row_ror:12 row_mask:0xf bank_mask:0x4
    v_add_f32_dpp v10, v88, v10 row_ror:8 row_mask:0xf bank_mask:0x4
    v_add_f32_dpp v13, v80, v13 row_ror:4 row_mask:0xf bank_mask:0x2
    v_mfma_f32_16x16x32_bf16 v[136:139], v[144:147], v[24:27], 0
    v_mfma_f32_16x16x32_bf16 v[128:131], v[140:143], v[28:31], v[128:131]
    v_add_f32_dpp v12, v107, v106 row_ror:12 row_mask:0xf bank_mask:0x4
    v_add_f32_dpp v11, v96, v11 row_ror:8 row_mask:0xf bank_mask:0x4
    v_add_f32_dpp v10, v89, v10 row_ror:4 row_mask:0xf bank_mask:0x4
    v_mfma_f32_16x16x32_bf16 v[144:147], v[152:155], v[24:27], 0
    v_mfma_f32_16x16x32_bf16 v[136:139], v[148:151], v[28:31], v[136:139]
    v_add_f32_dpp v13, v115, v114 row_ror:12 row_mask:0xf bank_mask:0x4
    v_add_f32_dpp v12, v104, v12 row_ror:8 row_mask:0xf bank_mask:0x4
    v_add_f32_dpp v11, v97, v11 row_ror:4 row_mask:0xf bank_mask:0x4
    v_mfma_f32_16x16x32_bf16 v[144:147], v[156:159], v[28:31], v[144:147]
    v_add_f32_dpp v10, v120, v123 row_ror:12 row_mask:0xf bank_mask:0x8
    v_add_f32_dpp v13, v112, v13 row_ror:8 row_mask:0xf bank_mask:0x4
    v_add_f32_dpp v12, v105, v12 row_ror:4 row_mask:0xf bank_mask:0x4
    s_memrealtime s[8:9]
    s_waitcnt vmcnt(8)
    s_waitcnt lgkmcnt(0)
    s_sub_u32 s8, s8, s30
    s_cmpk_ge_u32 s8, 1599
    s_cbranch_scc1 .ap_182
    s_waitcnt vmcnt(5)
    s_cmpk_ge_u32 s8, 1499
    s_cbranch_scc1 .ap_182
    s_waitcnt vmcnt(4)
    s_bitcmp1_b64 s[14:15], 44
    s_cbranch_scc0 1
    s_waitcnt vmcnt(2)
    s_cmpk_ge_u32 s8, 1379
    s_cbranch_scc1 .ap_182
    s_waitcnt vmcnt(1)
.ap_182:
    s_add_u32 s63, s69, 163840
    buffer_load_dwordx4 v[208:211], v1, s[44:47], s63 offen nt
    s_cmp_eq_u32 s3, 0
    s_cbranch_scc1 .Lst_b2_0
    s_cmp_eq_u32 s3, 1
    s_branch .Lsk_b1_2
.Lst_b1_2:
    s_branch .Lrt_b1_2
.Lsk_b1_2:
    s_cbranch_scc1 .Lst_b2_1
    s_cmp_eq_u32 s3, 2
    s_cbranch_scc1 .Lst_b2_2
    s_cmp_eq_u32 s3, 3
    s_cbranch_scc1 .Lst_b2_3
.Lrt_b2_0:
.Lrt_b2_1:
.Lrt_b2_2:
.Lrt_b2_3:
    v_add_f32_dpp v11, v128, v131 row_ror:12 row_mask:0xf bank_mask:0x8
    v_add_f32_dpp v10, v121, v10 row_ror:8 row_mask:0xf bank_mask:0x8
    v_add_f32_dpp v13, v113, v13 row_ror:4 row_mask:0xf bank_mask:0x4
    v_add_f32_dpp v12, v136, v139 row_ror:12 row_mask:0xf bank_mask:0x8
    v_add_f32_dpp v11, v129, v11 row_ror:8 row_mask:0xf bank_mask:0x8
    v_add_f32_dpp v10, v122, v10 row_ror:4 row_mask:0xf bank_mask:0x8
    v_add_f32_dpp v13, v144, v147 row_ror:12 row_mask:0xf bank_mask:0x8
    v_add_f32_dpp v12, v137, v12 row_ror:8 row_mask:0xf bank_mask:0x8
    v_add_f32_dpp v11, v130, v11 row_ror:4 row_mask:0xf bank_mask:0x8
    v_add_f32_dpp v13, v145, v13 row_ror:8 row_mask:0xf bank_mask:0x8
    v_add_f32_dpp v12, v138, v12 row_ror:4 row_mask:0xf bank_mask:0x8
    s_memrealtime s[8:9]
    s_waitcnt vmcnt(8)
    s_waitcnt lgkmcnt(0)
    s_sub_u32 s8, s8, s30
    s_cmpk_ge_u32 s8, 1604
    s_cbranch_scc1 .ap_183
    s_waitcnt vmcnt(5)
    s_cmpk_ge_u32 s8, 1504
    s_cbranch_scc1 .ap_183
    s_waitcnt vmcnt(4)
    s_bitcmp1_b64 s[14:15], 45
    s_cbranch_scc0 1
    s_waitcnt vmcnt(2)
    s_cmpk_ge_u32 s8, 1384
    s_cbranch_scc1 .ap_183
    s_waitcnt vmcnt(1)
.ap_183:
    s_add_u32 s63, s69, 172032
    buffer_load_dwordx4 v[212:215], v1, s[44:47], s63 offen nt
    v_add_f32_dpp v13, v146, v13 row_ror:4 row_mask:0xf bank_mask:0x8
    s_mov_b32 s60, 0x3db504f3
    s_mov_b32 s61, 0x3db504f3
    v_cvt_pk_bf16_f32 v10, v10, v11
    v_and_b32 v11, 0xffff0000, v10
    v_lshlrev_b32 v10, 16, v10
    v_cvt_pk_bf16_f32 v12, v12, v13
    v_and_b32 v13, 0xffff0000, v12
    v_lshlrev_b32 v12, 16, v12
    v_pk_mul_f32 v[10:11], v[10:11], s[60:61]
    v_pk_mul_f32 v[12:13], v[12:13], s[60:61]
    v_cvt_pk_bf16_f32 v10, v10, v11
    v_and_b32 v11, 0xffff0000, v10
    v_lshlrev_b32 v10, 16, v10
    v_cvt_pk_bf16_f32 v12, v12, v13
    v_and_b32 v13, 0xffff0000, v12
    v_lshlrev_b32 v12, 16, v12
    v_max_f32 v14, v10, v11
    v_max3_f32 v14, v14, v12, v13
    s_mov_b32 s60, 0x3fb8aa3b
    v_mov_b32 v22, s34
    v_mov_b32 v23, s34
    v_max_f32_dpp v14, v14, v14 quad_perm:[2,3,0,1] row_mask:0xf bank_mask:0xf
    s_nop 1
    v_max_f32_dpp v14, v14, v14 row_ror:4 row_mask:0xf bank_mask:0xf
    s_nop 1
    v_max_f32_dpp v14, v14, v14 row_ror:8 row_mask:0xf bank_mask:0xf
    v_mov_b32 v15, v14
    s_nop 1
    v_permlane16_swap_b32 v15, v14
    v_max_f32 v14, v15, v14
    v_mov_b32 v15, v14
    s_nop 1
    v_permlane32_swap_b32 v15, v14
    v_max_f32 v14, v15, v14
    v_mul_f32 v15, 0xbfb8aa3b, v14
    v_fma_f32 v10, v10, s60, v15
    v_fma_f32 v11, v11, s60, v15
    v_fma_f32 v12, v12, s60, v15
    v_fma_f32 v13, v13, s60, v15
    v_exp_f32 v10, v10
    v_exp_f32 v11, v11
    v_exp_f32 v12, v12
    v_exp_f32 v13, v13
    v_mov_b32 v20, v14
    v_pk_add_f32 v[16:17], v[10:11], v[12:13]
    v_add_f32 v21, v16, v17
    s_lshl_b32 s60, s68, 5
    s_lshl_b32 s61, s3, 4
    s_add_u32 s61, s61, 159104
    v_add_u32 v16, s61, v3
    v_mov_b32 v17, 159232
    v_mov_b32 v18, 1
    s_add_u32 s60, s60, s59
    v_add_f32_dpp v21, v21, v21 quad_perm:[2,3,0,1] row_mask:0xf bank_mask:0xf
    s_nop 1
    v_add_f32_dpp v21, v21, v21 row_ror:4 row_mask:0xf bank_mask:0xf
    s_nop 1
    v_add_f32_dpp v21, v21, v21 row_ror:8 row_mask:0xf bank_mask:0xf
    v_mov_b32 v15, v21
    s_nop 1
    v_permlane16_swap_b32 v15, v21
    v_add_f32 v21, v15, v21
    v_mov_b32 v15, v21
    s_nop 1
    v_permlane32_swap_b32 v15, v21
    v_add_f32 v21, v15, v21
    s_mov_b64 exec, 3
    ds_write_b64 v16, v[20:21]
    s_mov_b64 exec, 1
    ds_add_rtn_u32 v18, v17, v18
    s_mov_b64 exec, -1
    v_and_b32 v16, 0x78, v3
    v_or_b32 v16, 159104, v16
    s_waitcnt lgkmcnt(0)
    v_readfirstlane_b32 s61, v18
    s_cmp_eq_u32 s61, 7
    s_nop 3
    s_cbranch_scc0 .mlc_184
    ds_read_b64 v[18:19], v16
    s_waitcnt lgkmcnt(0)
    v_mov_b32 v20, v18
    s_nop 1
    v_max_f32_dpp v20, v20, v20 quad_perm:[2,3,0,1] row_mask:0xf bank_mask:0xf
    s_nop 1
    v_max_f32_dpp v20, v20, v20 row_ror:4 row_mask:0xf bank_mask:0xf
    s_nop 1
    v_max_f32_dpp v20, v20, v20 row_ror:8 row_mask:0xf bank_mask:0xf
    v_sub_f32 v18, v18, v20
    v_mul_f32 v18, 0x3fb8aa3b, v18
    v_exp_f32 v18, v18
    s_nop 0
    v_mul_f32 v21, v18, v19
    s_nop 1
    v_add_f32_dpp v21, v21, v21 quad_perm:[2,3,0,1] row_mask:0xf bank_mask:0xf
    s_nop 1
    v_add_f32_dpp v21, v21, v21 row_ror:4 row_mask:0xf bank_mask:0xf
    s_nop 1
    v_add_f32_dpp v21, v21, v21 row_ror:8 row_mask:0xf bank_mask:0xf
    s_mov_b64 exec, 3
    s_add_u32 s57, s60, 0x800000
    buffer_store_dwordx4 v[20:23], v2, s[36:39], s57 offen
    s_cmp_lg_u32 s0, 0
    s_nop 0
    s_cbranch_scc1 .nosl_185
    buffer_store_dwordx4 v[20:23], v2, s[36:39], s60 offen sc1
.nosl_185:
    s_mov_b64 exec, -1
.mlc_184:
    s_add_u32 s59, s59, s0
    s_memrealtime s[8:9]
    s_waitcnt vmcnt(8)
    s_waitcnt lgkmcnt(0)
    s_sub_u32 s8, s8, s30
    s_cmpk_ge_u32 s8, 1635
    s_cbranch_scc1 .ap_186
    s_waitcnt vmcnt(5)
    s_cmpk_ge_u32 s8, 1535
    s_cbranch_scc1 .ap_186
    s_waitcnt vmcnt(4)
    s_bitcmp1_b64 s[14:15], 46
    s_cbranch_scc0 1
    s_waitcnt vmcnt(2)
    s_cmpk_ge_u32 s8, 1415
    s_cbranch_scc1 .ap_186
    s_waitcnt vmcnt(1)
.ap_186:
    s_add_u32 s63, s69, 180224
    buffer_load_dwordx4 v[216:219], v1, s[44:47], s63 offen nt
    s_memrealtime s[8:9]
    s_waitcnt vmcnt(8)
    s_waitcnt lgkmcnt(0)
    s_sub_u32 s8, s8, s30
    s_cmpk_ge_u32 s8, 1667
    s_cbranch_scc1 .ap_187
    s_waitcnt vmcnt(5)
    s_cmpk_ge_u32 s8, 1567
    s_cbranch_scc1 .ap_187
    s_waitcnt vmcnt(4)
    s_bitcmp1_b64 s[14:15], 47
    s_cbranch_scc0 1
    s_waitcnt vmcnt(2)
    s_cmpk_ge_u32 s8, 1447
    s_cbranch_scc1 .ap_187
    s_waitcnt vmcnt(1)
.ap_187:
    s_add_u32 s63, s69, 188416
    buffer_load_dwordx4 v[220:223], v1, s[44:47], s63 offen nt
    s_and_b32 s56, s64, 0
    s_mul_i32 s56, s56, 18432
    s_mul_i32 s57, s3, 2304
    s_add_u32 s56, s56, s57
    s_add_u32 s56, s56, 0x37000
    buffer_load_dwordx4 v[32:35], v2, s[36:39], s56 offen offset:0 sc1
    buffer_load_dwordx4 v[40:43], v2, s[36:39], s56 offen offset:1024 sc1
    buffer_load_dwordx2 v[48:49], v5, s[36:39], s56 offen offset:0 sc1
    s_memrealtime s[8:9]
    s_waitcnt vmcnt(11)
    s_waitcnt lgkmcnt(0)
    s_sub_u32 s8, s8, s30
    s_cmpk_ge_u32 s8, 1699
    s_cbranch_scc1 .ap_188
    s_waitcnt vmcnt(8)
    s_cmpk_ge_u32 s8, 1599
    s_cbranch_scc1 .ap_188
    s_waitcnt vmcnt(7)
    s_bitcmp1_b64 s[14:15], 48
    s_cbranch_scc0 1
    s_waitcnt vmcnt(5)
    s_cmpk_ge_u32 s8, 1479
    s_cbranch_scc1 .ap_188
    s_branch .Lsk_b1_3
.Lst_b1_3:
    s_branch .Lrt_b1_3
.Lsk_b1_3:
    s_waitcnt vmcnt(4)
.ap_188:
    s_add_u32 s63, s69, 262144
    buffer_load_dwordx4 v[224:227], v1, s[44:47], s63 offen nt
    s_memrealtime s[8:9]
    s_waitcnt vmcnt(11)
    s_waitcnt lgkmcnt(0)
    s_sub_u32 s8, s8, s30
    s_cmpk_ge_u32 s8, 1731
    s_cbranch_scc1 .ap_189
    s_waitcnt vmcnt(8)
    s_cmpk_ge_u32 s8, 1631
    s_cbranch_scc1 .ap_189
    s_waitcnt vmcnt(7)
    s_bitcmp1_b64 s[14:15], 49
    s_cbranch_scc0 1
    s_waitcnt vmcnt(5)
    s_cmpk_ge_u32 s8, 1511
    s_cbranch_scc1 .ap_189
    s_waitcnt vmcnt(4)
.ap_189:
    s_add_u32 s63, s69, 270336
    buffer_load_dwordx4 v[228:231], v1, s[44:47], s63 offen nt
    s_and_b32 s56, s64, 0
    s_mul_i32 s56, s56, 18432
    s_mul_i32 s57, s3, 2304
    s_add_u32 s56, s56, s57
    s_add_u32 s56, s56, 0x49000
    buffer_load_dwordx4 v[56:59], v2, s[36:39], s56 offen offset:0 sc1
    buffer_load_dwordx4 v[64:67], v2, s[36:39], s56 offen offset:1024 sc1
    buffer_load_dwordx2 v[72:73], v5, s[36:39], s56 offen offset:0 sc1
    s_memrealtime s[8:9]
    s_waitcnt vmcnt(14)
    s_waitcnt lgkmcnt(0)
    s_sub_u32 s8, s8, s30
    s_cmpk_ge_u32 s8, 1763
    s_cbranch_scc1 .ap_190
    s_waitcnt vmcnt(11)
    s_cmpk_ge_u32 s8, 1663
    s_cbranch_scc1 .ap_190
    s_waitcnt vmcnt(10)
    s_bitcmp1_b64 s[14:15], 50
    s_cbranch_scc0 1
    s_waitcnt vmcnt(8)
    s_cmpk_ge_u32 s8, 1543
    s_cbranch_scc1 .ap_190
    s_waitcnt vmcnt(4)
.ap_190:
    s_add_u32 s63, s69, 278528
    buffer_load_dwordx4 v[232:235], v1, s[44:47], s63 offen nt
    s_memrealtime s[8:9]
    s_waitcnt vmcnt(14)
    s_waitcnt lgkmcnt(0)
    s_sub_u32 s8, s8, s30
    s_cmpk_ge_u32 s8, 1794
    s_cbranch_scc1 .ap_191
    s_waitcnt vmcnt(11)
    s_cmpk_ge_u32 s8, 1694
    s_cbranch_scc1 .ap_191
    s_waitcnt vmcnt(10)
    s_bitcmp1_b64 s[14:15], 51
    s_cbranch_scc0 1
    s_waitcnt vmcnt(5)
    s_cmpk_ge_u32 s8, 1574
    s_cbranch_scc1 .ap_191
    s_waitcnt vmcnt(4)
.ap_191:
    s_add_u32 s63, s69, 286720
    buffer_load_dwordx4 v[236:239], v1, s[44:47], s63 offen nt
    s_memrealtime s[8:9]
    s_waitcnt vmcnt(14)
    s_waitcnt lgkmcnt(0)
    s_sub_u32 s8, s8, s30
    s_cmpk_ge_u32 s8, 1826
    s_cbranch_scc1 .ap_192
    s_waitcnt vmcnt(11)
    s_cmpk_ge_u32 s8, 1726
    s_cbranch_scc1 .ap_192
    s_waitcnt vmcnt(10)
    s_bitcmp1_b64 s[14:15], 52
    s_cbranch_scc0 1
    s_waitcnt vmcnt(5)
    s_cmpk_ge_u32 s8, 1606
    s_cbranch_scc1 .ap_192
    s_waitcnt vmcnt(1)
.ap_192:
    s_add_u32 s63, s69, 294912
    buffer_load_dwordx4 v[240:243], v1, s[44:47], s63 offen nt
    s_memrealtime s[8:9]
    s_waitcnt vmcnt(14)
    s_waitcnt lgkmcnt(0)
    s_sub_u32 s8, s8, s30
    s_cmpk_ge_u32 s8, 1858
    s_cbranch_scc1 .ap_193
    s_waitcnt vmcnt(11)
    s_cmpk_ge_u32 s8, 1758
    s_cbranch_scc1 .ap_193
    s_waitcnt vmcnt(7)
    s_bitcmp1_b64 s[14:15], 53
    s_cbranch_scc0 1
    s_waitcnt vmcnt(2)
    s_cmpk_ge_u32 s8, 1638
    s_cbranch_scc1 .ap_193
    s_waitcnt vmcnt(1)
.ap_193:
    s_add_u32 s63, s69, 303104
    buffer_load_dwordx4 v[244:247], v1, s[44:47], s63 offen nt
    buffer_load_dwordx4 v[24:27], v9, s[36:39], s59 offen offset:0 sc1
    s_memrealtime s[8:9]
    s_waitcnt vmcnt(14)
    s_waitcnt lgkmcnt(0)
    s_sub_u32 s8, s8, s30
    s_cmpk_ge_u32 s8, 1890
    s_cbranch_scc1 .ap_194
    s_waitcnt vmcnt(8)
    s_cmpk_ge_u32 s8, 1790
    s_cbranch_scc1 .ap_194
    s_waitcnt vmcnt(4)
    s_bitcmp1_b64 s[14:15], 54
    s_cbranch_scc0 1
    s_waitcnt vmcnt(2)
    s_cmpk_ge_u32 s8, 1670
    s_cbranch_scc1 .ap_194
    s_waitcnt vmcnt(1)
.ap_194:
    s_add_u32 s63, s69, 311296
    buffer_load_dwordx4 v[248:251], v1, s[44:47], s63 offen nt
    s_memrealtime s[8:9]
    s_waitcnt vmcnt(14)
    s_waitcnt lgkmcnt(0)
    s_sub_u32 s8, s8, s30
    s_cmpk_ge_u32 s8, 1922
    s_cbranch_scc1 .ap_195
    s_waitcnt vmcnt(5)
    s_cmpk_ge_u32 s8, 1822
    s_cbranch_scc1 .ap_195
    s_waitcnt vmcnt(4)
    s_bitcmp1_b64 s[14:15], 55
    s_cbranch_scc0 1
    s_waitcnt vmcnt(2)
    s_cmpk_ge_u32 s8, 1702
    s_cbranch_scc1 .ap_195
    s_waitcnt vmcnt(1)
.ap_195:
    s_add_u32 s63, s69, 319488
    buffer_load_dwordx4 v[252:255], v1, s[44:47], s63 offen nt
    s_memrealtime s[8:9]
    s_waitcnt vmcnt(11)
    s_waitcnt lgkmcnt(0)
    s_sub_u32 s8, s8, s30
    s_cmpk_ge_u32 s8, 1953
    s_cbranch_scc1 .ap_196
    s_waitcnt vmcnt(5)
    s_cmpk_ge_u32 s8, 1853
    s_cbranch_scc1 .ap_196
    s_waitcnt vmcnt(4)
    s_bitcmp1_b64 s[14:15], 56
    s_cbranch_scc0 1
    s_waitcnt vmcnt(2)
    s_cmpk_ge_u32 s8, 1733
    s_cbranch_scc1 .ap_196
    s_waitcnt vmcnt(1)
.ap_196:
    s_add_u32 s63, s69, 393216
    buffer_load_dwordx4 v[36:39], v1, s[44:47], s63 offen nt
    s_memrealtime s[8:9]
    s_waitcnt vmcnt(11)
    s_waitcnt lgkmcnt(0)
    s_sub_u32 s8, s8, s30
    s_cmpk_ge_u32 s8, 1985
    s_cbranch_scc1 .ap_197
    s_waitcnt vmcnt(5)
    s_cmpk_ge_u32 s8, 1885
    s_cbranch_scc1 .ap_197
    s_waitcnt vmcnt(4)
    s_bitcmp1_b64 s[14:15], 57
    s_cbranch_scc0 1
    s_waitcnt vmcnt(2)
    s_cmpk_ge_u32 s8, 1765
    s_cbranch_scc1 .ap_197
    s_waitcnt vmcnt(1)
.ap_197:
    s_add_u32 s63, s69, 401408
    buffer_load_dwordx4 v[44:47], v1, s[44:47], s63 offen nt
    s_memrealtime s[8:9]
    s_waitcnt vmcnt(8)
    s_waitcnt lgkmcnt(0)
    s_sub_u32 s8, s8, s30
    s_cmpk_ge_u32 s8, 2017
    s_cbranch_scc1 .ap_198
    s_waitcnt vmcnt(5)
    s_cmpk_ge_u32 s8, 1917
    s_cbranch_scc1 .ap_198
    s_waitcnt vmcnt(4)
    s_bitcmp1_b64 s[14:15], 58
    s_cbranch_scc0 1
    s_waitcnt vmcnt(2)
    s_cmpk_ge_u32 s8, 1797
    s_cbranch_scc1 .ap_198
    s_waitcnt vmcnt(1)
.ap_198:
    s_add_u32 s63, s69, 409600
    buffer_load_dwordx4 v[52:55], v1, s[44:47], s63 offen nt
    s_waitcnt vmcnt(5)
    s_branch .gpc_200
.gp_199:
    s_xor_b32 s59, s59, 0x800000
    buffer_load_dwordx4 v[24:27], v9, s[36:39], s59 offen offset:0 sc1
    s_waitcnt vmcnt(0)
.gpc_200:
    v_cmp_eq_u32 vcc, s34, v26
    s_cmp_eq_u64 vcc, -1
    s_nop 3
    s_cbranch_scc1 .gpd_201
    s_sub_u32 s35, s35, 1
    s_cbranch_scc1 .Lexit
    s_sleep 1
    s_branch .gp_199
.gpd_201:
    v_mov_b32 v16, v24
    s_nop 1
    v_max_f32_dpp v16, v16, v16 row_ror:4 row_mask:0xf bank_mask:0xf
    v_sub_f32 v17, v24, v16
    v_sub_f32 v18, v14, v16
    v_mul_f32 v17, 0x3fb8aa3b, v17
    v_mul_f32 v18, 0x3fb8aa3b, v18
    v_exp_f32 v17, v17
    v_exp_f32 v18, v18
    v_mul_f32 v17, v17, v25
    s_nop 1
    v_add_f32_dpp v17, v17, v17 row_ror:4 row_mask:0xf bank_mask:0xf
    v_rcp_f32 v19, v17
    s_nop 0
    v_fma_f32 v15, -v17, v19, 1.0
    v_fma_f32 v19, v15, v19, v19
    s_branch .Lsk_b1_4
.Lst_b1_4:
    s_branch .Lrt_b1_4
.Lsk_b1_4:
    v_mul_f32 v18, v18, v19
    v_mul_f32 v10, v10, v18
    v_mul_f32 v11, v11, v18
    v_mul_f32 v12, v12, v18
    v_mul_f32 v13, v13, v18
    v_mov_b32_dpp v112, v10 quad_perm:[2,3,0,1] row_mask:0xf bank_mask:0xf
    v_mov_b32_dpp v113, v11 quad_perm:[2,3,0,1] row_mask:0xf bank_mask:0xf
    v_mov_b32_dpp v114, v12 quad_perm:[2,3,0,1] row_mask:0xf bank_mask:0xf
    v_mov_b32_dpp v115, v13 quad_perm:[2,3,0,1] row_mask:0xf bank_mask:0xf
    v_cvt_pk_bf16_f32 v96, v10, v112
    v_cvt_pk_bf16_f32 v100, v11, v113
    v_cvt_pk_bf16_f32 v104, v12, v114
    v_cvt_pk_bf16_f32 v108, v13, v115
    v_mov_b32_dpp v97, v96 row_ror:12 row_mask:0xf bank_mask:0xf
    v_mov_b32_dpp v101, v100 row_ror:12 row_mask:0xf bank_mask:0xf
    v_mov_b32_dpp v105, v104 row_ror:12 row_mask:0xf bank_mask:0xf
    v_mov_b32_dpp v109, v108 row_ror:12 row_mask:0xf bank_mask:0xf
    v_mov_b32_dpp v98, v96 row_ror:8 row_mask:0xf bank_mask:0xf
    v_mov_b32_dpp v102, v100 row_ror:8 row_mask:0xf bank_mask:0xf
    v_mov_b32_dpp v106, v104 row_ror:8 row_mask:0xf bank_mask:0xf
    v_mov_b32_dpp v110, v108 row_ror:8 row_mask:0xf bank_mask:0xf
    v_mov_b32_dpp v99, v96 row_ror:4 row_mask:0xf bank_mask:0xf
    v_mov_b32_dpp v103, v100 row_ror:4 row_mask:0xf bank_mask:0xf
    v_mov_b32_dpp v107, v104 row_ror:4 row_mask:0xf bank_mask:0xf
    v_mov_b32_dpp v111, v108 row_ror:4 row_mask:0xf bank_mask:0xf
    s_lshl_b32 s60, s3, 10
    s_add_u32 s60, s60, 147456
    v_lshlrev_b32 v10, 5, v0
    v_add_u32 v10, s60, v10
    s_memrealtime s[8:9]
    s_waitcnt lgkmcnt(0)
    s_sub_u32 s8, s8, s30
    s_cmpk_ge_u32 s8, 2049
    s_cbranch_scc1 .ap_202
    s_waitcnt vmcnt(5)
    s_cmpk_ge_u32 s8, 1949
    s_cbranch_scc1 .ap_202
    s_waitcnt vmcnt(4)
    s_bitcmp1_b64 s[14:15], 59
    s_cbranch_scc0 1
    s_waitcnt vmcnt(2)
    s_cmpk_ge_u32 s8, 1829
    s_cbranch_scc1 .ap_202
    s_waitcnt vmcnt(1)
.ap_202:
    s_add_u32 s63, s69, 417792
    buffer_load_dwordx4 v[60:63], v1, s[44:47], s63 offen nt
    v_perm_b32 v112, v164, v160, s94
    v_perm_b32 v113, v172, v168, s94
    v_perm_b32 v114, v180, v176, s94
    v_perm_b32 v115, v188, v184, s94
    s_nop 1
    v_mfma_f32_16x16x32_bf16 v[128:131], v[96:99], v[112:115], 0
    v_perm_b32 v116, v164, v160, s95
    v_perm_b32 v117, v172, v168, s95
    v_perm_b32 v118, v180, v176, s95
    v_perm_b32 v119, v188, v184, s95
    s_nop 1
    v_mfma_f32_16x16x32_bf16 v[132:135], v[96:99], v[116:119], 0
    v_perm_b32 v120, v165, v161, s94
    v_perm_b32 v121, v173, v169, s94
    v_perm_b32 v122, v181, v177, s94
    v_perm_b32 v123, v189, v185, s94
    s_nop 1
    v_mfma_f32_16x16x32_bf16 v[136:139], v[96:99], v[120:123], 0
    v_perm_b32 v124, v165, v161, s95
    v_perm_b32 v125, v173, v169, s95
    v_perm_b32 v126, v181, v177, s95
    v_perm_b32 v127, v189, v185, s95
    s_nop 1
    v_mfma_f32_16x16x32_bf16 v[140:143], v[96:99], v[124:127], 0
    v_perm_b32 v112, v166, v162, s94
    v_perm_b32 v113, v174, v170, s94
    v_perm_b32 v114, v182, v178, s94
    v_perm_b32 v115, v190, v186, s94
    s_nop 1
    v_mfma_f32_16x16x32_bf16 v[144:147], v[96:99], v[112:115], 0
    v_perm_b32 v116, v166, v162, s95
    v_perm_b32 v117, v174, v170, s95
    v_perm_b32 v118, v182, v178, s95
    v_perm_b32 v119, v190, v186, s95
    s_nop 1
    v_mfma_f32_16x16x32_bf16 v[148:151], v[96:99], v[116:119], 0
    v_perm_b32 v120, v167, v163, s94
    v_perm_b32 v121, v175, v171, s94
    v_perm_b32 v122, v183, v179, s94
    v_perm_b32 v123, v191, v187, s94
    s_nop 1
    v_mfma_f32_16x16x32_bf16 v[152:155], v[96:99], v[120:123], 0
    v_perm_b32 v124, v167, v163, s95
    v_perm_b32 v125, v175, v171, s95
    v_perm_b32 v126, v183, v179, s95
    v_perm_b32 v127, v191, v187, s95
    s_nop 1
    v_mfma_f32_16x16x32_bf16 v[156:159], v[96:99], v[124:127], 0
    s_memrealtime s[8:9]
    s_waitcnt lgkmcnt(0)
    s_sub_u32 s8, s8, s30
    s_cmpk_ge_u32 s8, 2081
    s_nop 3
    s_cbranch_scc1 .ap_203
    s_waitcnt vmcnt(5)
    s_cmpk_ge_u32 s8, 1981
    s_cbranch_scc1 .ap_203
    s_waitcnt vmcnt(4)
    s_bitcmp1_b64 s[14:15], 60
    s_cbranch_scc0 1
    s_waitcnt vmcnt(2)
    s_cmpk_ge_u32 s8, 1861
    s_cbranch_scc1 .ap_203
    s_waitcnt vmcnt(1)
.ap_203:
    s_add_u32 s63, s69, 425984
    buffer_load_dwordx4 v[68:71], v1, s[44:47], s63 offen nt
    v_perm_b32 v112, v196, v192, s94
    v_perm_b32 v113, v204, v200, s94
    v_perm_b32 v114, v212, v208, s94
    v_perm_b32 v115, v220, v216, s94
    s_nop 1
    v_mfma_f32_16x16x32_bf16 v[128:131], v[100:103], v[112:115], v[128:131]
    v_perm_b32 v116, v196, v192, s95
    v_perm_b32 v117, v204, v200, s95
    v_perm_b32 v118, v212, v208, s95
    v_perm_b32 v119, v220, v216, s95
    s_nop 1
    v_mfma_f32_16x16x32_bf16 v[132:135], v[100:103], v[116:119], v[132:135]
    v_perm_b32 v120, v197, v193, s94
    v_perm_b32 v121, v205, v201, s94
    v_perm_b32 v122, v213, v209, s94
    v_perm_b32 v123, v221, v217, s94
    s_nop 1
    v_mfma_f32_16x16x32_bf16 v[136:139], v[100:103], v[120:123], v[136:139]
    v_perm_b32 v124, v197, v193, s95
    v_perm_b32 v125, v205, v201, s95
    v_perm_b32 v126, v213, v209, s95
    v_perm_b32 v127, v221, v217, s95
    s_nop 1
    v_mfma_f32_16x16x32_bf16 v[140:143], v[100:103], v[124:127], v[140:143]
    v_perm_b32 v112, v198, v194, s94
    v_perm_b32 v113, v206, v202, s94
    v_perm_b32 v114, v214, v210, s94
    v_perm_b32 v115, v222, v218, s94
    s_nop 1
    v_mfma_f32_16x16x32_bf16 v[144:147], v[100:103], v[112:115], v[144:147]
    v_perm_b32 v116, v198, v194, s95
    v_perm_b32 v117, v206, v202, s95
    v_perm_b32 v118, v214, v210, s95
    v_perm_b32 v119, v222, v218, s95
    s_nop 1
    v_mfma_f32_16x16x32_bf16 v[148:151], v[100:103], v[116:119], v[148:151]
    v_perm_b32 v120, v199, v195, s94
    v_perm_b32 v121, v207, v203, s94
    v_perm_b32 v122, v215, v211, s94
    v_perm_b32 v123, v223, v219, s94
    s_nop 1
    v_mfma_f32_16x16x32_bf16 v[152:155], v[100:103], v[120:123], v[152:155]
    v_perm_b32 v124, v199, v195, s95
    v_perm_b32 v125, v207, v203, s95
    v_perm_b32 v126, v215, v211, s95
    v_perm_b32 v127, v223, v219, s95
    s_nop 1
    v_mfma_f32_16x16x32_bf16 v[156:159], v[100:103], v[124:127], v[156:159]
    s_memrealtime s[8:9]
    s_waitcnt lgkmcnt(0)
    s_sub_u32 s8, s8, s30
    s_cmpk_ge_u32 s8, 2112
    s_nop 3
    s_cbranch_scc1 .ap_204
    s_branch .Lsk_b1_5
.Lst_b1_5:
    s_branch .Lrt_b1_5
.Lsk_b1_5:
    s_waitcnt vmcnt(5)
    s_cmpk_ge_u32 s8, 2012
    s_cbranch_scc1 .ap_204
    s_waitcnt vmcnt(4)
    s_bitcmp1_b64 s[14:15], 61
    s_cbranch_scc0 1
    s_waitcnt vmcnt(2)
    s_cmpk_ge_u32 s8, 1892
    s_cbranch_scc1 .ap_204
    s_waitcnt vmcnt(1)
.ap_204:
    s_add_u32 s63, s69, 434176
    buffer_load_dwordx4 v[76:79], v1, s[44:47], s63 offen nt
    s_waitcnt vmcnt(6)
    v_perm_b32 v112, v228, v224, s94
    v_perm_b32 v113, v236, v232, s94
    v_perm_b32 v114, v244, v240, s94
    v_perm_b32 v115, v252, v248, s94
    s_nop 1
    v_mfma_f32_16x16x32_bf16 v[128:131], v[104:107], v[112:115], v[128:131]
    v_perm_b32 v116, v228, v224, s95
    v_perm_b32 v117, v236, v232, s95
    v_perm_b32 v118, v244, v240, s95
    v_perm_b32 v119, v252, v248, s95
    s_nop 1
    v_mfma_f32_16x16x32_bf16 v[132:135], v[104:107], v[116:119], v[132:135]
    v_perm_b32 v120, v229, v225, s94
    v_perm_b32 v121, v237, v233, s94
    v_perm_b32 v122, v245, v241, s94
    v_perm_b32 v123, v253, v249, s94
    s_nop 1
    v_mfma_f32_16x16x32_bf16 v[136:139], v[104:107], v[120:123], v[136:139]
    v_perm_b32 v124, v229, v225, s95
    v_perm_b32 v125, v237, v233, s95
    v_perm_b32 v126, v245, v241, s95
    v_perm_b32 v127, v253, v249, s95
    s_nop 1
    v_mfma_f32_16x16x32_bf16 v[140:143], v[104:107], v[124:127], v[140:143]
    v_perm_b32 v112, v230, v226, s94
    v_perm_b32 v113, v238, v234, s94
    v_perm_b32 v114, v246, v242, s94
    v_perm_b32 v115, v254, v250, s94
    s_nop 1
    v_mfma_f32_16x16x32_bf16 v[144:147], v[104:107], v[112:115], v[144:147]
    v_perm_b32 v116, v230, v226, s95
    v_perm_b32 v117, v238, v234, s95
    v_perm_b32 v118, v246, v242, s95
    v_perm_b32 v119, v254, v250, s95
    s_nop 1
    v_mfma_f32_16x16x32_bf16 v[148:151], v[104:107], v[116:119], v[148:151]
    v_perm_b32 v120, v231, v227, s94
    v_perm_b32 v121, v239, v235, s94
    v_perm_b32 v122, v247, v243, s94
    v_perm_b32 v123, v255, v251, s94
    s_nop 1
    v_mfma_f32_16x16x32_bf16 v[152:155], v[104:107], v[120:123], v[152:155]
    v_perm_b32 v124, v231, v227, s95
    v_perm_b32 v125, v239, v235, s95
    v_perm_b32 v126, v247, v243, s95
    v_perm_b32 v127, v255, v251, s95
    s_nop 1
    v_mfma_f32_16x16x32_bf16 v[156:159], v[104:107], v[124:127], v[156:159]
    s_memrealtime s[8:9]
    s_waitcnt lgkmcnt(0)
    s_sub_u32 s8, s8, s30
    s_cmpk_ge_u32 s8, 2144
    s_nop 3
    s_cbranch_scc1 .ap_205
    s_waitcnt vmcnt(5)
    s_cmpk_ge_u32 s8, 2044
    s_cbranch_scc1 .ap_205
    s_waitcnt vmcnt(4)
    s_bitcmp1_b64 s[14:15], 62
    s_cbranch_scc0 1
    s_waitcnt vmcnt(2)
    s_cmpk_ge_u32 s8, 1924
    s_cbranch_scc1 .ap_205
    s_waitcnt vmcnt(1)
.ap_205:
    s_add_u32 s63, s69, 442368
    buffer_load_dwordx4 v[84:87], v1, s[44:47], s63 offen nt
    s_memrealtime s[8:9]
    s_waitcnt lgkmcnt(0)
    s_sub_u32 s8, s8, s30
    s_cmpk_ge_u32 s8, 2176
    s_cbranch_scc1 .ap_206
    s_waitcnt vmcnt(5)
    s_cmpk_ge_u32 s8, 2076
    s_cbranch_scc1 .ap_206
    s_waitcnt vmcnt(4)
    s_bitcmp1_b64 s[14:15], 63
    s_cbranch_scc0 1
    s_waitcnt vmcnt(2)
    s_cmpk_ge_u32 s8, 1956
    s_cbranch_scc1 .ap_206
    s_waitcnt vmcnt(1)
.ap_206:
    s_add_u32 s63, s69, 450560
    buffer_load_dwordx4 v[92:95], v1, s[44:47], s63 offen nt
    s_setprio 0
    s_waitcnt vmcnt(6)
    v_perm_b32 v160, v44, v36, s94
    v_perm_b32 v164, v44, v36, s95
    v_perm_b32 v168, v45, v37, s94
    v_perm_b32 v172, v45, v37, s95
    v_perm_b32 v176, v46, v38, s94
    v_perm_b32 v180, v46, v38, s95
    v_perm_b32 v184, v47, v39, s94
    v_perm_b32 v188, v47, v39, s95
    s_waitcnt vmcnt(4)
    v_perm_b32 v161, v60, v52, s94
    v_perm_b32 v165, v60, v52, s95
    v_perm_b32 v169, v61, v53, s94
    v_perm_b32 v173, v61, v53, s95
    v_perm_b32 v177, v62, v54, s94
    v_perm_b32 v181, v62, v54, s95
    v_perm_b32 v185, v63, v55, s94
    v_perm_b32 v189, v63, v55, s95
    s_waitcnt vmcnt(2)
    v_perm_b32 v162, v76, v68, s94
    v_perm_b32 v166, v76, v68, s95
    v_perm_b32 v170, v77, v69, s94
    v_perm_b32 v174, v77, v69, s95
    v_perm_b32 v178, v78, v70, s94
    v_perm_b32 v182, v78, v70, s95
    v_perm_b32 v186, v79, v71, s94
    v_perm_b32 v190, v79, v71, s95
    s_branch .Lsk_b1_6
    .fill 6, 4, 0xbf800000
.Lst_b1_6:
    s_branch .Lrt_b1_6
.Lsk_b1_6:
    s_waitcnt vmcnt(0)
    s_add_u32 m0, s101, 90112
    s_add_u32 s56, s100, 1179648
    buffer_load_dwordx4 v6, s[52:55], s56 offen nt lds
    s_add_u32 m0, s101, 98304
    s_add_u32 s56, s100, 1769472
    buffer_load_dwordx4 v6, s[52:55], s56 offen nt lds
    s_add_u32 m0, s101, 106496
    s_add_u32 s56, s100, 2359296
    buffer_load_dwordx4 v6, s[52:55], s56 offen nt lds
    s_add_u32 m0, s101, 114688
    s_add_u32 s56, s100, 2949120
    buffer_load_dwordx4 v6, s[52:55], s56 offen nt lds
    s_add_u32 m0, s101, 122880
    s_add_u32 s56, s100, 3538944
    buffer_load_dwordx4 v6, s[52:55], s56 offen nt lds
    v_perm_b32 v163, v92, v84, s94
    v_perm_b32 v167, v92, v84, s95
    v_perm_b32 v171, v93, v85, s94
    v_mfma_f32_16x16x32_bf16 v[128:131], v[108:111], v[160:163], v[128:131]
    v_perm_b32 v175, v93, v85, s95
    v_mfma_f32_16x16x32_bf16 v[132:135], v[108:111], v[164:167], v[132:135]
    v_perm_b32 v179, v94, v86, s94
    v_mfma_f32_16x16x32_bf16 v[136:139], v[108:111], v[168:171], v[136:139]
    v_perm_b32 v183, v94, v86, s95
    v_mfma_f32_16x16x32_bf16 v[140:143], v[108:111], v[172:175], v[140:143]
    v_perm_b32 v187, v95, v87, s94
    v_mfma_f32_16x16x32_bf16 v[144:147], v[108:111], v[176:179], v[144:147]
    v_perm_b32 v191, v95, v87, s95
    v_mfma_f32_16x16x32_bf16 v[148:151], v[108:111], v[180:183], v[148:151]
    v_mfma_f32_16x16x32_bf16 v[152:155], v[108:111], v[184:187], v[152:155]
    v_mfma_f32_16x16x32_bf16 v[156:159], v[108:111], v[188:191], v[156:159]
    s_mov_b64 exec, 0xffff
    ds_write2_b32 v10, v128, v129 offset0:0 offset1:128
    ds_write2_b32 v10, v132, v133 offset0:1 offset1:129
    ds_write2_b32 v10, v136, v137 offset0:2 offset1:130
    ds_write2_b32 v10, v140, v141 offset0:3 offset1:131
    ds_write2_b32 v10, v144, v145 offset0:4 offset1:132
    ds_write2_b32 v10, v148, v149 offset0:5 offset1:133
    ds_write2_b32 v10, v152, v153 offset0:6 offset1:134
    ds_write2_b32 v10, v156, v157 offset0:7 offset1:135
    s_mov_b64 exec, -1
    s_waitcnt lgkmcnt(0)
    s_barrier
    s_cmp_lg_u32 s3, 7
    s_cbranch_scc1 .opub_207
    v_add_u32 v10, 147456, v2
    ds_read_b128 v[196:199], v10 offset:0
    ds_read_b128 v[200:203], v10 offset:1024
    ds_read_b128 v[204:207], v10 offset:2048
    ds_read_b128 v[208:211], v10 offset:3072
    ds_read_b128 v[212:215], v10 offset:4096
    ds_read_b128 v[216:219], v10 offset:5120
    ds_read_b128 v[220:223], v10 offset:6144
    ds_read_b128 v[224:227], v10 offset:7168
    v_lshrrev_b32 v11, 5, v0
    v_lshlrev_b32 v11, 13, v11
    v_and_b32 v12, 31, v0
    v_lshl_add_u32 v11, v12, 4, v11
    s_lshl4_add_u32 s56, s67, s66
    s_lshl1_add_u32 s56, s56, s68
    s_lshl_b32 s56, s56, 9
    s_add_u32 s56, s56, 0xa0000
    s_mov_b32 s60, 0x07060503
    s_mov_b32 s61, 0x07060502
    s_mov_b32 s62, 0x07060501
    v_mov_b32 v15, s34
    s_waitcnt lgkmcnt(6)
    v_pk_add_f32 v[196:197], v[196:197], v[200:201]
    v_pk_add_f32 v[198:199], v[198:199], v[202:203]
    s_waitcnt lgkmcnt(5)
    v_pk_add_f32 v[196:197], v[196:197], v[204:205]
    v_pk_add_f32 v[198:199], v[198:199], v[206:207]
    s_waitcnt lgkmcnt(4)
    v_pk_add_f32 v[196:197], v[196:197], v[208:209]
    v_pk_add_f32 v[198:199], v[198:199], v[210:211]
    s_waitcnt lgkmcnt(3)
    v_pk_add_f32 v[196:197], v[196:197], v[212:213]
    v_pk_add_f32 v[198:199], v[198:199], v[214:215]
    s_waitcnt lgkmcnt(2)
    v_pk_add_f32 v[196:197], v[196:197], v[216:217]
    v_pk_add_f32 v[198:199], v[198:199], v[218:219]
    s_waitcnt lgkmcnt(1)
    v_pk_add_f32 v[196:197], v[196:197], v[220:221]
    v_pk_add_f32 v[198:199], v[198:199], v[222:223]
    s_waitcnt lgkmcnt(0)
    v_pk_add_f32 v[196:197], v[196:197], v[224:225]
    v_pk_add_f32 v[198:199], v[198:199], v[226:227]
    v_perm_b32 v12, v196, v199, s60
    v_perm_b32 v13, v197, v199, s61
    v_perm_b32 v14, v198, v199, s62
    s_add_u32 s57, s56, 0x800000
    buffer_store_dwordx4 v[12:15], v11, s[36:39], s57 offen
    s_cmp_lg_u32 s0, 0
    s_nop 0
    s_cbranch_scc1 .nosl_208
    buffer_store_dwordx4 v[12:15], v11, s[36:39], s56 offen sc1
.nosl_208:
.opub_207:
    s_mov_b32 s61, s101
    v_lshrrev_b32 v25, 4, v0
    v_bfe_u32 v26, v0, 1, 1
    v_lshl_add_u32 v25, v25, 1, v26
    v_bfe_u32 v26, v0, 2, 2
    v_lshl_add_u32 v19, v25, 3, v26
    v_lshlrev_b32 v19, 7, v19
    v_and_b32 v25, 3, v25
    v_lshrrev_b32 v26, 1, v26
    v_lshl_add_u32 v25, v25, 1, v26
    v_xor_b32 v25, s3, v25
    v_lshl_add_u32 v19, v25, 4, v19
    v_and_b32 v25, 1, v0
    v_lshl_add_u32 v19, v25, 3, v19
    v_add_u32 v20, 32768, v19
    ds_read_b64_tr_b16 v[160:161], v19 offset:0
    ds_read_b64_tr_b16 v[162:163], v19 offset:512
    ds_read_b64_tr_b16 v[168:169], v19 offset:8192
    ds_read_b64_tr_b16 v[170:171], v19 offset:8704
    ds_read_b64_tr_b16 v[176:177], v19 offset:16384
    ds_read_b64_tr_b16 v[178:179], v19 offset:16896
    ds_read_b64_tr_b16 v[184:185], v19 offset:24576
    ds_read_b64_tr_b16 v[186:187], v19 offset:25088
    ds_read_b64_tr_b16 v[192:193], v20 offset:0
    ds_read_b64_tr_b16 v[194:195], v20 offset:512
    ds_read_b64_tr_b16 v[200:201], v20 offset:8192
    ds_read_b64_tr_b16 v[202:203], v20 offset:8704
    ds_read_b64_tr_b16 v[208:209], v20 offset:16384
    ds_read_b64_tr_b16 v[210:211], v20 offset:16896
    ds_read_b64_tr_b16 v[216:217], v20 offset:24576
    ds_read_b64_tr_b16 v[218:219], v20 offset:25088
    ds_read_b64_tr_b16 v[224:225], v20 offset:32768
    ds_read_b64_tr_b16 v[226:227], v20 offset:33280
    v_add_u32 v19, 73728, v19
    v_add_u32 v20, 73728, v20
    s_mov_b32 s48, s22
    s_and_b32 s49, s23, 0xffff
    s_mov_b32 s50, 0x510000
    s_mov_b32 s51, 0x00020000
    s_mul_i32 s69, s99, 73728
    s_mul_i32 s56, s3, 9216
    s_add_u32 s69, s69, s56
    v_bfe_u32 v25, v0, 4, 1
    s_and_b32 s56, s3, 1
    s_lshl_b32 s56, s56, 2
    v_lshl_or_b32 v25, v25, 1, s56
    v_and_b32 v26, 7, v0
    v_xor_b32 v25, v25, v26
    v_lshrrev_b32 v26, 3, v0
    v_mul_u32_u24 v26, 1152, v26
    v_lshl_add_u32 v24, v25, 4, v26
    s_and_b32 s58, s64, 0
    s_mul_i32 s58, s58, 18432
    s_mul_i32 s59, s3, 2304
    s_add_u32 s58, s58, s59
    s_add_u32 s62, s58, 0x37000
    s_add_u32 s63, s58, 0x49000
    s_mul_i32 s101, s64, 18432
    s_add_u32 s101, s101, s59
    s_add_u32 s101, s101, 0x170000
    s_branch .Lsk_b1_7
.Lst_b1_7:
    s_branch .Lrt_b1_7
.Lsk_b1_7:
    s_waitcnt lgkmcnt(0)
    s_barrier
    s_add_u32 m0, s61, 131072
    s_add_u32 s56, s100, 4128768
    buffer_load_dwordx4 v6, s[52:55], s56 offen nt lds
    s_add_u32 m0, s61, 139264
    s_add_u32 s56, s100, 4718592
    buffer_load_dwordx4 v6, s[52:55], s56 offen nt lds
    s_add_u32 m0, s61, 0
    s_nop 0
    buffer_load_dwordx4 v24, s[48:51], s69 offen offset:0 nt lds
    s_add_u32 m0, s61, 8064
    s_nop 0
    buffer_load_dwordx4 v24, s[48:51], s69 offen offset:128 nt lds
    s_add_u32 m0, s61, 16128
    s_nop 0
    buffer_load_dwordx4 v24, s[48:51], s69 offen offset:256 nt lds
    s_add_u32 m0, s61, 24192
    s_nop 0
    buffer_load_dwordx4 v24, s[48:51], s69 offen offset:384 nt lds
    s_add_u32 m0, s61, 32256
    s_nop 0
    buffer_load_dwordx4 v24, s[48:51], s69 offen offset:512 nt lds
    s_add_u32 m0, s61, 40320
    s_nop 0
    buffer_load_dwordx4 v24, s[48:51], s69 offen offset:640 nt lds
    s_add_u32 m0, s61, 48384
    s_nop 0
    buffer_load_dwordx4 v24, s[48:51], s69 offen offset:768 nt lds
    s_add_u32 m0, s61, 56448
    s_nop 0
    buffer_load_dwordx4 v24, s[48:51], s69 offen offset:896 nt lds
    s_add_u32 m0, s61, 64512
    s_nop 0
    buffer_load_dwordx4 v24, s[48:51], s69 offen offset:1024 nt lds
    v_bfe_u32 v16, v0, 1, 3
    v_mul_u32_u24 v16, 1312, v16
    v_lshrrev_b32 v25, 4, v0
    v_lshl_add_u32 v16, v25, 5, v16
    v_and_b32 v25, 1, v0
    v_lshl_add_u32 v16, v25, 4, v16
    v_add_u32 v16, 147456, v16
    s_mul_i32 s56, s3, 1312
    s_add_u32 s56, s56, 147456
    v_add_u32 v17, s56, v3
    v_add_u32 v18, s56, v4
    v_bfe_u32 v21, v0, 1, 3
    v_mul_u32_u24 v21, 144, v21
    v_bfe_u32 v25, v0, 4, 1
    v_lshl_add_u32 v21, v25, 3, v21
    v_lshrrev_b32 v25, 5, v0
    v_lshl_add_u32 v21, v25, 2, v21
    v_and_b32 v25, 1, v0
    v_lshl_add_u32 v21, v25, 1, v21
    s_lshl_b32 s56, s3, 4
    s_add_u32 s56, s56, 157952
    v_add_u32 v21, s56, v21
    v_and_b32 v22, 15, v0
    v_lshlrev_b32 v22, 3, v22
    s_mul_i32 s56, s3, 144
    s_add_u32 s56, s56, 157952
    v_add_u32 v22, s56, v22
    s_mul_i32 s56, s3, 1312
    s_add_u32 s56, s56, 147456
    v_mov_b32 v17, s56
    v_bfe_u32 v25, v0, 4, 2
    v_lshl_add_u32 v17, v25, 7, v17
    v_bfe_u32 v25, v0, 1, 1
    v_lshl_add_u32 v17, v25, 6, v17
    v_bfe_u32 v25, v0, 3, 1
    v_lshl_add_u32 v17, v25, 5, v17
    v_bfe_u32 v25, v0, 2, 1
    v_lshl_add_u32 v17, v25, 3, v17
    v_bfe_u32 v25, v0, 0, 1
    v_lshl_add_u32 v17, v25, 2, v17
    s_add_u32 s56, s56, 1024
    v_mov_b32 v18, s56
    v_bfe_u32 v25, v0, 2, 1
    v_lshl_add_u32 v18, v25, 6, v18
    v_bfe_u32 v25, v0, 4, 1
    v_lshl_add_u32 v18, v25, 5, v18
    v_bfe_u32 v25, v0, 0, 1
    v_lshl_add_u32 v18, v25, 4, v18
    v_bfe_u32 v25, v0, 3, 1
    v_lshl_add_u32 v18, v25, 3, v18
    v_bfe_u32 v25, v0, 1, 1
    v_lshl_add_u32 v18, v25, 2, v18
    v_lshrrev_b32 v25, 3, v0
    v_mul_u32_u24 v21, 144, v25
    v_and_b32 v25, 7, v0
    v_lshl_add_u32 v21, v25, 1, v21
    s_lshl_b32 s56, s3, 4
    v_lshrrev_b32 v25, 3, v0
    v_mul_u32_u24 v26, 144, v25
    v_mov_b32 v21, v26
    v_bfe_u32 v25, v0, 1, 1
    v_lshl_add_u32 v21, v25, 4, v21
    v_bfe_u32 v25, v0, 2, 1
    v_lshl_add_u32 v21, v25, 2, v21
    v_bfe_u32 v25, v0, 0, 1
    v_lshl_add_u32 v21, v25, 1, v21
    s_and_b32 s57, s3, 1
    s_lshl_b32 s57, s57, 3
    s_sub_u32 s56, s56, s57
    s_add_u32 s56, s56, 157952
    v_add_u32 v21, s56, v21
    v_mov_b32 v156, 0x4444
    v_mov_b32 v25, 0xeeee
    v_cndmask_b32 v156, v156, v25, s[96:97]
    v_mov_b32 v152, 0
    v_mov_b32 v153, 0
    v_mov_b32 v154, 0
    v_mov_b32 v155, 0
    v_mov_b32 v232, 0
    v_mov_b32 v233, 0
    v_mov_b32 v234, 0
    v_mov_b32 v235, 0
    v_mov_b32 v236, 0
    v_mov_b32 v237, 0
    v_mov_b32 v238, 0
    v_mov_b32 v239, 0
    v_mov_b32 v240, 0
    v_mov_b32 v241, 0
    v_mov_b32 v242, 0
    v_mov_b32 v243, 0
    v_mov_b32 v244, 0
    v_mov_b32 v245, 0
    v_mov_b32 v246, 0
    v_mov_b32 v247, 0
    v_mov_b32 v248, 0
    v_mov_b32 v249, 0
    v_mov_b32 v250, 0
    v_mov_b32 v251, 0
    v_mov_b32 v252, 0
    v_mov_b32 v253, 0
    v_mov_b32 v254, 0
    v_mov_b32 v255, 0
    s_mov_b32 s56, 157952
    v_bfe_u32 v22, v0, 1, 3
    v_mul_u32_u24 v22, 144, v22
    v_and_b32 v25, 48, v0
    v_lshl_add_u32 v22, v25, 1, v22
    v_and_b32 v25, 1, v0
    v_lshlrev_b32 v25, 4, v25
    v_add3_u32 v22, v22, v25, s56
    v_lshrrev_b32 v23, 4, v0
    v_and_b32 v25, 1, v0
    v_lshl_add_u32 v23, v23, 1, v25
    v_mul_u32_u24 v23, 9216, v23
    v_bfe_u32 v25, v0, 1, 3
    v_lshl_add_u32 v23, v25, 4, v23
    v_lshrrev_b32 v25, 4, v0
    v_bfe_u32 v26, v0, 2, 2
    v_lshl_add_u32 v28, v25, 3, v26
    v_lshlrev_b32 v28, 7, v28
    v_and_b32 v25, 1, v25
    v_lshrrev_b32 v26, 1, v26
    v_lshl_add_u32 v25, v25, 1, v26
    s_and_b32 s56, s3, 1
    s_lshl_b32 s56, s56, 1
    v_xor_b32 v25, s56, v25
    v_and_b32 v26, 3, v0
    v_lshl_add_u32 v28, v26, 3, v28
    s_lshr_b32 s56, s3, 1
    s_lshl_b32 s56, s56, 13
    v_add_u32 v28, s56, v28
    v_xor_b32 v26, 1, v25
    v_lshl_add_u32 v29, v26, 5, v28
    v_lshl_add_u32 v28, v25, 5, v28
    v_add_u32 v30, 0x10000, v28
    v_add_u32 v31, 0x10000, v29
    s_mul_i32 s59, s3, 73728
    s_lshl_b32 s56, s99, 7
    s_branch .Lsk_b2_0
.Lst_b2_0:
    s_branch .Lrt_b2_0
.Lsk_b2_0:
    s_add_u32 s59, s59, s56
    s_add_u32 s59, s59, 0x1a0000
    s_add_u32 s99, s59, 589824
    s_add_u32 s100, s59, 1179648
    s_lshl4_add_u32 s6, s64, s65
    s_lshl4_add_u32 s6, s6, 0xca3f70
    s_branch .gpc_210
.gp_209:
    buffer_load_dwordx4 v[32:35], v2, s[36:39], s62 offen offset:0 sc1
    buffer_load_dwordx4 v[40:43], v2, s[36:39], s62 offen offset:1024 sc1
    buffer_load_dwordx2 v[48:49], v5, s[36:39], s62 offen offset:0 sc1
    buffer_load_dwordx4 v[56:59], v2, s[36:39], s63 offen offset:0 sc1
    buffer_load_dwordx4 v[64:67], v2, s[36:39], s63 offen offset:1024 sc1
    buffer_load_dwordx2 v[72:73], v5, s[36:39], s63 offen offset:0 sc1
    s_waitcnt vmcnt(0)
.gpc_210:
    v_min_u32 v25, v33, v35
    v_max_u32 v26, v33, v35
    v_min3_u32 v25, v25, v41, v43
    v_max3_u32 v26, v26, v41, v43
    v_min3_u32 v25, v25, v49, v57
    v_max3_u32 v26, v26, v49, v57
    v_min3_u32 v25, v25, v59, v65
    v_max3_u32 v26, v26, v59, v65
    v_min3_u32 v25, v25, v67, v73
    v_max3_u32 v26, v26, v67, v73
    v_cmp_eq_u32 vcc, s34, v25
    v_cmp_eq_u32 s[56:57], s34, v26
    s_and_b64 vcc, vcc, s[56:57]
    s_cmp_eq_u64 vcc, -1
    s_nop 2
    s_cbranch_scc1 .gpd_211
    s_sub_u32 s35, s35, 1
    s_cbranch_scc1 .Lexit
    s_sleep 2
    s_branch .gp_209
.gpd_211:
    v_lshlrev_b32 v78, 16, v32
    v_and_b32 v79, 0xffff0000, v32
    v_lshlrev_b32 v88, 16, v56
    v_and_b32 v89, 0xffff0000, v56
    v_lshlrev_b32 v80, 16, v34
    v_and_b32 v81, 0xffff0000, v34
    v_lshlrev_b32 v90, 16, v58
    v_and_b32 v91, 0xffff0000, v58
    v_lshlrev_b32 v82, 16, v40
    v_and_b32 v83, 0xffff0000, v40
    v_lshlrev_b32 v92, 16, v64
    v_and_b32 v93, 0xffff0000, v64
    v_lshlrev_b32 v84, 16, v42
    v_and_b32 v85, 0xffff0000, v42
    v_lshlrev_b32 v94, 16, v66
    v_and_b32 v95, 0xffff0000, v66
    v_lshlrev_b32 v86, 16, v48
    v_and_b32 v87, 0xffff0000, v48
    v_lshlrev_b32 v96, 16, v72
    v_and_b32 v97, 0xffff0000, v72
    s_waitcnt vmcnt(9)
    s_barrier
    ds_read_b64_tr_b16 v[164:165], v19 offset:0
    ds_read_b64_tr_b16 v[166:167], v19 offset:512
    ds_read_b64_tr_b16 v[172:173], v19 offset:8192
    ds_read_b64_tr_b16 v[174:175], v19 offset:8704
    ds_read_b64_tr_b16 v[180:181], v19 offset:16384
    ds_read_b64_tr_b16 v[182:183], v19 offset:16896
    ds_read_b64_tr_b16 v[188:189], v19 offset:24576
    ds_read_b64_tr_b16 v[190:191], v19 offset:25088
    ds_read_b64_tr_b16 v[196:197], v20 offset:0
    ds_read_b64_tr_b16 v[198:199], v20 offset:512
    ds_read_b64_tr_b16 v[204:205], v20 offset:8192
    ds_read_b64_tr_b16 v[206:207], v20 offset:8704
    ds_read_b64_tr_b16 v[212:213], v20 offset:16384
    ds_read_b64_tr_b16 v[214:215], v20 offset:16896
    ds_read_b64_tr_b16 v[220:221], v20 offset:24576
    ds_read_b64_tr_b16 v[222:223], v20 offset:25088
    ds_read_b64_tr_b16 v[228:229], v20 offset:32768
    ds_read_b64_tr_b16 v[230:231], v20 offset:33280
    s_waitcnt lgkmcnt(0)
    v_mov_b32 v8, v160
    v_mov_b32 v9, v161
    v_mov_b32 v10, v162
    v_mov_b32 v11, v163
    v_mov_b32_dpp v160, v164 row_ror:8 row_mask:0xf bank_mask:0xc
    v_mov_b32_dpp v161, v165 row_ror:8 row_mask:0xf bank_mask:0xc
    v_mov_b32_dpp v162, v166 row_ror:8 row_mask:0xf bank_mask:0xc
    v_mov_b32_dpp v163, v167 row_ror:8 row_mask:0xf bank_mask:0xc
    v_mov_b32_dpp v164, v8 row_ror:8 row_mask:0xf bank_mask:0x3
    v_mov_b32_dpp v165, v9 row_ror:8 row_mask:0xf bank_mask:0x3
    v_mov_b32_dpp v166, v10 row_ror:8 row_mask:0xf bank_mask:0x3
    v_mov_b32_dpp v167, v11 row_ror:8 row_mask:0xf bank_mask:0x3
    v_mov_b32 v8, v168
    v_mov_b32 v9, v169
    v_mov_b32 v10, v170
    v_mov_b32 v11, v171
    v_mov_b32_dpp v168, v172 row_ror:8 row_mask:0xf bank_mask:0xc
    v_mov_b32_dpp v169, v173 row_ror:8 row_mask:0xf bank_mask:0xc
    v_mov_b32_dpp v170, v174 row_ror:8 row_mask:0xf bank_mask:0xc
    v_mov_b32_dpp v171, v175 row_ror:8 row_mask:0xf bank_mask:0xc
    v_mov_b32_dpp v172, v8 row_ror:8 row_mask:0xf bank_mask:0x3
    v_mov_b32_dpp v173, v9 row_ror:8 row_mask:0xf bank_mask:0x3
    v_mov_b32_dpp v174, v10 row_ror:8 row_mask:0xf bank_mask:0x3
    v_mov_b32_dpp v175, v11 row_ror:8 row_mask:0xf bank_mask:0x3
    v_mov_b32 v8, v176
    v_mov_b32 v9, v177
    v_mov_b32 v10, v178
    v_mov_b32 v11, v179
    v_mov_b32_dpp v176, v180 row_ror:8 row_mask:0xf bank_mask:0xc
    v_mov_b32_dpp v177, v181 row_ror:8 row_mask:0xf bank_mask:0xc
    v_mov_b32_dpp v178, v182 row_ror:8 row_mask:0xf bank_mask:0xc
    v_mov_b32_dpp v179, v183 row_ror:8 row_mask:0xf bank_mask:0xc
    v_mov_b32_dpp v180, v8 row_ror:8 row_mask:0xf bank_mask:0x3
    v_mov_b32_dpp v181, v9 row_ror:8 row_mask:0xf bank_mask:0x3
    v_mov_b32_dpp v182, v10 row_ror:8 row_mask:0xf bank_mask:0x3
    v_mov_b32_dpp v183, v11 row_ror:8 row_mask:0xf bank_mask:0x3
    v_mov_b32 v8, v184
    v_mov_b32 v9, v185
    v_mov_b32 v10, v186
    v_mov_b32 v11, v187
    v_mov_b32_dpp v184, v188 row_ror:8 row_mask:0xf bank_mask:0xc
    v_mov_b32_dpp v185, v189 row_ror:8 row_mask:0xf bank_mask:0xc
    v_mov_b32_dpp v186, v190 row_ror:8 row_mask:0xf bank_mask:0xc
    v_mov_b32_dpp v187, v191 row_ror:8 row_mask:0xf bank_mask:0xc
    v_mov_b32_dpp v188, v8 row_ror:8 row_mask:0xf bank_mask:0x3
    v_mov_b32_dpp v189, v9 row_ror:8 row_mask:0xf bank_mask:0x3
    v_mov_b32_dpp v190, v10 row_ror:8 row_mask:0xf bank_mask:0x3
    v_mov_b32_dpp v191, v11 row_ror:8 row_mask:0xf bank_mask:0x3
    v_mov_b32 v8, v192
    v_mov_b32 v9, v193
    v_mov_b32 v10, v194
    v_mov_b32 v11, v195
    v_mov_b32_dpp v192, v196 row_ror:8 row_mask:0xf bank_mask:0xc
    v_mov_b32_dpp v193, v197 row_ror:8 row_mask:0xf bank_mask:0xc
    v_mov_b32_dpp v194, v198 row_ror:8 row_mask:0xf bank_mask:0xc
    v_mov_b32_dpp v195, v199 row_ror:8 row_mask:0xf bank_mask:0xc
    v_mov_b32_dpp v196, v8 row_ror:8 row_mask:0xf bank_mask:0x3
    v_mov_b32_dpp v197, v9 row_ror:8 row_mask:0xf bank_mask:0x3
    v_mov_b32_dpp v198, v10 row_ror:8 row_mask:0xf bank_mask:0x3
    v_mov_b32_dpp v199, v11 row_ror:8 row_mask:0xf bank_mask:0x3
    v_mov_b32 v8, v200
    v_mov_b32 v9, v201
    v_mov_b32 v10, v202
    v_mov_b32 v11, v203
    v_mov_b32_dpp v200, v204 row_ror:8 row_mask:0xf bank_mask:0xc
    v_mov_b32_dpp v201, v205 row_ror:8 row_mask:0xf bank_mask:0xc
    v_mov_b32_dpp v202, v206 row_ror:8 row_mask:0xf bank_mask:0xc
    v_mov_b32_dpp v203, v207 row_ror:8 row_mask:0xf bank_mask:0xc
    v_mov_b32_dpp v204, v8 row_ror:8 row_mask:0xf bank_mask:0x3
    v_mov_b32_dpp v205, v9 row_ror:8 row_mask:0xf bank_mask:0x3
    v_mov_b32_dpp v206, v10 row_ror:8 row_mask:0xf bank_mask:0x3
    v_mov_b32_dpp v207, v11 row_ror:8 row_mask:0xf bank_mask:0x3
    v_mov_b32 v8, v208
    v_mov_b32 v9, v209
    v_mov_b32 v10, v210
    v_mov_b32 v11, v211
    v_mov_b32_dpp v208, v212 row_ror:8 row_mask:0xf bank_mask:0xc
    v_mov_b32_dpp v209, v213 row_ror:8 row_mask:0xf bank_mask:0xc
    v_mov_b32_dpp v210, v214 row_ror:8 row_mask:0xf bank_mask:0xc
    v_mov_b32_dpp v211, v215 row_ror:8 row_mask:0xf bank_mask:0xc
    v_mov_b32_dpp v212, v8 row_ror:8 row_mask:0xf bank_mask:0x3
    v_mov_b32_dpp v213, v9 row_ror:8 row_mask:0xf bank_mask:0x3
    v_mov_b32_dpp v214, v10 row_ror:8 row_mask:0xf bank_mask:0x3
    v_mov_b32_dpp v215, v11 row_ror:8 row_mask:0xf bank_mask:0x3
    v_mov_b32 v8, v216
    v_mov_b32 v9, v217
    v_mov_b32 v10, v218
    v_mov_b32 v11, v219
    v_mov_b32_dpp v216, v220 row_ror:8 row_mask:0xf bank_mask:0xc
    v_mov_b32_dpp v217, v221 row_ror:8 row_mask:0xf bank_mask:0xc
    s_branch .Lsk_b2_1
.Lst_b2_1:
    s_branch .Lrt_b2_1
.Lsk_b2_1:
    v_mov_b32_dpp v218, v222 row_ror:8 row_mask:0xf bank_mask:0xc
    v_mov_b32_dpp v219, v223 row_ror:8 row_mask:0xf bank_mask:0xc
    v_mov_b32_dpp v220, v8 row_ror:8 row_mask:0xf bank_mask:0x3
    v_mov_b32_dpp v221, v9 row_ror:8 row_mask:0xf bank_mask:0x3
    v_mov_b32_dpp v222, v10 row_ror:8 row_mask:0xf bank_mask:0x3
    v_mov_b32_dpp v223, v11 row_ror:8 row_mask:0xf bank_mask:0x3
    v_mov_b32 v8, v224
    v_mov_b32 v9, v225
    v_mov_b32 v10, v226
    v_mov_b32 v11, v227
    v_mov_b32_dpp v224, v228 row_ror:8 row_mask:0xf bank_mask:0xc
    v_mov_b32_dpp v225, v229 row_ror:8 row_mask:0xf bank_mask:0xc
    v_mov_b32_dpp v226, v230 row_ror:8 row_mask:0xf bank_mask:0xc
    v_mov_b32_dpp v227, v231 row_ror:8 row_mask:0xf bank_mask:0xc
    v_mov_b32_dpp v228, v8 row_ror:8 row_mask:0xf bank_mask:0x3
    v_mov_b32_dpp v229, v9 row_ror:8 row_mask:0xf bank_mask:0x3
    v_mov_b32_dpp v230, v10 row_ror:8 row_mask:0xf bank_mask:0x3
    v_mov_b32_dpp v231, v11 row_ror:8 row_mask:0xf bank_mask:0x3
    s_waitcnt vmcnt(0)
    s_add_u32 s58, s101, s0
    buffer_load_dwordx4 v[68:71], v2, s[36:39], s58 offen offset:0 sc1
    buffer_load_dwordx4 v[72:75], v2, s[36:39], s58 offen offset:1024 sc1
    buffer_load_dwordx2 v[76:77], v5, s[36:39], s58 offen offset:0 sc1
    s_barrier
    ds_read_b64_tr_b16 v[104:105], v28 offset:0
    ds_read_b64_tr_b16 v[106:107], v28 offset:512
    ds_read_b64_tr_b16 v[112:113], v29 offset:0
    ds_read_b64_tr_b16 v[114:115], v29 offset:512
    ds_read_b64_tr_b16 v[108:109], v28 offset:4096
    ds_read_b64_tr_b16 v[110:111], v28 offset:4608
    ds_read_b64_tr_b16 v[116:117], v29 offset:4096
    ds_read_b64_tr_b16 v[118:119], v29 offset:4608
    ds_read_b64_tr_b16 v[120:121], v28 offset:32768
    ds_read_b64_tr_b16 v[122:123], v28 offset:33280
    ds_read_b64_tr_b16 v[128:129], v29 offset:32768
    ds_read_b64_tr_b16 v[130:131], v29 offset:33280
    ds_read_b64_tr_b16 v[124:125], v28 offset:36864
    ds_read_b64_tr_b16 v[126:127], v28 offset:37376
    ds_read_b64_tr_b16 v[132:133], v29 offset:36864
    ds_read_b64_tr_b16 v[134:135], v29 offset:37376
    s_cmp_ge_u32 s3, 2
    s_cbranch_scc1 .Lbc_nodn3
    ds_read_b64_tr_b16 v[136:137], v30 offset:0
    ds_read_b64_tr_b16 v[138:139], v30 offset:512
    ds_read_b64_tr_b16 v[144:145], v31 offset:0
    ds_read_b64_tr_b16 v[146:147], v31 offset:512
    ds_read_b64_tr_b16 v[140:141], v30 offset:4096
    ds_read_b64_tr_b16 v[142:143], v30 offset:4608
    ds_read_b64_tr_b16 v[148:149], v31 offset:4096
    ds_read_b64_tr_b16 v[150:151], v31 offset:4608
.Lbc_nodn3:
    s_branch .Lsk_b2_2
    .fill 115, 4, 0xbf800000
.Lst_b2_2:
    s_branch .Lrt_b2_2
.Lsk_b2_2:
    s_mov_b32 s69, 0
    s_branch .gpc_214
.gp_212:
    s_add_u32 s69, s69, 1
    s_and_b32 s56, s69, 0x41
    s_cmp_lg_u32 s56, 0x41
    s_cselect_b32 s56, 0, 0x800000
    s_xor_b32 s56, s56, s0
    s_add_u32 s58, s101, s56
    buffer_load_dwordx4 v[68:71], v2, s[36:39], s58 offen offset:0 sc1
    buffer_load_dwordx4 v[72:75], v2, s[36:39], s58 offen offset:1024 sc1
    buffer_load_dwordx2 v[76:77], v5, s[36:39], s58 offen offset:0 sc1
.gpc_214:
    s_waitcnt vmcnt(0)
    v_min3_u32 v25, v69, v71, v73
    v_max3_u32 v26, v69, v71, v73
    v_min3_u32 v25, v25, v75, v77
    v_max3_u32 v26, v26, v75, v77
    v_cmp_eq_u32 vcc, s34, v25
    v_cmp_eq_u32 s[56:57], s34, v26
    s_and_b64 vcc, vcc, s[56:57]
    s_cmp_eq_u64 vcc, -1
    s_nop 2
    s_cbranch_scc1 .gpd_213
    s_sub_u32 s35, s35, 1
    s_cbranch_scc1 .Lexit
    s_branch .gp_212
.gpd_213:
    s_mov_b32 s56, 0x3f803f80
    v_dot2_f32_bf16 v98, v68, s56, 0
    v_dot2_f32_bf16 v99, v68, v68, 0
    v_dot2_f32_bf16 v98, v70, s56, v98
    v_dot2_f32_bf16 v99, v70, v70, v99
    v_dot2_f32_bf16 v98, v72, s56, v98
    v_dot2_f32_bf16 v99, v72, v72, v99
    v_dot2_f32_bf16 v98, v74, s56, v98
    v_dot2_f32_bf16 v99, v74, v74, v99
    s_mov_b64 exec, 0xffffffff
    v_dot2_f32_bf16 v98, v76, s56, v98
    v_dot2_f32_bf16 v99, v76, v76, v99
    s_mov_b64 exec, -1
    s_nop 1
    v_permlane32_swap_b32 v98, v99
    v_add_f32 v98, v98, v99
    v_mov_b32 v100, v98
    s_nop 1
    v_permlane16_swap_b32 v100, v98
    v_add_f32 v98, v100, v98
    v_and_b32 v69, 0xffff0000, v68
    v_lshlrev_b32 v68, 16, v68
    v_add_f32_dpp v98, v98, v98 row_ror:8 row_mask:0xf bank_mask:0xf
    v_and_b32 v71, 0xffff0000, v70
    v_lshlrev_b32 v70, 16, v70
    v_add_f32_dpp v98, v98, v98 row_ror:4 row_mask:0xf bank_mask:0xf
    v_and_b32 v73, 0xffff0000, v72
    v_lshlrev_b32 v72, 16, v72
    v_add_f32_dpp v98, v98, v98 quad_perm:[2,3,0,1] row_mask:0xf bank_mask:0xf
    v_and_b32 v75, 0xffff0000, v74
    v_lshlrev_b32 v74, 16, v74
    v_add_f32_dpp v98, v98, v98 quad_perm:[1,0,3,2] row_mask:0xf bank_mask:0xf
    v_mul_f32 v98, 0x3ae38e39, v98
    v_and_b32 v77, 0xffff0000, v76
    v_lshlrev_b32 v76, 16, v76
    v_readlane_b32 s56, v98, 0
    v_readlane_b32 s57, v98, 32
    s_nop 0
    v_mov_b32 v98, s56
    v_fma_f32 v99, -v98, v98, s57
    v_max_f32 v99, 0, v99
    v_cvt_pk_bf16_f32 v100, -v98, v99
    v_and_b32 v101, 0xffff0000, v100
    v_add_f32 v101, 0x3727c5ac, v101
    v_lshlrev_b32 v98, 16, v100
    v_cvt_pk_bf16_f32 v101, v101, v101
    v_lshlrev_b32 v101, 16, v101
    v_sqrt_f32 v101, v101
    v_mov_b32 v99, v98
    v_cvt_pk_bf16_f32 v101, v101, v101
    v_lshlrev_b32 v101, 16, v101
    v_rcp_f32 v100, v101
    v_rcp_f32 v101, v101
    v_pk_add_f32 v[68:69], v[68:69], v[98:99]
    v_pk_add_f32 v[70:71], v[70:71], v[98:99]
    v_pk_add_f32 v[72:73], v[72:73], v[98:99]
    v_pk_add_f32 v[74:75], v[74:75], v[98:99]
    v_pk_add_f32 v[76:77], v[76:77], v[98:99]
    v_cvt_pk_bf16_f32 v68, v68, v69
    v_and_b32 v69, 0xffff0000, v68
    v_lshlrev_b32 v68, 16, v68
    v_cvt_pk_bf16_f32 v70, v70, v71
    v_and_b32 v71, 0xffff0000, v70
    v_lshlrev_b32 v70, 16, v70
    v_cvt_pk_bf16_f32 v72, v72, v73
    v_and_b32 v73, 0xffff0000, v72
    v_lshlrev_b32 v72, 16, v72
    v_cvt_pk_bf16_f32 v74, v74, v75
    v_and_b32 v75, 0xffff0000, v74
    v_lshlrev_b32 v74, 16, v74
    v_cvt_pk_bf16_f32 v76, v76, v77
    v_and_b32 v77, 0xffff0000, v76
    v_lshlrev_b32 v76, 16, v76
    v_pk_mul_f32 v[68:69], v[68:69], v[100:101]
    v_pk_mul_f32 v[70:71], v[70:71], v[100:101]
    v_pk_mul_f32 v[72:73], v[72:73], v[100:101]
    v_pk_mul_f32 v[74:75], v[74:75], v[100:101]
    v_pk_mul_f32 v[76:77], v[76:77], v[100:101]
    v_cvt_pk_bf16_f32 v68, v68, v69
    v_and_b32 v69, 0xffff0000, v68
    v_lshlrev_b32 v68, 16, v68
    v_cvt_pk_bf16_f32 v70, v70, v71
    v_and_b32 v71, 0xffff0000, v70
    v_lshlrev_b32 v70, 16, v70
    v_cvt_pk_bf16_f32 v72, v72, v73
    v_and_b32 v73, 0xffff0000, v72
    v_lshlrev_b32 v72, 16, v72
    v_cvt_pk_bf16_f32 v74, v74, v75
    v_and_b32 v75, 0xffff0000, v74
    v_lshlrev_b32 v74, 16, v74
    v_cvt_pk_bf16_f32 v76, v76, v77
    v_and_b32 v77, 0xffff0000, v76
    v_lshlrev_b32 v76, 16, v76
    v_pk_mul_f32 v[68:69], v[68:69], v[88:89]
    v_pk_mul_f32 v[70:71], v[70:71], v[90:91]
    v_pk_mul_f32 v[72:73], v[72:73], v[92:93]
    v_pk_mul_f32 v[74:75], v[74:75], v[94:95]
    v_pk_mul_f32 v[76:77], v[76:77], v[96:97]
    v_cvt_pk_bf16_f32 v68, v68, v69
    v_and_b32 v69, 0xffff0000, v68
    v_lshlrev_b32 v68, 16, v68
    v_cvt_pk_bf16_f32 v70, v70, v71
    v_and_b32 v71, 0xffff0000, v70
    v_lshlrev_b32 v70, 16, v70
    v_cvt_pk_bf16_f32 v72, v72, v73
    v_and_b32 v73, 0xffff0000, v72
    v_lshlrev_b32 v72, 16, v72
    v_cvt_pk_bf16_f32 v74, v74, v75
    v_and_b32 v75, 0xffff0000, v74
    v_lshlrev_b32 v74, 16, v74
    v_cvt_pk_bf16_f32 v76, v76, v77
    v_and_b32 v77, 0xffff0000, v76
    v_lshlrev_b32 v76, 16, v76
    v_pk_add_f32 v[68:69], v[68:69], v[78:79]
    v_pk_add_f32 v[70:71], v[70:71], v[80:81]
    v_pk_add_f32 v[72:73], v[72:73], v[82:83]
    v_pk_add_f32 v[74:75], v[74:75], v[84:85]
    v_pk_add_f32 v[76:77], v[76:77], v[86:87]
    v_cvt_pk_bf16_f32 v8, v68, v69
    v_cvt_pk_bf16_f32 v9, v70, v71
    v_cvt_pk_bf16_f32 v10, v72, v73
    v_cvt_pk_bf16_f32 v11, v74, v75
    v_cvt_pk_bf16_f32 v12, v76, v77
    ds_write2_b32 v17, v8, v9 offset0:0 offset1:4
    ds_write2_b32 v17, v10, v11 offset0:128 offset1:132
    ds_write_b32 v18, v12
    s_branch .Lsk_b2_3
    .fill 20, 4, 0xbf800000
.Lst_b2_3:
    s_branch .Lrt_b2_3
.Lsk_b2_3:
    s_waitcnt lgkmcnt(0)
    s_barrier
    ds_read_b128 v[32:35], v16 offset:0
    ds_read_b128 v[36:39], v16 offset:128
    ds_read_b128 v[40:43], v16 offset:256
    ds_read_b128 v[44:47], v16 offset:384
    ds_read_b128 v[48:51], v16 offset:512
    ds_read_b128 v[52:55], v16 offset:640
    ds_read_b128 v[56:59], v16 offset:768
    ds_read_b128 v[60:63], v16 offset:896
    ds_read_b128 v[64:67], v16 offset:1024
    s_waitcnt lgkmcnt(8)
    v_smfmac_f32_16x16x64_bf16 v[152:155], v[32:35], v[160:167], v156
    s_waitcnt lgkmcnt(7)
    v_smfmac_f32_16x16x64_bf16 v[152:155], v[36:39], v[168:175], v156
    s_waitcnt lgkmcnt(6)
    v_smfmac_f32_16x16x64_bf16 v[152:155], v[40:43], v[176:183], v156
    s_waitcnt lgkmcnt(5)
    v_smfmac_f32_16x16x64_bf16 v[152:155], v[44:47], v[184:191], v156
    s_waitcnt lgkmcnt(4)
    v_smfmac_f32_16x16x64_bf16 v[152:155], v[48:51], v[192:199], v156
    s_waitcnt lgkmcnt(3)
    v_smfmac_f32_16x16x64_bf16 v[152:155], v[52:55], v[200:207], v156
    s_waitcnt lgkmcnt(2)
    v_smfmac_f32_16x16x64_bf16 v[152:155], v[56:59], v[208:215], v156
    s_waitcnt lgkmcnt(1)
    v_smfmac_f32_16x16x64_bf16 v[152:155], v[60:63], v[216:223], v156
    s_waitcnt lgkmcnt(0)
    v_smfmac_f32_16x16x64_bf16 v[152:155], v[64:67], v[224:231], v156
    s_nop 7
    v_add_f32 v12, v152, v153
    v_add_f32 v13, v154, v155
    v_cvt_pk_bf16_f32 v13, v12, v13
    v_lshlrev_b32 v12, 16, v13
    v_and_b32 v14, 0xffff0000, v13
    v_mov_b32 v13, v14
    s_nop 0
    v_mov_b32_dpp v14, v12 row_ror:8 row_mask:0xf bank_mask:0x3
    v_mov_b32_dpp v12, v13 row_ror:8 row_mask:0xf bank_mask:0xc
    v_max_f32 v12, 0xc2ae0000, v12
    v_min_f32 v27, 0x43000000, v12
    v_mul_f32 v25, 0xbfb8aa3b, v27
    v_fma_f32 v26, v27, s98, -v25
    v_fmac_f32 v26, 0xb2a57060, v27
    v_exp_f32 v25, v25
    v_mul_f32 v26, 0x3f317218, v26
    v_fmac_f32 v25, v25, v26
    v_add_f32 v25, 1.0, v25
    v_rcp_f32 v26, v25
    s_nop 0
    v_mul_f32 v27, v12, v26
    v_fma_f32 v25, -v27, v25, v12
    v_fma_f32 v12, v25, v26, v27
    v_cvt_pk_bf16_f32 v12, v12, v12
    v_lshlrev_b32 v12, 16, v12
    v_mul_f32 v12, v12, v14
    v_cvt_pk_bf16_f32 v12, v12, v12
    ds_write_b16 v21, v12
    s_mov_b32 s60, 0x07060503
    s_mov_b32 s61, 0x07060502
    s_mov_b32 s62, 0x07060501
    s_mov_b32 vcc_lo, 0x55555555
    s_mov_b32 vcc_hi, 0x55555555
    v_mov_b32 v59, s34
    v_mov_b32 v63, s34
    v_mov_b32 v67, s34
    s_cmp_ge_u32 s3, 2
    s_waitcnt lgkmcnt(0)
    s_barrier
    ds_read_b128 v[8:11], v22
    s_waitcnt lgkmcnt(0)
    v_smfmac_f32_16x16x64_bf16 v[232:235], v[8:11], v[104:111], v156
    v_smfmac_f32_16x16x64_bf16 v[236:239], v[8:11], v[112:119], v156
    v_smfmac_f32_16x16x64_bf16 v[240:243], v[8:11], v[120:127], v156
    v_smfmac_f32_16x16x64_bf16 v[244:247], v[8:11], v[128:135], v156
    s_cbranch_scc0 .Lbc_three
    s_nop 4
    v_add_f32 v232, v232, v233
    v_add_f32 v234, v234, v235
    v_add_f32 v236, v236, v237
    v_add_f32 v238, v238, v239
    s_not_b64 vcc, vcc
    v_cndmask_b32_dpp v233, v232, v234, vcc quad_perm:[1,0,3,2] row_mask:0xf bank_mask:0xf
    v_cndmask_b32_dpp v235, v236, v238, vcc quad_perm:[1,0,3,2] row_mask:0xf bank_mask:0xf
    s_not_b64 vcc, vcc
    v_cndmask_b32_dpp v232, v234, v232, vcc quad_perm:[1,0,3,2] row_mask:0xf bank_mask:0xf
    v_cndmask_b32_dpp v234, v238, v236, vcc quad_perm:[1,0,3,2] row_mask:0xf bank_mask:0xf
    v_perm_b32 v56, v232, v235, s60
    v_perm_b32 v57, v233, v235, s61
    v_perm_b32 v58, v234, v235, s62
    buffer_store_dwordx4 v[56:59], v23, s[36:39], s59 offen sc1
    v_add_f32 v240, v240, v241
    v_add_f32 v242, v242, v243
    v_add_f32 v244, v244, v245
    v_add_f32 v246, v246, v247
    s_not_b64 vcc, vcc
    v_cndmask_b32_dpp v241, v240, v242, vcc quad_perm:[1,0,3,2] row_mask:0xf bank_mask:0xf
    v_cndmask_b32_dpp v243, v244, v246, vcc quad_perm:[1,0,3,2] row_mask:0xf bank_mask:0xf
    s_not_b64 vcc, vcc
    v_cndmask_b32_dpp v240, v242, v240, vcc quad_perm:[1,0,3,2] row_mask:0xf bank_mask:0xf
    v_cndmask_b32_dpp v242, v246, v244, vcc quad_perm:[1,0,3,2] row_mask:0xf bank_mask:0xf
    v_perm_b32 v60, v240, v243, s60
    v_perm_b32 v61, v241, v243, s61
    v_perm_b32 v62, v242, v243, s62
    buffer_store_dwordx4 v[60:63], v23, s[36:39], s99 offen sc1
    s_nop 1
    s_branch .Lexit
.Lbc_three:
    v_smfmac_f32_16x16x64_bf16 v[248:251], v[8:11], v[136:143], v156
    v_smfmac_f32_16x16x64_bf16 v[252:255], v[8:11], v[144:151], v156
    s_nop 3
    v_add_f32 v232, v232, v233
    v_add_f32 v234, v234, v235
    v_add_f32 v236, v236, v237
    v_add_f32 v238, v238, v239
    s_not_b64 vcc, vcc
    v_cndmask_b32_dpp v233, v232, v234, vcc quad_perm:[1,0,3,2] row_mask:0xf bank_mask:0xf
    v_cndmask_b32_dpp v235, v236, v238, vcc quad_perm:[1,0,3,2] row_mask:0xf bank_mask:0xf
    s_not_b64 vcc, vcc
    v_cndmask_b32_dpp v232, v234, v232, vcc quad_perm:[1,0,3,2] row_mask:0xf bank_mask:0xf
    v_cndmask_b32_dpp v234, v238, v236, vcc quad_perm:[1,0,3,2] row_mask:0xf bank_mask:0xf
    v_perm_b32 v56, v232, v235, s60
    v_perm_b32 v57, v233, v235, s61
    v_perm_b32 v58, v234, v235, s62
    buffer_store_dwordx4 v[56:59], v23, s[36:39], s59 offen sc1
    v_add_f32 v240, v240, v241
    v_add_f32 v242, v242, v243
    v_add_f32 v244, v244, v245
    v_add_f32 v246, v246, v247
    s_not_b64 vcc, vcc
    v_cndmask_b32_dpp v241, v240, v242, vcc quad_perm:[1,0,3,2] row_mask:0xf bank_mask:0xf
    v_cndmask_b32_dpp v243, v244, v246, vcc quad_perm:[1,0,3,2] row_mask:0xf bank_mask:0xf
    s_not_b64 vcc, vcc
    v_cndmask_b32_dpp v240, v242, v240, vcc quad_perm:[1,0,3,2] row_mask:0xf bank_mask:0xf
    v_cndmask_b32_dpp v242, v246, v244, vcc quad_perm:[1,0,3,2] row_mask:0xf bank_mask:0xf
    v_perm_b32 v60, v240, v243, s60
    v_perm_b32 v61, v241, v243, s61
    v_perm_b32 v62, v242, v243, s62
    buffer_store_dwordx4 v[60:63], v23, s[36:39], s99 offen sc1
    v_add_f32 v248, v248, v249
    v_add_f32 v250, v250, v251
    v_add_f32 v252, v252, v253
    v_add_f32 v254, v254, v255
    s_not_b64 vcc, vcc
    v_cndmask_b32_dpp v249, v248, v250, vcc quad_perm:[1,0,3,2] row_mask:0xf bank_mask:0xf
    v_cndmask_b32_dpp v251, v252, v254, vcc quad_perm:[1,0,3,2] row_mask:0xf bank_mask:0xf
    s_not_b64 vcc, vcc
    v_cndmask_b32_dpp v248, v250, v248, vcc quad_perm:[1,0,3,2] row_mask:0xf bank_mask:0xf
    v_cndmask_b32_dpp v250, v254, v252, vcc quad_perm:[1,0,3,2] row_mask:0xf bank_mask:0xf
    v_perm_b32 v64, v248, v251, s60
    v_perm_b32 v65, v249, v251, s61
    v_perm_b32 v66, v250, v251, s62
    buffer_store_dwordx4 v[64:67], v23, s[36:39], s100 offen sc1
    s_cmp_eq_u32 s3, 0
    s_cselect_b64 exec, 1, 0
    buffer_store_dword v59, v2, s[36:39], s6 offen
    s_mov_b64 exec, -1
.Lexit:
.Lend:
s_endpgm
.section .rodata,"a"
.p2align 6
.amdhsa_kernel adaLN_cond__sliding_block_cached__moe_arch_mod__decode_kernel
  .amdhsa_next_free_vgpr 256
  .amdhsa_next_free_sgpr 102
  .amdhsa_accum_offset 256
  .amdhsa_group_segment_fixed_size 0
  .amdhsa_kernarg_size 120
  .amdhsa_user_sgpr_count 2
  .amdhsa_user_sgpr_kernarg_segment_ptr 1
  .amdhsa_system_sgpr_workgroup_id_x 1
.end_amdhsa_kernel
```
